```python
import torch

def _softmax(x, axis=-1):
    return torch.softmax(x, dim=axis)
def _gelu(x):
    return torch.nn.functional.gelu(x, approximate="tanh")
def _silu(x):
    return torch.nn.functional.silu(x)
def _sigmoid(x):
    return torch.sigmoid(x)
def _layernorm(x, axis=-1, eps=1e-5):
    m = x.mean(dim=axis, keepdim=True)
    v = x.var(dim=axis, keepdim=True, unbiased=False)
    return (x - m) / torch.sqrt(v + eps)
def _scatter_add(tgt, idx, src, axis=0):
    return tgt.clone().index_add_(axis, idx, src)
def _segment_sum(src, seg, n):
    out = torch.zeros((n,) + src.shape[1:], dtype=src.dtype)
    return out.index_add_(0, seg, src)
def _pad(x, pw):
    flat = tuple(v for pair in reversed(pw) for v in pair)
    return torch.nn.functional.pad(x, flat)

kernel_name = 'sequential_preLN__ssm_conv_s4d__moe_arch_mod__prompt'

def setup_inputs():

    _w = (lambda a: (lambda t: t.to(torch.bfloat16) if t.is_floating_point() else t)(torch.as_tensor(a)))
    def _A_setup():
        Bsz, L, D, N = 1, 2048, 576, 128
        return {
            "u": _w((lambda *s: torch.randn(*s, dtype=torch.bfloat16) * 0.2)(Bsz, L, D)),
            "log_A_real": _w((lambda *s: torch.randn(*s, dtype=torch.bfloat16) * 6.4)(D, N) * 0.5),
            "A_imag": _w((lambda *s: torch.randn(*s, dtype=torch.bfloat16) * 0.2)(D, N) * 3.14),
            "C_real": _w((lambda *s: torch.randn(*s, dtype=torch.bfloat16) * 0.2)(D, N) / N ** 0.5),
            "C_imag": _w((lambda *s: torch.randn(*s, dtype=torch.bfloat16) * 0.2)(D, N) / N ** 0.5),
            "log_dt": _w((lambda *s: torch.randn(*s, dtype=torch.bfloat16) * 0.2)(D) * 0.5 - 4.0),
            "D_skip": _w((lambda *s: torch.randn(*s, dtype=torch.bfloat16) * 0.2)(D)),
        }
    _A_in = _A_setup()

    def _B_setup():
        B, S, D, F, C = 1, 2048, 576, 4608, 8
        return {
            "x": _w((lambda *s: torch.randn(*s, dtype=torch.bfloat16) * 0.2)(B, S, D)),
            "w_r": _w((lambda *s: torch.randn(*s, dtype=torch.bfloat16) * 0.2)(D)),
            "w_gate": _w((lambda *s: torch.randn(*s, dtype=torch.bfloat16) * 0.2)(D, F)),
            "w_up": _w((lambda *s: torch.randn(*s, dtype=torch.bfloat16) * 0.2)(D, F)),
            "w_down": _w((lambda *s: torch.randn(*s, dtype=torch.bfloat16) * 0.2)(F, D)),
        }
    _B_in = _B_setup()

    return {
        "A_u": _A_in["u"],
        "A_log_A_real": _A_in["log_A_real"],
        "A_A_imag": _A_in["A_imag"],
        "A_C_real": _A_in["C_real"],
        "A_C_imag": _A_in["C_imag"],
        "A_log_dt": _A_in["log_dt"],
        "A_D_skip": _A_in["D_skip"],
        "B_x": _B_in["x"],
        "B_w_r": _B_in["w_r"],
        "B_w_gate": _B_in["w_gate"],
        "B_w_up": _B_in["w_up"],
        "B_w_down": _B_in["w_down"],
    }

def reference(A_u, A_log_A_real, A_A_imag, A_C_real, A_C_imag, A_log_dt, A_D_skip, B_x, B_w_r, B_w_gate, B_w_up, B_w_down):
    def _A_ref(u, log_A_real, A_imag, C_real, C_imag, log_dt, D_skip):
        L = u.shape[1]
        dt = torch.exp(log_dt)
        A = -torch.exp(log_A_real) + 1j * A_imag
        C = (C_real + 1j * C_imag) * dt[:, None]
        pos = (lambda x, dt: x.to(dt))(torch.arange(L), log_dt.dtype)
        P = torch.exp((A * dt[:, None])[:, :, None] * pos[None, None, :])
        K = 2.0 * torch.einsum("dn,dnl->dl", C, P).real
        L2 = 2 * L
        u_t = (lambda x, *d: x.permute(*d))(u, 0, 2, 1)
        Kf = (lambda x, *a, **k: torch.fft.rfft(x.float(), *a, **k))(K, L2)
        Uf = (lambda x, *a, **k: torch.fft.rfft(x.float(), *a, **k))(u_t, L2)
        y = (lambda x, *a, **k: torch.fft.irfft(x, *a, **k).to(torch.bfloat16))(Uf * Kf[None, :, :], L2)[:, :, :L]
        y = (lambda x, *d: x.permute(*d))(y, 0, 2, 1)
        return y + u * D_skip[None, None, :]

    def _B_ref(x, w_r, w_gate, w_up, w_down):
        B, S, D = x.shape
        C = 8
        r = x @ w_r
        idx = torch.argsort(-r, axis=-1)[:, :C]
        idx_e = (lambda x, n, axis: torch.repeat_interleave(x, n, dim=axis))(idx.reshape(B, C, 1), D, axis=2)
        x_sel = (lambda x, i, axis: torch.take_along_dim(x, i, dim=axis))(x, idx_e, axis=1)
        g = _silu(x_sel @ w_gate)
        u = x_sel @ w_up
        y = (g * u) @ w_down
        r_sel = _sigmoid((lambda x, i, axis: torch.take_along_dim(x, i, dim=axis))(r, idx, axis=1))
        y = y * r_sel.reshape(B, C, 1)
        b_off = (torch.arange(B) * S).reshape(B, 1)
        flat_idx = (idx + b_off).reshape(B * C)
        zero = (x * 0.0).reshape(B * S, D)
        upd = _scatter_add(zero, flat_idx, y.reshape(B * C, D), axis=0)
        return x + upd.reshape(B, S, D)

    x = A_u
    h = x + _A_ref(_layernorm(x, axis=-1), A_log_A_real, A_A_imag, A_C_real, A_C_imag, A_log_dt, A_D_skip)
    h2 = h + _B_ref(_layernorm(h, axis=-1), B_w_r, B_w_gate, B_w_up, B_w_down)
    return h2
```

```asm
; @launch grid=(216,1,1) block=(512,1,1) lds=163840
.amdgcn_target "amdgcn-amd-amdhsa--gfx950"
.text
.globl sequential_preLN__ssm_conv_s4d__moe_arch_mod__prompt_kernel
.p2align 8
.type sequential_preLN__ssm_conv_s4d__moe_arch_mod__prompt_kernel,@function
sequential_preLN__ssm_conv_s4d__moe_arch_mod__prompt_kernel:
    s_cmp_ge_u32 s2, 216
    s_cbranch_scc1 END
    s_load_dwordx16 s[4:19], s[0:1], 0
    s_load_dwordx8 s[20:27], s[0:1], 64
    s_load_dwordx2 s[28:29], s[0:1], 96
    s_load_dwordx2 s[30:31], s[0:1], 112
    s_getpc_b64 s[42:43]
PC0:
    v_and_b32 v1, 63, v0
    v_lshrrev_b32 v12, 6, v0
    v_lshlrev_b32 v13, 7, v0
    v_readfirstlane_b32 s3, v12
    s_add_u32 s44, s42, TBL-PC0
    s_addc_u32 s45, s43, 0
    v_min_u32 v13, TBL-PC0, v13
    global_load_dword v255, v13, s[42:43]
    v_lshlrev_b32 v2, 4, v1
    v_lshlrev_b32 v3, 4, v0
    s_cmp_ge_u32 s2, 144
    s_cbranch_scc1 FROLE
    s_lshr_b32 s46, s3, 2
    s_lshl_b32 s48, s46, 12
    s_add_u32 s48, s48, 7168
    v_add_u32 v12, s48, v2
    global_load_dwordx4 v[208:211], v12, s[44:45] offset:0
    global_load_dwordx4 v[212:215], v12, s[44:45] offset:1024
    global_load_dwordx4 v[216:219], v12, s[44:45] offset:2048
    global_load_dwordx4 v[220:223], v12, s[44:45] offset:3072
    s_cmp_ge_u32 s3, 4
    s_cbranch_scc1 C_NOBX
    v_add_u32 v12, 4096, v2
    global_load_dwordx4 v[224:227], v12, s[44:45] offset:-4096
    global_load_dwordx4 v[228:231], v12, s[44:45] offset:-3072
    global_load_dwordx4 v[232:235], v12, s[44:45] offset:-2048
    global_load_dwordx4 v[236:239], v12, s[44:45] offset:-1024
    global_load_dwordx4 v[240:243], v12, s[44:45] offset:0
    global_load_dwordx4 v[244:247], v12, s[44:45] offset:1024
    global_load_dwordx4 v[248:251], v12, s[44:45] offset:2048
C_NOBX:
    s_lshl_b32 s49, s2, 4
    s_add_u32 s49, s49, s3
    s_mul_i32 s50, s49, 1152
    v_and_b32 v12, 31, v1
    v_lshrrev_b32 v13, 5, v1
    v_mul_u32_u24 v13, 9216, v13
    v_add_u32 v13, s50, v13
    v_lshl_add_u32 v4, v12, 4, v13
    v_lshl_add_u32 v5, v12, 2, v13
    s_and_b32 s51, s3, 3
    s_lshl_b32 s52, s2, 2
    s_add_u32 s52, s52, s51
    s_lshl_b32 s53, s52, 8
    s_lshl_b32 s54, s46, 7
    s_add_u32 s53, s53, s54
    v_lshl_add_u32 v14, v1, 1, s53
    v_xor_b32 v15, 128, v14
    v_mov_b32 v28, 0
    v_mov_b32 v29, 0
    v_mov_b32 v30, 0
    v_mov_b32 v31, 0
    v_mov_b32 v32, 0
    v_mov_b32 v33, 0
    v_lshlrev_b32 v12, 7, v1
    v_min_u32 v12, 1024, v12
    s_lshl_b32 s54, s2, 3
    s_waitcnt lgkmcnt(0)
    s_cmp_ge_u32 s2, 128
    s_cbranch_scc1 C_NOX
    global_load_dwordx4 v[16:19], v4, s[4:5]
    global_load_dwordx4 v[20:23], v4, s[4:5] offset:512
    global_load_dword v24, v5, s[4:5] offset:1024
C_NOX:
    s_load_dword s40, s[30:31], 0
    s_load_dwordx2 s[56:57], s[14:15], s54
    global_load_short_d16_hi v28, v14, s[6:7]
    global_load_short_d16_hi v29, v14, s[8:9]
    global_load_short_d16_hi v30, v14, s[10:11]
    global_load_short_d16_hi v31, v14, s[12:13]
    global_load_short_d16_hi v32, v15, s[10:11]
    global_load_short_d16_hi v33, v15, s[12:13]
    global_load_dword v254, v12, s[16:17]
    global_load_dword v253, v12, s[20:21]
    s_mov_b32 s32, s30
    s_and_b32 s33, s31, 0xffff
    s_mov_b32 s34, 0x10000000
    s_mov_b32 s35, 0x00020000
    v_mov_b32 v36, 0
    v_mov_b32 v37, 0
    v_mov_b32 v38, 0
    v_mov_b32 v39, 0
    v_add_u32 v12, 134400, v3
    ds_write_b128 v12, v[36:39]
    v_cmp_gt_u32 vcc, 336, v0
    s_and_saveexec_b64 s[58:59], vcc
    ds_write_b128 v12, v[36:39] offset:8192
    s_mov_b64 exec, -1
    v_mov_b32 v6, 0x3f80
    v_mov_b32 v7, 1.0
    v_mov_b32 v8, 0x3f803f80
    v_mov_b32 v9, 0xfff8fff8
    v_mov_b32 v11, 0x40004
    s_cmp_ge_u32 s2, 128
    s_cbranch_scc1 C_NOLN1
    v_and_b32 v12, 31, v1
    v_lshrrev_b32 v13, 5, v1
    v_mul_u32_u24 v13, 9600, v13
    s_mul_i32 s46, s3, 1184
    s_add_u32 s46, s46, 115328
    v_add_u32 v13, s46, v13
    v_lshl_add_u32 v34, v12, 4, v13
    v_lshl_add_u32 v35, v12, 2, v13
    v_and_b32 v12, 1, v1
    v_mul_u32_u24 v12, 9600, v12
    v_bfe_u32 v13, v1, 2, 2
    v_mul_u32_u24 v13, 1184, v13
    v_add_u32 v12, v12, v13
    v_lshrrev_b32 v13, 4, v1
    v_lshl_add_u32 v12, v13, 4, v12
    v_and_b32 v13, 2, v1
    v_lshl_add_u32 v12, v13, 2, v12
    s_lshl_b32 s46, s3, 6
    s_add_u32 s46, s46, 115328
    v_add_u32 v36, s46, v12
    v_lshrrev_b32 v12, 3, v0
    v_and_b32 v13, 7, v0
    v_lshlrev_b32 v13, 4, v13
    v_lshl_add_u32 v37, v12, 14, v13
    s_lshl_b32 s55, s2, 7
    s_add_u32 s55, s55, 1048576
    v_mov_b32 v40, 0
    v_mov_b32 v41, 0
    s_waitcnt vmcnt(8) lgkmcnt(0)
    s_add_u32 s40, s40, 1
    s_and_b32 s41, s40, 7
    s_bfe_u32 s46, s40, 0x30003
    s_lshl_b32 s46, s46, 16
    s_or_b32 s41, s41, s46
    v_dot2c_f32_bf16 v40, v16, v8
    v_dot2c_f32_bf16 v41, v16, v16
    v_dot2c_f32_bf16 v40, v17, v8
    v_dot2c_f32_bf16 v41, v17, v17
    v_dot2c_f32_bf16 v40, v18, v8
    v_dot2c_f32_bf16 v41, v18, v18
    v_dot2c_f32_bf16 v40, v19, v8
    v_dot2c_f32_bf16 v41, v19, v19
    v_dot2c_f32_bf16 v40, v20, v8
    v_dot2c_f32_bf16 v41, v20, v20
    v_dot2c_f32_bf16 v40, v21, v8
    v_dot2c_f32_bf16 v41, v21, v21
    v_dot2c_f32_bf16 v40, v22, v8
    v_dot2c_f32_bf16 v41, v22, v22
    v_dot2c_f32_bf16 v40, v23, v8
    v_dot2c_f32_bf16 v41, v23, v23
    v_dot2c_f32_bf16 v40, v24, v8
    v_dot2c_f32_bf16 v41, v24, v24
    v_mov_b32 v10, s41
    s_nop 1
    v_permlane16_swap_b32 v40, v41
    v_add_f32 v40, v40, v41
    s_nop 1
    v_add_f32_dpp v40, v40, v40 row_ror:8 row_mask:0xf bank_mask:0xf
    s_nop 1
    v_add_f32_dpp v40, v40, v40 row_ror:4 row_mask:0xf bank_mask:0xf
    s_nop 1
    v_add_f32_dpp v40, v40, v40 row_ror:2 row_mask:0xf bank_mask:0xf
    s_nop 1
    v_add_f32_dpp v40, v40, v40 row_ror:1 row_mask:0xf bank_mask:0xf
    v_mov_b32 v41, v40
    s_nop 1
    v_permlane16_swap_b32 v40, v41
    v_mul_f32 v40, 0x3ae38e39, v40
    v_mul_f32 v41, 0x3ae38e39, v41
    v_fma_f32 v41, -v40, v40, v41
    v_cvt_pk_bf16_f32 v42, 0, v40
    v_max_f32 v41, 0, v41
    v_cvt_pk_bf16_f32 v41, 0, v41
    v_add_f32 v41, 0x3727c5ac, v41
    v_cvt_pk_bf16_f32 v41, 0, v41
    v_sqrt_f32 v41, v41
    s_nop 0
    v_cvt_pk_bf16_f32 v41, 0, v41
    v_rcp_f32 v44, v41
    v_dot2_f32_bf16 v48, v16, v6, v42 neg_lo:[0,0,1]
    v_dot2_f32_bf16 v49, v16, v7, v42 neg_lo:[0,0,1]
    v_dot2_f32_bf16 v50, v17, v6, v42 neg_lo:[0,0,1]
    v_dot2_f32_bf16 v51, v17, v7, v42 neg_lo:[0,0,1]
    v_dot2_f32_bf16 v52, v18, v6, v42 neg_lo:[0,0,1]
    v_dot2_f32_bf16 v53, v18, v7, v42 neg_lo:[0,0,1]
    v_dot2_f32_bf16 v54, v19, v6, v42 neg_lo:[0,0,1]
    v_dot2_f32_bf16 v55, v19, v7, v42 neg_lo:[0,0,1]
    v_dot2_f32_bf16 v56, v20, v6, v42 neg_lo:[0,0,1]
    v_dot2_f32_bf16 v57, v20, v7, v42 neg_lo:[0,0,1]
    v_dot2_f32_bf16 v58, v21, v6, v42 neg_lo:[0,0,1]
    v_dot2_f32_bf16 v59, v21, v7, v42 neg_lo:[0,0,1]
    v_dot2_f32_bf16 v60, v22, v6, v42 neg_lo:[0,0,1]
    v_dot2_f32_bf16 v61, v22, v7, v42 neg_lo:[0,0,1]
    v_dot2_f32_bf16 v62, v23, v6, v42 neg_lo:[0,0,1]
    v_dot2_f32_bf16 v63, v23, v7, v42 neg_lo:[0,0,1]
    v_dot2_f32_bf16 v64, v24, v6, v42 neg_lo:[0,0,1]
    v_dot2_f32_bf16 v65, v24, v7, v42 neg_lo:[0,0,1]
    v_cvt_pk_bf16_f32 v48, 0, v48
    v_cvt_pk_bf16_f32 v49, 0, v49
    v_cvt_pk_bf16_f32 v50, 0, v50
    v_cvt_pk_bf16_f32 v51, 0, v51
    v_cvt_pk_bf16_f32 v52, 0, v52
    v_cvt_pk_bf16_f32 v53, 0, v53
    v_cvt_pk_bf16_f32 v54, 0, v54
    v_cvt_pk_bf16_f32 v55, 0, v55
    v_cvt_pk_bf16_f32 v56, 0, v56
    v_cvt_pk_bf16_f32 v57, 0, v57
    v_cvt_pk_bf16_f32 v58, 0, v58
    v_cvt_pk_bf16_f32 v59, 0, v59
    v_cvt_pk_bf16_f32 v60, 0, v60
    v_cvt_pk_bf16_f32 v61, 0, v61
    v_cvt_pk_bf16_f32 v62, 0, v62
    v_cvt_pk_bf16_f32 v63, 0, v63
    v_cvt_pk_bf16_f32 v64, 0, v64
    v_cvt_pk_bf16_f32 v65, 0, v65
    v_pk_mul_f32 v[48:49], v[48:49], v[44:45] op_sel_hi:[1,0]
    v_pk_mul_f32 v[50:51], v[50:51], v[44:45] op_sel_hi:[1,0]
    v_pk_mul_f32 v[52:53], v[52:53], v[44:45] op_sel_hi:[1,0]
    v_pk_mul_f32 v[54:55], v[54:55], v[44:45] op_sel_hi:[1,0]
    v_pk_mul_f32 v[56:57], v[56:57], v[44:45] op_sel_hi:[1,0]
    v_pk_mul_f32 v[58:59], v[58:59], v[44:45] op_sel_hi:[1,0]
    v_pk_mul_f32 v[60:61], v[60:61], v[44:45] op_sel_hi:[1,0]
    v_pk_mul_f32 v[62:63], v[62:63], v[44:45] op_sel_hi:[1,0]
    v_pk_mul_f32 v[64:65], v[64:65], v[44:45] op_sel_hi:[1,0]
    v_cvt_pkrtz_f16_f32 v68, v48, v49
    v_cvt_pkrtz_f16_f32 v69, v50, v51
    v_add_u32 v68, v11, v68
    v_cvt_pkrtz_f16_f32 v70, v52, v53
    v_add_u32 v69, v11, v69
    v_cvt_pkrtz_f16_f32 v71, v54, v55
    v_add_u32 v70, v11, v70
    v_cvt_pkrtz_f16_f32 v72, v56, v57
    v_add_u32 v71, v11, v71
    v_cvt_pkrtz_f16_f32 v73, v58, v59
    v_add_u32 v72, v11, v72
    ds_write_b128 v34, v[68:71]
    v_cvt_pkrtz_f16_f32 v74, v60, v61
    v_add_u32 v73, v11, v73
    v_cvt_pkrtz_f16_f32 v75, v62, v63
    v_add_u32 v74, v11, v74
    v_cvt_pkrtz_f16_f32 v76, v64, v65
    v_add_u32 v75, v11, v75
    v_add_u32 v76, v11, v76
    ds_write_b128 v34, v[72:75] offset:512
    ds_write_b32 v35, v76 offset:1024
    s_waitcnt lgkmcnt(0)
    s_barrier
    ds_read_b64_tr_b16 v[48:49], v36 offset:0
    ds_read_b64_tr_b16 v[50:51], v36 offset:4736
    ds_read_b64_tr_b16 v[52:53], v36 offset:512
    ds_read_b64_tr_b16 v[54:55], v36 offset:5248
    s_cmp_ge_u32 s3, 2
    s_cbranch_scc1 L1_A
    ds_read_b64_tr_b16 v[56:57], v36 offset:1024
    ds_read_b64_tr_b16 v[58:59], v36 offset:5760
    s_add_u32 s46, s55, 2097152
    s_waitcnt lgkmcnt(0)
    v_and_or_b32 v56, v56, v9, v10
    v_and_or_b32 v57, v57, v9, v10
    v_and_or_b32 v58, v58, v9, v10
    v_and_or_b32 v59, v59, v9, v10
    buffer_store_dwordx4 v[56:59], v37, s[32:35], s46 offen sc1
L1_A:
    s_add_u32 s46, s55, 1048576
    s_waitcnt lgkmcnt(2)
    v_and_or_b32 v48, v48, v9, v10
    v_and_or_b32 v49, v49, v9, v10
    v_and_or_b32 v50, v50, v9, v10
    v_and_or_b32 v51, v51, v9, v10
    buffer_store_dwordx4 v[48:51], v37, s[32:35], s55 offen sc1
    s_waitcnt lgkmcnt(0)
    v_and_or_b32 v52, v52, v9, v10
    v_and_or_b32 v53, v53, v9, v10
    v_and_or_b32 v54, v54, v9, v10
    v_and_or_b32 v55, v55, v9, v10
    buffer_store_dwordx4 v[52:55], v37, s[32:35], s46 offen sc1
    s_waitcnt vmcnt(3)
    s_branch C_KG
C_NOLN1:
    s_waitcnt vmcnt(0) lgkmcnt(0)
    s_add_u32 s40, s40, 1
    s_and_b32 s41, s40, 7
    s_bfe_u32 s46, s40, 0x30003
    s_lshl_b32 s46, s46, 16
    s_or_b32 s41, s41, s46
    v_mov_b32 v10, s41
C_KG:
    s_bitcmp1_b32 s51, 1
    s_cselect_b32 s56, s57, s56
    s_lshl_b32 s57, s56, 16
    s_and_b32 s56, s56, 0xffff0000
    s_bitcmp1_b32 s51, 0
    s_cselect_b32 s56, s56, s57
    s_lshr_b32 s46, s3, 2
    s_lshl_b32 s46, s46, 8
    s_mul_i32 s60, s51, 17408
    s_add_u32 s60, s60, s46
    s_mul_i32 s61, s51, 11424
    s_add_u32 s61, s61, s46
    s_add_u32 s61, s61, 16384
    v_mov_b32 v60, 0x3fb8aa3b
    v_mul_f32 v60, s56, v60
    v_mul_f32 v62, 0x3fb8aa3b, v28
    v_exp_f32 v60, v60
    v_exp_f32 v62, v62
    v_add_f32 v64, |v30|, |v31|
    v_add_f32 v65, |v32|, |v33|
    v_cvt_pk_bf16_f32 v60, 0, v60
    v_cvt_pk_bf16_f32 v62, 0, v62
    v_add_f32 v64, v64, v65
    v_mul_f32 v62, v62, v60
    v_mul_f32 v63, v29, v60
    v_mul_f32 v62, 0xbfb8aa3b, v62
    v_mul_f32 v63, 0.15915494, v63
    v_mov_b32 v58, -100
    v_mov_b32 v59, 100
    v_mul_f32 v104, 0x41000000, v62
    v_add_f32_dpp v64, v64, v64 row_ror:8 row_mask:0xf bank_mask:0xf
    v_mul_f32 v105, 0x41000000, v63
    v_exp_f32 v104, v104
    v_fract_f32 v105, v105
    v_add_f32_dpp v64, v64, v64 row_ror:4 row_mask:0xf bank_mask:0xf
    v_cos_f32 v72, v105
    v_sin_f32 v73, v105
    v_add_f32_dpp v64, v64, v64 row_ror:2 row_mask:0xf bank_mask:0xf
    v_pk_mul_f32 v[72:73], v[72:73], v[104:105] op_sel_hi:[1,0] neg_hi:[1,0]
    v_exp_f32 v106, v62
    v_add_f32_dpp v64, v64, v64 row_ror:1 row_mask:0xf bank_mask:0xf
    v_fract_f32 v107, v63
    v_cos_f32 v66, v107
    v_sin_f32 v67, v107
    v_mov_b32 v65, v64
    v_pk_mul_f32 v[66:67], v[66:67], v[106:107] op_sel_hi:[1,0]
    v_mul_f32 v108, 0x43800000, v62
    v_permlane16_swap_b32 v64, v65
    v_mul_f32 v109, 0x43800000, v63
    v_exp_f32 v108, v108
    v_add_f32 v64, v64, v65
    v_fract_f32 v109, v109
    v_cos_f32 v68, v109
    v_sin_f32 v69, v109
    v_mov_b32 v65, v64
    v_pk_mul_f32 v[68:69], v[68:69], v[108:109] op_sel_hi:[1,0]
    v_mov_b32 v164, 0x3c00
    s_mov_b32 m0, s60
    s_nop 0
    ds_write_addtid_b32 v164 offset:0
    v_permlane32_swap_b32 v64, v65
    v_pk_mul_f32 v[74:75], v[72:73], v[72:73] op_sel_hi:[1,0]
    v_cvt_pk_f16_f32 v161, v72, v73
    v_add_f32 v64, v64, v65
    v_pk_fma_f32 v[74:75], v[72:73], v[72:73], v[74:75] op_sel:[1,1,0] op_sel_hi:[0,1,1] neg_lo:[1,0,0]
    ds_write_addtid_b32 v161 offset:544
    v_pk_mul_f32 v[76:77], v[74:75], v[72:73] op_sel_hi:[1,0]
    v_cvt_pk_f16_f32 v162, v74, v75
    v_add_f32 v60, v60, v60
    v_pk_fma_f32 v[76:77], v[74:75], v[72:73], v[76:77] op_sel:[1,1,0] op_sel_hi:[0,1,1] neg_lo:[1,0,0]
    ds_write_addtid_b32 v162 offset:1088
    v_pk_mul_f32 v[78:79], v[74:75], v[74:75] op_sel_hi:[1,0]
    v_cvt_pk_f16_f32 v163, v76, v77
    v_mul_f32 v64, v64, v60
    v_pk_fma_f32 v[78:79], v[74:75], v[74:75], v[78:79] op_sel:[1,1,0] op_sel_hi:[0,1,1] neg_lo:[1,0,0]
    ds_write_addtid_b32 v163 offset:1632
    v_pk_mul_f32 v[80:81], v[78:79], v[72:73] op_sel_hi:[1,0]
    v_cvt_pk_f16_f32 v160, v78, v79
    v_frexp_exp_i32_f32 v64, v64
    v_pk_fma_f32 v[80:81], v[78:79], v[72:73], v[80:81] op_sel:[1,1,0] op_sel_hi:[0,1,1] neg_lo:[1,0,0]
    ds_write_addtid_b32 v160 offset:2176
    v_pk_mul_f32 v[82:83], v[78:79], v[74:75] op_sel_hi:[1,0]
    v_cvt_pk_f16_f32 v161, v80, v81
    v_med3_i32 v64, v64, v58, v59
    v_pk_fma_f32 v[82:83], v[78:79], v[74:75], v[82:83] op_sel:[1,1,0] op_sel_hi:[0,1,1] neg_lo:[1,0,0]
    ds_write_addtid_b32 v161 offset:2720
    v_pk_mul_f32 v[84:85], v[78:79], v[76:77] op_sel_hi:[1,0]
    v_cvt_pk_f16_f32 v162, v82, v83
    v_sub_u32 v65, 0, v64
    v_pk_fma_f32 v[84:85], v[78:79], v[76:77], v[84:85] op_sel:[1,1,0] op_sel_hi:[0,1,1] neg_lo:[1,0,0]
    ds_write_addtid_b32 v162 offset:3264
    v_pk_mul_f32 v[86:87], v[78:79], v[78:79] op_sel_hi:[1,0]
    v_cvt_pk_f16_f32 v163, v84, v85
    v_ldexp_f32 v60, v60, v65
    v_pk_fma_f32 v[86:87], v[78:79], v[78:79], v[86:87] op_sel:[1,1,0] op_sel_hi:[0,1,1] neg_lo:[1,0,0]
    ds_write_addtid_b32 v163 offset:3808
    v_pk_mul_f32 v[88:89], v[86:87], v[72:73] op_sel_hi:[1,0]
    v_cvt_pk_f16_f32 v160, v86, v87
    v_ldexp_f32 v64, 1.0, v64
    v_pk_fma_f32 v[88:89], v[86:87], v[72:73], v[88:89] op_sel:[1,1,0] op_sel_hi:[0,1,1] neg_lo:[1,0,0]
    ds_write_addtid_b32 v160 offset:4352
    v_pk_mul_f32 v[90:91], v[86:87], v[74:75] op_sel_hi:[1,0]
    v_cvt_pk_f16_f32 v161, v88, v89
    v_pk_mul_f32 v[30:31], v[30:31], v[60:61] op_sel_hi:[1,0]
    v_pk_fma_f32 v[90:91], v[86:87], v[74:75], v[90:91] op_sel:[1,1,0] op_sel_hi:[0,1,1] neg_lo:[1,0,0]
    ds_write_addtid_b32 v161 offset:4896
    v_cvt_pk_f16_f32 v162, v90, v91
    ds_write_addtid_b32 v162 offset:5440
    v_pk_mul_f32 v[92:93], v[86:87], v[76:77] op_sel_hi:[1,0]
    v_cvt_pk_f16_f32 v163, v30, v31
    v_pk_fma_f32 v[92:93], v[86:87], v[76:77], v[92:93] op_sel:[1,1,0] op_sel_hi:[0,1,1] neg_lo:[1,0,0]
    s_mov_b32 m0, s61
    s_nop 0
    ds_write_addtid_b32 v163 offset:64128
    v_pk_mul_f32 v[120:121], v[30:31], v[66:67] op_sel_hi:[1,0]
    v_cvt_pk_f16_f32 v160, v92, v93
    v_pk_fma_f32 v[120:121], v[30:31], v[66:67], v[120:121] op_sel:[1,1,0] op_sel_hi:[0,1,1] neg_lo:[1,0,0]
    s_mov_b32 m0, s60
    s_nop 0
    ds_write_addtid_b32 v160 offset:5984
    v_pk_mul_f32 v[94:95], v[86:87], v[78:79] op_sel_hi:[1,0]
    v_cvt_pk_f16_f32 v161, v120, v121
    v_pk_fma_f32 v[94:95], v[86:87], v[78:79], v[94:95] op_sel:[1,1,0] op_sel_hi:[0,1,1] neg_lo:[1,0,0]
    s_mov_b32 m0, s61
    s_nop 0
    ds_write_addtid_b32 v161 offset:53248
    v_pk_mul_f32 v[122:123], v[120:121], v[66:67] op_sel_hi:[1,0]
    v_cvt_pk_f16_f32 v162, v94, v95
    v_pk_fma_f32 v[122:123], v[120:121], v[66:67], v[122:123] op_sel:[1,1,0] op_sel_hi:[0,1,1] neg_lo:[1,0,0]
    s_mov_b32 m0, s60
    s_nop 0
    ds_write_addtid_b32 v162 offset:6528
    v_pk_mul_f32 v[96:97], v[86:87], v[80:81] op_sel_hi:[1,0]
    v_cvt_pk_f16_f32 v163, v122, v123
    v_pk_fma_f32 v[96:97], v[86:87], v[80:81], v[96:97] op_sel:[1,1,0] op_sel_hi:[0,1,1] neg_lo:[1,0,0]
    s_mov_b32 m0, s61
    s_nop 0
    ds_write_addtid_b32 v163 offset:53792
    v_pk_mul_f32 v[124:125], v[122:123], v[66:67] op_sel_hi:[1,0]
    v_cvt_pk_f16_f32 v160, v96, v97
    v_pk_fma_f32 v[124:125], v[122:123], v[66:67], v[124:125] op_sel:[1,1,0] op_sel_hi:[0,1,1] neg_lo:[1,0,0]
    s_mov_b32 m0, s60
    s_nop 0
    ds_write_addtid_b32 v160 offset:7072
    v_pk_mul_f32 v[98:99], v[86:87], v[82:83] op_sel_hi:[1,0]
    v_cvt_pk_f16_f32 v161, v124, v125
    v_pk_fma_f32 v[98:99], v[86:87], v[82:83], v[98:99] op_sel:[1,1,0] op_sel_hi:[0,1,1] neg_lo:[1,0,0]
    s_mov_b32 m0, s61
    s_nop 0
    ds_write_addtid_b32 v161 offset:54336
    v_pk_mul_f32 v[126:127], v[124:125], v[66:67] op_sel_hi:[1,0]
    v_cvt_pk_f16_f32 v162, v98, v99
    v_pk_fma_f32 v[126:127], v[124:125], v[66:67], v[126:127] op_sel:[1,1,0] op_sel_hi:[0,1,1] neg_lo:[1,0,0]
    s_mov_b32 m0, s60
    s_nop 0
    ds_write_addtid_b32 v162 offset:7616
    v_pk_mul_f32 v[100:101], v[86:87], v[84:85] op_sel_hi:[1,0]
    v_cvt_pk_f16_f32 v163, v126, v127
    v_pk_fma_f32 v[100:101], v[86:87], v[84:85], v[100:101] op_sel:[1,1,0] op_sel_hi:[0,1,1] neg_lo:[1,0,0]
    s_mov_b32 m0, s61
    s_nop 0
    ds_write_addtid_b32 v163 offset:54880
    v_pk_mul_f32 v[128:129], v[126:127], v[66:67] op_sel_hi:[1,0]
    v_cvt_pk_f16_f32 v160, v100, v101
    v_pk_fma_f32 v[128:129], v[126:127], v[66:67], v[128:129] op_sel:[1,1,0] op_sel_hi:[0,1,1] neg_lo:[1,0,0]
    s_mov_b32 m0, s60
    s_nop 0
    ds_write_addtid_b32 v160 offset:8160
    v_pk_mul_f32 v[102:103], v[86:87], v[86:87] op_sel_hi:[1,0]
    v_cvt_pk_f16_f32 v161, v128, v129
    v_pk_fma_f32 v[102:103], v[86:87], v[86:87], v[102:103] op_sel:[1,1,0] op_sel_hi:[0,1,1] neg_lo:[1,0,0]
    s_mov_b32 m0, s61
    s_nop 0
    ds_write_addtid_b32 v161 offset:55424
    v_pk_mul_f32 v[130:131], v[128:129], v[66:67] op_sel_hi:[1,0]
    v_cvt_pk_f16_f32 v162, v102, v103
    v_pk_fma_f32 v[130:131], v[128:129], v[66:67], v[130:131] op_sel:[1,1,0] op_sel_hi:[0,1,1] neg_lo:[1,0,0]
    s_mov_b32 m0, s60
    s_nop 0
    ds_write_addtid_b32 v162 offset:8704
    v_pk_mul_f32 v[112:113], v[102:103], v[72:73] op_sel_hi:[1,0]
    v_cvt_pk_f16_f32 v163, v130, v131
    v_pk_fma_f32 v[112:113], v[102:103], v[72:73], v[112:113] op_sel:[1,1,0] op_sel_hi:[0,1,1] neg_lo:[1,0,0]
    s_mov_b32 m0, s61
    s_nop 0
    ds_write_addtid_b32 v163 offset:55968
    v_pk_mul_f32 v[132:133], v[130:131], v[66:67] op_sel_hi:[1,0]
    v_cvt_pk_f16_f32 v160, v112, v113
    v_pk_fma_f32 v[132:133], v[130:131], v[66:67], v[132:133] op_sel:[1,1,0] op_sel_hi:[0,1,1] neg_lo:[1,0,0]
    s_mov_b32 m0, s60
    s_nop 0
    ds_write_addtid_b32 v160 offset:9248
    v_pk_mul_f32 v[114:115], v[102:103], v[74:75] op_sel_hi:[1,0]
    v_cvt_pk_f16_f32 v161, v132, v133
    v_pk_fma_f32 v[114:115], v[102:103], v[74:75], v[114:115] op_sel:[1,1,0] op_sel_hi:[0,1,1] neg_lo:[1,0,0]
    s_mov_b32 m0, s61
    s_nop 0
    ds_write_addtid_b32 v161 offset:56512
    v_pk_mul_f32 v[134:135], v[132:133], v[66:67] op_sel_hi:[1,0]
    v_cvt_pk_f16_f32 v162, v114, v115
    v_pk_fma_f32 v[134:135], v[132:133], v[66:67], v[134:135] op_sel:[1,1,0] op_sel_hi:[0,1,1] neg_lo:[1,0,0]
    s_mov_b32 m0, s60
    s_nop 0
    ds_write_addtid_b32 v162 offset:9792
    v_pk_mul_f32 v[116:117], v[102:103], v[76:77] op_sel_hi:[1,0]
    v_cvt_pk_f16_f32 v163, v134, v135
    v_pk_fma_f32 v[116:117], v[102:103], v[76:77], v[116:117] op_sel:[1,1,0] op_sel_hi:[0,1,1] neg_lo:[1,0,0]
    s_mov_b32 m0, s61
    s_nop 0
    ds_write_addtid_b32 v163 offset:57056
    v_pk_mul_f32 v[136:137], v[122:123], v[68:69] op_sel_hi:[1,0]
    v_cvt_pk_f16_f32 v160, v116, v117
    v_pk_fma_f32 v[136:137], v[122:123], v[68:69], v[136:137] op_sel:[1,1,0] op_sel_hi:[0,1,1] neg_lo:[1,0,0]
    s_mov_b32 m0, s60
    s_nop 0
    ds_write_addtid_b32 v160 offset:10336
    v_pk_mul_f32 v[110:111], v[102:103], v[78:79] op_sel_hi:[1,0]
    v_cvt_pk_f16_f32 v161, v136, v137
    v_pk_fma_f32 v[110:111], v[102:103], v[78:79], v[110:111] op_sel:[1,1,0] op_sel_hi:[0,1,1] neg_lo:[1,0,0]
    s_mov_b32 m0, s61
    s_nop 0
    ds_write_addtid_b32 v161 offset:57600
    v_pk_mul_f32 v[138:139], v[126:127], v[68:69] op_sel_hi:[1,0]
    v_cvt_pk_f16_f32 v162, v110, v111
    v_pk_fma_f32 v[138:139], v[126:127], v[68:69], v[138:139] op_sel:[1,1,0] op_sel_hi:[0,1,1] neg_lo:[1,0,0]
    s_mov_b32 m0, s60
    s_nop 0
    ds_write_addtid_b32 v162 offset:10880
    v_pk_mul_f32 v[112:113], v[102:103], v[80:81] op_sel_hi:[1,0]
    v_cvt_pk_f16_f32 v163, v138, v139
    v_pk_fma_f32 v[112:113], v[102:103], v[80:81], v[112:113] op_sel:[1,1,0] op_sel_hi:[0,1,1] neg_lo:[1,0,0]
    s_mov_b32 m0, s61
    s_nop 0
    ds_write_addtid_b32 v163 offset:58144
    v_pk_mul_f32 v[140:141], v[130:131], v[68:69] op_sel_hi:[1,0]
    v_cvt_pk_f16_f32 v160, v112, v113
    v_pk_fma_f32 v[140:141], v[130:131], v[68:69], v[140:141] op_sel:[1,1,0] op_sel_hi:[0,1,1] neg_lo:[1,0,0]
    s_mov_b32 m0, s60
    s_nop 0
    ds_write_addtid_b32 v160 offset:11424
    v_pk_mul_f32 v[114:115], v[102:103], v[82:83] op_sel_hi:[1,0]
    v_cvt_pk_f16_f32 v161, v140, v141
    v_pk_fma_f32 v[114:115], v[102:103], v[82:83], v[114:115] op_sel:[1,1,0] op_sel_hi:[0,1,1] neg_lo:[1,0,0]
    s_mov_b32 m0, s61
    s_nop 0
    ds_write_addtid_b32 v161 offset:58688
    v_pk_mul_f32 v[142:143], v[134:135], v[68:69] op_sel_hi:[1,0]
    v_cvt_pk_f16_f32 v162, v114, v115
    v_pk_fma_f32 v[142:143], v[134:135], v[68:69], v[142:143] op_sel:[1,1,0] op_sel_hi:[0,1,1] neg_lo:[1,0,0]
    s_mov_b32 m0, s60
    s_nop 0
    ds_write_addtid_b32 v162 offset:11968
    v_pk_mul_f32 v[116:117], v[102:103], v[84:85] op_sel_hi:[1,0]
    v_cvt_pk_f16_f32 v163, v142, v143
    v_pk_fma_f32 v[116:117], v[102:103], v[84:85], v[116:117] op_sel:[1,1,0] op_sel_hi:[0,1,1] neg_lo:[1,0,0]
    s_mov_b32 m0, s61
    s_nop 0
    ds_write_addtid_b32 v163 offset:59232
    v_pk_mul_f32 v[144:145], v[138:139], v[68:69] op_sel_hi:[1,0]
    v_cvt_pk_f16_f32 v160, v116, v117
    v_pk_fma_f32 v[144:145], v[138:139], v[68:69], v[144:145] op_sel:[1,1,0] op_sel_hi:[0,1,1] neg_lo:[1,0,0]
    s_mov_b32 m0, s60
    s_nop 0
    ds_write_addtid_b32 v160 offset:12512
    v_pk_mul_f32 v[110:111], v[102:103], v[86:87] op_sel_hi:[1,0]
    v_cvt_pk_f16_f32 v161, v144, v145
    v_pk_fma_f32 v[110:111], v[102:103], v[86:87], v[110:111] op_sel:[1,1,0] op_sel_hi:[0,1,1] neg_lo:[1,0,0]
    s_mov_b32 m0, s61
    s_nop 0
    ds_write_addtid_b32 v161 offset:59776
    v_pk_mul_f32 v[146:147], v[142:143], v[68:69] op_sel_hi:[1,0]
    v_cvt_pk_f16_f32 v162, v110, v111
    v_pk_fma_f32 v[146:147], v[142:143], v[68:69], v[146:147] op_sel:[1,1,0] op_sel_hi:[0,1,1] neg_lo:[1,0,0]
    s_mov_b32 m0, s60
    s_nop 0
    ds_write_addtid_b32 v162 offset:13056
    v_pk_mul_f32 v[112:113], v[102:103], v[88:89] op_sel_hi:[1,0]
    v_cvt_pk_f16_f32 v163, v146, v147
    v_pk_fma_f32 v[112:113], v[102:103], v[88:89], v[112:113] op_sel:[1,1,0] op_sel_hi:[0,1,1] neg_lo:[1,0,0]
    s_mov_b32 m0, s61
    s_nop 0
    ds_write_addtid_b32 v163 offset:60320
    v_pk_mul_f32 v[148:149], v[144:145], v[68:69] op_sel_hi:[1,0]
    v_cvt_pk_f16_f32 v160, v112, v113
    v_pk_fma_f32 v[148:149], v[144:145], v[68:69], v[148:149] op_sel:[1,1,0] op_sel_hi:[0,1,1] neg_lo:[1,0,0]
    s_mov_b32 m0, s60
    s_nop 0
    ds_write_addtid_b32 v160 offset:13600
    v_pk_mul_f32 v[114:115], v[102:103], v[90:91] op_sel_hi:[1,0]
    v_cvt_pk_f16_f32 v161, v148, v149
    v_pk_fma_f32 v[114:115], v[102:103], v[90:91], v[114:115] op_sel:[1,1,0] op_sel_hi:[0,1,1] neg_lo:[1,0,0]
    s_mov_b32 m0, s61
    s_nop 0
    ds_write_addtid_b32 v161 offset:60864
    v_pk_mul_f32 v[150:151], v[146:147], v[68:69] op_sel_hi:[1,0]
    v_cvt_pk_f16_f32 v162, v114, v115
    v_pk_fma_f32 v[150:151], v[146:147], v[68:69], v[150:151] op_sel:[1,1,0] op_sel_hi:[0,1,1] neg_lo:[1,0,0]
    s_mov_b32 m0, s60
    s_nop 0
    ds_write_addtid_b32 v162 offset:14144
    v_pk_mul_f32 v[116:117], v[102:103], v[92:93] op_sel_hi:[1,0]
    v_cvt_pk_f16_f32 v163, v150, v151
    v_pk_fma_f32 v[116:117], v[102:103], v[92:93], v[116:117] op_sel:[1,1,0] op_sel_hi:[0,1,1] neg_lo:[1,0,0]
    s_mov_b32 m0, s61
    s_nop 0
    ds_write_addtid_b32 v163 offset:61408
    v_pk_mul_f32 v[152:153], v[150:151], v[68:69] op_sel_hi:[1,0]
    v_cvt_pk_f16_f32 v160, v116, v117
    v_pk_fma_f32 v[152:153], v[150:151], v[68:69], v[152:153] op_sel:[1,1,0] op_sel_hi:[0,1,1] neg_lo:[1,0,0]
    s_mov_b32 m0, s60
    s_nop 0
    ds_write_addtid_b32 v160 offset:14688
    v_pk_mul_f32 v[110:111], v[102:103], v[94:95] op_sel_hi:[1,0]
    v_cvt_pk_f16_f32 v161, v152, v153
    v_pk_fma_f32 v[110:111], v[102:103], v[94:95], v[110:111] op_sel:[1,1,0] op_sel_hi:[0,1,1] neg_lo:[1,0,0]
    s_mov_b32 m0, s61
    s_nop 0
    ds_write_addtid_b32 v161 offset:61952
    v_pk_mul_f32 v[154:155], v[152:153], v[68:69] op_sel_hi:[1,0]
    v_cvt_pk_f16_f32 v162, v110, v111
    v_pk_fma_f32 v[154:155], v[152:153], v[68:69], v[154:155] op_sel:[1,1,0] op_sel_hi:[0,1,1] neg_lo:[1,0,0]
    s_mov_b32 m0, s60
    s_nop 0
    ds_write_addtid_b32 v162 offset:15232
    v_pk_mul_f32 v[112:113], v[102:103], v[96:97] op_sel_hi:[1,0]
    v_cvt_pk_f16_f32 v163, v154, v155
    v_pk_fma_f32 v[112:113], v[102:103], v[96:97], v[112:113] op_sel:[1,1,0] op_sel_hi:[0,1,1] neg_lo:[1,0,0]
    s_mov_b32 m0, s61
    s_nop 0
    ds_write_addtid_b32 v163 offset:62496
    v_pk_mul_f32 v[156:157], v[154:155], v[68:69] op_sel_hi:[1,0]
    v_cvt_pk_f16_f32 v160, v112, v113
    v_pk_fma_f32 v[156:157], v[154:155], v[68:69], v[156:157] op_sel:[1,1,0] op_sel_hi:[0,1,1] neg_lo:[1,0,0]
    s_mov_b32 m0, s60
    s_nop 0
    ds_write_addtid_b32 v160 offset:15776
    v_pk_mul_f32 v[114:115], v[102:103], v[98:99] op_sel_hi:[1,0]
    v_cvt_pk_f16_f32 v161, v156, v157
    v_pk_fma_f32 v[114:115], v[102:103], v[98:99], v[114:115] op_sel:[1,1,0] op_sel_hi:[0,1,1] neg_lo:[1,0,0]
    s_mov_b32 m0, s61
    s_nop 0
    ds_write_addtid_b32 v161 offset:63040
    v_pk_mul_f32 v[158:159], v[156:157], v[68:69] op_sel_hi:[1,0]
    v_cvt_pk_f16_f32 v162, v114, v115
    v_pk_fma_f32 v[158:159], v[156:157], v[68:69], v[158:159] op_sel:[1,1,0] op_sel_hi:[0,1,1] neg_lo:[1,0,0]
    s_mov_b32 m0, s60
    s_nop 0
    ds_write_addtid_b32 v162 offset:16320
    v_pk_mul_f32 v[116:117], v[102:103], v[100:101] op_sel_hi:[1,0]
    v_cvt_pk_f16_f32 v163, v158, v159
    v_pk_fma_f32 v[116:117], v[102:103], v[100:101], v[116:117] op_sel:[1,1,0] op_sel_hi:[0,1,1] neg_lo:[1,0,0]
    s_mov_b32 m0, s61
    s_nop 0
    ds_write_addtid_b32 v163 offset:63584
    v_cvt_pk_f16_f32 v160, v116, v117
    s_mov_b32 m0, s60
    s_nop 0
    ds_write_addtid_b32 v160 offset:16864
    s_cmp_ge_u32 s3, 4
    s_cbranch_scc1 KG_NOSC
    s_and_b32 s46, s40, 0x7fffff
    v_or_b32 v64, s46, v64
    v_mov_b32 v65, 0
    s_lshl_b32 s46, s52, 2
    s_add_u32 s46, s46, 8192
    s_mov_b64 exec, 1
    buffer_store_dword v64, v65, s[32:35], s46 offen sc1
    s_mov_b64 exec, -1
KG_NOSC:
    v_and_b32 v12, 15, v1
    v_lshrrev_b32 v13, 4, v1
    v_lshlrev_b32 v13, 4, v13
    v_mul_u32_u24 v40, 544, v12
    v_add_u32 v40, v40, v13
    v_min_u32 v41, 4, v12
    v_mul_u32_u24 v41, 544, v41
    v_add_u32 v41, v41, v13
    s_mul_i32 s46, s51, 11424
    s_add_u32 s46, s46, 69632
    v_add_u32 v42, s46, v40
    s_add_u32 s46, s46, 8704
    v_add_u32 v41, s46, v41
    s_lshr_b32 s46, s3, 2
    s_mul_i32 s46, s46, 8704
    s_mul_i32 s48, s51, 17408
    s_add_u32 s46, s46, s48
    v_add_u32 v40, s46, v40
    s_mul_i32 s62, s51, 3328
    s_add_u32 s62, s62, 134400
    v_add_u32 v208, s62, v208
    v_add_u32 v209, s62, v209
    v_add_u32 v210, s62, v210
    v_add_u32 v211, s62, v211
    v_add_u32 v212, s62, v212
    v_add_u32 v213, s62, v213
    v_add_u32 v214, s62, v214
    v_add_u32 v215, s62, v215
    v_add_u32 v216, s62, v216
    v_add_u32 v217, s62, v217
    v_add_u32 v218, s62, v218
    v_add_u32 v219, s62, v219
    v_add_u32 v220, s62, v220
    v_add_u32 v221, s62, v221
    s_waitcnt lgkmcnt(0)
    s_barrier
    ds_read_b128 v[60:63], v40 offset:0
    ds_read_b128 v[64:67], v42 offset:0
    ds_read_b128 v[68:71], v41 offset:0
    ds_read_b128 v[72:75], v40 offset:64
    ds_read_b128 v[76:79], v42 offset:64
    ds_read_b128 v[80:83], v41 offset:64
    ds_read_b128 v[84:87], v40 offset:128
    ds_read_b128 v[88:91], v42 offset:128
    ds_read_b128 v[92:95], v41 offset:128
    ds_read_b128 v[96:99], v40 offset:192
    ds_read_b128 v[100:103], v42 offset:192
    ds_read_b128 v[104:107], v41 offset:192
    ds_read_b128 v[108:111], v40 offset:256
    ds_read_b128 v[112:115], v42 offset:256
    ds_read_b128 v[116:119], v41 offset:256
    s_waitcnt lgkmcnt(12)
    v_mfma_f32_16x16x32_f16 v[44:47], v[64:67], v[60:63], 0
    v_mfma_f32_16x16x32_f16 v[48:51], v[68:71], v[60:63], 0
    ds_read_b128 v[120:123], v40 offset:320
    ds_read_b128 v[124:127], v42 offset:320
    ds_read_b128 v[128:131], v41 offset:320
    s_waitcnt lgkmcnt(12)
    v_mfma_f32_16x16x32_f16 v[44:47], v[76:79], v[72:75], v[44:47]
    v_mfma_f32_16x16x32_f16 v[48:51], v[80:83], v[72:75], v[48:51]
    ds_read_b128 v[132:135], v40 offset:384
    ds_read_b128 v[136:139], v42 offset:384
    ds_read_b128 v[140:143], v41 offset:384
    s_waitcnt lgkmcnt(12)
    v_mfma_f32_16x16x32_f16 v[44:47], v[88:91], v[84:87], v[44:47]
    v_mfma_f32_16x16x32_f16 v[48:51], v[92:95], v[84:87], v[48:51]
    ds_read_b128 v[144:147], v40 offset:448
    ds_read_b128 v[148:151], v42 offset:448
    ds_read_b128 v[152:155], v41 offset:448
    s_waitcnt lgkmcnt(12)
    v_mfma_f32_16x16x32_f16 v[44:47], v[100:103], v[96:99], v[44:47]
    v_mfma_f32_16x16x32_f16 v[48:51], v[104:107], v[96:99], v[48:51]
    s_waitcnt lgkmcnt(9)
    v_mfma_f32_16x16x32_f16 v[44:47], v[112:115], v[108:111], v[44:47]
    v_mfma_f32_16x16x32_f16 v[48:51], v[116:119], v[108:111], v[48:51]
    s_waitcnt lgkmcnt(6)
    v_mfma_f32_16x16x32_f16 v[44:47], v[124:127], v[120:123], v[44:47]
    v_mfma_f32_16x16x32_f16 v[48:51], v[128:131], v[120:123], v[48:51]
    s_waitcnt lgkmcnt(3)
    v_mfma_f32_16x16x32_f16 v[44:47], v[136:139], v[132:135], v[44:47]
    v_mfma_f32_16x16x32_f16 v[48:51], v[140:143], v[132:135], v[48:51]
    s_waitcnt lgkmcnt(0)
    v_mfma_f32_16x16x32_f16 v[44:47], v[148:151], v[144:147], v[44:47]
    v_mfma_f32_16x16x32_f16 v[48:51], v[152:155], v[144:147], v[48:51]
    s_lshl_b32 s63, s2, 14
    s_add_u32 s63, s63, 1048576
    s_add_u32 s48, s63, 8192
    buffer_load_dwordx4 v[28:31], v3, s[32:35], s63 offen sc1
    buffer_load_dwordx4 v[32:35], v3, s[32:35], s48 offen sc1
    s_nop 1
    v_cvt_pk_f16_f32 v52, v47, v46
    v_cvt_pk_f16_f32 v53, v45, v44
    v_cvt_pk_f16_f32 v54, v46, v45
    v_cvt_pk_f16_f32 v55, v47, v47
    v_cvt_pk_f16_f32 v56, v45, v45
    v_cvt_pk_f16_f32 v57, v48, v49
    v_cvt_pk_f16_f32 v58, v50, v51
    ds_write_b32 v208, v52
    ds_write_b32 v209, v53
    ds_write_b32 v210, v54
    ds_write_b16 v211, v52
    ds_write_b16_d16_hi v212, v53
    ds_write_b32 v213, v55
    ds_write_b32 v214, v56
    ds_write_b32 v215, v55
    ds_write_b32 v216, v56
    ds_write_b32 v217, v55
    ds_write_b16 v218, v57
    ds_write_b16_d16_hi v219, v57
    ds_write_b16 v220, v58
    ds_write_b16_d16_hi v221, v58
    v_and_b32 v12, 15, v1
    v_lshrrev_b32 v13, 4, v1
    v_lshlrev_b32 v40, 3, v13
    v_sub_u32 v40, v40, v12
    v_add_u32 v40, 15, v40
    v_and_b32 v41, 1, v40
    v_mul_u32_u24 v41, 1218, v41
    v_lshl_add_u32 v40, v40, 1, v41
    v_add_u32 v40, s62, v40
    v_add_u32 v41, 512, v40
    v_lshlrev_b32 v42, 2, v13
    v_sub_u32 v42, v42, v12
    v_lshlrev_b32 v42, 2, v42
    s_add_u32 s46, s62, 2428
    v_add_u32 v42, s46, v42
    v_mov_b32 v43, s62
    v_and_b32 v36, 3, v0
    v_mul_u32_u24 v36, 4640, v36
    v_lshrrev_b32 v37, 2, v0
    v_lshl_add_u32 v36, v37, 4, v36
    s_waitcnt lgkmcnt(0)
    s_barrier
    s_cmp_ge_u32 s3, 4
    s_cbranch_scc1 KT_HELP
    ds_read_u16 v44, v43 offset:2688
    ds_read2_b32 v[116:117], v41 offset0:128 offset1:129
    ds_read2_b32 v[118:119], v41 offset0:130 offset1:131
    ds_read2_b32 v[120:121], v41 offset0:112 offset1:113
    ds_read2_b32 v[122:123], v41 offset0:114 offset1:115
    ds_read2_b32 v[124:125], v41 offset0:96 offset1:97
    ds_read2_b32 v[126:127], v41 offset0:98 offset1:99
    ds_read2_b32 v[128:129], v41 offset0:80 offset1:81
    ds_read2_b32 v[130:131], v41 offset0:82 offset1:83
    ds_read2_b32 v[132:133], v41 offset0:64 offset1:65
    ds_read2_b32 v[134:135], v41 offset0:66 offset1:67
    ds_read2_b32 v[136:137], v41 offset0:48 offset1:49
    ds_read2_b32 v[138:139], v41 offset0:50 offset1:51
    ds_read2_b32 v[140:141], v41 offset0:32 offset1:33
    ds_read2_b32 v[142:143], v41 offset0:34 offset1:35
    s_waitcnt lgkmcnt(14)
    v_lshl_or_b32 v44, v44, 16, v44
    v_and_b32 v248, v44, v248
    v_and_b32 v249, v44, v249
    v_and_b32 v250, v44, v250
    v_and_b32 v251, v44, v251
    ds_read2_b32 v[144:145], v41 offset0:16 offset1:17
    ds_read2_b32 v[146:147], v41 offset0:18 offset1:19
    ds_read2_b32 v[148:149], v41 offset0:0 offset1:1
    ds_read2_b32 v[150:151], v41 offset0:2 offset1:3
    ds_read2_b32 v[152:153], v40 offset0:112 offset1:113
    ds_read2_b32 v[154:155], v40 offset0:114 offset1:115
    ds_read2_b32 v[156:157], v40 offset0:96 offset1:97
    ds_read2_b32 v[158:159], v40 offset0:98 offset1:99
    ds_read2_b32 v[160:161], v40 offset0:80 offset1:81
    ds_read2_b32 v[162:163], v40 offset0:82 offset1:83
    ds_read2_b32 v[164:165], v40 offset0:64 offset1:65
    ds_read2_b32 v[166:167], v40 offset0:66 offset1:67
    ds_read2_b32 v[168:169], v40 offset0:48 offset1:49
    ds_read2_b32 v[170:171], v40 offset0:50 offset1:51
    ds_read2_b32 v[172:173], v40 offset0:32 offset1:33
    ds_read2_b32 v[174:175], v40 offset0:34 offset1:35
    ds_read2_b32 v[176:177], v40 offset0:16 offset1:17
    ds_read2_b32 v[178:179], v40 offset0:18 offset1:19
    ds_read2_b32 v[180:181], v40 offset0:0 offset1:1
    ds_read2_b32 v[182:183], v40 offset0:2 offset1:3
    ds_read2_b32 v[184:185], v42 offset0:32 offset1:33
    ds_read2_b32 v[186:187], v42 offset0:34 offset1:35
    ds_read2_b32 v[188:189], v42 offset0:96 offset1:97
    ds_read2_b32 v[190:191], v42 offset0:98 offset1:99
    ds_read2_b32 v[192:193], v42 offset0:16 offset1:17
    ds_read2_b32 v[194:195], v42 offset0:18 offset1:19
    ds_read2_b32 v[196:197], v42 offset0:80 offset1:81
    ds_read2_b32 v[198:199], v42 offset0:82 offset1:83
    ds_read2_b32 v[200:201], v42 offset0:0 offset1:1
    ds_read2_b32 v[202:203], v42 offset0:2 offset1:3
    ds_read2_b32 v[204:205], v42 offset0:64 offset1:65
    ds_read2_b32 v[206:207], v42 offset0:66 offset1:67
    ds_read2_b32 v[208:209], v42 offset0:176 offset1:177
    ds_read2_b32 v[210:211], v42 offset0:178 offset1:179
    ds_read2_b32 v[212:213], v42 offset0:160 offset1:161
    ds_read2_b32 v[214:215], v42 offset0:162 offset1:163
    ds_read2_b32 v[216:217], v42 offset0:144 offset1:145
    ds_read2_b32 v[218:219], v42 offset0:146 offset1:147
    ds_read2_b32 v[220:221], v42 offset0:128 offset1:129
    ds_read2_b32 v[222:223], v42 offset0:130 offset1:131
    s_branch KT_JOIN
KT_HELP:
    v_mov_b32 v44, 0
    v_mov_b32 v45, 0
    v_mov_b32 v46, 0
    v_mov_b32 v47, 0
    s_mul_i32 s46, s51, 4640
    v_add_u32 v12, s46, v2
    s_mov_b64 exec, 0xffffffff
    ds_write_b128 v12, v[44:47] offset:0
    s_mov_b64 exec, -1
KT_JOIN:
    s_mov_b32 s47, 0
PL1:
    s_waitcnt vmcnt(0)
    v_xor_b32 v28, v10, v28
    v_xor_b32 v29, v10, v29
    v_xor_b32 v30, v10, v30
    v_xor_b32 v31, v10, v31
    v_xor_b32 v32, v10, v32
    v_xor_b32 v33, v10, v33
    v_xor_b32 v34, v10, v34
    v_xor_b32 v35, v10, v35
    v_or3_b32 v38, v28, v29, v30
    v_or3_b32 v38, v38, v31, v32
    v_or3_b32 v38, v38, v33, v34
    v_or_b32 v38, v38, v35
    v_and_b32 v38, 0x70007, v38
    v_cmp_ne_u32 vcc, 0, v38
    s_cbranch_vccz PD2
    s_sleep 2
    buffer_load_dwordx4 v[28:31], v3, s[32:35], s63 offen sc1
    buffer_load_dwordx4 v[32:35], v3, s[32:35], s48 offen sc1
    s_add_u32 s47, s47, 1
    s_cmp_lt_u32 s47, 65536
    s_cbranch_scc1 PL1
    s_waitcnt vmcnt(0)
    v_xor_b32 v28, v10, v28
    v_xor_b32 v29, v10, v29
    v_xor_b32 v30, v10, v30
    v_xor_b32 v31, v10, v31
    v_xor_b32 v32, v10, v32
    v_xor_b32 v33, v10, v33
    v_xor_b32 v34, v10, v34
    v_xor_b32 v35, v10, v35
    v_or3_b32 v38, v28, v29, v30
    v_or3_b32 v38, v38, v31, v32
    v_or3_b32 v38, v38, v33, v34
    v_or_b32 v38, v38, v35
    v_and_b32 v38, 0x70007, v38
    v_cmp_ne_u32 vcc, 0, v38
PD2:
    ds_write_b128 v36, v[28:31] offset:512
    ds_write_b128 v36, v[32:35] offset:2560
    v_and_b32 v12, 15, v1
    v_lshrrev_b32 v13, 4, v1
    v_lshlrev_b32 v14, 5, v12
    v_lshl_add_u32 v14, v13, 4, v14
    s_mul_i32 s46, s51, 4640
    v_add_u32 v14, s46, v14
    v_lshlrev_b32 v15, 3, v12
    v_lshl_add_u32 v15, v13, 7, v15
    s_mul_i32 s46, s51, 4128
    v_add_u32 v15, s46, v15
    s_waitcnt lgkmcnt(0)
    s_barrier
    s_cmp_ge_u32 s3, 4
    s_cbranch_scc1 C_CONVEND
    ds_read_b128 v[60:63], v14 offset:480
    ds_read_b128 v[64:67], v14 offset:464
    ds_read_b128 v[68:71], v14 offset:416
    ds_read_b128 v[72:75], v14 offset:352
    ds_read_b128 v[76:79], v14 offset:288
    ds_read_b128 v[80:83], v14 offset:224
    s_waitcnt lgkmcnt(5)
    v_mfma_f32_16x16x32_f16 v[92:95], v[60:63], v[224:227], 0
    v_mfma_f32_16x16x32_f16 v[96:99], v[60:63], v[228:231], 0
    v_mfma_f32_16x16x32_f16 v[100:103], v[60:63], v[232:235], 0
    v_mfma_f32_16x16x32_f16 v[108:111], v[60:63], v[240:243], 0
    v_mfma_f32_16x16x32_f16 v[28:31], v[116:119], v[60:63], 0
    v_mfma_f32_16x16x32_f16 v[32:35], v[148:151], v[60:63], 0
    v_mfma_f32_16x16x32_f16 v[36:39], v[180:183], v[60:63], 0
    v_mfma_f32_16x16x32_f16 v[44:47], v[248:251], v[60:63], 0
    ds_read_b128 v[84:87], v14 offset:160
    s_waitcnt lgkmcnt(5)
    v_mfma_f32_16x16x32_f16 v[104:107], v[64:67], v[236:239], 0
    v_mfma_f32_16x16x32_f16 v[112:115], v[64:67], v[244:247], 0
    ds_read_b128 v[88:91], v14 offset:96
    s_waitcnt lgkmcnt(5)
    v_mfma_f32_16x16x32_f16 v[28:31], v[120:123], v[68:71], v[28:31]
    v_cvt_pk_f16_f32 v92, v96, v92
    v_mfma_f32_16x16x32_f16 v[32:35], v[152:155], v[68:71], v[32:35]
    v_cvt_pk_f16_f32 v93, v97, v93
    ds_read_b128 v[60:63], v14 offset:32
    s_waitcnt lgkmcnt(5)
    v_mfma_f32_16x16x32_f16 v[28:31], v[124:127], v[72:75], v[28:31]
    v_cvt_pk_f16_f32 v94, v98, v94
    v_mfma_f32_16x16x32_f16 v[32:35], v[156:159], v[72:75], v[32:35]
    v_cvt_pk_f16_f32 v95, v99, v95
    ds_read_b128 v[64:67], v14 offset:992
    s_waitcnt lgkmcnt(5)
    v_mfma_f32_16x16x32_f16 v[28:31], v[128:131], v[76:79], v[28:31]
    v_cvt_pk_f16_f32 v100, v104, v100
    v_mfma_f32_16x16x32_f16 v[32:35], v[160:163], v[76:79], v[32:35]
    v_cvt_pk_f16_f32 v101, v105, v101
    ds_read_b128 v[68:71], v14 offset:976
    s_waitcnt lgkmcnt(5)
    v_mfma_f32_16x16x32_f16 v[28:31], v[132:135], v[80:83], v[28:31]
    v_cvt_pk_f16_f32 v102, v106, v102
    v_mfma_f32_16x16x32_f16 v[32:35], v[164:167], v[80:83], v[32:35]
    v_cvt_pk_f16_f32 v103, v107, v103
    ds_read_b128 v[72:75], v14 offset:928
    s_waitcnt lgkmcnt(5)
    v_mfma_f32_16x16x32_f16 v[28:31], v[136:139], v[84:87], v[28:31]
    v_cvt_pk_f16_f32 v108, v108, v112
    v_mfma_f32_16x16x32_f16 v[32:35], v[168:171], v[84:87], v[32:35]
    v_cvt_pk_f16_f32 v109, v109, v113
    ds_read_b128 v[76:79], v14 offset:864
    s_waitcnt lgkmcnt(5)
    v_mfma_f32_16x16x32_f16 v[28:31], v[140:143], v[88:91], v[28:31]
    v_cvt_pk_f16_f32 v110, v110, v114
    v_mfma_f32_16x16x32_f16 v[32:35], v[172:175], v[88:91], v[32:35]
    v_cvt_pk_f16_f32 v111, v111, v115
    ds_read_b128 v[80:83], v14 offset:800
    s_waitcnt lgkmcnt(5)
    v_mfma_f32_16x16x32_f16 v[28:31], v[144:147], v[60:63], v[28:31]
    v_mfma_f32_16x16x32_f16 v[32:35], v[176:179], v[60:63], v[32:35]
    ds_read_b128 v[84:87], v14 offset:736
    v_mfma_f32_16x16x32_f16 v[36:39], v[92:95], v[184:187], v[36:39]
    v_mfma_f32_16x16x32_f16 v[40:43], v[92:95], v[192:195], 0
    v_mfma_f32_16x16x32_f16 v[44:47], v[92:95], v[200:203], v[44:47]
    v_mfma_f32_16x16x32_f16 v[36:39], v[100:103], v[188:191], v[36:39]
    v_mfma_f32_16x16x32_f16 v[40:43], v[100:103], v[196:199], v[40:43]
    s_nop 0
    v_cvt_pkrtz_f16_f32 v28, v28, v29
    v_mfma_f32_16x16x32_f16 v[44:47], v[100:103], v[204:207], v[44:47]
    v_cvt_pkrtz_f16_f32 v29, v30, v31
    v_mfma_f32_16x16x32_f16 v[44:47], v[108:111], v[208:211], v[44:47]
    v_add_u32 v28, v11, v28
    v_mfma_f32_16x16x32_f16 v[48:51], v[108:111], v[212:215], 0
    v_add_u32 v29, v11, v29
    v_mfma_f32_16x16x32_f16 v[52:55], v[108:111], v[216:219], 0
    ds_write_b64 v15, v[28:29] offset:20480
    v_mfma_f32_16x16x32_f16 v[56:59], v[108:111], v[220:223], 0
    s_waitcnt lgkmcnt(6)
    v_mfma_f32_16x16x32_f16 v[92:95], v[64:67], v[224:227], 0
    v_mfma_f32_16x16x32_f16 v[96:99], v[64:67], v[228:231], 0
    v_mfma_f32_16x16x32_f16 v[100:103], v[64:67], v[232:235], 0
    v_mfma_f32_16x16x32_f16 v[108:111], v[64:67], v[240:243], 0
    v_mfma_f32_16x16x32_f16 v[32:35], v[116:119], v[64:67], v[32:35]
    v_mfma_f32_16x16x32_f16 v[36:39], v[148:151], v[64:67], v[36:39]
    v_mfma_f32_16x16x32_f16 v[40:43], v[180:183], v[64:67], v[40:43]
    v_mfma_f32_16x16x32_f16 v[48:51], v[248:251], v[64:67], v[48:51]
    ds_read_b128 v[88:91], v14 offset:672
    s_waitcnt lgkmcnt(6)
    v_mfma_f32_16x16x32_f16 v[104:107], v[68:71], v[236:239], 0
    v_mfma_f32_16x16x32_f16 v[112:115], v[68:71], v[244:247], 0
    ds_read_b128 v[60:63], v14 offset:608
    s_waitcnt lgkmcnt(6)
    v_mfma_f32_16x16x32_f16 v[32:35], v[120:123], v[72:75], v[32:35]
    v_cvt_pk_f16_f32 v92, v96, v92
    v_mfma_f32_16x16x32_f16 v[36:39], v[152:155], v[72:75], v[36:39]
    v_cvt_pk_f16_f32 v93, v97, v93
    ds_read_b128 v[64:67], v14 offset:544
    s_waitcnt lgkmcnt(6)
    v_mfma_f32_16x16x32_f16 v[32:35], v[124:127], v[76:79], v[32:35]
    v_cvt_pk_f16_f32 v94, v98, v94
    v_mfma_f32_16x16x32_f16 v[36:39], v[156:159], v[76:79], v[36:39]
    v_cvt_pk_f16_f32 v95, v99, v95
    ds_read_b128 v[68:71], v14 offset:1504
    s_waitcnt lgkmcnt(6)
    v_mfma_f32_16x16x32_f16 v[32:35], v[128:131], v[80:83], v[32:35]
    v_cvt_pk_f16_f32 v100, v104, v100
    v_mfma_f32_16x16x32_f16 v[36:39], v[160:163], v[80:83], v[36:39]
    v_cvt_pk_f16_f32 v101, v105, v101
    ds_read_b128 v[72:75], v14 offset:1488
    s_waitcnt lgkmcnt(6)
    v_mfma_f32_16x16x32_f16 v[32:35], v[132:135], v[84:87], v[32:35]
    v_cvt_pk_f16_f32 v102, v106, v102
    v_mfma_f32_16x16x32_f16 v[36:39], v[164:167], v[84:87], v[36:39]
    v_cvt_pk_f16_f32 v103, v107, v103
    ds_read_b128 v[76:79], v14 offset:1440
    s_waitcnt lgkmcnt(5)
    v_mfma_f32_16x16x32_f16 v[32:35], v[136:139], v[88:91], v[32:35]
    v_cvt_pk_f16_f32 v108, v108, v112
    v_mfma_f32_16x16x32_f16 v[36:39], v[168:171], v[88:91], v[36:39]
    v_cvt_pk_f16_f32 v109, v109, v113
    ds_read_b128 v[80:83], v14 offset:1376
    s_waitcnt lgkmcnt(5)
    v_mfma_f32_16x16x32_f16 v[32:35], v[140:143], v[60:63], v[32:35]
    v_cvt_pk_f16_f32 v110, v110, v114
    v_mfma_f32_16x16x32_f16 v[36:39], v[172:175], v[60:63], v[36:39]
    v_cvt_pk_f16_f32 v111, v111, v115
    ds_read_b128 v[84:87], v14 offset:1312
    s_waitcnt lgkmcnt(5)
    v_mfma_f32_16x16x32_f16 v[32:35], v[144:147], v[64:67], v[32:35]
    v_mfma_f32_16x16x32_f16 v[36:39], v[176:179], v[64:67], v[36:39]
    ds_read_b128 v[88:91], v14 offset:1248
    v_mfma_f32_16x16x32_f16 v[40:43], v[92:95], v[184:187], v[40:43]
    v_mfma_f32_16x16x32_f16 v[44:47], v[92:95], v[192:195], v[44:47]
    v_mfma_f32_16x16x32_f16 v[48:51], v[92:95], v[200:203], v[48:51]
    v_mfma_f32_16x16x32_f16 v[40:43], v[100:103], v[188:191], v[40:43]
    v_mfma_f32_16x16x32_f16 v[44:47], v[100:103], v[196:199], v[44:47]
    s_nop 0
    v_cvt_pkrtz_f16_f32 v32, v32, v33
    v_mfma_f32_16x16x32_f16 v[48:51], v[100:103], v[204:207], v[48:51]
    v_cvt_pkrtz_f16_f32 v33, v34, v35
    v_mfma_f32_16x16x32_f16 v[48:51], v[108:111], v[208:211], v[48:51]
    v_add_u32 v32, v11, v32
    v_mfma_f32_16x16x32_f16 v[52:55], v[108:111], v[212:215], v[52:55]
    v_add_u32 v33, v11, v33
    v_mfma_f32_16x16x32_f16 v[56:59], v[108:111], v[216:219], v[56:59]
    ds_write_b64 v15, v[32:33] offset:20992
    s_waitcnt lgkmcnt(6)
    v_mfma_f32_16x16x32_f16 v[92:95], v[68:71], v[224:227], 0
    v_mfma_f32_16x16x32_f16 v[96:99], v[68:71], v[228:231], 0
    v_mfma_f32_16x16x32_f16 v[100:103], v[68:71], v[232:235], 0
    v_mfma_f32_16x16x32_f16 v[108:111], v[68:71], v[240:243], 0
    v_mfma_f32_16x16x32_f16 v[36:39], v[116:119], v[68:71], v[36:39]
    v_mfma_f32_16x16x32_f16 v[40:43], v[148:151], v[68:71], v[40:43]
    v_mfma_f32_16x16x32_f16 v[44:47], v[180:183], v[68:71], v[44:47]
    v_mfma_f32_16x16x32_f16 v[52:55], v[248:251], v[68:71], v[52:55]
    ds_read_b128 v[60:63], v14 offset:1184
    s_waitcnt lgkmcnt(6)
    v_mfma_f32_16x16x32_f16 v[104:107], v[72:75], v[236:239], 0
    v_mfma_f32_16x16x32_f16 v[112:115], v[72:75], v[244:247], 0
    ds_read_b128 v[64:67], v14 offset:1120
    s_waitcnt lgkmcnt(6)
    v_mfma_f32_16x16x32_f16 v[36:39], v[120:123], v[76:79], v[36:39]
    v_cvt_pk_f16_f32 v92, v96, v92
    v_mfma_f32_16x16x32_f16 v[40:43], v[152:155], v[76:79], v[40:43]
    v_cvt_pk_f16_f32 v93, v97, v93
    ds_read_b128 v[68:71], v14 offset:1056
    s_waitcnt lgkmcnt(6)
    v_mfma_f32_16x16x32_f16 v[36:39], v[124:127], v[80:83], v[36:39]
    v_cvt_pk_f16_f32 v94, v98, v94
    v_mfma_f32_16x16x32_f16 v[40:43], v[156:159], v[80:83], v[40:43]
    v_cvt_pk_f16_f32 v95, v99, v95
    ds_read_b128 v[72:75], v14 offset:2016
    s_waitcnt lgkmcnt(6)
    v_mfma_f32_16x16x32_f16 v[36:39], v[128:131], v[84:87], v[36:39]
    v_cvt_pk_f16_f32 v100, v104, v100
    v_mfma_f32_16x16x32_f16 v[40:43], v[160:163], v[84:87], v[40:43]
    v_cvt_pk_f16_f32 v101, v105, v101
    ds_read_b128 v[76:79], v14 offset:2000
    s_waitcnt lgkmcnt(6)
    v_mfma_f32_16x16x32_f16 v[36:39], v[132:135], v[88:91], v[36:39]
    v_cvt_pk_f16_f32 v102, v106, v102
    v_mfma_f32_16x16x32_f16 v[40:43], v[164:167], v[88:91], v[40:43]
    v_cvt_pk_f16_f32 v103, v107, v103
    ds_read_b128 v[80:83], v14 offset:1952
    s_waitcnt lgkmcnt(5)
    v_mfma_f32_16x16x32_f16 v[36:39], v[136:139], v[60:63], v[36:39]
    v_cvt_pk_f16_f32 v108, v108, v112
    v_mfma_f32_16x16x32_f16 v[40:43], v[168:171], v[60:63], v[40:43]
    v_cvt_pk_f16_f32 v109, v109, v113
    ds_read_b128 v[84:87], v14 offset:1888
    s_waitcnt lgkmcnt(5)
    v_mfma_f32_16x16x32_f16 v[36:39], v[140:143], v[64:67], v[36:39]
    v_cvt_pk_f16_f32 v110, v110, v114
    v_mfma_f32_16x16x32_f16 v[40:43], v[172:175], v[64:67], v[40:43]
    v_cvt_pk_f16_f32 v111, v111, v115
    ds_read_b128 v[88:91], v14 offset:1824
    s_waitcnt lgkmcnt(5)
    v_mfma_f32_16x16x32_f16 v[36:39], v[144:147], v[68:71], v[36:39]
    v_mfma_f32_16x16x32_f16 v[40:43], v[176:179], v[68:71], v[40:43]
    ds_read_b128 v[60:63], v14 offset:1760
    v_mfma_f32_16x16x32_f16 v[44:47], v[92:95], v[184:187], v[44:47]
    v_mfma_f32_16x16x32_f16 v[48:51], v[92:95], v[192:195], v[48:51]
    v_mfma_f32_16x16x32_f16 v[52:55], v[92:95], v[200:203], v[52:55]
    v_mfma_f32_16x16x32_f16 v[44:47], v[100:103], v[188:191], v[44:47]
    v_mfma_f32_16x16x32_f16 v[48:51], v[100:103], v[196:199], v[48:51]
    s_nop 0
    v_cvt_pkrtz_f16_f32 v36, v36, v37
    v_mfma_f32_16x16x32_f16 v[52:55], v[100:103], v[204:207], v[52:55]
    v_cvt_pkrtz_f16_f32 v37, v38, v39
    v_mfma_f32_16x16x32_f16 v[52:55], v[108:111], v[208:211], v[52:55]
    v_add_u32 v36, v11, v36
    v_mfma_f32_16x16x32_f16 v[56:59], v[108:111], v[212:215], v[56:59]
    v_add_u32 v37, v11, v37
    s_waitcnt lgkmcnt(5)
    v_mfma_f32_16x16x32_f16 v[92:95], v[72:75], v[224:227], 0
    ds_write_b64 v15, v[36:37] offset:21504
    v_mfma_f32_16x16x32_f16 v[96:99], v[72:75], v[228:231], 0
    v_mfma_f32_16x16x32_f16 v[100:103], v[72:75], v[232:235], 0
    v_mfma_f32_16x16x32_f16 v[108:111], v[72:75], v[240:243], 0
    v_mfma_f32_16x16x32_f16 v[40:43], v[116:119], v[72:75], v[40:43]
    v_mfma_f32_16x16x32_f16 v[44:47], v[148:151], v[72:75], v[44:47]
    v_mfma_f32_16x16x32_f16 v[48:51], v[180:183], v[72:75], v[48:51]
    v_mfma_f32_16x16x32_f16 v[56:59], v[248:251], v[72:75], v[56:59]
    ds_read_b128 v[64:67], v14 offset:1696
    s_waitcnt lgkmcnt(6)
    v_mfma_f32_16x16x32_f16 v[104:107], v[76:79], v[236:239], 0
    v_mfma_f32_16x16x32_f16 v[112:115], v[76:79], v[244:247], 0
    ds_read_b128 v[68:71], v14 offset:1632
    s_waitcnt lgkmcnt(6)
    v_mfma_f32_16x16x32_f16 v[40:43], v[120:123], v[80:83], v[40:43]
    v_cvt_pk_f16_f32 v92, v96, v92
    v_mfma_f32_16x16x32_f16 v[44:47], v[152:155], v[80:83], v[44:47]
    v_cvt_pk_f16_f32 v93, v97, v93
    ds_read_b128 v[72:75], v14 offset:1568
    s_waitcnt lgkmcnt(6)
    v_mfma_f32_16x16x32_f16 v[40:43], v[124:127], v[84:87], v[40:43]
    v_cvt_pk_f16_f32 v94, v98, v94
    v_mfma_f32_16x16x32_f16 v[44:47], v[156:159], v[84:87], v[44:47]
    v_cvt_pk_f16_f32 v95, v99, v95
    ds_read_b128 v[76:79], v14 offset:2528
    s_waitcnt lgkmcnt(6)
    v_mfma_f32_16x16x32_f16 v[40:43], v[128:131], v[88:91], v[40:43]
    v_cvt_pk_f16_f32 v100, v104, v100
    v_mfma_f32_16x16x32_f16 v[44:47], v[160:163], v[88:91], v[44:47]
    v_cvt_pk_f16_f32 v101, v105, v101
    ds_read_b128 v[80:83], v14 offset:2512
    s_waitcnt lgkmcnt(6)
    v_mfma_f32_16x16x32_f16 v[40:43], v[132:135], v[60:63], v[40:43]
    v_cvt_pk_f16_f32 v102, v106, v102
    v_mfma_f32_16x16x32_f16 v[44:47], v[164:167], v[60:63], v[44:47]
    v_cvt_pk_f16_f32 v103, v107, v103
    ds_read_b128 v[84:87], v14 offset:2464
    s_waitcnt lgkmcnt(5)
    v_mfma_f32_16x16x32_f16 v[40:43], v[136:139], v[64:67], v[40:43]
    v_cvt_pk_f16_f32 v108, v108, v112
    v_mfma_f32_16x16x32_f16 v[44:47], v[168:171], v[64:67], v[44:47]
    v_cvt_pk_f16_f32 v109, v109, v113
    ds_read_b128 v[88:91], v14 offset:2400
    s_waitcnt lgkmcnt(5)
    v_mfma_f32_16x16x32_f16 v[40:43], v[140:143], v[68:71], v[40:43]
    v_cvt_pk_f16_f32 v110, v110, v114
    v_mfma_f32_16x16x32_f16 v[44:47], v[172:175], v[68:71], v[44:47]
    v_cvt_pk_f16_f32 v111, v111, v115
    ds_read_b128 v[60:63], v14 offset:2336
    s_waitcnt lgkmcnt(5)
    v_mfma_f32_16x16x32_f16 v[40:43], v[144:147], v[72:75], v[40:43]
    v_mfma_f32_16x16x32_f16 v[44:47], v[176:179], v[72:75], v[44:47]
    ds_read_b128 v[64:67], v14 offset:2272
    v_mfma_f32_16x16x32_f16 v[48:51], v[92:95], v[184:187], v[48:51]
    v_mfma_f32_16x16x32_f16 v[52:55], v[92:95], v[192:195], v[52:55]
    v_mfma_f32_16x16x32_f16 v[56:59], v[92:95], v[200:203], v[56:59]
    v_mfma_f32_16x16x32_f16 v[48:51], v[100:103], v[188:191], v[48:51]
    v_mfma_f32_16x16x32_f16 v[52:55], v[100:103], v[196:199], v[52:55]
    s_nop 0
    v_cvt_pkrtz_f16_f32 v40, v40, v41
    v_mfma_f32_16x16x32_f16 v[56:59], v[100:103], v[204:207], v[56:59]
    v_cvt_pkrtz_f16_f32 v41, v42, v43
    v_mfma_f32_16x16x32_f16 v[56:59], v[108:111], v[208:211], v[56:59]
    v_add_u32 v40, v11, v40
    s_waitcnt lgkmcnt(5)
    v_mfma_f32_16x16x32_f16 v[92:95], v[76:79], v[224:227], 0
    v_add_u32 v41, v11, v41
    v_mfma_f32_16x16x32_f16 v[96:99], v[76:79], v[228:231], 0
    ds_write_b64 v15, v[40:41] offset:22016
    v_mfma_f32_16x16x32_f16 v[100:103], v[76:79], v[232:235], 0
    v_mfma_f32_16x16x32_f16 v[44:47], v[116:119], v[76:79], v[44:47]
    v_mfma_f32_16x16x32_f16 v[48:51], v[148:151], v[76:79], v[48:51]
    v_mfma_f32_16x16x32_f16 v[52:55], v[180:183], v[76:79], v[52:55]
    ds_read_b128 v[68:71], v14 offset:2208
    s_waitcnt lgkmcnt(6)
    v_mfma_f32_16x16x32_f16 v[104:107], v[80:83], v[236:239], 0
    ds_read_b128 v[72:75], v14 offset:2144
    s_waitcnt lgkmcnt(6)
    v_mfma_f32_16x16x32_f16 v[44:47], v[120:123], v[84:87], v[44:47]
    v_cvt_pk_f16_f32 v92, v96, v92
    v_mfma_f32_16x16x32_f16 v[48:51], v[152:155], v[84:87], v[48:51]
    v_cvt_pk_f16_f32 v93, v97, v93
    ds_read_b128 v[76:79], v14 offset:2080
    s_waitcnt lgkmcnt(6)
    v_mfma_f32_16x16x32_f16 v[44:47], v[124:127], v[88:91], v[44:47]
    v_cvt_pk_f16_f32 v94, v98, v94
    v_mfma_f32_16x16x32_f16 v[48:51], v[156:159], v[88:91], v[48:51]
    v_cvt_pk_f16_f32 v95, v99, v95
    ds_read_b128 v[80:83], v14 offset:3040
    s_waitcnt lgkmcnt(6)
    v_mfma_f32_16x16x32_f16 v[44:47], v[128:131], v[60:63], v[44:47]
    v_cvt_pk_f16_f32 v100, v104, v100
    v_mfma_f32_16x16x32_f16 v[48:51], v[160:163], v[60:63], v[48:51]
    v_cvt_pk_f16_f32 v101, v105, v101
    ds_read_b128 v[84:87], v14 offset:3024
    s_waitcnt lgkmcnt(6)
    v_mfma_f32_16x16x32_f16 v[44:47], v[132:135], v[64:67], v[44:47]
    v_cvt_pk_f16_f32 v102, v106, v102
    v_mfma_f32_16x16x32_f16 v[48:51], v[164:167], v[64:67], v[48:51]
    v_cvt_pk_f16_f32 v103, v107, v103
    ds_read_b128 v[88:91], v14 offset:2976
    s_waitcnt lgkmcnt(5)
    v_mfma_f32_16x16x32_f16 v[44:47], v[136:139], v[68:71], v[44:47]
    v_mfma_f32_16x16x32_f16 v[48:51], v[168:171], v[68:71], v[48:51]
    ds_read_b128 v[60:63], v14 offset:2912
    s_waitcnt lgkmcnt(5)
    v_mfma_f32_16x16x32_f16 v[44:47], v[140:143], v[72:75], v[44:47]
    v_mfma_f32_16x16x32_f16 v[48:51], v[172:175], v[72:75], v[48:51]
    ds_read_b128 v[64:67], v14 offset:2848
    s_waitcnt lgkmcnt(5)
    v_mfma_f32_16x16x32_f16 v[44:47], v[144:147], v[76:79], v[44:47]
    v_mfma_f32_16x16x32_f16 v[48:51], v[176:179], v[76:79], v[48:51]
    ds_read_b128 v[68:71], v14 offset:2784
    v_mfma_f32_16x16x32_f16 v[52:55], v[92:95], v[184:187], v[52:55]
    v_mfma_f32_16x16x32_f16 v[56:59], v[92:95], v[192:195], v[56:59]
    v_mfma_f32_16x16x32_f16 v[52:55], v[100:103], v[188:191], v[52:55]
    v_mfma_f32_16x16x32_f16 v[56:59], v[100:103], v[196:199], v[56:59]
    s_waitcnt lgkmcnt(5)
    v_mfma_f32_16x16x32_f16 v[92:95], v[80:83], v[224:227], 0
    v_cvt_pkrtz_f16_f32 v44, v44, v45
    v_mfma_f32_16x16x32_f16 v[96:99], v[80:83], v[228:231], 0
    v_cvt_pkrtz_f16_f32 v45, v46, v47
    v_mfma_f32_16x16x32_f16 v[100:103], v[80:83], v[232:235], 0
    v_add_u32 v44, v11, v44
    v_mfma_f32_16x16x32_f16 v[48:51], v[116:119], v[80:83], v[48:51]
    v_add_u32 v45, v11, v45
    v_mfma_f32_16x16x32_f16 v[52:55], v[148:151], v[80:83], v[52:55]
    ds_write_b64 v15, v[44:45] offset:22528
    v_mfma_f32_16x16x32_f16 v[56:59], v[180:183], v[80:83], v[56:59]
    ds_read_b128 v[72:75], v14 offset:2720
    s_waitcnt lgkmcnt(6)
    v_mfma_f32_16x16x32_f16 v[104:107], v[84:87], v[236:239], 0
    ds_read_b128 v[76:79], v14 offset:2656
    s_waitcnt lgkmcnt(6)
    v_mfma_f32_16x16x32_f16 v[48:51], v[120:123], v[88:91], v[48:51]
    v_cvt_pk_f16_f32 v92, v96, v92
    v_mfma_f32_16x16x32_f16 v[52:55], v[152:155], v[88:91], v[52:55]
    v_cvt_pk_f16_f32 v93, v97, v93
    ds_read_b128 v[80:83], v14 offset:2592
    s_waitcnt lgkmcnt(6)
    v_mfma_f32_16x16x32_f16 v[48:51], v[124:127], v[60:63], v[48:51]
    v_cvt_pk_f16_f32 v94, v98, v94
    v_mfma_f32_16x16x32_f16 v[52:55], v[156:159], v[60:63], v[52:55]
    v_cvt_pk_f16_f32 v95, v99, v95
    ds_read_b128 v[84:87], v14 offset:3552
    s_waitcnt lgkmcnt(6)
    v_mfma_f32_16x16x32_f16 v[48:51], v[128:131], v[64:67], v[48:51]
    v_cvt_pk_f16_f32 v100, v104, v100
    v_mfma_f32_16x16x32_f16 v[52:55], v[160:163], v[64:67], v[52:55]
    v_cvt_pk_f16_f32 v101, v105, v101
    ds_read_b128 v[88:91], v14 offset:3488
    s_waitcnt lgkmcnt(6)
    v_mfma_f32_16x16x32_f16 v[48:51], v[132:135], v[68:71], v[48:51]
    v_cvt_pk_f16_f32 v102, v106, v102
    v_mfma_f32_16x16x32_f16 v[52:55], v[164:167], v[68:71], v[52:55]
    v_cvt_pk_f16_f32 v103, v107, v103
    ds_read_b128 v[60:63], v14 offset:3424
    s_waitcnt lgkmcnt(5)
    v_mfma_f32_16x16x32_f16 v[48:51], v[136:139], v[72:75], v[48:51]
    v_mfma_f32_16x16x32_f16 v[52:55], v[168:171], v[72:75], v[52:55]
    ds_read_b128 v[64:67], v14 offset:3360
    s_waitcnt lgkmcnt(5)
    v_mfma_f32_16x16x32_f16 v[48:51], v[140:143], v[76:79], v[48:51]
    v_mfma_f32_16x16x32_f16 v[52:55], v[172:175], v[76:79], v[52:55]
    ds_read_b128 v[68:71], v14 offset:3296
    s_waitcnt lgkmcnt(5)
    v_mfma_f32_16x16x32_f16 v[48:51], v[144:147], v[80:83], v[48:51]
    v_mfma_f32_16x16x32_f16 v[52:55], v[176:179], v[80:83], v[52:55]
    ds_read_b128 v[72:75], v14 offset:3232
    v_mfma_f32_16x16x32_f16 v[56:59], v[92:95], v[184:187], v[56:59]
    v_mfma_f32_16x16x32_f16 v[56:59], v[100:103], v[188:191], v[56:59]
    s_waitcnt lgkmcnt(5)
    v_mfma_f32_16x16x32_f16 v[52:55], v[116:119], v[84:87], v[52:55]
    v_mfma_f32_16x16x32_f16 v[56:59], v[148:151], v[84:87], v[56:59]
    ds_read_b128 v[76:79], v14 offset:3168
    s_waitcnt lgkmcnt(5)
    v_mfma_f32_16x16x32_f16 v[52:55], v[120:123], v[88:91], v[52:55]
    v_cvt_pkrtz_f16_f32 v48, v48, v49
    v_mfma_f32_16x16x32_f16 v[56:59], v[152:155], v[88:91], v[56:59]
    v_cvt_pkrtz_f16_f32 v49, v50, v51
    ds_read_b128 v[80:83], v14 offset:3104
    s_waitcnt lgkmcnt(5)
    v_mfma_f32_16x16x32_f16 v[52:55], v[124:127], v[60:63], v[52:55]
    v_add_u32 v48, v11, v48
    v_mfma_f32_16x16x32_f16 v[56:59], v[156:159], v[60:63], v[56:59]
    v_add_u32 v49, v11, v49
    ds_read_b128 v[84:87], v14 offset:4064
    s_waitcnt lgkmcnt(5)
    v_mfma_f32_16x16x32_f16 v[52:55], v[128:131], v[64:67], v[52:55]
    ds_write_b64 v15, v[48:49] offset:23040
    v_mfma_f32_16x16x32_f16 v[56:59], v[160:163], v[64:67], v[56:59]
    ds_read_b128 v[88:91], v14 offset:4000
    s_waitcnt lgkmcnt(6)
    v_mfma_f32_16x16x32_f16 v[52:55], v[132:135], v[68:71], v[52:55]
    v_mfma_f32_16x16x32_f16 v[56:59], v[164:167], v[68:71], v[56:59]
    ds_read_b128 v[60:63], v14 offset:3936
    s_waitcnt lgkmcnt(6)
    v_mfma_f32_16x16x32_f16 v[52:55], v[136:139], v[72:75], v[52:55]
    v_mfma_f32_16x16x32_f16 v[56:59], v[168:171], v[72:75], v[56:59]
    ds_read_b128 v[64:67], v14 offset:3872
    s_waitcnt lgkmcnt(6)
    v_mfma_f32_16x16x32_f16 v[52:55], v[140:143], v[76:79], v[52:55]
    v_mfma_f32_16x16x32_f16 v[56:59], v[172:175], v[76:79], v[56:59]
    ds_read_b128 v[68:71], v14 offset:3808
    s_waitcnt lgkmcnt(6)
    v_mfma_f32_16x16x32_f16 v[52:55], v[144:147], v[80:83], v[52:55]
    v_mfma_f32_16x16x32_f16 v[56:59], v[176:179], v[80:83], v[56:59]
    ds_read_b128 v[72:75], v14 offset:3744
    s_waitcnt lgkmcnt(6)
    v_mfma_f32_16x16x32_f16 v[56:59], v[116:119], v[84:87], v[56:59]
    ds_read_b128 v[76:79], v14 offset:3680
    s_waitcnt lgkmcnt(5)
    v_mfma_f32_16x16x32_f16 v[56:59], v[120:123], v[88:91], v[56:59]
    ds_read_b128 v[80:83], v14 offset:3616
    s_waitcnt lgkmcnt(5)
    v_mfma_f32_16x16x32_f16 v[56:59], v[124:127], v[60:63], v[56:59]
    s_waitcnt lgkmcnt(4)
    v_mfma_f32_16x16x32_f16 v[56:59], v[128:131], v[64:67], v[56:59]
    s_waitcnt lgkmcnt(3)
    v_mfma_f32_16x16x32_f16 v[56:59], v[132:135], v[68:71], v[56:59]
    v_cvt_pkrtz_f16_f32 v52, v52, v53
    s_waitcnt lgkmcnt(2)
    v_mfma_f32_16x16x32_f16 v[56:59], v[136:139], v[72:75], v[56:59]
    v_cvt_pkrtz_f16_f32 v53, v54, v55
    s_waitcnt lgkmcnt(1)
    v_mfma_f32_16x16x32_f16 v[56:59], v[140:143], v[76:79], v[56:59]
    v_add_u32 v52, v11, v52
    s_waitcnt lgkmcnt(0)
    v_mfma_f32_16x16x32_f16 v[56:59], v[144:147], v[80:83], v[56:59]
    v_add_u32 v53, v11, v53
    ds_write_b64 v15, v[52:53] offset:23552
    s_nop 5
    v_cvt_pkrtz_f16_f32 v56, v56, v57
    v_cvt_pkrtz_f16_f32 v57, v58, v59
    v_add_u32 v56, v11, v56
    v_add_u32 v57, v11, v57
    ds_write_b64 v15, v[56:57] offset:24064
C_CONVEND:
    v_and_b32 v13, 31, v1
    v_lshlrev_b32 v38, 5, v13
    v_lshlrev_b32 v39, 3, v13
    v_lshlrev_b32 v12, 4, v13
    v_lshlrev_b32 v13, 2, v13
    s_cmp_ge_u32 s2, 128
    s_cbranch_scc1 AC_NOR
    global_load_dwordx4 v[28:31], v12, s[16:17]
    global_load_dwordx4 v[32:35], v12, s[16:17] offset:512
    global_load_dword v36, v13, s[16:17] offset:1024
    global_load_dwordx4 v[40:43], v12, s[20:21]
    global_load_dwordx4 v[44:47], v12, s[20:21] offset:512
    global_load_dword v48, v13, s[20:21] offset:1024
    s_mov_b32 s46, 8192
    buffer_load_dwordx4 v[52:55], v38, s[32:35], s46 offen offset:0 sc1
    buffer_load_dwordx4 v[56:59], v38, s[32:35], s46 offen offset:16 sc1
    buffer_load_dwordx4 v[60:63], v38, s[32:35], s46 offen offset:1024 sc1
    buffer_load_dwordx4 v[64:67], v38, s[32:35], s46 offen offset:1040 sc1
    buffer_load_dwordx2 v[68:69], v39, s[32:35], s46 offen offset:2048 sc1
AC_NOR:
    v_bfe_u32 v14, v1, 2, 2
    v_mul_u32_u24 v14, 4128, v14
    v_and_b32 v15, 1, v1
    v_lshl_add_u32 v14, v15, 7, v14
    v_lshrrev_b32 v15, 4, v1
    v_lshl_add_u32 v14, v15, 4, v14
    v_and_b32 v15, 2, v1
    v_lshl_add_u32 v14, v15, 2, v14
    s_lshr_b32 s46, s3, 1
    s_lshl_b32 s46, s46, 9
    s_and_b32 s48, s3, 1
    s_lshl_b32 s48, s48, 6
    s_add_u32 s46, s46, s48
    v_add_u32 v14, s46, v14
    v_lshrrev_b32 v15, 3, v0
    v_mul_u32_u24 v15, 18432, v15
    v_and_b32 v37, 7, v0
    v_lshl_add_u32 v15, v37, 4, v15
    s_lshl_b32 s55, s2, 7
    s_add_u32 s55, s55, 4194304
    s_add_u32 s48, s55, 1179648
    s_waitcnt lgkmcnt(0)
    s_barrier
    ds_read_b64_tr_b16 v[192:193], v14 offset:20480
    ds_read_b64_tr_b16 v[194:195], v14 offset:20736
    ds_read_b64_tr_b16 v[196:197], v14 offset:22528
    ds_read_b64_tr_b16 v[198:199], v14 offset:22784
    s_waitcnt lgkmcnt(2)
    v_and_or_b32 v192, v192, v9, v10
    v_and_or_b32 v193, v193, v9, v10
    v_and_or_b32 v194, v194, v9, v10
    v_and_or_b32 v195, v195, v9, v10
    buffer_store_dwordx4 v[192:195], v15, s[32:35], s55 offen sc1
    s_waitcnt lgkmcnt(0)
    v_and_or_b32 v196, v196, v9, v10
    v_and_or_b32 v197, v197, v9, v10
    v_and_or_b32 v198, v198, v9, v10
    v_and_or_b32 v199, v199, v9, v10
    buffer_store_dwordx4 v[196:199], v15, s[32:35], s48 offen sc1
    s_cmp_ge_u32 s2, 128
    s_cbranch_scc1 ZROLE
    v_lshrrev_b32 v14, 5, v1
    v_mul_u32_u24 v14, 9600, v14
    s_mul_i32 s46, s3, 1184
    s_add_u32 s46, s46, 115328
    v_add_u32 v14, s46, v14
    v_add_u32 v15, v14, v13
    v_add_u32 v14, v14, v12
    ds_read_b128 v[72:75], v14
    ds_read_b128 v[76:79], v14 offset:512
    ds_read_b32 v80, v15 offset:1024
    s_mul_i32 s60, s2, 18432
    s_add_u32 s60, s60, 4194304
    s_add_u32 s61, s60, 8192
    s_add_u32 s62, s60, 16384
    v_mov_b32 v204, 0
    s_waitcnt vmcnt(7)
    v_lshlrev_b32 v84, 16, v28
    v_and_b32 v85, 0xffff0000, v28
    v_lshlrev_b32 v120, 16, v40
    v_and_b32 v121, 0xffff0000, v40
    v_dot2c_f32_bf16 v204, v40, v8
    v_lshlrev_b32 v86, 16, v29
    v_and_b32 v87, 0xffff0000, v29
    v_lshlrev_b32 v122, 16, v41
    v_and_b32 v123, 0xffff0000, v41
    v_dot2c_f32_bf16 v204, v41, v8
    v_lshlrev_b32 v88, 16, v30
    v_and_b32 v89, 0xffff0000, v30
    v_lshlrev_b32 v124, 16, v42
    v_and_b32 v125, 0xffff0000, v42
    v_dot2c_f32_bf16 v204, v42, v8
    v_lshlrev_b32 v90, 16, v31
    v_and_b32 v91, 0xffff0000, v31
    v_lshlrev_b32 v126, 16, v43
    v_and_b32 v127, 0xffff0000, v43
    v_dot2c_f32_bf16 v204, v43, v8
    v_lshlrev_b32 v92, 16, v32
    v_and_b32 v93, 0xffff0000, v32
    v_lshlrev_b32 v128, 16, v44
    v_and_b32 v129, 0xffff0000, v44
    v_dot2c_f32_bf16 v204, v44, v8
    v_lshlrev_b32 v94, 16, v33
    v_and_b32 v95, 0xffff0000, v33
    v_lshlrev_b32 v130, 16, v45
    v_and_b32 v131, 0xffff0000, v45
    v_dot2c_f32_bf16 v204, v45, v8
    v_lshlrev_b32 v96, 16, v34
    v_and_b32 v97, 0xffff0000, v34
    v_lshlrev_b32 v132, 16, v46
    v_and_b32 v133, 0xffff0000, v46
    v_dot2c_f32_bf16 v204, v46, v8
    v_lshlrev_b32 v98, 16, v35
    v_and_b32 v99, 0xffff0000, v35
    v_lshlrev_b32 v134, 16, v47
    v_and_b32 v135, 0xffff0000, v47
    v_dot2c_f32_bf16 v204, v47, v8
    v_lshlrev_b32 v100, 16, v36
    v_and_b32 v101, 0xffff0000, v36
    v_lshlrev_b32 v136, 16, v48
    v_and_b32 v137, 0xffff0000, v48
    v_dot2c_f32_bf16 v204, v48, v8
    s_waitcnt lgkmcnt(0)
    v_and_b32 v72, v9, v72
    v_and_b32 v73, v9, v73
    v_and_b32 v74, v9, v74
    v_and_b32 v75, v9, v75
    v_and_b32 v76, v9, v76
    v_and_b32 v77, v9, v77
    v_and_b32 v78, v9, v78
    v_and_b32 v79, v9, v79
    v_and_b32 v80, v9, v80
    v_fma_mix_f32 v84, v72, v84, 0 op_sel:[0,0,0] op_sel_hi:[1,0,0]
    v_fma_mix_f32 v85, v72, v85, 0 op_sel:[1,0,0] op_sel_hi:[1,0,0]
    v_fma_mix_f32 v86, v73, v86, 0 op_sel:[0,0,0] op_sel_hi:[1,0,0]
    v_add_f32_dpp v204, v204, v204 row_ror:8 row_mask:0xf bank_mask:0xf
    v_fma_mix_f32 v87, v73, v87, 0 op_sel:[1,0,0] op_sel_hi:[1,0,0]
    v_fma_mix_f32 v88, v74, v88, 0 op_sel:[0,0,0] op_sel_hi:[1,0,0]
    v_fma_mix_f32 v89, v74, v89, 0 op_sel:[1,0,0] op_sel_hi:[1,0,0]
    v_fma_mix_f32 v90, v75, v90, 0 op_sel:[0,0,0] op_sel_hi:[1,0,0]
    v_fma_mix_f32 v91, v75, v91, 0 op_sel:[1,0,0] op_sel_hi:[1,0,0]
    v_add_f32_dpp v204, v204, v204 row_ror:4 row_mask:0xf bank_mask:0xf
    v_fma_mix_f32 v92, v76, v92, 0 op_sel:[0,0,0] op_sel_hi:[1,0,0]
    v_fma_mix_f32 v93, v76, v93, 0 op_sel:[1,0,0] op_sel_hi:[1,0,0]
    v_fma_mix_f32 v94, v77, v94, 0 op_sel:[0,0,0] op_sel_hi:[1,0,0]
    v_fma_mix_f32 v95, v77, v95, 0 op_sel:[1,0,0] op_sel_hi:[1,0,0]
    v_fma_mix_f32 v96, v78, v96, 0 op_sel:[0,0,0] op_sel_hi:[1,0,0]
    v_add_f32_dpp v204, v204, v204 row_ror:2 row_mask:0xf bank_mask:0xf
    v_fma_mix_f32 v97, v78, v97, 0 op_sel:[1,0,0] op_sel_hi:[1,0,0]
    v_fma_mix_f32 v98, v79, v98, 0 op_sel:[0,0,0] op_sel_hi:[1,0,0]
    v_fma_mix_f32 v99, v79, v99, 0 op_sel:[1,0,0] op_sel_hi:[1,0,0]
    v_fma_mix_f32 v100, v80, v100, 0 op_sel:[0,0,0] op_sel_hi:[1,0,0]
    v_fma_mix_f32 v101, v80, v101, 0 op_sel:[1,0,0] op_sel_hi:[1,0,0]
    v_add_f32_dpp v204, v204, v204 row_ror:1 row_mask:0xf bank_mask:0xf
    v_cvt_pk_bf16_f32 v84, 0, v84
    v_cvt_pk_bf16_f32 v85, 0, v85
    v_cvt_pk_bf16_f32 v86, 0, v86
    v_cvt_pk_bf16_f32 v87, 0, v87
    v_cvt_pk_bf16_f32 v88, 0, v88
    v_mov_b32 v37, v204
    v_cvt_pk_bf16_f32 v89, 0, v89
    v_cvt_pk_bf16_f32 v90, 0, v90
    v_cvt_pk_bf16_f32 v91, 0, v91
    v_cvt_pk_bf16_f32 v92, 0, v92
    v_cvt_pk_bf16_f32 v93, 0, v93
    v_permlane16_swap_b32 v204, v37
    v_cvt_pk_bf16_f32 v94, 0, v94
    v_cvt_pk_bf16_f32 v95, 0, v95
    v_cvt_pk_bf16_f32 v96, 0, v96
    v_cvt_pk_bf16_f32 v97, 0, v97
    v_cvt_pk_bf16_f32 v98, 0, v98
    v_add_f32 v204, v204, v37
    v_cvt_pk_bf16_f32 v99, 0, v99
    v_cvt_pk_bf16_f32 v100, 0, v100
    v_cvt_pk_bf16_f32 v101, 0, v101
    v_dot2_f32_bf16 v102, v16, v6, v84
    v_dot2_f32_bf16 v103, v16, v7, v85
    v_dot2_f32_bf16 v104, v17, v6, v86
    v_dot2_f32_bf16 v105, v17, v7, v87
    v_dot2_f32_bf16 v106, v18, v6, v88
    v_dot2_f32_bf16 v107, v18, v7, v89
    v_dot2_f32_bf16 v108, v19, v6, v90
    v_dot2_f32_bf16 v109, v19, v7, v91
    v_dot2_f32_bf16 v110, v20, v6, v92
    v_dot2_f32_bf16 v111, v20, v7, v93
    v_dot2_f32_bf16 v112, v21, v6, v94
    v_dot2_f32_bf16 v113, v21, v7, v95
    v_dot2_f32_bf16 v114, v22, v6, v96
    v_dot2_f32_bf16 v115, v22, v7, v97
    v_dot2_f32_bf16 v116, v23, v6, v98
    v_dot2_f32_bf16 v117, v23, v7, v99
    v_dot2_f32_bf16 v118, v24, v6, v100
    v_dot2_f32_bf16 v119, v24, v7, v101
    s_and_b32 s48, s40, 0x7fffff
    v_mov_b32 v36, s48
    s_mov_b32 s47, 0
PL4:
    s_waitcnt vmcnt(0)
    v_xor_b32 v52, v36, v52
    v_xor_b32 v53, v36, v53
    v_xor_b32 v54, v36, v54
    v_xor_b32 v55, v36, v55
    v_xor_b32 v56, v36, v56
    v_xor_b32 v57, v36, v57
    v_xor_b32 v58, v36, v58
    v_xor_b32 v59, v36, v59
    v_xor_b32 v60, v36, v60
    v_xor_b32 v61, v36, v61
    v_xor_b32 v62, v36, v62
    v_xor_b32 v63, v36, v63
    v_xor_b32 v64, v36, v64
    v_xor_b32 v65, v36, v65
    v_xor_b32 v66, v36, v66
    v_xor_b32 v67, v36, v67
    v_xor_b32 v68, v36, v68
    v_xor_b32 v69, v36, v69
    v_or_b32 v37, v52, v53
    v_or3_b32 v37, v37, v54, v55
    v_or3_b32 v37, v37, v56, v57
    v_or3_b32 v37, v37, v58, v59
    v_or3_b32 v37, v37, v60, v61
    v_or3_b32 v37, v37, v62, v63
    v_or3_b32 v37, v37, v64, v65
    v_or3_b32 v37, v37, v66, v67
    v_or3_b32 v37, v37, v68, v69
    v_and_b32 v37, 0x7fffff, v37
    v_cmp_ne_u32 vcc, 0, v37
    s_cbranch_vccz PD5
    s_sleep 4
    s_mov_b32 s46, 8192
    buffer_load_dwordx4 v[52:55], v38, s[32:35], s46 offen offset:0 sc1
    buffer_load_dwordx4 v[56:59], v38, s[32:35], s46 offen offset:16 sc1
    buffer_load_dwordx4 v[60:63], v38, s[32:35], s46 offen offset:1024 sc1
    buffer_load_dwordx4 v[64:67], v38, s[32:35], s46 offen offset:1040 sc1
    buffer_load_dwordx2 v[68:69], v39, s[32:35], s46 offen offset:2048 sc1
    s_add_u32 s47, s47, 1
    s_cmp_lt_u32 s47, 65536
    s_cbranch_scc1 PL4
    s_waitcnt vmcnt(0)
    v_xor_b32 v52, v36, v52
    v_xor_b32 v53, v36, v53
    v_xor_b32 v54, v36, v54
    v_xor_b32 v55, v36, v55
    v_xor_b32 v56, v36, v56
    v_xor_b32 v57, v36, v57
    v_xor_b32 v58, v36, v58
    v_xor_b32 v59, v36, v59
    v_xor_b32 v60, v36, v60
    v_xor_b32 v61, v36, v61
    v_xor_b32 v62, v36, v62
    v_xor_b32 v63, v36, v63
    v_xor_b32 v64, v36, v64
    v_xor_b32 v65, v36, v65
    v_xor_b32 v66, v36, v66
    v_xor_b32 v67, v36, v67
    v_xor_b32 v68, v36, v68
    v_xor_b32 v69, v36, v69
    v_or_b32 v37, v52, v53
    v_or3_b32 v37, v37, v54, v55
    v_or3_b32 v37, v37, v56, v57
    v_or3_b32 v37, v37, v58, v59
    v_or3_b32 v37, v37, v60, v61
    v_or3_b32 v37, v37, v62, v63
    v_or3_b32 v37, v37, v64, v65
    v_or3_b32 v37, v37, v66, v67
    v_or3_b32 v37, v37, v68, v69
    v_and_b32 v37, 0x7fffff, v37
    v_cmp_ne_u32 vcc, 0, v37
PD5:
    v_and_b32 v36, 7, v0
    v_mul_u32_u24 v36, 2320, v36
    v_lshrrev_b32 v37, 3, v0
    v_lshl_add_u32 v36, v37, 4, v36
    v_lshrrev_b32 v37, 5, v1
    s_mul_i32 s46, s3, 2320
    s_add_u32 s46, s46, 40960
    v_lshl_add_u32 v37, v37, 3, s46
    v_lshl_add_u32 v38, v12, 1, v37
    v_bfe_u32 v39, v1, 1, 4
    v_lshl_add_u32 v39, v39, 4, v37
    v_and_b32 v37, 1, v1
    v_lshl_add_u32 v39, v37, 2, v39
    s_cmp_ge_u32 s3, 2
    s_cbranch_scc1 RP_2
    buffer_load_dwordx4 v[140:143], v3, s[32:35], s60 offen sc1
    buffer_load_dwordx4 v[144:147], v3, s[32:35], s61 offen sc1
    buffer_load_dwordx4 v[148:151], v3, s[32:35], s62 offen sc1
    s_mov_b32 s47, 0
PL7:
    s_waitcnt vmcnt(0)
    v_xor_b32 v140, v10, v140
    v_xor_b32 v141, v10, v141
    v_xor_b32 v142, v10, v142
    v_xor_b32 v143, v10, v143
    v_xor_b32 v144, v10, v144
    v_xor_b32 v145, v10, v145
    v_xor_b32 v146, v10, v146
    v_xor_b32 v147, v10, v147
    v_xor_b32 v148, v10, v148
    v_xor_b32 v149, v10, v149
    v_xor_b32 v150, v10, v150
    v_xor_b32 v151, v10, v151
    v_or3_b32 v37, v140, v141, v142
    v_or3_b32 v37, v37, v143, v144
    v_or3_b32 v37, v37, v145, v146
    v_or3_b32 v37, v37, v147, v148
    v_or3_b32 v37, v37, v149, v150
    v_or_b32 v37, v37, v151
    v_and_b32 v37, 0x70007, v37
    v_cmp_ne_u32 vcc, 0, v37
    s_cbranch_vccz PD8
    s_sleep 2
    buffer_load_dwordx4 v[140:143], v3, s[32:35], s60 offen sc1
    buffer_load_dwordx4 v[144:147], v3, s[32:35], s61 offen sc1
    buffer_load_dwordx4 v[148:151], v3, s[32:35], s62 offen sc1
    s_add_u32 s47, s47, 1
    s_cmp_lt_u32 s47, 65536
    s_cbranch_scc1 PL7
    s_waitcnt vmcnt(0)
    v_xor_b32 v140, v10, v140
    v_xor_b32 v141, v10, v141
    v_xor_b32 v142, v10, v142
    v_xor_b32 v143, v10, v143
    v_xor_b32 v144, v10, v144
    v_xor_b32 v145, v10, v145
    v_xor_b32 v146, v10, v146
    v_xor_b32 v147, v10, v147
    v_xor_b32 v148, v10, v148
    v_xor_b32 v149, v10, v149
    v_xor_b32 v150, v10, v150
    v_xor_b32 v151, v10, v151
    v_or3_b32 v37, v140, v141, v142
    v_or3_b32 v37, v37, v143, v144
    v_or3_b32 v37, v37, v145, v146
    v_or3_b32 v37, v37, v147, v148
    v_or3_b32 v37, v37, v149, v150
    v_or_b32 v37, v37, v151
    v_and_b32 v37, 0x70007, v37
    v_cmp_ne_u32 vcc, 0, v37
PD8:
    ds_write_b128 v36, v[148:151] offset:43008
    s_branch RP_3
RP_2:
    buffer_load_dwordx4 v[140:143], v3, s[32:35], s60 offen sc1
    buffer_load_dwordx4 v[144:147], v3, s[32:35], s61 offen sc1
    s_mov_b32 s47, 0
PL10:
    s_waitcnt vmcnt(0)
    v_xor_b32 v140, v10, v140
    v_xor_b32 v141, v10, v141
    v_xor_b32 v142, v10, v142
    v_xor_b32 v143, v10, v143
    v_xor_b32 v144, v10, v144
    v_xor_b32 v145, v10, v145
    v_xor_b32 v146, v10, v146
    v_xor_b32 v147, v10, v147
    v_or3_b32 v37, v140, v141, v142
    v_or3_b32 v37, v37, v143, v144
    v_or3_b32 v37, v37, v145, v146
    v_or_b32 v37, v37, v147
    v_and_b32 v37, 0x70007, v37
    v_cmp_ne_u32 vcc, 0, v37
    s_cbranch_vccz PD11
    s_sleep 2
    buffer_load_dwordx4 v[140:143], v3, s[32:35], s60 offen sc1
    buffer_load_dwordx4 v[144:147], v3, s[32:35], s61 offen sc1
    s_add_u32 s47, s47, 1
    s_cmp_lt_u32 s47, 65536
    s_cbranch_scc1 PL10
    s_waitcnt vmcnt(0)
    v_xor_b32 v140, v10, v140
    v_xor_b32 v141, v10, v141
    v_xor_b32 v142, v10, v142
    v_xor_b32 v143, v10, v143
    v_xor_b32 v144, v10, v144
    v_xor_b32 v145, v10, v145
    v_xor_b32 v146, v10, v146
    v_xor_b32 v147, v10, v147
    v_or3_b32 v37, v140, v141, v142
    v_or3_b32 v37, v37, v143, v144
    v_or3_b32 v37, v37, v145, v146
    v_or_b32 v37, v37, v147
    v_and_b32 v37, 0x70007, v37
    v_cmp_ne_u32 vcc, 0, v37
PD11:
RP_3:
    ds_write_b128 v36, v[140:143] offset:40960
    ds_write_b128 v36, v[144:147] offset:41984
    s_waitcnt lgkmcnt(0)
    s_barrier
    ds_read2_b64 v[152:155], v38 offset0:0 offset1:2
    ds_read2_b64 v[156:159], v38 offset0:128 offset1:130
    ds_read_b32 v160, v39 offset:2048
    v_lshrrev_b32 v36, 5, v1
    v_lshlrev_b32 v36, 5, v36
    s_lshl_b32 s46, s3, 2
    s_add_u32 s46, s46, 147712
    v_add_u32 v36, s46, v36
    s_and_b32 s63, s40, 0xffff
    s_waitcnt lgkmcnt(2)
    v_fma_mix_f32 v162, v152, v52, v102 op_sel:[0,0,0] op_sel_hi:[1,0,0]
    v_fma_mix_f32 v163, v152, v53, v103 op_sel:[1,0,0] op_sel_hi:[1,0,0]
    v_fma_mix_f32 v164, v153, v54, v104 op_sel:[0,0,0] op_sel_hi:[1,0,0]
    v_fma_mix_f32 v165, v153, v55, v105 op_sel:[1,0,0] op_sel_hi:[1,0,0]
    v_pk_mul_f32 v[30:31], v[162:163], v[162:163]
    v_pk_mul_f32 v[32:33], v[162:163], v[120:121]
    v_fma_mix_f32 v166, v154, v56, v106 op_sel:[0,0,0] op_sel_hi:[1,0,0]
    v_fma_mix_f32 v167, v154, v57, v107 op_sel:[1,0,0] op_sel_hi:[1,0,0]
    v_pk_add_f32 v[28:29], v[162:163], v[164:165]
    v_pk_fma_f32 v[30:31], v[164:165], v[164:165], v[30:31]
    v_pk_fma_f32 v[32:33], v[164:165], v[122:123], v[32:33]
    v_fma_mix_f32 v168, v155, v58, v108 op_sel:[0,0,0] op_sel_hi:[1,0,0]
    v_fma_mix_f32 v169, v155, v59, v109 op_sel:[1,0,0] op_sel_hi:[1,0,0]
    v_pk_add_f32 v[28:29], v[28:29], v[166:167]
    v_pk_fma_f32 v[30:31], v[166:167], v[166:167], v[30:31]
    v_pk_fma_f32 v[32:33], v[166:167], v[124:125], v[32:33]
    s_waitcnt lgkmcnt(1)
    v_fma_mix_f32 v170, v156, v60, v110 op_sel:[0,0,0] op_sel_hi:[1,0,0]
    v_fma_mix_f32 v171, v156, v61, v111 op_sel:[1,0,0] op_sel_hi:[1,0,0]
    v_pk_add_f32 v[28:29], v[28:29], v[168:169]
    v_pk_fma_f32 v[30:31], v[168:169], v[168:169], v[30:31]
    v_pk_fma_f32 v[32:33], v[168:169], v[126:127], v[32:33]
    v_fma_mix_f32 v172, v157, v62, v112 op_sel:[0,0,0] op_sel_hi:[1,0,0]
    v_fma_mix_f32 v173, v157, v63, v113 op_sel:[1,0,0] op_sel_hi:[1,0,0]
    v_pk_add_f32 v[28:29], v[28:29], v[170:171]
    v_pk_fma_f32 v[30:31], v[170:171], v[170:171], v[30:31]
    v_pk_fma_f32 v[32:33], v[170:171], v[128:129], v[32:33]
    v_fma_mix_f32 v174, v158, v64, v114 op_sel:[0,0,0] op_sel_hi:[1,0,0]
    v_fma_mix_f32 v175, v158, v65, v115 op_sel:[1,0,0] op_sel_hi:[1,0,0]
    v_pk_add_f32 v[28:29], v[28:29], v[172:173]
    v_pk_fma_f32 v[30:31], v[172:173], v[172:173], v[30:31]
    v_pk_fma_f32 v[32:33], v[172:173], v[130:131], v[32:33]
    v_fma_mix_f32 v176, v159, v66, v116 op_sel:[0,0,0] op_sel_hi:[1,0,0]
    v_fma_mix_f32 v177, v159, v67, v117 op_sel:[1,0,0] op_sel_hi:[1,0,0]
    v_pk_add_f32 v[28:29], v[28:29], v[174:175]
    v_pk_fma_f32 v[30:31], v[174:175], v[174:175], v[30:31]
    v_pk_fma_f32 v[32:33], v[174:175], v[132:133], v[32:33]
    s_waitcnt lgkmcnt(0)
    v_fma_mix_f32 v178, v160, v68, v118 op_sel:[0,0,0] op_sel_hi:[1,0,0]
    v_fma_mix_f32 v179, v160, v69, v119 op_sel:[1,0,0] op_sel_hi:[1,0,0]
    v_pk_add_f32 v[28:29], v[28:29], v[176:177]
    v_pk_fma_f32 v[30:31], v[176:177], v[176:177], v[30:31]
    v_pk_fma_f32 v[32:33], v[176:177], v[134:135], v[32:33]
    v_pk_add_f32 v[28:29], v[28:29], v[178:179]
    v_pk_fma_f32 v[30:31], v[178:179], v[178:179], v[30:31]
    v_pk_fma_f32 v[32:33], v[178:179], v[136:137], v[32:33]
    v_add_f32 v28, v28, v29
    v_add_f32 v30, v30, v31
    v_add_f32 v32, v32, v33
    s_nop 0
    v_permlane16_swap_b32 v28, v30
    v_add_f32 v28, v28, v30
    v_add_f32_dpp v32, v32, v32 row_ror:8 row_mask:0xf bank_mask:0xf
    s_nop 0
    v_add_f32_dpp v28, v28, v28 row_ror:8 row_mask:0xf bank_mask:0xf
    v_add_f32_dpp v32, v32, v32 row_ror:4 row_mask:0xf bank_mask:0xf
    s_nop 0
    v_add_f32_dpp v28, v28, v28 row_ror:4 row_mask:0xf bank_mask:0xf
    v_add_f32_dpp v32, v32, v32 row_ror:2 row_mask:0xf bank_mask:0xf
    s_nop 0
    v_add_f32_dpp v28, v28, v28 row_ror:2 row_mask:0xf bank_mask:0xf
    v_add_f32_dpp v32, v32, v32 row_ror:1 row_mask:0xf bank_mask:0xf
    s_nop 0
    v_add_f32_dpp v28, v28, v28 row_ror:1 row_mask:0xf bank_mask:0xf
    v_mov_b32 v33, v32
    v_mov_b32 v30, v28
    s_nop 1
    v_permlane16_swap_b32 v28, v30
    v_permlane16_swap_b32 v32, v33
    v_add_f32 v32, v32, v33
    v_mul_f32 v28, 0x3ae38e39, v28
    v_mul_f32 v30, 0x3ae38e39, v30
    v_fma_f32 v30, -v28, v28, v30
    v_cvt_pk_bf16_f32 v200, 0, v28
    v_max_f32 v30, 0, v30
    v_cvt_pk_bf16_f32 v30, 0, v30
    v_add_f32 v30, 0x3727c5ac, v30
    v_cvt_pk_bf16_f32 v30, 0, v30
    v_sqrt_f32 v30, v30
    s_nop 0
    v_cvt_pk_bf16_f32 v30, 0, v30
    v_rcp_f32 v202, v30
    v_fma_f32 v32, -v200, v204, v32
    v_mul_f32 v32, v32, v202
    v_cvt_pk_bf16_f32 v216, 0, v32
    v_ashrrev_i32 v28, 31, v216
    v_and_b32 v28, 0x7fff0000, v28
    v_xor_b32 v28, v28, v216
    s_or_b32 s46, s63, 0x80000000
    v_xor_b32 v28, s46, v28
    s_mov_b32 exec_lo, 1
    s_mov_b32 exec_hi, 1
    ds_write_b32 v36, v28
    s_mov_b64 exec, -1
    v_and_b32 v37, 15, v1
    v_lshlrev_b32 v36, 2, v37
    v_add_u32 v36, 147712, v36
    v_add_u32 v14, 147712, v2
    s_lshl_b32 s46, s2, 7
    s_add_u32 s46, s46, 16384
    s_waitcnt lgkmcnt(0)
    s_barrier
    s_cmp_lg_u32 s3, 0
    s_cbranch_scc1 L2_NOKEY
    s_mov_b64 exec, 0xf
    ds_read_b128 v[28:31], v14
    s_waitcnt lgkmcnt(0)
    buffer_store_dwordx4 v[28:31], v2, s[32:35], s46 offen sc1
    s_mov_b64 exec, -1
L2_NOKEY:
    ds_read_b32 v205, v36
    v_fma_mix_f32 v162, v152, v52, v84 op_sel:[0,0,0] op_sel_hi:[1,0,0]
    v_fma_mix_f32 v163, v152, v53, v85 op_sel:[1,0,0] op_sel_hi:[1,0,0]
    v_fma_mix_f32 v164, v153, v54, v86 op_sel:[0,0,0] op_sel_hi:[1,0,0]
    v_fma_mix_f32 v165, v153, v55, v87 op_sel:[1,0,0] op_sel_hi:[1,0,0]
    v_fma_mix_f32 v166, v154, v56, v88 op_sel:[0,0,0] op_sel_hi:[1,0,0]
    v_fma_mix_f32 v167, v154, v57, v89 op_sel:[1,0,0] op_sel_hi:[1,0,0]
    v_fma_mix_f32 v168, v155, v58, v90 op_sel:[0,0,0] op_sel_hi:[1,0,0]
    v_fma_mix_f32 v169, v155, v59, v91 op_sel:[1,0,0] op_sel_hi:[1,0,0]
    v_fma_mix_f32 v170, v156, v60, v92 op_sel:[0,0,0] op_sel_hi:[1,0,0]
    v_fma_mix_f32 v171, v156, v61, v93 op_sel:[1,0,0] op_sel_hi:[1,0,0]
    v_fma_mix_f32 v172, v157, v62, v94 op_sel:[0,0,0] op_sel_hi:[1,0,0]
    v_fma_mix_f32 v173, v157, v63, v95 op_sel:[1,0,0] op_sel_hi:[1,0,0]
    v_fma_mix_f32 v174, v158, v64, v96 op_sel:[0,0,0] op_sel_hi:[1,0,0]
    v_fma_mix_f32 v175, v158, v65, v97 op_sel:[1,0,0] op_sel_hi:[1,0,0]
    v_fma_mix_f32 v176, v159, v66, v98 op_sel:[0,0,0] op_sel_hi:[1,0,0]
    v_fma_mix_f32 v177, v159, v67, v99 op_sel:[1,0,0] op_sel_hi:[1,0,0]
    v_fma_mix_f32 v178, v160, v68, v100 op_sel:[0,0,0] op_sel_hi:[1,0,0]
    v_fma_mix_f32 v179, v160, v69, v101 op_sel:[1,0,0] op_sel_hi:[1,0,0]
    v_cvt_pk_bf16_f32 v162, 0, v162
    v_cvt_pk_bf16_f32 v163, 0, v163
    v_cvt_pk_bf16_f32 v164, 0, v164
    v_cvt_pk_bf16_f32 v165, 0, v165
    v_cvt_pk_bf16_f32 v166, 0, v166
    v_cvt_pk_bf16_f32 v167, 0, v167
    v_cvt_pk_bf16_f32 v168, 0, v168
    v_cvt_pk_bf16_f32 v169, 0, v169
    v_cvt_pk_bf16_f32 v170, 0, v170
    v_cvt_pk_bf16_f32 v171, 0, v171
    v_cvt_pk_bf16_f32 v172, 0, v172
    v_cvt_pk_bf16_f32 v173, 0, v173
    v_cvt_pk_bf16_f32 v174, 0, v174
    v_cvt_pk_bf16_f32 v175, 0, v175
    v_cvt_pk_bf16_f32 v176, 0, v176
    v_cvt_pk_bf16_f32 v177, 0, v177
    v_cvt_pk_bf16_f32 v178, 0, v178
    v_cvt_pk_bf16_f32 v179, 0, v179
    v_dot2_f32_bf16 v162, v16, v6, v162
    v_dot2_f32_bf16 v163, v16, v7, v163
    v_dot2_f32_bf16 v164, v17, v6, v164
    v_dot2_f32_bf16 v165, v17, v7, v165
    v_dot2_f32_bf16 v166, v18, v6, v166
    v_dot2_f32_bf16 v167, v18, v7, v167
    v_dot2_f32_bf16 v168, v19, v6, v168
    v_dot2_f32_bf16 v169, v19, v7, v169
    v_dot2_f32_bf16 v170, v20, v6, v170
    v_dot2_f32_bf16 v171, v20, v7, v171
    v_dot2_f32_bf16 v172, v21, v6, v172
    v_dot2_f32_bf16 v173, v21, v7, v173
    v_dot2_f32_bf16 v174, v22, v6, v174
    v_dot2_f32_bf16 v175, v22, v7, v175
    v_dot2_f32_bf16 v176, v23, v6, v176
    v_dot2_f32_bf16 v177, v23, v7, v177
    v_dot2_f32_bf16 v178, v24, v6, v178
    v_dot2_f32_bf16 v179, v24, v7, v179
    s_lshl_b32 s46, s2, 4
    s_sub_u32 s46, 0xffff, s46
    v_sub_u32 v37, s46, v37
    s_waitcnt lgkmcnt(0)
    v_and_b32 v205, 0xffff0000, v205
    v_or_b32 v205, v205, v37
    v_cvt_pk_bf16_f32 v162, 0, v162
    v_mov_b32 v206, v205
    v_cvt_pk_bf16_f32 v163, 0, v163
    v_cvt_pk_bf16_f32 v164, 0, v164
    v_cvt_pk_bf16_f32 v165, 0, v165
    v_max_u32_dpp v206, v206, v206 row_ror:8 row_mask:0xf bank_mask:0xf
    v_cvt_pk_bf16_f32 v166, 0, v166
    v_cvt_pk_bf16_f32 v167, 0, v167
    v_cvt_pk_bf16_f32 v168, 0, v168
    v_max_u32_dpp v206, v206, v206 row_ror:4 row_mask:0xf bank_mask:0xf
    v_cvt_pk_bf16_f32 v169, 0, v169
    v_cvt_pk_bf16_f32 v170, 0, v170
    v_cvt_pk_bf16_f32 v171, 0, v171
    v_max_u32_dpp v206, v206, v206 row_ror:2 row_mask:0xf bank_mask:0xf
    v_cvt_pk_bf16_f32 v172, 0, v172
    v_cvt_pk_bf16_f32 v173, 0, v173
    v_cvt_pk_bf16_f32 v174, 0, v174
    v_max_u32_dpp v206, v206, v206 row_ror:1 row_mask:0xf bank_mask:0xf
    v_cvt_pk_bf16_f32 v175, 0, v175
    v_cvt_pk_bf16_f32 v176, 0, v176
    v_readfirstlane_b32 s56, v206
    v_cvt_pk_bf16_f32 v177, 0, v177
    v_cvt_pk_bf16_f32 v178, 0, v178
    v_cvt_pk_bf16_f32 v179, 0, v179
    v_cmp_ne_u32 vcc, v206, v205
    v_pk_add_f32 v[102:103], v[162:163], v[200:201] op_sel_hi:[1,0] neg_lo:[0,1] neg_hi:[0,1]
    v_pk_add_f32 v[104:105], v[164:165], v[200:201] op_sel_hi:[1,0] neg_lo:[0,1] neg_hi:[0,1]
    v_pk_add_f32 v[106:107], v[166:167], v[200:201] op_sel_hi:[1,0] neg_lo:[0,1] neg_hi:[0,1]
    v_cndmask_b32 v205, 0, v205, vcc
    v_pk_add_f32 v[108:109], v[168:169], v[200:201] op_sel_hi:[1,0] neg_lo:[0,1] neg_hi:[0,1]
    v_pk_add_f32 v[110:111], v[170:171], v[200:201] op_sel_hi:[1,0] neg_lo:[0,1] neg_hi:[0,1]
    v_pk_add_f32 v[112:113], v[172:173], v[200:201] op_sel_hi:[1,0] neg_lo:[0,1] neg_hi:[0,1]
    v_mov_b32 v206, v205
    v_pk_add_f32 v[114:115], v[174:175], v[200:201] op_sel_hi:[1,0] neg_lo:[0,1] neg_hi:[0,1]
    v_pk_add_f32 v[116:117], v[176:177], v[200:201] op_sel_hi:[1,0] neg_lo:[0,1] neg_hi:[0,1]
    v_pk_add_f32 v[118:119], v[178:179], v[200:201] op_sel_hi:[1,0] neg_lo:[0,1] neg_hi:[0,1]
    v_max_u32_dpp v206, v206, v206 row_ror:8 row_mask:0xf bank_mask:0xf
    v_cvt_pk_bf16_f32 v102, 0, v102
    v_cvt_pk_bf16_f32 v103, 0, v103
    v_cvt_pk_bf16_f32 v104, 0, v104
    v_max_u32_dpp v206, v206, v206 row_ror:4 row_mask:0xf bank_mask:0xf
    v_cvt_pk_bf16_f32 v105, 0, v105
    v_cvt_pk_bf16_f32 v106, 0, v106
    v_max_u32_dpp v206, v206, v206 row_ror:2 row_mask:0xf bank_mask:0xf
    v_cvt_pk_bf16_f32 v107, 0, v107
    v_cvt_pk_bf16_f32 v108, 0, v108
    v_cvt_pk_bf16_f32 v109, 0, v109
    v_max_u32_dpp v206, v206, v206 row_ror:1 row_mask:0xf bank_mask:0xf
    v_cvt_pk_bf16_f32 v110, 0, v110
    v_cvt_pk_bf16_f32 v111, 0, v111
    v_cvt_pk_bf16_f32 v112, 0, v112
    v_readfirstlane_b32 s57, v206
    v_cvt_pk_bf16_f32 v113, 0, v113
    v_cvt_pk_bf16_f32 v114, 0, v114
    v_cvt_pk_bf16_f32 v115, 0, v115
    v_cmp_ne_u32 vcc, v206, v205
    v_cvt_pk_bf16_f32 v116, 0, v116
    v_cvt_pk_bf16_f32 v117, 0, v117
    v_cvt_pk_bf16_f32 v118, 0, v118
    v_cndmask_b32 v205, 0, v205, vcc
    v_cvt_pk_bf16_f32 v119, 0, v119
    v_lshrrev_b32 v14, 2, v0
    v_and_b32 v15, 3, v0
    v_lshlrev_b32 v15, 4, v15
    v_lshl_add_u32 v14, v14, 7, v15
    s_mov_b32 s60, 16384
    buffer_load_dwordx4 v[208:211], v14, s[32:35], s60 offen sc1
    v_pk_mul_f32 v[102:103], v[102:103], v[202:203] op_sel_hi:[1,0]
    v_pk_mul_f32 v[104:105], v[104:105], v[202:203] op_sel_hi:[1,0]
    v_pk_mul_f32 v[106:107], v[106:107], v[202:203] op_sel_hi:[1,0]
    v_pk_mul_f32 v[108:109], v[108:109], v[202:203] op_sel_hi:[1,0]
    v_pk_mul_f32 v[110:111], v[110:111], v[202:203] op_sel_hi:[1,0]
    v_pk_mul_f32 v[112:113], v[112:113], v[202:203] op_sel_hi:[1,0]
    v_pk_mul_f32 v[114:115], v[114:115], v[202:203] op_sel_hi:[1,0]
    v_pk_mul_f32 v[116:117], v[116:117], v[202:203] op_sel_hi:[1,0]
    v_pk_mul_f32 v[118:119], v[118:119], v[202:203] op_sel_hi:[1,0]
    v_cvt_pk_bf16_f32 v180, v102, v103
    v_cvt_pk_bf16_f32 v181, v104, v105
    v_cvt_pk_bf16_f32 v182, v106, v107
    v_cvt_pk_bf16_f32 v184, v108, v109
    v_cvt_pk_bf16_f32 v185, v110, v111
    v_cvt_pk_bf16_f32 v186, v112, v113
    v_cvt_pk_bf16_f32 v188, v114, v115
    v_cvt_pk_bf16_f32 v189, v116, v117
    v_cvt_pk_bf16_f32 v190, v118, v119
    v_mov_b32 v183, s40
    v_mov_b32 v187, s40
    v_mov_b32 v191, s40
    v_lshlrev_b32 v15, 2, v0
    v_sub_u32 v212, 0xffff, v15
    v_subrev_u32 v213, 1, v212
    v_subrev_u32 v214, 2, v212
    v_subrev_u32 v215, 3, v212
    v_mov_b32 v36, s63
    v_mov_b32 v15, 147776
    s_mov_b64 s[58:59], -1
    s_mov_b32 s47, 0
PL13:
    s_waitcnt vmcnt(0)
    v_xor_b32 v208, v36, v208
    v_xor_b32 v209, v36, v209
    v_xor_b32 v210, v36, v210
    v_xor_b32 v211, v36, v211
    v_or3_b32 v37, v208, v209, v210
    v_or_b32 v37, v37, v211
    v_and_b32 v37, 0xffff, v37
    v_cmp_ne_u32 vcc, 0, v37
    s_cbranch_vccz PD14
    s_sleep 2
    buffer_load_dwordx4 v[208:211], v14, s[32:35], s60 offen sc1
    s_add_u32 s47, s47, 1
    s_cmp_lt_u32 s47, 65536
    s_cbranch_scc1 PL13
    s_waitcnt vmcnt(0)
    v_xor_b32 v208, v36, v208
    v_xor_b32 v209, v36, v209
    v_xor_b32 v210, v36, v210
    v_xor_b32 v211, v36, v211
    v_or3_b32 v37, v208, v209, v210
    v_or_b32 v37, v37, v211
    v_and_b32 v37, 0xffff, v37
    v_cmp_ne_u32 vcc, 0, v37
PD14:
    v_or_b32 v208, v208, v212
    v_or_b32 v209, v209, v213
    v_or_b32 v210, v210, v214
    v_or_b32 v211, v211, v215
RK_LOOP:
    v_cmp_lt_u32 s[4:5], s56, v208
    v_cmp_lt_u32 s[6:7], s56, v209
    v_cmp_lt_u32 s[8:9], s56, v210
    v_cmp_lt_u32 s[10:11], s56, v211
    s_bcnt1_i32_b64 s4, s[4:5]
    s_bcnt1_i32_b64 s6, s[6:7]
    s_bcnt1_i32_b64 s8, s[8:9]
    s_bcnt1_i32_b64 s10, s[10:11]
    s_add_u32 s4, s4, s6
    s_add_u32 s8, s8, s10
    s_add_u32 s46, s4, s8
    v_cmp_lt_u32 s[12:13], s57, v208
    v_cmp_lt_u32 s[14:15], s57, v209
    v_cmp_lt_u32 s[16:17], s57, v210
    v_cmp_lt_u32 s[18:19], s57, v211
    s_bcnt1_i32_b64 s12, s[12:13]
    s_bcnt1_i32_b64 s14, s[14:15]
    s_bcnt1_i32_b64 s16, s[16:17]
    s_bcnt1_i32_b64 s18, s[18:19]
    s_add_u32 s12, s12, s14
    s_add_u32 s16, s16, s18
    s_add_u32 s48, s12, s16
    s_lshl_b32 s48, s48, 16
    s_add_u32 s46, s46, s48
    v_mov_b32 v37, s46
    s_mov_b64 exec, 1
    ds_add_u32 v15, v37
    s_mov_b64 exec, -1
    s_waitcnt lgkmcnt(0)
    s_barrier
    ds_read_b32 v37, v15
    v_add_u32 v15, 4, v15
    s_waitcnt lgkmcnt(0)
    v_readfirstlane_b32 s53, v37
    s_and_b32 s54, s53, 0xffff
    s_cmp_ge_u32 s54, 8
    s_cbranch_scc1 RK_DONE
    s_andn2_b32 s46, 0xffff, s56
    s_and_b32 s48, s46, 7
    s_cmp_lg_u32 s48, s3
    s_cbranch_scc1 RK_N16
    s_bitcmp1_b32 s46, 3
    s_cselect_b32 exec_lo, 0, -1
    s_cselect_b32 exec_hi, -1, 0
    s_andn2_b64 s[58:59], s[58:59], exec
    s_mul_i32 s48, s54, 1536
    s_add_u32 s48, s48, 65536
    buffer_store_dwordx4 v[180:183], v12, s[32:35], s48 offen offset:0 sc1
    buffer_store_dwordx4 v[184:187], v12, s[32:35], s48 offen offset:512 sc1
    buffer_store_dwordx4 v[188:191], v12, s[32:35], s48 offen offset:1024 sc1
    v_and_b32 v28, 0xffff, v180
    v_or_b32 v28, v28, v162
    v_lshrrev_b32 v29, 16, v180
    v_or_b32 v29, v29, v163
    v_and_b32 v30, 0xffff, v181
    v_or_b32 v30, v30, v164
    v_lshrrev_b32 v31, 16, v181
    v_or_b32 v31, v31, v165
    v_and_b32 v32, 0xffff, v182
    v_or_b32 v32, v32, v166
    v_lshrrev_b32 v33, 16, v182
    v_or_b32 v33, v33, v167
    v_and_b32 v34, 0xffff, v184
    v_or_b32 v34, v34, v168
    v_lshrrev_b32 v35, 16, v184
    v_or_b32 v35, v35, v169
    v_and_b32 v36, 0xffff, v185
    v_or_b32 v36, v36, v170
    v_lshrrev_b32 v37, 16, v185
    v_or_b32 v37, v37, v171
    v_and_b32 v38, 0xffff, v186
    v_or_b32 v38, v38, v172
    v_lshrrev_b32 v39, 16, v186
    v_or_b32 v39, v39, v173
    v_and_b32 v40, 0xffff, v188
    v_or_b32 v40, v40, v174
    v_lshrrev_b32 v41, 16, v188
    v_or_b32 v41, v41, v175
    v_and_b32 v42, 0xffff, v189
    v_or_b32 v42, v42, v176
    v_lshrrev_b32 v43, 16, v189
    v_or_b32 v43, v43, v177
    v_and_b32 v44, 0xffff, v190
    v_or_b32 v44, v44, v178
    v_lshrrev_b32 v45, 16, v190
    v_or_b32 v45, v45, v179
    s_mul_i32 s48, s54, 2432
    s_add_u32 s48, s48, 131072
    v_lshlrev_b32 v46, 1, v13
    buffer_store_dwordx4 v[28:31], v12, s[32:35], s48 offen offset:0 sc1
    buffer_store_dwordx4 v[32:35], v12, s[32:35], s48 offen offset:512 sc1
    buffer_store_dwordx4 v[36:39], v12, s[32:35], s48 offen offset:1024 sc1
    buffer_store_dwordx4 v[40:43], v12, s[32:35], s48 offen offset:1536 sc1
    buffer_store_dwordx2 v[44:45], v46, s[32:35], s48 offen offset:2048 sc1
    v_mov_b32 v48, s46
    v_mov_b32 v49, v216
    v_mov_b32 v50, s40
    v_mov_b32 v51, s40
    s_and_b32 exec_lo, exec_lo, 1
    s_and_b32 exec_hi, exec_hi, 1
    s_waitcnt vmcnt(0)
    buffer_store_dwordx4 v[48:51], v12, s[32:35], s48 offen offset:2304 sc1
    s_mov_b64 exec, -1
RK_N16:
    s_lshr_b32 s54, s53, 16
    s_cmp_ge_u32 s54, 8
    s_cbranch_scc1 RK_DONE
    s_andn2_b32 s46, 0xffff, s57
    s_and_b32 s48, s46, 7
    s_cmp_lg_u32 s48, s3
    s_cbranch_scc1 RK_N17
    s_bitcmp1_b32 s46, 3
    s_cselect_b32 exec_lo, 0, -1
    s_cselect_b32 exec_hi, -1, 0
    s_andn2_b64 s[58:59], s[58:59], exec
    s_mul_i32 s48, s54, 1536
    s_add_u32 s48, s48, 65536
    buffer_store_dwordx4 v[180:183], v12, s[32:35], s48 offen offset:0 sc1
    buffer_store_dwordx4 v[184:187], v12, s[32:35], s48 offen offset:512 sc1
    buffer_store_dwordx4 v[188:191], v12, s[32:35], s48 offen offset:1024 sc1
    v_and_b32 v28, 0xffff, v180
    v_or_b32 v28, v28, v162
    v_lshrrev_b32 v29, 16, v180
    v_or_b32 v29, v29, v163
    v_and_b32 v30, 0xffff, v181
    v_or_b32 v30, v30, v164
    v_lshrrev_b32 v31, 16, v181
    v_or_b32 v31, v31, v165
    v_and_b32 v32, 0xffff, v182
    v_or_b32 v32, v32, v166
    v_lshrrev_b32 v33, 16, v182
    v_or_b32 v33, v33, v167
    v_and_b32 v34, 0xffff, v184
    v_or_b32 v34, v34, v168
    v_lshrrev_b32 v35, 16, v184
    v_or_b32 v35, v35, v169
    v_and_b32 v36, 0xffff, v185
    v_or_b32 v36, v36, v170
    v_lshrrev_b32 v37, 16, v185
    v_or_b32 v37, v37, v171
    v_and_b32 v38, 0xffff, v186
    v_or_b32 v38, v38, v172
    v_lshrrev_b32 v39, 16, v186
    v_or_b32 v39, v39, v173
    v_and_b32 v40, 0xffff, v188
    v_or_b32 v40, v40, v174
    v_lshrrev_b32 v41, 16, v188
    v_or_b32 v41, v41, v175
    v_and_b32 v42, 0xffff, v189
    v_or_b32 v42, v42, v176
    v_lshrrev_b32 v43, 16, v189
    v_or_b32 v43, v43, v177
    v_and_b32 v44, 0xffff, v190
    v_or_b32 v44, v44, v178
    v_lshrrev_b32 v45, 16, v190
    v_or_b32 v45, v45, v179
    s_mul_i32 s48, s54, 2432
    s_add_u32 s48, s48, 131072
    v_lshlrev_b32 v46, 1, v13
    buffer_store_dwordx4 v[28:31], v12, s[32:35], s48 offen offset:0 sc1
    buffer_store_dwordx4 v[32:35], v12, s[32:35], s48 offen offset:512 sc1
    buffer_store_dwordx4 v[36:39], v12, s[32:35], s48 offen offset:1024 sc1
    buffer_store_dwordx4 v[40:43], v12, s[32:35], s48 offen offset:1536 sc1
    buffer_store_dwordx2 v[44:45], v46, s[32:35], s48 offen offset:2048 sc1
    v_mov_b32 v48, s46
    v_mov_b32 v49, v216
    v_mov_b32 v50, s40
    v_mov_b32 v51, s40
    s_and_b32 exec_lo, exec_lo, 1
    s_and_b32 exec_hi, exec_hi, 1
    s_waitcnt vmcnt(0)
    buffer_store_dwordx4 v[48:51], v12, s[32:35], s48 offen offset:2304 sc1
    s_mov_b64 exec, -1
RK_N17:
    v_mov_b32 v206, v205
    s_nop 1
    v_max_u32_dpp v206, v206, v206 row_ror:8 row_mask:0xf bank_mask:0xf
    s_nop 1
    v_max_u32_dpp v206, v206, v206 row_ror:4 row_mask:0xf bank_mask:0xf
    s_nop 1
    v_max_u32_dpp v206, v206, v206 row_ror:2 row_mask:0xf bank_mask:0xf
    s_nop 1
    v_max_u32_dpp v206, v206, v206 row_ror:1 row_mask:0xf bank_mask:0xf
    s_nop 0
    v_readfirstlane_b32 s56, v206
    v_cmp_ne_u32 vcc, v206, v205
    s_nop 1
    v_cndmask_b32 v205, 0, v205, vcc
    v_mov_b32 v206, v205
    s_nop 1
    v_max_u32_dpp v206, v206, v206 row_ror:8 row_mask:0xf bank_mask:0xf
    s_nop 1
    v_max_u32_dpp v206, v206, v206 row_ror:4 row_mask:0xf bank_mask:0xf
    s_nop 1
    v_max_u32_dpp v206, v206, v206 row_ror:2 row_mask:0xf bank_mask:0xf
    s_nop 1
    v_max_u32_dpp v206, v206, v206 row_ror:1 row_mask:0xf bank_mask:0xf
    s_nop 0
    v_readfirstlane_b32 s57, v206
    v_cmp_ne_u32 vcc, v206, v205
    s_nop 1
    v_cndmask_b32 v205, 0, v205, vcc
    s_branch RK_LOOP
RK_DONE:
    v_dot2_f32_bf16 v162, v180, v6, v162
    v_dot2_f32_bf16 v163, v180, v7, v163
    v_dot2_f32_bf16 v164, v181, v6, v164
    v_dot2_f32_bf16 v165, v181, v7, v165
    v_dot2_f32_bf16 v166, v182, v6, v166
    v_dot2_f32_bf16 v167, v182, v7, v167
    v_dot2_f32_bf16 v168, v184, v6, v168
    v_dot2_f32_bf16 v169, v184, v7, v169
    v_dot2_f32_bf16 v170, v185, v6, v170
    v_dot2_f32_bf16 v171, v185, v7, v171
    v_dot2_f32_bf16 v172, v186, v6, v172
    v_dot2_f32_bf16 v173, v186, v7, v173
    v_dot2_f32_bf16 v174, v188, v6, v174
    v_dot2_f32_bf16 v175, v188, v7, v175
    v_dot2_f32_bf16 v176, v189, v6, v176
    v_dot2_f32_bf16 v177, v189, v7, v177
    v_dot2_f32_bf16 v178, v190, v6, v178
    v_dot2_f32_bf16 v179, v190, v7, v179
    v_cvt_pk_bf16_f32 v16, v162, v163
    v_cvt_pk_bf16_f32 v17, v164, v165
    v_cvt_pk_bf16_f32 v18, v166, v167
    v_cvt_pk_bf16_f32 v19, v168, v169
    v_cvt_pk_bf16_f32 v20, v170, v171
    v_cvt_pk_bf16_f32 v21, v172, v173
    v_cvt_pk_bf16_f32 v22, v174, v175
    v_cvt_pk_bf16_f32 v23, v176, v177
    v_cvt_pk_bf16_f32 v24, v178, v179
    s_mov_b64 exec, s[58:59]
    s_cbranch_execz RK_NOOUT
    global_store_dwordx4 v4, v[16:19], s[28:29] sc1
    global_store_dwordx4 v4, v[20:23], s[28:29] offset:512 sc1
    global_store_dword v5, v24, s[28:29] offset:1024 sc1
RK_NOOUT:
    s_mov_b64 exec, -1
ZROLE:
    s_cmp_lg_u32 s3, 0
    s_cbranch_scc1 DUMP
    s_and_b32 s50, s2, 7
    s_mul_i32 s50, s50, 18
    s_lshr_b32 s46, s2, 3
    s_add_u32 s50, s50, s46
    v_and_b32 v12, 7, v1
    v_mul_u32_u24 v12, 2432, v12
    s_mov_b32 s60, 131072
    buffer_load_dwordx4 v[28:31], v12, s[32:35], s60 offen offset:2304 sc1
    s_lshr_b32 s46, s50, 6
    s_lshl_b32 s46, s46, 10
    s_and_b32 s48, s50, 1
    s_lshl_b32 s48, s48, 9
    s_add_u32 s46, s46, s48
    s_bfe_u32 s48, s50, 0x50001
    s_lshl_b32 s48, s48, 4
    s_add_u32 s46, s46, s48
    s_lshl_b32 s48, s50, 4
    s_cmp_ge_u32 s50, 128
    s_cselect_b32 s46, s48, s46
    s_add_u32 s61, s46, 131072
    v_bfe_u32 v13, v1, 4, 1
    v_lshrrev_b32 v14, 5, v1
    v_lshl_add_u32 v13, v13, 1, v14
    v_lshl_add_u32 v14, v13, 2, v12
    s_mov_b32 s47, 0
PL18:
    s_waitcnt vmcnt(0)
    v_cmp_ne_u32 vcc, s40, v30
    s_cbranch_vccz PD19
    s_sleep 8
    buffer_load_dwordx4 v[28:31], v12, s[32:35], s60 offen offset:2304 sc1
    s_add_u32 s47, s47, 1
    s_cmp_lt_u32 s47, 65536
    s_cbranch_scc1 PL18
    s_waitcnt vmcnt(0)
    v_cmp_ne_u32 vcc, s40, v30
PD19:
    buffer_load_dword v32, v14, s[32:35], s61 offen sc1
    v_mul_f32 v33, 0xbfb8aa3b, v29
    v_exp_f32 v33, v33
    s_nop 0
    v_add_f32 v33, 1.0, v33
    v_rcp_f32 v33, v33
    s_nop 0
    v_cvt_pk_bf16_f32 v33, 0, v33
    v_min_u32 v28, 2047, v28
    v_mul_u32_u24 v28, 1152, v28
    s_lshl_b32 s46, s50, 3
    v_lshl_add_u32 v13, v13, 1, s46
    v_add_u32 v28, v28, v13
    s_mul_i32 s60, s50, 9216
    s_add_u32 s60, s60, 7340032
    s_add_u32 s61, s60, 4096
    s_add_u32 s62, s60, 8192
    s_and_b32 s46, s40, 63
    v_mov_b32 v36, s46
    s_waitcnt vmcnt(0)
    v_lshlrev_b32 v34, 16, v32
    v_and_b32 v35, 0xffff0000, v32
    buffer_load_dwordx4 v[40:43], v2, s[32:35], s60 offen offset:0 sc1
    buffer_load_dwordx4 v[44:47], v2, s[32:35], s60 offen offset:1024 sc1
    buffer_load_dwordx4 v[48:51], v2, s[32:35], s60 offen offset:2048 sc1
    buffer_load_dwordx4 v[52:55], v2, s[32:35], s60 offen offset:3072 sc1
    buffer_load_dwordx4 v[56:59], v2, s[32:35], s61 offen offset:0 sc1
    buffer_load_dwordx4 v[60:63], v2, s[32:35], s61 offen offset:1024 sc1
    buffer_load_dwordx4 v[64:67], v2, s[32:35], s61 offen offset:2048 sc1
    buffer_load_dwordx4 v[68:71], v2, s[32:35], s61 offen offset:3072 sc1
    buffer_load_dwordx4 v[72:75], v2, s[32:35], s62 offen offset:0 sc1
    s_mov_b32 s47, 0
PL21:
    s_waitcnt vmcnt(0)
    v_xor_b32 v40, v36, v40
    v_xor_b32 v41, v36, v41
    v_xor_b32 v42, v36, v42
    v_xor_b32 v43, v36, v43
    v_xor_b32 v44, v36, v44
    v_xor_b32 v45, v36, v45
    v_xor_b32 v46, v36, v46
    v_xor_b32 v47, v36, v47
    v_xor_b32 v48, v36, v48
    v_xor_b32 v49, v36, v49
    v_xor_b32 v50, v36, v50
    v_xor_b32 v51, v36, v51
    v_xor_b32 v52, v36, v52
    v_xor_b32 v53, v36, v53
    v_xor_b32 v54, v36, v54
    v_xor_b32 v55, v36, v55
    v_xor_b32 v56, v36, v56
    v_xor_b32 v57, v36, v57
    v_xor_b32 v58, v36, v58
    v_xor_b32 v59, v36, v59
    v_xor_b32 v60, v36, v60
    v_xor_b32 v61, v36, v61
    v_xor_b32 v62, v36, v62
    v_xor_b32 v63, v36, v63
    v_xor_b32 v64, v36, v64
    v_xor_b32 v65, v36, v65
    v_xor_b32 v66, v36, v66
    v_xor_b32 v67, v36, v67
    v_xor_b32 v68, v36, v68
    v_xor_b32 v69, v36, v69
    v_xor_b32 v70, v36, v70
    v_xor_b32 v71, v36, v71
    v_xor_b32 v72, v36, v72
    v_xor_b32 v73, v36, v73
    v_xor_b32 v74, v36, v74
    v_xor_b32 v75, v36, v75
    v_or_b32 v37, v40, v41
    v_or3_b32 v37, v37, v42, v43
    v_or3_b32 v37, v37, v44, v45
    v_or3_b32 v37, v37, v46, v47
    v_or3_b32 v37, v37, v48, v49
    v_or3_b32 v37, v37, v50, v51
    v_or3_b32 v37, v37, v52, v53
    v_or3_b32 v37, v37, v54, v55
    v_or3_b32 v37, v37, v56, v57
    v_or3_b32 v37, v37, v58, v59
    v_or3_b32 v37, v37, v60, v61
    v_or3_b32 v37, v37, v62, v63
    v_or3_b32 v37, v37, v64, v65
    v_or3_b32 v37, v37, v66, v67
    v_or3_b32 v37, v37, v68, v69
    v_or3_b32 v37, v37, v70, v71
    v_or3_b32 v37, v37, v72, v73
    v_or3_b32 v37, v37, v74, v75
    v_and_b32 v37, 63, v37
    v_cmp_ne_u32 vcc, 0, v37
    s_cbranch_vccz PD22
    s_sleep 2
    buffer_load_dwordx4 v[40:43], v2, s[32:35], s60 offen offset:0 sc1
    buffer_load_dwordx4 v[44:47], v2, s[32:35], s60 offen offset:1024 sc1
    buffer_load_dwordx4 v[48:51], v2, s[32:35], s60 offen offset:2048 sc1
    buffer_load_dwordx4 v[52:55], v2, s[32:35], s60 offen offset:3072 sc1
    buffer_load_dwordx4 v[56:59], v2, s[32:35], s61 offen offset:0 sc1
    buffer_load_dwordx4 v[60:63], v2, s[32:35], s61 offen offset:1024 sc1
    buffer_load_dwordx4 v[64:67], v2, s[32:35], s61 offen offset:2048 sc1
    buffer_load_dwordx4 v[68:71], v2, s[32:35], s61 offen offset:3072 sc1
    buffer_load_dwordx4 v[72:75], v2, s[32:35], s62 offen offset:0 sc1
    s_add_u32 s47, s47, 1
    s_cmp_lt_u32 s47, 65536
    s_cbranch_scc1 PL21
    s_waitcnt vmcnt(0)
    v_xor_b32 v40, v36, v40
    v_xor_b32 v41, v36, v41
    v_xor_b32 v42, v36, v42
    v_xor_b32 v43, v36, v43
    v_xor_b32 v44, v36, v44
    v_xor_b32 v45, v36, v45
    v_xor_b32 v46, v36, v46
    v_xor_b32 v47, v36, v47
    v_xor_b32 v48, v36, v48
    v_xor_b32 v49, v36, v49
    v_xor_b32 v50, v36, v50
    v_xor_b32 v51, v36, v51
    v_xor_b32 v52, v36, v52
    v_xor_b32 v53, v36, v53
    v_xor_b32 v54, v36, v54
    v_xor_b32 v55, v36, v55
    v_xor_b32 v56, v36, v56
    v_xor_b32 v57, v36, v57
    v_xor_b32 v58, v36, v58
    v_xor_b32 v59, v36, v59
    v_xor_b32 v60, v36, v60
    v_xor_b32 v61, v36, v61
    v_xor_b32 v62, v36, v62
    v_xor_b32 v63, v36, v63
    v_xor_b32 v64, v36, v64
    v_xor_b32 v65, v36, v65
    v_xor_b32 v66, v36, v66
    v_xor_b32 v67, v36, v67
    v_xor_b32 v68, v36, v68
    v_xor_b32 v69, v36, v69
    v_xor_b32 v70, v36, v70
    v_xor_b32 v71, v36, v71
    v_xor_b32 v72, v36, v72
    v_xor_b32 v73, v36, v73
    v_xor_b32 v74, v36, v74
    v_xor_b32 v75, v36, v75
    v_or_b32 v37, v40, v41
    v_or3_b32 v37, v37, v42, v43
    v_or3_b32 v37, v37, v44, v45
    v_or3_b32 v37, v37, v46, v47
    v_or3_b32 v37, v37, v48, v49
    v_or3_b32 v37, v37, v50, v51
    v_or3_b32 v37, v37, v52, v53
    v_or3_b32 v37, v37, v54, v55
    v_or3_b32 v37, v37, v56, v57
    v_or3_b32 v37, v37, v58, v59
    v_or3_b32 v37, v37, v60, v61
    v_or3_b32 v37, v37, v62, v63
    v_or3_b32 v37, v37, v64, v65
    v_or3_b32 v37, v37, v66, v67
    v_or3_b32 v37, v37, v68, v69
    v_or3_b32 v37, v37, v70, v71
    v_or3_b32 v37, v37, v72, v73
    v_or3_b32 v37, v37, v74, v75
    v_and_b32 v37, 63, v37
    v_cmp_ne_u32 vcc, 0, v37
PD22:
    v_pk_add_f32 v[40:41], v[40:41], v[44:45]
    v_pk_add_f32 v[42:43], v[42:43], v[46:47]
    v_pk_add_f32 v[48:49], v[48:49], v[52:53]
    v_pk_add_f32 v[50:51], v[50:51], v[54:55]
    v_pk_add_f32 v[56:57], v[56:57], v[60:61]
    v_pk_add_f32 v[58:59], v[58:59], v[62:63]
    v_pk_add_f32 v[64:65], v[64:65], v[68:69]
    v_pk_add_f32 v[66:67], v[66:67], v[70:71]
    v_pk_add_f32 v[40:41], v[40:41], v[48:49]
    v_pk_add_f32 v[42:43], v[42:43], v[50:51]
    v_pk_add_f32 v[56:57], v[56:57], v[64:65]
    v_pk_add_f32 v[58:59], v[58:59], v[66:67]
    v_pk_add_f32 v[40:41], v[40:41], v[56:57]
    v_pk_add_f32 v[42:43], v[42:43], v[58:59]
    v_pk_add_f32 v[40:41], v[40:41], v[72:73]
    v_pk_add_f32 v[42:43], v[42:43], v[74:75]
    s_nop 0
    v_permlane32_swap_b32 v40, v41
    v_permlane32_swap_b32 v42, v43
    v_add_f32 v40, v40, v41
    v_add_f32 v42, v42, v43
    s_nop 1
    v_permlane16_swap_b32 v40, v42
    v_add_f32 v40, v40, v42
    s_nop 1
    v_add_f32_dpp v40, v40, v40 row_ror:8 row_mask:0xf bank_mask:0xf
    v_cvt_pk_bf16_f32 v40, 0, v40
    v_mul_f32 v40, v40, v33
    v_cvt_pk_bf16_f32 v40, 0, v40
    v_add_f32 v40, v40, v34
    v_cvt_pk_bf16_f32 v40, 0, v40
    v_add_f32 v40, v40, v35
    v_cvt_pk_bf16_f32 v40, v40, v40
    s_mov_b32 exec_lo, 0x00ff00ff
    s_mov_b32 exec_hi, 0x00ff00ff
    global_store_short v28, v40, s[28:29]
    s_cmp_lg_u32 s2, 0
    s_cbranch_scc1 DUMP
    s_mov_b64 exec, 1
    v_mov_b32 v36, s40
    buffer_store_dword v36, v2, s[32:35], 0 offen
    s_branch DUMP
FROLE:
    s_sub_u32 s50, s2, 144
    v_lshrrev_b32 v12, 3, v0
    v_and_b32 v13, 7, v0
    v_lshlrev_b32 v13, 4, v13
    v_mul_u32_u24 v4, 9216, v12
    v_add_u32 v4, v4, v13
    v_mul_u32_u24 v5, 1152, v12
    v_add_u32 v5, v5, v13
    s_lshl_b32 s46, s50, 7
    s_mul_i32 s48, s50, 73728
    s_mov_b32 s38, 5308416
    s_mov_b32 s39, 0x00020000
    s_mov_b32 s54, 5308416
    s_mov_b32 s55, 0x00020000
    s_mov_b32 s58, 5308416
    s_mov_b32 s59, 0x00020000
    s_waitcnt lgkmcnt(0)
    s_mov_b32 s36, s22
    s_and_b32 s37, s23, 0xffff
    s_mov_b32 s52, s24
    s_and_b32 s53, s25, 0xffff
    s_mov_b32 s56, s26
    s_and_b32 s57, s27, 0xffff
    s_load_dword s40, s[30:31], 0
    buffer_load_dwordx4 v[16:19], v4, s[36:39], s46 offen nt
    buffer_load_dwordx4 v[20:23], v4, s[52:55], s46 offen nt
    s_add_u32 s46, s46, 589824
    buffer_load_dwordx4 v[24:27], v4, s[36:39], s46 offen nt
    buffer_load_dwordx4 v[28:31], v4, s[52:55], s46 offen nt
    s_add_u32 s46, s46, 589824
    buffer_load_dwordx4 v[32:35], v4, s[36:39], s46 offen nt
    buffer_load_dwordx4 v[36:39], v4, s[52:55], s46 offen nt
    s_add_u32 s46, s46, 589824
    buffer_load_dwordx4 v[40:43], v4, s[36:39], s46 offen nt
    buffer_load_dwordx4 v[44:47], v4, s[52:55], s46 offen nt
    s_add_u32 s46, s46, 589824
    buffer_load_dwordx4 v[48:51], v4, s[36:39], s46 offen nt
    buffer_load_dwordx4 v[52:55], v4, s[52:55], s46 offen nt
    s_add_u32 s46, s46, 589824
    buffer_load_dwordx4 v[56:59], v4, s[36:39], s46 offen nt
    buffer_load_dwordx4 v[60:63], v4, s[52:55], s46 offen nt
    s_add_u32 s46, s46, 589824
    buffer_load_dwordx4 v[64:67], v4, s[36:39], s46 offen nt
    buffer_load_dwordx4 v[68:71], v4, s[52:55], s46 offen nt
    s_add_u32 s46, s46, 589824
    buffer_load_dwordx4 v[72:75], v4, s[36:39], s46 offen nt
    buffer_load_dwordx4 v[76:79], v4, s[52:55], s46 offen nt
    s_add_u32 s46, s46, 589824
    buffer_load_dwordx4 v[80:83], v4, s[36:39], s46 offen nt
    buffer_load_dwordx4 v[84:87], v4, s[52:55], s46 offen nt
    s_add_u32 s46, s46, 589824
    buffer_load_dwordx4 v[88:91], v5, s[56:59], s48 offen offset:0 nt
    buffer_load_dwordx4 v[92:95], v5, s[56:59], s48 offen offset:128 nt
    buffer_load_dwordx4 v[96:99], v5, s[56:59], s48 offen offset:256 nt
    buffer_load_dwordx4 v[100:103], v5, s[56:59], s48 offen offset:384 nt
    buffer_load_dwordx4 v[104:107], v5, s[56:59], s48 offen offset:512 nt
    buffer_load_dwordx4 v[108:111], v5, s[56:59], s48 offen offset:640 nt
    buffer_load_dwordx4 v[112:115], v5, s[56:59], s48 offen offset:768 nt
    buffer_load_dwordx4 v[116:119], v5, s[56:59], s48 offen offset:896 nt
    buffer_load_dwordx4 v[120:123], v5, s[56:59], s48 offen offset:1024 nt
    s_mov_b32 s32, s30
    s_and_b32 s33, s31, 0xffff
    s_mov_b32 s34, 0x10000000
    s_mov_b32 s35, 0x00020000
    v_mul_u32_u24 v6, 272, v12
    v_add_u32 v6, v6, v13
    v_lshrrev_b32 v14, 4, v1
    v_bfe_u32 v15, v1, 2, 2
    v_lshl_add_u32 v7, v14, 3, v15
    v_mul_u32_u24 v7, 272, v7
    v_and_b32 v8, 2, v1
    v_lshl_add_u32 v7, v8, 6, v7
    v_and_b32 v8, 1, v1
    v_lshl_add_u32 v7, v8, 3, v7
    s_lshl_b32 s46, s3, 4
    v_add_u32 v7, s46, v7
    v_bfe_u32 v8, v1, 3, 3
    v_mul_u32_u24 v8, 1184, v8
    v_add_u32 v8, v8, v13
    s_mul_i32 s46, s3, 9600
    v_add_u32 v8, s46, v8
    v_mul_u32_u24 v9, 9600, v14
    v_mul_u32_u24 v15, 1184, v15
    v_add_u32 v9, v9, v15
    v_and_b32 v15, 3, v1
    v_lshl_add_u32 v9, v15, 3, v9
    s_lshl_b32 s46, s3, 5
    v_add_u32 v9, s46, v9
    v_add_u32 v242, 0, v0
    v_mul_u32_u24 v243, 683, v242
    v_lshrrev_b32 v243, 16, v243
    v_mul_u32_u24 v244, 96, v243
    v_sub_u32 v242, v242, v244
    v_mul_u32_u24 v243, 1168, v243
    v_add_u32 v243, 81920, v243
    v_and_b32 v244, 31, v242
    v_lshrrev_b32 v242, 5, v242
    v_lshl_add_u32 v245, v244, 4, v243
    v_lshl_add_u32 v246, v244, 2, v243
    v_add_u32 v246, 1024, v246
    v_cmp_eq_u32 s[60:61], 1, v242
    v_cmp_eq_u32 s[62:63], 2, v242
    v_mov_b32 v247, 0
    v_mov_b32 v248, 12
    v_cndmask_b32 v247, v247, v248, s[60:61]
    v_mov_b32 v248, 520
    v_cndmask_b32 v247, v247, v248, s[62:63]
    v_add_u32 v236, v247, v245
    v_mov_b32 v247, 4
    v_mov_b32 v248, 512
    v_cndmask_b32 v247, v247, v248, s[60:61]
    v_mov_b32 v248, 524
    v_cndmask_b32 v247, v247, v248, s[62:63]
    v_add_u32 v237, v247, v245
    v_mov_b32 v247, 8
    v_mov_b32 v248, 516
    v_cndmask_b32 v247, v247, v248, s[60:61]
    v_add_u32 v247, v247, v245
    v_cndmask_b32 v238, v247, v246, s[62:63]
    v_add_u32 v242, 512, v0
    v_mul_u32_u24 v243, 683, v242
    v_lshrrev_b32 v243, 16, v243
    v_mul_u32_u24 v244, 96, v243
    v_sub_u32 v242, v242, v244
    v_mul_u32_u24 v243, 1168, v243
    v_add_u32 v243, 81920, v243
    v_and_b32 v244, 31, v242
    v_lshrrev_b32 v242, 5, v242
    v_lshl_add_u32 v245, v244, 4, v243
    v_lshl_add_u32 v246, v244, 2, v243
    v_add_u32 v246, 1024, v246
    v_cmp_eq_u32 s[60:61], 1, v242
    v_cmp_eq_u32 s[62:63], 2, v242
    v_mov_b32 v247, 0
    v_mov_b32 v248, 12
    v_cndmask_b32 v247, v247, v248, s[60:61]
    v_mov_b32 v248, 520
    v_cndmask_b32 v247, v247, v248, s[62:63]
    v_add_u32 v239, v247, v245
    v_mov_b32 v247, 4
    v_mov_b32 v248, 512
    v_cndmask_b32 v247, v247, v248, s[60:61]
    v_mov_b32 v248, 524
    v_cndmask_b32 v247, v247, v248, s[62:63]
    v_add_u32 v240, v247, v245
    v_mov_b32 v247, 8
    v_mov_b32 v248, 516
    v_cndmask_b32 v247, v247, v248, s[60:61]
    v_add_u32 v247, v247, v245
    v_cndmask_b32 v241, v247, v246, s[62:63]
    v_and_b32 v15, 7, v1
    v_mul_u32_u24 v10, 1168, v15
    v_lshl_add_u32 v10, v14, 4, v10
    v_add_u32 v10, 81920, v10
    v_mul_u32_u24 v11, 144, v15
    v_add_u32 v11, 98304, v11
    v_lshl_add_u32 v242, v14, 4, v11
    v_bfe_u32 v243, v1, 4, 1
    v_lshl_add_u32 v11, v243, 3, v11
    v_bfe_u32 v243, v1, 3, 1
    v_lshl_add_u32 v11, v243, 2, v11
    v_lshrrev_b32 v244, 5, v1
    v_lshl_add_u32 v11, v244, 1, v11
    s_lshl_b32 s46, s3, 4
    v_add_u32 v11, s46, v11
    v_lshl_add_u32 v243, v243, 5, v14
    v_mul_u32_u24 v243, 9216, v243
    v_lshl_add_u32 v243, v15, 4, v243
    s_mul_i32 s62, s3, 36864
    s_lshl_b32 s46, s50, 7
    s_add_u32 s62, s62, s46
    s_add_u32 s62, s62, 7340032
    v_and_b32 v244, 8, v1
    v_cmp_eq_u32 s[60:61], 0, v244
    s_waitcnt lgkmcnt(0)
    s_add_u32 s40, s40, 1
    s_and_b32 s46, s40, 63
    v_mov_b32 v245, s46
    v_mov_b32 v246, 0xffffffc0
    s_waitcnt vmcnt(25)
    ds_write_b128 v6, v[16:19] offset:0
    ds_write_b128 v6, v[20:23] offset:128
    s_waitcnt vmcnt(23)
    ds_write_b128 v6, v[24:27] offset:17408
    ds_write_b128 v6, v[28:31] offset:17536
    s_waitcnt vmcnt(21)
    ds_write_b128 v6, v[32:35] offset:34816
    ds_write_b128 v6, v[36:39] offset:34944
    s_waitcnt vmcnt(19)
    v_add_u32 v6, 52224, v6
    ds_write_b128 v6, v[40:43] offset:0
    ds_write_b128 v6, v[44:47] offset:128
    s_waitcnt vmcnt(17)
    ds_write_b128 v6, v[48:51] offset:17408
    ds_write_b128 v6, v[52:55] offset:17536
    s_waitcnt lgkmcnt(0)
    s_barrier
    ds_read_b64_tr_b16 v[124:125], v7 offset:0
    ds_read_b64_tr_b16 v[126:127], v7 offset:1088
    ds_read_b64_tr_b16 v[128:129], v7 offset:8704
    ds_read_b64_tr_b16 v[130:131], v7 offset:9792
    ds_read_b64_tr_b16 v[132:133], v7 offset:17408
    ds_read_b64_tr_b16 v[134:135], v7 offset:18496
    ds_read_b64_tr_b16 v[136:137], v7 offset:26112
    ds_read_b64_tr_b16 v[138:139], v7 offset:27200
    ds_read_b64_tr_b16 v[140:141], v7 offset:34816
    ds_read_b64_tr_b16 v[142:143], v7 offset:35904
    ds_read_b64_tr_b16 v[144:145], v7 offset:43520
    ds_read_b64_tr_b16 v[146:147], v7 offset:44608
    v_add_u32 v7, 52224, v7
    ds_read_b64_tr_b16 v[148:149], v7 offset:0
    ds_read_b64_tr_b16 v[150:151], v7 offset:1088
    ds_read_b64_tr_b16 v[152:153], v7 offset:8704
    ds_read_b64_tr_b16 v[154:155], v7 offset:9792
    ds_read_b64_tr_b16 v[156:157], v7 offset:17408
    ds_read_b64_tr_b16 v[158:159], v7 offset:18496
    ds_read_b64_tr_b16 v[160:161], v7 offset:26112
    ds_read_b64_tr_b16 v[162:163], v7 offset:27200
    s_waitcnt vmcnt(15)
    ds_write_b128 v6, v[56:59] offset:34816
    ds_write_b128 v6, v[60:63] offset:34944
    s_waitcnt vmcnt(13)
    v_add_u32 v6, 52224, v6
    ds_write_b128 v6, v[64:67] offset:0
    ds_write_b128 v6, v[68:71] offset:128
    s_waitcnt vmcnt(11)
    ds_write_b128 v6, v[72:75] offset:17408
    ds_write_b128 v6, v[76:79] offset:17536
    s_waitcnt vmcnt(9)
    ds_write_b128 v6, v[80:83] offset:34816
    ds_write_b128 v6, v[84:87] offset:34944
    s_waitcnt lgkmcnt(0)
    s_barrier
    ds_read_b64_tr_b16 v[164:165], v7 offset:34816
    ds_read_b64_tr_b16 v[166:167], v7 offset:35904
    ds_read_b64_tr_b16 v[168:169], v7 offset:43520
    ds_read_b64_tr_b16 v[170:171], v7 offset:44608
    v_add_u32 v7, 52224, v7
    ds_read_b64_tr_b16 v[172:173], v7 offset:0
    ds_read_b64_tr_b16 v[174:175], v7 offset:1088
    ds_read_b64_tr_b16 v[176:177], v7 offset:8704
    ds_read_b64_tr_b16 v[178:179], v7 offset:9792
    ds_read_b64_tr_b16 v[180:181], v7 offset:17408
    ds_read_b64_tr_b16 v[182:183], v7 offset:18496
    ds_read_b64_tr_b16 v[184:185], v7 offset:26112
    ds_read_b64_tr_b16 v[186:187], v7 offset:27200
    ds_read_b64_tr_b16 v[188:189], v7 offset:34816
    ds_read_b64_tr_b16 v[190:191], v7 offset:35904
    ds_read_b64_tr_b16 v[192:193], v7 offset:43520
    ds_read_b64_tr_b16 v[194:195], v7 offset:44608
    s_waitcnt lgkmcnt(0)
    s_barrier
    s_waitcnt vmcnt(8)
    ds_write_b128 v8, v[88:91] offset:0
    s_waitcnt vmcnt(7)
    ds_write_b128 v8, v[92:95] offset:128
    s_waitcnt vmcnt(6)
    ds_write_b128 v8, v[96:99] offset:256
    s_waitcnt vmcnt(5)
    ds_write_b128 v8, v[100:103] offset:384
    s_waitcnt vmcnt(4)
    ds_write_b128 v8, v[104:107] offset:512
    s_waitcnt vmcnt(3)
    ds_write_b128 v8, v[108:111] offset:640
    s_waitcnt vmcnt(2)
    ds_write_b128 v8, v[112:115] offset:768
    s_waitcnt vmcnt(1)
    ds_write_b128 v8, v[116:119] offset:896
    s_waitcnt vmcnt(0)
    ds_write_b128 v8, v[120:123] offset:1024
    s_waitcnt lgkmcnt(0)
    s_barrier
    ds_read_b64_tr_b16 v[196:197], v9 offset:0
    ds_read_b64_tr_b16 v[198:199], v9 offset:4736
    ds_read_b64_tr_b16 v[200:201], v9 offset:38400
    ds_read_b64_tr_b16 v[202:203], v9 offset:43136
    ds_read_b64_tr_b16 v[204:205], v9 offset:256
    ds_read_b64_tr_b16 v[206:207], v9 offset:4992
    ds_read_b64_tr_b16 v[208:209], v9 offset:38656
    ds_read_b64_tr_b16 v[210:211], v9 offset:43392
    ds_read_b64_tr_b16 v[212:213], v9 offset:512
    ds_read_b64_tr_b16 v[214:215], v9 offset:5248
    ds_read_b64_tr_b16 v[216:217], v9 offset:38912
    ds_read_b64_tr_b16 v[218:219], v9 offset:43648
    ds_read_b64_tr_b16 v[220:221], v9 offset:768
    ds_read_b64_tr_b16 v[222:223], v9 offset:5504
    ds_read_b64_tr_b16 v[224:225], v9 offset:39168
    ds_read_b64_tr_b16 v[226:227], v9 offset:43904
    ds_read_b64_tr_b16 v[228:229], v9 offset:1024
    ds_read_b64_tr_b16 v[230:231], v9 offset:5760
    ds_read_b64_tr_b16 v[232:233], v9 offset:39424
    ds_read_b64_tr_b16 v[234:235], v9 offset:44160
    s_mov_b32 s48, 65536
    s_add_u32 s49, s48, 8192
    s_waitcnt lgkmcnt(0)
    s_cmp_ge_u32 s3, 4
    s_cbranch_scc1 F_P1
    buffer_load_dwordx4 v[16:19], v3, s[32:35], s48 offen sc1
    buffer_load_dwordx4 v[20:23], v3, s[32:35], s49 offen sc1
    s_mov_b32 s47, 0
PL24:
    s_waitcnt vmcnt(0)
    v_cmp_ne_u32 vcc, s40, v19
    v_cmp_ne_u32 s[52:53], s40, v23
    s_or_b64 vcc, vcc, s[52:53]
    s_cbranch_vccz PD25
    s_sleep 2
    buffer_load_dwordx4 v[16:19], v3, s[32:35], s48 offen sc1
    buffer_load_dwordx4 v[20:23], v3, s[32:35], s49 offen sc1
    s_add_u32 s47, s47, 1
    s_cmp_lt_u32 s47, 65536
    s_cbranch_scc1 PL24
    s_waitcnt vmcnt(0)
    v_cmp_ne_u32 vcc, s40, v19
    v_cmp_ne_u32 s[52:53], s40, v23
    s_or_b64 vcc, vcc, s[52:53]
PD25:
    ds_write_b32 v239, v20
    ds_write_b32 v240, v21
    ds_write_b32 v241, v22
    s_branch F_P2
F_P1:
    buffer_load_dwordx4 v[16:19], v3, s[32:35], s48 offen sc1
    s_mov_b32 s47, 0
PL27:
    s_waitcnt vmcnt(0)
    v_cmp_ne_u32 vcc, s40, v19
    s_cbranch_vccz PD28
    s_sleep 2
    buffer_load_dwordx4 v[16:19], v3, s[32:35], s48 offen sc1
    s_add_u32 s47, s47, 1
    s_cmp_lt_u32 s47, 65536
    s_cbranch_scc1 PL27
    s_waitcnt vmcnt(0)
    v_cmp_ne_u32 vcc, s40, v19
PD28:
F_P2:
    ds_write_b32 v236, v16
    ds_write_b32 v237, v17
    ds_write_b32 v238, v18
    s_waitcnt lgkmcnt(0)
    s_barrier
    ds_read_b128 v[32:35], v10 offset:0
    ds_read_b128 v[36:39], v10 offset:64
    ds_read_b128 v[40:43], v10 offset:128
    ds_read_b128 v[44:47], v10 offset:192
    ds_read_b128 v[48:51], v10 offset:256
    ds_read_b128 v[52:55], v10 offset:320
    ds_read_b128 v[56:59], v10 offset:384
    s_waitcnt lgkmcnt(6)
    v_mfma_f32_16x16x32_bf16 v[24:27], v[124:127], v[32:35], 0
    ds_read_b128 v[60:63], v10 offset:448
    s_waitcnt lgkmcnt(6)
    v_mfma_f32_16x16x32_bf16 v[24:27], v[128:131], v[36:39], v[24:27]
    ds_read_b128 v[64:67], v10 offset:512
    s_waitcnt lgkmcnt(6)
    v_mfma_f32_16x16x32_bf16 v[24:27], v[132:135], v[40:43], v[24:27]
    ds_read_b128 v[68:71], v10 offset:576
    s_waitcnt lgkmcnt(6)
    v_mfma_f32_16x16x32_bf16 v[24:27], v[136:139], v[44:47], v[24:27]
    ds_read_b128 v[72:75], v10 offset:640
    s_waitcnt lgkmcnt(6)
    v_mfma_f32_16x16x32_bf16 v[24:27], v[140:143], v[48:51], v[24:27]
    ds_read_b128 v[76:79], v10 offset:704
    s_waitcnt lgkmcnt(6)
    v_mfma_f32_16x16x32_bf16 v[24:27], v[144:147], v[52:55], v[24:27]
    ds_read_b128 v[80:83], v10 offset:768
    s_waitcnt lgkmcnt(6)
    v_mfma_f32_16x16x32_bf16 v[24:27], v[148:151], v[56:59], v[24:27]
    ds_read_b128 v[84:87], v10 offset:832
    s_waitcnt lgkmcnt(6)
    v_mfma_f32_16x16x32_bf16 v[24:27], v[152:155], v[60:63], v[24:27]
    ds_read_b128 v[88:91], v10 offset:896
    s_waitcnt lgkmcnt(6)
    v_mfma_f32_16x16x32_bf16 v[24:27], v[156:159], v[64:67], v[24:27]
    ds_read_b128 v[92:95], v10 offset:960
    s_waitcnt lgkmcnt(6)
    v_mfma_f32_16x16x32_bf16 v[24:27], v[160:163], v[68:71], v[24:27]
    ds_read_b128 v[96:99], v10 offset:1024
    s_waitcnt lgkmcnt(6)
    v_mfma_f32_16x16x32_bf16 v[24:27], v[164:167], v[72:75], v[24:27]
    ds_read_b128 v[100:103], v10 offset:1088
    s_waitcnt lgkmcnt(6)
    v_mfma_f32_16x16x32_bf16 v[24:27], v[168:171], v[76:79], v[24:27]
    s_waitcnt lgkmcnt(5)
    v_mfma_f32_16x16x32_bf16 v[24:27], v[172:175], v[80:83], v[24:27]
    s_waitcnt lgkmcnt(4)
    v_mfma_f32_16x16x32_bf16 v[24:27], v[176:179], v[84:87], v[24:27]
    s_waitcnt lgkmcnt(3)
    v_mfma_f32_16x16x32_bf16 v[24:27], v[180:183], v[88:91], v[24:27]
    s_waitcnt lgkmcnt(2)
    v_mfma_f32_16x16x32_bf16 v[24:27], v[184:187], v[92:95], v[24:27]
    s_waitcnt lgkmcnt(1)
    v_mfma_f32_16x16x32_bf16 v[24:27], v[188:191], v[96:99], v[24:27]
    s_waitcnt lgkmcnt(0)
    v_mfma_f32_16x16x32_bf16 v[24:27], v[192:195], v[100:103], v[24:27]
    s_nop 7
    v_cndmask_b32 v28, v26, v24, s[60:61]
    v_cndmask_b32 v29, v27, v25, s[60:61]
    v_cvt_pk_bf16_f32 v28, 0, v28
    v_cvt_pk_bf16_f32 v29, 0, v29
    s_nop 1
    v_permlane32_swap_b32 v28, v29
    v_mul_f32 v30, 0xbfb8aa3b, v28
    v_exp_f32 v30, v30
    s_nop 0
    v_add_f32 v30, 1.0, v30
    v_rcp_f32 v30, v30
    s_nop 0
    v_mul_f32 v28, v28, v30
    v_cvt_pk_bf16_f32 v28, 0, v28
    v_mul_f32 v28, v28, v29
    v_cvt_pk_bf16_f32 v28, v28, v28
    ds_write_b16 v11, v28
    s_waitcnt lgkmcnt(0)
    s_barrier
    ds_read_b128 v[16:19], v242
    ds_read_b128 v[20:23], v242 offset:64
    s_waitcnt lgkmcnt(1)
    v_mfma_f32_16x16x32_bf16 v[32:35], v[196:199], v[16:19], 0
    v_mfma_f32_16x16x32_bf16 v[36:39], v[204:207], v[16:19], 0
    v_mfma_f32_16x16x32_bf16 v[40:43], v[212:215], v[16:19], 0
    v_mfma_f32_16x16x32_bf16 v[44:47], v[220:223], v[16:19], 0
    v_mfma_f32_16x16x32_bf16 v[48:51], v[228:231], v[16:19], 0
    s_waitcnt lgkmcnt(0)
    v_mfma_f32_16x16x32_bf16 v[32:35], v[200:203], v[20:23], v[32:35]
    v_mfma_f32_16x16x32_bf16 v[36:39], v[208:211], v[20:23], v[36:39]
    v_mfma_f32_16x16x32_bf16 v[40:43], v[216:219], v[20:23], v[40:43]
    v_mfma_f32_16x16x32_bf16 v[44:47], v[224:227], v[20:23], v[44:47]
    v_mfma_f32_16x16x32_bf16 v[48:51], v[232:235], v[20:23], v[48:51]
    s_nop 4
    v_cndmask_b32 v32, v36, v32, s[60:61]
    v_cndmask_b32 v33, v37, v33, s[60:61]
    v_cndmask_b32 v34, v38, v34, s[60:61]
    v_cndmask_b32 v35, v39, v35, s[60:61]
    v_and_or_b32 v32, v32, v246, v245
    v_and_or_b32 v33, v33, v246, v245
    v_and_or_b32 v34, v34, v246, v245
    v_and_or_b32 v35, v35, v246, v245
    buffer_store_dwordx4 v[32:35], v243, s[32:35], s62 offen sc1
    s_add_u32 s62, s62, 589824
    v_cndmask_b32 v40, v44, v40, s[60:61]
    v_cndmask_b32 v41, v45, v41, s[60:61]
    v_cndmask_b32 v42, v46, v42, s[60:61]
    v_cndmask_b32 v43, v47, v43, s[60:61]
    v_and_or_b32 v40, v40, v246, v245
    v_and_or_b32 v41, v41, v246, v245
    v_and_or_b32 v42, v42, v246, v245
    v_and_or_b32 v43, v43, v246, v245
    buffer_store_dwordx4 v[40:43], v243, s[32:35], s62 offen sc1
    s_add_u32 s62, s62, 589824
    s_cmp_ge_u32 s3, 4
    s_cbranch_scc1 DUMP
    v_and_or_b32 v48, v48, v246, v245
    v_and_or_b32 v49, v49, v246, v245
    v_and_or_b32 v50, v50, v246, v245
    v_and_or_b32 v51, v51, v246, v245
    s_mov_b64 exec, s[60:61]
    buffer_store_dwordx4 v[48:51], v243, s[32:35], s62 offen sc1
DUMP:
END:
    s_endpgm
.p2align 7
.type TBL,@object
TBL:
.long 0x0, 0x0, 0x0, 0x0, 0x0, 0x0, 0x0, 0x0
.long 0x0, 0x0, 0x0, 0x0, 0x0, 0x0, 0x0, 0x0
.long 0x0, 0x0, 0x0, 0x0, 0x0, 0x0, 0x0, 0x0
.long 0x0, 0x0, 0x0, 0x0, 0x0, 0x0, 0x0, 0x0
.long 0x0, 0x0, 0x0, 0x0, 0x0, 0x0, 0x0, 0x0
.long 0x0, 0x0, 0x0, 0x0, 0x0, 0x0, 0x0, 0x0
.long 0x0, 0x0, 0x0, 0x0, 0x0, 0x0, 0x0, 0x0
.long 0x0, 0x0, 0x0, 0x0, 0x0, 0x0, 0x0, 0x0
.long 0x0, 0x3c000000, 0x3c003c00, 0x0, 0x0, 0x0, 0x3c003c00, 0x3c00
.long 0x0, 0x0, 0x3c000000, 0x3c003c00, 0x0, 0x0, 0x0, 0x3c003c00
.long 0x0, 0x0, 0x0, 0x3c000000, 0x0, 0x0, 0x0, 0x0
.long 0x0, 0x0, 0x0, 0x0, 0x0, 0x0, 0x0, 0x0
.long 0x0, 0x0, 0x0, 0x0, 0x0, 0x0, 0x0, 0x0
.long 0x0, 0x0, 0x0, 0x0, 0x0, 0x0, 0x0, 0x0
.long 0x0, 0x0, 0x0, 0x0, 0x0, 0x0, 0x0, 0x0
.long 0x0, 0x0, 0x0, 0x0, 0x0, 0x0, 0x0, 0x0
.long 0x0, 0x0, 0x0, 0x0, 0x0, 0x0, 0x0, 0x0
.long 0x0, 0x0, 0x0, 0x0, 0x3c00, 0x0, 0x0, 0x0
.long 0x3c003c00, 0x0, 0x0, 0x0, 0x3c003c00, 0x3c00, 0x0, 0x0
.long 0x3c000000, 0x3c003c00, 0x0, 0x0, 0x0, 0x3c003c00, 0x3c00, 0x0
.long 0x0, 0x3c000000, 0x3c003c00, 0x0, 0x0, 0x0, 0x3c003c00, 0x3c00
.long 0x0, 0x0, 0x3c000000, 0x3c003c00, 0x0, 0x0, 0x0, 0x3c003c00
.long 0x0, 0x0, 0x0, 0x3c000000, 0x0, 0x0, 0x0, 0x0
.long 0x0, 0x0, 0x0, 0x0, 0x0, 0x0, 0x0, 0x0
.long 0x0, 0x0, 0x0, 0x0, 0x0, 0x0, 0x0, 0x0
.long 0x0, 0x0, 0x0, 0x0, 0x0, 0x0, 0x0, 0x0
.long 0x0, 0x0, 0x0, 0x0, 0x0, 0x0, 0x0, 0x0
.long 0x0, 0x0, 0x0, 0x0, 0x0, 0x0, 0x0, 0x0
.long 0x0, 0x0, 0x0, 0x0, 0x0, 0x0, 0x0, 0x0
.long 0x0, 0x0, 0x0, 0x0, 0x3c00, 0x0, 0x0, 0x0
.long 0x3c003c00, 0x0, 0x0, 0x0, 0x3c003c00, 0x3c00, 0x0, 0x0
.long 0x3c000000, 0x3c003c00, 0x0, 0x0, 0x0, 0x3c003c00, 0x3c00, 0x0
.long 0x0, 0x0, 0x0, 0x3c003c00, 0x0, 0x0, 0x0, 0x3c000000
.long 0x0, 0x0, 0x0, 0x0, 0x0, 0x0, 0x0, 0x0
.long 0x0, 0x0, 0x0, 0x0, 0x0, 0x0, 0x0, 0x0
.long 0x0, 0x0, 0x0, 0x0, 0x0, 0x0, 0x0, 0x0
.long 0x0, 0x0, 0x0, 0x0, 0x0, 0x0, 0x0, 0x0
.long 0x0, 0x0, 0x0, 0x0, 0x0, 0x0, 0x0, 0x0
.long 0x0, 0x0, 0x0, 0x0, 0x0, 0x0, 0x0, 0x0
.long 0x0, 0x0, 0x0, 0x0, 0x0, 0x0, 0x0, 0x0
.long 0x3c003c00, 0x3c00, 0x0, 0x0, 0x3c003c00, 0x3c003c00, 0x0, 0x0
.long 0x3c003c00, 0x3c003c00, 0x3c00, 0x0, 0x3c000000, 0x3c003c00, 0x3c003c00, 0x0
.long 0x0, 0x3c003c00, 0x3c003c00, 0x3c00, 0x0, 0x3c000000, 0x3c003c00, 0x3c003c00
.long 0x0, 0x0, 0x3c003c00, 0x3c003c00, 0x0, 0x0, 0x3c000000, 0x3c003c00
.long 0x0, 0x0, 0x0, 0x3c003c00, 0x0, 0x0, 0x0, 0x3c000000
.long 0x0, 0x0, 0x0, 0x0, 0x0, 0x0, 0x0, 0x0
.long 0x0, 0x0, 0x0, 0x0, 0x0, 0x0, 0x0, 0x0
.long 0x0, 0x0, 0x0, 0x0, 0x0, 0x0, 0x0, 0x0
.long 0x0, 0x0, 0x0, 0x0, 0x0, 0x0, 0x0, 0x0
.long 0x0, 0x0, 0x0, 0x0, 0x0, 0x0, 0x0, 0x0
.long 0x0, 0x0, 0x0, 0x0, 0x0, 0x0, 0x0, 0x0
.long 0x3c00, 0x0, 0x0, 0x0, 0x3c003c00, 0x0, 0x0, 0x0
.long 0x3c003c00, 0x3c00, 0x0, 0x0, 0x3c003c00, 0x3c003c00, 0x0, 0x0
.long 0x3c003c00, 0x3c003c00, 0x3c00, 0x0, 0x3c000000, 0x3c003c00, 0x3c003c00, 0x0
.long 0x0, 0x3c003c00, 0x3c003c00, 0x3c00, 0x0, 0x3c000000, 0x3c003c00, 0x3c003c00
.long 0x0, 0x0, 0x3c003c00, 0x3c003c00, 0x0, 0x0, 0x3c000000, 0x3c003c00
.long 0x0, 0x0, 0x0, 0x0, 0x0, 0x0, 0x0, 0x0
.long 0x0, 0x0, 0x0, 0x0, 0x0, 0x0, 0x0, 0x0
.long 0x0, 0x0, 0x0, 0x0, 0x0, 0x0, 0x0, 0x0
.long 0x0, 0x0, 0x0, 0x0, 0x0, 0x0, 0x0, 0x0
.long 0x0, 0x0, 0x0, 0x0, 0x0, 0x0, 0x0, 0x0
.long 0x0, 0x0, 0x0, 0x0, 0x0, 0x0, 0x0, 0x0
.long 0x0, 0x0, 0x0, 0x0, 0x0, 0x0, 0x0, 0x0
.long 0x3c00, 0x0, 0x0, 0x0, 0x3c003c00, 0x0, 0x0, 0x0
.long 0x0, 0x3c000000, 0x3c003c00, 0x0, 0x0, 0x0, 0x3c003c00, 0x3c00
.long 0x0, 0x0, 0x3c000000, 0x3c003c00, 0x0, 0x0, 0x0, 0x3c003c00
.long 0x0, 0x0, 0x0, 0x3c000000, 0x0, 0x0, 0x0, 0x0
.long 0x0, 0x0, 0x0, 0x0, 0x0, 0x0, 0x0, 0x0
.long 0x0, 0x0, 0x0, 0x0, 0x0, 0x0, 0x0, 0x0
.long 0x0, 0x0, 0x0, 0x0, 0x0, 0x0, 0x0, 0x0
.long 0x0, 0x0, 0x0, 0x0, 0x0, 0x0, 0x0, 0x0
.long 0x0, 0x0, 0x0, 0x0, 0x0, 0x0, 0x0, 0x0
.long 0x0, 0x0, 0x0, 0x0, 0x0, 0x0, 0x0, 0x0
.long 0x0, 0x0, 0x0, 0x0, 0x3c00, 0x0, 0x0, 0x0
.long 0x3c003c00, 0x0, 0x0, 0x0, 0x3c003c00, 0x3c00, 0x0, 0x0
.long 0x3c000000, 0x3c003c00, 0x0, 0x0, 0x0, 0x3c003c00, 0x3c00, 0x0
.long 0x0, 0x3c000000, 0x3c003c00, 0x0, 0x0, 0x0, 0x3c003c00, 0x3c00
.long 0x0, 0x0, 0x3c000000, 0x3c003c00, 0x0, 0x0, 0x0, 0x3c003c00
.long 0x0, 0x0, 0x0, 0x3c000000, 0x0, 0x0, 0x0, 0x0
.long 0x0, 0x0, 0x0, 0x0, 0x0, 0x0, 0x0, 0x0
.long 0x0, 0x0, 0x0, 0x0, 0x0, 0x0, 0x0, 0x0
.long 0x0, 0x0, 0x0, 0x0, 0x0, 0x0, 0x0, 0x0
.long 0x0, 0x0, 0x0, 0x0, 0x0, 0x0, 0x0, 0x0
.long 0x0, 0x0, 0x0, 0x0, 0x0, 0x0, 0x0, 0x0
.long 0x0, 0x0, 0x0, 0x0, 0x0, 0x0, 0x0, 0x0
.long 0x0, 0x0, 0x0, 0x0, 0x3c00, 0x0, 0x0, 0x0
.long 0x3c003c00, 0x0, 0x0, 0x0, 0x3c003c00, 0x3c00, 0x0, 0x0
.long 0x3c000000, 0x3c003c00, 0x0, 0x0, 0x0, 0x3c003c00, 0x3c00, 0x0
.long 0x0, 0x0, 0x0, 0x0, 0x0, 0x0, 0x0, 0x0
.long 0x0, 0x0, 0x0, 0x0, 0x0, 0x0, 0x0, 0x0
.long 0x0, 0x0, 0x0, 0x0, 0x0, 0x0, 0x0, 0x0
.long 0x0, 0x0, 0x0, 0x0, 0x0, 0x0, 0x0, 0x0
.long 0x0, 0x0, 0x0, 0x0, 0x0, 0x0, 0x0, 0x0
.long 0x0, 0x0, 0x0, 0x0, 0x0, 0x0, 0x0, 0x0
.long 0x0, 0x0, 0x0, 0x0, 0x0, 0x0, 0x0, 0x0
.long 0x0, 0x0, 0x0, 0x0, 0x0, 0x0, 0x0, 0x0
.long 0x0, 0x0, 0x0, 0x3c003c00, 0x0, 0x0, 0x0, 0x3c000000
.long 0x0, 0x0, 0x0, 0x0, 0x0, 0x0, 0x0, 0x0
.long 0x0, 0x0, 0x0, 0x0, 0x0, 0x0, 0x0, 0x0
.long 0x0, 0x0, 0x0, 0x0, 0x0, 0x0, 0x0, 0x0
.long 0x0, 0x0, 0x0, 0x0, 0x0, 0x0, 0x0, 0x0
.long 0x0, 0x0, 0x0, 0x0, 0x0, 0x0, 0x0, 0x0
.long 0x0, 0x0, 0x0, 0x0, 0x0, 0x0, 0x0, 0x0
.long 0x0, 0x0, 0x0, 0x0, 0x0, 0x0, 0x0, 0x0
.long 0x3c003c00, 0x3c00, 0x0, 0x0, 0x3c003c00, 0x3c003c00, 0x0, 0x0
.long 0x3c003c00, 0x3c003c00, 0x3c00, 0x0, 0x3c000000, 0x3c003c00, 0x3c003c00, 0x0
.long 0x0, 0x3c003c00, 0x3c003c00, 0x3c00, 0x0, 0x3c000000, 0x3c003c00, 0x3c003c00
.long 0x0, 0x0, 0x3c003c00, 0x3c003c00, 0x0, 0x0, 0x3c000000, 0x3c003c00
.long 0x0, 0x0, 0x0, 0x3c003c00, 0x0, 0x0, 0x0, 0x3c000000
.long 0x0, 0x0, 0x0, 0x0, 0x0, 0x0, 0x0, 0x0
.long 0x0, 0x0, 0x0, 0x0, 0x0, 0x0, 0x0, 0x0
.long 0x0, 0x0, 0x0, 0x0, 0x0, 0x0, 0x0, 0x0
.long 0x0, 0x0, 0x0, 0x0, 0x0, 0x0, 0x0, 0x0
.long 0x0, 0x0, 0x0, 0x0, 0x0, 0x0, 0x0, 0x0
.long 0x0, 0x0, 0x0, 0x0, 0x0, 0x0, 0x0, 0x0
.long 0x3c00, 0x0, 0x0, 0x0, 0x3c003c00, 0x0, 0x0, 0x0
.long 0x3c003c00, 0x3c00, 0x0, 0x0, 0x3c003c00, 0x3c003c00, 0x0, 0x0
.long 0x3c003c00, 0x3c003c00, 0x3c00, 0x0, 0x3c000000, 0x3c003c00, 0x3c003c00, 0x0
.long 0x0, 0x3c003c00, 0x3c003c00, 0x3c00, 0x0, 0x3c000000, 0x3c003c00, 0x3c003c00
.long 0x0, 0x0, 0x3c003c00, 0x3c003c00, 0x0, 0x0, 0x3c000000, 0x3c003c00
.long 0x0, 0x0, 0x0, 0x0, 0x0, 0x0, 0x0, 0x0
.long 0x0, 0x0, 0x0, 0x0, 0x0, 0x0, 0x0, 0x0
.long 0x0, 0x0, 0x0, 0x0, 0x0, 0x0, 0x0, 0x0
.long 0x0, 0x0, 0x0, 0x0, 0x0, 0x0, 0x0, 0x0
.long 0x0, 0x0, 0x0, 0x0, 0x0, 0x0, 0x0, 0x0
.long 0x0, 0x0, 0x0, 0x0, 0x0, 0x0, 0x0, 0x0
.long 0x0, 0x0, 0x0, 0x0, 0x0, 0x0, 0x0, 0x0
.long 0x3c00, 0x0, 0x0, 0x0, 0x3c003c00, 0x0, 0x0, 0x0
.long 0x0, 0x0, 0x3c000000, 0x3c003c00, 0x0, 0x0, 0x0, 0x3c003c00
.long 0x0, 0x0, 0x0, 0x3c000000, 0x0, 0x0, 0x0, 0x0
.long 0x0, 0x0, 0x0, 0x0, 0x0, 0x0, 0x0, 0x0
.long 0x0, 0x0, 0x0, 0x0, 0x0, 0x0, 0x0, 0x0
.long 0x0, 0x0, 0x0, 0x0, 0x0, 0x0, 0x0, 0x0
.long 0x0, 0x0, 0x0, 0x0, 0x0, 0x0, 0x0, 0x0
.long 0x0, 0x0, 0x0, 0x0, 0x0, 0x0, 0x0, 0x0
.long 0x0, 0x0, 0x0, 0x0, 0x0, 0x0, 0x0, 0x0
.long 0x3c003c00, 0x3c003c00, 0x0, 0x0, 0x3c003c00, 0x3c003c00, 0x3c00, 0x0
.long 0x3c003c00, 0x3c003c00, 0x3c003c00, 0x0, 0x3c003c00, 0x3c003c00, 0x3c003c00, 0x3c00
.long 0x3c000000, 0x3c003c00, 0x3c003c00, 0x3c003c00, 0x0, 0x3c003c00, 0x3c003c00, 0x3c003c00
.long 0x0, 0x3c000000, 0x3c003c00, 0x3c003c00, 0x0, 0x0, 0x3c003c00, 0x3c003c00
.long 0x0, 0x0, 0x3c000000, 0x3c003c00, 0x0, 0x0, 0x0, 0x3c003c00
.long 0x0, 0x0, 0x0, 0x3c000000, 0x0, 0x0, 0x0, 0x0
.long 0x0, 0x0, 0x0, 0x0, 0x0, 0x0, 0x0, 0x0
.long 0x0, 0x0, 0x0, 0x0, 0x0, 0x0, 0x0, 0x0
.long 0x0, 0x0, 0x0, 0x0, 0x0, 0x0, 0x0, 0x0
.long 0x0, 0x0, 0x0, 0x0, 0x0, 0x0, 0x0, 0x0
.long 0x0, 0x0, 0x0, 0x0, 0x3c00, 0x0, 0x0, 0x0
.long 0x3c003c00, 0x0, 0x0, 0x0, 0x3c003c00, 0x3c00, 0x0, 0x0
.long 0x3c003c00, 0x3c003c00, 0x0, 0x0, 0x3c003c00, 0x3c003c00, 0x3c00, 0x0
.long 0x3c003c00, 0x3c003c00, 0x3c003c00, 0x0, 0x3c003c00, 0x3c003c00, 0x3c003c00, 0x3c00
.long 0x3c000000, 0x3c003c00, 0x3c003c00, 0x3c003c00, 0x0, 0x3c003c00, 0x3c003c00, 0x3c003c00
.long 0x0, 0x3c000000, 0x3c003c00, 0x3c003c00, 0x0, 0x0, 0x3c003c00, 0x3c003c00
.long 0x0, 0x0, 0x0, 0x0, 0x0, 0x0, 0x0, 0x0
.long 0x0, 0x0, 0x0, 0x0, 0x0, 0x0, 0x0, 0x0
.long 0x0, 0x0, 0x0, 0x0, 0x0, 0x0, 0x0, 0x0
.long 0x0, 0x0, 0x0, 0x0, 0x0, 0x0, 0x0, 0x0
.long 0x0, 0x0, 0x0, 0x0, 0x0, 0x0, 0x0, 0x0
.long 0x0, 0x0, 0x0, 0x0, 0x0, 0x0, 0x0, 0x0
.long 0x0, 0x0, 0x0, 0x0, 0x3c00, 0x0, 0x0, 0x0
.long 0x3c003c00, 0x0, 0x0, 0x0, 0x3c003c00, 0x3c00, 0x0, 0x0
.long 0x0, 0x0, 0x3c003c00, 0x3c003c00, 0x0, 0x0, 0x3c000000, 0x3c003c00
.long 0x0, 0x0, 0x0, 0x3c003c00, 0x0, 0x0, 0x0, 0x3c000000
.long 0x0, 0x0, 0x0, 0x0, 0x0, 0x0, 0x0, 0x0
.long 0x0, 0x0, 0x0, 0x0, 0x0, 0x0, 0x0, 0x0
.long 0x0, 0x0, 0x0, 0x0, 0x0, 0x0, 0x0, 0x0
.long 0x0, 0x0, 0x0, 0x0, 0x0, 0x0, 0x0, 0x0
.long 0x0, 0x0, 0x0, 0x0, 0x0, 0x0, 0x0, 0x0
.long 0x0, 0x0, 0x0, 0x0, 0x0, 0x0, 0x0, 0x0
.long 0x3c003c00, 0x3c003c00, 0x3c00, 0x0, 0x3c003c00, 0x3c003c00, 0x3c003c00, 0x0
.long 0x3c003c00, 0x3c003c00, 0x3c003c00, 0x3c00, 0x3c003c00, 0x3c003c00, 0x3c003c00, 0x3c003c00
.long 0x3c003c00, 0x3c003c00, 0x3c003c00, 0x3c003c00, 0x3c000000, 0x3c003c00, 0x3c003c00, 0x3c003c00
.long 0x0, 0x3c003c00, 0x3c003c00, 0x3c003c00, 0x0, 0x3c000000, 0x3c003c00, 0x3c003c00
.long 0x0, 0x0, 0x3c003c00, 0x3c003c00, 0x0, 0x0, 0x3c000000, 0x3c003c00
.long 0x0, 0x0, 0x0, 0x3c003c00, 0x0, 0x0, 0x0, 0x3c000000
.long 0x0, 0x0, 0x0, 0x0, 0x0, 0x0, 0x0, 0x0
.long 0x0, 0x0, 0x0, 0x0, 0x0, 0x0, 0x0, 0x0
.long 0x0, 0x0, 0x0, 0x0, 0x0, 0x0, 0x0, 0x0
.long 0x0, 0x0, 0x0, 0x0, 0x0, 0x0, 0x0, 0x0
.long 0x3c00, 0x0, 0x0, 0x0, 0x3c003c00, 0x0, 0x0, 0x0
.long 0x3c003c00, 0x3c00, 0x0, 0x0, 0x3c003c00, 0x3c003c00, 0x0, 0x0
.long 0x3c003c00, 0x3c003c00, 0x3c00, 0x0, 0x3c003c00, 0x3c003c00, 0x3c003c00, 0x0
.long 0x3c003c00, 0x3c003c00, 0x3c003c00, 0x3c00, 0x3c003c00, 0x3c003c00, 0x3c003c00, 0x3c003c00
.long 0x3c003c00, 0x3c003c00, 0x3c003c00, 0x3c003c00, 0x3c000000, 0x3c003c00, 0x3c003c00, 0x3c003c00
.long 0x0, 0x3c003c00, 0x3c003c00, 0x3c003c00, 0x0, 0x3c000000, 0x3c003c00, 0x3c003c00
.long 0x0, 0x0, 0x0, 0x0, 0x0, 0x0, 0x0, 0x0
.long 0x0, 0x0, 0x0, 0x0, 0x0, 0x0, 0x0, 0x0
.long 0x0, 0x0, 0x0, 0x0, 0x0, 0x0, 0x0, 0x0
.long 0x0, 0x0, 0x0, 0x0, 0x0, 0x0, 0x0, 0x0
.long 0x0, 0x0, 0x0, 0x0, 0x0, 0x0, 0x0, 0x0
.long 0x0, 0x0, 0x0, 0x0, 0x0, 0x0, 0x0, 0x0
.long 0x3c00, 0x0, 0x0, 0x0, 0x3c003c00, 0x0, 0x0, 0x0
.long 0x3c003c00, 0x3c00, 0x0, 0x0, 0x3c003c00, 0x3c003c00, 0x0, 0x0
.long 0x0, 0x0, 0x0, 0x0, 0x0, 0x0, 0x0, 0x0
.long 0x0, 0x0, 0x0, 0x0, 0x0, 0x0, 0x0, 0x0
.long 0x0, 0x0, 0x0, 0x0, 0x0, 0x0, 0x0, 0x0
.long 0x0, 0x0, 0x0, 0x0, 0x0, 0x0, 0x0, 0x0
.long 0x0, 0x0, 0x0, 0x0, 0x0, 0x0, 0x0, 0x0
.long 0x0, 0x0, 0x0, 0x0, 0x0, 0x0, 0x0, 0x0
.long 0x0, 0x0, 0x0, 0x0, 0x0, 0x0, 0x0, 0x0
.long 0x0, 0x0, 0x0, 0x0, 0x0, 0x0, 0x0, 0x0
.long 0x0, 0x0, 0xffffffff, 0x0, 0x0, 0x0, 0xffff0000, 0xffff
.long 0x0, 0x0, 0x0, 0xffffffff, 0x0, 0x0, 0x0, 0xffff0000
.long 0x0, 0x0, 0x0, 0x0, 0x0, 0x0, 0x0, 0x0
.long 0x0, 0x0, 0x0, 0x0, 0x0, 0x0, 0x0, 0x0
.long 0x0, 0x0, 0x0, 0x0, 0x0, 0x0, 0x0, 0x0
.long 0x0, 0x0, 0x0, 0x0, 0x0, 0x0, 0x0, 0x0
.long 0x0, 0x0, 0x0, 0x0, 0x0, 0x0, 0x0, 0x0
.long 0x0, 0x0, 0x0, 0x0, 0x0, 0x0, 0x0, 0x0
.long 0x0, 0x0, 0x0, 0x0, 0x0, 0x0, 0x0, 0x0
.long 0x0, 0x0, 0x0, 0x0, 0xffff, 0x0, 0x0, 0x0
.long 0xffffffff, 0x0, 0x0, 0x0, 0xffff0000, 0xffff, 0x0, 0x0
.long 0x0, 0xffffffff, 0x0, 0x0, 0x0, 0xffff0000, 0xffff, 0x0
.long 0x0, 0x0, 0xffffffff, 0x0, 0x0, 0x0, 0xffff0000, 0xffff
.long 0x0, 0x0, 0x0, 0xffffffff, 0x0, 0x0, 0x0, 0xffff0000
.long 0x0, 0x0, 0x0, 0x0, 0x0, 0x0, 0x0, 0x0
.long 0x0, 0x0, 0x0, 0x0, 0x0, 0x0, 0x0, 0x0
.long 0x0, 0x0, 0x0, 0x0, 0x0, 0x0, 0x0, 0x0
.long 0x0, 0x0, 0x0, 0x0, 0x0, 0x0, 0x0, 0x0
.long 0x0, 0x0, 0x0, 0x0, 0x0, 0x0, 0x0, 0x0
.long 0x0, 0x0, 0x0, 0x0, 0x0, 0x0, 0x0, 0x0
.long 0x0, 0x0, 0x0, 0x0, 0x0, 0x0, 0x0, 0x0
.long 0x0, 0x0, 0x0, 0x0, 0xffff, 0x0, 0x0, 0x0
.long 0xffffffff, 0x0, 0x0, 0x0, 0xffff0000, 0xffff, 0x0, 0x0
.long 0x0, 0xffffffff, 0x0, 0x0, 0x0, 0xffff0000, 0xffff, 0x0
.long 0x8f8, 0x8fc, 0x438, 0x436, 0x8e8, 0x8ec, 0x428, 0x426
.long 0x8d8, 0x8dc, 0x418, 0x416, 0x8c8, 0x8cc, 0x408, 0x406
.long 0x8b8, 0x8bc, 0x3f8, 0x3f6, 0x8a8, 0x8ac, 0x3e8, 0x3e6
.long 0x898, 0x89c, 0x3d8, 0x3d6, 0x888, 0x88c, 0x3c8, 0x3c6
.long 0x878, 0x87c, 0x3b8, 0x3b6, 0x868, 0x86c, 0x3a8, 0x3a6
.long 0x858, 0x85c, 0x398, 0x396, 0x848, 0x84c, 0x388, 0x386
.long 0x838, 0x83c, 0x378, 0x376, 0x828, 0x82c, 0x368, 0x366
.long 0x818, 0x81c, 0x358, 0x356, 0x808, 0x80c, 0x348, 0x346
.long 0x8f0, 0x8f4, 0x430, 0x42e, 0x8e0, 0x8e4, 0x420, 0x41e
.long 0x8d0, 0x8d4, 0x410, 0x40e, 0x8c0, 0x8c4, 0x400, 0x3fe
.long 0x8b0, 0x8b4, 0x3f0, 0x3ee, 0x8a0, 0x8a4, 0x3e0, 0x3de
.long 0x890, 0x894, 0x3d0, 0x3ce, 0x880, 0x884, 0x3c0, 0x3be
.long 0x870, 0x874, 0x3b0, 0x3ae, 0x860, 0x864, 0x3a0, 0x39e
.long 0x850, 0x854, 0x390, 0x38e, 0x840, 0x844, 0x380, 0x37e
.long 0x830, 0x834, 0x370, 0x36e, 0x820, 0x824, 0x360, 0x35e
.long 0x810, 0x814, 0x350, 0x34e, 0x800, 0x804, 0x340, 0x33e
.long 0x230, 0x238, 0x6f4, 0x6ee, 0x220, 0x228, 0x6e4, 0x6de
.long 0x210, 0x218, 0x6d4, 0x6ce, 0x200, 0x208, 0x6c4, 0x6be
.long 0x1f0, 0x1f8, 0x6b4, 0x6ae, 0x1e0, 0x1e8, 0x6a4, 0x69e
.long 0x1d0, 0x1d8, 0x694, 0x68e, 0x1c0, 0x1c8, 0x684, 0x67e
.long 0x1b0, 0x1b8, 0x674, 0x66e, 0x1a0, 0x1a8, 0x664, 0x65e
.long 0x190, 0x198, 0x654, 0x64e, 0x180, 0x188, 0x644, 0x63e
.long 0x170, 0x178, 0x634, 0x62e, 0x160, 0x168, 0x624, 0x61e
.long 0x150, 0x158, 0x614, 0x60e, 0x140, 0x148, 0x604, 0x5fe
.long 0x9bc, 0x9fc, 0xc80, 0xc80, 0xabc, 0xafc, 0xc80, 0xc80
.long 0x9b8, 0x9f8, 0xc80, 0xc80, 0xab8, 0xaf8, 0xc80, 0xc80
.long 0x9b4, 0x9f4, 0xc80, 0xc80, 0xab4, 0xaf4, 0xc80, 0xc80
.long 0x9b0, 0x9f0, 0xc80, 0xc80, 0xab0, 0xaf0, 0xc80, 0xc80
.long 0x9ac, 0x9ec, 0xc80, 0xc80, 0xaac, 0xaec, 0xc80, 0xc80
.long 0x9a8, 0x9e8, 0xc80, 0xc80, 0xaa8, 0xae8, 0xc80, 0xc80
.long 0x9a4, 0x9e4, 0xc80, 0xc80, 0xaa4, 0xae4, 0xc80, 0xc80
.long 0x9a0, 0x9e0, 0xc80, 0xc80, 0xaa0, 0xae0, 0xc80, 0xc80
.long 0x43c, 0xc80, 0xc80, 0xc80, 0x42c, 0xc80, 0xc80, 0xc80
.long 0x41c, 0xc80, 0xc80, 0xc80, 0x40c, 0xc80, 0xc80, 0xc80
.long 0x3fc, 0xc80, 0xc80, 0xc80, 0x3ec, 0xc80, 0xc80, 0xc80
.long 0x3dc, 0xc80, 0xc80, 0xc80, 0x3cc, 0xc80, 0xc80, 0xc80
.long 0x3bc, 0xc80, 0xc80, 0xc80, 0x3ac, 0xc80, 0xc80, 0xc80
.long 0x39c, 0xc80, 0xc80, 0xc80, 0x38c, 0xc80, 0xc80, 0xc80
.long 0x37c, 0xc80, 0xc80, 0xc80, 0x36c, 0xc80, 0xc80, 0xc80
.long 0x35c, 0xc80, 0xc80, 0xc80, 0x34c, 0xc80, 0xc80, 0xc80
.long 0x434, 0xc80, 0xc80, 0xc80, 0x424, 0xc80, 0xc80, 0xc80
.long 0x414, 0xc80, 0xc80, 0xc80, 0x404, 0xc80, 0xc80, 0xc80
.long 0x3f4, 0xc80, 0xc80, 0xc80, 0x3e4, 0xc80, 0xc80, 0xc80
.long 0x3d4, 0xc80, 0xc80, 0xc80, 0x3c4, 0xc80, 0xc80, 0xc80
.long 0x3b4, 0xc80, 0xc80, 0xc80, 0x3a4, 0xc80, 0xc80, 0xc80
.long 0x394, 0xc80, 0xc80, 0xc80, 0x384, 0xc80, 0xc80, 0xc80
.long 0x374, 0xc80, 0xc80, 0xc80, 0x364, 0xc80, 0xc80, 0xc80
.long 0x354, 0xc80, 0xc80, 0xc80, 0x344, 0xc80, 0xc80, 0xc80
.long 0x6fc, 0x22c, 0x234, 0x6f0, 0x6ec, 0x21c, 0x224, 0x6e0
.long 0x6dc, 0x20c, 0x214, 0x6d0, 0x6cc, 0x1fc, 0x204, 0x6c0
.long 0x6bc, 0x1ec, 0x1f4, 0x6b0, 0x6ac, 0x1dc, 0x1e4, 0x6a0
.long 0x69c, 0x1cc, 0x1d4, 0x690, 0x68c, 0x1bc, 0x1c4, 0x680
.long 0x67c, 0x1ac, 0x1b4, 0x670, 0x66c, 0x19c, 0x1a4, 0x660
.long 0x65c, 0x18c, 0x194, 0x650, 0x64c, 0x17c, 0x184, 0x640
.long 0x63c, 0x16c, 0x174, 0x630, 0x62c, 0x15c, 0x164, 0x620
.long 0x61c, 0x14c, 0x154, 0x610, 0x60c, 0x13c, 0x144, 0x600
.long 0xc80, 0xc80, 0xc80, 0xc80, 0xc80, 0xc80, 0xc80, 0xc80
.long 0xc80, 0xc80, 0xc80, 0xc80, 0xc80, 0xc80, 0xc80, 0xc80
.long 0xc80, 0xc80, 0xc80, 0xc80, 0xc80, 0xc80, 0xc80, 0xc80
.long 0xc80, 0xc80, 0xc80, 0xc80, 0xc80, 0xc80, 0xc80, 0xc80
.long 0xc80, 0xc80, 0xc80, 0xc80, 0xc80, 0xc80, 0xc80, 0xc80
.long 0xc80, 0xc80, 0xc80, 0xc80, 0xc80, 0xc80, 0xc80, 0xc80
.long 0xc80, 0xc80, 0xc80, 0xc80, 0xc80, 0xc80, 0xc80, 0xc80
.long 0xc80, 0xc80, 0xc80, 0xc80, 0xc80, 0xc80, 0xc80, 0xc80
.long 0xc80, 0xc80, 0xc3c, 0xbfc, 0xc80, 0xc80, 0xc3e, 0xbfe
.long 0xc80, 0xc80, 0xc38, 0xbf8, 0xc80, 0xc80, 0xc3a, 0xbfa
.long 0xc80, 0xc80, 0xc34, 0xbf4, 0xc80, 0xc80, 0xc36, 0xbf6
.long 0xc80, 0xc80, 0xc30, 0xbf0, 0xc80, 0xc80, 0xc32, 0xbf2
.long 0xc80, 0xc80, 0xc2c, 0xbec, 0xc80, 0xc80, 0xc2e, 0xbee
.long 0xc80, 0xc80, 0xc28, 0xbe8, 0xc80, 0xc80, 0xc2a, 0xbea
.long 0xc80, 0xc80, 0xc24, 0xbe4, 0xc80, 0xc80, 0xc26, 0xbe6
.long 0xc80, 0xc80, 0xc20, 0xbe0, 0xc80, 0xc80, 0xc22, 0xbe2
.long 0xc80, 0xc80, 0x43e, 0x900, 0xc80, 0xc80, 0xc80, 0xc80
.long 0xc80, 0xc80, 0xc80, 0xc80, 0xc80, 0xc80, 0xc80, 0xc80
.long 0xc80, 0xc80, 0xc80, 0xc80, 0xc80, 0xc80, 0xc80, 0xc80
.long 0xc80, 0xc80, 0xc80, 0xc80, 0xc80, 0xc80, 0xc80, 0xc80
.long 0xc80, 0xc80, 0xc80, 0xc80, 0xc80, 0xc80, 0xc80, 0xc80
.long 0xc80, 0xc80, 0xc80, 0xc80, 0xc80, 0xc80, 0xc80, 0xc80
.long 0xc80, 0xc80, 0xc80, 0xc80, 0xc80, 0xc80, 0xc80, 0xc80
.long 0xc80, 0xc80, 0xc80, 0xc80, 0xc80, 0xc80, 0xc80, 0xc80
.long 0x6f8, 0xc80, 0xc80, 0xc80, 0x6e8, 0xc80, 0xc80, 0xc80
.long 0x6d8, 0xc80, 0xc80, 0xc80, 0x6c8, 0xc80, 0xc80, 0xc80
.long 0x6b8, 0xc80, 0xc80, 0xc80, 0x6a8, 0xc80, 0xc80, 0xc80
.long 0x698, 0xc80, 0xc80, 0xc80, 0x688, 0xc80, 0xc80, 0xc80
.long 0x678, 0xc80, 0xc80, 0xc80, 0x668, 0xc80, 0xc80, 0xc80
.long 0x658, 0xc80, 0xc80, 0xc80, 0x648, 0xc80, 0xc80, 0xc80
.long 0x638, 0xc80, 0xc80, 0xc80, 0x628, 0xc80, 0xc80, 0xc80
.long 0x618, 0xc80, 0xc80, 0xc80, 0x608, 0xc80, 0xc80, 0xc80
.long 0xc80, 0xc80, 0xc80, 0xc80, 0xc80, 0xc80, 0xc80, 0xc80
.long 0xc80, 0xc80, 0xc80, 0xc80, 0xc80, 0xc80, 0xc80, 0xc80
.long 0xc80, 0xc80, 0xc80, 0xc80, 0xc80, 0xc80, 0xc80, 0xc80
.long 0xc80, 0xc80, 0xc80, 0xc80, 0xc80, 0xc80, 0xc80, 0xc80
.long 0xc80, 0xc80, 0xc80, 0xc80, 0xc80, 0xc80, 0xc80, 0xc80
.long 0xc80, 0xc80, 0xc80, 0xc80, 0xc80, 0xc80, 0xc80, 0xc80
.long 0xc80, 0xc80, 0xc80, 0xc80, 0xc80, 0xc80, 0xc80, 0xc80
.long 0xc80, 0xc80, 0xc80, 0xc80, 0xc80, 0xc80, 0xc80, 0xc80
.long 0xbbc, 0xb7c, 0xc80, 0xc80, 0xbbe, 0xb7e, 0xc80, 0xc80
.long 0xbb8, 0xb78, 0xc80, 0xc80, 0xbba, 0xb7a, 0xc80, 0xc80
.long 0xbb4, 0xb74, 0xc80, 0xc80, 0xbb6, 0xb76, 0xc80, 0xc80
.long 0xbb0, 0xb70, 0xc80, 0xc80, 0xbb2, 0xb72, 0xc80, 0xc80
.long 0xbac, 0xb6c, 0xc80, 0xc80, 0xbae, 0xb6e, 0xc80, 0xc80
.long 0xba8, 0xb68, 0xc80, 0xc80, 0xbaa, 0xb6a, 0xc80, 0xc80
.long 0xba4, 0xb64, 0xc80, 0xc80, 0xba6, 0xb66, 0xc80, 0xc80
.long 0xba0, 0xb60, 0xc80, 0xc80, 0xba2, 0xb62, 0xc80, 0xc80
.long 0xc80, 0xc80, 0xc80, 0xc80, 0xc80, 0xc80, 0xc80, 0xc80
.long 0xc80, 0xc80, 0xc80, 0xc80, 0xc80, 0xc80, 0xc80, 0xc80
.long 0xc80, 0xc80, 0xc80, 0xc80, 0xc80, 0xc80, 0xc80, 0xc80
.long 0xc80, 0xc80, 0xc80, 0xc80, 0xc80, 0xc80, 0xc80, 0xc80
.long 0xc80, 0xc80, 0xc80, 0xc80, 0xc80, 0xc80, 0xc80, 0xc80
.long 0xc80, 0xc80, 0xc80, 0xc80, 0xc80, 0xc80, 0xc80, 0xc80
.long 0xc80, 0xc80, 0xc80, 0xc80, 0xc80, 0xc80, 0xc80, 0xc80
.long 0xc80, 0xc80, 0xc80, 0xc80, 0xc80, 0xc80, 0xc80, 0xc80
.long 0xc80, 0xc80, 0xc80, 0xc80, 0xc80, 0xc80, 0xc80, 0xc80
.long 0xc80, 0xc80, 0xc80, 0xc80, 0xc80, 0xc80, 0xc80, 0xc80
.long 0xc80, 0xc80, 0xc80, 0xc80, 0xc80, 0xc80, 0xc80, 0xc80
.long 0xc80, 0xc80, 0xc80, 0xc80, 0xc80, 0xc80, 0xc80, 0xc80
.long 0xc80, 0xc80, 0xc80, 0xc80, 0xc80, 0xc80, 0xc80, 0xc80
.long 0xc80, 0xc80, 0xc80, 0xc80, 0xc80, 0xc80, 0xc80, 0xc80
.long 0xc80, 0xc80, 0xc80, 0xc80, 0xc80, 0xc80, 0xc80, 0xc80
.long 0xc80, 0xc80, 0xc80, 0xc80, 0xc80, 0xc80, 0xc80, 0xc80
.long 0xc80, 0xc80, 0xc80, 0xc80, 0xc80, 0xc80, 0xc80, 0xc80
.long 0xc80, 0xc80, 0xc80, 0xc80, 0xc80, 0xc80, 0xc80, 0xc80
.long 0xc80, 0xc80, 0xc80, 0xc80, 0xc80, 0xc80, 0xc80, 0xc80
.long 0xc80, 0xc80, 0xc80, 0xc80, 0xc80, 0xc80, 0xc80, 0xc80
.long 0xc80, 0xc80, 0xc80, 0xc80, 0xc80, 0xc80, 0xc80, 0xc80
.long 0xc80, 0xc80, 0xc80, 0xc80, 0xc80, 0xc80, 0xc80, 0xc80
.long 0xc80, 0xc80, 0xc80, 0xc80, 0xc80, 0xc80, 0xc80, 0xc80
.long 0xc80, 0xc80, 0xc80, 0xc80, 0xc80, 0xc80, 0xc80, 0xc80
.long 0x7f8, 0x7fc, 0x338, 0x336, 0x7e8, 0x7ec, 0x328, 0x326
.long 0x7d8, 0x7dc, 0x318, 0x316, 0x7c8, 0x7cc, 0x308, 0x306
.long 0x7b8, 0x7bc, 0x2f8, 0x2f6, 0x7a8, 0x7ac, 0x2e8, 0x2e6
.long 0x798, 0x79c, 0x2d8, 0x2d6, 0x788, 0x78c, 0x2c8, 0x2c6
.long 0x778, 0x77c, 0x2b8, 0x2b6, 0x768, 0x76c, 0x2a8, 0x2a6
.long 0x758, 0x75c, 0x298, 0x296, 0x748, 0x74c, 0x288, 0x286
.long 0x738, 0x73c, 0x278, 0x276, 0x728, 0x72c, 0x268, 0x266
.long 0x718, 0x71c, 0x258, 0x256, 0x708, 0x70c, 0x248, 0x246
.long 0x7f0, 0x7f4, 0x330, 0x32e, 0x7e0, 0x7e4, 0x320, 0x31e
.long 0x7d0, 0x7d4, 0x310, 0x30e, 0x7c0, 0x7c4, 0x300, 0x2fe
.long 0x7b0, 0x7b4, 0x2f0, 0x2ee, 0x7a0, 0x7a4, 0x2e0, 0x2de
.long 0x790, 0x794, 0x2d0, 0x2ce, 0x780, 0x784, 0x2c0, 0x2be
.long 0x770, 0x774, 0x2b0, 0x2ae, 0x760, 0x764, 0x2a0, 0x29e
.long 0x750, 0x754, 0x290, 0x28e, 0x740, 0x744, 0x280, 0x27e
.long 0x730, 0x734, 0x270, 0x26e, 0x720, 0x724, 0x260, 0x25e
.long 0x710, 0x714, 0x250, 0x24e, 0x700, 0x704, 0x240, 0x6fe
.long 0x130, 0x138, 0x5f4, 0x5ee, 0x120, 0x128, 0x5e4, 0x5de
.long 0x110, 0x118, 0x5d4, 0x5ce, 0x100, 0x108, 0x5c4, 0x5be
.long 0xf0, 0xf8, 0x5b4, 0x5ae, 0xe0, 0xe8, 0x5a4, 0x59e
.long 0xd0, 0xd8, 0x594, 0x58e, 0xc0, 0xc8, 0x584, 0x57e
.long 0xb0, 0xb8, 0x574, 0x56e, 0xa0, 0xa8, 0x564, 0x55e
.long 0x90, 0x98, 0x554, 0x54e, 0x80, 0x88, 0x544, 0x53e
.long 0x70, 0x78, 0x534, 0x52e, 0x60, 0x68, 0x524, 0x51e
.long 0x50, 0x58, 0x514, 0x50e, 0x40, 0x48, 0x504, 0x3a
.long 0x99c, 0x9dc, 0xc80, 0xc80, 0xa9c, 0xadc, 0xc80, 0xc80
.long 0x998, 0x9d8, 0xc80, 0xc80, 0xa98, 0xad8, 0xc80, 0xc80
.long 0x994, 0x9d4, 0xc80, 0xc80, 0xa94, 0xad4, 0xc80, 0xc80
.long 0x990, 0x9d0, 0xc80, 0xc80, 0xa90, 0xad0, 0xc80, 0xc80
.long 0x98c, 0x9cc, 0xc80, 0xc80, 0xa8c, 0xacc, 0xc80, 0xc80
.long 0x988, 0x9c8, 0xc80, 0xc80, 0xa88, 0xac8, 0xc80, 0xc80
.long 0x984, 0x9c4, 0xc80, 0xc80, 0xa84, 0xac4, 0xc80, 0xc80
.long 0x980, 0x9c0, 0xc80, 0xc80, 0xa80, 0xac0, 0xc80, 0xc80
.long 0x33c, 0xc80, 0xc80, 0xc80, 0x32c, 0xc80, 0xc80, 0xc80
.long 0x31c, 0xc80, 0xc80, 0xc80, 0x30c, 0xc80, 0xc80, 0xc80
.long 0x2fc, 0xc80, 0xc80, 0xc80, 0x2ec, 0xc80, 0xc80, 0xc80
.long 0x2dc, 0xc80, 0xc80, 0xc80, 0x2cc, 0xc80, 0xc80, 0xc80
.long 0x2bc, 0xc80, 0xc80, 0xc80, 0x2ac, 0xc80, 0xc80, 0xc80
.long 0x29c, 0xc80, 0xc80, 0xc80, 0x28c, 0xc80, 0xc80, 0xc80
.long 0x27c, 0xc80, 0xc80, 0xc80, 0x26c, 0xc80, 0xc80, 0xc80
.long 0x25c, 0xc80, 0xc80, 0xc80, 0x24c, 0xc80, 0xc80, 0xc80
.long 0x334, 0xc80, 0xc80, 0xc80, 0x324, 0xc80, 0xc80, 0xc80
.long 0x314, 0xc80, 0xc80, 0xc80, 0x304, 0xc80, 0xc80, 0xc80
.long 0x2f4, 0xc80, 0xc80, 0xc80, 0x2e4, 0xc80, 0xc80, 0xc80
.long 0x2d4, 0xc80, 0xc80, 0xc80, 0x2c4, 0xc80, 0xc80, 0xc80
.long 0x2b4, 0xc80, 0xc80, 0xc80, 0x2a4, 0xc80, 0xc80, 0xc80
.long 0x294, 0xc80, 0xc80, 0xc80, 0x284, 0xc80, 0xc80, 0xc80
.long 0x274, 0xc80, 0xc80, 0xc80, 0x264, 0xc80, 0xc80, 0xc80
.long 0x254, 0xc80, 0xc80, 0xc80, 0x244, 0xc80, 0xc80, 0x23c
.long 0x5fc, 0x12c, 0x134, 0x5f0, 0x5ec, 0x11c, 0x124, 0x5e0
.long 0x5dc, 0x10c, 0x114, 0x5d0, 0x5cc, 0xfc, 0x104, 0x5c0
.long 0x5bc, 0xec, 0xf4, 0x5b0, 0x5ac, 0xdc, 0xe4, 0x5a0
.long 0x59c, 0xcc, 0xd4, 0x590, 0x58c, 0xbc, 0xc4, 0x580
.long 0x57c, 0xac, 0xb4, 0x570, 0x56c, 0x9c, 0xa4, 0x560
.long 0x55c, 0x8c, 0x94, 0x550, 0x54c, 0x7c, 0x84, 0x540
.long 0x53c, 0x6c, 0x74, 0x530, 0x52c, 0x5c, 0x64, 0x520
.long 0x51c, 0x4c, 0x54, 0x510, 0x50c, 0x3c, 0x44, 0x500
.long 0xc80, 0xc80, 0xc80, 0xc80, 0xc80, 0xc80, 0xc80, 0xc80
.long 0xc80, 0xc80, 0xc80, 0xc80, 0xc80, 0xc80, 0xc80, 0xc80
.long 0xc80, 0xc80, 0xc80, 0xc80, 0xc80, 0xc80, 0xc80, 0xc80
.long 0xc80, 0xc80, 0xc80, 0xc80, 0xc80, 0xc80, 0xc80, 0xc80
.long 0xc80, 0xc80, 0xc80, 0xc80, 0xc80, 0xc80, 0xc80, 0xc80
.long 0xc80, 0xc80, 0xc80, 0xc80, 0xc80, 0xc80, 0xc80, 0xc80
.long 0xc80, 0xc80, 0xc80, 0xc80, 0xc80, 0xc80, 0xc80, 0xc80
.long 0xc80, 0xc80, 0xc80, 0xc80, 0xc80, 0xc80, 0xc80, 0xc80
.long 0xc80, 0xc80, 0xc1c, 0xbdc, 0xc80, 0xc80, 0xc1e, 0xbde
.long 0xc80, 0xc80, 0xc18, 0xbd8, 0xc80, 0xc80, 0xc1a, 0xbda
.long 0xc80, 0xc80, 0xc14, 0xbd4, 0xc80, 0xc80, 0xc16, 0xbd6
.long 0xc80, 0xc80, 0xc10, 0xbd0, 0xc80, 0xc80, 0xc12, 0xbd2
.long 0xc80, 0xc80, 0xc0c, 0xbcc, 0xc80, 0xc80, 0xc0e, 0xbce
.long 0xc80, 0xc80, 0xc08, 0xbc8, 0xc80, 0xc80, 0xc0a, 0xbca
.long 0xc80, 0xc80, 0xc04, 0xbc4, 0xc80, 0xc80, 0xc06, 0xbc6
.long 0xc80, 0xc80, 0xc00, 0xbc0, 0xc80, 0xc80, 0xc02, 0xbc2
.long 0xc80, 0xc80, 0xc80, 0xc80, 0xc80, 0xc80, 0xc80, 0xc80
.long 0xc80, 0xc80, 0xc80, 0xc80, 0xc80, 0xc80, 0xc80, 0xc80
.long 0xc80, 0xc80, 0xc80, 0xc80, 0xc80, 0xc80, 0xc80, 0xc80
.long 0xc80, 0xc80, 0xc80, 0xc80, 0xc80, 0xc80, 0xc80, 0xc80
.long 0xc80, 0xc80, 0xc80, 0xc80, 0xc80, 0xc80, 0xc80, 0xc80
.long 0xc80, 0xc80, 0xc80, 0xc80, 0xc80, 0xc80, 0xc80, 0xc80
.long 0xc80, 0xc80, 0xc80, 0xc80, 0xc80, 0xc80, 0xc80, 0xc80
.long 0xc80, 0xc80, 0xc80, 0xc80, 0xc80, 0xc80, 0xc80, 0xc80
.long 0x5f8, 0xc80, 0xc80, 0xc80, 0x5e8, 0xc80, 0xc80, 0xc80
.long 0x5d8, 0xc80, 0xc80, 0xc80, 0x5c8, 0xc80, 0xc80, 0xc80
.long 0x5b8, 0xc80, 0xc80, 0xc80, 0x5a8, 0xc80, 0xc80, 0xc80
.long 0x598, 0xc80, 0xc80, 0xc80, 0x588, 0xc80, 0xc80, 0xc80
.long 0x578, 0xc80, 0xc80, 0xc80, 0x568, 0xc80, 0xc80, 0xc80
.long 0x558, 0xc80, 0xc80, 0xc80, 0x548, 0xc80, 0xc80, 0xc80
.long 0x538, 0xc80, 0xc80, 0xc80, 0x528, 0xc80, 0xc80, 0xc80
.long 0x518, 0xc80, 0xc80, 0xc80, 0x508, 0x4fc, 0xc80, 0xc80
.long 0xc80, 0xc80, 0xc80, 0xc80, 0xc80, 0xc80, 0xc80, 0xc80
.long 0xc80, 0xc80, 0xc80, 0xc80, 0xc80, 0xc80, 0xc80, 0xc80
.long 0xc80, 0xc80, 0xc80, 0xc80, 0xc80, 0xc80, 0xc80, 0xc80
.long 0xc80, 0xc80, 0xc80, 0xc80, 0xc80, 0xc80, 0xc80, 0xc80
.long 0xc80, 0xc80, 0xc80, 0xc80, 0xc80, 0xc80, 0xc80, 0xc80
.long 0xc80, 0xc80, 0xc80, 0xc80, 0xc80, 0xc80, 0xc80, 0xc80
.long 0xc80, 0xc80, 0xc80, 0xc80, 0xc80, 0xc80, 0xc80, 0xc80
.long 0xc80, 0xc80, 0xc80, 0xc80, 0xc80, 0xc80, 0xc80, 0xc80
.long 0xb9c, 0xb5c, 0xc80, 0xc80, 0xb9e, 0xb5e, 0xc80, 0xc80
.long 0xb98, 0xb58, 0xc80, 0xc80, 0xb9a, 0xb5a, 0xc80, 0xc80
.long 0xb94, 0xb54, 0xc80, 0xc80, 0xb96, 0xb56, 0xc80, 0xc80
.long 0xb90, 0xb50, 0xc80, 0xc80, 0xb92, 0xb52, 0xc80, 0xc80
.long 0xb8c, 0xb4c, 0xc80, 0xc80, 0xb8e, 0xb4e, 0xc80, 0xc80
.long 0xb88, 0xb48, 0xc80, 0xc80, 0xb8a, 0xb4a, 0xc80, 0xc80
.long 0xb84, 0xb44, 0xc80, 0xc80, 0xb86, 0xb46, 0xc80, 0xc80
.long 0xb80, 0xb40, 0xc80, 0xc80, 0xb82, 0xb42, 0xc80, 0xc80
.long 0xc80, 0xc80, 0xc80, 0xc80, 0xc80, 0xc80, 0xc80, 0xc80
.long 0xc80, 0xc80, 0xc80, 0xc80, 0xc80, 0xc80, 0xc80, 0xc80
.long 0xc80, 0xc80, 0xc80, 0xc80, 0xc80, 0xc80, 0xc80, 0xc80
.long 0xc80, 0xc80, 0xc80, 0xc80, 0xc80, 0xc80, 0xc80, 0xc80
.long 0xc80, 0xc80, 0xc80, 0xc80, 0xc80, 0xc80, 0xc80, 0xc80
.long 0xc80, 0xc80, 0xc80, 0xc80, 0xc80, 0xc80, 0xc80, 0xc80
.long 0xc80, 0xc80, 0xc80, 0xc80, 0xc80, 0xc80, 0xc80, 0xc80
.long 0xc80, 0xc80, 0xc80, 0xc80, 0xc80, 0xc80, 0xc80, 0xc80
.long 0xc80, 0xc80, 0xc80, 0xc80, 0xc80, 0xc80, 0xc80, 0xc80
.long 0xc80, 0xc80, 0xc80, 0xc80, 0xc80, 0xc80, 0xc80, 0xc80
.long 0xc80, 0xc80, 0xc80, 0xc80, 0xc80, 0xc80, 0xc80, 0xc80
.long 0xc80, 0xc80, 0xc80, 0xc80, 0xc80, 0xc80, 0xc80, 0xc80
.long 0xc80, 0xc80, 0xc80, 0xc80, 0xc80, 0xc80, 0xc80, 0xc80
.long 0xc80, 0xc80, 0xc80, 0xc80, 0xc80, 0xc80, 0xc80, 0xc80
.long 0xc80, 0xc80, 0xc80, 0xc80, 0xc80, 0xc80, 0xc80, 0xc80
.long 0xc80, 0xc80, 0xc80, 0xc80, 0xc80, 0xc80, 0xc80, 0xc80
.long 0xc80, 0xc80, 0xc80, 0xc80, 0xc80, 0xc80, 0xc80, 0xc80
.long 0xc80, 0xc80, 0xc80, 0xc80, 0xc80, 0xc80, 0xc80, 0xc80
.long 0xc80, 0xc80, 0xc80, 0xc80, 0xc80, 0xc80, 0xc80, 0xc80
.long 0xc80, 0xc80, 0xc80, 0xc80, 0xc80, 0xc80, 0xc80, 0xc80
.long 0xc80, 0xc80, 0xc80, 0xc80, 0xc80, 0xc80, 0xc80, 0xc80
.long 0xc80, 0xc80, 0xc80, 0xc80, 0xc80, 0xc80, 0xc80, 0xc80
.long 0xc80, 0xc80, 0xc80, 0xc80, 0xc80, 0xc80, 0xc80, 0xc80
.long 0xc80, 0xc80, 0xc80, 0xc80, 0xc80, 0xc80, 0xc80, 0xc80
.size TBL, .-TBL
.section .rodata,"a"
.p2align 6
.amdhsa_kernel sequential_preLN__ssm_conv_s4d__moe_arch_mod__prompt_kernel
  .amdhsa_next_free_vgpr 256
  .amdhsa_next_free_sgpr 102
  .amdhsa_accum_offset 256
  .amdhsa_group_segment_fixed_size 0
  .amdhsa_kernarg_size 120
  .amdhsa_user_sgpr_count 2
  .amdhsa_user_sgpr_kernarg_segment_ptr 1
  .amdhsa_system_sgpr_workgroup_id_x 1
.end_amdhsa_kernel
```

```asm
; @launch grid=(248,1,1) block=(512,1,1) lds=163840
.amdgcn_target "amdgcn-amd-amdhsa--gfx950"
.text
.globl sequential_preLN__ssm_conv_s4d__moe_arch_mod__prompt_kernel
.p2align 8
.type sequential_preLN__ssm_conv_s4d__moe_arch_mod__prompt_kernel,@function
sequential_preLN__ssm_conv_s4d__moe_arch_mod__prompt_kernel:
    s_cmp_ge_u32 s2, 248
    s_cbranch_scc1 END
    s_load_dwordx16 s[4:19], s[0:1], 0
    s_load_dwordx8 s[20:27], s[0:1], 64
    s_load_dwordx2 s[28:29], s[0:1], 96
    s_load_dwordx2 s[30:31], s[0:1], 112
    s_getpc_b64 s[42:43]
PC0:
    v_and_b32 v1, 63, v0
    v_lshrrev_b32 v14, 6, v0
    v_lshlrev_b32 v15, 7, v0
    v_readfirstlane_b32 s3, v14
    s_add_u32 s44, s42, TBL-PC0
    s_addc_u32 s45, s43, 0
    v_lshlrev_b32 v2, 4, v1
    v_lshlrev_b32 v3, 4, v0
    s_sub_u32 s50, s2, 144
    s_cmp_lt_u32 s50, 72
    s_cbranch_scc1 FROLE
    s_sub_u32 s49, s2, 120
    s_cmp_lt_u32 s2, 144
    s_cselect_b32 s49, 255, s49
    s_cmp_lt_u32 s2, 96
    s_cselect_b32 s49, s2, s49
    s_lshl_b32 s46, s49, 4
    s_add_u32 s46, s46, s3
    s_mul_i32 s50, s46, 1152
    v_and_b32 v13, 31, v1
    v_lshrrev_b32 v15, 5, v1
    v_mul_u32_u24 v14, 9216, v15
    v_add_u32 v14, s50, v14
    v_lshlrev_b32 v12, 4, v13
    v_lshlrev_b32 v13, 2, v13
    v_add_u32 v4, v12, v14
    v_add_u32 v5, v13, v14
    s_and_b32 s51, s3, 3
    s_lshl_b32 s52, s2, 2
    s_add_u32 s52, s52, s51
    s_lshr_b32 s46, s3, 2
    s_lshl_b32 s53, s52, 8
    s_lshl_b32 s54, s46, 7
    s_add_u32 s53, s53, s54
    v_lshl_add_u32 v34, v1, 1, s53
    v_xor_b32 v35, 128, v34
    v_mov_b32 v28, 0
    v_mov_b32 v29, 0
    v_mov_b32 v30, 0
    v_mov_b32 v31, 0
    v_mov_b32 v32, 0
    v_mov_b32 v33, 0
    s_lshl_b32 s54, s2, 3
    s_waitcnt lgkmcnt(0)
    s_cmp_ge_u32 s2, 144
    s_cbranch_scc1 C_NOP
    s_load_dwordx2 s[56:57], s[14:15], s54
    global_load_short_d16_hi v28, v34, s[6:7] nt
    global_load_short_d16_hi v29, v34, s[8:9] nt
    global_load_short_d16_hi v30, v34, s[10:11] nt
    global_load_short_d16_hi v31, v34, s[12:13] nt
    global_load_short_d16_hi v32, v35, s[10:11] nt
    global_load_short_d16_hi v33, v35, s[12:13] nt
C_NOP:
    s_cmp_ge_u32 s49, 128
    s_cbranch_scc1 C_NOX
    global_load_dwordx4 v[16:19], v4, s[4:5] nt
    global_load_dwordx4 v[20:23], v4, s[4:5] offset:512 nt
    global_load_dword v24, v5, s[4:5] offset:1024 nt
C_NOX:
    s_load_dword s40, s[30:31], 0
    s_mov_b32 s32, s30
    s_and_b32 s33, s31, 0xffff
    s_mov_b32 s34, 0x10000000
    s_mov_b32 s35, 0x00020000
    v_mov_b32 v36, 0
    v_mov_b32 v37, 0
    v_mov_b32 v38, 0
    v_mov_b32 v39, 0
    v_add_u32 v14, 151680, v3
    ds_write_b128 v14, v[36:39]
    v_cmp_gt_u32 vcc, 240, v0
    s_and_saveexec_b64 s[58:59], vcc
    ds_write_b128 v14, v[36:39] offset:8192
    s_mov_b64 exec, -1
    s_mul_i32 s48, s51, 4640
    s_add_u32 s48, s48, 114048
    v_add_u32 v14, s48, v12
    ds_write_b128 v14, v[36:39]
    v_mov_b32 v6, 0x3f80
    v_mov_b32 v7, 1.0
    v_mov_b32 v8, 0x3f803f80
    v_mov_b32 v9, 0xfff8fff8
    v_mov_b32 v11, 0x40004
    v_and_b32 v14, 15, v1
    v_lshrrev_b32 v15, 4, v1
    v_lshlrev_b32 v248, 5, v14
    v_lshl_add_u32 v248, v15, 4, v248
    v_add_u32 v248, s48, v248
    s_mul_i32 s48, s51, 6144
    s_add_u32 s48, s48, 20480
    v_add_u32 v249, s48, v2
    s_mul_i32 s62, s51, 2976
    s_add_u32 s62, s62, 151680
    v_lshlrev_b32 v250, 3, v15
    v_sub_u32 v250, v250, v14
    v_add_u32 v250, 15, v250
    v_and_b32 v40, 1, v250
    v_mul_u32_u24 v40, 1090, v40
    v_lshl_add_u32 v250, v250, 1, v40
    v_add_u32 v250, s62, v250
    s_cmp_ge_u32 s3, 4
    s_cbranch_scc1 C_H1
    v_lshlrev_b32 v251, 3, v14
    v_lshl_add_u32 v251, v15, 7, v251
    s_mul_i32 s48, s51, 4128
    v_add_u32 v251, s48, v251
    v_add_u32 v252, 576, v250
    v_add_u32 v250, 64, v250
    v_and_b32 v40, 31, v1
    v_mul_u32_u24 v40, 528, v40
    v_lshrrev_b32 v41, 5, v1
    v_lshl_add_u32 v40, v41, 4, v40
    s_mul_i32 s48, s51, 16896
    v_add_u32 v253, s48, v40
    s_branch C_S2
C_H1:
    v_lshlrev_b32 v251, 2, v15
    v_sub_u32 v251, v251, v14
    v_lshlrev_b32 v251, 2, v251
    s_add_u32 s48, s62, 2252
    v_add_u32 v251, s48, v251
    v_bfe_u32 v40, v1, 2, 2
    v_mul_u32_u24 v40, 4128, v40
    v_and_b32 v41, 1, v1
    v_lshl_add_u32 v40, v41, 7, v40
    v_lshl_add_u32 v40, v15, 4, v40
    v_and_b32 v41, 2, v1
    v_lshl_add_u32 v40, v41, 2, v40
    s_and_b32 s48, s3, 1
    s_lshl_b32 s48, s48, 6
    v_add_u32 v252, s48, v40
    v_lshrrev_b32 v40, 3, v1
    v_mul_u32_u24 v40, 18432, v40
    v_and_b32 v41, 7, v1
    v_lshl_add_u32 v253, v41, 4, v40
    s_and_b32 s48, s3, 1
    s_mul_i32 s48, s48, 147456
    s_lshl_b32 s63, s2, 7
    s_add_u32 s63, s63, s48
    s_add_u32 s63, s63, 4194304
    v_and_b32 v40, 3, v1
    v_mul_u32_u24 v40, 4640, v40
    v_lshrrev_b32 v41, 2, v1
    v_lshl_add_u32 v40, v41, 4, v40
    s_lshl_b32 s48, s51, 10
    s_add_u32 s48, s48, 114560
    v_add_u32 v254, s48, v40
C_S2:
    s_cmp_ge_u32 s3, 4
    s_cselect_b32 s46, 4, 7
    s_lshl_b32 s46, s46, 10
    v_add_u32 v27, s46, v2
    s_lshr_b32 s46, s3, 2
    s_lshl_b32 s46, s46, 8
    s_mul_i32 s60, s51, 16896
    s_add_u32 s60, s60, s46
    s_mul_i32 s61, s51, 11616
    s_add_u32 s61, s61, s46
    s_add_u32 s61, s61, 16384
    v_lshrrev_b32 v15, 5, v1
    v_mul_u32_u24 v15, 9600, v15
    s_mul_i32 s46, s3, 1184
    s_add_u32 s46, s46, 132608
    v_add_u32 v15, s46, v15
    v_add_u32 v25, v12, v15
    v_add_u32 v26, v13, v15
    v_and_b32 v14, 1, v1
    v_mul_u32_u24 v14, 9600, v14
    v_bfe_u32 v15, v1, 2, 2
    v_mul_u32_u24 v15, 1184, v15
    v_add_u32 v14, v14, v15
    v_lshrrev_b32 v15, 4, v1
    v_lshl_add_u32 v14, v15, 4, v14
    v_and_b32 v15, 2, v1
    v_lshl_add_u32 v14, v15, 2, v14
    s_lshl_b32 s46, s3, 6
    s_add_u32 s46, s46, 132608
    v_add_u32 v36, s46, v14
    v_lshrrev_b32 v14, 3, v0
    v_and_b32 v15, 7, v0
    v_lshlrev_b32 v15, 4, v15
    v_lshl_add_u32 v37, v14, 14, v15
    s_lshl_b32 s55, s49, 7
    s_add_u32 s55, s55, 1048576
    s_add_u32 s48, s55, 1048576
    s_add_u32 s50, s55, 2097152
    v_mov_b32 v120, 0
    v_mov_b32 v121, 0
    v_lshlrev_b32 v38, 13, v1
    s_lshl_b32 s53, s49, 6
    s_add_u32 s53, s53, 262144
    s_waitcnt lgkmcnt(0)
    s_add_u32 s40, s40, 1
    s_and_b32 s41, s40, 7
    s_bfe_u32 s46, s40, 0x30003
    s_lshl_b32 s46, s46, 16
    s_or_b32 s41, s41, s46
    v_mov_b32 v10, s41
    s_cmp_ge_u32 s2, 144
    s_cbranch_scc1 C_LN1
    s_cmp_lt_u32 s49, 128
    s_cbranch_scc1 C_K0
    s_waitcnt vmcnt(0)
C_K0:
    s_waitcnt vmcnt(3)
    s_bitcmp1_b32 s51, 1
    s_cselect_b32 s56, s57, s56
    s_lshl_b32 s57, s56, 16
    s_and_b32 s56, s56, 0xffff0000
    s_bitcmp1_b32 s51, 0
    s_cselect_b32 s56, s56, s57
    v_mov_b32 v60, 0x3fb8aa3b
    v_mul_f32 v62, 0x3fb8aa3b, v28
    v_mul_f32 v60, s56, v60
    v_exp_f32 v62, v62
    v_exp_f32 v60, v60
    v_add_f32 v64, |v30|, |v31|
    v_add_f32 v65, |v32|, |v33|
    v_cvt_pk_bf16_f32 v62, 0, v62
    v_cvt_pk_bf16_f32 v60, 0, v60
    v_add_f32 v64, v64, v65
    v_mul_f32 v62, v62, v60
    v_mul_f32 v63, v29, v60
    v_mul_f32 v62, 0xbfb8aa3b, v62
    v_mul_f32 v63, 0.15915494, v63
    v_mul_f32 v104, 0x41000000, v62
    v_add_f32_dpp v64, v64, v64 row_ror:8 row_mask:0xf bank_mask:0xf
    v_mul_f32 v105, 0x41000000, v63
    v_exp_f32 v104, v104
    v_fract_f32 v105, v105
    v_add_f32_dpp v64, v64, v64 row_ror:4 row_mask:0xf bank_mask:0xf
    v_cos_f32 v72, v105
    v_sin_f32 v73, v105
    v_add_f32_dpp v64, v64, v64 row_ror:2 row_mask:0xf bank_mask:0xf
    v_pk_mul_f32 v[72:73], v[72:73], v[104:105] op_sel_hi:[1,0] neg_hi:[1,0]
    v_exp_f32 v106, v62
    v_add_f32_dpp v64, v64, v64 row_ror:1 row_mask:0xf bank_mask:0xf
    v_fract_f32 v107, v63
    v_cos_f32 v66, v107
    v_sin_f32 v67, v107
    v_mov_b32 v65, v64
    v_pk_mul_f32 v[66:67], v[66:67], v[106:107] op_sel_hi:[1,0]
    v_mul_f32 v108, 0x43800000, v62
    v_permlane16_swap_b32 v64, v65
    v_mul_f32 v109, 0x43800000, v63
    v_exp_f32 v108, v108
    v_add_f32 v64, v64, v65
    v_fract_f32 v109, v109
    v_cos_f32 v68, v109
    v_sin_f32 v69, v109
    v_mov_b32 v65, v64
    v_pk_mul_f32 v[68:69], v[68:69], v[108:109] op_sel_hi:[1,0]
    s_mov_b32 m0, s60
    v_mov_b32 v166, 0x3c00
    ds_write_addtid_b32 v166 offset:0
    v_pk_mul_f32 v[74:75], v[72:73], v[72:73] op_sel_hi:[1,0]
    v_permlane32_swap_b32 v64, v65
    v_pk_fma_f32 v[74:75], v[72:73], v[72:73], v[74:75] op_sel:[1,1,0] op_sel_hi:[0,1,1] neg_lo:[1,0,0]
    s_cmp_lt_u32 s49, 128
    s_cbranch_scc1 C_LN1
    s_cmp_ge_u32 s2, 144
    s_cbranch_scc1 LL1
    s_cmp_ge_u32 s3, 4
    s_cbranch_scc1 LL2
    global_load_dwordx4 v[184:187], v27, s[44:45] offset:0
    global_load_dwordx4 v[188:191], v27, s[44:45] offset:1024
    global_load_dwordx4 v[192:195], v27, s[44:45] offset:2048
LL1:
    global_load_dwordx4 v[208:211], v12, s[16:17]
    global_load_dwordx4 v[212:215], v12, s[16:17] offset:512
    global_load_dword v216, v13, s[16:17] offset:1024
    global_load_dwordx4 v[218:221], v12, s[20:21]
    global_load_dwordx4 v[222:225], v12, s[20:21] offset:512
    global_load_dword v226, v13, s[20:21] offset:1024
    s_branch LL3
LL2:
    global_load_dwordx4 v[168:171], v27, s[44:45] offset:-4096
    global_load_dwordx4 v[172:175], v27, s[44:45] offset:-3072
    global_load_dwordx4 v[176:179], v27, s[44:45] offset:-2048
    global_load_dwordx4 v[180:183], v27, s[44:45] offset:-1024
    global_load_dwordx4 v[184:187], v27, s[44:45] offset:0
    global_load_dwordx4 v[188:191], v27, s[44:45] offset:1024
    global_load_dwordx4 v[192:195], v27, s[44:45] offset:2048
LL3:
    s_branch C_K1
C_LN1:
    s_waitcnt vmcnt(0)
    s_cmp_ge_u32 s2, 144
    s_cbranch_scc1 LL4
    s_cmp_ge_u32 s3, 4
    s_cbranch_scc1 LL5
    global_load_dwordx4 v[184:187], v27, s[44:45] offset:0
    global_load_dwordx4 v[188:191], v27, s[44:45] offset:1024
    global_load_dwordx4 v[192:195], v27, s[44:45] offset:2048
LL4:
    global_load_dwordx4 v[208:211], v12, s[16:17]
    global_load_dwordx4 v[212:215], v12, s[16:17] offset:512
    global_load_dword v216, v13, s[16:17] offset:1024
    global_load_dwordx4 v[218:221], v12, s[20:21]
    global_load_dwordx4 v[222:225], v12, s[20:21] offset:512
    global_load_dword v226, v13, s[20:21] offset:1024
    s_branch LL6
LL5:
    global_load_dwordx4 v[168:171], v27, s[44:45] offset:-4096
    global_load_dwordx4 v[172:175], v27, s[44:45] offset:-3072
    global_load_dwordx4 v[176:179], v27, s[44:45] offset:-2048
    global_load_dwordx4 v[180:183], v27, s[44:45] offset:-1024
    global_load_dwordx4 v[184:187], v27, s[44:45] offset:0
    global_load_dwordx4 v[188:191], v27, s[44:45] offset:1024
    global_load_dwordx4 v[192:195], v27, s[44:45] offset:2048
LL6:
    v_dot2c_f32_bf16 v120, v16, v8
    v_dot2c_f32_bf16 v121, v16, v16
    v_dot2c_f32_bf16 v120, v17, v8
    v_dot2c_f32_bf16 v121, v17, v17
    v_dot2c_f32_bf16 v120, v18, v8
    v_dot2c_f32_bf16 v121, v18, v18
    v_dot2c_f32_bf16 v120, v19, v8
    v_dot2c_f32_bf16 v121, v19, v19
    v_dot2c_f32_bf16 v120, v20, v8
    v_dot2c_f32_bf16 v121, v20, v20
    v_dot2c_f32_bf16 v120, v21, v8
    v_dot2c_f32_bf16 v121, v21, v21
    v_dot2c_f32_bf16 v120, v22, v8
    v_dot2c_f32_bf16 v121, v22, v22
    v_dot2c_f32_bf16 v120, v23, v8
    v_dot2c_f32_bf16 v121, v23, v23
    v_dot2c_f32_bf16 v120, v24, v8
    v_dot2c_f32_bf16 v121, v24, v24
    s_nop 2
    v_permlane16_swap_b32 v120, v121
    v_add_f32 v120, v120, v121
    s_nop 1
    v_add_f32_dpp v120, v120, v120 row_ror:8 row_mask:0xf bank_mask:0xf
    s_nop 1
    v_add_f32_dpp v120, v120, v120 row_ror:4 row_mask:0xf bank_mask:0xf
    s_nop 1
    v_add_f32_dpp v120, v120, v120 row_ror:2 row_mask:0xf bank_mask:0xf
    s_nop 1
    v_add_f32_dpp v120, v120, v120 row_ror:1 row_mask:0xf bank_mask:0xf
    v_mov_b32 v121, v120
    s_nop 1
    v_permlane16_swap_b32 v120, v121
    v_mul_f32 v120, 0x3ae38e39, v120
    v_mul_f32 v121, 0x3ae38e39, v121
    v_fma_f32 v121, -v120, v120, v121
    v_cvt_pk_bf16_f32 v122, 0, v120
    v_max_f32 v121, 0, v121
    v_cvt_pk_bf16_f32 v121, 0, v121
    v_add_f32 v121, 0x3727c5ac, v121
    v_cvt_pk_bf16_f32 v121, 0, v121
    v_sqrt_f32 v121, v121
    s_nop 0
    v_cvt_pk_bf16_f32 v121, 0, v121
    v_rcp_f32 v124, v121
    v_dot2_f32_bf16 v126, v16, v6, v122 neg_lo:[0,0,1]
    v_dot2_f32_bf16 v127, v16, v7, v122 neg_lo:[0,0,1]
    v_dot2_f32_bf16 v128, v17, v6, v122 neg_lo:[0,0,1]
    v_dot2_f32_bf16 v129, v17, v7, v122 neg_lo:[0,0,1]
    v_dot2_f32_bf16 v130, v18, v6, v122 neg_lo:[0,0,1]
    v_dot2_f32_bf16 v131, v18, v7, v122 neg_lo:[0,0,1]
    v_dot2_f32_bf16 v132, v19, v6, v122 neg_lo:[0,0,1]
    v_dot2_f32_bf16 v133, v19, v7, v122 neg_lo:[0,0,1]
    v_dot2_f32_bf16 v134, v20, v6, v122 neg_lo:[0,0,1]
    v_dot2_f32_bf16 v135, v20, v7, v122 neg_lo:[0,0,1]
    v_dot2_f32_bf16 v136, v21, v6, v122 neg_lo:[0,0,1]
    v_dot2_f32_bf16 v137, v21, v7, v122 neg_lo:[0,0,1]
    v_dot2_f32_bf16 v138, v22, v6, v122 neg_lo:[0,0,1]
    v_dot2_f32_bf16 v139, v22, v7, v122 neg_lo:[0,0,1]
    v_dot2_f32_bf16 v140, v23, v6, v122 neg_lo:[0,0,1]
    v_dot2_f32_bf16 v141, v23, v7, v122 neg_lo:[0,0,1]
    v_dot2_f32_bf16 v142, v24, v6, v122 neg_lo:[0,0,1]
    v_dot2_f32_bf16 v143, v24, v7, v122 neg_lo:[0,0,1]
    s_cmp_lg_u32 s3, 7
    s_cbranch_scc1 UHS7
    v_mov_b32 v39, s40
    s_mov_b64 exec, 0xff
    buffer_store_dword v39, v38, s[32:35], s53 offen sc1
    s_mov_b64 exec, -1
UHS7:
    v_cvt_pk_bf16_f32 v126, 0, v126
    v_cvt_pk_bf16_f32 v127, 0, v127
    v_cvt_pk_bf16_f32 v128, 0, v128
    v_cvt_pk_bf16_f32 v129, 0, v129
    v_cvt_pk_bf16_f32 v130, 0, v130
    v_cvt_pk_bf16_f32 v131, 0, v131
    v_cvt_pk_bf16_f32 v132, 0, v132
    v_cvt_pk_bf16_f32 v133, 0, v133
    v_cvt_pk_bf16_f32 v134, 0, v134
    v_cvt_pk_bf16_f32 v135, 0, v135
    v_cvt_pk_bf16_f32 v136, 0, v136
    v_cvt_pk_bf16_f32 v137, 0, v137
    v_cvt_pk_bf16_f32 v138, 0, v138
    v_cvt_pk_bf16_f32 v139, 0, v139
    v_cvt_pk_bf16_f32 v140, 0, v140
    v_cvt_pk_bf16_f32 v141, 0, v141
    v_cvt_pk_bf16_f32 v142, 0, v142
    v_cvt_pk_bf16_f32 v143, 0, v143
    v_pk_mul_f32 v[126:127], v[126:127], v[124:125] op_sel_hi:[1,0]
    v_pk_mul_f32 v[128:129], v[128:129], v[124:125] op_sel_hi:[1,0]
    v_pk_mul_f32 v[130:131], v[130:131], v[124:125] op_sel_hi:[1,0]
    v_pk_mul_f32 v[132:133], v[132:133], v[124:125] op_sel_hi:[1,0]
    v_pk_mul_f32 v[134:135], v[134:135], v[124:125] op_sel_hi:[1,0]
    v_pk_mul_f32 v[136:137], v[136:137], v[124:125] op_sel_hi:[1,0]
    v_pk_mul_f32 v[138:139], v[138:139], v[124:125] op_sel_hi:[1,0]
    v_pk_mul_f32 v[140:141], v[140:141], v[124:125] op_sel_hi:[1,0]
    v_pk_mul_f32 v[142:143], v[142:143], v[124:125] op_sel_hi:[1,0]
    v_cvt_pkrtz_f16_f32 v144, v126, v127
    v_cvt_pkrtz_f16_f32 v145, v128, v129
    v_add_u32 v144, v11, v144
    v_cvt_pkrtz_f16_f32 v146, v130, v131
    v_add_u32 v145, v11, v145
    v_cvt_pkrtz_f16_f32 v147, v132, v133
    v_add_u32 v146, v11, v146
    v_cvt_pkrtz_f16_f32 v148, v134, v135
    v_add_u32 v147, v11, v147
    v_cvt_pkrtz_f16_f32 v149, v136, v137
    v_add_u32 v148, v11, v148
    ds_write_b128 v25, v[144:147]
    v_cvt_pkrtz_f16_f32 v150, v138, v139
    v_add_u32 v149, v11, v149
    v_cvt_pkrtz_f16_f32 v151, v140, v141
    v_add_u32 v150, v11, v150
    v_cvt_pkrtz_f16_f32 v152, v142, v143
    v_add_u32 v151, v11, v151
    v_add_u32 v152, v11, v152
    ds_write_b128 v25, v[148:151] offset:512
    ds_write_b32 v26, v152 offset:1024
    s_waitcnt lgkmcnt(0)
    s_barrier
    ds_read_b64_tr_b16 v[126:127], v36 offset:0
    ds_read_b64_tr_b16 v[128:129], v36 offset:4736
    ds_read_b64_tr_b16 v[130:131], v36 offset:512
    ds_read_b64_tr_b16 v[132:133], v36 offset:5248
    s_cmp_ge_u32 s3, 2
    s_cbranch_scc1 L1_A
    ds_read_b64_tr_b16 v[134:135], v36 offset:1024
    ds_read_b64_tr_b16 v[136:137], v36 offset:5760
    s_waitcnt lgkmcnt(0)
    v_and_or_b32 v134, v134, v9, v10
    v_and_or_b32 v135, v135, v9, v10
    v_and_or_b32 v136, v136, v9, v10
    v_and_or_b32 v137, v137, v9, v10
    buffer_store_dwordx4 v[134:137], v37, s[32:35], s50 offen sc1
L1_A:
    s_waitcnt lgkmcnt(2)
    v_and_or_b32 v126, v126, v9, v10
    v_and_or_b32 v127, v127, v9, v10
    v_and_or_b32 v128, v128, v9, v10
    v_and_or_b32 v129, v129, v9, v10
    buffer_store_dwordx4 v[126:129], v37, s[32:35], s55 offen sc1
    s_waitcnt lgkmcnt(0)
    v_and_or_b32 v130, v130, v9, v10
    v_and_or_b32 v131, v131, v9, v10
    v_and_or_b32 v132, v132, v9, v10
    v_and_or_b32 v133, v133, v9, v10
    buffer_store_dwordx4 v[130:133], v37, s[32:35], s48 offen sc1
    s_cmp_lt_u32 s2, 144
    s_cbranch_scc1 C_K1
    s_waitcnt vmcnt(0)
    s_branch RPREP
C_K1:
    s_lshl_b32 s48, s2, 14
    s_lshl_b32 s46, s51, 12
    s_add_u32 s48, s48, s46
    s_add_u32 s48, s48, 1048576
    s_getreg_b32 s50, hwreg(HW_REG_XCC_ID, 0, 3)
    s_lshl_b32 s50, s50, 13
    s_lshl_b32 s46, s51, 11
    s_add_u32 s50, s50, s46
    s_add_u32 s50, s50, 262144
    v_lshlrev_b32 v59, 2, v12
    s_mov_b32 s59, 0
    v_pk_mul_f32 v[76:77], v[74:75], v[72:73] op_sel_hi:[1,0]
    v_pk_mul_f32 v[78:79], v[74:75], v[74:75] op_sel_hi:[1,0]
    v_cvt_pk_f16_f32 v162, v72, v73
    v_cvt_pk_f16_f32 v163, v74, v75
    v_add_f32 v64, v64, v65
    v_pk_fma_f32 v[76:77], v[74:75], v[72:73], v[76:77] op_sel:[1,1,0] op_sel_hi:[0,1,1] neg_lo:[1,0,0]
    ds_write_addtid_b32 v162 offset:528
    v_pk_fma_f32 v[78:79], v[74:75], v[74:75], v[78:79] op_sel:[1,1,0] op_sel_hi:[0,1,1] neg_lo:[1,0,0]
    ds_write_addtid_b32 v163 offset:1056
    v_pk_mul_f32 v[80:81], v[78:79], v[72:73] op_sel_hi:[1,0]
    v_pk_mul_f32 v[82:83], v[78:79], v[74:75] op_sel_hi:[1,0]
    v_cvt_pk_f16_f32 v164, v76, v77
    v_cvt_pk_f16_f32 v165, v78, v79
    v_mul_f32 v64, v64, v60
    v_pk_fma_f32 v[80:81], v[78:79], v[72:73], v[80:81] op_sel:[1,1,0] op_sel_hi:[0,1,1] neg_lo:[1,0,0]
    ds_write_addtid_b32 v164 offset:1584
    v_pk_fma_f32 v[82:83], v[78:79], v[74:75], v[82:83] op_sel:[1,1,0] op_sel_hi:[0,1,1] neg_lo:[1,0,0]
    ds_write_addtid_b32 v165 offset:2112
    v_pk_mul_f32 v[84:85], v[78:79], v[76:77] op_sel_hi:[1,0]
    v_pk_mul_f32 v[86:87], v[78:79], v[78:79] op_sel_hi:[1,0]
    v_cvt_pk_f16_f32 v162, v80, v81
    v_cvt_pk_f16_f32 v163, v82, v83
    v_frexp_exp_i32_f32 v64, v64
    v_pk_fma_f32 v[84:85], v[78:79], v[76:77], v[84:85] op_sel:[1,1,0] op_sel_hi:[0,1,1] neg_lo:[1,0,0]
    ds_write_addtid_b32 v162 offset:2640
    v_pk_fma_f32 v[86:87], v[78:79], v[78:79], v[86:87] op_sel:[1,1,0] op_sel_hi:[0,1,1] neg_lo:[1,0,0]
    ds_write_addtid_b32 v163 offset:3168
    v_pk_mul_f32 v[88:89], v[86:87], v[72:73] op_sel_hi:[1,0]
    v_pk_mul_f32 v[90:91], v[86:87], v[74:75] op_sel_hi:[1,0]
    v_cvt_pk_f16_f32 v164, v84, v85
    v_cvt_pk_f16_f32 v165, v86, v87
    v_max_i32 v64, -100, v64
    v_pk_fma_f32 v[88:89], v[86:87], v[72:73], v[88:89] op_sel:[1,1,0] op_sel_hi:[0,1,1] neg_lo:[1,0,0]
    ds_write_addtid_b32 v164 offset:3696
    v_pk_fma_f32 v[90:91], v[86:87], v[74:75], v[90:91] op_sel:[1,1,0] op_sel_hi:[0,1,1] neg_lo:[1,0,0]
    ds_write_addtid_b32 v165 offset:4224
    v_pk_mul_f32 v[92:93], v[86:87], v[76:77] op_sel_hi:[1,0]
    v_pk_mul_f32 v[94:95], v[86:87], v[78:79] op_sel_hi:[1,0]
    v_cvt_pk_f16_f32 v162, v88, v89
    v_cvt_pk_f16_f32 v163, v90, v91
    v_min_i32 v64, 100, v64
    v_pk_fma_f32 v[92:93], v[86:87], v[76:77], v[92:93] op_sel:[1,1,0] op_sel_hi:[0,1,1] neg_lo:[1,0,0]
    ds_write_addtid_b32 v162 offset:4752
    v_pk_fma_f32 v[94:95], v[86:87], v[78:79], v[94:95] op_sel:[1,1,0] op_sel_hi:[0,1,1] neg_lo:[1,0,0]
    ds_write_addtid_b32 v163 offset:5280
    v_pk_mul_f32 v[96:97], v[86:87], v[80:81] op_sel_hi:[1,0]
    v_pk_mul_f32 v[98:99], v[86:87], v[82:83] op_sel_hi:[1,0]
    v_cvt_pk_f16_f32 v164, v92, v93
    v_cvt_pk_f16_f32 v165, v94, v95
    v_sub_u32 v65, 0, v64
    v_pk_fma_f32 v[96:97], v[86:87], v[80:81], v[96:97] op_sel:[1,1,0] op_sel_hi:[0,1,1] neg_lo:[1,0,0]
    ds_write_addtid_b32 v164 offset:5808
    v_pk_fma_f32 v[98:99], v[86:87], v[82:83], v[98:99] op_sel:[1,1,0] op_sel_hi:[0,1,1] neg_lo:[1,0,0]
    ds_write_addtid_b32 v165 offset:6336
    v_pk_mul_f32 v[100:101], v[86:87], v[84:85] op_sel_hi:[1,0]
    v_pk_mul_f32 v[102:103], v[86:87], v[86:87] op_sel_hi:[1,0]
    v_cvt_pk_f16_f32 v162, v96, v97
    v_cvt_pk_f16_f32 v163, v98, v99
    v_ldexp_f32 v60, v60, v65
    v_pk_fma_f32 v[100:101], v[86:87], v[84:85], v[100:101] op_sel:[1,1,0] op_sel_hi:[0,1,1] neg_lo:[1,0,0]
    ds_write_addtid_b32 v162 offset:6864
    v_pk_fma_f32 v[102:103], v[86:87], v[86:87], v[102:103] op_sel:[1,1,0] op_sel_hi:[0,1,1] neg_lo:[1,0,0]
    ds_write_addtid_b32 v163 offset:7392
    v_pk_mul_f32 v[112:113], v[102:103], v[72:73] op_sel_hi:[1,0]
    v_pk_mul_f32 v[114:115], v[102:103], v[74:75] op_sel_hi:[1,0]
    v_cvt_pk_f16_f32 v164, v100, v101
    v_cvt_pk_f16_f32 v165, v102, v103
    v_pk_mul_f32 v[30:31], v[30:31], v[60:61] op_sel_hi:[1,0]
    v_pk_fma_f32 v[112:113], v[102:103], v[72:73], v[112:113] op_sel:[1,1,0] op_sel_hi:[0,1,1] neg_lo:[1,0,0]
    ds_write_addtid_b32 v164 offset:7920
    v_pk_fma_f32 v[114:115], v[102:103], v[74:75], v[114:115] op_sel:[1,1,0] op_sel_hi:[0,1,1] neg_lo:[1,0,0]
    ds_write_addtid_b32 v165 offset:8448
    v_pk_mul_f32 v[116:117], v[102:103], v[76:77] op_sel_hi:[1,0]
    v_pk_mul_f32 v[110:111], v[102:103], v[78:79] op_sel_hi:[1,0]
    v_cvt_pk_f16_f32 v162, v112, v113
    v_cvt_pk_f16_f32 v163, v114, v115
    v_pk_fma_f32 v[116:117], v[102:103], v[76:77], v[116:117] op_sel:[1,1,0] op_sel_hi:[0,1,1] neg_lo:[1,0,0]
    ds_write_addtid_b32 v162 offset:8976
    v_pk_fma_f32 v[110:111], v[102:103], v[78:79], v[110:111] op_sel:[1,1,0] op_sel_hi:[0,1,1] neg_lo:[1,0,0]
    ds_write_addtid_b32 v163 offset:9504
    v_pk_mul_f32 v[112:113], v[102:103], v[80:81] op_sel_hi:[1,0]
    v_pk_mul_f32 v[114:115], v[102:103], v[82:83] op_sel_hi:[1,0]
    v_cvt_pk_f16_f32 v164, v116, v117
    v_cvt_pk_f16_f32 v165, v110, v111
    v_pk_fma_f32 v[112:113], v[102:103], v[80:81], v[112:113] op_sel:[1,1,0] op_sel_hi:[0,1,1] neg_lo:[1,0,0]
    ds_write_addtid_b32 v164 offset:10032
    v_pk_fma_f32 v[114:115], v[102:103], v[82:83], v[114:115] op_sel:[1,1,0] op_sel_hi:[0,1,1] neg_lo:[1,0,0]
    ds_write_addtid_b32 v165 offset:10560
    v_pk_mul_f32 v[120:121], v[30:31], v[66:67] op_sel_hi:[1,0]
    v_cvt_pk_f16_f32 v162, v112, v113
    v_cvt_pk_f16_f32 v163, v114, v115
    v_pk_fma_f32 v[120:121], v[30:31], v[66:67], v[120:121] op_sel:[1,1,0] op_sel_hi:[0,1,1] neg_lo:[1,0,0]
    ds_write_addtid_b32 v162 offset:11088
    ds_write_addtid_b32 v163 offset:11616
    s_cmp_ge_u32 s3, 4
    s_cbranch_scc1 C_K3
    v_add_u32 v64, 1, v64
    s_and_b32 s46, s40, 0x7fffff
    v_ldexp_f32 v64, 1.0, v64
    s_lshl_b32 s53, s2, 7
    v_or_b32 v64, s46, v64
    s_lshl_b32 s46, s51, 2
    s_add_u32 s46, s46, s53
    s_add_u32 s46, s46, 32768
    s_mov_b64 exec, 1
    buffer_store_dword v64, v2, s[32:35], s46 offen sc1
    s_mov_b64 exec, -1
C_K3:
    v_pk_mul_f32 v[136:137], v[30:31], v[68:69] op_sel_hi:[1,0]
    v_pk_mul_f32 v[122:123], v[120:121], v[66:67] op_sel_hi:[1,0]
    v_cvt_pk_f16_f32 v164, v30, v31
    v_cvt_pk_f16_f32 v165, v120, v121
    s_mov_b32 m0, s61
    v_pk_fma_f32 v[136:137], v[30:31], v[68:69], v[136:137] op_sel:[1,1,0] op_sel_hi:[0,1,1] neg_lo:[1,0,0]
    ds_write_addtid_b32 v164 offset:51200
    v_pk_fma_f32 v[122:123], v[120:121], v[66:67], v[122:123] op_sel:[1,1,0] op_sel_hi:[0,1,1] neg_lo:[1,0,0]
    ds_write_addtid_b32 v165 offset:51728
    v_pk_mul_f32 v[124:125], v[122:123], v[66:67] op_sel_hi:[1,0]
    v_pk_mul_f32 v[138:139], v[122:123], v[68:69] op_sel_hi:[1,0]
    v_cvt_pk_f16_f32 v162, v136, v137
    v_cvt_pk_f16_f32 v163, v122, v123
    v_pk_fma_f32 v[124:125], v[122:123], v[66:67], v[124:125] op_sel:[1,1,0] op_sel_hi:[0,1,1] neg_lo:[1,0,0]
    ds_write_addtid_b32 v162 offset:55952
    v_pk_fma_f32 v[138:139], v[122:123], v[68:69], v[138:139] op_sel:[1,1,0] op_sel_hi:[0,1,1] neg_lo:[1,0,0]
    ds_write_addtid_b32 v163 offset:52256
    v_pk_mul_f32 v[126:127], v[124:125], v[66:67] op_sel_hi:[1,0]
    v_cvt_pk_f16_f32 v164, v124, v125
    v_cvt_pk_f16_f32 v165, v138, v139
    v_pk_fma_f32 v[126:127], v[124:125], v[66:67], v[126:127] op_sel:[1,1,0] op_sel_hi:[0,1,1] neg_lo:[1,0,0]
    ds_write_addtid_b32 v164 offset:52784
    ds_write_addtid_b32 v165 offset:56480
    v_pk_mul_f32 v[128:129], v[126:127], v[66:67] op_sel_hi:[1,0]
    v_pk_mul_f32 v[140:141], v[126:127], v[68:69] op_sel_hi:[1,0]
    v_cvt_pk_f16_f32 v162, v126, v127
    v_pk_fma_f32 v[128:129], v[126:127], v[66:67], v[128:129] op_sel:[1,1,0] op_sel_hi:[0,1,1] neg_lo:[1,0,0]
    ds_write_addtid_b32 v162 offset:53312
    v_pk_fma_f32 v[140:141], v[126:127], v[68:69], v[140:141] op_sel:[1,1,0] op_sel_hi:[0,1,1] neg_lo:[1,0,0]
    v_pk_mul_f32 v[130:131], v[128:129], v[66:67] op_sel_hi:[1,0]
    v_pk_mul_f32 v[146:147], v[140:141], v[68:69] op_sel_hi:[1,0]
    v_cvt_pk_f16_f32 v163, v128, v129
    v_cvt_pk_f16_f32 v164, v140, v141
    v_pk_fma_f32 v[130:131], v[128:129], v[66:67], v[130:131] op_sel:[1,1,0] op_sel_hi:[0,1,1] neg_lo:[1,0,0]
    ds_write_addtid_b32 v163 offset:53840
    v_pk_fma_f32 v[146:147], v[140:141], v[68:69], v[146:147] op_sel:[1,1,0] op_sel_hi:[0,1,1] neg_lo:[1,0,0]
    ds_write_addtid_b32 v164 offset:57008
    v_pk_mul_f32 v[132:133], v[130:131], v[66:67] op_sel_hi:[1,0]
    v_pk_mul_f32 v[142:143], v[130:131], v[68:69] op_sel_hi:[1,0]
    v_cvt_pk_f16_f32 v165, v130, v131
    v_cvt_pk_f16_f32 v162, v146, v147
    v_pk_fma_f32 v[132:133], v[130:131], v[66:67], v[132:133] op_sel:[1,1,0] op_sel_hi:[0,1,1] neg_lo:[1,0,0]
    ds_write_addtid_b32 v165 offset:54368
    v_pk_fma_f32 v[142:143], v[130:131], v[68:69], v[142:143] op_sel:[1,1,0] op_sel_hi:[0,1,1] neg_lo:[1,0,0]
    ds_write_addtid_b32 v162 offset:58592
    v_pk_mul_f32 v[134:135], v[132:133], v[66:67] op_sel_hi:[1,0]
    v_pk_mul_f32 v[150:151], v[146:147], v[68:69] op_sel_hi:[1,0]
    v_cvt_pk_f16_f32 v163, v132, v133
    v_cvt_pk_f16_f32 v164, v142, v143
    v_pk_fma_f32 v[134:135], v[132:133], v[66:67], v[134:135] op_sel:[1,1,0] op_sel_hi:[0,1,1] neg_lo:[1,0,0]
    ds_write_addtid_b32 v163 offset:54896
    v_pk_fma_f32 v[150:151], v[146:147], v[68:69], v[150:151] op_sel:[1,1,0] op_sel_hi:[0,1,1] neg_lo:[1,0,0]
    ds_write_addtid_b32 v164 offset:57536
    v_pk_mul_f32 v[144:145], v[134:135], v[68:69] op_sel_hi:[1,0]
    v_pk_mul_f32 v[116:117], v[102:103], v[84:85] op_sel_hi:[1,0]
    v_cvt_pk_f16_f32 v165, v134, v135
    v_cvt_pk_f16_f32 v162, v150, v151
    v_pk_fma_f32 v[144:145], v[134:135], v[68:69], v[144:145] op_sel:[1,1,0] op_sel_hi:[0,1,1] neg_lo:[1,0,0]
    ds_write_addtid_b32 v165 offset:55424
    v_pk_fma_f32 v[116:117], v[102:103], v[84:85], v[116:117] op_sel:[1,1,0] op_sel_hi:[0,1,1] neg_lo:[1,0,0]
    ds_write_addtid_b32 v162 offset:59648
    v_pk_mul_f32 v[148:149], v[144:145], v[68:69] op_sel_hi:[1,0]
    v_pk_mul_f32 v[110:111], v[102:103], v[86:87] op_sel_hi:[1,0]
    v_cvt_pk_f16_f32 v163, v144, v145
    v_cvt_pk_f16_f32 v164, v116, v117
    v_pk_fma_f32 v[148:149], v[144:145], v[68:69], v[148:149] op_sel:[1,1,0] op_sel_hi:[0,1,1] neg_lo:[1,0,0]
    ds_write_addtid_b32 v163 offset:58064
    s_mov_b32 m0, s60
    v_pk_fma_f32 v[110:111], v[102:103], v[86:87], v[110:111] op_sel:[1,1,0] op_sel_hi:[0,1,1] neg_lo:[1,0,0]
    ds_write_addtid_b32 v164 offset:12144
    v_pk_mul_f32 v[152:153], v[148:149], v[68:69] op_sel_hi:[1,0]
    v_pk_mul_f32 v[112:113], v[102:103], v[88:89] op_sel_hi:[1,0]
    v_cvt_pk_f16_f32 v165, v148, v149
    v_cvt_pk_f16_f32 v162, v110, v111
    s_mov_b32 m0, s61
    v_pk_fma_f32 v[152:153], v[148:149], v[68:69], v[152:153] op_sel:[1,1,0] op_sel_hi:[0,1,1] neg_lo:[1,0,0]
    ds_write_addtid_b32 v165 offset:59120
    s_mov_b32 m0, s60
    v_pk_fma_f32 v[112:113], v[102:103], v[88:89], v[112:113] op_sel:[1,1,0] op_sel_hi:[0,1,1] neg_lo:[1,0,0]
    ds_write_addtid_b32 v162 offset:12672
    v_pk_mul_f32 v[114:115], v[102:103], v[90:91] op_sel_hi:[1,0]
    v_pk_mul_f32 v[154:155], v[152:153], v[68:69] op_sel_hi:[1,0]
    v_cvt_pk_f16_f32 v163, v152, v153
    v_cvt_pk_f16_f32 v164, v112, v113
    s_mov_b32 m0, s61
    v_pk_fma_f32 v[114:115], v[102:103], v[90:91], v[114:115] op_sel:[1,1,0] op_sel_hi:[0,1,1] neg_lo:[1,0,0]
    ds_write_addtid_b32 v163 offset:60176
    s_mov_b32 m0, s60
    v_pk_fma_f32 v[154:155], v[152:153], v[68:69], v[154:155] op_sel:[1,1,0] op_sel_hi:[0,1,1] neg_lo:[1,0,0]
    ds_write_addtid_b32 v164 offset:13200
    v_pk_mul_f32 v[116:117], v[102:103], v[92:93] op_sel_hi:[1,0]
    v_pk_mul_f32 v[156:157], v[154:155], v[68:69] op_sel_hi:[1,0]
    v_cvt_pk_f16_f32 v165, v114, v115
    v_cvt_pk_f16_f32 v162, v154, v155
    v_pk_fma_f32 v[116:117], v[102:103], v[92:93], v[116:117] op_sel:[1,1,0] op_sel_hi:[0,1,1] neg_lo:[1,0,0]
    ds_write_addtid_b32 v165 offset:13728
    s_mov_b32 m0, s61
    v_pk_fma_f32 v[156:157], v[154:155], v[68:69], v[156:157] op_sel:[1,1,0] op_sel_hi:[0,1,1] neg_lo:[1,0,0]
    ds_write_addtid_b32 v162 offset:60704
    s_cmp_lt_u32 s3, 4
    s_cbranch_scc1 C_K2
    buffer_load_dword v58, v59, s[32:35], s50 offen sc1
C_K2:
    v_pk_mul_f32 v[110:111], v[102:103], v[94:95] op_sel_hi:[1,0]
    v_pk_mul_f32 v[112:113], v[102:103], v[96:97] op_sel_hi:[1,0]
    v_cvt_pk_f16_f32 v163, v116, v117
    v_cvt_pk_f16_f32 v164, v156, v157
    s_mov_b32 m0, s60
    v_pk_fma_f32 v[110:111], v[102:103], v[94:95], v[110:111] op_sel:[1,1,0] op_sel_hi:[0,1,1] neg_lo:[1,0,0]
    ds_write_addtid_b32 v163 offset:14256
    s_mov_b32 m0, s61
    v_pk_fma_f32 v[112:113], v[102:103], v[96:97], v[112:113] op_sel:[1,1,0] op_sel_hi:[0,1,1] neg_lo:[1,0,0]
    ds_write_addtid_b32 v164 offset:61232
    v_pk_mul_f32 v[158:159], v[156:157], v[68:69] op_sel_hi:[1,0]
    v_pk_mul_f32 v[114:115], v[102:103], v[98:99] op_sel_hi:[1,0]
    v_cvt_pk_f16_f32 v165, v110, v111
    v_cvt_pk_f16_f32 v162, v112, v113
    s_mov_b32 m0, s60
    v_pk_fma_f32 v[158:159], v[156:157], v[68:69], v[158:159] op_sel:[1,1,0] op_sel_hi:[0,1,1] neg_lo:[1,0,0]
    ds_write_addtid_b32 v165 offset:14784
    v_pk_fma_f32 v[114:115], v[102:103], v[98:99], v[114:115] op_sel:[1,1,0] op_sel_hi:[0,1,1] neg_lo:[1,0,0]
    ds_write_addtid_b32 v162 offset:15312
    v_pk_mul_f32 v[160:161], v[158:159], v[68:69] op_sel_hi:[1,0]
    v_pk_mul_f32 v[116:117], v[102:103], v[100:101] op_sel_hi:[1,0]
    v_cvt_pk_f16_f32 v163, v158, v159
    v_cvt_pk_f16_f32 v164, v114, v115
    s_mov_b32 m0, s61
    v_pk_fma_f32 v[160:161], v[158:159], v[68:69], v[160:161] op_sel:[1,1,0] op_sel_hi:[0,1,1] neg_lo:[1,0,0]
    ds_write_addtid_b32 v163 offset:61760
    s_mov_b32 m0, s60
    v_pk_fma_f32 v[116:117], v[102:103], v[100:101], v[116:117] op_sel:[1,1,0] op_sel_hi:[0,1,1] neg_lo:[1,0,0]
    ds_write_addtid_b32 v164 offset:15840
    v_cvt_pk_f16_f32 v165, v160, v161
    v_cvt_pk_f16_f32 v162, v116, v117
    s_mov_b32 m0, s61
    s_nop 0
    ds_write_addtid_b32 v165 offset:62288
    s_mov_b32 m0, s60
    s_nop 0
    ds_write_addtid_b32 v162 offset:16368
    s_cmp_ge_u32 s3, 4
    s_cbranch_scc1 H_PATH
    s_waitcnt vmcnt(7)
    s_mul_i32 s46, s51, 11616
    s_add_u32 s46, s46, 67584
    v_add_u32 v195, s46, v195
    ds_read_b128 v[92:95], v195 offset:0
    ds_read_b128 v[96:99], v253 offset:0
    ds_read_b128 v[100:103], v195 offset:32
    ds_read_b128 v[104:107], v253 offset:32
    ds_read_b128 v[108:111], v195 offset:64
    ds_read_b128 v[112:115], v253 offset:64
    ds_read_b128 v[116:119], v195 offset:96
    ds_read_b128 v[120:123], v253 offset:96
    ds_read_b128 v[124:127], v195 offset:128
    ds_read_b128 v[128:131], v253 offset:128
    ds_read_b128 v[132:135], v195 offset:160
    ds_read_b128 v[136:139], v253 offset:160
    ds_read_b128 v[140:143], v195 offset:192
    ds_read_b128 v[144:147], v253 offset:192
    ds_read_b128 v[148:151], v195 offset:224
    ds_read_b128 v[152:155], v253 offset:224
    s_waitcnt lgkmcnt(14)
    v_mfma_f32_32x32x16_f16 v[168:183], v[92:95], v[96:99], 0
    s_waitcnt lgkmcnt(12)
    v_mfma_f32_32x32x16_f16 v[168:183], v[100:103], v[104:107], v[168:183]
    s_waitcnt lgkmcnt(10)
    v_mfma_f32_32x32x16_f16 v[168:183], v[108:111], v[112:115], v[168:183]
    s_waitcnt lgkmcnt(8)
    v_mfma_f32_32x32x16_f16 v[168:183], v[116:119], v[120:123], v[168:183]
    s_waitcnt lgkmcnt(6)
    v_mfma_f32_32x32x16_f16 v[168:183], v[124:127], v[128:131], v[168:183]
    s_waitcnt lgkmcnt(4)
    v_mfma_f32_32x32x16_f16 v[168:183], v[132:135], v[136:139], v[168:183]
    s_waitcnt lgkmcnt(2)
    v_mfma_f32_32x32x16_f16 v[168:183], v[140:143], v[144:147], v[168:183]
    s_waitcnt lgkmcnt(0)
    v_mfma_f32_32x32x16_f16 v[168:183], v[148:151], v[152:155], v[168:183]
    s_barrier
    ds_read_b128 v[92:95], v195 offset:256
    ds_read_b128 v[96:99], v253 offset:256
    ds_read_b128 v[100:103], v195 offset:288
    ds_read_b128 v[104:107], v253 offset:288
    ds_read_b128 v[108:111], v195 offset:320
    ds_read_b128 v[112:115], v253 offset:320
    ds_read_b128 v[116:119], v195 offset:352
    ds_read_b128 v[120:123], v253 offset:352
    ds_read_b128 v[124:127], v195 offset:384
    ds_read_b128 v[128:131], v253 offset:384
    ds_read_b128 v[132:135], v195 offset:416
    ds_read_b128 v[136:139], v253 offset:416
    ds_read_b128 v[140:143], v195 offset:448
    ds_read_b128 v[144:147], v253 offset:448
    ds_read_b128 v[148:151], v195 offset:480
    ds_read_b128 v[152:155], v253 offset:480
    s_waitcnt lgkmcnt(14)
    v_mfma_f32_32x32x16_f16 v[168:183], v[92:95], v[96:99], v[168:183]
    v_add_u32 v184, s62, v184
    v_add_u32 v185, s62, v185
    v_add_u32 v186, s62, v186
    s_waitcnt lgkmcnt(12)
    v_mfma_f32_32x32x16_f16 v[168:183], v[100:103], v[104:107], v[168:183]
    v_add_u32 v187, s62, v187
    v_add_u32 v188, s62, v188
    v_add_u32 v189, s62, v189
    s_waitcnt lgkmcnt(10)
    v_mfma_f32_32x32x16_f16 v[168:183], v[108:111], v[112:115], v[168:183]
    v_add_u32 v190, s62, v190
    v_add_u32 v191, s62, v191
    v_add_u32 v192, s62, v192
    s_waitcnt lgkmcnt(8)
    v_mfma_f32_32x32x16_f16 v[168:183], v[116:119], v[120:123], v[168:183]
    v_add_u32 v193, s62, v193
    v_add_u32 v194, s62, v194
    s_waitcnt lgkmcnt(6)
    v_mfma_f32_32x32x16_f16 v[168:183], v[124:127], v[128:131], v[168:183]
    s_waitcnt lgkmcnt(4)
    v_mfma_f32_32x32x16_f16 v[168:183], v[132:135], v[136:139], v[168:183]
    s_waitcnt lgkmcnt(2)
    v_mfma_f32_32x32x16_f16 v[168:183], v[140:143], v[144:147], v[168:183]
    s_waitcnt lgkmcnt(0)
    v_mfma_f32_32x32x16_f16 v[168:183], v[148:151], v[152:155], v[168:183]
    s_nop 11
    v_cvt_pk_f16_f32 v196, v171, v170
    v_cvt_pk_f16_f32 v197, v169, v168
    v_cvt_pk_f16_f32 v198, v183, v182
    ds_write2_b32 v184, v196, v197 offset0:0 offset1:1
    v_cvt_pk_f16_f32 v199, v181, v180
    v_cvt_pk_f16_f32 v200, v175, v175
    ds_write2_b32 v185, v198, v199 offset0:0 offset1:1
    v_cvt_pk_f16_f32 v201, v174, v173
    v_cvt_pk_f16_f32 v202, v173, v173
    ds_write2_b32 v189, v200, v201 offset0:0 offset1:1
    ds_write_b32 v190, v200
    v_cvt_pk_f16_f32 v203, v172, v176
    ds_write2_b32 v188, v200, v202 offset0:0 offset1:2
    v_cvt_pk_f16_f32 v204, v175, v174
    ds_write2_b32 v189, v202, v203 offset0:2 offset1:3
    v_cvt_pk_f16_f32 v205, v173, v172
    ds_write_b32 v186, v204
    v_cvt_pk_f16_f32 v206, v176, v177
    ds_write_b32 v187, v205
    v_cvt_pk_f16_f32 v207, v178, v179
    ds_write_b16 v191, v206
    ds_write_b16_d16_hi v192, v206
    ds_write_b16 v193, v207
    ds_write_b16_d16_hi v194, v207
    ds_read2_b32 v[28:29], v252 offset0:112 offset1:113
    ds_read2_b32 v[30:31], v252 offset0:114 offset1:115
    ds_read2_b32 v[32:33], v252 offset0:96 offset1:97
    ds_read2_b32 v[34:35], v252 offset0:98 offset1:99
    ds_read2_b32 v[36:37], v252 offset0:80 offset1:81
    ds_read2_b32 v[38:39], v252 offset0:82 offset1:83
    ds_read2_b32 v[40:41], v252 offset0:64 offset1:65
    ds_read2_b32 v[42:43], v252 offset0:66 offset1:67
    ds_read2_b32 v[44:45], v252 offset0:48 offset1:49
    ds_read2_b32 v[46:47], v252 offset0:50 offset1:51
    ds_read2_b32 v[48:49], v252 offset0:32 offset1:33
    ds_read2_b32 v[50:51], v252 offset0:34 offset1:35
    ds_read2_b32 v[52:53], v252 offset0:16 offset1:17
    ds_read2_b32 v[54:55], v252 offset0:18 offset1:19
    ds_read2_b32 v[56:57], v252 offset0:0 offset1:1
    ds_read2_b32 v[58:59], v252 offset0:2 offset1:3
    s_waitcnt lgkmcnt(15)
    s_barrier
    ds_read_b128 v[92:95], v248 offset:480
    ds_read_b128 v[96:99], v248 offset:416
    ds_read_b128 v[100:103], v248 offset:352
    ds_read_b128 v[104:107], v248 offset:288
    ds_read_b128 v[108:111], v248 offset:224
    ds_read_b128 v[112:115], v248 offset:160
    ds_read_b128 v[116:119], v248 offset:96
    ds_read_b128 v[120:123], v248 offset:32
    s_waitcnt lgkmcnt(7)
    v_mfma_f32_16x16x32_f16 v[156:159], v[28:31], v[92:95], 0
    ds_read2_b32 v[60:61], v250 offset0:112 offset1:113
    ds_read2_b32 v[62:63], v250 offset0:114 offset1:115
    ds_read_b128 v[124:127], v248 offset:992
    s_waitcnt lgkmcnt(9)
    v_mfma_f32_16x16x32_f16 v[156:159], v[32:35], v[96:99], v[156:159]
    ds_read2_b32 v[64:65], v250 offset0:96 offset1:97
    ds_read2_b32 v[66:67], v250 offset0:98 offset1:99
    ds_read_b128 v[128:131], v248 offset:928
    s_waitcnt lgkmcnt(11)
    v_mfma_f32_16x16x32_f16 v[156:159], v[36:39], v[100:103], v[156:159]
    ds_read2_b32 v[68:69], v250 offset0:80 offset1:81
    ds_read2_b32 v[70:71], v250 offset0:82 offset1:83
    ds_read_b128 v[132:135], v248 offset:864
    s_waitcnt lgkmcnt(13)
    v_mfma_f32_16x16x32_f16 v[156:159], v[40:43], v[104:107], v[156:159]
    ds_read2_b32 v[72:73], v250 offset0:64 offset1:65
    ds_read2_b32 v[74:75], v250 offset0:66 offset1:67
    ds_read_b128 v[136:139], v248 offset:800
    s_waitcnt lgkmcnt(15)
    v_mfma_f32_16x16x32_f16 v[156:159], v[44:47], v[108:111], v[156:159]
    ds_read2_b32 v[76:77], v250 offset0:48 offset1:49
    ds_read2_b32 v[78:79], v250 offset0:50 offset1:51
    ds_read_b128 v[140:143], v248 offset:736
    s_waitcnt lgkmcnt(15)
    v_mfma_f32_16x16x32_f16 v[156:159], v[48:51], v[112:115], v[156:159]
    ds_read2_b32 v[80:81], v250 offset0:32 offset1:33
    ds_read2_b32 v[82:83], v250 offset0:34 offset1:35
    ds_read_b128 v[144:147], v248 offset:672
    s_waitcnt lgkmcnt(15)
    v_mfma_f32_16x16x32_f16 v[156:159], v[52:55], v[116:119], v[156:159]
    ds_read2_b32 v[84:85], v250 offset0:16 offset1:17
    ds_read2_b32 v[86:87], v250 offset0:18 offset1:19
    ds_read_b128 v[148:151], v248 offset:608
    s_waitcnt lgkmcnt(15)
    v_mfma_f32_16x16x32_f16 v[156:159], v[56:59], v[120:123], v[156:159]
    ds_read2_b32 v[88:89], v250 offset0:0 offset1:1
    ds_read2_b32 v[90:91], v250 offset0:2 offset1:3
    ds_read_b128 v[152:155], v248 offset:544
    s_waitcnt lgkmcnt(15)
    v_mfma_f32_16x16x32_f16 v[160:163], v[60:63], v[92:95], 0
    ds_read_b128 v[92:95], v248 offset:1504
    s_waitcnt lgkmcnt(15)
    v_mfma_f32_16x16x32_f16 v[160:163], v[28:31], v[124:127], v[160:163]
    v_mfma_f32_16x16x32_f16 v[160:163], v[64:67], v[96:99], v[160:163]
    ds_read_b128 v[96:99], v248 offset:1440
    v_mfma_f32_16x16x32_f16 v[160:163], v[32:35], v[128:131], v[160:163]
    s_waitcnt lgkmcnt(15)
    v_mfma_f32_16x16x32_f16 v[160:163], v[68:71], v[100:103], v[160:163]
    ds_read_b128 v[100:103], v248 offset:1376
    s_waitcnt lgkmcnt(15)
    v_mfma_f32_16x16x32_f16 v[160:163], v[36:39], v[132:135], v[160:163]
    v_cvt_pkrtz_f16_f32 v156, v156, v157
    v_cvt_pkrtz_f16_f32 v157, v158, v159
    v_mfma_f32_16x16x32_f16 v[160:163], v[72:75], v[104:107], v[160:163]
    ds_read_b128 v[104:107], v248 offset:1312
    v_mfma_f32_16x16x32_f16 v[160:163], v[40:43], v[136:139], v[160:163]
    v_add_u32 v156, v11, v156
    v_add_u32 v157, v11, v157
    s_waitcnt lgkmcnt(14)
    v_mfma_f32_16x16x32_f16 v[160:163], v[76:79], v[108:111], v[160:163]
    ds_read_b128 v[108:111], v248 offset:1248
    s_waitcnt lgkmcnt(11)
    v_mfma_f32_16x16x32_f16 v[160:163], v[44:47], v[140:143], v[160:163]
    ds_write_b64 v251, v[156:157] offset:0
    v_mfma_f32_16x16x32_f16 v[160:163], v[80:83], v[112:115], v[160:163]
    ds_read_b128 v[112:115], v248 offset:1184
    v_mfma_f32_16x16x32_f16 v[160:163], v[48:51], v[144:147], v[160:163]
    s_barrier
    ds_read_b128 v[164:167], v249 offset:0
    ds_read_b128 v[168:171], v249 offset:1024
    s_waitcnt lgkmcnt(13)
    v_mfma_f32_16x16x32_f16 v[160:163], v[84:87], v[116:119], v[160:163]
    ds_read_b128 v[116:119], v248 offset:1120
    s_waitcnt lgkmcnt(10)
    v_mfma_f32_16x16x32_f16 v[160:163], v[52:55], v[148:151], v[160:163]
    v_mfma_f32_16x16x32_f16 v[160:163], v[88:91], v[120:123], v[160:163]
    ds_read_b128 v[120:123], v248 offset:1056
    v_mfma_f32_16x16x32_f16 v[160:163], v[56:59], v[152:155], v[160:163]
    s_waitcnt lgkmcnt(3)
    v_mfma_f32_16x16x32_f16 v[164:167], v[60:63], v[124:127], v[164:167]
    ds_read_b128 v[124:127], v248 offset:2016
    v_mfma_f32_16x16x32_f16 v[164:167], v[28:31], v[92:95], v[164:167]
    v_mfma_f32_16x16x32_f16 v[164:167], v[64:67], v[128:131], v[164:167]
    ds_read_b128 v[128:131], v248 offset:1952
    v_mfma_f32_16x16x32_f16 v[164:167], v[32:35], v[96:99], v[164:167]
    v_mfma_f32_16x16x32_f16 v[164:167], v[68:71], v[132:135], v[164:167]
    ds_read_b128 v[132:135], v248 offset:1888
    v_mfma_f32_16x16x32_f16 v[164:167], v[36:39], v[100:103], v[164:167]
    v_cvt_pkrtz_f16_f32 v160, v160, v161
    v_cvt_pkrtz_f16_f32 v161, v162, v163
    v_mfma_f32_16x16x32_f16 v[164:167], v[72:75], v[136:139], v[164:167]
    ds_read_b128 v[136:139], v248 offset:1824
    v_mfma_f32_16x16x32_f16 v[164:167], v[40:43], v[104:107], v[164:167]
    v_add_u32 v160, v11, v160
    v_add_u32 v161, v11, v161
    v_mfma_f32_16x16x32_f16 v[164:167], v[76:79], v[140:143], v[164:167]
    ds_read_b128 v[140:143], v248 offset:1760
    v_mfma_f32_16x16x32_f16 v[164:167], v[44:47], v[108:111], v[164:167]
    ds_write_b64 v251, v[160:161] offset:512
    v_mfma_f32_16x16x32_f16 v[164:167], v[80:83], v[144:147], v[164:167]
    ds_read_b128 v[144:147], v248 offset:1696
    v_mfma_f32_16x16x32_f16 v[164:167], v[48:51], v[112:115], v[164:167]
    v_mfma_f32_16x16x32_f16 v[164:167], v[84:87], v[148:151], v[164:167]
    ds_read_b128 v[148:151], v248 offset:1632
    s_waitcnt lgkmcnt(8)
    v_mfma_f32_16x16x32_f16 v[164:167], v[52:55], v[116:119], v[164:167]
    v_mfma_f32_16x16x32_f16 v[164:167], v[88:91], v[152:155], v[164:167]
    ds_read_b128 v[152:155], v248 offset:1568
    v_mfma_f32_16x16x32_f16 v[164:167], v[56:59], v[120:123], v[164:167]
    v_mfma_f32_16x16x32_f16 v[168:171], v[60:63], v[92:95], v[168:171]
    ds_read_b128 v[92:95], v248 offset:2528
    s_waitcnt lgkmcnt(8)
    v_mfma_f32_16x16x32_f16 v[168:171], v[28:31], v[124:127], v[168:171]
    v_mfma_f32_16x16x32_f16 v[168:171], v[64:67], v[96:99], v[168:171]
    ds_read_b128 v[96:99], v248 offset:2464
    v_mfma_f32_16x16x32_f16 v[168:171], v[32:35], v[128:131], v[168:171]
    v_mfma_f32_16x16x32_f16 v[168:171], v[68:71], v[100:103], v[168:171]
    ds_read_b128 v[100:103], v248 offset:2400
    s_waitcnt lgkmcnt(8)
    v_mfma_f32_16x16x32_f16 v[168:171], v[36:39], v[132:135], v[168:171]
    v_cvt_pkrtz_f16_f32 v164, v164, v165
    v_cvt_pkrtz_f16_f32 v165, v166, v167
    v_mfma_f32_16x16x32_f16 v[168:171], v[72:75], v[104:107], v[168:171]
    ds_read_b128 v[104:107], v248 offset:2336
    v_mfma_f32_16x16x32_f16 v[168:171], v[40:43], v[136:139], v[168:171]
    v_add_u32 v164, v11, v164
    v_add_u32 v165, v11, v165
    v_mfma_f32_16x16x32_f16 v[168:171], v[76:79], v[108:111], v[168:171]
    ds_read_b128 v[108:111], v248 offset:2272
    s_waitcnt lgkmcnt(7)
    v_mfma_f32_16x16x32_f16 v[168:171], v[44:47], v[140:143], v[168:171]
    ds_write_b64 v251, v[164:165] offset:1024
    v_mfma_f32_16x16x32_f16 v[168:171], v[80:83], v[112:115], v[168:171]
    ds_read_b128 v[112:115], v248 offset:2208
    v_mfma_f32_16x16x32_f16 v[168:171], v[48:51], v[144:147], v[168:171]
    s_waitcnt lgkmcnt(1)
    s_barrier
    ds_read_b128 v[172:175], v249 offset:2048
    ds_read_b128 v[176:179], v249 offset:3072
    ds_read_b128 v[180:183], v249 offset:4096
    ds_read_b128 v[184:187], v249 offset:5120
    v_mfma_f32_16x16x32_f16 v[168:171], v[84:87], v[116:119], v[168:171]
    ds_read_b128 v[116:119], v248 offset:2144
    v_mfma_f32_16x16x32_f16 v[168:171], v[52:55], v[148:151], v[168:171]
    v_mfma_f32_16x16x32_f16 v[168:171], v[88:91], v[120:123], v[168:171]
    ds_read_b128 v[120:123], v248 offset:2080
    v_mfma_f32_16x16x32_f16 v[168:171], v[56:59], v[152:155], v[168:171]
    s_waitcnt lgkmcnt(5)
    v_mfma_f32_16x16x32_f16 v[172:175], v[60:63], v[124:127], v[172:175]
    ds_read_b128 v[124:127], v248 offset:3040
    v_mfma_f32_16x16x32_f16 v[172:175], v[28:31], v[92:95], v[172:175]
    v_mfma_f32_16x16x32_f16 v[172:175], v[64:67], v[128:131], v[172:175]
    ds_read_b128 v[128:131], v248 offset:2976
    v_mfma_f32_16x16x32_f16 v[172:175], v[32:35], v[96:99], v[172:175]
    v_mfma_f32_16x16x32_f16 v[172:175], v[68:71], v[132:135], v[172:175]
    ds_read_b128 v[132:135], v248 offset:2912
    v_mfma_f32_16x16x32_f16 v[172:175], v[36:39], v[100:103], v[172:175]
    v_cvt_pkrtz_f16_f32 v168, v168, v169
    v_cvt_pkrtz_f16_f32 v169, v170, v171
    v_mfma_f32_16x16x32_f16 v[172:175], v[72:75], v[136:139], v[172:175]
    ds_read_b128 v[136:139], v248 offset:2848
    v_mfma_f32_16x16x32_f16 v[172:175], v[40:43], v[104:107], v[172:175]
    v_add_u32 v168, v11, v168
    v_add_u32 v169, v11, v169
    v_mfma_f32_16x16x32_f16 v[172:175], v[76:79], v[140:143], v[172:175]
    ds_read_b128 v[140:143], v248 offset:2784
    v_mfma_f32_16x16x32_f16 v[172:175], v[44:47], v[108:111], v[172:175]
    ds_write_b64 v251, v[168:169] offset:1536
    v_mfma_f32_16x16x32_f16 v[172:175], v[80:83], v[144:147], v[172:175]
    ds_read_b128 v[144:147], v248 offset:2720
    v_mfma_f32_16x16x32_f16 v[172:175], v[48:51], v[112:115], v[172:175]
    v_mfma_f32_16x16x32_f16 v[172:175], v[84:87], v[148:151], v[172:175]
    ds_read_b128 v[148:151], v248 offset:2656
    s_waitcnt lgkmcnt(8)
    v_mfma_f32_16x16x32_f16 v[172:175], v[52:55], v[116:119], v[172:175]
    v_mfma_f32_16x16x32_f16 v[172:175], v[88:91], v[152:155], v[172:175]
    ds_read_b128 v[152:155], v248 offset:2592
    v_mfma_f32_16x16x32_f16 v[172:175], v[56:59], v[120:123], v[172:175]
    v_mfma_f32_16x16x32_f16 v[176:179], v[60:63], v[92:95], v[176:179]
    ds_read_b128 v[92:95], v248 offset:3552
    s_waitcnt lgkmcnt(8)
    v_mfma_f32_16x16x32_f16 v[176:179], v[28:31], v[124:127], v[176:179]
    v_mfma_f32_16x16x32_f16 v[176:179], v[64:67], v[96:99], v[176:179]
    ds_read_b128 v[96:99], v248 offset:3488
    v_mfma_f32_16x16x32_f16 v[176:179], v[32:35], v[128:131], v[176:179]
    v_mfma_f32_16x16x32_f16 v[176:179], v[68:71], v[100:103], v[176:179]
    ds_read_b128 v[100:103], v248 offset:3424
    s_waitcnt lgkmcnt(8)
    v_mfma_f32_16x16x32_f16 v[176:179], v[36:39], v[132:135], v[176:179]
    v_cvt_pkrtz_f16_f32 v172, v172, v173
    v_cvt_pkrtz_f16_f32 v173, v174, v175
    v_mfma_f32_16x16x32_f16 v[176:179], v[72:75], v[104:107], v[176:179]
    ds_read_b128 v[104:107], v248 offset:3360
    v_mfma_f32_16x16x32_f16 v[176:179], v[40:43], v[136:139], v[176:179]
    v_add_u32 v172, v11, v172
    v_add_u32 v173, v11, v173
    v_mfma_f32_16x16x32_f16 v[176:179], v[76:79], v[108:111], v[176:179]
    ds_read_b128 v[108:111], v248 offset:3296
    s_waitcnt lgkmcnt(7)
    v_mfma_f32_16x16x32_f16 v[176:179], v[44:47], v[140:143], v[176:179]
    ds_write_b64 v251, v[172:173] offset:2048
    v_mfma_f32_16x16x32_f16 v[176:179], v[80:83], v[112:115], v[176:179]
    ds_read_b128 v[112:115], v248 offset:3232
    v_mfma_f32_16x16x32_f16 v[176:179], v[48:51], v[144:147], v[176:179]
    v_mfma_f32_16x16x32_f16 v[176:179], v[84:87], v[116:119], v[176:179]
    ds_read_b128 v[116:119], v248 offset:3168
    s_waitcnt lgkmcnt(8)
    v_mfma_f32_16x16x32_f16 v[176:179], v[52:55], v[148:151], v[176:179]
    v_mfma_f32_16x16x32_f16 v[176:179], v[88:91], v[120:123], v[176:179]
    ds_read_b128 v[120:123], v248 offset:3104
    v_mfma_f32_16x16x32_f16 v[176:179], v[56:59], v[152:155], v[176:179]
    s_waitcnt lgkmcnt(3)
    s_barrier
    v_mfma_f32_16x16x32_f16 v[180:183], v[60:63], v[124:127], v[180:183]
    ds_read_b128 v[124:127], v248 offset:4064
    v_mfma_f32_16x16x32_f16 v[180:183], v[28:31], v[92:95], v[180:183]
    v_mfma_f32_16x16x32_f16 v[180:183], v[64:67], v[128:131], v[180:183]
    ds_read_b128 v[128:131], v248 offset:4000
    v_mfma_f32_16x16x32_f16 v[180:183], v[32:35], v[96:99], v[180:183]
    v_mfma_f32_16x16x32_f16 v[180:183], v[68:71], v[132:135], v[180:183]
    ds_read_b128 v[132:135], v248 offset:3936
    v_mfma_f32_16x16x32_f16 v[180:183], v[36:39], v[100:103], v[180:183]
    v_cvt_pkrtz_f16_f32 v176, v176, v177
    v_cvt_pkrtz_f16_f32 v177, v178, v179
    v_mfma_f32_16x16x32_f16 v[180:183], v[72:75], v[136:139], v[180:183]
    ds_read_b128 v[136:139], v248 offset:3872
    v_mfma_f32_16x16x32_f16 v[180:183], v[40:43], v[104:107], v[180:183]
    v_add_u32 v176, v11, v176
    v_add_u32 v177, v11, v177
    v_mfma_f32_16x16x32_f16 v[180:183], v[76:79], v[140:143], v[180:183]
    ds_read_b128 v[140:143], v248 offset:3808
    s_waitcnt lgkmcnt(7)
    v_mfma_f32_16x16x32_f16 v[180:183], v[44:47], v[108:111], v[180:183]
    ds_write_b64 v251, v[176:177] offset:2560
    v_mfma_f32_16x16x32_f16 v[180:183], v[80:83], v[144:147], v[180:183]
    ds_read_b128 v[144:147], v248 offset:3744
    v_mfma_f32_16x16x32_f16 v[180:183], v[48:51], v[112:115], v[180:183]
    v_mfma_f32_16x16x32_f16 v[180:183], v[84:87], v[148:151], v[180:183]
    ds_read_b128 v[148:151], v248 offset:3680
    s_waitcnt lgkmcnt(8)
    v_mfma_f32_16x16x32_f16 v[180:183], v[52:55], v[116:119], v[180:183]
    v_mfma_f32_16x16x32_f16 v[180:183], v[88:91], v[152:155], v[180:183]
    ds_read_b128 v[152:155], v248 offset:3616
    v_mfma_f32_16x16x32_f16 v[180:183], v[56:59], v[120:123], v[180:183]
    s_waitcnt lgkmcnt(3)
    s_barrier
    v_mfma_f32_16x16x32_f16 v[184:187], v[60:63], v[92:95], v[184:187]
    v_mfma_f32_16x16x32_f16 v[184:187], v[28:31], v[124:127], v[184:187]
    v_mfma_f32_16x16x32_f16 v[184:187], v[64:67], v[96:99], v[184:187]
    v_mfma_f32_16x16x32_f16 v[184:187], v[32:35], v[128:131], v[184:187]
    v_mfma_f32_16x16x32_f16 v[184:187], v[68:71], v[100:103], v[184:187]
    s_nop 0
    v_cvt_pkrtz_f16_f32 v180, v180, v181
    v_cvt_pkrtz_f16_f32 v181, v182, v183
    v_mfma_f32_16x16x32_f16 v[184:187], v[36:39], v[132:135], v[184:187]
    v_add_u32 v180, v11, v180
    v_add_u32 v181, v11, v181
    v_mfma_f32_16x16x32_f16 v[184:187], v[72:75], v[104:107], v[184:187]
    ds_write_b64 v251, v[180:181] offset:3072
    v_mfma_f32_16x16x32_f16 v[184:187], v[40:43], v[136:139], v[184:187]
    v_mfma_f32_16x16x32_f16 v[184:187], v[76:79], v[108:111], v[184:187]
    s_waitcnt lgkmcnt(3)
    v_mfma_f32_16x16x32_f16 v[184:187], v[44:47], v[140:143], v[184:187]
    s_waitcnt lgkmcnt(0)
    s_barrier
    v_mfma_f32_16x16x32_f16 v[184:187], v[80:83], v[112:115], v[184:187]
    v_mfma_f32_16x16x32_f16 v[184:187], v[48:51], v[144:147], v[184:187]
    v_mfma_f32_16x16x32_f16 v[184:187], v[84:87], v[116:119], v[184:187]
    v_mfma_f32_16x16x32_f16 v[184:187], v[52:55], v[148:151], v[184:187]
    v_mfma_f32_16x16x32_f16 v[184:187], v[88:91], v[120:123], v[184:187]
    v_mfma_f32_16x16x32_f16 v[184:187], v[56:59], v[152:155], v[184:187]
    s_nop 7
    v_cvt_pkrtz_f16_f32 v184, v184, v185
    v_cvt_pkrtz_f16_f32 v185, v186, v187
    v_add_u32 v184, v11, v184
    v_add_u32 v185, v11, v185
    ds_write_b64 v251, v[184:185] offset:3584
    s_waitcnt lgkmcnt(0)
    s_barrier
    s_branch RPREP
H_PATH:
    s_waitcnt lgkmcnt(0)
    s_barrier
    s_mov_b32 s47, 0
PL8:
    s_waitcnt vmcnt(0)
    v_cmp_ne_u32 vcc, s40, v58
    s_cbranch_vccz PD9
    s_add_u32 s47, s47, 1
    s_cmp_ge_u32 s47, 65536
    s_cbranch_scc1 PD9
    s_sleep 1
    buffer_load_dword v58, v59, s[32:35], s50 offen sc1
    s_branch PL8
PD9:
    buffer_load_dwordx4 v[40:43], v2, s[32:35], s48 offen offset:0 sc1
    buffer_load_dwordx4 v[44:47], v2, s[32:35], s48 offen offset:1024 sc1
    buffer_load_dwordx4 v[48:51], v2, s[32:35], s48 offen offset:2048 sc1
    buffer_load_dwordx4 v[52:55], v2, s[32:35], s48 offen offset:3072 sc1
    s_mov_b32 s47, 0
PL10:
    s_waitcnt vmcnt(0)
    v_xor_b32 v40, v10, v40
    v_xor_b32 v41, v10, v41
    v_xor_b32 v42, v10, v42
    v_xor_b32 v43, v10, v43
    v_xor_b32 v44, v10, v44
    v_xor_b32 v45, v10, v45
    v_xor_b32 v46, v10, v46
    v_xor_b32 v47, v10, v47
    v_xor_b32 v48, v10, v48
    v_xor_b32 v49, v10, v49
    v_xor_b32 v50, v10, v50
    v_xor_b32 v51, v10, v51
    v_xor_b32 v52, v10, v52
    v_xor_b32 v53, v10, v53
    v_xor_b32 v54, v10, v54
    v_xor_b32 v55, v10, v55
    v_or3_b32 v14, v40, v41, v42
    v_or3_b32 v14, v14, v43, v44
    v_or3_b32 v14, v14, v45, v46
    v_or3_b32 v14, v14, v47, v48
    v_or3_b32 v14, v14, v49, v50
    v_or3_b32 v14, v14, v51, v52
    v_or3_b32 v14, v14, v53, v54
    v_or_b32 v14, v14, v55
    v_and_b32 v14, 0x70007, v14
    v_cmp_ne_u32 vcc, 0, v14
    s_cbranch_vccz PD11
    s_add_u32 s47, s47, 1
    s_cmp_ge_u32 s47, 65536
    s_cbranch_scc1 PD11
    s_sleep 2
    buffer_load_dwordx4 v[40:43], v2, s[32:35], s48 offen offset:0 sc1
    buffer_load_dwordx4 v[44:47], v2, s[32:35], s48 offen offset:1024 sc1
    buffer_load_dwordx4 v[48:51], v2, s[32:35], s48 offen offset:2048 sc1
    buffer_load_dwordx4 v[52:55], v2, s[32:35], s48 offen offset:3072 sc1
    s_branch PL10
PD11:
    ds_write_b128 v254, v[40:43] offset:0
    ds_write_b128 v254, v[44:47] offset:256
    ds_write_b128 v254, v[48:51] offset:512
    ds_write_b128 v254, v[52:55] offset:768
    v_mov_b32 v15, s62
    s_setprio 1
    s_waitcnt lgkmcnt(0)
    s_barrier
    ds_read_b128 v[28:31], v248 offset:480
    ds_read_b128 v[32:35], v248 offset:464
    ds_read_b128 v[36:39], v248 offset:992
    ds_read_b128 v[40:43], v248 offset:976
    s_waitcnt lgkmcnt(3)
    v_mfma_f32_16x16x32_f16 v[76:79], v[28:31], v[172:175], 0
    v_mfma_f32_16x16x32_f16 v[80:83], v[28:31], v[168:171], 0
    v_mfma_f32_16x16x32_f16 v[88:91], v[28:31], v[176:179], 0
    s_waitcnt lgkmcnt(2)
    v_mfma_f32_16x16x32_f16 v[84:87], v[32:35], v[180:183], 0
    ds_read_b128 v[44:47], v248 offset:1504
    ds_read_b128 v[48:51], v248 offset:1488
    v_mfma_f32_16x16x32_f16 v[92:95], v[28:31], v[184:187], 0
    s_nop 1
    v_cvt_pk_f16_f32 v100, v76, v80
    v_cvt_pk_f16_f32 v101, v77, v81
    v_mfma_f32_16x16x32_f16 v[96:99], v[32:35], v[188:191], 0
    v_cvt_pk_f16_f32 v102, v78, v82
    v_cvt_pk_f16_f32 v103, v79, v83
    s_waitcnt lgkmcnt(3)
    v_mfma_f32_16x16x32_f16 v[76:79], v[36:39], v[172:175], 0
    v_cvt_pk_f16_f32 v104, v84, v88
    v_cvt_pk_f16_f32 v105, v85, v89
    v_mfma_f32_16x16x32_f16 v[80:83], v[36:39], v[168:171], 0
    v_cvt_pk_f16_f32 v106, v86, v90
    v_cvt_pk_f16_f32 v107, v87, v91
    v_mfma_f32_16x16x32_f16 v[88:91], v[36:39], v[176:179], 0
    v_cvt_pk_f16_f32 v148, v92, v96
    v_cvt_pk_f16_f32 v149, v93, v97
    s_waitcnt lgkmcnt(2)
    v_mfma_f32_16x16x32_f16 v[84:87], v[40:43], v[180:183], 0
    v_cvt_pk_f16_f32 v150, v94, v98
    v_cvt_pk_f16_f32 v151, v95, v99
    ds_read_b128 v[52:55], v248 offset:2016
    ds_read_b128 v[56:59], v248 offset:2000
    v_mfma_f32_16x16x32_f16 v[92:95], v[36:39], v[184:187], 0
    v_cvt_pk_f16_f32 v108, v76, v80
    v_cvt_pk_f16_f32 v109, v77, v81
    v_mfma_f32_16x16x32_f16 v[96:99], v[40:43], v[188:191], 0
    v_cvt_pk_f16_f32 v110, v78, v82
    v_cvt_pk_f16_f32 v111, v79, v83
    s_waitcnt lgkmcnt(3)
    v_mfma_f32_16x16x32_f16 v[76:79], v[44:47], v[172:175], 0
    v_cvt_pk_f16_f32 v112, v84, v88
    v_cvt_pk_f16_f32 v113, v85, v89
    v_mfma_f32_16x16x32_f16 v[80:83], v[44:47], v[168:171], 0
    v_cvt_pk_f16_f32 v114, v86, v90
    v_cvt_pk_f16_f32 v115, v87, v91
    v_mfma_f32_16x16x32_f16 v[88:91], v[44:47], v[176:179], 0
    v_cvt_pk_f16_f32 v152, v92, v96
    v_cvt_pk_f16_f32 v153, v93, v97
    s_waitcnt lgkmcnt(2)
    v_mfma_f32_16x16x32_f16 v[84:87], v[48:51], v[180:183], 0
    v_cvt_pk_f16_f32 v154, v94, v98
    v_cvt_pk_f16_f32 v155, v95, v99
    ds_read_b128 v[60:63], v248 offset:2528
    ds_read_b128 v[64:67], v248 offset:2512
    v_mfma_f32_16x16x32_f16 v[92:95], v[44:47], v[184:187], 0
    v_cvt_pk_f16_f32 v116, v76, v80
    v_cvt_pk_f16_f32 v117, v77, v81
    v_mfma_f32_16x16x32_f16 v[96:99], v[48:51], v[188:191], 0
    v_cvt_pk_f16_f32 v118, v78, v82
    v_cvt_pk_f16_f32 v119, v79, v83
    ds_read_b128 v[68:71], v248 offset:3040
    ds_read_b128 v[72:75], v248 offset:3024
    s_waitcnt lgkmcnt(5)
    v_mfma_f32_16x16x32_f16 v[76:79], v[52:55], v[172:175], 0
    v_cvt_pk_f16_f32 v120, v84, v88
    v_cvt_pk_f16_f32 v121, v85, v89
    v_mfma_f32_16x16x32_f16 v[80:83], v[52:55], v[168:171], 0
    v_cvt_pk_f16_f32 v122, v86, v90
    v_cvt_pk_f16_f32 v123, v87, v91
    v_mfma_f32_16x16x32_f16 v[88:91], v[52:55], v[176:179], 0
    v_cvt_pk_f16_f32 v156, v92, v96
    v_cvt_pk_f16_f32 v157, v93, v97
    s_waitcnt lgkmcnt(4)
    v_mfma_f32_16x16x32_f16 v[84:87], v[56:59], v[180:183], 0
    v_cvt_pk_f16_f32 v158, v94, v98
    v_cvt_pk_f16_f32 v159, v95, v99
    ds_read2_b32 v[196:197], v250 offset0:0 offset1:1
    ds_read2_b32 v[198:199], v250 offset0:2 offset1:3
    v_mfma_f32_16x16x32_f16 v[92:95], v[52:55], v[184:187], 0
    v_cvt_pk_f16_f32 v124, v76, v80
    v_cvt_pk_f16_f32 v125, v77, v81
    v_mfma_f32_16x16x32_f16 v[96:99], v[56:59], v[188:191], 0
    v_cvt_pk_f16_f32 v126, v78, v82
    v_cvt_pk_f16_f32 v127, v79, v83
    ds_read2_b32 v[200:201], v251 offset0:32 offset1:33
    ds_read2_b32 v[202:203], v251 offset0:34 offset1:35
    s_waitcnt lgkmcnt(7)
    v_mfma_f32_16x16x32_f16 v[76:79], v[60:63], v[172:175], 0
    v_cvt_pk_f16_f32 v128, v84, v88
    v_cvt_pk_f16_f32 v129, v85, v89
    v_mfma_f32_16x16x32_f16 v[80:83], v[60:63], v[168:171], 0
    v_cvt_pk_f16_f32 v130, v86, v90
    v_cvt_pk_f16_f32 v131, v87, v91
    ds_read2_b32 v[204:205], v251 offset0:80 offset1:81
    ds_read2_b32 v[206:207], v251 offset0:82 offset1:83
    v_mfma_f32_16x16x32_f16 v[88:91], v[60:63], v[176:179], 0
    v_cvt_pk_f16_f32 v160, v92, v96
    v_cvt_pk_f16_f32 v161, v93, v97
    s_waitcnt lgkmcnt(8)
    v_mfma_f32_16x16x32_f16 v[84:87], v[64:67], v[180:183], 0
    v_cvt_pk_f16_f32 v162, v94, v98
    v_cvt_pk_f16_f32 v163, v95, v99
    ds_read2_b32 v[208:209], v251 offset0:16 offset1:17
    ds_read2_b32 v[210:211], v251 offset0:18 offset1:19
    s_waitcnt lgkmcnt(9)
    v_mfma_f32_16x16x32_f16 v[92:95], v[68:71], v[172:175], 0
    v_cvt_pk_f16_f32 v132, v76, v80
    v_cvt_pk_f16_f32 v133, v77, v81
    v_mfma_f32_16x16x32_f16 v[96:99], v[68:71], v[168:171], 0
    v_cvt_pk_f16_f32 v134, v78, v82
    v_cvt_pk_f16_f32 v135, v79, v83
    ds_read2_b32 v[212:213], v251 offset0:64 offset1:65
    ds_read2_b32 v[214:215], v251 offset0:66 offset1:67
    v_mfma_f32_16x16x32_f16 v[80:83], v[68:71], v[176:179], 0
    v_cvt_pk_f16_f32 v136, v84, v88
    v_cvt_pk_f16_f32 v137, v85, v89
    s_waitcnt lgkmcnt(10)
    v_mfma_f32_16x16x32_f16 v[76:79], v[72:75], v[180:183], 0
    v_cvt_pk_f16_f32 v138, v86, v90
    v_cvt_pk_f16_f32 v139, v87, v91
    ds_read_u16 v15, v15 offset:2448
    s_waitcnt lgkmcnt(9)
    v_mfma_f32_16x16x32_f16 v[164:167], v[196:199], v[28:31], 0
    v_cvt_pk_f16_f32 v140, v92, v96
    v_cvt_pk_f16_f32 v141, v93, v97
    s_waitcnt lgkmcnt(7)
    v_mfma_f32_16x16x32_f16 v[164:167], v[100:103], v[200:203], v[164:167]
    v_cvt_pk_f16_f32 v142, v94, v98
    v_cvt_pk_f16_f32 v143, v95, v99
    s_waitcnt lgkmcnt(5)
    v_mfma_f32_16x16x32_f16 v[164:167], v[104:107], v[204:207], v[164:167]
    v_cvt_pk_f16_f32 v144, v76, v80
    v_cvt_pk_f16_f32 v145, v77, v81
    v_mfma_f32_16x16x32_f16 v[240:243], v[196:199], v[36:39], 0
    v_cvt_pk_f16_f32 v146, v78, v82
    v_cvt_pk_f16_f32 v147, v79, v83
    v_mfma_f32_16x16x32_f16 v[240:243], v[108:111], v[200:203], v[240:243]
    s_waitcnt lgkmcnt(0)
    v_lshl_or_b32 v15, v15, 16, v15
    v_and_b32 v192, v15, v192
    v_and_b32 v193, v15, v193
    v_and_b32 v194, v15, v194
    v_and_b32 v195, v15, v195
    v_mfma_f32_16x16x32_f16 v[240:243], v[112:115], v[204:207], v[240:243]
    v_mfma_f32_16x16x32_f16 v[240:243], v[100:103], v[208:211], v[240:243]
    v_mfma_f32_16x16x32_f16 v[240:243], v[104:107], v[212:215], v[240:243]
    ds_write_b128 v249, v[164:167] offset:0
    s_nop 6
    ds_write_b128 v249, v[240:243] offset:1024
    s_waitcnt lgkmcnt(0)
    s_barrier
    ds_read2_b32 v[216:217], v251 offset0:0 offset1:1
    ds_read2_b32 v[218:219], v251 offset0:2 offset1:3
    ds_read2_b32 v[220:221], v251 offset0:48 offset1:49
    ds_read2_b32 v[222:223], v251 offset0:50 offset1:51
    ds_read2_b32 v[224:225], v251 offset0:160 offset1:161
    ds_read2_b32 v[226:227], v251 offset0:162 offset1:163
    v_mfma_f32_16x16x32_f16 v[164:167], v[196:199], v[44:47], 0
    ds_read2_b32 v[228:229], v251 offset0:144 offset1:145
    ds_read2_b32 v[230:231], v251 offset0:146 offset1:147
    v_mfma_f32_16x16x32_f16 v[164:167], v[116:119], v[200:203], v[164:167]
    ds_read2_b32 v[232:233], v251 offset0:128 offset1:129
    ds_read2_b32 v[234:235], v251 offset0:130 offset1:131
    v_mfma_f32_16x16x32_f16 v[164:167], v[120:123], v[204:207], v[164:167]
    ds_read2_b32 v[236:237], v251 offset0:112 offset1:113
    ds_read2_b32 v[238:239], v251 offset0:114 offset1:115
    v_mfma_f32_16x16x32_f16 v[164:167], v[108:111], v[208:211], v[164:167]
    v_mfma_f32_16x16x32_f16 v[164:167], v[112:115], v[212:215], v[164:167]
    s_waitcnt lgkmcnt(10)
    v_mfma_f32_16x16x32_f16 v[164:167], v[100:103], v[216:219], v[164:167]
    s_waitcnt lgkmcnt(8)
    v_mfma_f32_16x16x32_f16 v[164:167], v[104:107], v[220:223], v[164:167]
    v_mfma_f32_16x16x32_f16 v[164:167], v[192:195], v[28:31], v[164:167]
    s_waitcnt lgkmcnt(6)
    v_mfma_f32_16x16x32_f16 v[164:167], v[148:151], v[224:227], v[164:167]
    v_mfma_f32_16x16x32_f16 v[240:243], v[196:199], v[52:55], 0
    v_mfma_f32_16x16x32_f16 v[240:243], v[124:127], v[200:203], v[240:243]
    v_mfma_f32_16x16x32_f16 v[240:243], v[128:131], v[204:207], v[240:243]
    v_mfma_f32_16x16x32_f16 v[240:243], v[116:119], v[208:211], v[240:243]
    v_mfma_f32_16x16x32_f16 v[240:243], v[120:123], v[212:215], v[240:243]
    s_nop 2
    ds_write_b128 v249, v[164:167] offset:2048
    v_mfma_f32_16x16x32_f16 v[240:243], v[108:111], v[216:219], v[240:243]
    s_mov_b64 s[54:55], 0
    s_cmp_ge_u32 s49, 128
    s_cbranch_scc1 H_NOR0
    s_movk_i32 s53, 144
    s_lshl_b32 s46, s51, 6
    v_add_u32 v14, s46, v1
    v_cmp_gt_u32 s[54:55], s53, v14
    v_lshlrev_b32 v27, 7, v14
    v_lshlrev_b32 v14, 4, v14
    s_mov_b32 s53, 32768
    s_and_b64 exec, s[54:55], -1
    s_cbranch_execz SCS12
    buffer_load_dwordx4 v[244:247], v27, s[32:35], s53 offen sc1
SCS12:
    s_mov_b64 exec, -1
H_NOR0:
    v_mfma_f32_16x16x32_f16 v[240:243], v[112:115], v[220:223], v[240:243]
    v_mfma_f32_16x16x32_f16 v[240:243], v[192:195], v[36:39], v[240:243]
    v_mfma_f32_16x16x32_f16 v[240:243], v[152:155], v[224:227], v[240:243]
    s_waitcnt lgkmcnt(5)
    v_mfma_f32_16x16x32_f16 v[240:243], v[148:151], v[228:231], v[240:243]
    v_mfma_f32_16x16x32_f16 v[164:167], v[196:199], v[60:63], 0
    v_mfma_f32_16x16x32_f16 v[164:167], v[132:135], v[200:203], v[164:167]
    v_mfma_f32_16x16x32_f16 v[164:167], v[136:139], v[204:207], v[164:167]
    v_mfma_f32_16x16x32_f16 v[164:167], v[124:127], v[208:211], v[164:167]
    v_mfma_f32_16x16x32_f16 v[164:167], v[128:131], v[212:215], v[164:167]
    s_nop 2
    ds_write_b128 v249, v[240:243] offset:3072
    v_mfma_f32_16x16x32_f16 v[164:167], v[116:119], v[216:219], v[164:167]
    v_mfma_f32_16x16x32_f16 v[164:167], v[120:123], v[220:223], v[164:167]
    v_mfma_f32_16x16x32_f16 v[164:167], v[192:195], v[44:47], v[164:167]
    v_mfma_f32_16x16x32_f16 v[164:167], v[156:159], v[224:227], v[164:167]
    v_mfma_f32_16x16x32_f16 v[164:167], v[152:155], v[228:231], v[164:167]
    s_waitcnt lgkmcnt(4)
    v_mfma_f32_16x16x32_f16 v[164:167], v[148:151], v[232:235], v[164:167]
    v_mfma_f32_16x16x32_f16 v[240:243], v[196:199], v[68:71], 0
    v_mfma_f32_16x16x32_f16 v[240:243], v[140:143], v[200:203], v[240:243]
    v_mfma_f32_16x16x32_f16 v[240:243], v[144:147], v[204:207], v[240:243]
    v_mfma_f32_16x16x32_f16 v[240:243], v[132:135], v[208:211], v[240:243]
    v_mfma_f32_16x16x32_f16 v[240:243], v[136:139], v[212:215], v[240:243]
    s_nop 2
    ds_write_b128 v249, v[164:167] offset:4096
    v_mfma_f32_16x16x32_f16 v[240:243], v[124:127], v[216:219], v[240:243]
    v_mfma_f32_16x16x32_f16 v[240:243], v[128:131], v[220:223], v[240:243]
    v_mfma_f32_16x16x32_f16 v[240:243], v[192:195], v[52:55], v[240:243]
    v_mfma_f32_16x16x32_f16 v[240:243], v[160:163], v[224:227], v[240:243]
    v_mfma_f32_16x16x32_f16 v[240:243], v[156:159], v[228:231], v[240:243]
    v_mfma_f32_16x16x32_f16 v[240:243], v[152:155], v[232:235], v[240:243]
    s_waitcnt lgkmcnt(3)
    v_mfma_f32_16x16x32_f16 v[240:243], v[148:151], v[236:239], v[240:243]
    s_nop 7
    ds_write_b128 v249, v[240:243] offset:5120
    s_setprio 0
    s_and_b64 exec, s[54:55], -1
    s_cbranch_execz SCF13
    s_and_b32 s56, s40, 0x7fffff
    s_mov_b32 s47, 0
    s_waitcnt vmcnt(0)
SCP14:
    v_xor_b32 v244, s56, v244
    v_xor_b32 v245, s56, v245
    v_xor_b32 v246, s56, v246
    v_xor_b32 v247, s56, v247
    v_or3_b32 v15, v244, v245, v246
    v_or_b32 v15, v15, v247
    v_and_b32 v15, 0x7fffff, v15
    v_cmp_ne_u32 vcc, 0, v15
    s_cbranch_vccz SCD15
    s_add_u32 s47, s47, 1
    s_cmp_ge_u32 s47, 65536
    s_cbranch_scc1 SCD15
    s_sleep 8
    buffer_load_dwordx4 v[244:247], v27, s[32:35], s53 offen sc1
    s_waitcnt vmcnt(0)
    s_branch SCP14
SCD15:
    ds_write_b128 v14, v[244:247] offset:46080
SCF13:
    s_mov_b64 exec, -1
    s_waitcnt lgkmcnt(0)
    s_barrier
    s_bitcmp1_b32 s3, 1
    s_cselect_b32 s46, 1, 0
    s_lshl_b32 s50, s46, 9
    v_add_u32 v15, s50, v252
    s_mul_i32 s46, s46, 294912
    s_add_u32 s46, s46, s63
    ds_read_b64_tr_b16 v[244:245], v15 offset:0
    ds_read_b64_tr_b16 v[246:247], v15 offset:256
    s_waitcnt lgkmcnt(0)
    v_and_or_b32 v244, v244, v9, v10
    v_and_or_b32 v245, v245, v9, v10
    v_and_or_b32 v246, v246, v9, v10
    v_and_or_b32 v247, v247, v9, v10
    buffer_store_dwordx4 v[244:247], v253, s[32:35], s46 offen sc1
    s_cmp_ge_u32 s49, 128
    s_cbranch_scc1 H_NOR
    global_load_dwordx4 v[208:211], v12, s[16:17]
    global_load_dwordx4 v[212:215], v12, s[16:17] offset:512
    global_load_dword v216, v13, s[16:17] offset:1024
    global_load_dwordx4 v[218:221], v12, s[20:21]
    global_load_dwordx4 v[222:225], v12, s[20:21] offset:512
    global_load_dword v226, v13, s[20:21] offset:1024
H_NOR:
    s_add_u32 s46, s63, 589824
    s_bitcmp1_b32 s3, 1
    s_cbranch_scc1 YS16
    ds_read_b64_tr_b16 v[244:245], v252 offset:1024
    ds_read_b64_tr_b16 v[246:247], v252 offset:1280
    s_waitcnt lgkmcnt(0)
    v_and_or_b32 v244, v244, v9, v10
    v_and_or_b32 v245, v245, v9, v10
    v_and_or_b32 v246, v246, v9, v10
    v_and_or_b32 v247, v247, v9, v10
    buffer_store_dwordx4 v[244:247], v253, s[32:35], s46 offen sc1
YS16:
    s_waitcnt lgkmcnt(0)
    s_barrier
    s_bitcmp1_b32 s3, 1
    s_cselect_b32 s46, 3, 4
    s_lshl_b32 s50, s46, 9
    v_add_u32 v15, s50, v252
    s_mul_i32 s46, s46, 294912
    s_add_u32 s46, s46, s63
    ds_read_b64_tr_b16 v[244:245], v15 offset:0
    ds_read_b64_tr_b16 v[246:247], v15 offset:256
    s_waitcnt lgkmcnt(0)
    v_and_or_b32 v244, v244, v9, v10
    v_and_or_b32 v245, v245, v9, v10
    v_and_or_b32 v246, v246, v9, v10
    v_and_or_b32 v247, v247, v9, v10
    buffer_store_dwordx4 v[244:247], v253, s[32:35], s46 offen sc1
    s_add_u32 s46, s63, 1474560
    s_bitcmp1_b32 s3, 1
    s_waitcnt lgkmcnt(0)
    s_barrier
    s_cbranch_scc0 YS17
    ds_read_b64_tr_b16 v[244:245], v252 offset:2560
    ds_read_b64_tr_b16 v[246:247], v252 offset:2816
    s_waitcnt lgkmcnt(0)
    v_and_or_b32 v244, v244, v9, v10
    v_and_or_b32 v245, v245, v9, v10
    v_and_or_b32 v246, v246, v9, v10
    v_and_or_b32 v247, v247, v9, v10
    buffer_store_dwordx4 v[244:247], v253, s[32:35], s46 offen sc1
YS17:
    s_add_u32 s46, s63, 1769472
    s_bitcmp1_b32 s3, 1
    s_waitcnt lgkmcnt(0)
    s_barrier
    s_cbranch_scc1 YS18
    ds_read_b64_tr_b16 v[244:245], v252 offset:3072
    ds_read_b64_tr_b16 v[246:247], v252 offset:3328
    s_waitcnt lgkmcnt(0)
    v_and_or_b32 v244, v244, v9, v10
    v_and_or_b32 v245, v245, v9, v10
    v_and_or_b32 v246, v246, v9, v10
    v_and_or_b32 v247, v247, v9, v10
    buffer_store_dwordx4 v[244:247], v253, s[32:35], s46 offen sc1
YS18:
    s_add_u32 s46, s63, 2064384
    s_bitcmp1_b32 s3, 1
    s_waitcnt lgkmcnt(0)
    s_barrier
    s_cbranch_scc0 YS19
    ds_read_b64_tr_b16 v[244:245], v252 offset:3584
    ds_read_b64_tr_b16 v[246:247], v252 offset:3840
    s_waitcnt lgkmcnt(0)
    v_and_or_b32 v244, v244, v9, v10
    v_and_or_b32 v245, v245, v9, v10
    v_and_or_b32 v246, v246, v9, v10
    v_and_or_b32 v247, v247, v9, v10
    buffer_store_dwordx4 v[244:247], v253, s[32:35], s46 offen sc1
YS19:
RPREP:
    s_cmp_ge_u32 s49, 128
    s_cbranch_scc1 ZROLE
    ds_read_b128 v[72:75], v25
    ds_read_b128 v[76:79], v25 offset:512
    ds_read_b32 v80, v26 offset:1024
    v_lshlrev_b32 v38, 1, v12
    v_lshlrev_b32 v39, 1, v13
    s_mul_i32 s60, s49, 18432
    s_add_u32 s60, s60, 4194304
    s_add_u32 s61, s60, 8192
    s_add_u32 s62, s60, 16384
    v_mov_b32 v204, 0
    s_waitcnt vmcnt(1)
    s_cmp_ge_u32 s49, 80
    s_cbranch_scc1 RP_0
    buffer_load_dwordx4 v[140:143], v3, s[32:35], s60 offen sc1
    buffer_load_dwordx4 v[144:147], v3, s[32:35], s61 offen sc1
    s_cmp_ge_u32 s3, 2
    s_cbranch_scc1 YL20
    buffer_load_dwordx4 v[148:151], v3, s[32:35], s62 offen sc1
YL20:
RP_0:
    v_lshlrev_b32 v84, 16, v208
    v_and_b32 v85, 0xffff0000, v208
    v_lshlrev_b32 v120, 16, v218
    v_and_b32 v121, 0xffff0000, v218
    v_dot2c_f32_bf16 v204, v218, v8
    v_lshlrev_b32 v86, 16, v209
    v_and_b32 v87, 0xffff0000, v209
    v_lshlrev_b32 v122, 16, v219
    v_and_b32 v123, 0xffff0000, v219
    v_dot2c_f32_bf16 v204, v219, v8
    v_lshlrev_b32 v88, 16, v210
    v_and_b32 v89, 0xffff0000, v210
    v_lshlrev_b32 v124, 16, v220
    v_and_b32 v125, 0xffff0000, v220
    v_dot2c_f32_bf16 v204, v220, v8
    v_lshlrev_b32 v90, 16, v211
    v_and_b32 v91, 0xffff0000, v211
    v_lshlrev_b32 v126, 16, v221
    v_and_b32 v127, 0xffff0000, v221
    v_dot2c_f32_bf16 v204, v221, v8
    v_lshlrev_b32 v92, 16, v212
    v_and_b32 v93, 0xffff0000, v212
    v_lshlrev_b32 v128, 16, v222
    v_and_b32 v129, 0xffff0000, v222
    v_dot2c_f32_bf16 v204, v222, v8
    v_lshlrev_b32 v94, 16, v213
    v_and_b32 v95, 0xffff0000, v213
    v_lshlrev_b32 v130, 16, v223
    v_and_b32 v131, 0xffff0000, v223
    v_dot2c_f32_bf16 v204, v223, v8
    v_lshlrev_b32 v96, 16, v214
    v_and_b32 v97, 0xffff0000, v214
    v_lshlrev_b32 v132, 16, v224
    v_and_b32 v133, 0xffff0000, v224
    v_dot2c_f32_bf16 v204, v224, v8
    v_lshlrev_b32 v98, 16, v215
    v_and_b32 v99, 0xffff0000, v215
    v_lshlrev_b32 v134, 16, v225
    v_and_b32 v135, 0xffff0000, v225
    v_dot2c_f32_bf16 v204, v225, v8
    v_lshlrev_b32 v100, 16, v216
    v_and_b32 v101, 0xffff0000, v216
    v_lshlrev_b32 v136, 16, v226
    v_and_b32 v137, 0xffff0000, v226
    v_dot2c_f32_bf16 v204, v226, v8
    s_waitcnt lgkmcnt(0)
    v_and_b32 v72, v9, v72
    v_and_b32 v73, v9, v73
    v_and_b32 v74, v9, v74
    v_and_b32 v75, v9, v75
    v_and_b32 v76, v9, v76
    v_and_b32 v77, v9, v77
    v_and_b32 v78, v9, v78
    v_and_b32 v79, v9, v79
    v_and_b32 v80, v9, v80
    v_fma_mix_f32 v84, v72, v84, 0 op_sel:[0,0,0] op_sel_hi:[1,0,0]
    v_fma_mix_f32 v85, v72, v85, 0 op_sel:[1,0,0] op_sel_hi:[1,0,0]
    v_fma_mix_f32 v86, v73, v86, 0 op_sel:[0,0,0] op_sel_hi:[1,0,0]
    v_add_f32_dpp v204, v204, v204 row_ror:8 row_mask:0xf bank_mask:0xf
    v_fma_mix_f32 v87, v73, v87, 0 op_sel:[1,0,0] op_sel_hi:[1,0,0]
    v_fma_mix_f32 v88, v74, v88, 0 op_sel:[0,0,0] op_sel_hi:[1,0,0]
    v_fma_mix_f32 v89, v74, v89, 0 op_sel:[1,0,0] op_sel_hi:[1,0,0]
    v_fma_mix_f32 v90, v75, v90, 0 op_sel:[0,0,0] op_sel_hi:[1,0,0]
    v_fma_mix_f32 v91, v75, v91, 0 op_sel:[1,0,0] op_sel_hi:[1,0,0]
    v_add_f32_dpp v204, v204, v204 row_ror:4 row_mask:0xf bank_mask:0xf
    v_fma_mix_f32 v92, v76, v92, 0 op_sel:[0,0,0] op_sel_hi:[1,0,0]
    v_fma_mix_f32 v93, v76, v93, 0 op_sel:[1,0,0] op_sel_hi:[1,0,0]
    v_fma_mix_f32 v94, v77, v94, 0 op_sel:[0,0,0] op_sel_hi:[1,0,0]
    v_fma_mix_f32 v95, v77, v95, 0 op_sel:[1,0,0] op_sel_hi:[1,0,0]
    v_fma_mix_f32 v96, v78, v96, 0 op_sel:[0,0,0] op_sel_hi:[1,0,0]
    v_add_f32_dpp v204, v204, v204 row_ror:2 row_mask:0xf bank_mask:0xf
    v_fma_mix_f32 v97, v78, v97, 0 op_sel:[1,0,0] op_sel_hi:[1,0,0]
    v_fma_mix_f32 v98, v79, v98, 0 op_sel:[0,0,0] op_sel_hi:[1,0,0]
    v_fma_mix_f32 v99, v79, v99, 0 op_sel:[1,0,0] op_sel_hi:[1,0,0]
    v_fma_mix_f32 v100, v80, v100, 0 op_sel:[0,0,0] op_sel_hi:[1,0,0]
    v_fma_mix_f32 v101, v80, v101, 0 op_sel:[1,0,0] op_sel_hi:[1,0,0]
    v_add_f32_dpp v204, v204, v204 row_ror:1 row_mask:0xf bank_mask:0xf
    v_cvt_pk_bf16_f32 v84, 0, v84
    v_cvt_pk_bf16_f32 v85, 0, v85
    v_cvt_pk_bf16_f32 v86, 0, v86
    v_cvt_pk_bf16_f32 v87, 0, v87
    v_cvt_pk_bf16_f32 v88, 0, v88
    v_mov_b32 v37, v204
    v_cvt_pk_bf16_f32 v89, 0, v89
    v_cvt_pk_bf16_f32 v90, 0, v90
    v_cvt_pk_bf16_f32 v91, 0, v91
    v_cvt_pk_bf16_f32 v92, 0, v92
    v_cvt_pk_bf16_f32 v93, 0, v93
    v_permlane16_swap_b32 v204, v37
    v_cvt_pk_bf16_f32 v94, 0, v94
    v_cvt_pk_bf16_f32 v95, 0, v95
    v_cvt_pk_bf16_f32 v96, 0, v96
    v_cvt_pk_bf16_f32 v97, 0, v97
    v_cvt_pk_bf16_f32 v98, 0, v98
    v_add_f32 v204, v204, v37
    v_cvt_pk_bf16_f32 v99, 0, v99
    v_cvt_pk_bf16_f32 v100, 0, v100
    v_cvt_pk_bf16_f32 v101, 0, v101
    v_dot2_f32_bf16 v102, v16, v6, v84
    v_dot2_f32_bf16 v103, v16, v7, v85
    v_dot2_f32_bf16 v104, v17, v6, v86
    v_dot2_f32_bf16 v105, v17, v7, v87
    v_dot2_f32_bf16 v106, v18, v6, v88
    v_dot2_f32_bf16 v107, v18, v7, v89
    v_dot2_f32_bf16 v108, v19, v6, v90
    v_dot2_f32_bf16 v109, v19, v7, v91
    v_dot2_f32_bf16 v110, v20, v6, v92
    v_dot2_f32_bf16 v111, v20, v7, v93
    v_dot2_f32_bf16 v112, v21, v6, v94
    v_dot2_f32_bf16 v113, v21, v7, v95
    v_dot2_f32_bf16 v114, v22, v6, v96
    v_dot2_f32_bf16 v115, v22, v7, v97
    v_dot2_f32_bf16 v116, v23, v6, v98
    v_dot2_f32_bf16 v117, v23, v7, v99
    v_dot2_f32_bf16 v118, v24, v6, v100
    v_dot2_f32_bf16 v119, v24, v7, v101
    s_cmp_lt_u32 s2, 144
    s_cbranch_scc1 RP_1
    s_cmp_ge_u32 s3, 4
    s_cbranch_scc1 RP_S
    s_movk_i32 s53, 144
    s_lshl_b32 s46, s51, 6
    v_add_u32 v14, s46, v1
    v_cmp_gt_u32 s[54:55], s53, v14
    v_lshlrev_b32 v27, 7, v14
    v_lshlrev_b32 v14, 4, v14
    s_mov_b32 s53, 32768
    s_and_b64 exec, s[54:55], -1
    s_cbranch_execz SCS21
    buffer_load_dwordx4 v[244:247], v27, s[32:35], s53 offen sc1
SCS21:
    s_mov_b64 exec, -1
    s_and_b64 exec, s[54:55], -1
    s_cbranch_execz SCF22
    s_and_b32 s56, s40, 0x7fffff
    s_mov_b32 s47, 0
    s_waitcnt vmcnt(0)
SCP23:
    v_xor_b32 v244, s56, v244
    v_xor_b32 v245, s56, v245
    v_xor_b32 v246, s56, v246
    v_xor_b32 v247, s56, v247
    v_or3_b32 v15, v244, v245, v246
    v_or_b32 v15, v15, v247
    v_and_b32 v15, 0x7fffff, v15
    v_cmp_ne_u32 vcc, 0, v15
    s_cbranch_vccz SCD24
    s_add_u32 s47, s47, 1
    s_cmp_ge_u32 s47, 65536
    s_cbranch_scc1 SCD24
    s_sleep 8
    buffer_load_dwordx4 v[244:247], v27, s[32:35], s53 offen sc1
    s_waitcnt vmcnt(0)
    s_branch SCP23
SCD24:
    ds_write_b128 v14, v[244:247] offset:46080
SCF22:
    s_mov_b64 exec, -1
RP_S:
    s_waitcnt lgkmcnt(0)
    s_barrier
RP_1:
    s_cmp_lt_u32 s49, 80
    s_cbranch_scc1 RP_2
    buffer_load_dwordx4 v[140:143], v3, s[32:35], s60 offen sc1
    buffer_load_dwordx4 v[144:147], v3, s[32:35], s61 offen sc1
    s_cmp_ge_u32 s3, 2
    s_cbranch_scc1 YL25
    buffer_load_dwordx4 v[148:151], v3, s[32:35], s62 offen sc1
YL25:
RP_2:
    ds_read_b128 v[52:55], v38 offset:46080
    ds_read_b128 v[56:59], v38 offset:46096
    ds_read_b128 v[60:63], v38 offset:47104
    ds_read_b128 v[64:67], v38 offset:47120
    ds_read_b64 v[68:69], v39 offset:48128
    v_and_b32 v36, 7, v0
    v_mul_u32_u24 v36, 2320, v36
    v_lshrrev_b32 v37, 3, v0
    v_lshl_add_u32 v36, v37, 4, v36
    v_lshrrev_b32 v37, 5, v1
    s_mul_i32 s46, s3, 2320
    s_add_u32 s46, s46, 49152
    v_lshl_add_u32 v37, v37, 3, s46
    v_lshl_add_u32 v38, v12, 1, v37
    v_bfe_u32 v39, v1, 1, 4
    v_lshl_add_u32 v39, v39, 4, v37
    v_and_b32 v37, 1, v1
    v_lshl_add_u32 v39, v37, 2, v39
    v_lshrrev_b32 v35, 5, v1
    v_lshlrev_b32 v35, 5, v35
    s_lshl_b32 s46, s3, 2
    s_add_u32 s46, s46, 163584
    v_add_u32 v35, s46, v35
    v_and_b32 v40, 15, v1
    v_lshlrev_b32 v34, 2, v40
    v_add_u32 v34, 163584, v34
    v_add_u32 v41, 163584, v2
    s_and_b32 s63, s40, 0xffff
    s_or_b32 s53, s63, 0x80000000
    s_lshl_b32 s54, s49, 7
    s_add_u32 s54, s54, 16384
    s_mov_b32 s58, 1
    s_mov_b32 s59, 1
    s_cmp_ge_u32 s3, 2
    s_cbranch_scc1 RP_3
    s_mov_b32 s47, 0
PL26:
    s_waitcnt vmcnt(0)
    v_xor_b32 v140, v10, v140
    v_xor_b32 v141, v10, v141
    v_xor_b32 v142, v10, v142
    v_xor_b32 v143, v10, v143
    v_xor_b32 v144, v10, v144
    v_xor_b32 v145, v10, v145
    v_xor_b32 v146, v10, v146
    v_xor_b32 v147, v10, v147
    v_xor_b32 v148, v10, v148
    v_xor_b32 v149, v10, v149
    v_xor_b32 v150, v10, v150
    v_xor_b32 v151, v10, v151
    v_or3_b32 v37, v140, v141, v142
    v_or3_b32 v37, v37, v143, v144
    v_or3_b32 v37, v37, v145, v146
    v_or3_b32 v37, v37, v147, v148
    v_or3_b32 v37, v37, v149, v150
    v_or_b32 v37, v37, v151
    v_and_b32 v37, 0x70007, v37
    v_cmp_ne_u32 vcc, 0, v37
    s_cbranch_vccz PD27
    s_add_u32 s47, s47, 1
    s_cmp_ge_u32 s47, 65536
    s_cbranch_scc1 PD27
    s_sleep 1
    buffer_load_dwordx4 v[140:143], v3, s[32:35], s60 offen sc1
    buffer_load_dwordx4 v[144:147], v3, s[32:35], s61 offen sc1
    buffer_load_dwordx4 v[148:151], v3, s[32:35], s62 offen sc1
    s_branch PL26
PD27:
    ds_write_b128 v36, v[148:151] offset:51200
    s_branch RP_4
RP_3:
    s_mov_b32 s47, 0
PL28:
    s_waitcnt vmcnt(0)
    v_xor_b32 v140, v10, v140
    v_xor_b32 v141, v10, v141
    v_xor_b32 v142, v10, v142
    v_xor_b32 v143, v10, v143
    v_xor_b32 v144, v10, v144
    v_xor_b32 v145, v10, v145
    v_xor_b32 v146, v10, v146
    v_xor_b32 v147, v10, v147
    v_or3_b32 v37, v140, v141, v142
    v_or3_b32 v37, v37, v143, v144
    v_or3_b32 v37, v37, v145, v146
    v_or_b32 v37, v37, v147
    v_and_b32 v37, 0x70007, v37
    v_cmp_ne_u32 vcc, 0, v37
    s_cbranch_vccz PD29
    s_add_u32 s47, s47, 1
    s_cmp_ge_u32 s47, 65536
    s_cbranch_scc1 PD29
    s_sleep 1
    buffer_load_dwordx4 v[140:143], v3, s[32:35], s60 offen sc1
    buffer_load_dwordx4 v[144:147], v3, s[32:35], s61 offen sc1
    s_branch PL28
PD29:
RP_4:
    ds_write_b128 v36, v[140:143] offset:49152
    ds_write_b128 v36, v[144:147] offset:50176
    s_waitcnt lgkmcnt(0)
    s_barrier
    ds_read2_b64 v[152:155], v38 offset0:0 offset1:2
    ds_read2_b64 v[156:159], v38 offset0:128 offset1:130
    ds_read_b32 v160, v39 offset:2048
    s_waitcnt lgkmcnt(2)
    v_fma_mix_f32 v162, v152, v52, v102 op_sel:[0,0,0] op_sel_hi:[1,0,0]
    v_fma_mix_f32 v163, v152, v53, v103 op_sel:[1,0,0] op_sel_hi:[1,0,0]
    v_fma_mix_f32 v164, v153, v54, v104 op_sel:[0,0,0] op_sel_hi:[1,0,0]
    v_fma_mix_f32 v165, v153, v55, v105 op_sel:[1,0,0] op_sel_hi:[1,0,0]
    v_pk_mul_f32 v[30:31], v[162:163], v[162:163]
    v_pk_mul_f32 v[32:33], v[162:163], v[120:121]
    v_fma_mix_f32 v166, v154, v56, v106 op_sel:[0,0,0] op_sel_hi:[1,0,0]
    v_fma_mix_f32 v167, v154, v57, v107 op_sel:[1,0,0] op_sel_hi:[1,0,0]
    v_pk_add_f32 v[28:29], v[162:163], v[164:165]
    v_pk_fma_f32 v[30:31], v[164:165], v[164:165], v[30:31]
    v_pk_fma_f32 v[32:33], v[164:165], v[122:123], v[32:33]
    v_fma_mix_f32 v168, v155, v58, v108 op_sel:[0,0,0] op_sel_hi:[1,0,0]
    v_fma_mix_f32 v169, v155, v59, v109 op_sel:[1,0,0] op_sel_hi:[1,0,0]
    v_pk_add_f32 v[28:29], v[28:29], v[166:167]
    v_pk_fma_f32 v[30:31], v[166:167], v[166:167], v[30:31]
    v_pk_fma_f32 v[32:33], v[166:167], v[124:125], v[32:33]
    s_waitcnt lgkmcnt(1)
    v_fma_mix_f32 v170, v156, v60, v110 op_sel:[0,0,0] op_sel_hi:[1,0,0]
    v_fma_mix_f32 v171, v156, v61, v111 op_sel:[1,0,0] op_sel_hi:[1,0,0]
    v_pk_add_f32 v[28:29], v[28:29], v[168:169]
    v_pk_fma_f32 v[30:31], v[168:169], v[168:169], v[30:31]
    v_pk_fma_f32 v[32:33], v[168:169], v[126:127], v[32:33]
    v_fma_mix_f32 v172, v157, v62, v112 op_sel:[0,0,0] op_sel_hi:[1,0,0]
    v_fma_mix_f32 v173, v157, v63, v113 op_sel:[1,0,0] op_sel_hi:[1,0,0]
    v_pk_add_f32 v[28:29], v[28:29], v[170:171]
    v_pk_fma_f32 v[30:31], v[170:171], v[170:171], v[30:31]
    v_pk_fma_f32 v[32:33], v[170:171], v[128:129], v[32:33]
    v_fma_mix_f32 v174, v158, v64, v114 op_sel:[0,0,0] op_sel_hi:[1,0,0]
    v_fma_mix_f32 v175, v158, v65, v115 op_sel:[1,0,0] op_sel_hi:[1,0,0]
    v_pk_add_f32 v[28:29], v[28:29], v[172:173]
    v_pk_fma_f32 v[30:31], v[172:173], v[172:173], v[30:31]
    v_pk_fma_f32 v[32:33], v[172:173], v[130:131], v[32:33]
    v_fma_mix_f32 v176, v159, v66, v116 op_sel:[0,0,0] op_sel_hi:[1,0,0]
    v_fma_mix_f32 v177, v159, v67, v117 op_sel:[1,0,0] op_sel_hi:[1,0,0]
    v_pk_add_f32 v[28:29], v[28:29], v[174:175]
    v_pk_fma_f32 v[30:31], v[174:175], v[174:175], v[30:31]
    v_pk_fma_f32 v[32:33], v[174:175], v[132:133], v[32:33]
    s_waitcnt lgkmcnt(0)
    v_fma_mix_f32 v178, v160, v68, v118 op_sel:[0,0,0] op_sel_hi:[1,0,0]
    v_fma_mix_f32 v179, v160, v69, v119 op_sel:[1,0,0] op_sel_hi:[1,0,0]
    v_pk_add_f32 v[28:29], v[28:29], v[176:177]
    v_pk_fma_f32 v[30:31], v[176:177], v[176:177], v[30:31]
    v_pk_fma_f32 v[32:33], v[176:177], v[134:135], v[32:33]
    v_pk_add_f32 v[28:29], v[28:29], v[178:179]
    v_pk_fma_f32 v[30:31], v[178:179], v[178:179], v[30:31]
    v_pk_fma_f32 v[32:33], v[178:179], v[136:137], v[32:33]
    v_add_f32 v28, v28, v29
    v_add_f32 v30, v30, v31
    v_add_f32 v32, v32, v33
    s_nop 0
    v_permlane16_swap_b32 v28, v30
    v_add_f32 v28, v28, v30
    v_add_f32_dpp v32, v32, v32 row_ror:8 row_mask:0xf bank_mask:0xf
    s_nop 0
    v_add_f32_dpp v28, v28, v28 row_ror:8 row_mask:0xf bank_mask:0xf
    v_add_f32_dpp v32, v32, v32 row_ror:4 row_mask:0xf bank_mask:0xf
    s_nop 0
    v_add_f32_dpp v28, v28, v28 row_ror:4 row_mask:0xf bank_mask:0xf
    v_add_f32_dpp v32, v32, v32 row_ror:2 row_mask:0xf bank_mask:0xf
    s_nop 0
    v_add_f32_dpp v28, v28, v28 row_ror:2 row_mask:0xf bank_mask:0xf
    v_add_f32_dpp v32, v32, v32 row_ror:1 row_mask:0xf bank_mask:0xf
    s_nop 0
    v_add_f32_dpp v28, v28, v28 row_ror:1 row_mask:0xf bank_mask:0xf
    v_mov_b32 v33, v32
    v_mov_b32 v30, v28
    s_nop 1
    v_permlane16_swap_b32 v28, v30
    v_permlane16_swap_b32 v32, v33
    v_add_f32 v32, v32, v33
    v_mul_f32 v28, 0x3ae38e39, v28
    v_mul_f32 v30, 0x3ae38e39, v30
    v_fma_f32 v30, -v28, v28, v30
    v_cvt_pk_bf16_f32 v200, 0, v28
    v_max_f32 v30, 0, v30
    v_cvt_pk_bf16_f32 v30, 0, v30
    v_add_f32 v30, 0x3727c5ac, v30
    v_cvt_pk_bf16_f32 v30, 0, v30
    v_sqrt_f32 v30, v30
    s_nop 0
    v_cvt_pk_bf16_f32 v30, 0, v30
    v_rcp_f32 v202, v30
    v_fma_f32 v32, -v200, v204, v32
    v_mul_f32 v32, v32, v202
    v_cvt_pk_bf16_f32 v236, 0, v32
    v_ashrrev_i32 v28, 31, v236
    v_and_b32 v28, 0x7fff0000, v28
    v_xor_b32 v28, v28, v236
    v_xor_b32 v28, s53, v28
    s_mov_b64 exec, s[58:59]
    ds_write_b32 v35, v28
    s_mov_b64 exec, -1
    s_waitcnt lgkmcnt(0)
    s_barrier
    s_cmp_lg_u32 s3, 0
    s_cbranch_scc1 L2_NOKEY
    s_mov_b64 exec, 0xf
    ds_read_b128 v[28:31], v41
    s_waitcnt lgkmcnt(0)
    buffer_store_dwordx4 v[28:31], v2, s[32:35], s54 offen sc1
    s_mov_b64 exec, -1
L2_NOKEY:
    ds_read_b32 v205, v34
    v_fma_mix_f32 v162, v152, v52, v84 op_sel:[0,0,0] op_sel_hi:[1,0,0]
    v_fma_mix_f32 v163, v152, v53, v85 op_sel:[1,0,0] op_sel_hi:[1,0,0]
    v_fma_mix_f32 v164, v153, v54, v86 op_sel:[0,0,0] op_sel_hi:[1,0,0]
    v_fma_mix_f32 v165, v153, v55, v87 op_sel:[1,0,0] op_sel_hi:[1,0,0]
    v_fma_mix_f32 v166, v154, v56, v88 op_sel:[0,0,0] op_sel_hi:[1,0,0]
    v_fma_mix_f32 v167, v154, v57, v89 op_sel:[1,0,0] op_sel_hi:[1,0,0]
    v_fma_mix_f32 v168, v155, v58, v90 op_sel:[0,0,0] op_sel_hi:[1,0,0]
    v_fma_mix_f32 v169, v155, v59, v91 op_sel:[1,0,0] op_sel_hi:[1,0,0]
    v_fma_mix_f32 v170, v156, v60, v92 op_sel:[0,0,0] op_sel_hi:[1,0,0]
    v_fma_mix_f32 v171, v156, v61, v93 op_sel:[1,0,0] op_sel_hi:[1,0,0]
    v_fma_mix_f32 v172, v157, v62, v94 op_sel:[0,0,0] op_sel_hi:[1,0,0]
    v_fma_mix_f32 v173, v157, v63, v95 op_sel:[1,0,0] op_sel_hi:[1,0,0]
    v_fma_mix_f32 v174, v158, v64, v96 op_sel:[0,0,0] op_sel_hi:[1,0,0]
    v_fma_mix_f32 v175, v158, v65, v97 op_sel:[1,0,0] op_sel_hi:[1,0,0]
    v_fma_mix_f32 v176, v159, v66, v98 op_sel:[0,0,0] op_sel_hi:[1,0,0]
    v_fma_mix_f32 v177, v159, v67, v99 op_sel:[1,0,0] op_sel_hi:[1,0,0]
    v_fma_mix_f32 v178, v160, v68, v100 op_sel:[0,0,0] op_sel_hi:[1,0,0]
    v_fma_mix_f32 v179, v160, v69, v101 op_sel:[1,0,0] op_sel_hi:[1,0,0]
    v_cvt_pk_bf16_f32 v162, 0, v162
    v_cvt_pk_bf16_f32 v163, 0, v163
    v_cvt_pk_bf16_f32 v164, 0, v164
    v_cvt_pk_bf16_f32 v165, 0, v165
    v_cvt_pk_bf16_f32 v166, 0, v166
    v_cvt_pk_bf16_f32 v167, 0, v167
    v_cvt_pk_bf16_f32 v168, 0, v168
    v_cvt_pk_bf16_f32 v169, 0, v169
    v_cvt_pk_bf16_f32 v170, 0, v170
    v_cvt_pk_bf16_f32 v171, 0, v171
    v_cvt_pk_bf16_f32 v172, 0, v172
    v_cvt_pk_bf16_f32 v173, 0, v173
    v_cvt_pk_bf16_f32 v174, 0, v174
    v_cvt_pk_bf16_f32 v175, 0, v175
    v_cvt_pk_bf16_f32 v176, 0, v176
    v_cvt_pk_bf16_f32 v177, 0, v177
    v_cvt_pk_bf16_f32 v178, 0, v178
    v_cvt_pk_bf16_f32 v179, 0, v179
    v_dot2_f32_bf16 v162, v16, v6, v162
    v_dot2_f32_bf16 v163, v16, v7, v163
    v_dot2_f32_bf16 v164, v17, v6, v164
    v_dot2_f32_bf16 v165, v17, v7, v165
    v_dot2_f32_bf16 v166, v18, v6, v166
    v_dot2_f32_bf16 v167, v18, v7, v167
    v_dot2_f32_bf16 v168, v19, v6, v168
    v_dot2_f32_bf16 v169, v19, v7, v169
    v_dot2_f32_bf16 v170, v20, v6, v170
    v_dot2_f32_bf16 v171, v20, v7, v171
    v_dot2_f32_bf16 v172, v21, v6, v172
    v_dot2_f32_bf16 v173, v21, v7, v173
    v_dot2_f32_bf16 v174, v22, v6, v174
    v_dot2_f32_bf16 v175, v22, v7, v175
    v_dot2_f32_bf16 v176, v23, v6, v176
    v_dot2_f32_bf16 v177, v23, v7, v177
    v_dot2_f32_bf16 v178, v24, v6, v178
    v_dot2_f32_bf16 v179, v24, v7, v179
    s_lshl_b32 s46, s49, 4
    s_sub_u32 s46, 0xffff, s46
    v_sub_u32 v37, s46, v40
    s_waitcnt lgkmcnt(0)
    v_and_b32 v205, 0xffff0000, v205
    v_or_b32 v205, v205, v37
    v_cvt_pk_bf16_f32 v162, 0, v162
    v_mov_b32 v206, v205
    v_cvt_pk_bf16_f32 v163, 0, v163
    v_cvt_pk_bf16_f32 v164, 0, v164
    v_cvt_pk_bf16_f32 v165, 0, v165
    v_max_u32_dpp v206, v206, v206 row_ror:8 row_mask:0xf bank_mask:0xf
    v_cvt_pk_bf16_f32 v166, 0, v166
    v_cvt_pk_bf16_f32 v167, 0, v167
    v_cvt_pk_bf16_f32 v168, 0, v168
    v_max_u32_dpp v206, v206, v206 row_ror:4 row_mask:0xf bank_mask:0xf
    v_cvt_pk_bf16_f32 v169, 0, v169
    v_cvt_pk_bf16_f32 v170, 0, v170
    v_cvt_pk_bf16_f32 v171, 0, v171
    v_max_u32_dpp v206, v206, v206 row_ror:2 row_mask:0xf bank_mask:0xf
    v_cvt_pk_bf16_f32 v172, 0, v172
    v_cvt_pk_bf16_f32 v173, 0, v173
    v_cvt_pk_bf16_f32 v174, 0, v174
    v_max_u32_dpp v206, v206, v206 row_ror:1 row_mask:0xf bank_mask:0xf
    v_cvt_pk_bf16_f32 v175, 0, v175
    v_cvt_pk_bf16_f32 v176, 0, v176
    v_readfirstlane_b32 s56, v206
    v_cvt_pk_bf16_f32 v177, 0, v177
    v_cvt_pk_bf16_f32 v178, 0, v178
    v_cvt_pk_bf16_f32 v179, 0, v179
    v_cmp_ne_u32 vcc, v206, v205
    v_pk_add_f32 v[102:103], v[162:163], v[200:201] op_sel_hi:[1,0] neg_lo:[0,1] neg_hi:[0,1]
    v_pk_add_f32 v[104:105], v[164:165], v[200:201] op_sel_hi:[1,0] neg_lo:[0,1] neg_hi:[0,1]
    v_pk_add_f32 v[106:107], v[166:167], v[200:201] op_sel_hi:[1,0] neg_lo:[0,1] neg_hi:[0,1]
    v_cndmask_b32 v205, 0, v205, vcc
    v_pk_add_f32 v[108:109], v[168:169], v[200:201] op_sel_hi:[1,0] neg_lo:[0,1] neg_hi:[0,1]
    v_pk_add_f32 v[110:111], v[170:171], v[200:201] op_sel_hi:[1,0] neg_lo:[0,1] neg_hi:[0,1]
    v_pk_add_f32 v[112:113], v[172:173], v[200:201] op_sel_hi:[1,0] neg_lo:[0,1] neg_hi:[0,1]
    v_mov_b32 v206, v205
    v_pk_add_f32 v[114:115], v[174:175], v[200:201] op_sel_hi:[1,0] neg_lo:[0,1] neg_hi:[0,1]
    v_pk_add_f32 v[116:117], v[176:177], v[200:201] op_sel_hi:[1,0] neg_lo:[0,1] neg_hi:[0,1]
    v_pk_add_f32 v[118:119], v[178:179], v[200:201] op_sel_hi:[1,0] neg_lo:[0,1] neg_hi:[0,1]
    v_max_u32_dpp v206, v206, v206 row_ror:8 row_mask:0xf bank_mask:0xf
    v_cvt_pk_bf16_f32 v102, 0, v102
    v_cvt_pk_bf16_f32 v103, 0, v103
    v_cvt_pk_bf16_f32 v104, 0, v104
    v_max_u32_dpp v206, v206, v206 row_ror:4 row_mask:0xf bank_mask:0xf
    v_cvt_pk_bf16_f32 v105, 0, v105
    v_cvt_pk_bf16_f32 v106, 0, v106
    v_max_u32_dpp v206, v206, v206 row_ror:2 row_mask:0xf bank_mask:0xf
    v_cvt_pk_bf16_f32 v107, 0, v107
    v_cvt_pk_bf16_f32 v108, 0, v108
    v_cvt_pk_bf16_f32 v109, 0, v109
    v_max_u32_dpp v206, v206, v206 row_ror:1 row_mask:0xf bank_mask:0xf
    v_cvt_pk_bf16_f32 v110, 0, v110
    v_cvt_pk_bf16_f32 v111, 0, v111
    v_cvt_pk_bf16_f32 v112, 0, v112
    v_readfirstlane_b32 s57, v206
    v_cvt_pk_bf16_f32 v113, 0, v113
    v_cvt_pk_bf16_f32 v114, 0, v114
    v_cvt_pk_bf16_f32 v115, 0, v115
    v_cmp_ne_u32 vcc, v206, v205
    v_cvt_pk_bf16_f32 v116, 0, v116
    v_cvt_pk_bf16_f32 v117, 0, v117
    v_cvt_pk_bf16_f32 v118, 0, v118
    v_cndmask_b32 v205, 0, v205, vcc
    v_cvt_pk_bf16_f32 v119, 0, v119
    v_lshrrev_b32 v14, 2, v0
    v_and_b32 v15, 3, v0
    v_lshlrev_b32 v15, 4, v15
    v_lshl_add_u32 v14, v14, 7, v15
    s_mov_b32 s60, 16384
    buffer_load_dwordx4 v[228:231], v14, s[32:35], s60 offen sc1
    v_pk_mul_f32 v[102:103], v[102:103], v[202:203] op_sel_hi:[1,0]
    v_pk_mul_f32 v[104:105], v[104:105], v[202:203] op_sel_hi:[1,0]
    v_pk_mul_f32 v[106:107], v[106:107], v[202:203] op_sel_hi:[1,0]
    v_pk_mul_f32 v[108:109], v[108:109], v[202:203] op_sel_hi:[1,0]
    v_pk_mul_f32 v[110:111], v[110:111], v[202:203] op_sel_hi:[1,0]
    v_pk_mul_f32 v[112:113], v[112:113], v[202:203] op_sel_hi:[1,0]
    v_pk_mul_f32 v[114:115], v[114:115], v[202:203] op_sel_hi:[1,0]
    v_pk_mul_f32 v[116:117], v[116:117], v[202:203] op_sel_hi:[1,0]
    v_pk_mul_f32 v[118:119], v[118:119], v[202:203] op_sel_hi:[1,0]
    v_cvt_pk_bf16_f32 v180, v102, v103
    v_cvt_pk_bf16_f32 v181, v104, v105
    v_cvt_pk_bf16_f32 v182, v106, v107
    v_cvt_pk_bf16_f32 v184, v108, v109
    v_cvt_pk_bf16_f32 v185, v110, v111
    v_cvt_pk_bf16_f32 v186, v112, v113
    v_cvt_pk_bf16_f32 v188, v114, v115
    v_cvt_pk_bf16_f32 v189, v116, v117
    v_cvt_pk_bf16_f32 v190, v118, v119
    v_mov_b32 v183, s40
    v_mov_b32 v187, s40
    v_mov_b32 v191, s40
    v_lshlrev_b32 v15, 2, v0
    v_sub_u32 v232, 0xffff, v15
    v_subrev_u32 v233, 1, v232
    v_subrev_u32 v234, 2, v232
    v_subrev_u32 v235, 3, v232
    v_mov_b32 v36, s63
    v_mov_b32 v15, 163648
    s_mov_b64 s[58:59], -1
    s_mov_b32 s47, 0
PL30:
    s_waitcnt vmcnt(0)
    v_xor_b32 v228, v36, v228
    v_xor_b32 v229, v36, v229
    v_xor_b32 v230, v36, v230
    v_xor_b32 v231, v36, v231
    v_or3_b32 v37, v228, v229, v230
    v_or_b32 v37, v37, v231
    v_and_b32 v37, 0xffff, v37
    v_cmp_ne_u32 vcc, 0, v37
    s_cbranch_vccz PD31
    s_add_u32 s47, s47, 1
    s_cmp_ge_u32 s47, 65536
    s_cbranch_scc1 PD31
    s_sleep 1
    buffer_load_dwordx4 v[228:231], v14, s[32:35], s60 offen sc1
    s_branch PL30
PD31:
    v_or_b32 v228, v228, v232
    v_or_b32 v229, v229, v233
    v_or_b32 v230, v230, v234
    v_or_b32 v231, v231, v235
RK_LOOP:
    v_cmp_lt_u32 s[4:5], s56, v228
    v_cmp_lt_u32 s[6:7], s56, v229
    v_cmp_lt_u32 s[8:9], s56, v230
    v_cmp_lt_u32 s[10:11], s56, v231
    s_bcnt1_i32_b64 s4, s[4:5]
    s_bcnt1_i32_b64 s6, s[6:7]
    s_bcnt1_i32_b64 s8, s[8:9]
    s_bcnt1_i32_b64 s10, s[10:11]
    s_add_u32 s4, s4, s6
    s_add_u32 s8, s8, s10
    s_add_u32 s46, s4, s8
    v_cmp_lt_u32 s[12:13], s57, v228
    v_cmp_lt_u32 s[14:15], s57, v229
    v_cmp_lt_u32 s[16:17], s57, v230
    v_cmp_lt_u32 s[18:19], s57, v231
    s_bcnt1_i32_b64 s12, s[12:13]
    s_bcnt1_i32_b64 s14, s[14:15]
    s_bcnt1_i32_b64 s16, s[16:17]
    s_bcnt1_i32_b64 s18, s[18:19]
    s_add_u32 s12, s12, s14
    s_add_u32 s16, s16, s18
    s_add_u32 s48, s12, s16
    s_lshl_b32 s48, s48, 16
    s_add_u32 s46, s46, s48
    v_mov_b32 v37, s46
    s_mov_b64 exec, 1
    ds_add_u32 v15, v37
    s_mov_b64 exec, -1
    s_waitcnt lgkmcnt(0)
    s_barrier
    ds_read_b32 v37, v15
    v_add_u32 v15, 4, v15
    s_waitcnt lgkmcnt(0)
    v_readfirstlane_b32 s53, v37
    s_and_b32 s54, s53, 0xffff
    s_cmp_ge_u32 s54, 8
    s_cbranch_scc1 RK_DONE
    s_andn2_b32 s46, 0xffff, s56
    s_and_b32 s48, s46, 7
    s_cmp_lg_u32 s48, s3
    s_cbranch_scc1 RK_N32
    s_bitcmp1_b32 s46, 3
    s_cselect_b32 exec_lo, 0, -1
    s_cselect_b32 exec_hi, -1, 0
    s_andn2_b64 s[58:59], s[58:59], exec
    s_mul_i32 s48, s54, 1536
    s_add_u32 s48, s48, 65536
    buffer_store_dwordx4 v[180:183], v12, s[32:35], s48 offen offset:0 sc1
    buffer_store_dwordx4 v[184:187], v12, s[32:35], s48 offen offset:512 sc1
    buffer_store_dwordx4 v[188:191], v12, s[32:35], s48 offen offset:1024 sc1
    v_mov_b32 v28, s46
    v_mov_b32 v29, v236
    v_mov_b32 v30, s40
    v_mov_b32 v31, s40
    s_mul_i32 s48, s54, 3200
    s_add_u32 s48, s48, 131072
    v_or_b32_sdwa v52, v162, v180 dst_sel:DWORD dst_unused:UNUSED_PAD src0_sel:DWORD src1_sel:WORD_0
    v_or_b32_sdwa v53, v163, v180 dst_sel:DWORD dst_unused:UNUSED_PAD src0_sel:DWORD src1_sel:WORD_1
    v_or_b32_sdwa v54, v164, v181 dst_sel:DWORD dst_unused:UNUSED_PAD src0_sel:DWORD src1_sel:WORD_0
    v_mov_b32 v55, s40
    buffer_store_dwordx4 v[52:55], v12, s[32:35], s48 offen offset:0 sc1
    v_or_b32_sdwa v56, v165, v181 dst_sel:DWORD dst_unused:UNUSED_PAD src0_sel:DWORD src1_sel:WORD_1
    v_or_b32_sdwa v57, v166, v182 dst_sel:DWORD dst_unused:UNUSED_PAD src0_sel:DWORD src1_sel:WORD_0
    v_or_b32_sdwa v58, v167, v182 dst_sel:DWORD dst_unused:UNUSED_PAD src0_sel:DWORD src1_sel:WORD_1
    v_mov_b32 v59, s40
    buffer_store_dwordx4 v[56:59], v12, s[32:35], s48 offen offset:512 sc1
    v_or_b32_sdwa v60, v168, v184 dst_sel:DWORD dst_unused:UNUSED_PAD src0_sel:DWORD src1_sel:WORD_0
    v_or_b32_sdwa v61, v169, v184 dst_sel:DWORD dst_unused:UNUSED_PAD src0_sel:DWORD src1_sel:WORD_1
    v_or_b32_sdwa v62, v170, v185 dst_sel:DWORD dst_unused:UNUSED_PAD src0_sel:DWORD src1_sel:WORD_0
    v_mov_b32 v63, s40
    buffer_store_dwordx4 v[60:63], v12, s[32:35], s48 offen offset:1024 sc1
    v_or_b32_sdwa v64, v171, v185 dst_sel:DWORD dst_unused:UNUSED_PAD src0_sel:DWORD src1_sel:WORD_1
    v_or_b32_sdwa v65, v172, v186 dst_sel:DWORD dst_unused:UNUSED_PAD src0_sel:DWORD src1_sel:WORD_0
    v_or_b32_sdwa v66, v173, v186 dst_sel:DWORD dst_unused:UNUSED_PAD src0_sel:DWORD src1_sel:WORD_1
    v_mov_b32 v67, s40
    buffer_store_dwordx4 v[64:67], v12, s[32:35], s48 offen offset:1536 sc1
    v_or_b32_sdwa v68, v174, v188 dst_sel:DWORD dst_unused:UNUSED_PAD src0_sel:DWORD src1_sel:WORD_0
    v_or_b32_sdwa v69, v175, v188 dst_sel:DWORD dst_unused:UNUSED_PAD src0_sel:DWORD src1_sel:WORD_1
    v_or_b32_sdwa v70, v176, v189 dst_sel:DWORD dst_unused:UNUSED_PAD src0_sel:DWORD src1_sel:WORD_0
    v_mov_b32 v71, s40
    buffer_store_dwordx4 v[68:71], v12, s[32:35], s48 offen offset:2048 sc1
    v_or_b32_sdwa v72, v177, v189 dst_sel:DWORD dst_unused:UNUSED_PAD src0_sel:DWORD src1_sel:WORD_1
    v_or_b32_sdwa v73, v178, v190 dst_sel:DWORD dst_unused:UNUSED_PAD src0_sel:DWORD src1_sel:WORD_0
    v_or_b32_sdwa v74, v179, v190 dst_sel:DWORD dst_unused:UNUSED_PAD src0_sel:DWORD src1_sel:WORD_1
    v_mov_b32 v75, s40
    buffer_store_dwordx4 v[72:75], v12, s[32:35], s48 offen offset:2560 sc1
    s_and_b32 exec_lo, exec_lo, 1
    s_and_b32 exec_hi, exec_hi, 1
    buffer_store_dwordx4 v[28:31], v12, s[32:35], s48 offen offset:3072 sc1
    s_mov_b64 exec, -1
RK_N32:
    s_lshr_b32 s54, s53, 16
    s_cmp_ge_u32 s54, 8
    s_cbranch_scc1 RK_DONE
    s_andn2_b32 s46, 0xffff, s57
    s_and_b32 s48, s46, 7
    s_cmp_lg_u32 s48, s3
    s_cbranch_scc1 RK_N33
    s_bitcmp1_b32 s46, 3
    s_cselect_b32 exec_lo, 0, -1
    s_cselect_b32 exec_hi, -1, 0
    s_andn2_b64 s[58:59], s[58:59], exec
    s_mul_i32 s48, s54, 1536
    s_add_u32 s48, s48, 65536
    buffer_store_dwordx4 v[180:183], v12, s[32:35], s48 offen offset:0 sc1
    buffer_store_dwordx4 v[184:187], v12, s[32:35], s48 offen offset:512 sc1
    buffer_store_dwordx4 v[188:191], v12, s[32:35], s48 offen offset:1024 sc1
    v_mov_b32 v28, s46
    v_mov_b32 v29, v236
    v_mov_b32 v30, s40
    v_mov_b32 v31, s40
    s_mul_i32 s48, s54, 3200
    s_add_u32 s48, s48, 131072
    v_or_b32_sdwa v52, v162, v180 dst_sel:DWORD dst_unused:UNUSED_PAD src0_sel:DWORD src1_sel:WORD_0
    v_or_b32_sdwa v53, v163, v180 dst_sel:DWORD dst_unused:UNUSED_PAD src0_sel:DWORD src1_sel:WORD_1
    v_or_b32_sdwa v54, v164, v181 dst_sel:DWORD dst_unused:UNUSED_PAD src0_sel:DWORD src1_sel:WORD_0
    v_mov_b32 v55, s40
    buffer_store_dwordx4 v[52:55], v12, s[32:35], s48 offen offset:0 sc1
    v_or_b32_sdwa v56, v165, v181 dst_sel:DWORD dst_unused:UNUSED_PAD src0_sel:DWORD src1_sel:WORD_1
    v_or_b32_sdwa v57, v166, v182 dst_sel:DWORD dst_unused:UNUSED_PAD src0_sel:DWORD src1_sel:WORD_0
    v_or_b32_sdwa v58, v167, v182 dst_sel:DWORD dst_unused:UNUSED_PAD src0_sel:DWORD src1_sel:WORD_1
    v_mov_b32 v59, s40
    buffer_store_dwordx4 v[56:59], v12, s[32:35], s48 offen offset:512 sc1
    v_or_b32_sdwa v60, v168, v184 dst_sel:DWORD dst_unused:UNUSED_PAD src0_sel:DWORD src1_sel:WORD_0
    v_or_b32_sdwa v61, v169, v184 dst_sel:DWORD dst_unused:UNUSED_PAD src0_sel:DWORD src1_sel:WORD_1
    v_or_b32_sdwa v62, v170, v185 dst_sel:DWORD dst_unused:UNUSED_PAD src0_sel:DWORD src1_sel:WORD_0
    v_mov_b32 v63, s40
    buffer_store_dwordx4 v[60:63], v12, s[32:35], s48 offen offset:1024 sc1
    v_or_b32_sdwa v64, v171, v185 dst_sel:DWORD dst_unused:UNUSED_PAD src0_sel:DWORD src1_sel:WORD_1
    v_or_b32_sdwa v65, v172, v186 dst_sel:DWORD dst_unused:UNUSED_PAD src0_sel:DWORD src1_sel:WORD_0
    v_or_b32_sdwa v66, v173, v186 dst_sel:DWORD dst_unused:UNUSED_PAD src0_sel:DWORD src1_sel:WORD_1
    v_mov_b32 v67, s40
    buffer_store_dwordx4 v[64:67], v12, s[32:35], s48 offen offset:1536 sc1
    v_or_b32_sdwa v68, v174, v188 dst_sel:DWORD dst_unused:UNUSED_PAD src0_sel:DWORD src1_sel:WORD_0
    v_or_b32_sdwa v69, v175, v188 dst_sel:DWORD dst_unused:UNUSED_PAD src0_sel:DWORD src1_sel:WORD_1
    v_or_b32_sdwa v70, v176, v189 dst_sel:DWORD dst_unused:UNUSED_PAD src0_sel:DWORD src1_sel:WORD_0
    v_mov_b32 v71, s40
    buffer_store_dwordx4 v[68:71], v12, s[32:35], s48 offen offset:2048 sc1
    v_or_b32_sdwa v72, v177, v189 dst_sel:DWORD dst_unused:UNUSED_PAD src0_sel:DWORD src1_sel:WORD_1
    v_or_b32_sdwa v73, v178, v190 dst_sel:DWORD dst_unused:UNUSED_PAD src0_sel:DWORD src1_sel:WORD_0
    v_or_b32_sdwa v74, v179, v190 dst_sel:DWORD dst_unused:UNUSED_PAD src0_sel:DWORD src1_sel:WORD_1
    v_mov_b32 v75, s40
    buffer_store_dwordx4 v[72:75], v12, s[32:35], s48 offen offset:2560 sc1
    s_and_b32 exec_lo, exec_lo, 1
    s_and_b32 exec_hi, exec_hi, 1
    buffer_store_dwordx4 v[28:31], v12, s[32:35], s48 offen offset:3072 sc1
    s_mov_b64 exec, -1
RK_N33:
    v_mov_b32 v206, v205
    s_nop 1
    v_max_u32_dpp v206, v206, v206 row_ror:8 row_mask:0xf bank_mask:0xf
    s_nop 1
    v_max_u32_dpp v206, v206, v206 row_ror:4 row_mask:0xf bank_mask:0xf
    s_nop 1
    v_max_u32_dpp v206, v206, v206 row_ror:2 row_mask:0xf bank_mask:0xf
    s_nop 1
    v_max_u32_dpp v206, v206, v206 row_ror:1 row_mask:0xf bank_mask:0xf
    s_nop 0
    v_readfirstlane_b32 s56, v206
    v_cmp_ne_u32 vcc, v206, v205
    s_nop 1
    v_cndmask_b32 v205, 0, v205, vcc
    v_mov_b32 v206, v205
    s_nop 1
    v_max_u32_dpp v206, v206, v206 row_ror:8 row_mask:0xf bank_mask:0xf
    s_nop 1
    v_max_u32_dpp v206, v206, v206 row_ror:4 row_mask:0xf bank_mask:0xf
    s_nop 1
    v_max_u32_dpp v206, v206, v206 row_ror:2 row_mask:0xf bank_mask:0xf
    s_nop 1
    v_max_u32_dpp v206, v206, v206 row_ror:1 row_mask:0xf bank_mask:0xf
    s_nop 0
    v_readfirstlane_b32 s57, v206
    v_cmp_ne_u32 vcc, v206, v205
    s_nop 1
    v_cndmask_b32 v205, 0, v205, vcc
    s_branch RK_LOOP
RK_DONE:
    v_dot2_f32_bf16 v162, v180, v6, v162
    v_dot2_f32_bf16 v163, v180, v7, v163
    v_dot2_f32_bf16 v164, v181, v6, v164
    v_dot2_f32_bf16 v165, v181, v7, v165
    v_dot2_f32_bf16 v166, v182, v6, v166
    v_dot2_f32_bf16 v167, v182, v7, v167
    v_dot2_f32_bf16 v168, v184, v6, v168
    v_dot2_f32_bf16 v169, v184, v7, v169
    v_dot2_f32_bf16 v170, v185, v6, v170
    v_dot2_f32_bf16 v171, v185, v7, v171
    v_dot2_f32_bf16 v172, v186, v6, v172
    v_dot2_f32_bf16 v173, v186, v7, v173
    v_dot2_f32_bf16 v174, v188, v6, v174
    v_dot2_f32_bf16 v175, v188, v7, v175
    v_dot2_f32_bf16 v176, v189, v6, v176
    v_dot2_f32_bf16 v177, v189, v7, v177
    v_dot2_f32_bf16 v178, v190, v6, v178
    v_dot2_f32_bf16 v179, v190, v7, v179
    v_cvt_pk_bf16_f32 v16, v162, v163
    v_cvt_pk_bf16_f32 v17, v164, v165
    v_cvt_pk_bf16_f32 v18, v166, v167
    v_cvt_pk_bf16_f32 v19, v168, v169
    v_cvt_pk_bf16_f32 v20, v170, v171
    v_cvt_pk_bf16_f32 v21, v172, v173
    v_cvt_pk_bf16_f32 v22, v174, v175
    v_cvt_pk_bf16_f32 v23, v176, v177
    v_cvt_pk_bf16_f32 v24, v178, v179
    s_mov_b64 exec, s[58:59]
    s_cbranch_execz RK_NOOUT
    global_store_dwordx4 v4, v[16:19], s[28:29] sc1
    global_store_dwordx4 v4, v[20:23], s[28:29] offset:512 sc1
    global_store_dword v5, v24, s[28:29] offset:1024 sc1
RK_NOOUT:
    s_mov_b64 exec, -1
    s_branch DUMP
ZROLE:
    s_cmp_ge_u32 s3, 3
    s_cbranch_scc1 DUMP
    s_and_b32 s50, s2, 7
    s_mul_i32 s50, s50, 18
    s_sub_u32 s46, s2, 96
    s_lshr_b32 s46, s46, 3
    s_mul_i32 s46, s46, 3
    s_add_u32 s50, s50, s46
    s_add_u32 s50, s50, s3
    v_and_b32 v12, 7, v1
    v_mul_u32_u24 v12, 3200, v12
    v_bfe_u32 v13, v1, 4, 1
    v_lshrrev_b32 v14, 5, v1
    v_lshl_add_u32 v13, v13, 1, v14
    s_lshl_b32 s46, s50, 2
    v_add_u32 v13, s46, v13
    v_bfe_u32 v14, v13, 3, 5
    v_and_b32 v15, 7, v13
    v_lshrrev_b32 v36, 8, v13
    v_lshl_add_u32 v15, v36, 3, v15
    s_cmp_lt_u32 s50, 128
    s_cbranch_scc1 Z_A
    v_bfe_u32 v14, v13, 1, 5
    v_and_b32 v15, 1, v13
    v_add_u32 v15, 16, v15
Z_A:
    v_mul_u32_u24 v36, 43, v15
    v_lshrrev_b32 v36, 7, v36
    v_mul_u32_u24 v37, 3, v36
    v_sub_u32 v15, v15, v37
    v_lshl_add_u32 v14, v14, 4, v12
    v_lshl_add_u32 v14, v36, 9, v14
    v_cmp_eq_u32 s[52:53], 1, v15
    v_cmp_eq_u32 s[54:55], 2, v15
    s_mul_i32 s60, s50, 9216
    s_add_u32 s60, s60, 7340032
    s_add_u32 s61, s60, 4096
    s_add_u32 s62, s60, 8192
    s_mov_b32 s63, 131072
    s_and_b32 s46, s40, 63
    v_mov_b32 v36, s46
    s_getreg_b32 s48, hwreg(HW_REG_XCC_ID, 0, 3)
    s_lshl_b32 s48, s48, 13
    s_add_u32 s48, s48, 327680
    s_add_u32 s59, s48, 4096
    v_lshlrev_b32 v80, 6, v1
    v_and_b32 v81, 7, v1
    v_lshlrev_b32 v81, 6, v81
    buffer_load_dword v38, v80, s[32:35], s48 offen sc1
    buffer_load_dword v39, v81, s[32:35], s59 offen sc1
    s_mov_b32 s47, 0
PL34:
    s_waitcnt vmcnt(0)
    v_cmp_ne_u32 vcc, s40, v38
    v_cmp_ne_u32 s[56:57], s40, v39
    s_or_b64 vcc, vcc, s[56:57]
    s_cbranch_vccz PD35
    s_add_u32 s47, s47, 1
    s_cmp_ge_u32 s47, 65536
    s_cbranch_scc1 PD35
    s_sleep 2
    buffer_load_dword v38, v80, s[32:35], s48 offen sc1
    buffer_load_dword v39, v81, s[32:35], s59 offen sc1
    s_branch PL34
PD35:
    s_mov_b32 s47, 0
ZL36:
    buffer_load_dwordx4 v[28:31], v12, s[32:35], s63 offen offset:3072 sc1
    buffer_load_dwordx4 v[32:35], v14, s[32:35], s63 offen sc1
    buffer_load_dwordx4 v[40:43], v2, s[32:35], s60 offen offset:0 sc1
    buffer_load_dwordx4 v[44:47], v2, s[32:35], s60 offen offset:1024 sc1
    buffer_load_dwordx4 v[48:51], v2, s[32:35], s60 offen offset:2048 sc1
    buffer_load_dwordx4 v[52:55], v2, s[32:35], s60 offen offset:3072 sc1
    buffer_load_dwordx4 v[56:59], v2, s[32:35], s61 offen offset:0 sc1
    buffer_load_dwordx4 v[60:63], v2, s[32:35], s61 offen offset:1024 sc1
    buffer_load_dwordx4 v[64:67], v2, s[32:35], s61 offen offset:2048 sc1
    buffer_load_dwordx4 v[68:71], v2, s[32:35], s61 offen offset:3072 sc1
    buffer_load_dwordx4 v[72:75], v2, s[32:35], s62 offen offset:0 sc1
    s_waitcnt vmcnt(9)
    v_xor_b32 v37, s40, v30
    v_xor_b32 v38, s40, v35
    v_cndmask_b32 v32, v32, v33, s[52:53]
    v_or_b32 v38, v37, v38
    v_cndmask_b32 v32, v32, v34, s[54:55]
    v_mul_f32 v33, 0xbfb8aa3b, v29
    v_exp_f32 v33, v33
    v_min_u32 v28, 2047, v28
    v_add_f32 v33, 1.0, v33
    v_rcp_f32 v33, v33
    v_mul_u32_u24 v28, 1152, v28
    v_cvt_pk_bf16_f32 v33, 0, v33
    v_lshl_add_u32 v28, v13, 1, v28
    v_lshlrev_b32 v34, 16, v32
    v_and_b32 v35, 0xffff0000, v32
    s_waitcnt vmcnt(8)
    v_xor_b32 v40, v36, v40
    v_xor_b32 v41, v36, v41
    v_xor_b32 v42, v36, v42
    v_xor_b32 v43, v36, v43
    v_or3_b32 v37, v40, v41, v42
    v_or_b32 v37, v37, v43
    s_waitcnt vmcnt(7)
    v_xor_b32 v44, v36, v44
    v_xor_b32 v45, v36, v45
    v_xor_b32 v46, v36, v46
    v_xor_b32 v47, v36, v47
    v_or3_b32 v37, v37, v44, v45
    v_or3_b32 v37, v37, v46, v47
    v_pk_add_f32 v[40:41], v[40:41], v[44:45]
    v_pk_add_f32 v[42:43], v[42:43], v[46:47]
    s_waitcnt vmcnt(6)
    v_xor_b32 v48, v36, v48
    v_xor_b32 v49, v36, v49
    v_xor_b32 v50, v36, v50
    v_xor_b32 v51, v36, v51
    v_or3_b32 v37, v37, v48, v49
    v_or3_b32 v37, v37, v50, v51
    v_pk_add_f32 v[40:41], v[40:41], v[48:49]
    v_pk_add_f32 v[42:43], v[42:43], v[50:51]
    s_waitcnt vmcnt(5)
    v_xor_b32 v52, v36, v52
    v_xor_b32 v53, v36, v53
    v_xor_b32 v54, v36, v54
    v_xor_b32 v55, v36, v55
    v_or3_b32 v37, v37, v52, v53
    v_or3_b32 v37, v37, v54, v55
    v_pk_add_f32 v[40:41], v[40:41], v[52:53]
    v_pk_add_f32 v[42:43], v[42:43], v[54:55]
    s_waitcnt vmcnt(4)
    v_xor_b32 v56, v36, v56
    v_xor_b32 v57, v36, v57
    v_xor_b32 v58, v36, v58
    v_xor_b32 v59, v36, v59
    v_or3_b32 v37, v37, v56, v57
    v_or3_b32 v37, v37, v58, v59
    v_pk_add_f32 v[40:41], v[40:41], v[56:57]
    v_pk_add_f32 v[42:43], v[42:43], v[58:59]
    s_waitcnt vmcnt(3)
    v_xor_b32 v60, v36, v60
    v_xor_b32 v61, v36, v61
    v_xor_b32 v62, v36, v62
    v_xor_b32 v63, v36, v63
    v_or3_b32 v37, v37, v60, v61
    v_or3_b32 v37, v37, v62, v63
    v_pk_add_f32 v[40:41], v[40:41], v[60:61]
    v_pk_add_f32 v[42:43], v[42:43], v[62:63]
    s_waitcnt vmcnt(2)
    v_xor_b32 v64, v36, v64
    v_xor_b32 v65, v36, v65
    v_xor_b32 v66, v36, v66
    v_xor_b32 v67, v36, v67
    v_or3_b32 v37, v37, v64, v65
    v_or3_b32 v37, v37, v66, v67
    v_pk_add_f32 v[40:41], v[40:41], v[64:65]
    v_pk_add_f32 v[42:43], v[42:43], v[66:67]
    s_waitcnt vmcnt(1)
    v_xor_b32 v68, v36, v68
    v_xor_b32 v69, v36, v69
    v_xor_b32 v70, v36, v70
    v_xor_b32 v71, v36, v71
    v_or3_b32 v37, v37, v68, v69
    v_or3_b32 v37, v37, v70, v71
    v_pk_add_f32 v[40:41], v[40:41], v[68:69]
    v_pk_add_f32 v[42:43], v[42:43], v[70:71]
    s_waitcnt vmcnt(0)
    v_xor_b32 v72, v36, v72
    v_xor_b32 v73, v36, v73
    v_xor_b32 v74, v36, v74
    v_xor_b32 v75, v36, v75
    v_or3_b32 v37, v37, v72, v73
    v_or3_b32 v37, v37, v74, v75
    v_pk_add_f32 v[40:41], v[40:41], v[72:73]
    v_pk_add_f32 v[42:43], v[42:43], v[74:75]
    v_and_or_b32 v37, v37, 63, v38
    v_cmp_ne_u32 vcc, 0, v37
    s_cbranch_vccz ZD37
    s_add_u32 s47, s47, 1
    s_cmp_ge_u32 s47, 65536
    s_cbranch_scc1 ZD37
    s_sleep 2
    s_branch ZL36
ZD37:
    v_permlane32_swap_b32 v40, v41
    v_permlane32_swap_b32 v42, v43
    v_add_f32 v40, v40, v41
    v_add_f32 v42, v42, v43
    s_nop 1
    v_permlane16_swap_b32 v40, v42
    v_add_f32 v40, v40, v42
    s_nop 1
    v_add_f32_dpp v40, v40, v40 row_ror:8 row_mask:0xf bank_mask:0xf
    v_cvt_pk_bf16_f32 v40, 0, v40
    v_mul_f32 v40, v40, v33
    v_cvt_pk_bf16_f32 v40, 0, v40
    v_add_f32 v40, v40, v34
    v_cvt_pk_bf16_f32 v40, 0, v40
    v_add_f32 v40, v40, v35
    v_cvt_pk_bf16_f32 v40, v40, v40
    s_mov_b32 exec_lo, 0x00ff00ff
    s_mov_b32 exec_hi, 0x00ff00ff
    global_store_short v28, v40, s[28:29]
    s_cmp_lg_u32 s50, 0
    s_cbranch_scc1 DUMP
    s_mov_b64 exec, 1
    v_mov_b32 v36, s40
    buffer_store_dword v36, v2, s[32:35], 0 offen
    s_branch DUMP
FROLE:
    v_cmp_gt_u32 vcc, TBLEND-PC0, v15
    s_and_saveexec_b64 s[58:59], vcc
    s_cbranch_execz F_NT
    global_load_dword v255, v15, s[42:43]
F_NT:
    s_mov_b64 exec, -1
    v_lshrrev_b32 v12, 3, v0
    v_and_b32 v13, 7, v0
    v_lshlrev_b32 v13, 4, v13
    v_mul_u32_u24 v4, 9216, v12
    v_add_u32 v4, v4, v13
    v_mul_u32_u24 v5, 1152, v12
    v_add_u32 v5, v5, v13
    s_lshl_b32 s46, s50, 7
    s_mul_i32 s48, s50, 73728
    s_mov_b32 s38, 5308416
    s_mov_b32 s39, 0x00020000
    s_mov_b32 s54, 5308416
    s_mov_b32 s55, 0x00020000
    s_mov_b32 s58, 5308416
    s_mov_b32 s59, 0x00020000
    s_waitcnt lgkmcnt(0)
    s_mov_b32 s36, s22
    s_and_b32 s37, s23, 0xffff
    s_mov_b32 s52, s24
    s_and_b32 s53, s25, 0xffff
    s_mov_b32 s56, s26
    s_and_b32 s57, s27, 0xffff
    s_load_dword s40, s[30:31], 0
    s_mov_b32 s32, s30
    s_and_b32 s33, s31, 0xffff
    s_mov_b32 s34, 0x10000000
    s_mov_b32 s35, 0x00020000
    v_mul_u32_u24 v6, 272, v12
    v_add_u32 v6, v6, v13
    v_lshrrev_b32 v14, 4, v1
    v_bfe_u32 v15, v1, 2, 2
    v_lshl_add_u32 v7, v14, 3, v15
    v_mul_u32_u24 v7, 272, v7
    v_and_b32 v8, 2, v1
    v_lshl_add_u32 v7, v8, 6, v7
    v_and_b32 v8, 1, v1
    v_lshl_add_u32 v7, v8, 3, v7
    s_lshl_b32 s46, s3, 4
    v_add_u32 v7, s46, v7
    v_bfe_u32 v8, v1, 3, 3
    v_mul_u32_u24 v8, 1184, v8
    v_add_u32 v8, v8, v13
    s_mul_i32 s46, s3, 9600
    v_add_u32 v8, s46, v8
    v_mul_u32_u24 v9, 9600, v14
    v_mul_u32_u24 v15, 1184, v15
    v_add_u32 v9, v9, v15
    v_and_b32 v15, 3, v1
    v_lshl_add_u32 v9, v15, 3, v9
    s_lshl_b32 s46, s3, 5
    v_add_u32 v9, s46, v9
    v_add_u32 v242, 0, v0
    v_mul_u32_u24 v243, 683, v242
    v_lshrrev_b32 v243, 16, v243
    v_mul_u32_u24 v244, 96, v243
    v_sub_u32 v242, v242, v244
    v_mul_u32_u24 v243, 1168, v243
    v_add_u32 v243, 81920, v243
    v_and_b32 v244, 31, v242
    v_lshrrev_b32 v242, 5, v242
    v_lshl_add_u32 v245, v244, 4, v243
    v_lshl_add_u32 v246, v244, 2, v243
    v_add_u32 v246, 1024, v246
    v_cmp_eq_u32 s[60:61], 1, v242
    v_cmp_eq_u32 s[62:63], 2, v242
    v_mov_b32 v247, 0
    v_mov_b32 v248, 12
    v_cndmask_b32 v247, v247, v248, s[60:61]
    v_mov_b32 v248, 520
    v_cndmask_b32 v247, v247, v248, s[62:63]
    v_add_u32 v236, v247, v245
    v_mov_b32 v247, 4
    v_mov_b32 v248, 512
    v_cndmask_b32 v247, v247, v248, s[60:61]
    v_mov_b32 v248, 524
    v_cndmask_b32 v247, v247, v248, s[62:63]
    v_add_u32 v237, v247, v245
    v_mov_b32 v247, 8
    v_mov_b32 v248, 516
    v_cndmask_b32 v247, v247, v248, s[60:61]
    v_add_u32 v247, v247, v245
    v_cndmask_b32 v238, v247, v246, s[62:63]
    v_add_u32 v242, 512, v0
    v_mul_u32_u24 v243, 683, v242
    v_lshrrev_b32 v243, 16, v243
    v_mul_u32_u24 v244, 96, v243
    v_sub_u32 v242, v242, v244
    v_mul_u32_u24 v243, 1168, v243
    v_add_u32 v243, 81920, v243
    v_and_b32 v244, 31, v242
    v_lshrrev_b32 v242, 5, v242
    v_lshl_add_u32 v245, v244, 4, v243
    v_lshl_add_u32 v246, v244, 2, v243
    v_add_u32 v246, 1024, v246
    v_cmp_eq_u32 s[60:61], 1, v242
    v_cmp_eq_u32 s[62:63], 2, v242
    v_mov_b32 v247, 0
    v_mov_b32 v248, 12
    v_cndmask_b32 v247, v247, v248, s[60:61]
    v_mov_b32 v248, 520
    v_cndmask_b32 v247, v247, v248, s[62:63]
    v_add_u32 v239, v247, v245
    v_mov_b32 v247, 4
    v_mov_b32 v248, 512
    v_cndmask_b32 v247, v247, v248, s[60:61]
    v_mov_b32 v248, 524
    v_cndmask_b32 v247, v247, v248, s[62:63]
    v_add_u32 v240, v247, v245
    v_mov_b32 v247, 8
    v_mov_b32 v248, 516
    v_cndmask_b32 v247, v247, v248, s[60:61]
    v_add_u32 v247, v247, v245
    v_cndmask_b32 v241, v247, v246, s[62:63]
    v_and_b32 v15, 7, v1
    v_mul_u32_u24 v10, 1168, v15
    v_lshl_add_u32 v10, v14, 4, v10
    v_add_u32 v10, 81920, v10
    v_mul_u32_u24 v11, 144, v15
    v_add_u32 v11, 98304, v11
    v_lshl_add_u32 v242, v14, 4, v11
    v_bfe_u32 v243, v1, 4, 1
    v_lshl_add_u32 v11, v243, 3, v11
    v_bfe_u32 v243, v1, 3, 1
    v_lshl_add_u32 v11, v243, 2, v11
    v_lshrrev_b32 v244, 5, v1
    v_lshl_add_u32 v11, v244, 1, v11
    s_lshl_b32 s46, s3, 4
    v_add_u32 v11, s46, v11
    v_lshl_add_u32 v243, v243, 5, v14
    v_mul_u32_u24 v243, 9216, v243
    v_lshl_add_u32 v243, v15, 4, v243
    s_mul_i32 s62, s3, 36864
    s_lshl_b32 s46, s50, 7
    s_add_u32 s62, s62, s46
    s_add_u32 s62, s62, 7340032
    v_and_b32 v244, 8, v1
    v_cmp_eq_u32 s[60:61], 0, v244
    s_waitcnt lgkmcnt(0)
    s_add_u32 s40, s40, 1
    s_and_b32 s46, s40, 63
    v_mov_b32 v245, s46
    v_mov_b32 v246, 0xffffffc0
    v_mov_b32 v249, s40
    v_lshlrev_b32 v250, 13, v1
    s_lshl_b32 s63, s50, 6
    s_add_u32 s63, s63, 327680
    s_lshl_b32 s46, s50, 7
    buffer_load_dwordx4 v[16:19], v4, s[36:39], s46 offen nt
    buffer_load_dwordx4 v[20:23], v4, s[52:55], s46 offen nt
    s_add_u32 s46, s46, 589824
    buffer_load_dwordx4 v[24:27], v4, s[36:39], s46 offen nt
    buffer_load_dwordx4 v[28:31], v4, s[52:55], s46 offen nt
    s_add_u32 s46, s46, 589824
    buffer_load_dwordx4 v[32:35], v4, s[36:39], s46 offen nt
    buffer_load_dwordx4 v[36:39], v4, s[52:55], s46 offen nt
    s_add_u32 s46, s46, 589824
    buffer_load_dwordx4 v[40:43], v4, s[36:39], s46 offen nt
    buffer_load_dwordx4 v[44:47], v4, s[52:55], s46 offen nt
    s_add_u32 s46, s46, 589824
    buffer_load_dwordx4 v[48:51], v4, s[36:39], s46 offen nt
    buffer_load_dwordx4 v[52:55], v4, s[52:55], s46 offen nt
    s_add_u32 s46, s46, 589824
    buffer_load_dwordx4 v[56:59], v4, s[36:39], s46 offen nt
    buffer_load_dwordx4 v[60:63], v4, s[52:55], s46 offen nt
    s_add_u32 s46, s46, 589824
    buffer_load_dwordx4 v[64:67], v4, s[36:39], s46 offen nt
    buffer_load_dwordx4 v[68:71], v4, s[52:55], s46 offen nt
    s_add_u32 s46, s46, 589824
    buffer_load_dwordx4 v[72:75], v4, s[36:39], s46 offen nt
    buffer_load_dwordx4 v[76:79], v4, s[52:55], s46 offen nt
    s_add_u32 s46, s46, 589824
    buffer_load_dwordx4 v[80:83], v4, s[36:39], s46 offen nt
    buffer_load_dwordx4 v[84:87], v4, s[52:55], s46 offen nt
    s_add_u32 s46, s46, 589824
    buffer_load_dwordx4 v[88:91], v5, s[56:59], s48 offen offset:0 nt
    buffer_load_dwordx4 v[92:95], v5, s[56:59], s48 offen offset:128 nt
    buffer_load_dwordx4 v[96:99], v5, s[56:59], s48 offen offset:256 nt
    buffer_load_dwordx4 v[100:103], v5, s[56:59], s48 offen offset:384 nt
    buffer_load_dwordx4 v[104:107], v5, s[56:59], s48 offen offset:512 nt
    buffer_load_dwordx4 v[108:111], v5, s[56:59], s48 offen offset:640 nt
    buffer_load_dwordx4 v[112:115], v5, s[56:59], s48 offen offset:768 nt
    buffer_load_dwordx4 v[116:119], v5, s[56:59], s48 offen offset:896 nt
    buffer_load_dwordx4 v[120:123], v5, s[56:59], s48 offen offset:1024 nt
    s_waitcnt vmcnt(25)
    ds_write_b128 v6, v[16:19] offset:0
    ds_write_b128 v6, v[20:23] offset:128
    s_waitcnt vmcnt(23)
    ds_write_b128 v6, v[24:27] offset:17408
    ds_write_b128 v6, v[28:31] offset:17536
    s_waitcnt vmcnt(21)
    ds_write_b128 v6, v[32:35] offset:34816
    ds_write_b128 v6, v[36:39] offset:34944
    s_waitcnt vmcnt(19)
    v_add_u32 v6, 52224, v6
    ds_write_b128 v6, v[40:43] offset:0
    ds_write_b128 v6, v[44:47] offset:128
    s_waitcnt vmcnt(17)
    ds_write_b128 v6, v[48:51] offset:17408
    ds_write_b128 v6, v[52:55] offset:17536
    s_waitcnt lgkmcnt(0)
    s_barrier
    ds_read_b64_tr_b16 v[124:125], v7 offset:0
    ds_read_b64_tr_b16 v[126:127], v7 offset:1088
    ds_read_b64_tr_b16 v[128:129], v7 offset:8704
    ds_read_b64_tr_b16 v[130:131], v7 offset:9792
    ds_read_b64_tr_b16 v[132:133], v7 offset:17408
    ds_read_b64_tr_b16 v[134:135], v7 offset:18496
    ds_read_b64_tr_b16 v[136:137], v7 offset:26112
    ds_read_b64_tr_b16 v[138:139], v7 offset:27200
    ds_read_b64_tr_b16 v[140:141], v7 offset:34816
    ds_read_b64_tr_b16 v[142:143], v7 offset:35904
    ds_read_b64_tr_b16 v[144:145], v7 offset:43520
    ds_read_b64_tr_b16 v[146:147], v7 offset:44608
    v_add_u32 v7, 52224, v7
    ds_read_b64_tr_b16 v[148:149], v7 offset:0
    ds_read_b64_tr_b16 v[150:151], v7 offset:1088
    ds_read_b64_tr_b16 v[152:153], v7 offset:8704
    ds_read_b64_tr_b16 v[154:155], v7 offset:9792
    ds_read_b64_tr_b16 v[156:157], v7 offset:17408
    ds_read_b64_tr_b16 v[158:159], v7 offset:18496
    ds_read_b64_tr_b16 v[160:161], v7 offset:26112
    ds_read_b64_tr_b16 v[162:163], v7 offset:27200
    s_waitcnt vmcnt(15)
    ds_write_b128 v6, v[56:59] offset:34816
    ds_write_b128 v6, v[60:63] offset:34944
    s_waitcnt vmcnt(13)
    v_add_u32 v6, 52224, v6
    ds_write_b128 v6, v[64:67] offset:0
    ds_write_b128 v6, v[68:71] offset:128
    s_waitcnt vmcnt(11)
    ds_write_b128 v6, v[72:75] offset:17408
    ds_write_b128 v6, v[76:79] offset:17536
    s_waitcnt vmcnt(9)
    ds_write_b128 v6, v[80:83] offset:34816
    ds_write_b128 v6, v[84:87] offset:34944
    s_waitcnt lgkmcnt(0)
    s_barrier
    ds_read_b64_tr_b16 v[164:165], v7 offset:34816
    ds_read_b64_tr_b16 v[166:167], v7 offset:35904
    ds_read_b64_tr_b16 v[168:169], v7 offset:43520
    ds_read_b64_tr_b16 v[170:171], v7 offset:44608
    v_add_u32 v7, 52224, v7
    ds_read_b64_tr_b16 v[172:173], v7 offset:0
    ds_read_b64_tr_b16 v[174:175], v7 offset:1088
    ds_read_b64_tr_b16 v[176:177], v7 offset:8704
    ds_read_b64_tr_b16 v[178:179], v7 offset:9792
    ds_read_b64_tr_b16 v[180:181], v7 offset:17408
    ds_read_b64_tr_b16 v[182:183], v7 offset:18496
    ds_read_b64_tr_b16 v[184:185], v7 offset:26112
    ds_read_b64_tr_b16 v[186:187], v7 offset:27200
    ds_read_b64_tr_b16 v[188:189], v7 offset:34816
    ds_read_b64_tr_b16 v[190:191], v7 offset:35904
    ds_read_b64_tr_b16 v[192:193], v7 offset:43520
    ds_read_b64_tr_b16 v[194:195], v7 offset:44608
    s_waitcnt lgkmcnt(0)
    s_barrier
    s_waitcnt vmcnt(8)
    ds_write_b128 v8, v[88:91] offset:0
    s_waitcnt vmcnt(7)
    ds_write_b128 v8, v[92:95] offset:128
    s_waitcnt vmcnt(6)
    ds_write_b128 v8, v[96:99] offset:256
    s_waitcnt vmcnt(5)
    ds_write_b128 v8, v[100:103] offset:384
    s_waitcnt vmcnt(4)
    ds_write_b128 v8, v[104:107] offset:512
    s_waitcnt vmcnt(3)
    ds_write_b128 v8, v[108:111] offset:640
    s_waitcnt vmcnt(2)
    ds_write_b128 v8, v[112:115] offset:768
    s_waitcnt vmcnt(1)
    ds_write_b128 v8, v[116:119] offset:896
    s_waitcnt vmcnt(0)
    ds_write_b128 v8, v[120:123] offset:1024
    s_waitcnt lgkmcnt(0)
    s_barrier
    ds_read_b64_tr_b16 v[196:197], v9 offset:0
    ds_read_b64_tr_b16 v[198:199], v9 offset:4736
    ds_read_b64_tr_b16 v[200:201], v9 offset:38400
    ds_read_b64_tr_b16 v[202:203], v9 offset:43136
    ds_read_b64_tr_b16 v[204:205], v9 offset:256
    ds_read_b64_tr_b16 v[206:207], v9 offset:4992
    ds_read_b64_tr_b16 v[208:209], v9 offset:38656
    ds_read_b64_tr_b16 v[210:211], v9 offset:43392
    ds_read_b64_tr_b16 v[212:213], v9 offset:512
    ds_read_b64_tr_b16 v[214:215], v9 offset:5248
    ds_read_b64_tr_b16 v[216:217], v9 offset:38912
    ds_read_b64_tr_b16 v[218:219], v9 offset:43648
    ds_read_b64_tr_b16 v[220:221], v9 offset:768
    ds_read_b64_tr_b16 v[222:223], v9 offset:5504
    ds_read_b64_tr_b16 v[224:225], v9 offset:39168
    ds_read_b64_tr_b16 v[226:227], v9 offset:43904
    ds_read_b64_tr_b16 v[228:229], v9 offset:1024
    ds_read_b64_tr_b16 v[230:231], v9 offset:5760
    ds_read_b64_tr_b16 v[232:233], v9 offset:39424
    ds_read_b64_tr_b16 v[234:235], v9 offset:44160
    s_mov_b32 s48, 65536
    s_add_u32 s49, s48, 8192
    s_waitcnt lgkmcnt(0)
    s_cmp_ge_u32 s3, 4
    s_cbranch_scc1 F_P1
    buffer_load_dwordx4 v[16:19], v3, s[32:35], s48 offen sc1
    buffer_load_dwordx4 v[20:23], v3, s[32:35], s49 offen sc1
    s_mov_b32 s47, 0
PL38:
    s_waitcnt vmcnt(0)
    v_cmp_ne_u32 vcc, s40, v19
    v_cmp_ne_u32 s[52:53], s40, v23
    s_or_b64 vcc, vcc, s[52:53]
    s_cbranch_vccz PD39
    s_add_u32 s47, s47, 1
    s_cmp_ge_u32 s47, 65536
    s_cbranch_scc1 PD39
    s_sleep 1
    buffer_load_dwordx4 v[16:19], v3, s[32:35], s48 offen sc1
    buffer_load_dwordx4 v[20:23], v3, s[32:35], s49 offen sc1
    s_branch PL38
PD39:
    ds_write_b32 v239, v20
    ds_write_b32 v240, v21
    ds_write_b32 v241, v22
    s_branch F_P2
F_P1:
    buffer_load_dwordx4 v[16:19], v3, s[32:35], s48 offen sc1
    s_mov_b32 s47, 0
PL40:
    s_waitcnt vmcnt(0)
    v_cmp_ne_u32 vcc, s40, v19
    s_cbranch_vccz PD41
    s_add_u32 s47, s47, 1
    s_cmp_ge_u32 s47, 65536
    s_cbranch_scc1 PD41
    s_sleep 1
    buffer_load_dwordx4 v[16:19], v3, s[32:35], s48 offen sc1
    s_branch PL40
PD41:
F_P2:
    ds_write_b32 v236, v16
    ds_write_b32 v237, v17
    ds_write_b32 v238, v18
    s_waitcnt lgkmcnt(0)
    s_barrier
    ds_read_b128 v[32:35], v10 offset:0
    ds_read_b128 v[36:39], v10 offset:64
    ds_read_b128 v[40:43], v10 offset:128
    ds_read_b128 v[44:47], v10 offset:192
    ds_read_b128 v[48:51], v10 offset:256
    ds_read_b128 v[52:55], v10 offset:320
    ds_read_b128 v[56:59], v10 offset:384
    s_waitcnt lgkmcnt(6)
    v_mfma_f32_16x16x32_bf16 v[24:27], v[124:127], v[32:35], 0
    ds_read_b128 v[60:63], v10 offset:448
    s_waitcnt lgkmcnt(6)
    v_mfma_f32_16x16x32_bf16 v[24:27], v[128:131], v[36:39], v[24:27]
    ds_read_b128 v[64:67], v10 offset:512
    s_waitcnt lgkmcnt(6)
    v_mfma_f32_16x16x32_bf16 v[24:27], v[132:135], v[40:43], v[24:27]
    ds_read_b128 v[68:71], v10 offset:576
    s_waitcnt lgkmcnt(6)
    v_mfma_f32_16x16x32_bf16 v[24:27], v[136:139], v[44:47], v[24:27]
    ds_read_b128 v[72:75], v10 offset:640
    s_cmp_lg_u32 s3, 7
    s_cbranch_scc1 FH42
    s_mov_b64 exec, 0xff
    buffer_store_dword v249, v250, s[32:35], s63 offen sc1
    s_mov_b64 exec, -1
FH42:
    s_waitcnt lgkmcnt(6)
    v_mfma_f32_16x16x32_bf16 v[24:27], v[140:143], v[48:51], v[24:27]
    ds_read_b128 v[76:79], v10 offset:704
    s_waitcnt lgkmcnt(6)
    v_mfma_f32_16x16x32_bf16 v[24:27], v[144:147], v[52:55], v[24:27]
    ds_read_b128 v[80:83], v10 offset:768
    s_waitcnt lgkmcnt(6)
    v_mfma_f32_16x16x32_bf16 v[24:27], v[148:151], v[56:59], v[24:27]
    ds_read_b128 v[84:87], v10 offset:832
    s_waitcnt lgkmcnt(6)
    v_mfma_f32_16x16x32_bf16 v[24:27], v[152:155], v[60:63], v[24:27]
    ds_read_b128 v[88:91], v10 offset:896
    s_waitcnt lgkmcnt(6)
    v_mfma_f32_16x16x32_bf16 v[24:27], v[156:159], v[64:67], v[24:27]
    ds_read_b128 v[92:95], v10 offset:960
    s_waitcnt lgkmcnt(6)
    v_mfma_f32_16x16x32_bf16 v[24:27], v[160:163], v[68:71], v[24:27]
    ds_read_b128 v[96:99], v10 offset:1024
    s_waitcnt lgkmcnt(6)
    v_mfma_f32_16x16x32_bf16 v[24:27], v[164:167], v[72:75], v[24:27]
    ds_read_b128 v[100:103], v10 offset:1088
    s_waitcnt lgkmcnt(6)
    v_mfma_f32_16x16x32_bf16 v[24:27], v[168:171], v[76:79], v[24:27]
    s_waitcnt lgkmcnt(5)
    v_mfma_f32_16x16x32_bf16 v[24:27], v[172:175], v[80:83], v[24:27]
    s_waitcnt lgkmcnt(4)
    v_mfma_f32_16x16x32_bf16 v[24:27], v[176:179], v[84:87], v[24:27]
    s_waitcnt lgkmcnt(3)
    v_mfma_f32_16x16x32_bf16 v[24:27], v[180:183], v[88:91], v[24:27]
    s_waitcnt lgkmcnt(2)
    v_mfma_f32_16x16x32_bf16 v[24:27], v[184:187], v[92:95], v[24:27]
    s_waitcnt lgkmcnt(1)
    v_mfma_f32_16x16x32_bf16 v[24:27], v[188:191], v[96:99], v[24:27]
    s_waitcnt lgkmcnt(0)
    v_mfma_f32_16x16x32_bf16 v[24:27], v[192:195], v[100:103], v[24:27]
    s_nop 7
    v_cndmask_b32 v28, v26, v24, s[60:61]
    v_cndmask_b32 v29, v27, v25, s[60:61]
    v_cvt_pk_bf16_f32 v28, 0, v28
    v_cvt_pk_bf16_f32 v29, 0, v29
    s_nop 1
    v_permlane32_swap_b32 v28, v29
    v_mul_f32 v30, 0xbfb8aa3b, v28
    v_exp_f32 v30, v30
    s_nop 0
    v_add_f32 v30, 1.0, v30
    v_rcp_f32 v30, v30
    s_nop 0
    v_mul_f32 v28, v28, v30
    v_cvt_pk_bf16_f32 v28, 0, v28
    v_mul_f32 v28, v28, v29
    v_cvt_pk_bf16_f32 v28, v28, v28
    ds_write_b16 v11, v28
    s_waitcnt lgkmcnt(0)
    s_barrier
    ds_read_b128 v[16:19], v242
    ds_read_b128 v[20:23], v242 offset:64
    s_waitcnt lgkmcnt(1)
    v_mfma_f32_16x16x32_bf16 v[32:35], v[196:199], v[16:19], 0
    v_mfma_f32_16x16x32_bf16 v[36:39], v[204:207], v[16:19], 0
    v_mfma_f32_16x16x32_bf16 v[40:43], v[212:215], v[16:19], 0
    v_mfma_f32_16x16x32_bf16 v[44:47], v[220:223], v[16:19], 0
    v_mfma_f32_16x16x32_bf16 v[48:51], v[228:231], v[16:19], 0
    s_waitcnt lgkmcnt(0)
    v_mfma_f32_16x16x32_bf16 v[32:35], v[200:203], v[20:23], v[32:35]
    v_mfma_f32_16x16x32_bf16 v[36:39], v[208:211], v[20:23], v[36:39]
    v_mfma_f32_16x16x32_bf16 v[40:43], v[216:219], v[20:23], v[40:43]
    v_mfma_f32_16x16x32_bf16 v[44:47], v[224:227], v[20:23], v[44:47]
    v_mfma_f32_16x16x32_bf16 v[48:51], v[232:235], v[20:23], v[48:51]
    s_nop 4
    v_cndmask_b32 v32, v36, v32, s[60:61]
    v_cndmask_b32 v33, v37, v33, s[60:61]
    v_cndmask_b32 v34, v38, v34, s[60:61]
    v_cndmask_b32 v35, v39, v35, s[60:61]
    v_and_or_b32 v32, v32, v246, v245
    v_and_or_b32 v33, v33, v246, v245
    v_and_or_b32 v34, v34, v246, v245
    v_and_or_b32 v35, v35, v246, v245
    buffer_store_dwordx4 v[32:35], v243, s[32:35], s62 offen sc1
    s_add_u32 s62, s62, 589824
    v_cndmask_b32 v40, v44, v40, s[60:61]
    v_cndmask_b32 v41, v45, v41, s[60:61]
    v_cndmask_b32 v42, v46, v42, s[60:61]
    v_cndmask_b32 v43, v47, v43, s[60:61]
    v_and_or_b32 v40, v40, v246, v245
    v_and_or_b32 v41, v41, v246, v245
    v_and_or_b32 v42, v42, v246, v245
    v_and_or_b32 v43, v43, v246, v245
    buffer_store_dwordx4 v[40:43], v243, s[32:35], s62 offen sc1
    s_add_u32 s62, s62, 589824
    s_cmp_ge_u32 s3, 4
    s_cbranch_scc1 DUMP
    v_and_or_b32 v48, v48, v246, v245
    v_and_or_b32 v49, v49, v246, v245
    v_and_or_b32 v50, v50, v246, v245
    v_and_or_b32 v51, v51, v246, v245
    s_mov_b64 exec, s[60:61]
    buffer_store_dwordx4 v[48:51], v243, s[32:35], s62 offen sc1
DUMP:
END:
    s_endpgm
.p2align 7
.type TBL,@object
TBL:
.long 0x0, 0x0, 0x0, 0x0, 0x0, 0x0, 0x0, 0x0
.long 0x0, 0x0, 0x0, 0x0, 0x0, 0x0, 0x0, 0x0
.long 0x0, 0x0, 0x0, 0x0, 0x0, 0x0, 0x0, 0x0
.long 0x0, 0x0, 0x0, 0x0, 0x0, 0x0, 0x0, 0x0
.long 0x0, 0x0, 0x0, 0x0, 0x0, 0x0, 0x0, 0x0
.long 0x0, 0x0, 0x0, 0x0, 0x0, 0x0, 0x0, 0x0
.long 0x0, 0x0, 0x0, 0x0, 0x0, 0x0, 0x0, 0x0
.long 0x0, 0x0, 0x0, 0x0, 0x0, 0x0, 0x0, 0x0
.long 0x0, 0x3c000000, 0x3c003c00, 0x0, 0x0, 0x0, 0x3c003c00, 0x3c00
.long 0x0, 0x0, 0x3c000000, 0x3c003c00, 0x0, 0x0, 0x0, 0x3c003c00
.long 0x0, 0x0, 0x0, 0x3c000000, 0x0, 0x0, 0x0, 0x0
.long 0x0, 0x0, 0x0, 0x0, 0x0, 0x0, 0x0, 0x0
.long 0x0, 0x0, 0x0, 0x0, 0x0, 0x0, 0x0, 0x0
.long 0x0, 0x0, 0x0, 0x0, 0x0, 0x0, 0x0, 0x0
.long 0x0, 0x0, 0x0, 0x0, 0x0, 0x0, 0x0, 0x0
.long 0x0, 0x0, 0x0, 0x0, 0x0, 0x0, 0x0, 0x0
.long 0x0, 0x0, 0x0, 0x0, 0x0, 0x0, 0x0, 0x0
.long 0x0, 0x0, 0x0, 0x0, 0x3c00, 0x0, 0x0, 0x0
.long 0x3c003c00, 0x0, 0x0, 0x0, 0x3c003c00, 0x3c00, 0x0, 0x0
.long 0x3c000000, 0x3c003c00, 0x0, 0x0, 0x0, 0x3c003c00, 0x3c00, 0x0
.long 0x0, 0x3c000000, 0x3c003c00, 0x0, 0x0, 0x0, 0x3c003c00, 0x3c00
.long 0x0, 0x0, 0x3c000000, 0x3c003c00, 0x0, 0x0, 0x0, 0x3c003c00
.long 0x0, 0x0, 0x0, 0x3c000000, 0x0, 0x0, 0x0, 0x0
.long 0x0, 0x0, 0x0, 0x0, 0x0, 0x0, 0x0, 0x0
.long 0x0, 0x0, 0x0, 0x0, 0x0, 0x0, 0x0, 0x0
.long 0x0, 0x0, 0x0, 0x0, 0x0, 0x0, 0x0, 0x0
.long 0x0, 0x0, 0x0, 0x0, 0x0, 0x0, 0x0, 0x0
.long 0x0, 0x0, 0x0, 0x0, 0x0, 0x0, 0x0, 0x0
.long 0x0, 0x0, 0x0, 0x0, 0x0, 0x0, 0x0, 0x0
.long 0x0, 0x0, 0x0, 0x0, 0x3c00, 0x0, 0x0, 0x0
.long 0x3c003c00, 0x0, 0x0, 0x0, 0x3c003c00, 0x3c00, 0x0, 0x0
.long 0x3c000000, 0x3c003c00, 0x0, 0x0, 0x0, 0x3c003c00, 0x3c00, 0x0
.long 0x0, 0x0, 0x0, 0x3c003c00, 0x0, 0x0, 0x0, 0x3c000000
.long 0x0, 0x0, 0x0, 0x0, 0x0, 0x0, 0x0, 0x0
.long 0x0, 0x0, 0x0, 0x0, 0x0, 0x0, 0x0, 0x0
.long 0x0, 0x0, 0x0, 0x0, 0x0, 0x0, 0x0, 0x0
.long 0x0, 0x0, 0x0, 0x0, 0x0, 0x0, 0x0, 0x0
.long 0x0, 0x0, 0x0, 0x0, 0x0, 0x0, 0x0, 0x0
.long 0x0, 0x0, 0x0, 0x0, 0x0, 0x0, 0x0, 0x0
.long 0x0, 0x0, 0x0, 0x0, 0x0, 0x0, 0x0, 0x0
.long 0x3c003c00, 0x3c00, 0x0, 0x0, 0x3c003c00, 0x3c003c00, 0x0, 0x0
.long 0x3c003c00, 0x3c003c00, 0x3c00, 0x0, 0x3c000000, 0x3c003c00, 0x3c003c00, 0x0
.long 0x0, 0x3c003c00, 0x3c003c00, 0x3c00, 0x0, 0x3c000000, 0x3c003c00, 0x3c003c00
.long 0x0, 0x0, 0x3c003c00, 0x3c003c00, 0x0, 0x0, 0x3c000000, 0x3c003c00
.long 0x0, 0x0, 0x0, 0x3c003c00, 0x0, 0x0, 0x0, 0x3c000000
.long 0x0, 0x0, 0x0, 0x0, 0x0, 0x0, 0x0, 0x0
.long 0x0, 0x0, 0x0, 0x0, 0x0, 0x0, 0x0, 0x0
.long 0x0, 0x0, 0x0, 0x0, 0x0, 0x0, 0x0, 0x0
.long 0x0, 0x0, 0x0, 0x0, 0x0, 0x0, 0x0, 0x0
.long 0x0, 0x0, 0x0, 0x0, 0x0, 0x0, 0x0, 0x0
.long 0x0, 0x0, 0x0, 0x0, 0x0, 0x0, 0x0, 0x0
.long 0x3c00, 0x0, 0x0, 0x0, 0x3c003c00, 0x0, 0x0, 0x0
.long 0x3c003c00, 0x3c00, 0x0, 0x0, 0x3c003c00, 0x3c003c00, 0x0, 0x0
.long 0x3c003c00, 0x3c003c00, 0x3c00, 0x0, 0x3c000000, 0x3c003c00, 0x3c003c00, 0x0
.long 0x0, 0x3c003c00, 0x3c003c00, 0x3c00, 0x0, 0x3c000000, 0x3c003c00, 0x3c003c00
.long 0x0, 0x0, 0x3c003c00, 0x3c003c00, 0x0, 0x0, 0x3c000000, 0x3c003c00
.long 0x0, 0x0, 0x0, 0x0, 0x0, 0x0, 0x0, 0x0
.long 0x0, 0x0, 0x0, 0x0, 0x0, 0x0, 0x0, 0x0
.long 0x0, 0x0, 0x0, 0x0, 0x0, 0x0, 0x0, 0x0
.long 0x0, 0x0, 0x0, 0x0, 0x0, 0x0, 0x0, 0x0
.long 0x0, 0x0, 0x0, 0x0, 0x0, 0x0, 0x0, 0x0
.long 0x0, 0x0, 0x0, 0x0, 0x0, 0x0, 0x0, 0x0
.long 0x0, 0x0, 0x0, 0x0, 0x0, 0x0, 0x0, 0x0
.long 0x3c00, 0x0, 0x0, 0x0, 0x3c003c00, 0x0, 0x0, 0x0
.long 0x0, 0x3c000000, 0x3c003c00, 0x0, 0x0, 0x0, 0x3c003c00, 0x3c00
.long 0x0, 0x0, 0x3c000000, 0x3c003c00, 0x0, 0x0, 0x0, 0x3c003c00
.long 0x0, 0x0, 0x0, 0x3c000000, 0x0, 0x0, 0x0, 0x0
.long 0x0, 0x0, 0x0, 0x0, 0x0, 0x0, 0x0, 0x0
.long 0x0, 0x0, 0x0, 0x0, 0x0, 0x0, 0x0, 0x0
.long 0x0, 0x0, 0x0, 0x0, 0x0, 0x0, 0x0, 0x0
.long 0x0, 0x0, 0x0, 0x0, 0x0, 0x0, 0x0, 0x0
.long 0x0, 0x0, 0x0, 0x0, 0x0, 0x0, 0x0, 0x0
.long 0x0, 0x0, 0x0, 0x0, 0x0, 0x0, 0x0, 0x0
.long 0x0, 0x0, 0x0, 0x0, 0x3c00, 0x0, 0x0, 0x0
.long 0x3c003c00, 0x0, 0x0, 0x0, 0x3c003c00, 0x3c00, 0x0, 0x0
.long 0x3c000000, 0x3c003c00, 0x0, 0x0, 0x0, 0x3c003c00, 0x3c00, 0x0
.long 0x0, 0x3c000000, 0x3c003c00, 0x0, 0x0, 0x0, 0x3c003c00, 0x3c00
.long 0x0, 0x0, 0x3c000000, 0x3c003c00, 0x0, 0x0, 0x0, 0x3c003c00
.long 0x0, 0x0, 0x0, 0x3c000000, 0x0, 0x0, 0x0, 0x0
.long 0x0, 0x0, 0x0, 0x0, 0x0, 0x0, 0x0, 0x0
.long 0x0, 0x0, 0x0, 0x0, 0x0, 0x0, 0x0, 0x0
.long 0x0, 0x0, 0x0, 0x0, 0x0, 0x0, 0x0, 0x0
.long 0x0, 0x0, 0x0, 0x0, 0x0, 0x0, 0x0, 0x0
.long 0x0, 0x0, 0x0, 0x0, 0x0, 0x0, 0x0, 0x0
.long 0x0, 0x0, 0x0, 0x0, 0x0, 0x0, 0x0, 0x0
.long 0x0, 0x0, 0x0, 0x0, 0x3c00, 0x0, 0x0, 0x0
.long 0x3c003c00, 0x0, 0x0, 0x0, 0x3c003c00, 0x3c00, 0x0, 0x0
.long 0x3c000000, 0x3c003c00, 0x0, 0x0, 0x0, 0x3c003c00, 0x3c00, 0x0
.long 0x0, 0x0, 0x0, 0x0, 0x0, 0x0, 0x0, 0x0
.long 0x0, 0x0, 0x0, 0x0, 0x0, 0x0, 0x0, 0x0
.long 0x0, 0x0, 0x0, 0x0, 0x0, 0x0, 0x0, 0x0
.long 0x0, 0x0, 0x0, 0x0, 0x0, 0x0, 0x0, 0x0
.long 0x0, 0x0, 0x0, 0x0, 0x0, 0x0, 0x0, 0x0
.long 0x0, 0x0, 0x0, 0x0, 0x0, 0x0, 0x0, 0x0
.long 0x0, 0x0, 0x0, 0x0, 0x0, 0x0, 0x0, 0x0
.long 0x0, 0x0, 0x0, 0x0, 0x0, 0x0, 0x0, 0x0
.long 0x0, 0x0, 0x0, 0x3c003c00, 0x0, 0x0, 0x0, 0x3c000000
.long 0x0, 0x0, 0x0, 0x0, 0x0, 0x0, 0x0, 0x0
.long 0x0, 0x0, 0x0, 0x0, 0x0, 0x0, 0x0, 0x0
.long 0x0, 0x0, 0x0, 0x0, 0x0, 0x0, 0x0, 0x0
.long 0x0, 0x0, 0x0, 0x0, 0x0, 0x0, 0x0, 0x0
.long 0x0, 0x0, 0x0, 0x0, 0x0, 0x0, 0x0, 0x0
.long 0x0, 0x0, 0x0, 0x0, 0x0, 0x0, 0x0, 0x0
.long 0x0, 0x0, 0x0, 0x0, 0x0, 0x0, 0x0, 0x0
.long 0x3c003c00, 0x3c00, 0x0, 0x0, 0x3c003c00, 0x3c003c00, 0x0, 0x0
.long 0x3c003c00, 0x3c003c00, 0x3c00, 0x0, 0x3c000000, 0x3c003c00, 0x3c003c00, 0x0
.long 0x0, 0x3c003c00, 0x3c003c00, 0x3c00, 0x0, 0x3c000000, 0x3c003c00, 0x3c003c00
.long 0x0, 0x0, 0x3c003c00, 0x3c003c00, 0x0, 0x0, 0x3c000000, 0x3c003c00
.long 0x0, 0x0, 0x0, 0x3c003c00, 0x0, 0x0, 0x0, 0x3c000000
.long 0x0, 0x0, 0x0, 0x0, 0x0, 0x0, 0x0, 0x0
.long 0x0, 0x0, 0x0, 0x0, 0x0, 0x0, 0x0, 0x0
.long 0x0, 0x0, 0x0, 0x0, 0x0, 0x0, 0x0, 0x0
.long 0x0, 0x0, 0x0, 0x0, 0x0, 0x0, 0x0, 0x0
.long 0x0, 0x0, 0x0, 0x0, 0x0, 0x0, 0x0, 0x0
.long 0x0, 0x0, 0x0, 0x0, 0x0, 0x0, 0x0, 0x0
.long 0x3c00, 0x0, 0x0, 0x0, 0x3c003c00, 0x0, 0x0, 0x0
.long 0x3c003c00, 0x3c00, 0x0, 0x0, 0x3c003c00, 0x3c003c00, 0x0, 0x0
.long 0x3c003c00, 0x3c003c00, 0x3c00, 0x0, 0x3c000000, 0x3c003c00, 0x3c003c00, 0x0
.long 0x0, 0x3c003c00, 0x3c003c00, 0x3c00, 0x0, 0x3c000000, 0x3c003c00, 0x3c003c00
.long 0x0, 0x0, 0x3c003c00, 0x3c003c00, 0x0, 0x0, 0x3c000000, 0x3c003c00
.long 0x0, 0x0, 0x0, 0x0, 0x0, 0x0, 0x0, 0x0
.long 0x0, 0x0, 0x0, 0x0, 0x0, 0x0, 0x0, 0x0
.long 0x0, 0x0, 0x0, 0x0, 0x0, 0x0, 0x0, 0x0
.long 0x0, 0x0, 0x0, 0x0, 0x0, 0x0, 0x0, 0x0
.long 0x0, 0x0, 0x0, 0x0, 0x0, 0x0, 0x0, 0x0
.long 0x0, 0x0, 0x0, 0x0, 0x0, 0x0, 0x0, 0x0
.long 0x0, 0x0, 0x0, 0x0, 0x0, 0x0, 0x0, 0x0
.long 0x3c00, 0x0, 0x0, 0x0, 0x3c003c00, 0x0, 0x0, 0x0
.long 0x0, 0x0, 0x3c000000, 0x3c003c00, 0x0, 0x0, 0x0, 0x3c003c00
.long 0x0, 0x0, 0x0, 0x3c000000, 0x0, 0x0, 0x0, 0x0
.long 0x0, 0x0, 0x0, 0x0, 0x0, 0x0, 0x0, 0x0
.long 0x0, 0x0, 0x0, 0x0, 0x0, 0x0, 0x0, 0x0
.long 0x0, 0x0, 0x0, 0x0, 0x0, 0x0, 0x0, 0x0
.long 0x0, 0x0, 0x0, 0x0, 0x0, 0x0, 0x0, 0x0
.long 0x0, 0x0, 0x0, 0x0, 0x0, 0x0, 0x0, 0x0
.long 0x0, 0x0, 0x0, 0x0, 0x0, 0x0, 0x0, 0x0
.long 0x3c003c00, 0x3c003c00, 0x0, 0x0, 0x3c003c00, 0x3c003c00, 0x3c00, 0x0
.long 0x3c003c00, 0x3c003c00, 0x3c003c00, 0x0, 0x3c003c00, 0x3c003c00, 0x3c003c00, 0x3c00
.long 0x3c000000, 0x3c003c00, 0x3c003c00, 0x3c003c00, 0x0, 0x3c003c00, 0x3c003c00, 0x3c003c00
.long 0x0, 0x3c000000, 0x3c003c00, 0x3c003c00, 0x0, 0x0, 0x3c003c00, 0x3c003c00
.long 0x0, 0x0, 0x3c000000, 0x3c003c00, 0x0, 0x0, 0x0, 0x3c003c00
.long 0x0, 0x0, 0x0, 0x3c000000, 0x0, 0x0, 0x0, 0x0
.long 0x0, 0x0, 0x0, 0x0, 0x0, 0x0, 0x0, 0x0
.long 0x0, 0x0, 0x0, 0x0, 0x0, 0x0, 0x0, 0x0
.long 0x0, 0x0, 0x0, 0x0, 0x0, 0x0, 0x0, 0x0
.long 0x0, 0x0, 0x0, 0x0, 0x0, 0x0, 0x0, 0x0
.long 0x0, 0x0, 0x0, 0x0, 0x3c00, 0x0, 0x0, 0x0
.long 0x3c003c00, 0x0, 0x0, 0x0, 0x3c003c00, 0x3c00, 0x0, 0x0
.long 0x3c003c00, 0x3c003c00, 0x0, 0x0, 0x3c003c00, 0x3c003c00, 0x3c00, 0x0
.long 0x3c003c00, 0x3c003c00, 0x3c003c00, 0x0, 0x3c003c00, 0x3c003c00, 0x3c003c00, 0x3c00
.long 0x3c000000, 0x3c003c00, 0x3c003c00, 0x3c003c00, 0x0, 0x3c003c00, 0x3c003c00, 0x3c003c00
.long 0x0, 0x3c000000, 0x3c003c00, 0x3c003c00, 0x0, 0x0, 0x3c003c00, 0x3c003c00
.long 0x0, 0x0, 0x0, 0x0, 0x0, 0x0, 0x0, 0x0
.long 0x0, 0x0, 0x0, 0x0, 0x0, 0x0, 0x0, 0x0
.long 0x0, 0x0, 0x0, 0x0, 0x0, 0x0, 0x0, 0x0
.long 0x0, 0x0, 0x0, 0x0, 0x0, 0x0, 0x0, 0x0
.long 0x0, 0x0, 0x0, 0x0, 0x0, 0x0, 0x0, 0x0
.long 0x0, 0x0, 0x0, 0x0, 0x0, 0x0, 0x0, 0x0
.long 0x0, 0x0, 0x0, 0x0, 0x3c00, 0x0, 0x0, 0x0
.long 0x3c003c00, 0x0, 0x0, 0x0, 0x3c003c00, 0x3c00, 0x0, 0x0
.long 0x0, 0x0, 0x3c003c00, 0x3c003c00, 0x0, 0x0, 0x3c000000, 0x3c003c00
.long 0x0, 0x0, 0x0, 0x3c003c00, 0x0, 0x0, 0x0, 0x3c000000
.long 0x0, 0x0, 0x0, 0x0, 0x0, 0x0, 0x0, 0x0
.long 0x0, 0x0, 0x0, 0x0, 0x0, 0x0, 0x0, 0x0
.long 0x0, 0x0, 0x0, 0x0, 0x0, 0x0, 0x0, 0x0
.long 0x0, 0x0, 0x0, 0x0, 0x0, 0x0, 0x0, 0x0
.long 0x0, 0x0, 0x0, 0x0, 0x0, 0x0, 0x0, 0x0
.long 0x0, 0x0, 0x0, 0x0, 0x0, 0x0, 0x0, 0x0
.long 0x3c003c00, 0x3c003c00, 0x3c00, 0x0, 0x3c003c00, 0x3c003c00, 0x3c003c00, 0x0
.long 0x3c003c00, 0x3c003c00, 0x3c003c00, 0x3c00, 0x3c003c00, 0x3c003c00, 0x3c003c00, 0x3c003c00
.long 0x3c003c00, 0x3c003c00, 0x3c003c00, 0x3c003c00, 0x3c000000, 0x3c003c00, 0x3c003c00, 0x3c003c00
.long 0x0, 0x3c003c00, 0x3c003c00, 0x3c003c00, 0x0, 0x3c000000, 0x3c003c00, 0x3c003c00
.long 0x0, 0x0, 0x3c003c00, 0x3c003c00, 0x0, 0x0, 0x3c000000, 0x3c003c00
.long 0x0, 0x0, 0x0, 0x3c003c00, 0x0, 0x0, 0x0, 0x3c000000
.long 0x0, 0x0, 0x0, 0x0, 0x0, 0x0, 0x0, 0x0
.long 0x0, 0x0, 0x0, 0x0, 0x0, 0x0, 0x0, 0x0
.long 0x0, 0x0, 0x0, 0x0, 0x0, 0x0, 0x0, 0x0
.long 0x0, 0x0, 0x0, 0x0, 0x0, 0x0, 0x0, 0x0
.long 0x3c00, 0x0, 0x0, 0x0, 0x3c003c00, 0x0, 0x0, 0x0
.long 0x3c003c00, 0x3c00, 0x0, 0x0, 0x3c003c00, 0x3c003c00, 0x0, 0x0
.long 0x3c003c00, 0x3c003c00, 0x3c00, 0x0, 0x3c003c00, 0x3c003c00, 0x3c003c00, 0x0
.long 0x3c003c00, 0x3c003c00, 0x3c003c00, 0x3c00, 0x3c003c00, 0x3c003c00, 0x3c003c00, 0x3c003c00
.long 0x3c003c00, 0x3c003c00, 0x3c003c00, 0x3c003c00, 0x3c000000, 0x3c003c00, 0x3c003c00, 0x3c003c00
.long 0x0, 0x3c003c00, 0x3c003c00, 0x3c003c00, 0x0, 0x3c000000, 0x3c003c00, 0x3c003c00
.long 0x0, 0x0, 0x0, 0x0, 0x0, 0x0, 0x0, 0x0
.long 0x0, 0x0, 0x0, 0x0, 0x0, 0x0, 0x0, 0x0
.long 0x0, 0x0, 0x0, 0x0, 0x0, 0x0, 0x0, 0x0
.long 0x0, 0x0, 0x0, 0x0, 0x0, 0x0, 0x0, 0x0
.long 0x0, 0x0, 0x0, 0x0, 0x0, 0x0, 0x0, 0x0
.long 0x0, 0x0, 0x0, 0x0, 0x0, 0x0, 0x0, 0x0
.long 0x3c00, 0x0, 0x0, 0x0, 0x3c003c00, 0x0, 0x0, 0x0
.long 0x3c003c00, 0x3c00, 0x0, 0x0, 0x3c003c00, 0x3c003c00, 0x0, 0x0
.long 0x0, 0x0, 0x0, 0x0, 0x0, 0x0, 0x0, 0x0
.long 0x0, 0x0, 0x0, 0x0, 0x0, 0x0, 0x0, 0x0
.long 0x0, 0x0, 0x0, 0x0, 0x0, 0x0, 0x0, 0x0
.long 0x0, 0x0, 0x0, 0x0, 0x0, 0x0, 0x0, 0x0
.long 0x0, 0x0, 0x0, 0x0, 0x0, 0x0, 0x0, 0x0
.long 0x0, 0x0, 0x0, 0x0, 0x0, 0x0, 0x0, 0x0
.long 0x0, 0x0, 0x0, 0x0, 0x0, 0x0, 0x0, 0x0
.long 0x0, 0x0, 0x0, 0x0, 0x0, 0x0, 0x0, 0x0
.long 0x0, 0x0, 0xffffffff, 0x0, 0x0, 0x0, 0xffff0000, 0xffff
.long 0x0, 0x0, 0x0, 0xffffffff, 0x0, 0x0, 0x0, 0xffff0000
.long 0x0, 0x0, 0x0, 0x0, 0x0, 0x0, 0x0, 0x0
.long 0x0, 0x0, 0x0, 0x0, 0x0, 0x0, 0x0, 0x0
.long 0x0, 0x0, 0x0, 0x0, 0x0, 0x0, 0x0, 0x0
.long 0x0, 0x0, 0x0, 0x0, 0x0, 0x0, 0x0, 0x0
.long 0x0, 0x0, 0x0, 0x0, 0x0, 0x0, 0x0, 0x0
.long 0x0, 0x0, 0x0, 0x0, 0x0, 0x0, 0x0, 0x0
.long 0x0, 0x0, 0x0, 0x0, 0x0, 0x0, 0x0, 0x0
.long 0x0, 0x0, 0x0, 0x0, 0xffff, 0x0, 0x0, 0x0
.long 0xffffffff, 0x0, 0x0, 0x0, 0xffff0000, 0xffff, 0x0, 0x0
.long 0x0, 0xffffffff, 0x0, 0x0, 0x0, 0xffff0000, 0xffff, 0x0
.long 0x0, 0x0, 0xffffffff, 0x0, 0x0, 0x0, 0xffff0000, 0xffff
.long 0x0, 0x0, 0x0, 0xffffffff, 0x0, 0x0, 0x0, 0xffff0000
.long 0x0, 0x0, 0x0, 0x0, 0x0, 0x0, 0x0, 0x0
.long 0x0, 0x0, 0x0, 0x0, 0x0, 0x0, 0x0, 0x0
.long 0x0, 0x0, 0x0, 0x0, 0x0, 0x0, 0x0, 0x0
.long 0x0, 0x0, 0x0, 0x0, 0x0, 0x0, 0x0, 0x0
.long 0x0, 0x0, 0x0, 0x0, 0x0, 0x0, 0x0, 0x0
.long 0x0, 0x0, 0x0, 0x0, 0x0, 0x0, 0x0, 0x0
.long 0x0, 0x0, 0x0, 0x0, 0x0, 0x0, 0x0, 0x0
.long 0x0, 0x0, 0x0, 0x0, 0xffff, 0x0, 0x0, 0x0
.long 0xffffffff, 0x0, 0x0, 0x0, 0xffff0000, 0xffff, 0x0, 0x0
.long 0x0, 0xffffffff, 0x0, 0x0, 0x0, 0xffff0000, 0xffff, 0x0
.long 0x878, 0x438, 0x230, 0x238, 0x868, 0x428, 0x220, 0x228
.long 0x858, 0x418, 0x210, 0x218, 0x848, 0x408, 0x200, 0x208
.long 0x838, 0x3f8, 0x1f0, 0x1f8, 0x828, 0x3e8, 0x1e0, 0x1e8
.long 0x818, 0x3d8, 0x1d0, 0x1d8, 0x808, 0x3c8, 0x1c0, 0x1c8
.long 0x7f8, 0x3b8, 0x1b0, 0x1b8, 0x7e8, 0x3a8, 0x1a0, 0x1a8
.long 0x7d8, 0x398, 0x190, 0x198, 0x7c8, 0x388, 0x180, 0x188
.long 0x7b8, 0x378, 0x170, 0x178, 0x7a8, 0x368, 0x160, 0x168
.long 0x798, 0x358, 0x150, 0x158, 0x788, 0x348, 0x140, 0x148
.long 0x778, 0x338, 0x130, 0x138, 0x768, 0x328, 0x120, 0x128
.long 0x758, 0x318, 0x110, 0x118, 0x748, 0x308, 0x100, 0x108
.long 0x738, 0x2f8, 0xf0, 0xf8, 0x728, 0x2e8, 0xe0, 0xe8
.long 0x718, 0x2d8, 0xd0, 0xd8, 0x708, 0x2c8, 0xc0, 0xc8
.long 0x6f8, 0x2b8, 0xb0, 0xb8, 0x6e8, 0x2a8, 0xa0, 0xa8
.long 0x6d8, 0x298, 0x90, 0x98, 0x6c8, 0x288, 0x80, 0x88
.long 0x6b8, 0x278, 0x70, 0x78, 0x6a8, 0x268, 0x60, 0x68
.long 0x698, 0x258, 0x50, 0x58, 0x688, 0x248, 0x40, 0x48
.long 0x870, 0x430, 0x90c, 0x94c, 0x860, 0x420, 0x9cc, 0xa0c
.long 0x850, 0x410, 0x908, 0x948, 0x840, 0x400, 0x9c8, 0xa08
.long 0x830, 0x3f0, 0x904, 0x944, 0x820, 0x3e0, 0x9c4, 0xa04
.long 0x810, 0x3d0, 0x900, 0x940, 0x800, 0x3c0, 0x9c0, 0xa00
.long 0x7f0, 0x3b0, 0x8fc, 0x93c, 0x7e0, 0x3a0, 0x9bc, 0x9fc
.long 0x7d0, 0x390, 0x8f8, 0x938, 0x7c0, 0x380, 0x9b8, 0x9f8
.long 0x7b0, 0x370, 0x8f4, 0x934, 0x7a0, 0x360, 0x9b4, 0x9f4
.long 0x790, 0x350, 0x8f0, 0x930, 0x780, 0x340, 0x9b0, 0x9f0
.long 0x770, 0x330, 0x8ec, 0x92c, 0x760, 0x320, 0x9ac, 0x9ec
.long 0x750, 0x310, 0x8e8, 0x928, 0x740, 0x300, 0x9a8, 0x9e8
.long 0x730, 0x2f0, 0x8e4, 0x924, 0x720, 0x2e0, 0x9a4, 0x9e4
.long 0x710, 0x2d0, 0x8e0, 0x920, 0x700, 0x2c0, 0x9a0, 0x9e0
.long 0x6f0, 0x2b0, 0x8dc, 0x91c, 0x6e0, 0x2a0, 0x99c, 0x9dc
.long 0x6d0, 0x290, 0x8d8, 0x918, 0x6c0, 0x280, 0x998, 0x9d8
.long 0x6b0, 0x270, 0x8d4, 0x914, 0x6a0, 0x260, 0x994, 0x9d4
.long 0x690, 0x250, 0x8d0, 0x910, 0x680, 0x240, 0x990, 0x9d0
.long 0x22c, 0x670, 0xb90, 0x23e, 0x21c, 0x660, 0xb90, 0xb90
.long 0x20c, 0x650, 0xb90, 0xb90, 0x1fc, 0x640, 0xb90, 0xb90
.long 0x1ec, 0x630, 0xb90, 0xb90, 0x1dc, 0x620, 0xb90, 0xb90
.long 0x1cc, 0x610, 0xb90, 0xb90, 0x1bc, 0x600, 0xb90, 0xb90
.long 0x1ac, 0x5f0, 0xb90, 0xb90, 0x19c, 0x5e0, 0xb90, 0xb90
.long 0x18c, 0x5d0, 0xb90, 0xb90, 0x17c, 0x5c0, 0xb90, 0xb90
.long 0x16c, 0x5b0, 0xb90, 0xb90, 0x15c, 0x5a0, 0xb90, 0xb90
.long 0x14c, 0x590, 0xb90, 0xb90, 0x13c, 0x580, 0xb90, 0xb90
.long 0x12c, 0x570, 0xb90, 0xb90, 0x11c, 0x560, 0xb90, 0xb90
.long 0x10c, 0x550, 0xb90, 0xb90, 0xfc, 0x540, 0xb90, 0xb90
.long 0xec, 0x530, 0xb90, 0xb90, 0xdc, 0x520, 0xb90, 0xb90
.long 0xcc, 0x510, 0xb90, 0xb90, 0xbc, 0x500, 0xb90, 0xb90
.long 0xac, 0x4f0, 0xb90, 0xb90, 0x9c, 0x4e0, 0xb90, 0xb90
.long 0x8c, 0x4d0, 0xb90, 0xb90, 0x7c, 0x4c0, 0xb90, 0xb90
.long 0x6c, 0x4b0, 0xb90, 0xb90, 0x5c, 0x4a0, 0xb90, 0xb90
.long 0x4c, 0x490, 0xb90, 0xb90, 0x3c, 0x480, 0x47c, 0xb90
.long 0xb90, 0xb90, 0xb90, 0xb4c, 0xb90, 0xb90, 0xb90, 0xb4e
.long 0xb90, 0xb90, 0xb90, 0xb48, 0xb90, 0xb90, 0xb90, 0xb4a
.long 0xb90, 0xb90, 0xb90, 0xb44, 0xb90, 0xb90, 0xb90, 0xb46
.long 0xb90, 0xb90, 0xb90, 0xb40, 0xb90, 0xb90, 0xb90, 0xb42
.long 0xb90, 0xb90, 0xb90, 0xb3c, 0xb90, 0xb90, 0xb90, 0xb3e
.long 0xb90, 0xb90, 0xb90, 0xb38, 0xb90, 0xb90, 0xb90, 0xb3a
.long 0xb90, 0xb90, 0xb90, 0xb34, 0xb90, 0xb90, 0xb90, 0xb36
.long 0xb90, 0xb90, 0xb90, 0xb30, 0xb90, 0xb90, 0xb90, 0xb32
.long 0xb90, 0xb90, 0xb90, 0xb2c, 0xb90, 0xb90, 0xb90, 0xb2e
.long 0xb90, 0xb90, 0xb90, 0xb28, 0xb90, 0xb90, 0xb90, 0xb2a
.long 0xb90, 0xb90, 0xb90, 0xb24, 0xb90, 0xb90, 0xb90, 0xb26
.long 0xb90, 0xb90, 0xb90, 0xb20, 0xb90, 0xb90, 0xb90, 0xb22
.long 0xb90, 0xb90, 0xb90, 0xb1c, 0xb90, 0xb90, 0xb90, 0xb1e
.long 0xb90, 0xb90, 0xb90, 0xb18, 0xb90, 0xb90, 0xb90, 0xb1a
.long 0xb90, 0xb90, 0xb90, 0xb14, 0xb90, 0xb90, 0xb90, 0xb16
.long 0xb90, 0xb90, 0xb90, 0xb10, 0xb90, 0xb90, 0xb90, 0xb12
.long 0x23c, 0x880, 0xb90, 0x210, 0xb90, 0xb90, 0xb90, 0x420
.long 0xb90, 0xb90, 0xb90, 0x630, 0xb90, 0xb90, 0xb90, 0x840
.long 0xb90, 0xb90, 0xb90, 0xa50, 0xb90, 0xb90, 0xb90, 0xc60
.long 0xb90, 0xb90, 0xb90, 0xe70, 0xb90, 0xb90, 0xb90, 0x1080
.long 0xb90, 0xb90, 0xb90, 0x14a0, 0xb90, 0xb90, 0xb90, 0x16b0
.long 0xb90, 0xb90, 0xb90, 0x18c0, 0xb90, 0xb90, 0xb90, 0x1ad0
.long 0xb90, 0xb90, 0xb90, 0x1ce0, 0xb90, 0xb90, 0xb90, 0x1ef0
.long 0xb90, 0xb90, 0xb90, 0x2100, 0xb90, 0xb90, 0xb90, 0x2310
.long 0xb90, 0xb90, 0xb90, 0x1290, 0xb90, 0xb90, 0xb90, 0x1290
.long 0xb90, 0xb90, 0xb90, 0x0, 0xb90, 0xb90, 0xb90, 0x1ad0
.long 0xb90, 0xb90, 0xb90, 0x2520, 0xb90, 0xb90, 0xb90, 0x2730
.long 0xb90, 0xb90, 0xb90, 0x2940, 0xb90, 0xb90, 0xb90, 0x2b50
.long 0xb90, 0xb90, 0xb90, 0x0, 0xb90, 0xb90, 0xb90, 0x210
.long 0xb90, 0xb90, 0xb90, 0x420, 0xb90, 0xb90, 0xb90, 0x630
.long 0xb90, 0xb90, 0xb90, 0x840, 0xb90, 0xb90, 0xb90, 0xa50
.long 0xb90, 0xb90, 0xb90, 0xc60, 0xb90, 0xb90, 0x3a, 0xe70
.long 0xb0c, 0xacc, 0xa8c, 0x220, 0xb0e, 0xace, 0xa8e, 0x430
.long 0xb08, 0xac8, 0xa88, 0x640, 0xb0a, 0xaca, 0xa8a, 0x850
.long 0xb04, 0xac4, 0xa84, 0xa60, 0xb06, 0xac6, 0xa86, 0xc70
.long 0xb00, 0xac0, 0xa80, 0xe80, 0xb02, 0xac2, 0xa82, 0x1090
.long 0xafc, 0xabc, 0xa7c, 0x14b0, 0xafe, 0xabe, 0xa7e, 0x16c0
.long 0xaf8, 0xab8, 0xa78, 0x18d0, 0xafa, 0xaba, 0xa7a, 0x1ae0
.long 0xaf4, 0xab4, 0xa74, 0x1cf0, 0xaf6, 0xab6, 0xa76, 0x1f00
.long 0xaf0, 0xab0, 0xa70, 0x2110, 0xaf2, 0xab2, 0xa72, 0x2320
.long 0xaec, 0xaac, 0xa6c, 0x12a0, 0xaee, 0xaae, 0xa6e, 0x12a0
.long 0xae8, 0xaa8, 0xa68, 0x10, 0xaea, 0xaaa, 0xa6a, 0x1ae0
.long 0xae4, 0xaa4, 0xa64, 0x2530, 0xae6, 0xaa6, 0xa66, 0x2740
.long 0xae0, 0xaa0, 0xa60, 0x2950, 0xae2, 0xaa2, 0xa62, 0x2b60
.long 0xadc, 0xa9c, 0xa5c, 0x10, 0xade, 0xa9e, 0xa5e, 0x220
.long 0xad8, 0xa98, 0xa58, 0x430, 0xada, 0xa9a, 0xa5a, 0x640
.long 0xad4, 0xa94, 0xa54, 0x850, 0xad6, 0xa96, 0xa56, 0xa60
.long 0xad0, 0xa90, 0xa50, 0xc70, 0xad2, 0xa92, 0xa52, 0xe80
TBLEND:
.size TBL, .-TBL
.section .rodata,"a"
.p2align 6
.amdhsa_kernel sequential_preLN__ssm_conv_s4d__moe_arch_mod__prompt_kernel
  .amdhsa_next_free_vgpr 256
  .amdhsa_next_free_sgpr 102
  .amdhsa_accum_offset 256
  .amdhsa_group_segment_fixed_size 0
  .amdhsa_kernarg_size 120
  .amdhsa_user_sgpr_count 2
  .amdhsa_user_sgpr_kernarg_segment_ptr 1
  .amdhsa_system_sgpr_workgroup_id_x 1
.end_amdhsa_kernel
```

```asm
; @launch grid=(248,1,1) block=(512,1,1) lds=163840
.amdgcn_target "amdgcn-amd-amdhsa--gfx950"
.text
.globl sequential_preLN__ssm_conv_s4d__moe_arch_mod__prompt_kernel
.p2align 8
.type sequential_preLN__ssm_conv_s4d__moe_arch_mod__prompt_kernel,@function
sequential_preLN__ssm_conv_s4d__moe_arch_mod__prompt_kernel:
    s_cmp_ge_u32 s2, 248
    s_cbranch_scc1 END
    s_load_dwordx16 s[4:19], s[0:1], 0
    s_load_dwordx8 s[20:27], s[0:1], 64
    s_load_dwordx2 s[28:29], s[0:1], 96
    s_load_dwordx2 s[30:31], s[0:1], 112
    s_getpc_b64 s[42:43]
PC0:
    v_and_b32 v1, 63, v0
    v_lshrrev_b32 v14, 6, v0
    v_lshlrev_b32 v15, 7, v0
    v_readfirstlane_b32 s3, v14
    s_add_u32 s44, s42, TBL-PC0
    s_addc_u32 s45, s43, 0
    v_lshlrev_b32 v2, 4, v1
    v_lshlrev_b32 v3, 4, v0
    s_sub_u32 s50, s2, 144
    s_cmp_lt_u32 s50, 72
    s_cbranch_scc1 FROLE
    s_sub_u32 s49, s2, 120
    s_cmp_lt_u32 s2, 144
    s_cselect_b32 s49, 255, s49
    s_cmp_lt_u32 s2, 96
    s_cselect_b32 s49, s2, s49
    s_lshl_b32 s46, s49, 4
    s_add_u32 s46, s46, s3
    s_mul_i32 s50, s46, 1152
    v_and_b32 v13, 31, v1
    v_lshrrev_b32 v15, 5, v1
    v_mul_u32_u24 v14, 9216, v15
    v_add_u32 v14, s50, v14
    v_lshlrev_b32 v12, 4, v13
    v_lshlrev_b32 v13, 2, v13
    v_add_u32 v4, v12, v14
    v_add_u32 v5, v13, v14
    s_and_b32 s51, s3, 3
    s_lshl_b32 s52, s2, 2
    s_add_u32 s52, s52, s51
    s_lshr_b32 s46, s3, 2
    s_lshl_b32 s53, s52, 8
    s_lshl_b32 s54, s46, 7
    s_add_u32 s53, s53, s54
    v_lshl_add_u32 v34, v1, 1, s53
    v_xor_b32 v35, 128, v34
    v_mov_b32 v28, 0
    v_mov_b32 v29, 0
    v_mov_b32 v30, 0
    v_mov_b32 v31, 0
    v_mov_b32 v32, 0
    v_mov_b32 v33, 0
    s_lshl_b32 s54, s2, 3
    s_waitcnt lgkmcnt(0)
    s_cmp_ge_u32 s2, 144
    s_cbranch_scc1 C_NOP
    s_load_dwordx2 s[56:57], s[14:15], s54
    global_load_short_d16_hi v28, v34, s[6:7] nt
    global_load_short_d16_hi v29, v34, s[8:9] nt
    global_load_short_d16_hi v30, v34, s[10:11] nt
    global_load_short_d16_hi v31, v34, s[12:13] nt
    global_load_short_d16_hi v32, v35, s[10:11] nt
    global_load_short_d16_hi v33, v35, s[12:13] nt
C_NOP:
    s_cmp_ge_u32 s49, 128
    s_cbranch_scc1 C_NOX
    global_load_dwordx4 v[16:19], v4, s[4:5] nt
    global_load_dwordx4 v[20:23], v4, s[4:5] offset:512 nt
    global_load_dword v24, v5, s[4:5] offset:1024 nt
C_NOX:
    s_load_dword s40, s[30:31], 0
    s_mov_b32 s32, s30
    s_and_b32 s33, s31, 0xffff
    s_mov_b32 s34, 0x10000000
    s_mov_b32 s35, 0x00020000
    v_mov_b32 v36, 0
    v_mov_b32 v37, 0
    v_mov_b32 v38, 0
    v_mov_b32 v39, 0
    v_add_u32 v14, 151680, v3
    ds_write_b128 v14, v[36:39]
    v_cmp_gt_u32 vcc, 240, v0
    s_and_saveexec_b64 s[58:59], vcc
    ds_write_b128 v14, v[36:39] offset:8192
    s_mov_b64 exec, -1
    s_mul_i32 s48, s51, 4640
    s_add_u32 s48, s48, 114048
    v_add_u32 v14, s48, v12
    ds_write_b128 v14, v[36:39]
    v_mov_b32 v6, 0x3f80
    v_mov_b32 v7, 1.0
    v_mov_b32 v8, 0x3f803f80
    v_mov_b32 v9, 0xfff8fff8
    v_mov_b32 v11, 0x40004
    v_and_b32 v14, 15, v1
    v_lshrrev_b32 v15, 4, v1
    v_lshlrev_b32 v248, 5, v14
    v_lshl_add_u32 v248, v15, 4, v248
    v_add_u32 v248, s48, v248
    s_mul_i32 s48, s51, 6144
    s_add_u32 s48, s48, 20480
    v_add_u32 v249, s48, v2
    s_mul_i32 s62, s51, 2976
    s_add_u32 s62, s62, 151680
    v_lshlrev_b32 v250, 3, v15
    v_sub_u32 v250, v250, v14
    v_add_u32 v250, 15, v250
    v_and_b32 v40, 1, v250
    v_mul_u32_u24 v40, 1090, v40
    v_lshl_add_u32 v250, v250, 1, v40
    v_add_u32 v250, s62, v250
    s_cmp_ge_u32 s3, 4
    s_cbranch_scc1 C_H1
    v_lshlrev_b32 v251, 3, v14
    v_lshl_add_u32 v251, v15, 7, v251
    s_mul_i32 s48, s51, 4128
    v_add_u32 v251, s48, v251
    v_add_u32 v252, 576, v250
    v_add_u32 v250, 64, v250
    v_and_b32 v40, 31, v1
    v_mul_u32_u24 v40, 528, v40
    v_lshrrev_b32 v41, 5, v1
    v_lshl_add_u32 v40, v41, 4, v40
    s_mul_i32 s48, s51, 28512
    v_add_u32 v253, s48, v40
    s_branch C_S2
C_H1:
    v_lshlrev_b32 v251, 2, v15
    v_sub_u32 v251, v251, v14
    v_lshlrev_b32 v251, 2, v251
    s_add_u32 s48, s62, 2252
    v_add_u32 v251, s48, v251
    v_bfe_u32 v40, v1, 2, 2
    v_mul_u32_u24 v40, 4128, v40
    v_and_b32 v41, 1, v1
    v_lshl_add_u32 v40, v41, 7, v40
    v_lshl_add_u32 v40, v15, 4, v40
    v_and_b32 v41, 2, v1
    v_lshl_add_u32 v40, v41, 2, v40
    s_and_b32 s48, s3, 1
    s_lshl_b32 s48, s48, 6
    v_add_u32 v252, s48, v40
    v_lshrrev_b32 v40, 3, v1
    v_mul_u32_u24 v40, 18432, v40
    v_and_b32 v41, 7, v1
    v_lshl_add_u32 v253, v41, 4, v40
    s_and_b32 s48, s3, 1
    s_mul_i32 s48, s48, 147456
    s_lshl_b32 s63, s2, 7
    s_add_u32 s63, s63, s48
    s_add_u32 s63, s63, 4194304
    v_and_b32 v40, 3, v1
    v_mul_u32_u24 v40, 4640, v40
    v_lshrrev_b32 v41, 2, v1
    v_lshl_add_u32 v40, v41, 4, v40
    s_lshl_b32 s48, s51, 10
    s_add_u32 s48, s48, 114560
    v_add_u32 v254, s48, v40
C_S2:
    s_cmp_ge_u32 s3, 4
    s_cselect_b32 s46, 4, 7
    s_lshl_b32 s46, s46, 10
    v_add_u32 v27, s46, v2
    s_lshr_b32 s46, s3, 2
    s_lshl_b32 s46, s46, 8
    s_mul_i32 s60, s51, 28512
    s_add_u32 s46, s60, s46
    v_lshl_add_u32 v40, v1, 2, s46
    v_add_u32 v41, 528, v40
    v_add_u32 v42, 1056, v40
    v_add_u32 v43, 1584, v40
    v_add_u32 v44, 2112, v40
    v_add_u32 v45, 2640, v40
    v_add_u32 v46, 3168, v40
    v_add_u32 v47, 3696, v40
    v_add_u32 v48, 4224, v40
    v_add_u32 v49, 4752, v40
    v_add_u32 v50, 5280, v40
    v_add_u32 v51, 5808, v40
    v_add_u32 v52, 6336, v40
    v_add_u32 v53, 6864, v40
    v_add_u32 v54, 7392, v40
    v_add_u32 v55, 7920, v40
    v_lshrrev_b32 v15, 5, v1
    v_mul_u32_u24 v15, 9600, v15
    s_mul_i32 s46, s3, 1184
    s_add_u32 s46, s46, 132608
    v_add_u32 v15, s46, v15
    v_add_u32 v25, v12, v15
    v_add_u32 v26, v13, v15
    v_and_b32 v14, 1, v1
    v_mul_u32_u24 v14, 9600, v14
    v_bfe_u32 v15, v1, 2, 2
    v_mul_u32_u24 v15, 1184, v15
    v_add_u32 v14, v14, v15
    v_lshrrev_b32 v15, 4, v1
    v_lshl_add_u32 v14, v15, 4, v14
    v_and_b32 v15, 2, v1
    v_lshl_add_u32 v14, v15, 2, v14
    s_lshl_b32 s46, s3, 6
    s_add_u32 s46, s46, 132608
    v_add_u32 v36, s46, v14
    v_lshrrev_b32 v14, 3, v0
    v_and_b32 v15, 7, v0
    v_lshlrev_b32 v15, 4, v15
    v_lshl_add_u32 v37, v14, 14, v15
    s_lshl_b32 s55, s49, 7
    s_add_u32 s55, s55, 1048576
    s_add_u32 s48, s55, 1048576
    s_add_u32 s50, s55, 2097152
    v_mov_b32 v120, 0
    v_mov_b32 v121, 0
    v_lshlrev_b32 v38, 14, v1
    s_lshl_b32 s53, s49, 7
    s_add_u32 s53, s53, 9568256
    s_waitcnt lgkmcnt(0)
    s_add_u32 s40, s40, 1
    s_and_b32 s41, s40, 7
    s_bfe_u32 s46, s40, 0x30003
    s_lshl_b32 s46, s46, 16
    s_or_b32 s41, s41, s46
    v_mov_b32 v10, s41
    s_cmp_ge_u32 s2, 144
    s_cbranch_scc1 C_LN1
    s_cmp_lt_u32 s49, 128
    s_cbranch_scc1 C_K0
    s_waitcnt vmcnt(0)
C_K0:
    s_waitcnt vmcnt(3)
    s_bitcmp1_b32 s51, 1
    s_cselect_b32 s56, s57, s56
    s_lshl_b32 s57, s56, 16
    s_and_b32 s56, s56, 0xffff0000
    s_bitcmp1_b32 s51, 0
    s_cselect_b32 s56, s56, s57
    v_mov_b32 v60, 0x3fb8aa3b
    v_mul_f32 v62, 0x3fb8aa3b, v28
    v_mul_f32 v60, s56, v60
    v_exp_f32 v62, v62
    v_exp_f32 v60, v60
    v_add_f32 v64, |v30|, |v31|
    v_add_f32 v65, |v32|, |v33|
    v_cvt_pk_bf16_f32 v62, 0, v62
    v_cvt_pk_bf16_f32 v60, 0, v60
    v_add_f32 v64, v64, v65
    v_mul_f32 v62, v62, v60
    v_mul_f32 v63, v29, v60
    v_mul_f32 v62, 0xbfb8aa3b, v62
    v_mul_f32 v63, 0.15915494, v63
    v_mul_f32 v104, 0x41000000, v62
    v_add_f32_dpp v64, v64, v64 row_ror:8 row_mask:0xf bank_mask:0xf
    v_mul_f32 v105, 0x41000000, v63
    v_exp_f32 v104, v104
    v_fract_f32 v105, v105
    v_add_f32_dpp v64, v64, v64 row_ror:4 row_mask:0xf bank_mask:0xf
    v_cos_f32 v72, v105
    v_sin_f32 v73, v105
    v_add_f32_dpp v64, v64, v64 row_ror:2 row_mask:0xf bank_mask:0xf
    v_pk_mul_f32 v[72:73], v[72:73], v[104:105] op_sel_hi:[1,0] neg_hi:[1,0]
    v_exp_f32 v106, v62
    v_add_f32_dpp v64, v64, v64 row_ror:1 row_mask:0xf bank_mask:0xf
    v_fract_f32 v107, v63
    v_cos_f32 v66, v107
    v_sin_f32 v67, v107
    v_mov_b32 v65, v64
    v_pk_mul_f32 v[66:67], v[66:67], v[106:107] op_sel_hi:[1,0]
    v_mul_f32 v108, 0x43800000, v62
    v_permlane16_swap_b32 v64, v65
    v_mul_f32 v109, 0x43800000, v63
    v_exp_f32 v108, v108
    v_add_f32 v64, v64, v65
    v_fract_f32 v109, v109
    v_cos_f32 v68, v109
    v_sin_f32 v69, v109
    v_mov_b32 v65, v64
    v_pk_mul_f32 v[68:69], v[68:69], v[108:109] op_sel_hi:[1,0]
    v_mov_b32 v162, 0x3c00
    v_pk_mul_f32 v[74:75], v[72:73], v[72:73] op_sel_hi:[1,0]
    v_permlane32_swap_b32 v64, v65
    v_pk_fma_f32 v[74:75], v[72:73], v[72:73], v[74:75] op_sel:[1,1,0] op_sel_hi:[0,1,1] neg_lo:[1,0,0]
    s_cmp_lt_u32 s49, 128
    s_cbranch_scc1 C_LN1
    s_cmp_ge_u32 s2, 144
    s_cbranch_scc1 LL1
    s_cmp_ge_u32 s3, 4
    s_cbranch_scc1 LL2
    global_load_dwordx4 v[184:187], v27, s[44:45] offset:0
    global_load_dwordx4 v[188:191], v27, s[44:45] offset:1024
    global_load_dwordx4 v[192:195], v27, s[44:45] offset:2048
LL1:
    global_load_dwordx4 v[208:211], v12, s[16:17]
    global_load_dwordx4 v[212:215], v12, s[16:17] offset:512
    global_load_dword v216, v13, s[16:17] offset:1024
    global_load_dwordx4 v[218:221], v12, s[20:21]
    global_load_dwordx4 v[222:225], v12, s[20:21] offset:512
    global_load_dword v226, v13, s[20:21] offset:1024
    s_branch LL3
LL2:
    global_load_dwordx4 v[168:171], v27, s[44:45] offset:-4096
    global_load_dwordx4 v[172:175], v27, s[44:45] offset:-3072
    global_load_dwordx4 v[176:179], v27, s[44:45] offset:-2048
    global_load_dwordx4 v[180:183], v27, s[44:45] offset:-1024
    global_load_dwordx4 v[184:187], v27, s[44:45] offset:0
    global_load_dwordx4 v[188:191], v27, s[44:45] offset:1024
    global_load_dwordx4 v[192:195], v27, s[44:45] offset:2048
LL3:
    s_branch C_K1
C_LN1:
    s_waitcnt vmcnt(0)
    s_cmp_ge_u32 s2, 144
    s_cbranch_scc1 LL4
    s_cmp_ge_u32 s3, 4
    s_cbranch_scc1 LL5
    global_load_dwordx4 v[184:187], v27, s[44:45] offset:0
    global_load_dwordx4 v[188:191], v27, s[44:45] offset:1024
    global_load_dwordx4 v[192:195], v27, s[44:45] offset:2048
LL4:
    global_load_dwordx4 v[208:211], v12, s[16:17]
    global_load_dwordx4 v[212:215], v12, s[16:17] offset:512
    global_load_dword v216, v13, s[16:17] offset:1024
    global_load_dwordx4 v[218:221], v12, s[20:21]
    global_load_dwordx4 v[222:225], v12, s[20:21] offset:512
    global_load_dword v226, v13, s[20:21] offset:1024
    s_branch LL6
LL5:
    global_load_dwordx4 v[168:171], v27, s[44:45] offset:-4096
    global_load_dwordx4 v[172:175], v27, s[44:45] offset:-3072
    global_load_dwordx4 v[176:179], v27, s[44:45] offset:-2048
    global_load_dwordx4 v[180:183], v27, s[44:45] offset:-1024
    global_load_dwordx4 v[184:187], v27, s[44:45] offset:0
    global_load_dwordx4 v[188:191], v27, s[44:45] offset:1024
    global_load_dwordx4 v[192:195], v27, s[44:45] offset:2048
LL6:
    v_dot2c_f32_bf16 v120, v16, v8
    v_dot2c_f32_bf16 v121, v16, v16
    v_dot2c_f32_bf16 v120, v17, v8
    v_dot2c_f32_bf16 v121, v17, v17
    v_dot2c_f32_bf16 v120, v18, v8
    v_dot2c_f32_bf16 v121, v18, v18
    v_dot2c_f32_bf16 v120, v19, v8
    v_dot2c_f32_bf16 v121, v19, v19
    v_dot2c_f32_bf16 v120, v20, v8
    v_dot2c_f32_bf16 v121, v20, v20
    v_dot2c_f32_bf16 v120, v21, v8
    v_dot2c_f32_bf16 v121, v21, v21
    v_dot2c_f32_bf16 v120, v22, v8
    v_dot2c_f32_bf16 v121, v22, v22
    v_dot2c_f32_bf16 v120, v23, v8
    v_dot2c_f32_bf16 v121, v23, v23
    v_dot2c_f32_bf16 v120, v24, v8
    v_dot2c_f32_bf16 v121, v24, v24
    s_nop 2
    v_permlane16_swap_b32 v120, v121
    v_add_f32 v120, v120, v121
    s_nop 1
    v_add_f32_dpp v120, v120, v120 row_ror:8 row_mask:0xf bank_mask:0xf
    s_nop 1
    v_add_f32_dpp v120, v120, v120 row_ror:4 row_mask:0xf bank_mask:0xf
    s_nop 1
    v_add_f32_dpp v120, v120, v120 row_ror:2 row_mask:0xf bank_mask:0xf
    s_nop 1
    v_add_f32_dpp v120, v120, v120 row_ror:1 row_mask:0xf bank_mask:0xf
    v_mov_b32 v121, v120
    s_nop 1
    v_permlane16_swap_b32 v120, v121
    v_mul_f32 v120, 0x3ae38e39, v120
    v_mul_f32 v121, 0x3ae38e39, v121
    v_fma_f32 v121, -v120, v120, v121
    v_cvt_pk_bf16_f32 v122, 0, v120
    v_max_f32 v121, 0, v121
    v_cvt_pk_bf16_f32 v121, 0, v121
    v_add_f32 v121, 0x3727c5ac, v121
    v_cvt_pk_bf16_f32 v121, 0, v121
    v_sqrt_f32 v121, v121
    s_nop 0
    v_cvt_pk_bf16_f32 v121, 0, v121
    v_rcp_f32 v124, v121
    v_dot2_f32_bf16 v126, v16, v6, v122 neg_lo:[0,0,1]
    v_dot2_f32_bf16 v127, v16, v7, v122 neg_lo:[0,0,1]
    v_dot2_f32_bf16 v128, v17, v6, v122 neg_lo:[0,0,1]
    v_dot2_f32_bf16 v129, v17, v7, v122 neg_lo:[0,0,1]
    v_dot2_f32_bf16 v130, v18, v6, v122 neg_lo:[0,0,1]
    v_dot2_f32_bf16 v131, v18, v7, v122 neg_lo:[0,0,1]
    v_dot2_f32_bf16 v132, v19, v6, v122 neg_lo:[0,0,1]
    v_dot2_f32_bf16 v133, v19, v7, v122 neg_lo:[0,0,1]
    v_dot2_f32_bf16 v134, v20, v6, v122 neg_lo:[0,0,1]
    v_dot2_f32_bf16 v135, v20, v7, v122 neg_lo:[0,0,1]
    v_dot2_f32_bf16 v136, v21, v6, v122 neg_lo:[0,0,1]
    v_dot2_f32_bf16 v137, v21, v7, v122 neg_lo:[0,0,1]
    v_dot2_f32_bf16 v138, v22, v6, v122 neg_lo:[0,0,1]
    v_dot2_f32_bf16 v139, v22, v7, v122 neg_lo:[0,0,1]
    v_dot2_f32_bf16 v140, v23, v6, v122 neg_lo:[0,0,1]
    v_dot2_f32_bf16 v141, v23, v7, v122 neg_lo:[0,0,1]
    v_dot2_f32_bf16 v142, v24, v6, v122 neg_lo:[0,0,1]
    v_dot2_f32_bf16 v143, v24, v7, v122 neg_lo:[0,0,1]
    s_cmp_lg_u32 s3, 3
    s_cbranch_scc1 UHS7
    v_mov_b32 v39, s40
    s_mov_b64 exec, 0xff
    buffer_store_dword v39, v38, s[32:35], s53 offen sc1
    s_mov_b64 exec, -1
UHS7:
    v_cvt_pk_bf16_f32 v126, 0, v126
    v_cvt_pk_bf16_f32 v127, 0, v127
    v_cvt_pk_bf16_f32 v128, 0, v128
    v_cvt_pk_bf16_f32 v129, 0, v129
    v_cvt_pk_bf16_f32 v130, 0, v130
    v_cvt_pk_bf16_f32 v131, 0, v131
    v_cvt_pk_bf16_f32 v132, 0, v132
    v_cvt_pk_bf16_f32 v133, 0, v133
    v_cvt_pk_bf16_f32 v134, 0, v134
    v_cvt_pk_bf16_f32 v135, 0, v135
    v_cvt_pk_bf16_f32 v136, 0, v136
    v_cvt_pk_bf16_f32 v137, 0, v137
    v_cvt_pk_bf16_f32 v138, 0, v138
    v_cvt_pk_bf16_f32 v139, 0, v139
    v_cvt_pk_bf16_f32 v140, 0, v140
    v_cvt_pk_bf16_f32 v141, 0, v141
    v_cvt_pk_bf16_f32 v142, 0, v142
    v_cvt_pk_bf16_f32 v143, 0, v143
    v_pk_mul_f32 v[126:127], v[126:127], v[124:125] op_sel_hi:[1,0]
    v_pk_mul_f32 v[128:129], v[128:129], v[124:125] op_sel_hi:[1,0]
    v_pk_mul_f32 v[130:131], v[130:131], v[124:125] op_sel_hi:[1,0]
    v_pk_mul_f32 v[132:133], v[132:133], v[124:125] op_sel_hi:[1,0]
    v_pk_mul_f32 v[134:135], v[134:135], v[124:125] op_sel_hi:[1,0]
    v_pk_mul_f32 v[136:137], v[136:137], v[124:125] op_sel_hi:[1,0]
    v_pk_mul_f32 v[138:139], v[138:139], v[124:125] op_sel_hi:[1,0]
    v_pk_mul_f32 v[140:141], v[140:141], v[124:125] op_sel_hi:[1,0]
    v_pk_mul_f32 v[142:143], v[142:143], v[124:125] op_sel_hi:[1,0]
    v_cvt_pkrtz_f16_f32 v144, v126, v127
    v_cvt_pkrtz_f16_f32 v145, v128, v129
    v_add_u32 v144, v11, v144
    v_cvt_pkrtz_f16_f32 v146, v130, v131
    v_add_u32 v145, v11, v145
    v_cvt_pkrtz_f16_f32 v147, v132, v133
    v_add_u32 v146, v11, v146
    v_cvt_pkrtz_f16_f32 v148, v134, v135
    v_add_u32 v147, v11, v147
    v_cvt_pkrtz_f16_f32 v149, v136, v137
    v_add_u32 v148, v11, v148
    ds_write_b128 v25, v[144:147]
    v_cvt_pkrtz_f16_f32 v150, v138, v139
    v_add_u32 v149, v11, v149
    v_cvt_pkrtz_f16_f32 v151, v140, v141
    v_add_u32 v150, v11, v150
    v_cvt_pkrtz_f16_f32 v152, v142, v143
    v_add_u32 v151, v11, v151
    v_add_u32 v152, v11, v152
    ds_write_b128 v25, v[148:151] offset:512
    ds_write_b32 v26, v152 offset:1024
    s_waitcnt lgkmcnt(0)
    s_barrier
    ds_read_b64_tr_b16 v[126:127], v36 offset:0
    ds_read_b64_tr_b16 v[128:129], v36 offset:4736
    ds_read_b64_tr_b16 v[130:131], v36 offset:512
    ds_read_b64_tr_b16 v[132:133], v36 offset:5248
    s_cmp_ge_u32 s3, 2
    s_cbranch_scc1 L1_A
    ds_read_b64_tr_b16 v[134:135], v36 offset:1024
    ds_read_b64_tr_b16 v[136:137], v36 offset:5760
    s_waitcnt lgkmcnt(0)
    v_and_or_b32 v134, v134, v9, v10
    v_and_or_b32 v135, v135, v9, v10
    v_and_or_b32 v136, v136, v9, v10
    v_and_or_b32 v137, v137, v9, v10
    buffer_store_dwordx4 v[134:137], v37, s[32:35], s50 offen sc1
L1_A:
    s_waitcnt lgkmcnt(2)
    v_and_or_b32 v126, v126, v9, v10
    v_and_or_b32 v127, v127, v9, v10
    v_and_or_b32 v128, v128, v9, v10
    v_and_or_b32 v129, v129, v9, v10
    buffer_store_dwordx4 v[126:129], v37, s[32:35], s55 offen sc1
    s_waitcnt lgkmcnt(0)
    v_and_or_b32 v130, v130, v9, v10
    v_and_or_b32 v131, v131, v9, v10
    v_and_or_b32 v132, v132, v9, v10
    v_and_or_b32 v133, v133, v9, v10
    buffer_store_dwordx4 v[130:133], v37, s[32:35], s48 offen sc1
    s_cmp_lt_u32 s2, 144
    s_cbranch_scc1 C_K1
    s_waitcnt vmcnt(0)
    s_branch RPREP
C_K1:
    s_lshl_b32 s48, s2, 14
    s_lshl_b32 s46, s51, 12
    s_add_u32 s48, s48, s46
    s_add_u32 s48, s48, 1048576
    s_getreg_b32 s50, hwreg(HW_REG_XCC_ID, 0, 3)
    s_lshl_b32 s50, s50, 14
    s_lshl_b32 s46, s51, 12
    s_add_u32 s50, s50, s46
    s_add_u32 s50, s50, 9568256
    v_lshlrev_b32 v59, 3, v12
    s_cmp_lt_u32 s3, 4
    s_cselect_b32 s59, 1, 0
    s_cmp_lt_u32 s3, 4
    s_cbranch_scc1 C_K5
    s_setprio 1
C_K5:
    v_pk_mul_f32 v[76:77], v[74:75], v[72:73] op_sel_hi:[1,0]
    v_pk_mul_f32 v[78:79], v[74:75], v[74:75] op_sel_hi:[1,0]
    v_cvt_pk_f16_f32 v163, v72, v73
    v_cvt_pk_f16_f32 v164, v74, v75
    v_add_f32 v64, v64, v65
    v_pk_fma_f32 v[76:77], v[74:75], v[72:73], v[76:77] op_sel:[1,1,0] op_sel_hi:[0,1,1] neg_lo:[1,0,0]
    v_pk_fma_f32 v[78:79], v[74:75], v[74:75], v[78:79] op_sel:[1,1,0] op_sel_hi:[0,1,1] neg_lo:[1,0,0]
    ds_write2st64_b32 v40, v163, v162 offset0:33 offset1:0
    v_pk_mul_f32 v[80:81], v[78:79], v[72:73] op_sel_hi:[1,0]
    v_pk_mul_f32 v[82:83], v[78:79], v[74:75] op_sel_hi:[1,0]
    v_cvt_pk_f16_f32 v165, v76, v77
    v_cvt_pk_f16_f32 v166, v78, v79
    v_mul_f32 v64, v64, v60
    v_pk_fma_f32 v[80:81], v[78:79], v[72:73], v[80:81] op_sel:[1,1,0] op_sel_hi:[0,1,1] neg_lo:[1,0,0]
    v_pk_fma_f32 v[82:83], v[78:79], v[74:75], v[82:83] op_sel:[1,1,0] op_sel_hi:[0,1,1] neg_lo:[1,0,0]
    ds_write2st64_b32 v41, v165, v164 offset0:33 offset1:0
    v_pk_mul_f32 v[84:85], v[78:79], v[76:77] op_sel_hi:[1,0]
    v_pk_mul_f32 v[86:87], v[78:79], v[78:79] op_sel_hi:[1,0]
    v_cvt_pk_f16_f32 v167, v80, v81
    v_cvt_pk_f16_f32 v56, v82, v83
    v_frexp_exp_i32_f32 v64, v64
    v_pk_fma_f32 v[84:85], v[78:79], v[76:77], v[84:85] op_sel:[1,1,0] op_sel_hi:[0,1,1] neg_lo:[1,0,0]
    v_pk_fma_f32 v[86:87], v[78:79], v[78:79], v[86:87] op_sel:[1,1,0] op_sel_hi:[0,1,1] neg_lo:[1,0,0]
    ds_write2st64_b32 v42, v167, v166 offset0:33 offset1:0
    v_pk_mul_f32 v[88:89], v[86:87], v[72:73] op_sel_hi:[1,0]
    v_pk_mul_f32 v[90:91], v[86:87], v[74:75] op_sel_hi:[1,0]
    v_cvt_pk_f16_f32 v57, v84, v85
    v_cvt_pk_f16_f32 v163, v86, v87
    v_max_i32 v64, -100, v64
    v_pk_fma_f32 v[88:89], v[86:87], v[72:73], v[88:89] op_sel:[1,1,0] op_sel_hi:[0,1,1] neg_lo:[1,0,0]
    v_pk_fma_f32 v[90:91], v[86:87], v[74:75], v[90:91] op_sel:[1,1,0] op_sel_hi:[0,1,1] neg_lo:[1,0,0]
    ds_write2st64_b32 v43, v57, v56 offset0:33 offset1:0
    v_pk_mul_f32 v[92:93], v[86:87], v[76:77] op_sel_hi:[1,0]
    v_pk_mul_f32 v[94:95], v[86:87], v[78:79] op_sel_hi:[1,0]
    v_cvt_pk_f16_f32 v162, v88, v89
    v_cvt_pk_f16_f32 v165, v90, v91
    v_min_i32 v64, 100, v64
    v_pk_fma_f32 v[92:93], v[86:87], v[76:77], v[92:93] op_sel:[1,1,0] op_sel_hi:[0,1,1] neg_lo:[1,0,0]
    v_pk_fma_f32 v[94:95], v[86:87], v[78:79], v[94:95] op_sel:[1,1,0] op_sel_hi:[0,1,1] neg_lo:[1,0,0]
    ds_write2st64_b32 v44, v162, v163 offset0:33 offset1:0
    v_pk_mul_f32 v[96:97], v[86:87], v[80:81] op_sel_hi:[1,0]
    v_pk_mul_f32 v[98:99], v[86:87], v[82:83] op_sel_hi:[1,0]
    v_cvt_pk_f16_f32 v164, v92, v93
    v_cvt_pk_f16_f32 v167, v94, v95
    v_sub_u32 v65, 0, v64
    v_pk_fma_f32 v[96:97], v[86:87], v[80:81], v[96:97] op_sel:[1,1,0] op_sel_hi:[0,1,1] neg_lo:[1,0,0]
    v_pk_fma_f32 v[98:99], v[86:87], v[82:83], v[98:99] op_sel:[1,1,0] op_sel_hi:[0,1,1] neg_lo:[1,0,0]
    ds_write2st64_b32 v45, v164, v165 offset0:33 offset1:0
    v_pk_mul_f32 v[100:101], v[86:87], v[84:85] op_sel_hi:[1,0]
    v_pk_mul_f32 v[102:103], v[86:87], v[86:87] op_sel_hi:[1,0]
    v_cvt_pk_f16_f32 v166, v96, v97
    v_cvt_pk_f16_f32 v57, v98, v99
    v_ldexp_f32 v60, v60, v65
    v_pk_fma_f32 v[100:101], v[86:87], v[84:85], v[100:101] op_sel:[1,1,0] op_sel_hi:[0,1,1] neg_lo:[1,0,0]
    v_pk_fma_f32 v[102:103], v[86:87], v[86:87], v[102:103] op_sel:[1,1,0] op_sel_hi:[0,1,1] neg_lo:[1,0,0]
    ds_write2st64_b32 v46, v166, v167 offset0:33 offset1:0
    v_pk_mul_f32 v[112:113], v[102:103], v[72:73] op_sel_hi:[1,0]
    v_pk_mul_f32 v[114:115], v[102:103], v[74:75] op_sel_hi:[1,0]
    v_cvt_pk_f16_f32 v56, v100, v101
    v_cvt_pk_f16_f32 v162, v102, v103
    v_pk_mul_f32 v[30:31], v[30:31], v[60:61] op_sel_hi:[1,0]
    v_pk_fma_f32 v[112:113], v[102:103], v[72:73], v[112:113] op_sel:[1,1,0] op_sel_hi:[0,1,1] neg_lo:[1,0,0]
    v_pk_fma_f32 v[114:115], v[102:103], v[74:75], v[114:115] op_sel:[1,1,0] op_sel_hi:[0,1,1] neg_lo:[1,0,0]
    ds_write2st64_b32 v47, v56, v57 offset0:33 offset1:0
    v_pk_mul_f32 v[116:117], v[102:103], v[76:77] op_sel_hi:[1,0]
    v_pk_mul_f32 v[110:111], v[102:103], v[78:79] op_sel_hi:[1,0]
    v_cvt_pk_f16_f32 v163, v112, v113
    v_cvt_pk_f16_f32 v164, v114, v115
    v_pk_fma_f32 v[116:117], v[102:103], v[76:77], v[116:117] op_sel:[1,1,0] op_sel_hi:[0,1,1] neg_lo:[1,0,0]
    v_pk_fma_f32 v[110:111], v[102:103], v[78:79], v[110:111] op_sel:[1,1,0] op_sel_hi:[0,1,1] neg_lo:[1,0,0]
    ds_write2st64_b32 v48, v163, v162 offset0:33 offset1:0
    v_pk_mul_f32 v[112:113], v[102:103], v[80:81] op_sel_hi:[1,0]
    v_pk_mul_f32 v[114:115], v[102:103], v[82:83] op_sel_hi:[1,0]
    v_cvt_pk_f16_f32 v165, v116, v117
    v_cvt_pk_f16_f32 v166, v110, v111
    v_pk_fma_f32 v[112:113], v[102:103], v[80:81], v[112:113] op_sel:[1,1,0] op_sel_hi:[0,1,1] neg_lo:[1,0,0]
    v_pk_fma_f32 v[114:115], v[102:103], v[82:83], v[114:115] op_sel:[1,1,0] op_sel_hi:[0,1,1] neg_lo:[1,0,0]
    ds_write2st64_b32 v49, v165, v164 offset0:33 offset1:0
    v_pk_mul_f32 v[120:121], v[30:31], v[66:67] op_sel_hi:[1,0]
    v_cvt_pk_f16_f32 v167, v112, v113
    v_cvt_pk_f16_f32 v56, v114, v115
    v_pk_fma_f32 v[120:121], v[30:31], v[66:67], v[120:121] op_sel:[1,1,0] op_sel_hi:[0,1,1] neg_lo:[1,0,0]
    ds_write2st64_b32 v50, v167, v166 offset0:33 offset1:0
    s_cmp_ge_u32 s3, 4
    s_cbranch_scc1 C_K3
    v_add_u32 v64, 1, v64
    s_and_b32 s46, s40, 0x7fffff
    v_ldexp_f32 v64, 1.0, v64
    s_lshl_b32 s53, s2, 7
    v_or_b32 v64, s46, v64
    s_lshl_b32 s46, s51, 2
    s_add_u32 s46, s46, s53
    s_add_u32 s46, s46, 32768
    s_mov_b64 exec, 1
    buffer_store_dword v64, v2, s[32:35], s46 offen sc1
    s_mov_b64 exec, -1
C_K3:
    v_pk_mul_f32 v[136:137], v[30:31], v[68:69] op_sel_hi:[1,0]
    v_pk_mul_f32 v[122:123], v[120:121], v[66:67] op_sel_hi:[1,0]
    v_cvt_pk_f16_f32 v57, v30, v31
    v_cvt_pk_f16_f32 v163, v120, v121
    v_pk_fma_f32 v[136:137], v[30:31], v[68:69], v[136:137] op_sel:[1,1,0] op_sel_hi:[0,1,1] neg_lo:[1,0,0]
    v_pk_fma_f32 v[122:123], v[120:121], v[66:67], v[122:123] op_sel:[1,1,0] op_sel_hi:[0,1,1] neg_lo:[1,0,0]
    ds_write_b32 v46, v57 offset:16896
    v_pk_mul_f32 v[124:125], v[122:123], v[66:67] op_sel_hi:[1,0]
    v_pk_mul_f32 v[138:139], v[122:123], v[68:69] op_sel_hi:[1,0]
    v_cvt_pk_f16_f32 v162, v136, v137
    v_cvt_pk_f16_f32 v165, v122, v123
    v_pk_fma_f32 v[124:125], v[122:123], v[66:67], v[124:125] op_sel:[1,1,0] op_sel_hi:[0,1,1] neg_lo:[1,0,0]
    v_pk_fma_f32 v[138:139], v[122:123], v[68:69], v[138:139] op_sel:[1,1,0] op_sel_hi:[0,1,1] neg_lo:[1,0,0]
    ds_write2st64_b32 v40, v162, v163 offset0:99 offset1:66
    v_pk_mul_f32 v[126:127], v[124:125], v[66:67] op_sel_hi:[1,0]
    v_cvt_pk_f16_f32 v164, v124, v125
    v_cvt_pk_f16_f32 v167, v138, v139
    v_pk_fma_f32 v[126:127], v[124:125], v[66:67], v[126:127] op_sel:[1,1,0] op_sel_hi:[0,1,1] neg_lo:[1,0,0]
    ds_write2st64_b32 v41, v167, v164 offset0:99 offset1:66
    v_pk_mul_f32 v[128:129], v[126:127], v[66:67] op_sel_hi:[1,0]
    v_pk_mul_f32 v[140:141], v[126:127], v[68:69] op_sel_hi:[1,0]
    v_cvt_pk_f16_f32 v166, v126, v127
    v_pk_fma_f32 v[128:129], v[126:127], v[66:67], v[128:129] op_sel:[1,1,0] op_sel_hi:[0,1,1] neg_lo:[1,0,0]
    v_pk_fma_f32 v[140:141], v[126:127], v[68:69], v[140:141] op_sel:[1,1,0] op_sel_hi:[0,1,1] neg_lo:[1,0,0]
    ds_write_b32 v47, v166 offset:16896
    s_setprio 0
    v_pk_mul_f32 v[130:131], v[128:129], v[66:67] op_sel_hi:[1,0]
    v_pk_mul_f32 v[146:147], v[140:141], v[68:69] op_sel_hi:[1,0]
    v_cvt_pk_f16_f32 v57, v128, v129
    v_cvt_pk_f16_f32 v162, v140, v141
    v_pk_fma_f32 v[130:131], v[128:129], v[66:67], v[130:131] op_sel:[1,1,0] op_sel_hi:[0,1,1] neg_lo:[1,0,0]
    v_pk_fma_f32 v[146:147], v[140:141], v[68:69], v[146:147] op_sel:[1,1,0] op_sel_hi:[0,1,1] neg_lo:[1,0,0]
    ds_write_b32 v48, v57 offset:16896
    v_pk_mul_f32 v[132:133], v[130:131], v[66:67] op_sel_hi:[1,0]
    v_pk_mul_f32 v[142:143], v[130:131], v[68:69] op_sel_hi:[1,0]
    v_cvt_pk_f16_f32 v163, v130, v131
    v_cvt_pk_f16_f32 v167, v146, v147
    v_pk_fma_f32 v[132:133], v[130:131], v[66:67], v[132:133] op_sel:[1,1,0] op_sel_hi:[0,1,1] neg_lo:[1,0,0]
    v_pk_fma_f32 v[142:143], v[130:131], v[68:69], v[142:143] op_sel:[1,1,0] op_sel_hi:[0,1,1] neg_lo:[1,0,0]
    ds_write2st64_b32 v45, v162, v165 offset0:99 offset1:66
    v_pk_mul_f32 v[134:135], v[132:133], v[66:67] op_sel_hi:[1,0]
    v_pk_mul_f32 v[150:151], v[146:147], v[68:69] op_sel_hi:[1,0]
    v_cvt_pk_f16_f32 v164, v132, v133
    v_cvt_pk_f16_f32 v166, v142, v143
    v_pk_fma_f32 v[134:135], v[132:133], v[66:67], v[134:135] op_sel:[1,1,0] op_sel_hi:[0,1,1] neg_lo:[1,0,0]
    v_pk_fma_f32 v[150:151], v[146:147], v[68:69], v[150:151] op_sel:[1,1,0] op_sel_hi:[0,1,1] neg_lo:[1,0,0]
    ds_write2st64_b32 v42, v167, v163 offset0:99 offset1:66
    v_pk_mul_f32 v[144:145], v[134:135], v[68:69] op_sel_hi:[1,0]
    v_pk_mul_f32 v[116:117], v[102:103], v[84:85] op_sel_hi:[1,0]
    ds_write_b32 v49, v164 offset:16896
    v_cvt_pk_f16_f32 v57, v134, v135
    v_cvt_pk_f16_f32 v162, v150, v151
    v_pk_fma_f32 v[144:145], v[134:135], v[68:69], v[144:145] op_sel:[1,1,0] op_sel_hi:[0,1,1] neg_lo:[1,0,0]
    v_pk_fma_f32 v[116:117], v[102:103], v[84:85], v[116:117] op_sel:[1,1,0] op_sel_hi:[0,1,1] neg_lo:[1,0,0]
    ds_write_b32 v50, v166 offset:16896
    v_pk_mul_f32 v[148:149], v[144:145], v[68:69] op_sel_hi:[1,0]
    v_pk_mul_f32 v[110:111], v[102:103], v[86:87] op_sel_hi:[1,0]
    v_cvt_pk_f16_f32 v165, v144, v145
    v_cvt_pk_f16_f32 v167, v116, v117
    v_pk_fma_f32 v[148:149], v[144:145], v[68:69], v[148:149] op_sel:[1,1,0] op_sel_hi:[0,1,1] neg_lo:[1,0,0]
    v_pk_fma_f32 v[110:111], v[102:103], v[86:87], v[110:111] op_sel:[1,1,0] op_sel_hi:[0,1,1] neg_lo:[1,0,0]
    ds_write2st64_b32 v43, v162, v57 offset0:99 offset1:66
    v_pk_mul_f32 v[152:153], v[148:149], v[68:69] op_sel_hi:[1,0]
    v_pk_mul_f32 v[112:113], v[102:103], v[88:89] op_sel_hi:[1,0]
    v_cvt_pk_f16_f32 v163, v148, v149
    v_cvt_pk_f16_f32 v164, v110, v111
    v_pk_fma_f32 v[152:153], v[148:149], v[68:69], v[152:153] op_sel:[1,1,0] op_sel_hi:[0,1,1] neg_lo:[1,0,0]
    v_pk_fma_f32 v[112:113], v[102:103], v[88:89], v[112:113] op_sel:[1,1,0] op_sel_hi:[0,1,1] neg_lo:[1,0,0]
    ds_write2st64_b32 v51, v167, v56 offset0:33 offset1:0
    v_pk_mul_f32 v[114:115], v[102:103], v[90:91] op_sel_hi:[1,0]
    v_pk_mul_f32 v[154:155], v[152:153], v[68:69] op_sel_hi:[1,0]
    v_cvt_pk_f16_f32 v166, v152, v153
    v_cvt_pk_f16_f32 v162, v112, v113
    v_pk_fma_f32 v[114:115], v[102:103], v[90:91], v[114:115] op_sel:[1,1,0] op_sel_hi:[0,1,1] neg_lo:[1,0,0]
    v_pk_fma_f32 v[154:155], v[152:153], v[68:69], v[154:155] op_sel:[1,1,0] op_sel_hi:[0,1,1] neg_lo:[1,0,0]
    ds_write2st64_b32 v44, v163, v165 offset0:99 offset1:66
    v_pk_mul_f32 v[116:117], v[102:103], v[92:93] op_sel_hi:[1,0]
    v_pk_mul_f32 v[156:157], v[154:155], v[68:69] op_sel_hi:[1,0]
    ds_write_b32 v51, v166 offset:16896
    v_cvt_pk_f16_f32 v57, v114, v115
    v_cvt_pk_f16_f32 v167, v154, v155
    v_pk_fma_f32 v[116:117], v[102:103], v[92:93], v[116:117] op_sel:[1,1,0] op_sel_hi:[0,1,1] neg_lo:[1,0,0]
    v_pk_fma_f32 v[156:157], v[154:155], v[68:69], v[156:157] op_sel:[1,1,0] op_sel_hi:[0,1,1] neg_lo:[1,0,0]
    ds_write2st64_b32 v52, v162, v164 offset0:33 offset1:0
    s_cmp_lt_u32 s3, 4
    s_cbranch_scc1 C_K2
    s_cmp_lt_u32 s49, 128
    s_cbranch_scc1 C_K2
    buffer_load_dword v58, v59, s[32:35], s50 offen sc1
C_K2:
    v_pk_mul_f32 v[110:111], v[102:103], v[94:95] op_sel_hi:[1,0]
    v_pk_mul_f32 v[112:113], v[102:103], v[96:97] op_sel_hi:[1,0]
    v_cvt_pk_f16_f32 v56, v116, v117
    v_cvt_pk_f16_f32 v163, v156, v157
    v_pk_fma_f32 v[110:111], v[102:103], v[94:95], v[110:111] op_sel:[1,1,0] op_sel_hi:[0,1,1] neg_lo:[1,0,0]
    v_pk_fma_f32 v[112:113], v[102:103], v[96:97], v[112:113] op_sel:[1,1,0] op_sel_hi:[0,1,1] neg_lo:[1,0,0]
    ds_write_b32 v52, v167 offset:16896
    v_pk_mul_f32 v[158:159], v[156:157], v[68:69] op_sel_hi:[1,0]
    v_pk_mul_f32 v[114:115], v[102:103], v[98:99] op_sel_hi:[1,0]
    ds_write2st64_b32 v53, v56, v57 offset0:33 offset1:0
    v_cvt_pk_f16_f32 v165, v110, v111
    v_cvt_pk_f16_f32 v166, v112, v113
    v_pk_fma_f32 v[158:159], v[156:157], v[68:69], v[158:159] op_sel:[1,1,0] op_sel_hi:[0,1,1] neg_lo:[1,0,0]
    v_pk_fma_f32 v[114:115], v[102:103], v[98:99], v[114:115] op_sel:[1,1,0] op_sel_hi:[0,1,1] neg_lo:[1,0,0]
    ds_write_b32 v53, v163 offset:16896
    v_pk_mul_f32 v[160:161], v[158:159], v[68:69] op_sel_hi:[1,0]
    v_pk_mul_f32 v[116:117], v[102:103], v[100:101] op_sel_hi:[1,0]
    v_cvt_pk_f16_f32 v162, v158, v159
    v_cvt_pk_f16_f32 v164, v114, v115
    v_pk_fma_f32 v[160:161], v[158:159], v[68:69], v[160:161] op_sel:[1,1,0] op_sel_hi:[0,1,1] neg_lo:[1,0,0]
    v_pk_fma_f32 v[116:117], v[102:103], v[100:101], v[116:117] op_sel:[1,1,0] op_sel_hi:[0,1,1] neg_lo:[1,0,0]
    ds_write2st64_b32 v54, v166, v165 offset0:33 offset1:0
    s_cmp_lg_u32 s59, 0
    s_cbranch_scc1 UB8
    s_cmp_ge_u32 s49, 128
    s_cbranch_scc1 UB8
    s_mov_b32 s59, 1
    buffer_load_dwordx4 v[200:203], v2, s[32:35], s48 offen offset:0 sc1
    buffer_load_dwordx4 v[204:207], v2, s[32:35], s48 offen offset:1024 sc1
    buffer_load_dwordx4 v[208:211], v2, s[32:35], s48 offen offset:2048 sc1
    buffer_load_dwordx4 v[212:215], v2, s[32:35], s48 offen offset:3072 sc1
UB8:
    v_cvt_pk_f16_f32 v167, v160, v161
    v_cvt_pk_f16_f32 v56, v116, v117
    ds_write_b32 v54, v162 offset:16896
    ds_write_b32 v55, v167 offset:16896
    ds_write2st64_b32 v55, v56, v164 offset0:33 offset1:0
    s_cmp_ge_u32 s3, 4
    s_cbranch_scc1 H_PATH
    s_waitcnt vmcnt(7)
    v_add_u32 v195, s60, v195
    ds_read_b128 v[92:95], v195 offset:0
    ds_read_b128 v[96:99], v253 offset:0
    ds_read_b128 v[100:103], v195 offset:32
    ds_read_b128 v[104:107], v253 offset:32
    s_barrier
    ds_read_b128 v[108:111], v195 offset:64
    ds_read_b128 v[112:115], v253 offset:64
    ds_read_b128 v[116:119], v195 offset:96
    ds_read_b128 v[120:123], v253 offset:96
    ds_read_b128 v[124:127], v195 offset:128
    ds_read_b128 v[128:131], v253 offset:128
    ds_read_b128 v[132:135], v195 offset:160
    ds_read_b128 v[136:139], v253 offset:160
    ds_read_b128 v[140:143], v195 offset:192
    ds_read_b128 v[144:147], v253 offset:192
    s_waitcnt lgkmcnt(12)
    v_mfma_f32_32x32x16_f16 v[168:183], v[92:95], v[96:99], 0
    ds_read_b128 v[148:151], v195 offset:224
    ds_read_b128 v[152:155], v253 offset:224
    s_waitcnt lgkmcnt(12)
    v_mfma_f32_32x32x16_f16 v[168:183], v[100:103], v[104:107], v[168:183]
    ds_read_b128 v[92:95], v195 offset:256
    ds_read_b128 v[96:99], v253 offset:256
    s_waitcnt lgkmcnt(12)
    v_mfma_f32_32x32x16_f16 v[168:183], v[108:111], v[112:115], v[168:183]
    ds_read_b128 v[100:103], v195 offset:288
    ds_read_b128 v[104:107], v253 offset:288
    s_waitcnt lgkmcnt(12)
    v_mfma_f32_32x32x16_f16 v[168:183], v[116:119], v[120:123], v[168:183]
    ds_read_b128 v[108:111], v195 offset:320
    ds_read_b128 v[112:115], v253 offset:320
    s_waitcnt lgkmcnt(12)
    v_mfma_f32_32x32x16_f16 v[168:183], v[124:127], v[128:131], v[168:183]
    ds_read_b128 v[116:119], v195 offset:352
    ds_read_b128 v[120:123], v253 offset:352
    s_waitcnt lgkmcnt(12)
    v_mfma_f32_32x32x16_f16 v[168:183], v[132:135], v[136:139], v[168:183]
    ds_read_b128 v[124:127], v195 offset:384
    ds_read_b128 v[128:131], v253 offset:384
    s_waitcnt lgkmcnt(12)
    v_mfma_f32_32x32x16_f16 v[168:183], v[140:143], v[144:147], v[168:183]
    ds_read_b128 v[132:135], v195 offset:416
    ds_read_b128 v[136:139], v253 offset:416
    s_waitcnt lgkmcnt(12)
    v_mfma_f32_32x32x16_f16 v[168:183], v[148:151], v[152:155], v[168:183]
    ds_read_b128 v[140:143], v195 offset:448
    ds_read_b128 v[144:147], v253 offset:448
    s_waitcnt lgkmcnt(12)
    v_mfma_f32_32x32x16_f16 v[168:183], v[92:95], v[96:99], v[168:183]
    ds_read_b128 v[148:151], v195 offset:480
    ds_read_b128 v[152:155], v253 offset:480
    s_waitcnt lgkmcnt(12)
    v_mfma_f32_32x32x16_f16 v[168:183], v[100:103], v[104:107], v[168:183]
    v_add_u32 v184, s62, v184
    v_add_u32 v185, s62, v185
    s_waitcnt lgkmcnt(10)
    v_mfma_f32_32x32x16_f16 v[168:183], v[108:111], v[112:115], v[168:183]
    v_add_u32 v186, s62, v186
    v_add_u32 v187, s62, v187
    s_waitcnt lgkmcnt(8)
    v_mfma_f32_32x32x16_f16 v[168:183], v[116:119], v[120:123], v[168:183]
    v_add_u32 v188, s62, v188
    v_add_u32 v189, s62, v189
    s_waitcnt lgkmcnt(6)
    v_mfma_f32_32x32x16_f16 v[168:183], v[124:127], v[128:131], v[168:183]
    v_add_u32 v190, s62, v190
    v_add_u32 v191, s62, v191
    s_waitcnt lgkmcnt(4)
    v_mfma_f32_32x32x16_f16 v[168:183], v[132:135], v[136:139], v[168:183]
    v_add_u32 v192, s62, v192
    v_add_u32 v193, s62, v193
    s_waitcnt lgkmcnt(2)
    v_mfma_f32_32x32x16_f16 v[168:183], v[140:143], v[144:147], v[168:183]
    v_add_u32 v194, s62, v194
    s_waitcnt lgkmcnt(0)
    v_mfma_f32_32x32x16_f16 v[168:183], v[148:151], v[152:155], v[168:183]
    s_nop 11
    v_cvt_pk_f16_f32 v196, v171, v170
    v_cvt_pk_f16_f32 v197, v169, v168
    v_cvt_pk_f16_f32 v198, v183, v182
    ds_write2_b32 v184, v196, v197 offset0:0 offset1:1
    v_cvt_pk_f16_f32 v199, v181, v180
    v_cvt_pk_f16_f32 v200, v175, v175
    ds_write2_b32 v185, v198, v199 offset0:0 offset1:1
    v_cvt_pk_f16_f32 v201, v174, v173
    v_cvt_pk_f16_f32 v202, v173, v173
    ds_write2_b32 v189, v200, v201 offset0:0 offset1:1
    ds_write_b32 v190, v200
    v_cvt_pk_f16_f32 v203, v172, v176
    ds_write2_b32 v188, v200, v202 offset0:0 offset1:2
    v_cvt_pk_f16_f32 v204, v175, v174
    ds_write2_b32 v189, v202, v203 offset0:2 offset1:3
    v_cvt_pk_f16_f32 v205, v173, v172
    ds_write_b32 v186, v204
    v_cvt_pk_f16_f32 v206, v176, v177
    ds_write_b32 v187, v205
    v_cvt_pk_f16_f32 v207, v178, v179
    ds_write_b16 v191, v206
    ds_write_b16_d16_hi v192, v206
    ds_write_b16 v193, v207
    ds_write_b16_d16_hi v194, v207
    ds_read2_b32 v[44:45], v252 offset0:48 offset1:49
    ds_read2_b32 v[46:47], v252 offset0:50 offset1:51
    ds_read2_b32 v[48:49], v252 offset0:32 offset1:33
    ds_read2_b32 v[50:51], v252 offset0:34 offset1:35
    ds_read2_b32 v[52:53], v252 offset0:16 offset1:17
    ds_read2_b32 v[54:55], v252 offset0:18 offset1:19
    ds_read2_b32 v[56:57], v252 offset0:0 offset1:1
    ds_read2_b32 v[58:59], v252 offset0:2 offset1:3
    ds_read2_b32 v[28:29], v252 offset0:112 offset1:113
    ds_read2_b32 v[30:31], v252 offset0:114 offset1:115
    ds_read2_b32 v[32:33], v252 offset0:96 offset1:97
    ds_read2_b32 v[34:35], v252 offset0:98 offset1:99
    ds_read2_b32 v[36:37], v252 offset0:80 offset1:81
    ds_read2_b32 v[38:39], v252 offset0:82 offset1:83
    ds_read2_b32 v[40:41], v252 offset0:64 offset1:65
    ds_read2_b32 v[42:43], v252 offset0:66 offset1:67
    s_waitcnt lgkmcnt(15)
    s_barrier
    ds_read_b128 v[92:95], v248 offset:480
    ds_read_b128 v[96:99], v248 offset:416
    ds_read_b128 v[100:103], v248 offset:352
    ds_read_b128 v[104:107], v248 offset:288
    ds_read_b128 v[108:111], v248 offset:992
    ds_read_b128 v[112:115], v248 offset:928
    ds_read_b128 v[116:119], v248 offset:864
    ds_read_b128 v[120:123], v248 offset:800
    s_waitcnt lgkmcnt(15)
    s_waitcnt lgkmcnt(7)
    v_mfma_f32_16x16x32_f16 v[188:191], v[44:47], v[92:95], 0
    ds_read2_b32 v[76:77], v250 offset0:48 offset1:49
    ds_read2_b32 v[78:79], v250 offset0:50 offset1:51
    s_waitcnt lgkmcnt(8)
    v_mfma_f32_16x16x32_f16 v[188:191], v[48:51], v[96:99], v[188:191]
    ds_read2_b32 v[80:81], v250 offset0:32 offset1:33
    ds_read2_b32 v[82:83], v250 offset0:34 offset1:35
    s_waitcnt lgkmcnt(9)
    v_mfma_f32_16x16x32_f16 v[188:191], v[52:55], v[100:103], v[188:191]
    ds_read2_b32 v[84:85], v250 offset0:16 offset1:17
    ds_read2_b32 v[86:87], v250 offset0:18 offset1:19
    s_waitcnt lgkmcnt(10)
    v_mfma_f32_16x16x32_f16 v[188:191], v[56:59], v[104:107], v[188:191]
    ds_read2_b32 v[88:89], v250 offset0:0 offset1:1
    ds_read2_b32 v[90:91], v250 offset0:2 offset1:3
    v_mfma_f32_16x16x32_f16 v[156:159], v[28:31], v[92:95], 0
    ds_read2_b32 v[60:61], v250 offset0:112 offset1:113
    ds_read2_b32 v[62:63], v250 offset0:114 offset1:115
    v_mfma_f32_16x16x32_f16 v[156:159], v[32:35], v[96:99], v[156:159]
    ds_read2_b32 v[64:65], v250 offset0:96 offset1:97
    ds_read2_b32 v[66:67], v250 offset0:98 offset1:99
    v_mfma_f32_16x16x32_f16 v[156:159], v[36:39], v[100:103], v[156:159]
    ds_read2_b32 v[68:69], v250 offset0:80 offset1:81
    ds_read2_b32 v[70:71], v250 offset0:82 offset1:83
    v_mfma_f32_16x16x32_f16 v[156:159], v[40:43], v[104:107], v[156:159]
    ds_read2_b32 v[72:73], v250 offset0:64 offset1:65
    ds_read2_b32 v[74:75], v250 offset0:66 offset1:67
    s_waitcnt lgkmcnt(15)
    v_mfma_f32_16x16x32_f16 v[192:195], v[44:47], v[108:111], 0
    ds_read_b128 v[124:127], v248 offset:1504
    v_mfma_f32_16x16x32_f16 v[192:195], v[48:51], v[112:115], v[192:195]
    ds_read_b128 v[128:131], v248 offset:1440
    s_waitcnt lgkmcnt(15)
    v_mfma_f32_16x16x32_f16 v[192:195], v[52:55], v[116:119], v[192:195]
    ds_read_b128 v[132:135], v248 offset:1376
    v_mfma_f32_16x16x32_f16 v[192:195], v[56:59], v[120:123], v[192:195]
    ds_read_b128 v[136:139], v248 offset:1312
    s_waitcnt lgkmcnt(15)
    v_mfma_f32_16x16x32_f16 v[192:195], v[76:79], v[92:95], v[192:195]
    v_add_f32_dpp v156, v188, v156 row_ror:8 row_mask:0xf bank_mask:0xc
    v_add_f32_dpp v157, v189, v157 row_ror:8 row_mask:0xf bank_mask:0xc
    s_waitcnt lgkmcnt(15)
    v_mfma_f32_16x16x32_f16 v[192:195], v[80:83], v[96:99], v[192:195]
    v_add_f32_dpp v158, v190, v158 row_ror:8 row_mask:0xf bank_mask:0xc
    v_add_f32_dpp v159, v191, v159 row_ror:8 row_mask:0xf bank_mask:0xc
    s_waitcnt lgkmcnt(14)
    v_mfma_f32_16x16x32_f16 v[192:195], v[84:87], v[100:103], v[192:195]
    v_cvt_pkrtz_f16_f32 v156, v156, v157
    v_cvt_pkrtz_f16_f32 v157, v158, v159
    s_waitcnt lgkmcnt(12)
    v_mfma_f32_16x16x32_f16 v[192:195], v[88:91], v[104:107], v[192:195]
    v_mfma_f32_16x16x32_f16 v[160:163], v[28:31], v[108:111], 0
    ds_write_b64 v251, v[156:157] offset:0
    v_mfma_f32_16x16x32_f16 v[160:163], v[32:35], v[112:115], v[160:163]
    v_mfma_f32_16x16x32_f16 v[160:163], v[36:39], v[116:119], v[160:163]
    v_mfma_f32_16x16x32_f16 v[160:163], v[40:43], v[120:123], v[160:163]
    s_waitcnt lgkmcnt(11)
    v_mfma_f32_16x16x32_f16 v[160:163], v[60:63], v[92:95], v[160:163]
    s_waitcnt lgkmcnt(9)
    v_mfma_f32_16x16x32_f16 v[160:163], v[64:67], v[96:99], v[160:163]
    v_mov_b32_dpp v188, v192 quad_perm:[0,1,2,3] row_mask:0xf bank_mask:0x3
    v_mov_b32_dpp v189, v193 quad_perm:[0,1,2,3] row_mask:0xf bank_mask:0x3
    s_waitcnt lgkmcnt(7)
    v_mfma_f32_16x16x32_f16 v[160:163], v[68:71], v[100:103], v[160:163]
    v_mov_b32_dpp v190, v194 quad_perm:[0,1,2,3] row_mask:0xf bank_mask:0x3
    v_mov_b32_dpp v191, v195 quad_perm:[0,1,2,3] row_mask:0xf bank_mask:0x3
    s_waitcnt lgkmcnt(5)
    v_mfma_f32_16x16x32_f16 v[160:163], v[72:75], v[104:107], v[160:163]
    s_waitcnt lgkmcnt(3)
    v_mfma_f32_16x16x32_f16 v[196:199], v[44:47], v[124:127], 0
    ds_read_b128 v[92:95], v248 offset:2016
    v_mfma_f32_16x16x32_f16 v[196:199], v[48:51], v[128:131], v[196:199]
    ds_read_b128 v[96:99], v248 offset:1952
    s_waitcnt lgkmcnt(3)
    v_mfma_f32_16x16x32_f16 v[196:199], v[52:55], v[132:135], v[196:199]
    ds_read_b128 v[100:103], v248 offset:1888
    v_mfma_f32_16x16x32_f16 v[196:199], v[56:59], v[136:139], v[196:199]
    ds_read_b128 v[104:107], v248 offset:1824
    v_mfma_f32_16x16x32_f16 v[196:199], v[76:79], v[108:111], v[196:199]
    v_add_f32_dpp v160, v188, v160 row_ror:8 row_mask:0xf bank_mask:0xf
    v_add_f32_dpp v161, v189, v161 row_ror:8 row_mask:0xf bank_mask:0xf
    v_mfma_f32_16x16x32_f16 v[196:199], v[80:83], v[112:115], v[196:199]
    v_add_f32_dpp v162, v190, v162 row_ror:8 row_mask:0xf bank_mask:0xf
    v_add_f32_dpp v163, v191, v163 row_ror:8 row_mask:0xf bank_mask:0xf
    v_mfma_f32_16x16x32_f16 v[196:199], v[84:87], v[116:119], v[196:199]
    v_cvt_pkrtz_f16_f32 v160, v160, v161
    v_cvt_pkrtz_f16_f32 v161, v162, v163
    v_mfma_f32_16x16x32_f16 v[196:199], v[88:91], v[120:123], v[196:199]
    v_mfma_f32_16x16x32_f16 v[164:167], v[28:31], v[124:127], 0
    ds_write_b64 v251, v[160:161] offset:512
    v_mfma_f32_16x16x32_f16 v[164:167], v[32:35], v[128:131], v[164:167]
    v_mfma_f32_16x16x32_f16 v[164:167], v[36:39], v[132:135], v[164:167]
    v_mfma_f32_16x16x32_f16 v[164:167], v[40:43], v[136:139], v[164:167]
    v_mfma_f32_16x16x32_f16 v[164:167], v[60:63], v[108:111], v[164:167]
    v_mfma_f32_16x16x32_f16 v[164:167], v[64:67], v[112:115], v[164:167]
    s_nop 0
    v_mov_b32_dpp v192, v196 quad_perm:[0,1,2,3] row_mask:0xf bank_mask:0x3
    v_mov_b32_dpp v193, v197 quad_perm:[0,1,2,3] row_mask:0xf bank_mask:0x3
    s_waitcnt lgkmcnt(0)
    s_barrier
    ds_read_b128 v[148:151], v249 offset:0
    ds_read_b128 v[152:155], v249 offset:1024
    v_mfma_f32_16x16x32_f16 v[164:167], v[68:71], v[116:119], v[164:167]
    v_mov_b32_dpp v194, v198 quad_perm:[0,1,2,3] row_mask:0xf bank_mask:0x3
    v_mov_b32_dpp v195, v199 quad_perm:[0,1,2,3] row_mask:0xf bank_mask:0x3
    v_mfma_f32_16x16x32_f16 v[164:167], v[72:75], v[120:123], v[164:167]
    v_mfma_f32_16x16x32_f16 v[188:191], v[44:47], v[92:95], 0
    ds_read_b128 v[108:111], v248 offset:2528
    v_mfma_f32_16x16x32_f16 v[188:191], v[48:51], v[96:99], v[188:191]
    ds_read_b128 v[112:115], v248 offset:2464
    v_mfma_f32_16x16x32_f16 v[188:191], v[52:55], v[100:103], v[188:191]
    ds_read_b128 v[116:119], v248 offset:2400
    v_mfma_f32_16x16x32_f16 v[188:191], v[56:59], v[104:107], v[188:191]
    ds_read_b128 v[120:123], v248 offset:2336
    v_mfma_f32_16x16x32_f16 v[188:191], v[76:79], v[124:127], v[188:191]
    v_add_f32_dpp v164, v192, v164 row_ror:8 row_mask:0xf bank_mask:0xf
    v_add_f32_dpp v165, v193, v165 row_ror:8 row_mask:0xf bank_mask:0xf
    v_mfma_f32_16x16x32_f16 v[188:191], v[80:83], v[128:131], v[188:191]
    v_add_f32_dpp v166, v194, v166 row_ror:8 row_mask:0xf bank_mask:0xf
    v_add_f32_dpp v167, v195, v167 row_ror:8 row_mask:0xf bank_mask:0xf
    v_mfma_f32_16x16x32_f16 v[188:191], v[84:87], v[132:135], v[188:191]
    s_waitcnt lgkmcnt(5)
    v_add_f32 v164, v164, v148
    v_add_f32 v165, v165, v149
    v_mfma_f32_16x16x32_f16 v[188:191], v[88:91], v[136:139], v[188:191]
    v_add_f32 v166, v166, v150
    v_add_f32 v167, v167, v151
    s_waitcnt lgkmcnt(4)
    v_mfma_f32_16x16x32_f16 v[152:155], v[28:31], v[92:95], v[152:155]
    v_cvt_pkrtz_f16_f32 v164, v164, v165
    v_cvt_pkrtz_f16_f32 v165, v166, v167
    v_mfma_f32_16x16x32_f16 v[152:155], v[32:35], v[96:99], v[152:155]
    v_mfma_f32_16x16x32_f16 v[152:155], v[36:39], v[100:103], v[152:155]
    ds_write_b64 v251, v[164:165] offset:1024
    v_mfma_f32_16x16x32_f16 v[152:155], v[40:43], v[104:107], v[152:155]
    v_mfma_f32_16x16x32_f16 v[152:155], v[60:63], v[124:127], v[152:155]
    v_mfma_f32_16x16x32_f16 v[152:155], v[64:67], v[128:131], v[152:155]
    v_mov_b32_dpp v196, v188 quad_perm:[0,1,2,3] row_mask:0xf bank_mask:0x3
    v_mov_b32_dpp v197, v189 quad_perm:[0,1,2,3] row_mask:0xf bank_mask:0x3
    v_mfma_f32_16x16x32_f16 v[152:155], v[68:71], v[132:135], v[152:155]
    v_mov_b32_dpp v198, v190 quad_perm:[0,1,2,3] row_mask:0xf bank_mask:0x3
    v_mov_b32_dpp v199, v191 quad_perm:[0,1,2,3] row_mask:0xf bank_mask:0x3
    v_mfma_f32_16x16x32_f16 v[152:155], v[72:75], v[136:139], v[152:155]
    s_waitcnt lgkmcnt(3)
    v_mfma_f32_16x16x32_f16 v[192:195], v[44:47], v[108:111], 0
    ds_read_b128 v[124:127], v248 offset:3040
    v_mfma_f32_16x16x32_f16 v[192:195], v[48:51], v[112:115], v[192:195]
    ds_read_b128 v[128:131], v248 offset:2976
    s_waitcnt lgkmcnt(3)
    v_mfma_f32_16x16x32_f16 v[192:195], v[52:55], v[116:119], v[192:195]
    ds_read_b128 v[132:135], v248 offset:2912
    v_mfma_f32_16x16x32_f16 v[192:195], v[56:59], v[120:123], v[192:195]
    ds_read_b128 v[136:139], v248 offset:2848
    v_mfma_f32_16x16x32_f16 v[192:195], v[76:79], v[92:95], v[192:195]
    v_add_f32_dpp v152, v196, v152 row_ror:8 row_mask:0xf bank_mask:0xf
    v_add_f32_dpp v153, v197, v153 row_ror:8 row_mask:0xf bank_mask:0xf
    v_mfma_f32_16x16x32_f16 v[192:195], v[80:83], v[96:99], v[192:195]
    v_add_f32_dpp v154, v198, v154 row_ror:8 row_mask:0xf bank_mask:0xf
    v_add_f32_dpp v155, v199, v155 row_ror:8 row_mask:0xf bank_mask:0xf
    v_mfma_f32_16x16x32_f16 v[192:195], v[84:87], v[100:103], v[192:195]
    v_cvt_pkrtz_f16_f32 v152, v152, v153
    v_cvt_pkrtz_f16_f32 v153, v154, v155
    v_mfma_f32_16x16x32_f16 v[192:195], v[88:91], v[104:107], v[192:195]
    v_mfma_f32_16x16x32_f16 v[172:175], v[28:31], v[108:111], 0
    ds_write_b64 v251, v[152:153] offset:1536
    v_mfma_f32_16x16x32_f16 v[172:175], v[32:35], v[112:115], v[172:175]
    v_mfma_f32_16x16x32_f16 v[172:175], v[36:39], v[116:119], v[172:175]
    v_mfma_f32_16x16x32_f16 v[172:175], v[40:43], v[120:123], v[172:175]
    v_mfma_f32_16x16x32_f16 v[172:175], v[60:63], v[92:95], v[172:175]
    v_mfma_f32_16x16x32_f16 v[172:175], v[64:67], v[96:99], v[172:175]
    s_nop 0
    v_mov_b32_dpp v188, v192 quad_perm:[0,1,2,3] row_mask:0xf bank_mask:0x3
    v_mov_b32_dpp v189, v193 quad_perm:[0,1,2,3] row_mask:0xf bank_mask:0x3
    s_waitcnt lgkmcnt(0)
    s_barrier
    ds_read_b128 v[140:143], v249 offset:2048
    ds_read_b128 v[144:147], v249 offset:3072
    v_mfma_f32_16x16x32_f16 v[172:175], v[68:71], v[100:103], v[172:175]
    v_mov_b32_dpp v190, v194 quad_perm:[0,1,2,3] row_mask:0xf bank_mask:0x3
    v_mov_b32_dpp v191, v195 quad_perm:[0,1,2,3] row_mask:0xf bank_mask:0x3
    v_mfma_f32_16x16x32_f16 v[172:175], v[72:75], v[104:107], v[172:175]
    v_mfma_f32_16x16x32_f16 v[196:199], v[44:47], v[124:127], 0
    ds_read_b128 v[92:95], v248 offset:3552
    v_mfma_f32_16x16x32_f16 v[196:199], v[48:51], v[128:131], v[196:199]
    ds_read_b128 v[96:99], v248 offset:3488
    v_mfma_f32_16x16x32_f16 v[196:199], v[52:55], v[132:135], v[196:199]
    ds_read_b128 v[100:103], v248 offset:3424
    v_mfma_f32_16x16x32_f16 v[196:199], v[56:59], v[136:139], v[196:199]
    ds_read_b128 v[104:107], v248 offset:3360
    v_mfma_f32_16x16x32_f16 v[196:199], v[76:79], v[108:111], v[196:199]
    v_add_f32_dpp v172, v188, v172 row_ror:8 row_mask:0xf bank_mask:0xf
    v_add_f32_dpp v173, v189, v173 row_ror:8 row_mask:0xf bank_mask:0xf
    v_mfma_f32_16x16x32_f16 v[196:199], v[80:83], v[112:115], v[196:199]
    v_add_f32_dpp v174, v190, v174 row_ror:8 row_mask:0xf bank_mask:0xf
    v_add_f32_dpp v175, v191, v175 row_ror:8 row_mask:0xf bank_mask:0xf
    v_mfma_f32_16x16x32_f16 v[196:199], v[84:87], v[116:119], v[196:199]
    s_waitcnt lgkmcnt(5)
    v_add_f32 v172, v172, v140
    v_add_f32 v173, v173, v141
    v_mfma_f32_16x16x32_f16 v[196:199], v[88:91], v[120:123], v[196:199]
    v_add_f32 v174, v174, v142
    v_add_f32 v175, v175, v143
    s_waitcnt lgkmcnt(4)
    v_mfma_f32_16x16x32_f16 v[144:147], v[28:31], v[124:127], v[144:147]
    v_cvt_pkrtz_f16_f32 v172, v172, v173
    v_cvt_pkrtz_f16_f32 v173, v174, v175
    v_mfma_f32_16x16x32_f16 v[144:147], v[32:35], v[128:131], v[144:147]
    v_mfma_f32_16x16x32_f16 v[144:147], v[36:39], v[132:135], v[144:147]
    ds_write_b64 v251, v[172:173] offset:2048
    v_mfma_f32_16x16x32_f16 v[144:147], v[40:43], v[136:139], v[144:147]
    v_mfma_f32_16x16x32_f16 v[144:147], v[60:63], v[108:111], v[144:147]
    v_mfma_f32_16x16x32_f16 v[144:147], v[64:67], v[112:115], v[144:147]
    v_mov_b32_dpp v192, v196 quad_perm:[0,1,2,3] row_mask:0xf bank_mask:0x3
    v_mov_b32_dpp v193, v197 quad_perm:[0,1,2,3] row_mask:0xf bank_mask:0x3
    v_mfma_f32_16x16x32_f16 v[144:147], v[68:71], v[116:119], v[144:147]
    v_mov_b32_dpp v194, v198 quad_perm:[0,1,2,3] row_mask:0xf bank_mask:0x3
    v_mov_b32_dpp v195, v199 quad_perm:[0,1,2,3] row_mask:0xf bank_mask:0x3
    v_mfma_f32_16x16x32_f16 v[144:147], v[72:75], v[120:123], v[144:147]
    s_waitcnt lgkmcnt(3)
    v_mfma_f32_16x16x32_f16 v[188:191], v[44:47], v[92:95], 0
    ds_read_b128 v[108:111], v248 offset:4064
    v_mfma_f32_16x16x32_f16 v[188:191], v[48:51], v[96:99], v[188:191]
    ds_read_b128 v[112:115], v248 offset:4000
    s_waitcnt lgkmcnt(3)
    v_mfma_f32_16x16x32_f16 v[188:191], v[52:55], v[100:103], v[188:191]
    ds_read_b128 v[116:119], v248 offset:3936
    v_mfma_f32_16x16x32_f16 v[188:191], v[56:59], v[104:107], v[188:191]
    ds_read_b128 v[120:123], v248 offset:3872
    v_mfma_f32_16x16x32_f16 v[188:191], v[76:79], v[124:127], v[188:191]
    v_add_f32_dpp v144, v192, v144 row_ror:8 row_mask:0xf bank_mask:0xf
    v_add_f32_dpp v145, v193, v145 row_ror:8 row_mask:0xf bank_mask:0xf
    v_mfma_f32_16x16x32_f16 v[188:191], v[80:83], v[128:131], v[188:191]
    v_add_f32_dpp v146, v194, v146 row_ror:8 row_mask:0xf bank_mask:0xf
    v_add_f32_dpp v147, v195, v147 row_ror:8 row_mask:0xf bank_mask:0xf
    v_mfma_f32_16x16x32_f16 v[188:191], v[84:87], v[132:135], v[188:191]
    v_cvt_pkrtz_f16_f32 v144, v144, v145
    v_cvt_pkrtz_f16_f32 v145, v146, v147
    v_mfma_f32_16x16x32_f16 v[188:191], v[88:91], v[136:139], v[188:191]
    v_mfma_f32_16x16x32_f16 v[180:183], v[28:31], v[92:95], 0
    ds_write_b64 v251, v[144:145] offset:2560
    v_mfma_f32_16x16x32_f16 v[180:183], v[32:35], v[96:99], v[180:183]
    v_mfma_f32_16x16x32_f16 v[180:183], v[36:39], v[100:103], v[180:183]
    v_mfma_f32_16x16x32_f16 v[180:183], v[40:43], v[104:107], v[180:183]
    v_mfma_f32_16x16x32_f16 v[180:183], v[60:63], v[124:127], v[180:183]
    s_waitcnt lgkmcnt(0)
    s_barrier
    ds_read_b128 v[148:151], v249 offset:4096
    ds_read_b128 v[152:155], v249 offset:5120
    v_mfma_f32_16x16x32_f16 v[180:183], v[64:67], v[128:131], v[180:183]
    v_mov_b32_dpp v196, v188 quad_perm:[0,1,2,3] row_mask:0xf bank_mask:0x3
    v_mov_b32_dpp v197, v189 quad_perm:[0,1,2,3] row_mask:0xf bank_mask:0x3
    v_mfma_f32_16x16x32_f16 v[180:183], v[68:71], v[132:135], v[180:183]
    v_mov_b32_dpp v198, v190 quad_perm:[0,1,2,3] row_mask:0xf bank_mask:0x3
    v_mov_b32_dpp v199, v191 quad_perm:[0,1,2,3] row_mask:0xf bank_mask:0x3
    v_mfma_f32_16x16x32_f16 v[180:183], v[72:75], v[136:139], v[180:183]
    v_mfma_f32_16x16x32_f16 v[192:195], v[44:47], v[108:111], 0
    v_mfma_f32_16x16x32_f16 v[192:195], v[48:51], v[112:115], v[192:195]
    v_mfma_f32_16x16x32_f16 v[192:195], v[52:55], v[116:119], v[192:195]
    v_mfma_f32_16x16x32_f16 v[192:195], v[56:59], v[120:123], v[192:195]
    v_mfma_f32_16x16x32_f16 v[192:195], v[76:79], v[92:95], v[192:195]
    v_mfma_f32_16x16x32_f16 v[192:195], v[80:83], v[96:99], v[192:195]
    s_nop 1
    v_add_f32_dpp v180, v196, v180 row_ror:8 row_mask:0xf bank_mask:0xf
    v_add_f32_dpp v181, v197, v181 row_ror:8 row_mask:0xf bank_mask:0xf
    v_mfma_f32_16x16x32_f16 v[192:195], v[84:87], v[100:103], v[192:195]
    v_add_f32_dpp v182, v198, v182 row_ror:8 row_mask:0xf bank_mask:0xf
    v_add_f32_dpp v183, v199, v183 row_ror:8 row_mask:0xf bank_mask:0xf
    v_mfma_f32_16x16x32_f16 v[192:195], v[88:91], v[104:107], v[192:195]
    s_waitcnt lgkmcnt(1)
    v_add_f32 v180, v180, v148
    v_add_f32 v181, v181, v149
    s_waitcnt lgkmcnt(0)
    v_mfma_f32_16x16x32_f16 v[152:155], v[28:31], v[108:111], v[152:155]
    v_add_f32 v182, v182, v150
    v_add_f32 v183, v183, v151
    v_mfma_f32_16x16x32_f16 v[152:155], v[32:35], v[112:115], v[152:155]
    v_cvt_pkrtz_f16_f32 v180, v180, v181
    v_cvt_pkrtz_f16_f32 v181, v182, v183
    v_mfma_f32_16x16x32_f16 v[152:155], v[36:39], v[116:119], v[152:155]
    v_mfma_f32_16x16x32_f16 v[152:155], v[40:43], v[120:123], v[152:155]
    ds_write_b64 v251, v[180:181] offset:3072
    s_waitcnt lgkmcnt(0)
    s_barrier
    v_mfma_f32_16x16x32_f16 v[152:155], v[60:63], v[92:95], v[152:155]
    v_mfma_f32_16x16x32_f16 v[152:155], v[64:67], v[96:99], v[152:155]
    v_mov_b32_dpp v188, v192 quad_perm:[0,1,2,3] row_mask:0xf bank_mask:0x3
    v_mov_b32_dpp v189, v193 quad_perm:[0,1,2,3] row_mask:0xf bank_mask:0x3
    v_mfma_f32_16x16x32_f16 v[152:155], v[68:71], v[100:103], v[152:155]
    v_mov_b32_dpp v190, v194 quad_perm:[0,1,2,3] row_mask:0xf bank_mask:0x3
    v_mov_b32_dpp v191, v195 quad_perm:[0,1,2,3] row_mask:0xf bank_mask:0x3
    v_mfma_f32_16x16x32_f16 v[152:155], v[72:75], v[104:107], v[152:155]
    s_nop 7
    v_add_f32_dpp v152, v188, v152 row_ror:8 row_mask:0xf bank_mask:0xf
    v_add_f32_dpp v153, v189, v153 row_ror:8 row_mask:0xf bank_mask:0xf
    v_add_f32_dpp v154, v190, v154 row_ror:8 row_mask:0xf bank_mask:0xf
    v_add_f32_dpp v155, v191, v155 row_ror:8 row_mask:0xf bank_mask:0xf
    v_cvt_pkrtz_f16_f32 v152, v152, v153
    v_cvt_pkrtz_f16_f32 v153, v154, v155
    ds_write_b64 v251, v[152:153] offset:3584
    s_waitcnt lgkmcnt(0)
    s_barrier
    s_branch RPREP
H_PATH:
    s_waitcnt lgkmcnt(0)
    s_barrier
    s_cmp_lg_u32 s59, 0
    s_cbranch_scc1 H_UI
    s_mov_b32 s47, 0
PL9:
    s_waitcnt vmcnt(0)
    v_cmp_ne_u32 vcc, s40, v58
    s_cbranch_vccz PD10
    s_add_u32 s47, s47, 1
    s_cmp_ge_u32 s47, 65536
    s_cbranch_scc1 PD10
    s_sleep 1
    buffer_load_dword v58, v59, s[32:35], s50 offen sc1
    s_branch PL9
PD10:
    buffer_load_dwordx4 v[200:203], v2, s[32:35], s48 offen offset:0 sc1
    buffer_load_dwordx4 v[204:207], v2, s[32:35], s48 offen offset:1024 sc1
    buffer_load_dwordx4 v[208:211], v2, s[32:35], s48 offen offset:2048 sc1
    buffer_load_dwordx4 v[212:215], v2, s[32:35], s48 offen offset:3072 sc1
H_UI:
    s_mov_b32 s47, 0
PL11:
    s_waitcnt vmcnt(0)
    v_xor_b32 v200, v10, v200
    v_xor_b32 v201, v10, v201
    v_xor_b32 v202, v10, v202
    v_xor_b32 v203, v10, v203
    v_xor_b32 v204, v10, v204
    v_xor_b32 v205, v10, v205
    v_xor_b32 v206, v10, v206
    v_xor_b32 v207, v10, v207
    v_xor_b32 v208, v10, v208
    v_xor_b32 v209, v10, v209
    v_xor_b32 v210, v10, v210
    v_xor_b32 v211, v10, v211
    v_xor_b32 v212, v10, v212
    v_xor_b32 v213, v10, v213
    v_xor_b32 v214, v10, v214
    v_xor_b32 v215, v10, v215
    v_or3_b32 v14, v200, v201, v202
    v_or3_b32 v14, v14, v203, v204
    v_or3_b32 v14, v14, v205, v206
    v_or3_b32 v14, v14, v207, v208
    v_or3_b32 v14, v14, v209, v210
    v_or3_b32 v14, v14, v211, v212
    v_or3_b32 v14, v14, v213, v214
    v_or_b32 v14, v14, v215
    v_and_b32 v14, 0x70007, v14
    v_cmp_ne_u32 vcc, 0, v14
    s_cbranch_vccz PD12
    s_add_u32 s47, s47, 1
    s_cmp_ge_u32 s47, 65536
    s_cbranch_scc1 PD12
    s_sleep 2
    buffer_load_dwordx4 v[200:203], v2, s[32:35], s48 offen offset:0 sc1
    buffer_load_dwordx4 v[204:207], v2, s[32:35], s48 offen offset:1024 sc1
    buffer_load_dwordx4 v[208:211], v2, s[32:35], s48 offen offset:2048 sc1
    buffer_load_dwordx4 v[212:215], v2, s[32:35], s48 offen offset:3072 sc1
    s_branch PL11
PD12:
    ds_write_b128 v254, v[200:203] offset:0
    ds_write_b128 v254, v[204:207] offset:256
    ds_write_b128 v254, v[208:211] offset:512
    ds_write_b128 v254, v[212:215] offset:768
    v_mov_b32 v15, s62
    s_setprio 1
    s_waitcnt lgkmcnt(0)
    s_barrier
    ds_read_b128 v[28:31], v248 offset:480
    ds_read_b128 v[32:35], v248 offset:464
    ds_read_b128 v[36:39], v248 offset:992
    ds_read_b128 v[40:43], v248 offset:976
    s_waitcnt lgkmcnt(3)
    v_mfma_f32_16x16x32_f16 v[76:79], v[28:31], v[172:175], 0
    v_mfma_f32_16x16x32_f16 v[80:83], v[28:31], v[168:171], 0
    v_mfma_f32_16x16x32_f16 v[88:91], v[28:31], v[176:179], 0
    s_waitcnt lgkmcnt(2)
    v_mfma_f32_16x16x32_f16 v[84:87], v[32:35], v[180:183], 0
    ds_read_b128 v[44:47], v248 offset:1504
    ds_read_b128 v[48:51], v248 offset:1488
    v_mfma_f32_16x16x32_f16 v[92:95], v[28:31], v[184:187], 0
    s_nop 1
    v_cvt_pk_f16_f32 v100, v76, v80
    v_cvt_pk_f16_f32 v101, v77, v81
    v_mfma_f32_16x16x32_f16 v[96:99], v[32:35], v[188:191], 0
    v_cvt_pk_f16_f32 v102, v78, v82
    v_cvt_pk_f16_f32 v103, v79, v83
    s_waitcnt lgkmcnt(3)
    v_mfma_f32_16x16x32_f16 v[76:79], v[36:39], v[172:175], 0
    v_cvt_pk_f16_f32 v104, v84, v88
    v_cvt_pk_f16_f32 v105, v85, v89
    v_mfma_f32_16x16x32_f16 v[80:83], v[36:39], v[168:171], 0
    v_cvt_pk_f16_f32 v106, v86, v90
    v_cvt_pk_f16_f32 v107, v87, v91
    v_mfma_f32_16x16x32_f16 v[88:91], v[36:39], v[176:179], 0
    v_cvt_pk_f16_f32 v148, v92, v96
    v_cvt_pk_f16_f32 v149, v93, v97
    s_waitcnt lgkmcnt(2)
    v_mfma_f32_16x16x32_f16 v[84:87], v[40:43], v[180:183], 0
    v_cvt_pk_f16_f32 v150, v94, v98
    v_cvt_pk_f16_f32 v151, v95, v99
    ds_read_b128 v[52:55], v248 offset:2016
    ds_read_b128 v[56:59], v248 offset:2000
    v_mfma_f32_16x16x32_f16 v[92:95], v[36:39], v[184:187], 0
    v_cvt_pk_f16_f32 v108, v76, v80
    v_cvt_pk_f16_f32 v109, v77, v81
    v_mfma_f32_16x16x32_f16 v[96:99], v[40:43], v[188:191], 0
    v_cvt_pk_f16_f32 v110, v78, v82
    v_cvt_pk_f16_f32 v111, v79, v83
    s_waitcnt lgkmcnt(3)
    v_mfma_f32_16x16x32_f16 v[76:79], v[44:47], v[172:175], 0
    v_cvt_pk_f16_f32 v112, v84, v88
    v_cvt_pk_f16_f32 v113, v85, v89
    v_mfma_f32_16x16x32_f16 v[80:83], v[44:47], v[168:171], 0
    v_cvt_pk_f16_f32 v114, v86, v90
    v_cvt_pk_f16_f32 v115, v87, v91
    ds_read_b128 v[60:63], v248 offset:2528
    ds_read_b128 v[64:67], v248 offset:2512
    v_mfma_f32_16x16x32_f16 v[88:91], v[44:47], v[176:179], 0
    v_cvt_pk_f16_f32 v152, v92, v96
    v_cvt_pk_f16_f32 v153, v93, v97
    s_waitcnt lgkmcnt(4)
    v_mfma_f32_16x16x32_f16 v[84:87], v[48:51], v[180:183], 0
    v_cvt_pk_f16_f32 v154, v94, v98
    v_cvt_pk_f16_f32 v155, v95, v99
    v_mfma_f32_16x16x32_f16 v[92:95], v[44:47], v[184:187], 0
    v_cvt_pk_f16_f32 v116, v76, v80
    v_cvt_pk_f16_f32 v117, v77, v81
    v_mfma_f32_16x16x32_f16 v[96:99], v[48:51], v[188:191], 0
    v_cvt_pk_f16_f32 v118, v78, v82
    v_cvt_pk_f16_f32 v119, v79, v83
    ds_read_b128 v[68:71], v248 offset:3040
    ds_read_b128 v[72:75], v248 offset:3024
    s_waitcnt lgkmcnt(5)
    v_mfma_f32_16x16x32_f16 v[76:79], v[52:55], v[172:175], 0
    v_cvt_pk_f16_f32 v120, v84, v88
    v_cvt_pk_f16_f32 v121, v85, v89
    v_mfma_f32_16x16x32_f16 v[80:83], v[52:55], v[168:171], 0
    v_cvt_pk_f16_f32 v122, v86, v90
    v_cvt_pk_f16_f32 v123, v87, v91
    v_mfma_f32_16x16x32_f16 v[88:91], v[52:55], v[176:179], 0
    v_cvt_pk_f16_f32 v156, v92, v96
    v_cvt_pk_f16_f32 v157, v93, v97
    s_waitcnt lgkmcnt(4)
    v_mfma_f32_16x16x32_f16 v[84:87], v[56:59], v[180:183], 0
    v_cvt_pk_f16_f32 v158, v94, v98
    v_cvt_pk_f16_f32 v159, v95, v99
    ds_read2_b32 v[196:197], v250 offset0:0 offset1:1
    ds_read2_b32 v[198:199], v250 offset0:2 offset1:3
    v_mfma_f32_16x16x32_f16 v[92:95], v[52:55], v[184:187], 0
    v_cvt_pk_f16_f32 v124, v76, v80
    v_cvt_pk_f16_f32 v125, v77, v81
    v_mfma_f32_16x16x32_f16 v[96:99], v[56:59], v[188:191], 0
    v_cvt_pk_f16_f32 v126, v78, v82
    v_cvt_pk_f16_f32 v127, v79, v83
    ds_read2_b32 v[200:201], v251 offset0:32 offset1:33
    ds_read2_b32 v[202:203], v251 offset0:34 offset1:35
    s_waitcnt lgkmcnt(7)
    v_mfma_f32_16x16x32_f16 v[76:79], v[60:63], v[172:175], 0
    v_cvt_pk_f16_f32 v128, v84, v88
    v_cvt_pk_f16_f32 v129, v85, v89
    v_mfma_f32_16x16x32_f16 v[80:83], v[60:63], v[168:171], 0
    v_cvt_pk_f16_f32 v130, v86, v90
    v_cvt_pk_f16_f32 v131, v87, v91
    ds_read2_b32 v[204:205], v251 offset0:80 offset1:81
    ds_read2_b32 v[206:207], v251 offset0:82 offset1:83
    v_mfma_f32_16x16x32_f16 v[88:91], v[60:63], v[176:179], 0
    v_cvt_pk_f16_f32 v160, v92, v96
    v_cvt_pk_f16_f32 v161, v93, v97
    s_waitcnt lgkmcnt(8)
    v_mfma_f32_16x16x32_f16 v[84:87], v[64:67], v[180:183], 0
    v_cvt_pk_f16_f32 v162, v94, v98
    v_cvt_pk_f16_f32 v163, v95, v99
    ds_read2_b32 v[208:209], v251 offset0:16 offset1:17
    ds_read2_b32 v[210:211], v251 offset0:18 offset1:19
    s_waitcnt lgkmcnt(9)
    v_mfma_f32_16x16x32_f16 v[92:95], v[68:71], v[172:175], 0
    v_cvt_pk_f16_f32 v132, v76, v80
    v_cvt_pk_f16_f32 v133, v77, v81
    v_mfma_f32_16x16x32_f16 v[96:99], v[68:71], v[168:171], 0
    v_cvt_pk_f16_f32 v134, v78, v82
    v_cvt_pk_f16_f32 v135, v79, v83
    ds_read2_b32 v[212:213], v251 offset0:64 offset1:65
    ds_read2_b32 v[214:215], v251 offset0:66 offset1:67
    v_mfma_f32_16x16x32_f16 v[80:83], v[68:71], v[176:179], 0
    v_cvt_pk_f16_f32 v136, v84, v88
    v_cvt_pk_f16_f32 v137, v85, v89
    s_waitcnt lgkmcnt(10)
    v_mfma_f32_16x16x32_f16 v[76:79], v[72:75], v[180:183], 0
    v_cvt_pk_f16_f32 v138, v86, v90
    v_cvt_pk_f16_f32 v139, v87, v91
    ds_read_u16 v15, v15 offset:2448
    s_waitcnt lgkmcnt(9)
    v_mfma_f32_16x16x32_f16 v[164:167], v[196:199], v[28:31], 0
    v_cvt_pk_f16_f32 v140, v92, v96
    v_cvt_pk_f16_f32 v141, v93, v97
    s_waitcnt lgkmcnt(7)
    v_mfma_f32_16x16x32_f16 v[164:167], v[100:103], v[200:203], v[164:167]
    v_cvt_pk_f16_f32 v142, v94, v98
    v_cvt_pk_f16_f32 v143, v95, v99
    s_waitcnt lgkmcnt(5)
    v_mfma_f32_16x16x32_f16 v[164:167], v[104:107], v[204:207], v[164:167]
    v_cvt_pk_f16_f32 v144, v76, v80
    v_cvt_pk_f16_f32 v145, v77, v81
    v_mfma_f32_16x16x32_f16 v[240:243], v[196:199], v[36:39], 0
    v_cvt_pk_f16_f32 v146, v78, v82
    v_cvt_pk_f16_f32 v147, v79, v83
    v_mfma_f32_16x16x32_f16 v[240:243], v[108:111], v[200:203], v[240:243]
    s_waitcnt lgkmcnt(0)
    v_lshl_or_b32 v15, v15, 16, v15
    v_and_b32 v192, v15, v192
    v_and_b32 v193, v15, v193
    v_and_b32 v194, v15, v194
    v_and_b32 v195, v15, v195
    v_mfma_f32_16x16x32_f16 v[240:243], v[112:115], v[204:207], v[240:243]
    ds_read2_b32 v[216:217], v251 offset0:0 offset1:1
    ds_read2_b32 v[218:219], v251 offset0:2 offset1:3
    v_mfma_f32_16x16x32_f16 v[240:243], v[100:103], v[208:211], v[240:243]
    ds_read2_b32 v[220:221], v251 offset0:48 offset1:49
    ds_read2_b32 v[222:223], v251 offset0:50 offset1:51
    v_mfma_f32_16x16x32_f16 v[240:243], v[104:107], v[212:215], v[240:243]
    ds_write_b128 v249, v[164:167] offset:0
    ds_read2_b32 v[224:225], v251 offset0:160 offset1:161
    ds_read2_b32 v[226:227], v251 offset0:162 offset1:163
    s_bitcmp1_b32 s3, 1
    s_cselect_b32 s46, 1, 0
    s_lshl_b32 s50, s46, 9
    v_add_u32 v15, s50, v252
    s_mul_i32 s46, s46, 294912
    s_add_u32 s46, s46, s63
    ds_write_b128 v249, v[240:243] offset:1024
    s_waitcnt lgkmcnt(0)
    s_barrier
    ds_read_b64_tr_b16 v[244:245], v15 offset:0
    ds_read_b64_tr_b16 v[246:247], v15 offset:256
    v_mfma_f32_16x16x32_f16 v[164:167], v[196:199], v[44:47], 0
    ds_read2_b32 v[228:229], v251 offset0:144 offset1:145
    ds_read2_b32 v[230:231], v251 offset0:146 offset1:147
    v_mfma_f32_16x16x32_f16 v[164:167], v[116:119], v[200:203], v[164:167]
    ds_read2_b32 v[232:233], v251 offset0:128 offset1:129
    ds_read2_b32 v[234:235], v251 offset0:130 offset1:131
    v_mfma_f32_16x16x32_f16 v[164:167], v[120:123], v[204:207], v[164:167]
    ds_read2_b32 v[236:237], v251 offset0:112 offset1:113
    ds_read2_b32 v[238:239], v251 offset0:114 offset1:115
    v_mfma_f32_16x16x32_f16 v[164:167], v[108:111], v[208:211], v[164:167]
    s_lshl_b32 s57, s51, 6
    v_add_u32 v14, s57, v1
    v_min_u32 v14, 143, v14
    v_lshlrev_b32 v27, 7, v14
    v_lshlrev_b32 v14, 4, v14
    s_mov_b32 s53, 32768
    buffer_load_dwordx4 v[32:35], v27, s[32:35], s53 offen sc1
    v_mfma_f32_16x16x32_f16 v[164:167], v[112:115], v[212:215], v[164:167]
    v_mfma_f32_16x16x32_f16 v[164:167], v[100:103], v[216:219], v[164:167]
    s_waitcnt lgkmcnt(6)
    v_add_u32 v244, v11, v244
    v_add_u32 v245, v11, v245
    v_add_u32 v246, v11, v246
    v_add_u32 v247, v11, v247
    v_and_or_b32 v244, v244, v9, v10
    v_and_or_b32 v245, v245, v9, v10
    v_and_or_b32 v246, v246, v9, v10
    v_and_or_b32 v247, v247, v9, v10
    buffer_store_dwordx4 v[244:247], v253, s[32:35], s46 offen sc1
    v_mfma_f32_16x16x32_f16 v[164:167], v[104:107], v[220:223], v[164:167]
    v_mfma_f32_16x16x32_f16 v[164:167], v[192:195], v[28:31], v[164:167]
    v_mfma_f32_16x16x32_f16 v[164:167], v[148:151], v[224:227], v[164:167]
    v_mfma_f32_16x16x32_f16 v[240:243], v[196:199], v[52:55], 0
    v_mfma_f32_16x16x32_f16 v[240:243], v[124:127], v[200:203], v[240:243]
    v_mfma_f32_16x16x32_f16 v[240:243], v[128:131], v[204:207], v[240:243]
    v_mfma_f32_16x16x32_f16 v[240:243], v[116:119], v[208:211], v[240:243]
    v_mfma_f32_16x16x32_f16 v[240:243], v[120:123], v[212:215], v[240:243]
    v_mfma_f32_16x16x32_f16 v[240:243], v[108:111], v[216:219], v[240:243]
    v_mfma_f32_16x16x32_f16 v[240:243], v[112:115], v[220:223], v[240:243]
    v_mfma_f32_16x16x32_f16 v[240:243], v[192:195], v[36:39], v[240:243]
    ds_write_b128 v249, v[164:167] offset:2048
    v_mfma_f32_16x16x32_f16 v[240:243], v[152:155], v[224:227], v[240:243]
    s_waitcnt lgkmcnt(5)
    v_mfma_f32_16x16x32_f16 v[240:243], v[148:151], v[228:231], v[240:243]
    v_mfma_f32_16x16x32_f16 v[164:167], v[196:199], v[60:63], 0
    v_mfma_f32_16x16x32_f16 v[164:167], v[132:135], v[200:203], v[164:167]
    v_mfma_f32_16x16x32_f16 v[164:167], v[136:139], v[204:207], v[164:167]
    v_mfma_f32_16x16x32_f16 v[164:167], v[124:127], v[208:211], v[164:167]
    v_mfma_f32_16x16x32_f16 v[164:167], v[128:131], v[212:215], v[164:167]
    v_mfma_f32_16x16x32_f16 v[164:167], v[116:119], v[216:219], v[164:167]
    v_mfma_f32_16x16x32_f16 v[164:167], v[120:123], v[220:223], v[164:167]
    v_mfma_f32_16x16x32_f16 v[164:167], v[192:195], v[44:47], v[164:167]
    ds_write_b128 v249, v[240:243] offset:3072
    v_mfma_f32_16x16x32_f16 v[164:167], v[156:159], v[224:227], v[164:167]
    v_mfma_f32_16x16x32_f16 v[164:167], v[152:155], v[228:231], v[164:167]
    s_waitcnt lgkmcnt(4)
    v_mfma_f32_16x16x32_f16 v[164:167], v[148:151], v[232:235], v[164:167]
    v_mfma_f32_16x16x32_f16 v[240:243], v[196:199], v[68:71], 0
    v_mfma_f32_16x16x32_f16 v[240:243], v[140:143], v[200:203], v[240:243]
    v_mfma_f32_16x16x32_f16 v[240:243], v[144:147], v[204:207], v[240:243]
    v_mfma_f32_16x16x32_f16 v[240:243], v[132:135], v[208:211], v[240:243]
    v_mfma_f32_16x16x32_f16 v[240:243], v[136:139], v[212:215], v[240:243]
    v_mfma_f32_16x16x32_f16 v[240:243], v[124:127], v[216:219], v[240:243]
    v_mfma_f32_16x16x32_f16 v[240:243], v[128:131], v[220:223], v[240:243]
    v_mfma_f32_16x16x32_f16 v[240:243], v[192:195], v[52:55], v[240:243]
    ds_write_b128 v249, v[164:167] offset:4096
    v_mfma_f32_16x16x32_f16 v[240:243], v[160:163], v[224:227], v[240:243]
    v_mfma_f32_16x16x32_f16 v[240:243], v[156:159], v[228:231], v[240:243]
    v_mfma_f32_16x16x32_f16 v[240:243], v[152:155], v[232:235], v[240:243]
    s_waitcnt lgkmcnt(3)
    v_mfma_f32_16x16x32_f16 v[240:243], v[148:151], v[236:239], v[240:243]
    s_bitcmp1_b32 s3, 1
    s_cselect_b32 s46, 3, 2
    s_lshl_b32 s50, s46, 9
    v_add_u32 v15, s50, v252
    s_mul_i32 s46, s46, 294912
    s_add_u32 s46, s46, s63
    s_nop 1
    ds_write_b128 v249, v[240:243] offset:5120
    s_waitcnt lgkmcnt(0)
    s_barrier
    ds_read_b64_tr_b16 v[244:245], v15 offset:0
    ds_read_b64_tr_b16 v[246:247], v15 offset:256
    s_waitcnt lgkmcnt(0)
    v_add_u32 v244, v11, v244
    v_add_u32 v245, v11, v245
    v_add_u32 v246, v11, v246
    v_add_u32 v247, v11, v247
    v_and_or_b32 v244, v244, v9, v10
    v_and_or_b32 v245, v245, v9, v10
    v_and_or_b32 v246, v246, v9, v10
    v_and_or_b32 v247, v247, v9, v10
    buffer_store_dwordx4 v[244:247], v253, s[32:35], s46 offen sc1
    s_setprio 0
    s_and_b32 s56, s40, 0x7fffff
    s_mov_b32 s47, 0
    s_waitcnt vmcnt(2)
SCP13:
    v_xor_b32 v32, s56, v32
    v_xor_b32 v33, s56, v33
    v_xor_b32 v34, s56, v34
    v_xor_b32 v35, s56, v35
    v_or3_b32 v255, v32, v33, v34
    v_or_b32 v255, v255, v35
    v_and_b32 v255, 0x7fffff, v255
    v_cmp_ne_u32 vcc, 0, v255
    s_cbranch_vccz SCD14
    s_add_u32 s47, s47, 1
    s_cmp_ge_u32 s47, 65536
    s_cbranch_scc1 SCD14
    s_sleep 8
    buffer_load_dwordx4 v[32:35], v27, s[32:35], s53 offen sc1
    s_waitcnt vmcnt(0)
    s_branch SCP13
SCD14:
    ds_write_b128 v14, v[32:35] offset:46080
    s_cmp_ge_u32 s49, 128
    s_cbranch_scc1 H_NOR
    global_load_dwordx4 v[208:211], v12, s[16:17]
    global_load_dwordx4 v[212:215], v12, s[16:17] offset:512
    global_load_dword v216, v13, s[16:17] offset:1024
    global_load_dwordx4 v[218:221], v12, s[20:21]
    global_load_dwordx4 v[222:225], v12, s[20:21] offset:512
    global_load_dword v226, v13, s[20:21] offset:1024
H_NOR:
    s_bitcmp1_b32 s3, 1
    s_cselect_b32 s46, 5, 4
    s_lshl_b32 s50, s46, 9
    v_add_u32 v15, s50, v252
    s_mul_i32 s46, s46, 294912
    s_add_u32 s46, s46, s63
    s_waitcnt lgkmcnt(0)
    s_barrier
    ds_read_b64_tr_b16 v[244:245], v15 offset:0
    ds_read_b64_tr_b16 v[246:247], v15 offset:256
    s_waitcnt lgkmcnt(0)
    v_add_u32 v244, v11, v244
    v_add_u32 v245, v11, v245
    v_add_u32 v246, v11, v246
    v_add_u32 v247, v11, v247
    v_and_or_b32 v244, v244, v9, v10
    v_and_or_b32 v245, v245, v9, v10
    v_and_or_b32 v246, v246, v9, v10
    v_and_or_b32 v247, v247, v9, v10
    buffer_store_dwordx4 v[244:247], v253, s[32:35], s46 offen sc1
    s_add_u32 s46, s63, 1769472
    s_bitcmp1_b32 s3, 1
    s_waitcnt lgkmcnt(0)
    s_barrier
    s_cbranch_scc1 YS15
    ds_read_b64_tr_b16 v[244:245], v252 offset:3072
    ds_read_b64_tr_b16 v[246:247], v252 offset:3328
    s_waitcnt lgkmcnt(0)
    v_add_u32 v244, v11, v244
    v_add_u32 v245, v11, v245
    v_add_u32 v246, v11, v246
    v_add_u32 v247, v11, v247
    v_and_or_b32 v244, v244, v9, v10
    v_and_or_b32 v245, v245, v9, v10
    v_and_or_b32 v246, v246, v9, v10
    v_and_or_b32 v247, v247, v9, v10
    buffer_store_dwordx4 v[244:247], v253, s[32:35], s46 offen sc1
YS15:
    s_add_u32 s46, s63, 2064384
    s_bitcmp1_b32 s3, 1
    s_waitcnt lgkmcnt(0)
    s_barrier
    s_cbranch_scc0 YS16
    ds_read_b64_tr_b16 v[244:245], v252 offset:3584
    ds_read_b64_tr_b16 v[246:247], v252 offset:3840
    s_waitcnt lgkmcnt(0)
    v_add_u32 v244, v11, v244
    v_add_u32 v245, v11, v245
    v_add_u32 v246, v11, v246
    v_add_u32 v247, v11, v247
    v_and_or_b32 v244, v244, v9, v10
    v_and_or_b32 v245, v245, v9, v10
    v_and_or_b32 v246, v246, v9, v10
    v_and_or_b32 v247, v247, v9, v10
    buffer_store_dwordx4 v[244:247], v253, s[32:35], s46 offen sc1
YS16:
RPREP:
    s_cmp_ge_u32 s49, 128
    s_cbranch_scc1 ZROLE
    ds_read_b128 v[72:75], v25
    ds_read_b128 v[76:79], v25 offset:512
    ds_read_b32 v80, v26 offset:1024
    v_lshlrev_b32 v38, 1, v12
    v_lshlrev_b32 v39, 1, v13
    s_mul_i32 s60, s49, 18432
    s_add_u32 s60, s60, 4194304
    s_add_u32 s61, s60, 8192
    s_add_u32 s62, s60, 16384
    v_mov_b32 v204, 0
    s_waitcnt vmcnt(1)
    s_cmp_ge_u32 s49, 64
    s_cbranch_scc1 RP_0
    buffer_load_dwordx4 v[140:143], v3, s[32:35], s60 offen sc1
    buffer_load_dwordx4 v[144:147], v3, s[32:35], s61 offen sc1
    s_cmp_ge_u32 s3, 2
    s_cbranch_scc1 YL17
    buffer_load_dwordx4 v[148:151], v3, s[32:35], s62 offen sc1
YL17:
RP_0:
    v_lshlrev_b32 v84, 16, v208
    v_and_b32 v85, 0xffff0000, v208
    v_lshlrev_b32 v120, 16, v218
    v_and_b32 v121, 0xffff0000, v218
    v_dot2c_f32_bf16 v204, v218, v8
    v_lshlrev_b32 v86, 16, v209
    v_and_b32 v87, 0xffff0000, v209
    v_lshlrev_b32 v122, 16, v219
    v_and_b32 v123, 0xffff0000, v219
    v_dot2c_f32_bf16 v204, v219, v8
    v_lshlrev_b32 v88, 16, v210
    v_and_b32 v89, 0xffff0000, v210
    v_lshlrev_b32 v124, 16, v220
    v_and_b32 v125, 0xffff0000, v220
    v_dot2c_f32_bf16 v204, v220, v8
    v_lshlrev_b32 v90, 16, v211
    v_and_b32 v91, 0xffff0000, v211
    v_lshlrev_b32 v126, 16, v221
    v_and_b32 v127, 0xffff0000, v221
    v_dot2c_f32_bf16 v204, v221, v8
    v_lshlrev_b32 v92, 16, v212
    v_and_b32 v93, 0xffff0000, v212
    v_lshlrev_b32 v128, 16, v222
    v_and_b32 v129, 0xffff0000, v222
    v_dot2c_f32_bf16 v204, v222, v8
    v_lshlrev_b32 v94, 16, v213
    v_and_b32 v95, 0xffff0000, v213
    v_lshlrev_b32 v130, 16, v223
    v_and_b32 v131, 0xffff0000, v223
    v_dot2c_f32_bf16 v204, v223, v8
    v_lshlrev_b32 v96, 16, v214
    v_and_b32 v97, 0xffff0000, v214
    v_lshlrev_b32 v132, 16, v224
    v_and_b32 v133, 0xffff0000, v224
    v_dot2c_f32_bf16 v204, v224, v8
    v_lshlrev_b32 v98, 16, v215
    v_and_b32 v99, 0xffff0000, v215
    v_lshlrev_b32 v134, 16, v225
    v_and_b32 v135, 0xffff0000, v225
    v_dot2c_f32_bf16 v204, v225, v8
    v_lshlrev_b32 v100, 16, v216
    v_and_b32 v101, 0xffff0000, v216
    v_lshlrev_b32 v136, 16, v226
    v_and_b32 v137, 0xffff0000, v226
    v_dot2c_f32_bf16 v204, v226, v8
    s_waitcnt lgkmcnt(0)
    v_and_b32 v72, v9, v72
    v_and_b32 v73, v9, v73
    v_and_b32 v74, v9, v74
    v_and_b32 v75, v9, v75
    v_and_b32 v76, v9, v76
    v_and_b32 v77, v9, v77
    v_and_b32 v78, v9, v78
    v_and_b32 v79, v9, v79
    v_and_b32 v80, v9, v80
    v_fma_mix_f32 v84, v72, v84, 0 op_sel:[0,0,0] op_sel_hi:[1,0,0]
    v_fma_mix_f32 v85, v72, v85, 0 op_sel:[1,0,0] op_sel_hi:[1,0,0]
    v_fma_mix_f32 v86, v73, v86, 0 op_sel:[0,0,0] op_sel_hi:[1,0,0]
    v_add_f32_dpp v204, v204, v204 row_ror:8 row_mask:0xf bank_mask:0xf
    v_fma_mix_f32 v87, v73, v87, 0 op_sel:[1,0,0] op_sel_hi:[1,0,0]
    v_fma_mix_f32 v88, v74, v88, 0 op_sel:[0,0,0] op_sel_hi:[1,0,0]
    v_fma_mix_f32 v89, v74, v89, 0 op_sel:[1,0,0] op_sel_hi:[1,0,0]
    v_fma_mix_f32 v90, v75, v90, 0 op_sel:[0,0,0] op_sel_hi:[1,0,0]
    v_fma_mix_f32 v91, v75, v91, 0 op_sel:[1,0,0] op_sel_hi:[1,0,0]
    v_add_f32_dpp v204, v204, v204 row_ror:4 row_mask:0xf bank_mask:0xf
    v_fma_mix_f32 v92, v76, v92, 0 op_sel:[0,0,0] op_sel_hi:[1,0,0]
    v_fma_mix_f32 v93, v76, v93, 0 op_sel:[1,0,0] op_sel_hi:[1,0,0]
    v_fma_mix_f32 v94, v77, v94, 0 op_sel:[0,0,0] op_sel_hi:[1,0,0]
    v_fma_mix_f32 v95, v77, v95, 0 op_sel:[1,0,0] op_sel_hi:[1,0,0]
    v_fma_mix_f32 v96, v78, v96, 0 op_sel:[0,0,0] op_sel_hi:[1,0,0]
    v_add_f32_dpp v204, v204, v204 row_ror:2 row_mask:0xf bank_mask:0xf
    v_fma_mix_f32 v97, v78, v97, 0 op_sel:[1,0,0] op_sel_hi:[1,0,0]
    v_fma_mix_f32 v98, v79, v98, 0 op_sel:[0,0,0] op_sel_hi:[1,0,0]
    v_fma_mix_f32 v99, v79, v99, 0 op_sel:[1,0,0] op_sel_hi:[1,0,0]
    v_fma_mix_f32 v100, v80, v100, 0 op_sel:[0,0,0] op_sel_hi:[1,0,0]
    v_fma_mix_f32 v101, v80, v101, 0 op_sel:[1,0,0] op_sel_hi:[1,0,0]
    v_add_f32_dpp v204, v204, v204 row_ror:1 row_mask:0xf bank_mask:0xf
    v_cvt_pk_bf16_f32 v84, 0, v84
    v_cvt_pk_bf16_f32 v85, 0, v85
    v_cvt_pk_bf16_f32 v86, 0, v86
    v_cvt_pk_bf16_f32 v87, 0, v87
    v_cvt_pk_bf16_f32 v88, 0, v88
    v_mov_b32 v37, v204
    v_cvt_pk_bf16_f32 v89, 0, v89
    v_cvt_pk_bf16_f32 v90, 0, v90
    v_cvt_pk_bf16_f32 v91, 0, v91
    v_cvt_pk_bf16_f32 v92, 0, v92
    v_cvt_pk_bf16_f32 v93, 0, v93
    v_permlane16_swap_b32 v204, v37
    v_cvt_pk_bf16_f32 v94, 0, v94
    v_cvt_pk_bf16_f32 v95, 0, v95
    v_cvt_pk_bf16_f32 v96, 0, v96
    v_cvt_pk_bf16_f32 v97, 0, v97
    v_cvt_pk_bf16_f32 v98, 0, v98
    v_add_f32 v204, v204, v37
    v_cvt_pk_bf16_f32 v99, 0, v99
    v_cvt_pk_bf16_f32 v100, 0, v100
    v_cvt_pk_bf16_f32 v101, 0, v101
    v_dot2_f32_bf16 v102, v16, v6, v84
    v_dot2_f32_bf16 v103, v16, v7, v85
    v_dot2_f32_bf16 v104, v17, v6, v86
    v_dot2_f32_bf16 v105, v17, v7, v87
    v_dot2_f32_bf16 v106, v18, v6, v88
    v_dot2_f32_bf16 v107, v18, v7, v89
    v_dot2_f32_bf16 v108, v19, v6, v90
    v_dot2_f32_bf16 v109, v19, v7, v91
    v_dot2_f32_bf16 v110, v20, v6, v92
    v_dot2_f32_bf16 v111, v20, v7, v93
    v_dot2_f32_bf16 v112, v21, v6, v94
    v_dot2_f32_bf16 v113, v21, v7, v95
    v_dot2_f32_bf16 v114, v22, v6, v96
    v_dot2_f32_bf16 v115, v22, v7, v97
    v_dot2_f32_bf16 v116, v23, v6, v98
    v_dot2_f32_bf16 v117, v23, v7, v99
    v_dot2_f32_bf16 v118, v24, v6, v100
    v_dot2_f32_bf16 v119, v24, v7, v101
    s_cmp_lt_u32 s2, 144
    s_cbranch_scc1 RP_1
    s_and_b32 s46, s2, 7
    s_sub_u32 s48, s2, 216
    s_lshr_b32 s48, s48, 3
    v_lshrrev_b32 v37, 3, v0
    v_mul_u32_u24 v37, 9216, v37
    v_and_b32 v36, 7, v0
    v_lshl_add_u32 v37, v36, 4, v37
    s_cmp_ge_u32 s46, 4
    s_cselect_b32 s50, 1, 0
    s_add_u32 s50, s50, s46
    s_lshl_b32 s50, s50, 10
    s_add_u32 s50, s50, 384
    s_lshr_b32 s53, s48, 1
    s_sub_u32 s53, 8, s53
    s_mul_i32 s53, s53, 589824
    s_add_u32 s50, s50, s53
    v_add_u32 v36, s50, v37
    s_bitcmp1_b32 s48, 0
    s_cselect_b32 s56, s24, s22
    s_cselect_b32 s57, s25, s23
    global_load_dwordx4 v[140:143], v36, s[56:57] nt
    s_cmp_lg_u32 s46, 3
    s_cbranch_scc1 PF_0
    global_load_dwordx4 v[144:147], v36, s[56:57] offset:1024 nt
PF_0:
    v_subrev_u32 v36, 1179648, v36
    global_load_dwordx4 v[140:143], v36, s[56:57] nt
    s_cmp_lg_u32 s46, 3
    s_cbranch_scc1 PF_1
    global_load_dwordx4 v[144:147], v36, s[56:57] offset:1024 nt
PF_1:
    v_subrev_u32 v36, 1179648, v36
    global_load_dwordx4 v[140:143], v36, s[56:57] nt
    s_cmp_lg_u32 s46, 3
    s_cbranch_scc1 PF_2
    global_load_dwordx4 v[144:147], v36, s[56:57] offset:1024 nt
PF_2:
    v_subrev_u32 v36, 1179648, v36
    s_waitcnt vmcnt(0)
    s_cmp_ge_u32 s3, 4
    s_cbranch_scc1 RP_S
    s_lshl_b32 s57, s51, 6
    v_add_u32 v14, s57, v1
    v_min_u32 v14, 143, v14
    v_lshlrev_b32 v27, 7, v14
    v_lshlrev_b32 v14, 4, v14
    s_mov_b32 s53, 32768
    buffer_load_dwordx4 v[32:35], v27, s[32:35], s53 offen sc1
    s_and_b32 s56, s40, 0x7fffff
    s_mov_b32 s47, 0
    s_waitcnt vmcnt(0)
SCP18:
    v_xor_b32 v32, s56, v32
    v_xor_b32 v33, s56, v33
    v_xor_b32 v34, s56, v34
    v_xor_b32 v35, s56, v35
    v_or3_b32 v255, v32, v33, v34
    v_or_b32 v255, v255, v35
    v_and_b32 v255, 0x7fffff, v255
    v_cmp_ne_u32 vcc, 0, v255
    s_cbranch_vccz SCD19
    s_add_u32 s47, s47, 1
    s_cmp_ge_u32 s47, 65536
    s_cbranch_scc1 SCD19
    s_sleep 8
    buffer_load_dwordx4 v[32:35], v27, s[32:35], s53 offen sc1
    s_waitcnt vmcnt(0)
    s_branch SCP18
SCD19:
    ds_write_b128 v14, v[32:35] offset:46080
RP_S:
    s_waitcnt lgkmcnt(0)
    s_barrier
RP_1:
    s_cmp_lt_u32 s49, 64
    s_cbranch_scc1 RP_2
    buffer_load_dwordx4 v[140:143], v3, s[32:35], s60 offen sc1
    buffer_load_dwordx4 v[144:147], v3, s[32:35], s61 offen sc1
    s_cmp_ge_u32 s3, 2
    s_cbranch_scc1 YL20
    buffer_load_dwordx4 v[148:151], v3, s[32:35], s62 offen sc1
YL20:
RP_2:
    ds_read_b128 v[52:55], v38 offset:46080
    ds_read_b128 v[56:59], v38 offset:46096
    ds_read_b128 v[60:63], v38 offset:47104
    ds_read_b128 v[64:67], v38 offset:47120
    ds_read_b64 v[68:69], v39 offset:48128
    v_and_b32 v36, 7, v0
    v_mul_u32_u24 v36, 2320, v36
    v_lshrrev_b32 v37, 3, v0
    v_lshl_add_u32 v36, v37, 4, v36
    v_lshrrev_b32 v37, 5, v1
    s_mul_i32 s46, s3, 2320
    s_add_u32 s46, s46, 49152
    v_lshl_add_u32 v37, v37, 3, s46
    v_lshl_add_u32 v38, v12, 1, v37
    v_bfe_u32 v39, v1, 1, 4
    v_lshl_add_u32 v39, v39, 4, v37
    v_and_b32 v37, 1, v1
    v_lshl_add_u32 v39, v37, 2, v39
    v_lshrrev_b32 v35, 5, v1
    v_lshlrev_b32 v35, 5, v35
    s_lshl_b32 s46, s3, 2
    s_add_u32 s46, s46, 163584
    v_add_u32 v35, s46, v35
    v_and_b32 v40, 15, v1
    v_lshlrev_b32 v34, 2, v40
    v_add_u32 v34, 163584, v34
    v_and_b32 v42, 48, v2
    v_add_u32 v41, 163584, v42
    v_lshrrev_b32 v43, 2, v1
    v_lshl_add_u32 v42, v43, 14, v42
    s_and_b32 s63, s40, 0xffff
    s_or_b32 s53, s63, 0x80000000
    s_lshl_b32 s54, s49, 6
    s_add_u32 s54, s54, 9437184
    s_mov_b32 s58, 1
    s_mov_b32 s59, 1
    s_lshl_b32 s46, s49, 4
    s_sub_u32 s46, 0xffff, s46
    v_sub_u32 v44, s46, v40
    v_mov_b32 v45, 0xffff0000
    v_lshrrev_b32 v46, 5, v1
    v_mul_u32_u24 v46, 12288, v46
    s_mul_i32 s46, s3, 1536
    v_add3_u32 v46, v46, v12, s46
    v_lshrrev_b32 v47, 2, v0
    v_and_b32 v48, 3, v0
    v_lshlrev_b32 v48, 4, v48
    v_lshl_add_u32 v47, v47, 6, v48
    v_mov_b32 v183, s40
    v_mov_b32 v187, s40
    v_mov_b32 v191, s40
    v_lshlrev_b32 v49, 2, v0
    v_sub_u32 v232, 0xffff, v49
    v_subrev_u32 v233, 1, v232
    v_subrev_u32 v234, 2, v232
    v_subrev_u32 v235, 3, v232
    v_mov_b32 v48, s63
    v_mov_b32 v49, 163648
    v_mov_b32 v50, -1
    s_cmp_ge_u32 s3, 2
    s_cbranch_scc1 RP_3
    s_mov_b32 s47, 0
PL21:
    s_waitcnt vmcnt(0)
    v_xor_b32 v140, v10, v140
    v_xor_b32 v141, v10, v141
    v_xor_b32 v142, v10, v142
    v_xor_b32 v143, v10, v143
    v_xor_b32 v144, v10, v144
    v_xor_b32 v145, v10, v145
    v_xor_b32 v146, v10, v146
    v_xor_b32 v147, v10, v147
    v_xor_b32 v148, v10, v148
    v_xor_b32 v149, v10, v149
    v_xor_b32 v150, v10, v150
    v_xor_b32 v151, v10, v151
    v_or3_b32 v37, v140, v141, v142
    v_or3_b32 v37, v37, v143, v144
    v_or3_b32 v37, v37, v145, v146
    v_or3_b32 v37, v37, v147, v148
    v_or3_b32 v37, v37, v149, v150
    v_or_b32 v37, v37, v151
    v_and_b32 v37, 0x70007, v37
    v_cmp_ne_u32 vcc, 0, v37
    s_cbranch_vccz PD22
    s_add_u32 s47, s47, 1
    s_cmp_ge_u32 s47, 65536
    s_cbranch_scc1 PD22
    s_sleep 1
    buffer_load_dwordx4 v[140:143], v3, s[32:35], s60 offen sc1
    buffer_load_dwordx4 v[144:147], v3, s[32:35], s61 offen sc1
    buffer_load_dwordx4 v[148:151], v3, s[32:35], s62 offen sc1
    s_branch PL21
PD22:
    ds_write_b128 v36, v[148:151] offset:51200
    s_branch RP_4
RP_3:
    s_mov_b32 s47, 0
PL23:
    s_waitcnt vmcnt(0)
    v_xor_b32 v140, v10, v140
    v_xor_b32 v141, v10, v141
    v_xor_b32 v142, v10, v142
    v_xor_b32 v143, v10, v143
    v_xor_b32 v144, v10, v144
    v_xor_b32 v145, v10, v145
    v_xor_b32 v146, v10, v146
    v_xor_b32 v147, v10, v147
    v_or3_b32 v37, v140, v141, v142
    v_or3_b32 v37, v37, v143, v144
    v_or3_b32 v37, v37, v145, v146
    v_or_b32 v37, v37, v147
    v_and_b32 v37, 0x70007, v37
    v_cmp_ne_u32 vcc, 0, v37
    s_cbranch_vccz PD24
    s_add_u32 s47, s47, 1
    s_cmp_ge_u32 s47, 65536
    s_cbranch_scc1 PD24
    s_sleep 1
    buffer_load_dwordx4 v[140:143], v3, s[32:35], s60 offen sc1
    buffer_load_dwordx4 v[144:147], v3, s[32:35], s61 offen sc1
    s_branch PL23
PD24:
RP_4:
    ds_write_b128 v36, v[140:143] offset:49152
    ds_write_b128 v36, v[144:147] offset:50176
    s_waitcnt lgkmcnt(0)
    s_barrier
    ds_read2_b64 v[152:155], v38 offset0:0 offset1:2
    ds_read2_b64 v[156:159], v38 offset0:128 offset1:130
    ds_read_b32 v160, v39 offset:2048
    s_getreg_b32 s60, hwreg(HW_REG_XCC_ID, 0, 3)
    s_mul_i32 s60, s60, 16384
    s_add_u32 s60, s60, 9437184
    s_lshl_b32 s61, s3, 14
    s_add_u32 s61, s61, 9830400
    s_waitcnt lgkmcnt(2)
    v_fma_mix_f32 v162, v152, v52, v102 op_sel:[0,0,0] op_sel_hi:[1,0,0]
    v_fma_mix_f32 v163, v152, v53, v103 op_sel:[1,0,0] op_sel_hi:[1,0,0]
    v_fma_mix_f32 v164, v153, v54, v104 op_sel:[0,0,0] op_sel_hi:[1,0,0]
    v_fma_mix_f32 v165, v153, v55, v105 op_sel:[1,0,0] op_sel_hi:[1,0,0]
    v_pk_mul_f32 v[30:31], v[162:163], v[162:163]
    v_pk_mul_f32 v[32:33], v[162:163], v[120:121]
    v_fma_mix_f32 v166, v154, v56, v106 op_sel:[0,0,0] op_sel_hi:[1,0,0]
    v_fma_mix_f32 v167, v154, v57, v107 op_sel:[1,0,0] op_sel_hi:[1,0,0]
    v_pk_add_f32 v[28:29], v[162:163], v[164:165]
    v_pk_fma_f32 v[30:31], v[164:165], v[164:165], v[30:31]
    v_pk_fma_f32 v[32:33], v[164:165], v[122:123], v[32:33]
    v_fma_mix_f32 v168, v155, v58, v108 op_sel:[0,0,0] op_sel_hi:[1,0,0]
    v_fma_mix_f32 v169, v155, v59, v109 op_sel:[1,0,0] op_sel_hi:[1,0,0]
    v_pk_add_f32 v[28:29], v[28:29], v[166:167]
    v_pk_fma_f32 v[30:31], v[166:167], v[166:167], v[30:31]
    v_pk_fma_f32 v[32:33], v[166:167], v[124:125], v[32:33]
    s_waitcnt lgkmcnt(1)
    v_fma_mix_f32 v170, v156, v60, v110 op_sel:[0,0,0] op_sel_hi:[1,0,0]
    v_fma_mix_f32 v171, v156, v61, v111 op_sel:[1,0,0] op_sel_hi:[1,0,0]
    v_pk_add_f32 v[28:29], v[28:29], v[168:169]
    v_pk_fma_f32 v[30:31], v[168:169], v[168:169], v[30:31]
    v_pk_fma_f32 v[32:33], v[168:169], v[126:127], v[32:33]
    v_fma_mix_f32 v172, v157, v62, v112 op_sel:[0,0,0] op_sel_hi:[1,0,0]
    v_fma_mix_f32 v173, v157, v63, v113 op_sel:[1,0,0] op_sel_hi:[1,0,0]
    v_pk_add_f32 v[28:29], v[28:29], v[170:171]
    v_pk_fma_f32 v[30:31], v[170:171], v[170:171], v[30:31]
    v_pk_fma_f32 v[32:33], v[170:171], v[128:129], v[32:33]
    v_fma_mix_f32 v174, v158, v64, v114 op_sel:[0,0,0] op_sel_hi:[1,0,0]
    v_fma_mix_f32 v175, v158, v65, v115 op_sel:[1,0,0] op_sel_hi:[1,0,0]
    v_pk_add_f32 v[28:29], v[28:29], v[172:173]
    v_pk_fma_f32 v[30:31], v[172:173], v[172:173], v[30:31]
    v_pk_fma_f32 v[32:33], v[172:173], v[130:131], v[32:33]
    v_fma_mix_f32 v176, v159, v66, v116 op_sel:[0,0,0] op_sel_hi:[1,0,0]
    v_fma_mix_f32 v177, v159, v67, v117 op_sel:[1,0,0] op_sel_hi:[1,0,0]
    v_pk_add_f32 v[28:29], v[28:29], v[174:175]
    v_pk_fma_f32 v[30:31], v[174:175], v[174:175], v[30:31]
    v_pk_fma_f32 v[32:33], v[174:175], v[132:133], v[32:33]
    s_waitcnt lgkmcnt(0)
    v_fma_mix_f32 v178, v160, v68, v118 op_sel:[0,0,0] op_sel_hi:[1,0,0]
    v_fma_mix_f32 v179, v160, v69, v119 op_sel:[1,0,0] op_sel_hi:[1,0,0]
    v_pk_add_f32 v[28:29], v[28:29], v[176:177]
    v_pk_fma_f32 v[30:31], v[176:177], v[176:177], v[30:31]
    v_pk_fma_f32 v[32:33], v[176:177], v[134:135], v[32:33]
    v_pk_add_f32 v[28:29], v[28:29], v[178:179]
    v_pk_fma_f32 v[30:31], v[178:179], v[178:179], v[30:31]
    v_pk_fma_f32 v[32:33], v[178:179], v[136:137], v[32:33]
    v_add_f32 v28, v28, v29
    v_add_f32 v30, v30, v31
    v_add_f32 v32, v32, v33
    s_nop 0
    v_permlane16_swap_b32 v28, v30
    v_add_f32 v28, v28, v30
    v_add_f32_dpp v32, v32, v32 row_ror:8 row_mask:0xf bank_mask:0xf
    s_nop 0
    v_add_f32_dpp v28, v28, v28 row_ror:8 row_mask:0xf bank_mask:0xf
    v_add_f32_dpp v32, v32, v32 row_ror:4 row_mask:0xf bank_mask:0xf
    s_nop 0
    v_add_f32_dpp v28, v28, v28 row_ror:4 row_mask:0xf bank_mask:0xf
    v_add_f32_dpp v32, v32, v32 row_ror:2 row_mask:0xf bank_mask:0xf
    s_nop 0
    v_add_f32_dpp v28, v28, v28 row_ror:2 row_mask:0xf bank_mask:0xf
    v_add_f32_dpp v32, v32, v32 row_ror:1 row_mask:0xf bank_mask:0xf
    s_nop 0
    v_add_f32_dpp v28, v28, v28 row_ror:1 row_mask:0xf bank_mask:0xf
    v_mov_b32 v33, v32
    v_mov_b32 v30, v28
    s_nop 1
    v_permlane16_swap_b32 v28, v30
    v_permlane16_swap_b32 v32, v33
    v_add_f32 v32, v32, v33
    v_mul_f32 v28, 0x3ae38e39, v28
    v_mul_f32 v30, 0x3ae38e39, v30
    v_fma_f32 v30, -v28, v28, v30
    v_cvt_pk_bf16_f32 v200, 0, v28
    v_max_f32 v30, 0, v30
    v_cvt_pk_bf16_f32 v30, 0, v30
    v_add_f32 v30, 0x3727c5ac, v30
    v_cvt_pk_bf16_f32 v30, 0, v30
    v_sqrt_f32 v30, v30
    s_nop 0
    v_cvt_pk_bf16_f32 v30, 0, v30
    v_rcp_f32 v202, v30
    v_fma_f32 v32, -v200, v204, v32
    v_mul_f32 v32, v32, v202
    v_cvt_pk_bf16_f32 v236, 0, v32
    v_ashrrev_i32 v28, 31, v236
    v_and_b32 v28, 0x7fff0000, v28
    v_xor_b32 v28, v28, v236
    v_xor_b32 v28, s53, v28
    s_mov_b64 exec, s[58:59]
    ds_write_b32 v35, v28
    s_mov_b64 exec, -1
    s_waitcnt lgkmcnt(0)
    s_barrier
    s_cmp_lg_u32 s3, 0
    s_cbranch_scc1 L2_NOKEY
    s_mov_b32 exec_hi, 0
    ds_read_b128 v[28:31], v41
    s_waitcnt lgkmcnt(0)
    buffer_store_dwordx4 v[28:31], v42, s[32:35], s54 offen sc1
    s_mov_b64 exec, -1
L2_NOKEY:
    ds_read_b32 v205, v34
    v_fma_mix_f32 v162, v152, v52, v84 op_sel:[0,0,0] op_sel_hi:[1,0,0]
    v_fma_mix_f32 v163, v152, v53, v85 op_sel:[1,0,0] op_sel_hi:[1,0,0]
    v_fma_mix_f32 v164, v153, v54, v86 op_sel:[0,0,0] op_sel_hi:[1,0,0]
    v_fma_mix_f32 v165, v153, v55, v87 op_sel:[1,0,0] op_sel_hi:[1,0,0]
    v_fma_mix_f32 v166, v154, v56, v88 op_sel:[0,0,0] op_sel_hi:[1,0,0]
    v_fma_mix_f32 v167, v154, v57, v89 op_sel:[1,0,0] op_sel_hi:[1,0,0]
    v_fma_mix_f32 v168, v155, v58, v90 op_sel:[0,0,0] op_sel_hi:[1,0,0]
    v_fma_mix_f32 v169, v155, v59, v91 op_sel:[1,0,0] op_sel_hi:[1,0,0]
    v_fma_mix_f32 v170, v156, v60, v92 op_sel:[0,0,0] op_sel_hi:[1,0,0]
    v_fma_mix_f32 v171, v156, v61, v93 op_sel:[1,0,0] op_sel_hi:[1,0,0]
    v_fma_mix_f32 v172, v157, v62, v94 op_sel:[0,0,0] op_sel_hi:[1,0,0]
    v_fma_mix_f32 v173, v157, v63, v95 op_sel:[1,0,0] op_sel_hi:[1,0,0]
    v_fma_mix_f32 v174, v158, v64, v96 op_sel:[0,0,0] op_sel_hi:[1,0,0]
    v_fma_mix_f32 v175, v158, v65, v97 op_sel:[1,0,0] op_sel_hi:[1,0,0]
    v_fma_mix_f32 v176, v159, v66, v98 op_sel:[0,0,0] op_sel_hi:[1,0,0]
    v_fma_mix_f32 v177, v159, v67, v99 op_sel:[1,0,0] op_sel_hi:[1,0,0]
    v_fma_mix_f32 v178, v160, v68, v100 op_sel:[0,0,0] op_sel_hi:[1,0,0]
    v_fma_mix_f32 v179, v160, v69, v101 op_sel:[1,0,0] op_sel_hi:[1,0,0]
    v_cvt_pk_bf16_f32 v162, 0, v162
    v_cvt_pk_bf16_f32 v163, 0, v163
    v_cvt_pk_bf16_f32 v164, 0, v164
    v_cvt_pk_bf16_f32 v165, 0, v165
    v_cvt_pk_bf16_f32 v166, 0, v166
    v_cvt_pk_bf16_f32 v167, 0, v167
    v_cvt_pk_bf16_f32 v168, 0, v168
    v_cvt_pk_bf16_f32 v169, 0, v169
    v_cvt_pk_bf16_f32 v170, 0, v170
    v_cvt_pk_bf16_f32 v171, 0, v171
    v_cvt_pk_bf16_f32 v172, 0, v172
    v_cvt_pk_bf16_f32 v173, 0, v173
    v_cvt_pk_bf16_f32 v174, 0, v174
    v_cvt_pk_bf16_f32 v175, 0, v175
    v_cvt_pk_bf16_f32 v176, 0, v176
    v_cvt_pk_bf16_f32 v177, 0, v177
    v_cvt_pk_bf16_f32 v178, 0, v178
    v_cvt_pk_bf16_f32 v179, 0, v179
    v_dot2_f32_bf16 v162, v16, v6, v162
    v_dot2_f32_bf16 v163, v16, v7, v163
    v_dot2_f32_bf16 v164, v17, v6, v164
    v_dot2_f32_bf16 v165, v17, v7, v165
    v_dot2_f32_bf16 v166, v18, v6, v166
    v_dot2_f32_bf16 v167, v18, v7, v167
    v_dot2_f32_bf16 v168, v19, v6, v168
    v_dot2_f32_bf16 v169, v19, v7, v169
    v_dot2_f32_bf16 v170, v20, v6, v170
    v_dot2_f32_bf16 v171, v20, v7, v171
    v_dot2_f32_bf16 v172, v21, v6, v172
    v_dot2_f32_bf16 v173, v21, v7, v173
    v_dot2_f32_bf16 v174, v22, v6, v174
    v_dot2_f32_bf16 v175, v22, v7, v175
    v_dot2_f32_bf16 v176, v23, v6, v176
    v_dot2_f32_bf16 v177, v23, v7, v177
    v_dot2_f32_bf16 v178, v24, v6, v178
    v_dot2_f32_bf16 v179, v24, v7, v179
    v_cvt_pk_bf16_f32 v162, 0, v162
    v_cvt_pk_bf16_f32 v163, 0, v163
    v_cvt_pk_bf16_f32 v164, 0, v164
    v_cvt_pk_bf16_f32 v165, 0, v165
    v_cvt_pk_bf16_f32 v166, 0, v166
    v_cvt_pk_bf16_f32 v167, 0, v167
    v_cvt_pk_bf16_f32 v168, 0, v168
    v_cvt_pk_bf16_f32 v169, 0, v169
    v_cvt_pk_bf16_f32 v170, 0, v170
    v_cvt_pk_bf16_f32 v171, 0, v171
    v_cvt_pk_bf16_f32 v172, 0, v172
    v_cvt_pk_bf16_f32 v173, 0, v173
    v_cvt_pk_bf16_f32 v174, 0, v174
    v_cvt_pk_bf16_f32 v175, 0, v175
    v_cvt_pk_bf16_f32 v176, 0, v176
    v_cvt_pk_bf16_f32 v177, 0, v177
    v_cvt_pk_bf16_f32 v178, 0, v178
    v_cvt_pk_bf16_f32 v179, 0, v179
    v_pk_add_f32 v[102:103], v[162:163], v[200:201] op_sel_hi:[1,0] neg_lo:[0,1] neg_hi:[0,1]
    v_pk_add_f32 v[104:105], v[164:165], v[200:201] op_sel_hi:[1,0] neg_lo:[0,1] neg_hi:[0,1]
    v_pk_add_f32 v[106:107], v[166:167], v[200:201] op_sel_hi:[1,0] neg_lo:[0,1] neg_hi:[0,1]
    v_pk_add_f32 v[108:109], v[168:169], v[200:201] op_sel_hi:[1,0] neg_lo:[0,1] neg_hi:[0,1]
    v_pk_add_f32 v[110:111], v[170:171], v[200:201] op_sel_hi:[1,0] neg_lo:[0,1] neg_hi:[0,1]
    v_pk_add_f32 v[112:113], v[172:173], v[200:201] op_sel_hi:[1,0] neg_lo:[0,1] neg_hi:[0,1]
    v_pk_add_f32 v[114:115], v[174:175], v[200:201] op_sel_hi:[1,0] neg_lo:[0,1] neg_hi:[0,1]
    v_pk_add_f32 v[116:117], v[176:177], v[200:201] op_sel_hi:[1,0] neg_lo:[0,1] neg_hi:[0,1]
    v_pk_add_f32 v[118:119], v[178:179], v[200:201] op_sel_hi:[1,0] neg_lo:[0,1] neg_hi:[0,1]
    v_cvt_pk_bf16_f32 v102, 0, v102
    v_cvt_pk_bf16_f32 v103, 0, v103
    v_cvt_pk_bf16_f32 v104, 0, v104
    v_cvt_pk_bf16_f32 v105, 0, v105
    v_cvt_pk_bf16_f32 v106, 0, v106
    v_cvt_pk_bf16_f32 v107, 0, v107
    v_cvt_pk_bf16_f32 v108, 0, v108
    v_cvt_pk_bf16_f32 v109, 0, v109
    v_cvt_pk_bf16_f32 v110, 0, v110
    buffer_load_dwordx4 v[228:231], v47, s[32:35], s60 offen sc1
    v_cvt_pk_bf16_f32 v111, 0, v111
    v_cvt_pk_bf16_f32 v112, 0, v112
    v_cvt_pk_bf16_f32 v113, 0, v113
    v_cvt_pk_bf16_f32 v114, 0, v114
    v_cvt_pk_bf16_f32 v115, 0, v115
    v_cvt_pk_bf16_f32 v116, 0, v116
    v_cvt_pk_bf16_f32 v117, 0, v117
    v_cvt_pk_bf16_f32 v118, 0, v118
    v_cvt_pk_bf16_f32 v119, 0, v119
    v_pk_mul_f32 v[102:103], v[102:103], v[202:203] op_sel_hi:[1,0]
    v_pk_mul_f32 v[104:105], v[104:105], v[202:203] op_sel_hi:[1,0]
    v_pk_mul_f32 v[106:107], v[106:107], v[202:203] op_sel_hi:[1,0]
    v_pk_mul_f32 v[108:109], v[108:109], v[202:203] op_sel_hi:[1,0]
    v_pk_mul_f32 v[110:111], v[110:111], v[202:203] op_sel_hi:[1,0]
    v_pk_mul_f32 v[112:113], v[112:113], v[202:203] op_sel_hi:[1,0]
    v_pk_mul_f32 v[114:115], v[114:115], v[202:203] op_sel_hi:[1,0]
    v_pk_mul_f32 v[116:117], v[116:117], v[202:203] op_sel_hi:[1,0]
    v_pk_mul_f32 v[118:119], v[118:119], v[202:203] op_sel_hi:[1,0]
    s_waitcnt lgkmcnt(0)
    v_and_or_b32 v205, v205, v45, v44
    v_mov_b32 v206, v205
    v_cvt_pk_bf16_f32 v180, v102, v103
    s_nop 0
    v_max_u32_dpp v206, v206, v206 row_ror:8 row_mask:0xf bank_mask:0xf
    v_cvt_pk_bf16_f32 v181, v104, v105
    s_nop 0
    v_max_u32_dpp v206, v206, v206 row_ror:4 row_mask:0xf bank_mask:0xf
    v_cvt_pk_bf16_f32 v182, v106, v107
    s_nop 0
    v_max_u32_dpp v206, v206, v206 row_ror:2 row_mask:0xf bank_mask:0xf
    s_nop 1
    v_max_u32_dpp v206, v206, v206 row_ror:1 row_mask:0xf bank_mask:0xf
    ds_write_b128 v46, v[180:183]
    v_readfirstlane_b32 s56, v206
    v_cvt_pk_bf16_f32 v184, v108, v109
    v_cmp_ne_u32 vcc, v206, v205
    v_cvt_pk_bf16_f32 v185, v110, v111
    s_nop 0
    v_cndmask_b32 v205, 0, v205, vcc
    v_mov_b32 v206, v205
    v_cvt_pk_bf16_f32 v186, v112, v113
    s_nop 0
    v_max_u32_dpp v206, v206, v206 row_ror:8 row_mask:0xf bank_mask:0xf
    ds_write_b128 v46, v[184:187] offset:512
    s_nop 0
    v_max_u32_dpp v206, v206, v206 row_ror:4 row_mask:0xf bank_mask:0xf
    v_cvt_pk_bf16_f32 v188, v114, v115
    s_nop 0
    v_max_u32_dpp v206, v206, v206 row_ror:2 row_mask:0xf bank_mask:0xf
    s_nop 1
    v_max_u32_dpp v206, v206, v206 row_ror:1 row_mask:0xf bank_mask:0xf
    v_cvt_pk_bf16_f32 v189, v116, v117
    v_readfirstlane_b32 s57, v206
    v_cvt_pk_bf16_f32 v190, v118, v119
    v_cmp_ne_u32 vcc, v206, v205
    ds_write_b128 v46, v[188:191] offset:1024
    s_nop 0
    v_cndmask_b32 v205, 0, v205, vcc
    s_waitcnt lgkmcnt(0)
    s_barrier
    s_andn2_b32 s46, 15, s56
    s_mul_i32 s46, s46, 1536
    v_add_u32 v37, s46, v2
    ds_read_b128 v[120:123], v37
    ds_read_b128 v[124:127], v37 offset:1024
    s_andn2_b32 s46, 15, s57
    s_mul_i32 s46, s46, 1536
    v_add_u32 v37, s46, v2
    ds_read_b128 v[128:131], v37
    ds_read_b128 v[132:135], v37 offset:1024
    s_mov_b32 s47, 0
PL25:
    s_waitcnt vmcnt(0)
    v_xor_b32 v228, v48, v228
    v_xor_b32 v229, v48, v229
    v_xor_b32 v230, v48, v230
    v_xor_b32 v231, v48, v231
    v_or3_b32 v37, v228, v229, v230
    v_or_b32 v37, v37, v231
    v_and_b32 v37, 0xffff, v37
    v_cmp_ne_u32 vcc, 0, v37
    s_cbranch_vccz PD26
    s_add_u32 s47, s47, 1
    s_cmp_ge_u32 s47, 65536
    s_cbranch_scc1 PD26
    s_sleep 1
    buffer_load_dwordx4 v[228:231], v47, s[32:35], s60 offen sc1
    s_branch PL25
PD26:
    v_or_b32 v228, v228, v232
    v_or_b32 v229, v229, v233
    v_or_b32 v230, v230, v234
    v_or_b32 v231, v231, v235
RK_LOOP:
    v_cmp_lt_u32 s[4:5], s56, v228
    v_cmp_lt_u32 s[6:7], s56, v229
    v_cmp_lt_u32 s[8:9], s56, v230
    v_cmp_lt_u32 s[10:11], s56, v231
    v_cmp_lt_u32 s[12:13], s57, v228
    v_cmp_lt_u32 s[14:15], s57, v229
    v_cmp_lt_u32 s[16:17], s57, v230
    v_cmp_lt_u32 s[18:19], s57, v231
    s_bcnt1_i32_b64 s4, s[4:5]
    s_bcnt1_i32_b64 s6, s[6:7]
    s_bcnt1_i32_b64 s8, s[8:9]
    s_bcnt1_i32_b64 s10, s[10:11]
    s_add_u32 s4, s4, s6
    s_add_u32 s8, s8, s10
    s_add_u32 s46, s4, s8
    s_bcnt1_i32_b64 s12, s[12:13]
    s_bcnt1_i32_b64 s14, s[14:15]
    s_bcnt1_i32_b64 s16, s[16:17]
    s_bcnt1_i32_b64 s18, s[18:19]
    s_add_u32 s12, s12, s14
    s_add_u32 s16, s16, s18
    s_add_u32 s48, s12, s16
    s_pack_ll_b32_b16 s46, s46, s48
    v_mov_b32 v37, s46
    s_mov_b64 exec, 1
    ds_add_u32 v49, v37
    s_mov_b64 exec, -1
    s_waitcnt lgkmcnt(0)
    s_barrier
    ds_read_b32 v37, v49
    v_add_u32 v49, 4, v49
    s_waitcnt lgkmcnt(0)
    v_readfirstlane_b32 s53, v37
    s_and_b32 s54, s53, 0xffff
    s_cmp_ge_u32 s54, 8
    s_cbranch_scc1 RK_DONE
    s_mul_i32 s48, s54, 1536
    s_add_u32 s48, s48, s61
    buffer_store_dwordx4 v[120:123], v2, s[32:35], s48 offen sc1
    s_mov_b32 exec_hi, 0
    buffer_store_dwordx4 v[124:127], v2, s[32:35], s48 offen offset:1024 sc1
    s_mov_b64 exec, -1
    s_andn2_b32 s46, 0xffff, s56
    s_and_b32 s48, s46, 7
    s_cmp_lg_u32 s48, s3
    s_cbranch_scc1 RK_N27
    s_bitcmp1_b32 s46, 3
    s_cselect_b32 exec_lo, 0, -1
    s_cselect_b32 exec_hi, -1, 0
    v_mov_b32 v50, s54
    v_mov_b32 v51, s46
    s_mov_b64 exec, -1
RK_N27:
    s_lshr_b32 s54, s53, 16
    s_cmp_ge_u32 s54, 8
    s_cbranch_scc1 RK_DONE
    s_mul_i32 s48, s54, 1536
    s_add_u32 s48, s48, s61
    buffer_store_dwordx4 v[128:131], v2, s[32:35], s48 offen sc1
    s_mov_b32 exec_hi, 0
    buffer_store_dwordx4 v[132:135], v2, s[32:35], s48 offen offset:1024 sc1
    s_mov_b64 exec, -1
    s_andn2_b32 s46, 0xffff, s57
    s_and_b32 s48, s46, 7
    s_cmp_lg_u32 s48, s3
    s_cbranch_scc1 RK_N28
    s_bitcmp1_b32 s46, 3
    s_cselect_b32 exec_lo, 0, -1
    s_cselect_b32 exec_hi, -1, 0
    v_mov_b32 v50, s54
    v_mov_b32 v51, s46
    s_mov_b64 exec, -1
RK_N28:
    v_mov_b32 v206, v205
    s_nop 1
    v_max_u32_dpp v206, v206, v206 row_ror:8 row_mask:0xf bank_mask:0xf
    s_nop 1
    v_max_u32_dpp v206, v206, v206 row_ror:4 row_mask:0xf bank_mask:0xf
    s_nop 1
    v_max_u32_dpp v206, v206, v206 row_ror:2 row_mask:0xf bank_mask:0xf
    s_nop 1
    v_max_u32_dpp v206, v206, v206 row_ror:1 row_mask:0xf bank_mask:0xf
    s_nop 0
    v_readfirstlane_b32 s56, v206
    v_cmp_ne_u32 vcc, v206, v205
    s_nop 1
    v_cndmask_b32 v205, 0, v205, vcc
    v_mov_b32 v206, v205
    s_nop 1
    v_max_u32_dpp v206, v206, v206 row_ror:8 row_mask:0xf bank_mask:0xf
    s_nop 1
    v_max_u32_dpp v206, v206, v206 row_ror:4 row_mask:0xf bank_mask:0xf
    s_nop 1
    v_max_u32_dpp v206, v206, v206 row_ror:2 row_mask:0xf bank_mask:0xf
    s_nop 1
    v_max_u32_dpp v206, v206, v206 row_ror:1 row_mask:0xf bank_mask:0xf
    s_nop 0
    v_readfirstlane_b32 s57, v206
    v_cmp_ne_u32 vcc, v206, v205
    s_nop 1
    v_cndmask_b32 v205, 0, v205, vcc
    s_andn2_b32 s46, 15, s56
    s_mul_i32 s46, s46, 1536
    v_add_u32 v37, s46, v2
    ds_read_b128 v[120:123], v37
    ds_read_b128 v[124:127], v37 offset:1024
    s_andn2_b32 s46, 15, s57
    s_mul_i32 s46, s46, 1536
    v_add_u32 v37, s46, v2
    ds_read_b128 v[128:131], v37
    ds_read_b128 v[132:135], v37 offset:1024
    s_branch RK_LOOP
RK_DONE:
    v_cmp_gt_u32 vcc, 8, v50
    s_andn2_b64 s[58:59], -1, vcc
    s_and_b64 exec, vcc, -1
    s_cbranch_execz RK_NOSEL
    v_mul_f32 v30, 0xbfb8aa3b, v236
    v_exp_f32 v30, v30
    v_mov_b32 v31, s40
    v_add_f32 v30, 1.0, v30
    v_rcp_f32 v30, v30
    v_mov_b32 v35, s40
    v_cvt_pk_bf16_f32 v30, 0, v30
    v_or_b32 v30, v51, v30
    v_mov_b32 v34, v30
    v_mul_u32_u24 v50, 4608, v50
    v_add_u32 v50, v50, v12
    s_mov_b32 s48, 131072
    s_mov_b32 s55, 131584
    v_or_b32_sdwa v28, v162, v180 dst_sel:DWORD dst_unused:UNUSED_PAD src0_sel:DWORD src1_sel:WORD_0
    v_or_b32_sdwa v29, v163, v180 dst_sel:DWORD dst_unused:UNUSED_PAD src0_sel:DWORD src1_sel:WORD_1
    buffer_store_dwordx4 v[28:31], v50, s[32:35], s48 offen offset:0 sc1
    v_or_b32_sdwa v32, v164, v181 dst_sel:DWORD dst_unused:UNUSED_PAD src0_sel:DWORD src1_sel:WORD_0
    v_or_b32_sdwa v33, v165, v181 dst_sel:DWORD dst_unused:UNUSED_PAD src0_sel:DWORD src1_sel:WORD_1
    buffer_store_dwordx4 v[32:35], v50, s[32:35], s55 offen offset:0 sc1
    v_or_b32_sdwa v28, v166, v182 dst_sel:DWORD dst_unused:UNUSED_PAD src0_sel:DWORD src1_sel:WORD_0
    v_or_b32_sdwa v29, v167, v182 dst_sel:DWORD dst_unused:UNUSED_PAD src0_sel:DWORD src1_sel:WORD_1
    buffer_store_dwordx4 v[28:31], v50, s[32:35], s55 offen offset:512 sc1
    v_or_b32_sdwa v32, v168, v184 dst_sel:DWORD dst_unused:UNUSED_PAD src0_sel:DWORD src1_sel:WORD_0
    v_or_b32_sdwa v33, v169, v184 dst_sel:DWORD dst_unused:UNUSED_PAD src0_sel:DWORD src1_sel:WORD_1
    buffer_store_dwordx4 v[32:35], v50, s[32:35], s55 offen offset:1024 sc1
    v_or_b32_sdwa v28, v170, v185 dst_sel:DWORD dst_unused:UNUSED_PAD src0_sel:DWORD src1_sel:WORD_0
    v_or_b32_sdwa v29, v171, v185 dst_sel:DWORD dst_unused:UNUSED_PAD src0_sel:DWORD src1_sel:WORD_1
    buffer_store_dwordx4 v[28:31], v50, s[32:35], s55 offen offset:1536 sc1
    v_or_b32_sdwa v32, v172, v186 dst_sel:DWORD dst_unused:UNUSED_PAD src0_sel:DWORD src1_sel:WORD_0
    v_or_b32_sdwa v33, v173, v186 dst_sel:DWORD dst_unused:UNUSED_PAD src0_sel:DWORD src1_sel:WORD_1
    buffer_store_dwordx4 v[32:35], v50, s[32:35], s55 offen offset:2048 sc1
    v_or_b32_sdwa v28, v174, v188 dst_sel:DWORD dst_unused:UNUSED_PAD src0_sel:DWORD src1_sel:WORD_0
    v_or_b32_sdwa v29, v175, v188 dst_sel:DWORD dst_unused:UNUSED_PAD src0_sel:DWORD src1_sel:WORD_1
    buffer_store_dwordx4 v[28:31], v50, s[32:35], s55 offen offset:2560 sc1
    v_or_b32_sdwa v32, v176, v189 dst_sel:DWORD dst_unused:UNUSED_PAD src0_sel:DWORD src1_sel:WORD_0
    v_or_b32_sdwa v33, v177, v189 dst_sel:DWORD dst_unused:UNUSED_PAD src0_sel:DWORD src1_sel:WORD_1
    buffer_store_dwordx4 v[32:35], v50, s[32:35], s55 offen offset:3072 sc1
    v_or_b32_sdwa v28, v178, v190 dst_sel:DWORD dst_unused:UNUSED_PAD src0_sel:DWORD src1_sel:WORD_0
    v_or_b32_sdwa v29, v179, v190 dst_sel:DWORD dst_unused:UNUSED_PAD src0_sel:DWORD src1_sel:WORD_1
    buffer_store_dwordx4 v[28:31], v50, s[32:35], s55 offen offset:3584 sc1
RK_NOSEL:
    s_mov_b64 exec, -1
    v_dot2_f32_bf16 v162, v180, v6, v162
    v_dot2_f32_bf16 v163, v180, v7, v163
    v_dot2_f32_bf16 v164, v181, v6, v164
    v_dot2_f32_bf16 v165, v181, v7, v165
    v_dot2_f32_bf16 v166, v182, v6, v166
    v_dot2_f32_bf16 v167, v182, v7, v167
    v_dot2_f32_bf16 v168, v184, v6, v168
    v_dot2_f32_bf16 v169, v184, v7, v169
    v_dot2_f32_bf16 v170, v185, v6, v170
    v_dot2_f32_bf16 v171, v185, v7, v171
    v_dot2_f32_bf16 v172, v186, v6, v172
    v_dot2_f32_bf16 v173, v186, v7, v173
    v_dot2_f32_bf16 v174, v188, v6, v174
    v_dot2_f32_bf16 v175, v188, v7, v175
    v_dot2_f32_bf16 v176, v189, v6, v176
    v_dot2_f32_bf16 v177, v189, v7, v177
    v_dot2_f32_bf16 v178, v190, v6, v178
    v_dot2_f32_bf16 v179, v190, v7, v179
    v_cvt_pk_bf16_f32 v16, v162, v163
    v_cvt_pk_bf16_f32 v17, v164, v165
    v_cvt_pk_bf16_f32 v18, v166, v167
    v_cvt_pk_bf16_f32 v19, v168, v169
    v_cvt_pk_bf16_f32 v20, v170, v171
    v_cvt_pk_bf16_f32 v21, v172, v173
    v_cvt_pk_bf16_f32 v22, v174, v175
    v_cvt_pk_bf16_f32 v23, v176, v177
    v_cvt_pk_bf16_f32 v24, v178, v179
    s_mov_b64 exec, s[58:59]
    s_cbranch_execz RK_NOOUT
    global_store_dwordx4 v4, v[16:19], s[28:29] sc1
    global_store_dwordx4 v4, v[20:23], s[28:29] offset:512 sc1
    global_store_dword v5, v24, s[28:29] offset:1024 sc1
RK_NOOUT:
    s_mov_b64 exec, -1
    s_cmp_ge_u32 s2, 144
    s_cbranch_scc1 DUMP
ZROLE:
    s_cmp_lg_u32 s3, 0
    s_cbranch_scc1 DUMP
    s_and_b32 s50, s2, 7
    s_mul_i32 s50, s50, 18
    s_lshr_b32 s46, s2, 3
    s_add_u32 s50, s50, s46
    v_and_b32 v12, 7, v1
    v_mul_u32_u24 v12, 4608, v12
    v_bfe_u32 v13, v1, 4, 1
    v_lshrrev_b32 v14, 5, v1
    v_lshl_add_u32 v13, v13, 1, v14
    s_lshl_b32 s46, s50, 2
    v_add_u32 v13, s46, v13
    v_bfe_u32 v14, v13, 3, 5
    v_and_b32 v15, 7, v13
    v_lshrrev_b32 v36, 8, v13
    v_lshl_add_u32 v15, v36, 3, v15
    s_cmp_lt_u32 s50, 128
    s_cbranch_scc1 Z_A
    v_bfe_u32 v14, v13, 1, 5
    v_and_b32 v15, 1, v13
    v_add_u32 v15, 16, v15
Z_A:
    v_lshrrev_b32 v36, 1, v15
    v_and_b32 v15, 1, v15
    v_lshl_add_u32 v14, v14, 4, v12
    v_lshl_add_u32 v14, v36, 9, v14
    v_cmp_eq_u32 s[52:53], 1, v15
    s_mul_i32 s60, s50, 9216
    s_add_u32 s60, s60, 7340032
    s_add_u32 s61, s60, 4096
    s_add_u32 s62, s60, 8192
    s_mov_b32 s63, 131072
    s_and_b32 s46, s40, 63
    v_mov_b32 v36, s46
    s_getreg_b32 s48, hwreg(HW_REG_XCC_ID, 0, 3)
    s_lshl_b32 s48, s48, 14
    s_add_u32 s48, s48, 9699328
    s_add_u32 s59, s48, 8192
    v_lshlrev_b32 v80, 7, v1
    v_and_b32 v81, 7, v1
    v_lshlrev_b32 v81, 7, v81
    buffer_load_dword v38, v80, s[32:35], s48 offen sc1
    buffer_load_dword v39, v81, s[32:35], s59 offen sc1
    s_mov_b32 s47, 0
PL29:
    s_waitcnt vmcnt(0)
    v_cmp_ne_u32 vcc, s40, v38
    v_cmp_ne_u32 s[56:57], s40, v39
    s_or_b64 vcc, vcc, s[56:57]
    s_cbranch_vccz PD30
    s_add_u32 s47, s47, 1
    s_cmp_ge_u32 s47, 65536
    s_cbranch_scc1 PD30
    s_sleep 2
    buffer_load_dword v38, v80, s[32:35], s48 offen sc1
    buffer_load_dword v39, v81, s[32:35], s59 offen sc1
    s_branch PL29
PD30:
    buffer_load_dwordx4 v[32:35], v14, s[32:35], s63 offen sc1
    s_mov_b32 s47, 0
PL31:
    s_waitcnt vmcnt(0)
    v_cmp_ne_u32 vcc, s40, v35
    s_cbranch_vccz PD32
    s_add_u32 s47, s47, 1
    s_cmp_ge_u32 s47, 65536
    s_cbranch_scc1 PD32
    s_sleep 2
    buffer_load_dwordx4 v[32:35], v14, s[32:35], s63 offen sc1
    s_branch PL31
PD32:
    v_mov_b32 v38, 0
    s_mov_b32 s47, 0
ZL33:
    buffer_load_dwordx4 v[40:43], v2, s[32:35], s60 offen offset:0 sc1
    buffer_load_dwordx4 v[44:47], v2, s[32:35], s60 offen offset:1024 sc1
    buffer_load_dwordx4 v[48:51], v2, s[32:35], s60 offen offset:2048 sc1
    buffer_load_dwordx4 v[52:55], v2, s[32:35], s60 offen offset:3072 sc1
    buffer_load_dwordx4 v[56:59], v2, s[32:35], s61 offen offset:0 sc1
    buffer_load_dwordx4 v[60:63], v2, s[32:35], s61 offen offset:1024 sc1
    buffer_load_dwordx4 v[64:67], v2, s[32:35], s61 offen offset:2048 sc1
    buffer_load_dwordx4 v[68:71], v2, s[32:35], s61 offen offset:3072 sc1
    buffer_load_dwordx4 v[72:75], v2, s[32:35], s62 offen offset:0 sc1
    s_cmp_lg_u32 s47, 0
    s_cbranch_scc1 Z_NS
    v_cndmask_b32 v32, v32, v33, s[52:53]
    v_and_b32 v33, 0xffff0000, v34
    v_and_b32 v28, 2047, v34
    v_mul_u32_u24 v28, 1152, v28
    v_lshl_add_u32 v28, v13, 1, v28
    v_lshlrev_b32 v34, 16, v32
    v_and_b32 v35, 0xffff0000, v32
Z_NS:
    s_waitcnt vmcnt(8)
    v_xor_b32 v40, v36, v40
    v_xor_b32 v41, v36, v41
    v_xor_b32 v42, v36, v42
    v_xor_b32 v43, v36, v43
    v_or3_b32 v37, v40, v41, v42
    v_or_b32 v37, v37, v43
    s_waitcnt vmcnt(7)
    v_xor_b32 v44, v36, v44
    v_xor_b32 v45, v36, v45
    v_xor_b32 v46, v36, v46
    v_xor_b32 v47, v36, v47
    v_or3_b32 v37, v37, v44, v45
    v_or3_b32 v37, v37, v46, v47
    v_pk_add_f32 v[40:41], v[40:41], v[44:45]
    v_pk_add_f32 v[42:43], v[42:43], v[46:47]
    s_waitcnt vmcnt(6)
    v_xor_b32 v48, v36, v48
    v_xor_b32 v49, v36, v49
    v_xor_b32 v50, v36, v50
    v_xor_b32 v51, v36, v51
    v_or3_b32 v37, v37, v48, v49
    v_or3_b32 v37, v37, v50, v51
    v_pk_add_f32 v[40:41], v[40:41], v[48:49]
    v_pk_add_f32 v[42:43], v[42:43], v[50:51]
    s_waitcnt vmcnt(5)
    v_xor_b32 v52, v36, v52
    v_xor_b32 v53, v36, v53
    v_xor_b32 v54, v36, v54
    v_xor_b32 v55, v36, v55
    v_or3_b32 v37, v37, v52, v53
    v_or3_b32 v37, v37, v54, v55
    v_pk_add_f32 v[40:41], v[40:41], v[52:53]
    v_pk_add_f32 v[42:43], v[42:43], v[54:55]
    s_waitcnt vmcnt(4)
    v_xor_b32 v56, v36, v56
    v_xor_b32 v57, v36, v57
    v_xor_b32 v58, v36, v58
    v_xor_b32 v59, v36, v59
    v_or3_b32 v37, v37, v56, v57
    v_or3_b32 v37, v37, v58, v59
    v_pk_add_f32 v[40:41], v[40:41], v[56:57]
    v_pk_add_f32 v[42:43], v[42:43], v[58:59]
    s_waitcnt vmcnt(3)
    v_xor_b32 v60, v36, v60
    v_xor_b32 v61, v36, v61
    v_xor_b32 v62, v36, v62
    v_xor_b32 v63, v36, v63
    v_or3_b32 v37, v37, v60, v61
    v_or3_b32 v37, v37, v62, v63
    v_pk_add_f32 v[40:41], v[40:41], v[60:61]
    v_pk_add_f32 v[42:43], v[42:43], v[62:63]
    s_waitcnt vmcnt(2)
    v_xor_b32 v64, v36, v64
    v_xor_b32 v65, v36, v65
    v_xor_b32 v66, v36, v66
    v_xor_b32 v67, v36, v67
    v_or3_b32 v37, v37, v64, v65
    v_or3_b32 v37, v37, v66, v67
    v_pk_add_f32 v[40:41], v[40:41], v[64:65]
    v_pk_add_f32 v[42:43], v[42:43], v[66:67]
    s_waitcnt vmcnt(1)
    v_xor_b32 v68, v36, v68
    v_xor_b32 v69, v36, v69
    v_xor_b32 v70, v36, v70
    v_xor_b32 v71, v36, v71
    v_or3_b32 v37, v37, v68, v69
    v_or3_b32 v37, v37, v70, v71
    v_pk_add_f32 v[40:41], v[40:41], v[68:69]
    v_pk_add_f32 v[42:43], v[42:43], v[70:71]
    s_waitcnt vmcnt(0)
    v_xor_b32 v72, v36, v72
    v_xor_b32 v73, v36, v73
    v_xor_b32 v74, v36, v74
    v_xor_b32 v75, v36, v75
    v_or3_b32 v37, v37, v72, v73
    v_or3_b32 v37, v37, v74, v75
    v_pk_add_f32 v[40:41], v[40:41], v[72:73]
    v_pk_add_f32 v[42:43], v[42:43], v[74:75]
    v_and_or_b32 v37, v37, 63, v38
    v_cmp_ne_u32 vcc, 0, v37
    s_cbranch_vccz ZD34
    s_add_u32 s47, s47, 1
    s_cmp_ge_u32 s47, 65536
    s_cbranch_scc1 ZD34
    s_sleep 2
    s_branch ZL33
ZD34:
    v_permlane32_swap_b32 v40, v41
    v_permlane32_swap_b32 v42, v43
    v_add_f32 v40, v40, v41
    v_add_f32 v42, v42, v43
    s_nop 1
    v_permlane16_swap_b32 v40, v42
    v_add_f32 v40, v40, v42
    s_nop 1
    v_add_f32_dpp v40, v40, v40 row_ror:8 row_mask:0xf bank_mask:0xf
    v_cvt_pk_bf16_f32 v40, 0, v40
    v_mul_f32 v40, v40, v33
    v_cvt_pk_bf16_f32 v40, 0, v40
    v_add_f32 v40, v40, v34
    v_cvt_pk_bf16_f32 v40, 0, v40
    v_add_f32 v40, v40, v35
    v_cvt_pk_bf16_f32 v40, v40, v40
    s_mov_b32 exec_lo, 0x00ff00ff
    s_mov_b32 exec_hi, 0x00ff00ff
    global_store_short v28, v40, s[28:29]
    s_cmp_lg_u32 s50, 0
    s_cbranch_scc1 DUMP
    s_mov_b64 exec, 1
    v_mov_b32 v36, s40
    buffer_store_dword v36, v2, s[32:35], 0 offen
    s_branch DUMP
FROLE:
    v_cmp_gt_u32 vcc, TBLEND-PC0, v15
    s_and_saveexec_b64 s[58:59], vcc
    s_cbranch_execz F_NT
    global_load_dword v255, v15, s[42:43]
F_NT:
    s_mov_b64 exec, -1
    s_and_b32 s46, s50, 7
    s_mul_i32 s46, s46, 9
    s_lshr_b32 s50, s50, 3
    s_add_u32 s50, s50, s46
    v_lshrrev_b32 v12, 3, v0
    v_and_b32 v13, 7, v0
    v_lshlrev_b32 v13, 4, v13
    v_mul_u32_u24 v4, 9216, v12
    v_add_u32 v4, v4, v13
    v_mul_u32_u24 v5, 1152, v12
    v_add_u32 v5, v5, v13
    s_lshl_b32 s46, s50, 7
    s_mul_i32 s48, s50, 73728
    s_mov_b32 s38, 5308416
    s_mov_b32 s39, 0x00020000
    s_mov_b32 s54, 5308416
    s_mov_b32 s55, 0x00020000
    s_mov_b32 s58, 5308416
    s_mov_b32 s59, 0x00020000
    s_waitcnt lgkmcnt(0)
    s_mov_b32 s36, s22
    s_and_b32 s37, s23, 0xffff
    s_mov_b32 s52, s24
    s_and_b32 s53, s25, 0xffff
    s_mov_b32 s56, s26
    s_and_b32 s57, s27, 0xffff
    s_load_dword s40, s[30:31], 0
    s_mov_b32 s32, s30
    s_and_b32 s33, s31, 0xffff
    s_mov_b32 s34, 0x10000000
    s_mov_b32 s35, 0x00020000
    v_mul_u32_u24 v6, 272, v12
    v_add_u32 v6, v6, v13
    v_lshrrev_b32 v14, 4, v1
    v_bfe_u32 v15, v1, 2, 2
    v_lshl_add_u32 v7, v14, 3, v15
    v_mul_u32_u24 v7, 272, v7
    v_and_b32 v8, 2, v1
    v_lshl_add_u32 v7, v8, 6, v7
    v_and_b32 v8, 1, v1
    v_lshl_add_u32 v7, v8, 3, v7
    s_lshl_b32 s46, s3, 4
    v_add_u32 v7, s46, v7
    v_bfe_u32 v8, v1, 3, 3
    v_mul_u32_u24 v8, 1184, v8
    v_add_u32 v8, v8, v13
    s_mul_i32 s46, s3, 9600
    v_add_u32 v8, s46, v8
    v_mul_u32_u24 v9, 9600, v14
    v_mul_u32_u24 v15, 1184, v15
    v_add_u32 v9, v9, v15
    v_and_b32 v15, 3, v1
    v_lshl_add_u32 v9, v15, 3, v9
    s_lshl_b32 s46, s3, 5
    v_add_u32 v9, s46, v9
    v_add_u32 v242, 0, v0
    v_mul_u32_u24 v243, 683, v242
    v_lshrrev_b32 v243, 16, v243
    v_mul_u32_u24 v244, 96, v243
    v_sub_u32 v242, v242, v244
    v_mul_u32_u24 v243, 1168, v243
    v_add_u32 v243, 81920, v243
    v_and_b32 v244, 31, v242
    v_lshrrev_b32 v242, 5, v242
    v_lshl_add_u32 v245, v244, 4, v243
    v_lshl_add_u32 v246, v244, 2, v243
    v_add_u32 v246, 1024, v246
    v_cmp_eq_u32 s[60:61], 1, v242
    v_cmp_eq_u32 s[62:63], 2, v242
    v_mov_b32 v247, 0
    v_mov_b32 v248, 12
    v_cndmask_b32 v247, v247, v248, s[60:61]
    v_mov_b32 v248, 520
    v_cndmask_b32 v247, v247, v248, s[62:63]
    v_add_u32 v236, v247, v245
    v_mov_b32 v247, 4
    v_mov_b32 v248, 512
    v_cndmask_b32 v247, v247, v248, s[60:61]
    v_mov_b32 v248, 524
    v_cndmask_b32 v247, v247, v248, s[62:63]
    v_add_u32 v237, v247, v245
    v_mov_b32 v247, 8
    v_mov_b32 v248, 516
    v_cndmask_b32 v247, v247, v248, s[60:61]
    v_add_u32 v247, v247, v245
    v_cndmask_b32 v238, v247, v246, s[62:63]
    v_add_u32 v242, 512, v0
    v_mul_u32_u24 v243, 683, v242
    v_lshrrev_b32 v243, 16, v243
    v_mul_u32_u24 v244, 96, v243
    v_sub_u32 v242, v242, v244
    v_mul_u32_u24 v243, 1168, v243
    v_add_u32 v243, 81920, v243
    v_and_b32 v244, 31, v242
    v_lshrrev_b32 v242, 5, v242
    v_lshl_add_u32 v245, v244, 4, v243
    v_lshl_add_u32 v246, v244, 2, v243
    v_add_u32 v246, 1024, v246
    v_cmp_eq_u32 s[60:61], 1, v242
    v_cmp_eq_u32 s[62:63], 2, v242
    v_mov_b32 v247, 0
    v_mov_b32 v248, 12
    v_cndmask_b32 v247, v247, v248, s[60:61]
    v_mov_b32 v248, 520
    v_cndmask_b32 v247, v247, v248, s[62:63]
    v_add_u32 v239, v247, v245
    v_mov_b32 v247, 4
    v_mov_b32 v248, 512
    v_cndmask_b32 v247, v247, v248, s[60:61]
    v_mov_b32 v248, 524
    v_cndmask_b32 v247, v247, v248, s[62:63]
    v_add_u32 v240, v247, v245
    v_mov_b32 v247, 8
    v_mov_b32 v248, 516
    v_cndmask_b32 v247, v247, v248, s[60:61]
    v_add_u32 v247, v247, v245
    v_cndmask_b32 v241, v247, v246, s[62:63]
    v_and_b32 v15, 7, v1
    v_mul_u32_u24 v10, 1168, v15
    v_lshl_add_u32 v10, v14, 4, v10
    v_add_u32 v10, 81920, v10
    v_mul_u32_u24 v11, 144, v15
    v_add_u32 v11, 98304, v11
    v_lshl_add_u32 v242, v14, 4, v11
    v_bfe_u32 v243, v1, 4, 1
    v_lshl_add_u32 v11, v243, 3, v11
    v_bfe_u32 v243, v1, 3, 1
    v_lshl_add_u32 v11, v243, 2, v11
    v_lshrrev_b32 v244, 5, v1
    v_lshl_add_u32 v11, v244, 1, v11
    s_lshl_b32 s46, s3, 4
    v_add_u32 v11, s46, v11
    v_lshl_add_u32 v243, v243, 5, v14
    v_mul_u32_u24 v243, 9216, v243
    v_lshl_add_u32 v243, v15, 4, v243
    s_mul_i32 s62, s3, 36864
    s_lshl_b32 s46, s50, 7
    s_add_u32 s62, s62, s46
    s_add_u32 s62, s62, 7340032
    v_and_b32 v244, 8, v1
    v_cmp_eq_u32 s[60:61], 0, v244
    s_waitcnt lgkmcnt(0)
    s_add_u32 s40, s40, 1
    s_and_b32 s46, s40, 63
    v_mov_b32 v245, s46
    v_mov_b32 v246, 0xffffffc0
    v_mov_b32 v249, s40
    v_lshlrev_b32 v250, 14, v1
    s_lshl_b32 s63, s50, 7
    s_add_u32 s63, s63, 9699328
    s_lshl_b32 s46, s50, 7
    buffer_load_dwordx4 v[16:19], v4, s[36:39], s46 offen nt
    buffer_load_dwordx4 v[20:23], v4, s[52:55], s46 offen nt
    s_add_u32 s46, s46, 589824
    buffer_load_dwordx4 v[24:27], v4, s[36:39], s46 offen nt
    buffer_load_dwordx4 v[28:31], v4, s[52:55], s46 offen nt
    s_add_u32 s46, s46, 589824
    buffer_load_dwordx4 v[32:35], v4, s[36:39], s46 offen nt
    buffer_load_dwordx4 v[36:39], v4, s[52:55], s46 offen nt
    s_add_u32 s46, s46, 589824
    buffer_load_dwordx4 v[40:43], v4, s[36:39], s46 offen nt
    buffer_load_dwordx4 v[44:47], v4, s[52:55], s46 offen nt
    s_add_u32 s46, s46, 589824
    buffer_load_dwordx4 v[48:51], v4, s[36:39], s46 offen nt
    buffer_load_dwordx4 v[52:55], v4, s[52:55], s46 offen nt
    s_add_u32 s46, s46, 589824
    buffer_load_dwordx4 v[56:59], v4, s[36:39], s46 offen nt
    buffer_load_dwordx4 v[60:63], v4, s[52:55], s46 offen nt
    s_add_u32 s46, s46, 589824
    buffer_load_dwordx4 v[64:67], v4, s[36:39], s46 offen nt
    buffer_load_dwordx4 v[68:71], v4, s[52:55], s46 offen nt
    s_add_u32 s46, s46, 589824
    buffer_load_dwordx4 v[72:75], v4, s[36:39], s46 offen nt
    buffer_load_dwordx4 v[76:79], v4, s[52:55], s46 offen nt
    s_add_u32 s46, s46, 589824
    buffer_load_dwordx4 v[80:83], v4, s[36:39], s46 offen nt
    buffer_load_dwordx4 v[84:87], v4, s[52:55], s46 offen nt
    s_add_u32 s46, s46, 589824
    buffer_load_dwordx4 v[88:91], v5, s[56:59], s48 offen offset:0 nt
    buffer_load_dwordx4 v[92:95], v5, s[56:59], s48 offen offset:128 nt
    buffer_load_dwordx4 v[96:99], v5, s[56:59], s48 offen offset:256 nt
    buffer_load_dwordx4 v[100:103], v5, s[56:59], s48 offen offset:384 nt
    buffer_load_dwordx4 v[104:107], v5, s[56:59], s48 offen offset:512 nt
    buffer_load_dwordx4 v[108:111], v5, s[56:59], s48 offen offset:640 nt
    buffer_load_dwordx4 v[112:115], v5, s[56:59], s48 offen offset:768 nt
    buffer_load_dwordx4 v[116:119], v5, s[56:59], s48 offen offset:896 nt
    buffer_load_dwordx4 v[120:123], v5, s[56:59], s48 offen offset:1024 nt
    s_waitcnt vmcnt(25)
    ds_write_b128 v6, v[16:19] offset:0
    ds_write_b128 v6, v[20:23] offset:128
    s_waitcnt vmcnt(23)
    ds_write_b128 v6, v[24:27] offset:17408
    ds_write_b128 v6, v[28:31] offset:17536
    s_waitcnt vmcnt(21)
    ds_write_b128 v6, v[32:35] offset:34816
    ds_write_b128 v6, v[36:39] offset:34944
    s_waitcnt vmcnt(19)
    v_add_u32 v6, 52224, v6
    ds_write_b128 v6, v[40:43] offset:0
    ds_write_b128 v6, v[44:47] offset:128
    s_waitcnt vmcnt(17)
    ds_write_b128 v6, v[48:51] offset:17408
    ds_write_b128 v6, v[52:55] offset:17536
    s_waitcnt lgkmcnt(0)
    s_barrier
    ds_read_b64_tr_b16 v[124:125], v7 offset:0
    ds_read_b64_tr_b16 v[126:127], v7 offset:1088
    ds_read_b64_tr_b16 v[128:129], v7 offset:8704
    ds_read_b64_tr_b16 v[130:131], v7 offset:9792
    ds_read_b64_tr_b16 v[132:133], v7 offset:17408
    ds_read_b64_tr_b16 v[134:135], v7 offset:18496
    ds_read_b64_tr_b16 v[136:137], v7 offset:26112
    ds_read_b64_tr_b16 v[138:139], v7 offset:27200
    ds_read_b64_tr_b16 v[140:141], v7 offset:34816
    ds_read_b64_tr_b16 v[142:143], v7 offset:35904
    ds_read_b64_tr_b16 v[144:145], v7 offset:43520
    ds_read_b64_tr_b16 v[146:147], v7 offset:44608
    v_add_u32 v7, 52224, v7
    ds_read_b64_tr_b16 v[148:149], v7 offset:0
    ds_read_b64_tr_b16 v[150:151], v7 offset:1088
    ds_read_b64_tr_b16 v[152:153], v7 offset:8704
    ds_read_b64_tr_b16 v[154:155], v7 offset:9792
    ds_read_b64_tr_b16 v[156:157], v7 offset:17408
    ds_read_b64_tr_b16 v[158:159], v7 offset:18496
    ds_read_b64_tr_b16 v[160:161], v7 offset:26112
    ds_read_b64_tr_b16 v[162:163], v7 offset:27200
    s_waitcnt vmcnt(15)
    ds_write_b128 v6, v[56:59] offset:34816
    ds_write_b128 v6, v[60:63] offset:34944
    s_waitcnt vmcnt(13)
    v_add_u32 v6, 52224, v6
    ds_write_b128 v6, v[64:67] offset:0
    ds_write_b128 v6, v[68:71] offset:128
    s_waitcnt vmcnt(11)
    ds_write_b128 v6, v[72:75] offset:17408
    ds_write_b128 v6, v[76:79] offset:17536
    s_waitcnt vmcnt(9)
    ds_write_b128 v6, v[80:83] offset:34816
    ds_write_b128 v6, v[84:87] offset:34944
    s_waitcnt lgkmcnt(0)
    s_barrier
    ds_read_b64_tr_b16 v[164:165], v7 offset:34816
    ds_read_b64_tr_b16 v[166:167], v7 offset:35904
    ds_read_b64_tr_b16 v[168:169], v7 offset:43520
    ds_read_b64_tr_b16 v[170:171], v7 offset:44608
    v_add_u32 v7, 52224, v7
    ds_read_b64_tr_b16 v[172:173], v7 offset:0
    ds_read_b64_tr_b16 v[174:175], v7 offset:1088
    ds_read_b64_tr_b16 v[176:177], v7 offset:8704
    ds_read_b64_tr_b16 v[178:179], v7 offset:9792
    ds_read_b64_tr_b16 v[180:181], v7 offset:17408
    ds_read_b64_tr_b16 v[182:183], v7 offset:18496
    ds_read_b64_tr_b16 v[184:185], v7 offset:26112
    ds_read_b64_tr_b16 v[186:187], v7 offset:27200
    ds_read_b64_tr_b16 v[188:189], v7 offset:34816
    ds_read_b64_tr_b16 v[190:191], v7 offset:35904
    ds_read_b64_tr_b16 v[192:193], v7 offset:43520
    ds_read_b64_tr_b16 v[194:195], v7 offset:44608
    s_waitcnt lgkmcnt(0)
    s_barrier
    s_waitcnt vmcnt(8)
    ds_write_b128 v8, v[88:91] offset:0
    s_waitcnt vmcnt(7)
    ds_write_b128 v8, v[92:95] offset:128
    s_waitcnt vmcnt(6)
    ds_write_b128 v8, v[96:99] offset:256
    s_waitcnt vmcnt(5)
    ds_write_b128 v8, v[100:103] offset:384
    s_waitcnt vmcnt(4)
    ds_write_b128 v8, v[104:107] offset:512
    s_waitcnt vmcnt(3)
    ds_write_b128 v8, v[108:111] offset:640
    s_waitcnt vmcnt(2)
    ds_write_b128 v8, v[112:115] offset:768
    s_waitcnt vmcnt(1)
    ds_write_b128 v8, v[116:119] offset:896
    s_waitcnt vmcnt(0)
    ds_write_b128 v8, v[120:123] offset:1024
    s_waitcnt lgkmcnt(0)
    s_barrier
    ds_read_b64_tr_b16 v[196:197], v9 offset:0
    ds_read_b64_tr_b16 v[198:199], v9 offset:4736
    ds_read_b64_tr_b16 v[200:201], v9 offset:38400
    ds_read_b64_tr_b16 v[202:203], v9 offset:43136
    ds_read_b64_tr_b16 v[204:205], v9 offset:256
    ds_read_b64_tr_b16 v[206:207], v9 offset:4992
    ds_read_b64_tr_b16 v[208:209], v9 offset:38656
    ds_read_b64_tr_b16 v[210:211], v9 offset:43392
    ds_read_b64_tr_b16 v[212:213], v9 offset:512
    ds_read_b64_tr_b16 v[214:215], v9 offset:5248
    ds_read_b64_tr_b16 v[216:217], v9 offset:38912
    ds_read_b64_tr_b16 v[218:219], v9 offset:43648
    ds_read_b64_tr_b16 v[220:221], v9 offset:768
    ds_read_b64_tr_b16 v[222:223], v9 offset:5504
    ds_read_b64_tr_b16 v[224:225], v9 offset:39168
    ds_read_b64_tr_b16 v[226:227], v9 offset:43904
    ds_read_b64_tr_b16 v[228:229], v9 offset:1024
    ds_read_b64_tr_b16 v[230:231], v9 offset:5760
    ds_read_b64_tr_b16 v[232:233], v9 offset:39424
    ds_read_b64_tr_b16 v[234:235], v9 offset:44160
    s_getreg_b32 s48, hwreg(HW_REG_XCC_ID, 0, 3)
    s_mul_i32 s48, s48, 16384
    s_add_u32 s48, s48, 9830400
    s_add_u32 s49, s48, 8192
    s_waitcnt lgkmcnt(0)
    s_cmp_ge_u32 s3, 4
    s_cbranch_scc1 F_P1
    buffer_load_dwordx4 v[16:19], v3, s[32:35], s48 offen sc1
    buffer_load_dwordx4 v[20:23], v3, s[32:35], s49 offen sc1
    s_mov_b32 s47, 0
PL35:
    s_waitcnt vmcnt(0)
    v_cmp_ne_u32 vcc, s40, v19
    v_cmp_ne_u32 s[52:53], s40, v23
    s_or_b64 vcc, vcc, s[52:53]
    s_cbranch_vccz PD36
    s_add_u32 s47, s47, 1
    s_cmp_ge_u32 s47, 65536
    s_cbranch_scc1 PD36
    s_sleep 1
    buffer_load_dwordx4 v[16:19], v3, s[32:35], s48 offen sc1
    buffer_load_dwordx4 v[20:23], v3, s[32:35], s49 offen sc1
    s_branch PL35
PD36:
    ds_write_b32 v239, v20
    ds_write_b32 v240, v21
    ds_write_b32 v241, v22
    s_branch F_P2
F_P1:
    buffer_load_dwordx4 v[16:19], v3, s[32:35], s48 offen sc1
    s_mov_b32 s47, 0
PL37:
    s_waitcnt vmcnt(0)
    v_cmp_ne_u32 vcc, s40, v19
    s_cbranch_vccz PD38
    s_add_u32 s47, s47, 1
    s_cmp_ge_u32 s47, 65536
    s_cbranch_scc1 PD38
    s_sleep 1
    buffer_load_dwordx4 v[16:19], v3, s[32:35], s48 offen sc1
    s_branch PL37
PD38:
F_P2:
    ds_write_b32 v236, v16
    ds_write_b32 v237, v17
    ds_write_b32 v238, v18
    s_waitcnt lgkmcnt(0)
    s_barrier
    ds_read_b128 v[32:35], v10 offset:0
    ds_read_b128 v[36:39], v10 offset:64
    ds_read_b128 v[40:43], v10 offset:128
    ds_read_b128 v[44:47], v10 offset:192
    s_cmp_lg_u32 s3, 7
    s_cbranch_scc1 FH39
    s_mov_b64 exec, 0xff
    buffer_store_dword v249, v250, s[32:35], s63 offen sc1
    s_mov_b64 exec, -1
FH39:
    ds_read_b128 v[48:51], v10 offset:256
    ds_read_b128 v[52:55], v10 offset:320
    ds_read_b128 v[56:59], v10 offset:384
    s_waitcnt lgkmcnt(6)
    v_mfma_f32_16x16x32_bf16 v[24:27], v[124:127], v[32:35], 0
    ds_read_b128 v[60:63], v10 offset:448
    s_waitcnt lgkmcnt(6)
    v_mfma_f32_16x16x32_bf16 v[24:27], v[128:131], v[36:39], v[24:27]
    ds_read_b128 v[64:67], v10 offset:512
    s_waitcnt lgkmcnt(6)
    v_mfma_f32_16x16x32_bf16 v[24:27], v[132:135], v[40:43], v[24:27]
    ds_read_b128 v[68:71], v10 offset:576
    s_waitcnt lgkmcnt(6)
    v_mfma_f32_16x16x32_bf16 v[24:27], v[136:139], v[44:47], v[24:27]
    ds_read_b128 v[72:75], v10 offset:640
    s_waitcnt lgkmcnt(6)
    v_mfma_f32_16x16x32_bf16 v[24:27], v[140:143], v[48:51], v[24:27]
    ds_read_b128 v[76:79], v10 offset:704
    s_waitcnt lgkmcnt(6)
    v_mfma_f32_16x16x32_bf16 v[24:27], v[144:147], v[52:55], v[24:27]
    ds_read_b128 v[80:83], v10 offset:768
    s_waitcnt lgkmcnt(6)
    v_mfma_f32_16x16x32_bf16 v[24:27], v[148:151], v[56:59], v[24:27]
    ds_read_b128 v[84:87], v10 offset:832
    s_waitcnt lgkmcnt(6)
    v_mfma_f32_16x16x32_bf16 v[24:27], v[152:155], v[60:63], v[24:27]
    ds_read_b128 v[88:91], v10 offset:896
    s_waitcnt lgkmcnt(6)
    v_mfma_f32_16x16x32_bf16 v[24:27], v[156:159], v[64:67], v[24:27]
    ds_read_b128 v[92:95], v10 offset:960
    s_waitcnt lgkmcnt(6)
    v_mfma_f32_16x16x32_bf16 v[24:27], v[160:163], v[68:71], v[24:27]
    ds_read_b128 v[96:99], v10 offset:1024
    s_waitcnt lgkmcnt(6)
    v_mfma_f32_16x16x32_bf16 v[24:27], v[164:167], v[72:75], v[24:27]
    ds_read_b128 v[100:103], v10 offset:1088
    s_waitcnt lgkmcnt(6)
    v_mfma_f32_16x16x32_bf16 v[24:27], v[168:171], v[76:79], v[24:27]
    s_waitcnt lgkmcnt(5)
    v_mfma_f32_16x16x32_bf16 v[24:27], v[172:175], v[80:83], v[24:27]
    s_waitcnt lgkmcnt(4)
    v_mfma_f32_16x16x32_bf16 v[24:27], v[176:179], v[84:87], v[24:27]
    s_waitcnt lgkmcnt(3)
    v_mfma_f32_16x16x32_bf16 v[24:27], v[180:183], v[88:91], v[24:27]
    s_waitcnt lgkmcnt(2)
    v_mfma_f32_16x16x32_bf16 v[24:27], v[184:187], v[92:95], v[24:27]
    s_waitcnt lgkmcnt(1)
    v_mfma_f32_16x16x32_bf16 v[24:27], v[188:191], v[96:99], v[24:27]
    s_waitcnt lgkmcnt(0)
    v_mfma_f32_16x16x32_bf16 v[24:27], v[192:195], v[100:103], v[24:27]
    s_nop 7
    v_cndmask_b32 v28, v26, v24, s[60:61]
    v_cndmask_b32 v29, v27, v25, s[60:61]
    v_cvt_pk_bf16_f32 v28, 0, v28
    v_cvt_pk_bf16_f32 v29, 0, v29
    s_nop 1
    v_permlane32_swap_b32 v28, v29
    v_mul_f32 v30, 0xbfb8aa3b, v28
    v_exp_f32 v30, v30
    s_nop 0
    v_add_f32 v30, 1.0, v30
    v_rcp_f32 v30, v30
    s_nop 0
    v_mul_f32 v28, v28, v30
    v_cvt_pk_bf16_f32 v28, 0, v28
    v_mul_f32 v28, v28, v29
    v_cvt_pk_bf16_f32 v28, v28, v28
    ds_write_b16 v11, v28
    s_waitcnt lgkmcnt(0)
    s_barrier
    ds_read_b128 v[16:19], v242
    ds_read_b128 v[20:23], v242 offset:64
    s_waitcnt lgkmcnt(1)
    v_mfma_f32_16x16x32_bf16 v[32:35], v[196:199], v[16:19], 0
    v_mfma_f32_16x16x32_bf16 v[36:39], v[204:207], v[16:19], 0
    v_mfma_f32_16x16x32_bf16 v[40:43], v[212:215], v[16:19], 0
    v_mfma_f32_16x16x32_bf16 v[44:47], v[220:223], v[16:19], 0
    v_mfma_f32_16x16x32_bf16 v[48:51], v[228:231], v[16:19], 0
    s_waitcnt lgkmcnt(0)
    v_mfma_f32_16x16x32_bf16 v[32:35], v[200:203], v[20:23], v[32:35]
    v_mfma_f32_16x16x32_bf16 v[36:39], v[208:211], v[20:23], v[36:39]
    v_mfma_f32_16x16x32_bf16 v[40:43], v[216:219], v[20:23], v[40:43]
    v_mfma_f32_16x16x32_bf16 v[44:47], v[224:227], v[20:23], v[44:47]
    v_mfma_f32_16x16x32_bf16 v[48:51], v[232:235], v[20:23], v[48:51]
    s_nop 4
    v_cndmask_b32 v32, v36, v32, s[60:61]
    v_cndmask_b32 v33, v37, v33, s[60:61]
    v_cndmask_b32 v34, v38, v34, s[60:61]
    v_cndmask_b32 v35, v39, v35, s[60:61]
    v_and_or_b32 v32, v32, v246, v245
    v_and_or_b32 v33, v33, v246, v245
    v_and_or_b32 v34, v34, v246, v245
    v_and_or_b32 v35, v35, v246, v245
    buffer_store_dwordx4 v[32:35], v243, s[32:35], s62 offen sc1
    s_add_u32 s62, s62, 589824
    v_cndmask_b32 v40, v44, v40, s[60:61]
    v_cndmask_b32 v41, v45, v41, s[60:61]
    v_cndmask_b32 v42, v46, v42, s[60:61]
    v_cndmask_b32 v43, v47, v43, s[60:61]
    v_and_or_b32 v40, v40, v246, v245
    v_and_or_b32 v41, v41, v246, v245
    v_and_or_b32 v42, v42, v246, v245
    v_and_or_b32 v43, v43, v246, v245
    buffer_store_dwordx4 v[40:43], v243, s[32:35], s62 offen sc1
    s_add_u32 s62, s62, 589824
    s_cmp_ge_u32 s3, 4
    s_cbranch_scc1 DUMP
    v_and_or_b32 v48, v48, v246, v245
    v_and_or_b32 v49, v49, v246, v245
    v_and_or_b32 v50, v50, v246, v245
    v_and_or_b32 v51, v51, v246, v245
    s_mov_b64 exec, s[60:61]
    buffer_store_dwordx4 v[48:51], v243, s[32:35], s62 offen sc1
DUMP:
END:
    s_endpgm
.p2align 7
.type TBL,@object
TBL:
.long 0x0, 0x0, 0x0, 0x0, 0x0, 0x0, 0x0, 0x0
.long 0x0, 0x0, 0x0, 0x0, 0x0, 0x0, 0x0, 0x0
.long 0x0, 0x0, 0x0, 0x0, 0x0, 0x0, 0x0, 0x0
.long 0x0, 0x0, 0x0, 0x0, 0x0, 0x0, 0x0, 0x0
.long 0x0, 0x0, 0x0, 0x0, 0x0, 0x0, 0x0, 0x0
.long 0x0, 0x0, 0x0, 0x0, 0x0, 0x0, 0x0, 0x0
.long 0x0, 0x0, 0x0, 0x0, 0x0, 0x0, 0x0, 0x0
.long 0x0, 0x0, 0x0, 0x0, 0x0, 0x0, 0x0, 0x0
.long 0x0, 0x3c000000, 0x3c003c00, 0x0, 0x0, 0x0, 0x3c003c00, 0x3c00
.long 0x0, 0x0, 0x3c000000, 0x3c003c00, 0x0, 0x0, 0x0, 0x3c003c00
.long 0x0, 0x0, 0x0, 0x3c000000, 0x0, 0x0, 0x0, 0x0
.long 0x0, 0x0, 0x0, 0x0, 0x0, 0x0, 0x0, 0x0
.long 0x0, 0x0, 0x0, 0x0, 0x0, 0x0, 0x0, 0x0
.long 0x0, 0x0, 0x0, 0x0, 0x0, 0x0, 0x0, 0x0
.long 0x0, 0x0, 0x0, 0x0, 0x0, 0x0, 0x0, 0x0
.long 0x0, 0x0, 0x0, 0x0, 0x0, 0x0, 0x0, 0x0
.long 0x0, 0x0, 0x0, 0x0, 0x0, 0x0, 0x0, 0x0
.long 0x0, 0x0, 0x0, 0x0, 0x3c00, 0x0, 0x0, 0x0
.long 0x3c003c00, 0x0, 0x0, 0x0, 0x3c003c00, 0x3c00, 0x0, 0x0
.long 0x3c000000, 0x3c003c00, 0x0, 0x0, 0x0, 0x3c003c00, 0x3c00, 0x0
.long 0x0, 0x3c000000, 0x3c003c00, 0x0, 0x0, 0x0, 0x3c003c00, 0x3c00
.long 0x0, 0x0, 0x3c000000, 0x3c003c00, 0x0, 0x0, 0x0, 0x3c003c00
.long 0x0, 0x0, 0x0, 0x3c000000, 0x0, 0x0, 0x0, 0x0
.long 0x0, 0x0, 0x0, 0x0, 0x0, 0x0, 0x0, 0x0
.long 0x0, 0x0, 0x0, 0x0, 0x0, 0x0, 0x0, 0x0
.long 0x0, 0x0, 0x0, 0x0, 0x0, 0x0, 0x0, 0x0
.long 0x0, 0x0, 0x0, 0x0, 0x0, 0x0, 0x0, 0x0
.long 0x0, 0x0, 0x0, 0x0, 0x0, 0x0, 0x0, 0x0
.long 0x0, 0x0, 0x0, 0x0, 0x0, 0x0, 0x0, 0x0
.long 0x0, 0x0, 0x0, 0x0, 0x3c00, 0x0, 0x0, 0x0
.long 0x3c003c00, 0x0, 0x0, 0x0, 0x3c003c00, 0x3c00, 0x0, 0x0
.long 0x3c000000, 0x3c003c00, 0x0, 0x0, 0x0, 0x3c003c00, 0x3c00, 0x0
.long 0x0, 0x0, 0x0, 0x3c003c00, 0x0, 0x0, 0x0, 0x3c000000
.long 0x0, 0x0, 0x0, 0x0, 0x0, 0x0, 0x0, 0x0
.long 0x0, 0x0, 0x0, 0x0, 0x0, 0x0, 0x0, 0x0
.long 0x0, 0x0, 0x0, 0x0, 0x0, 0x0, 0x0, 0x0
.long 0x0, 0x0, 0x0, 0x0, 0x0, 0x0, 0x0, 0x0
.long 0x0, 0x0, 0x0, 0x0, 0x0, 0x0, 0x0, 0x0
.long 0x0, 0x0, 0x0, 0x0, 0x0, 0x0, 0x0, 0x0
.long 0x0, 0x0, 0x0, 0x0, 0x0, 0x0, 0x0, 0x0
.long 0x3c003c00, 0x3c00, 0x0, 0x0, 0x3c003c00, 0x3c003c00, 0x0, 0x0
.long 0x3c003c00, 0x3c003c00, 0x3c00, 0x0, 0x3c000000, 0x3c003c00, 0x3c003c00, 0x0
.long 0x0, 0x3c003c00, 0x3c003c00, 0x3c00, 0x0, 0x3c000000, 0x3c003c00, 0x3c003c00
.long 0x0, 0x0, 0x3c003c00, 0x3c003c00, 0x0, 0x0, 0x3c000000, 0x3c003c00
.long 0x0, 0x0, 0x0, 0x3c003c00, 0x0, 0x0, 0x0, 0x3c000000
.long 0x0, 0x0, 0x0, 0x0, 0x0, 0x0, 0x0, 0x0
.long 0x0, 0x0, 0x0, 0x0, 0x0, 0x0, 0x0, 0x0
.long 0x0, 0x0, 0x0, 0x0, 0x0, 0x0, 0x0, 0x0
.long 0x0, 0x0, 0x0, 0x0, 0x0, 0x0, 0x0, 0x0
.long 0x0, 0x0, 0x0, 0x0, 0x0, 0x0, 0x0, 0x0
.long 0x0, 0x0, 0x0, 0x0, 0x0, 0x0, 0x0, 0x0
.long 0x3c00, 0x0, 0x0, 0x0, 0x3c003c00, 0x0, 0x0, 0x0
.long 0x3c003c00, 0x3c00, 0x0, 0x0, 0x3c003c00, 0x3c003c00, 0x0, 0x0
.long 0x3c003c00, 0x3c003c00, 0x3c00, 0x0, 0x3c000000, 0x3c003c00, 0x3c003c00, 0x0
.long 0x0, 0x3c003c00, 0x3c003c00, 0x3c00, 0x0, 0x3c000000, 0x3c003c00, 0x3c003c00
.long 0x0, 0x0, 0x3c003c00, 0x3c003c00, 0x0, 0x0, 0x3c000000, 0x3c003c00
.long 0x0, 0x0, 0x0, 0x0, 0x0, 0x0, 0x0, 0x0
.long 0x0, 0x0, 0x0, 0x0, 0x0, 0x0, 0x0, 0x0
.long 0x0, 0x0, 0x0, 0x0, 0x0, 0x0, 0x0, 0x0
.long 0x0, 0x0, 0x0, 0x0, 0x0, 0x0, 0x0, 0x0
.long 0x0, 0x0, 0x0, 0x0, 0x0, 0x0, 0x0, 0x0
.long 0x0, 0x0, 0x0, 0x0, 0x0, 0x0, 0x0, 0x0
.long 0x0, 0x0, 0x0, 0x0, 0x0, 0x0, 0x0, 0x0
.long 0x3c00, 0x0, 0x0, 0x0, 0x3c003c00, 0x0, 0x0, 0x0
.long 0x0, 0x3c000000, 0x3c003c00, 0x0, 0x0, 0x0, 0x3c003c00, 0x3c00
.long 0x0, 0x0, 0x3c000000, 0x3c003c00, 0x0, 0x0, 0x0, 0x3c003c00
.long 0x0, 0x0, 0x0, 0x3c000000, 0x0, 0x0, 0x0, 0x0
.long 0x0, 0x0, 0x0, 0x0, 0x0, 0x0, 0x0, 0x0
.long 0x0, 0x0, 0x0, 0x0, 0x0, 0x0, 0x0, 0x0
.long 0x0, 0x0, 0x0, 0x0, 0x0, 0x0, 0x0, 0x0
.long 0x0, 0x0, 0x0, 0x0, 0x0, 0x0, 0x0, 0x0
.long 0x0, 0x0, 0x0, 0x0, 0x0, 0x0, 0x0, 0x0
.long 0x0, 0x0, 0x0, 0x0, 0x0, 0x0, 0x0, 0x0
.long 0x0, 0x0, 0x0, 0x0, 0x3c00, 0x0, 0x0, 0x0
.long 0x3c003c00, 0x0, 0x0, 0x0, 0x3c003c00, 0x3c00, 0x0, 0x0
.long 0x3c000000, 0x3c003c00, 0x0, 0x0, 0x0, 0x3c003c00, 0x3c00, 0x0
.long 0x0, 0x3c000000, 0x3c003c00, 0x0, 0x0, 0x0, 0x3c003c00, 0x3c00
.long 0x0, 0x0, 0x3c000000, 0x3c003c00, 0x0, 0x0, 0x0, 0x3c003c00
.long 0x0, 0x0, 0x0, 0x3c000000, 0x0, 0x0, 0x0, 0x0
.long 0x0, 0x0, 0x0, 0x0, 0x0, 0x0, 0x0, 0x0
.long 0x0, 0x0, 0x0, 0x0, 0x0, 0x0, 0x0, 0x0
.long 0x0, 0x0, 0x0, 0x0, 0x0, 0x0, 0x0, 0x0
.long 0x0, 0x0, 0x0, 0x0, 0x0, 0x0, 0x0, 0x0
.long 0x0, 0x0, 0x0, 0x0, 0x0, 0x0, 0x0, 0x0
.long 0x0, 0x0, 0x0, 0x0, 0x0, 0x0, 0x0, 0x0
.long 0x0, 0x0, 0x0, 0x0, 0x3c00, 0x0, 0x0, 0x0
.long 0x3c003c00, 0x0, 0x0, 0x0, 0x3c003c00, 0x3c00, 0x0, 0x0
.long 0x3c000000, 0x3c003c00, 0x0, 0x0, 0x0, 0x3c003c00, 0x3c00, 0x0
.long 0x0, 0x0, 0x0, 0x0, 0x0, 0x0, 0x0, 0x0
.long 0x0, 0x0, 0x0, 0x0, 0x0, 0x0, 0x0, 0x0
.long 0x0, 0x0, 0x0, 0x0, 0x0, 0x0, 0x0, 0x0
.long 0x0, 0x0, 0x0, 0x0, 0x0, 0x0, 0x0, 0x0
.long 0x0, 0x0, 0x0, 0x0, 0x0, 0x0, 0x0, 0x0
.long 0x0, 0x0, 0x0, 0x0, 0x0, 0x0, 0x0, 0x0
.long 0x0, 0x0, 0x0, 0x0, 0x0, 0x0, 0x0, 0x0
.long 0x0, 0x0, 0x0, 0x0, 0x0, 0x0, 0x0, 0x0
.long 0x0, 0x0, 0x0, 0x3c003c00, 0x0, 0x0, 0x0, 0x3c000000
.long 0x0, 0x0, 0x0, 0x0, 0x0, 0x0, 0x0, 0x0
.long 0x0, 0x0, 0x0, 0x0, 0x0, 0x0, 0x0, 0x0
.long 0x0, 0x0, 0x0, 0x0, 0x0, 0x0, 0x0, 0x0
.long 0x0, 0x0, 0x0, 0x0, 0x0, 0x0, 0x0, 0x0
.long 0x0, 0x0, 0x0, 0x0, 0x0, 0x0, 0x0, 0x0
.long 0x0, 0x0, 0x0, 0x0, 0x0, 0x0, 0x0, 0x0
.long 0x0, 0x0, 0x0, 0x0, 0x0, 0x0, 0x0, 0x0
.long 0x3c003c00, 0x3c00, 0x0, 0x0, 0x3c003c00, 0x3c003c00, 0x0, 0x0
.long 0x3c003c00, 0x3c003c00, 0x3c00, 0x0, 0x3c000000, 0x3c003c00, 0x3c003c00, 0x0
.long 0x0, 0x3c003c00, 0x3c003c00, 0x3c00, 0x0, 0x3c000000, 0x3c003c00, 0x3c003c00
.long 0x0, 0x0, 0x3c003c00, 0x3c003c00, 0x0, 0x0, 0x3c000000, 0x3c003c00
.long 0x0, 0x0, 0x0, 0x3c003c00, 0x0, 0x0, 0x0, 0x3c000000
.long 0x0, 0x0, 0x0, 0x0, 0x0, 0x0, 0x0, 0x0
.long 0x0, 0x0, 0x0, 0x0, 0x0, 0x0, 0x0, 0x0
.long 0x0, 0x0, 0x0, 0x0, 0x0, 0x0, 0x0, 0x0
.long 0x0, 0x0, 0x0, 0x0, 0x0, 0x0, 0x0, 0x0
.long 0x0, 0x0, 0x0, 0x0, 0x0, 0x0, 0x0, 0x0
.long 0x0, 0x0, 0x0, 0x0, 0x0, 0x0, 0x0, 0x0
.long 0x3c00, 0x0, 0x0, 0x0, 0x3c003c00, 0x0, 0x0, 0x0
.long 0x3c003c00, 0x3c00, 0x0, 0x0, 0x3c003c00, 0x3c003c00, 0x0, 0x0
.long 0x3c003c00, 0x3c003c00, 0x3c00, 0x0, 0x3c000000, 0x3c003c00, 0x3c003c00, 0x0
.long 0x0, 0x3c003c00, 0x3c003c00, 0x3c00, 0x0, 0x3c000000, 0x3c003c00, 0x3c003c00
.long 0x0, 0x0, 0x3c003c00, 0x3c003c00, 0x0, 0x0, 0x3c000000, 0x3c003c00
.long 0x0, 0x0, 0x0, 0x0, 0x0, 0x0, 0x0, 0x0
.long 0x0, 0x0, 0x0, 0x0, 0x0, 0x0, 0x0, 0x0
.long 0x0, 0x0, 0x0, 0x0, 0x0, 0x0, 0x0, 0x0
.long 0x0, 0x0, 0x0, 0x0, 0x0, 0x0, 0x0, 0x0
.long 0x0, 0x0, 0x0, 0x0, 0x0, 0x0, 0x0, 0x0
.long 0x0, 0x0, 0x0, 0x0, 0x0, 0x0, 0x0, 0x0
.long 0x0, 0x0, 0x0, 0x0, 0x0, 0x0, 0x0, 0x0
.long 0x3c00, 0x0, 0x0, 0x0, 0x3c003c00, 0x0, 0x0, 0x0
.long 0x0, 0x0, 0x3c000000, 0x3c003c00, 0x0, 0x0, 0x0, 0x3c003c00
.long 0x0, 0x0, 0x0, 0x3c000000, 0x0, 0x0, 0x0, 0x0
.long 0x0, 0x0, 0x0, 0x0, 0x0, 0x0, 0x0, 0x0
.long 0x0, 0x0, 0x0, 0x0, 0x0, 0x0, 0x0, 0x0
.long 0x0, 0x0, 0x0, 0x0, 0x0, 0x0, 0x0, 0x0
.long 0x0, 0x0, 0x0, 0x0, 0x0, 0x0, 0x0, 0x0
.long 0x0, 0x0, 0x0, 0x0, 0x0, 0x0, 0x0, 0x0
.long 0x0, 0x0, 0x0, 0x0, 0x0, 0x0, 0x0, 0x0
.long 0x3c003c00, 0x3c003c00, 0x0, 0x0, 0x3c003c00, 0x3c003c00, 0x3c00, 0x0
.long 0x3c003c00, 0x3c003c00, 0x3c003c00, 0x0, 0x3c003c00, 0x3c003c00, 0x3c003c00, 0x3c00
.long 0x3c000000, 0x3c003c00, 0x3c003c00, 0x3c003c00, 0x0, 0x3c003c00, 0x3c003c00, 0x3c003c00
.long 0x0, 0x3c000000, 0x3c003c00, 0x3c003c00, 0x0, 0x0, 0x3c003c00, 0x3c003c00
.long 0x0, 0x0, 0x3c000000, 0x3c003c00, 0x0, 0x0, 0x0, 0x3c003c00
.long 0x0, 0x0, 0x0, 0x3c000000, 0x0, 0x0, 0x0, 0x0
.long 0x0, 0x0, 0x0, 0x0, 0x0, 0x0, 0x0, 0x0
.long 0x0, 0x0, 0x0, 0x0, 0x0, 0x0, 0x0, 0x0
.long 0x0, 0x0, 0x0, 0x0, 0x0, 0x0, 0x0, 0x0
.long 0x0, 0x0, 0x0, 0x0, 0x0, 0x0, 0x0, 0x0
.long 0x0, 0x0, 0x0, 0x0, 0x3c00, 0x0, 0x0, 0x0
.long 0x3c003c00, 0x0, 0x0, 0x0, 0x3c003c00, 0x3c00, 0x0, 0x0
.long 0x3c003c00, 0x3c003c00, 0x0, 0x0, 0x3c003c00, 0x3c003c00, 0x3c00, 0x0
.long 0x3c003c00, 0x3c003c00, 0x3c003c00, 0x0, 0x3c003c00, 0x3c003c00, 0x3c003c00, 0x3c00
.long 0x3c000000, 0x3c003c00, 0x3c003c00, 0x3c003c00, 0x0, 0x3c003c00, 0x3c003c00, 0x3c003c00
.long 0x0, 0x3c000000, 0x3c003c00, 0x3c003c00, 0x0, 0x0, 0x3c003c00, 0x3c003c00
.long 0x0, 0x0, 0x0, 0x0, 0x0, 0x0, 0x0, 0x0
.long 0x0, 0x0, 0x0, 0x0, 0x0, 0x0, 0x0, 0x0
.long 0x0, 0x0, 0x0, 0x0, 0x0, 0x0, 0x0, 0x0
.long 0x0, 0x0, 0x0, 0x0, 0x0, 0x0, 0x0, 0x0
.long 0x0, 0x0, 0x0, 0x0, 0x0, 0x0, 0x0, 0x0
.long 0x0, 0x0, 0x0, 0x0, 0x0, 0x0, 0x0, 0x0
.long 0x0, 0x0, 0x0, 0x0, 0x3c00, 0x0, 0x0, 0x0
.long 0x3c003c00, 0x0, 0x0, 0x0, 0x3c003c00, 0x3c00, 0x0, 0x0
.long 0x0, 0x0, 0x3c003c00, 0x3c003c00, 0x0, 0x0, 0x3c000000, 0x3c003c00
.long 0x0, 0x0, 0x0, 0x3c003c00, 0x0, 0x0, 0x0, 0x3c000000
.long 0x0, 0x0, 0x0, 0x0, 0x0, 0x0, 0x0, 0x0
.long 0x0, 0x0, 0x0, 0x0, 0x0, 0x0, 0x0, 0x0
.long 0x0, 0x0, 0x0, 0x0, 0x0, 0x0, 0x0, 0x0
.long 0x0, 0x0, 0x0, 0x0, 0x0, 0x0, 0x0, 0x0
.long 0x0, 0x0, 0x0, 0x0, 0x0, 0x0, 0x0, 0x0
.long 0x0, 0x0, 0x0, 0x0, 0x0, 0x0, 0x0, 0x0
.long 0x3c003c00, 0x3c003c00, 0x3c00, 0x0, 0x3c003c00, 0x3c003c00, 0x3c003c00, 0x0
.long 0x3c003c00, 0x3c003c00, 0x3c003c00, 0x3c00, 0x3c003c00, 0x3c003c00, 0x3c003c00, 0x3c003c00
.long 0x3c003c00, 0x3c003c00, 0x3c003c00, 0x3c003c00, 0x3c000000, 0x3c003c00, 0x3c003c00, 0x3c003c00
.long 0x0, 0x3c003c00, 0x3c003c00, 0x3c003c00, 0x0, 0x3c000000, 0x3c003c00, 0x3c003c00
.long 0x0, 0x0, 0x3c003c00, 0x3c003c00, 0x0, 0x0, 0x3c000000, 0x3c003c00
.long 0x0, 0x0, 0x0, 0x3c003c00, 0x0, 0x0, 0x0, 0x3c000000
.long 0x0, 0x0, 0x0, 0x0, 0x0, 0x0, 0x0, 0x0
.long 0x0, 0x0, 0x0, 0x0, 0x0, 0x0, 0x0, 0x0
.long 0x0, 0x0, 0x0, 0x0, 0x0, 0x0, 0x0, 0x0
.long 0x0, 0x0, 0x0, 0x0, 0x0, 0x0, 0x0, 0x0
.long 0x3c00, 0x0, 0x0, 0x0, 0x3c003c00, 0x0, 0x0, 0x0
.long 0x3c003c00, 0x3c00, 0x0, 0x0, 0x3c003c00, 0x3c003c00, 0x0, 0x0
.long 0x3c003c00, 0x3c003c00, 0x3c00, 0x0, 0x3c003c00, 0x3c003c00, 0x3c003c00, 0x0
.long 0x3c003c00, 0x3c003c00, 0x3c003c00, 0x3c00, 0x3c003c00, 0x3c003c00, 0x3c003c00, 0x3c003c00
.long 0x3c003c00, 0x3c003c00, 0x3c003c00, 0x3c003c00, 0x3c000000, 0x3c003c00, 0x3c003c00, 0x3c003c00
.long 0x0, 0x3c003c00, 0x3c003c00, 0x3c003c00, 0x0, 0x3c000000, 0x3c003c00, 0x3c003c00
.long 0x0, 0x0, 0x0, 0x0, 0x0, 0x0, 0x0, 0x0
.long 0x0, 0x0, 0x0, 0x0, 0x0, 0x0, 0x0, 0x0
.long 0x0, 0x0, 0x0, 0x0, 0x0, 0x0, 0x0, 0x0
.long 0x0, 0x0, 0x0, 0x0, 0x0, 0x0, 0x0, 0x0
.long 0x0, 0x0, 0x0, 0x0, 0x0, 0x0, 0x0, 0x0
.long 0x0, 0x0, 0x0, 0x0, 0x0, 0x0, 0x0, 0x0
.long 0x3c00, 0x0, 0x0, 0x0, 0x3c003c00, 0x0, 0x0, 0x0
.long 0x3c003c00, 0x3c00, 0x0, 0x0, 0x3c003c00, 0x3c003c00, 0x0, 0x0
.long 0x0, 0x0, 0x0, 0x0, 0x0, 0x0, 0x0, 0x0
.long 0x0, 0x0, 0x0, 0x0, 0x0, 0x0, 0x0, 0x0
.long 0x0, 0x0, 0x0, 0x0, 0x0, 0x0, 0x0, 0x0
.long 0x0, 0x0, 0x0, 0x0, 0x0, 0x0, 0x0, 0x0
.long 0x0, 0x0, 0x0, 0x0, 0x0, 0x0, 0x0, 0x0
.long 0x0, 0x0, 0x0, 0x0, 0x0, 0x0, 0x0, 0x0
.long 0x0, 0x0, 0x0, 0x0, 0x0, 0x0, 0x0, 0x0
.long 0x0, 0x0, 0x0, 0x0, 0x0, 0x0, 0x0, 0x0
.long 0x0, 0x0, 0xffffffff, 0x0, 0x0, 0x0, 0xffff0000, 0xffff
.long 0x0, 0x0, 0x0, 0xffffffff, 0x0, 0x0, 0x0, 0xffff0000
.long 0x0, 0x0, 0x0, 0x0, 0x0, 0x0, 0x0, 0x0
.long 0x0, 0x0, 0x0, 0x0, 0x0, 0x0, 0x0, 0x0
.long 0x0, 0x0, 0x0, 0x0, 0x0, 0x0, 0x0, 0x0
.long 0x0, 0x0, 0x0, 0x0, 0x0, 0x0, 0x0, 0x0
.long 0x0, 0x0, 0x0, 0x0, 0x0, 0x0, 0x0, 0x0
.long 0x0, 0x0, 0x0, 0x0, 0x0, 0x0, 0x0, 0x0
.long 0x0, 0x0, 0x0, 0x0, 0x0, 0x0, 0x0, 0x0
.long 0x0, 0x0, 0x0, 0x0, 0xffff, 0x0, 0x0, 0x0
.long 0xffffffff, 0x0, 0x0, 0x0, 0xffff0000, 0xffff, 0x0, 0x0
.long 0x0, 0xffffffff, 0x0, 0x0, 0x0, 0xffff0000, 0xffff, 0x0
.long 0x0, 0x0, 0xffffffff, 0x0, 0x0, 0x0, 0xffff0000, 0xffff
.long 0x0, 0x0, 0x0, 0xffffffff, 0x0, 0x0, 0x0, 0xffff0000
.long 0x0, 0x0, 0x0, 0x0, 0x0, 0x0, 0x0, 0x0
.long 0x0, 0x0, 0x0, 0x0, 0x0, 0x0, 0x0, 0x0
.long 0x0, 0x0, 0x0, 0x0, 0x0, 0x0, 0x0, 0x0
.long 0x0, 0x0, 0x0, 0x0, 0x0, 0x0, 0x0, 0x0
.long 0x0, 0x0, 0x0, 0x0, 0x0, 0x0, 0x0, 0x0
.long 0x0, 0x0, 0x0, 0x0, 0x0, 0x0, 0x0, 0x0
.long 0x0, 0x0, 0x0, 0x0, 0x0, 0x0, 0x0, 0x0
.long 0x0, 0x0, 0x0, 0x0, 0xffff, 0x0, 0x0, 0x0
.long 0xffffffff, 0x0, 0x0, 0x0, 0xffff0000, 0xffff, 0x0, 0x0
.long 0x0, 0xffffffff, 0x0, 0x0, 0x0, 0xffff0000, 0xffff, 0x0
.long 0x878, 0x438, 0x230, 0x238, 0x858, 0x418, 0x210, 0x218
.long 0x838, 0x3f8, 0x1f0, 0x1f8, 0x818, 0x3d8, 0x1d0, 0x1d8
.long 0x7f8, 0x3b8, 0x1b0, 0x1b8, 0x7d8, 0x398, 0x190, 0x198
.long 0x7b8, 0x378, 0x170, 0x178, 0x798, 0x358, 0x150, 0x158
.long 0x778, 0x338, 0x130, 0x138, 0x758, 0x318, 0x110, 0x118
.long 0x738, 0x2f8, 0xf0, 0xf8, 0x718, 0x2d8, 0xd0, 0xd8
.long 0x6f8, 0x2b8, 0xb0, 0xb8, 0x6d8, 0x298, 0x90, 0x98
.long 0x6b8, 0x278, 0x70, 0x78, 0x698, 0x258, 0x50, 0x58
.long 0x868, 0x428, 0x220, 0x228, 0x848, 0x408, 0x200, 0x208
.long 0x828, 0x3e8, 0x1e0, 0x1e8, 0x808, 0x3c8, 0x1c0, 0x1c8
.long 0x7e8, 0x3a8, 0x1a0, 0x1a8, 0x7c8, 0x388, 0x180, 0x188
.long 0x7a8, 0x368, 0x160, 0x168, 0x788, 0x348, 0x140, 0x148
.long 0x768, 0x328, 0x120, 0x128, 0x748, 0x308, 0x100, 0x108
.long 0x728, 0x2e8, 0xe0, 0xe8, 0x708, 0x2c8, 0xc0, 0xc8
.long 0x6e8, 0x2a8, 0xa0, 0xa8, 0x6c8, 0x288, 0x80, 0x88
.long 0x6a8, 0x268, 0x60, 0x68, 0x688, 0x248, 0x40, 0x48
.long 0x870, 0x430, 0x90c, 0x94c, 0x850, 0x410, 0x908, 0x948
.long 0x830, 0x3f0, 0x904, 0x944, 0x810, 0x3d0, 0x900, 0x940
.long 0x7f0, 0x3b0, 0x8fc, 0x93c, 0x7d0, 0x390, 0x8f8, 0x938
.long 0x7b0, 0x370, 0x8f4, 0x934, 0x790, 0x350, 0x8f0, 0x930
.long 0x770, 0x330, 0x8ec, 0x92c, 0x750, 0x310, 0x8e8, 0x928
.long 0x730, 0x2f0, 0x8e4, 0x924, 0x710, 0x2d0, 0x8e0, 0x920
.long 0x6f0, 0x2b0, 0x8dc, 0x91c, 0x6d0, 0x290, 0x8d8, 0x918
.long 0x6b0, 0x270, 0x8d4, 0x914, 0x690, 0x250, 0x8d0, 0x910
.long 0x860, 0x420, 0x9cc, 0xa0c, 0x840, 0x400, 0x9c8, 0xa08
.long 0x820, 0x3e0, 0x9c4, 0xa04, 0x800, 0x3c0, 0x9c0, 0xa00
.long 0x7e0, 0x3a0, 0x9bc, 0x9fc, 0x7c0, 0x380, 0x9b8, 0x9f8
.long 0x7a0, 0x360, 0x9b4, 0x9f4, 0x780, 0x340, 0x9b0, 0x9f0
.long 0x760, 0x320, 0x9ac, 0x9ec, 0x740, 0x300, 0x9a8, 0x9e8
.long 0x720, 0x2e0, 0x9a4, 0x9e4, 0x700, 0x2c0, 0x9a0, 0x9e0
.long 0x6e0, 0x2a0, 0x99c, 0x9dc, 0x6c0, 0x280, 0x998, 0x9d8
.long 0x6a0, 0x260, 0x994, 0x9d4, 0x680, 0x240, 0x990, 0x9d0
.long 0x22c, 0x670, 0xb90, 0x23e, 0x20c, 0x650, 0xb90, 0xb90
.long 0x1ec, 0x630, 0xb90, 0xb90, 0x1cc, 0x610, 0xb90, 0xb90
.long 0x1ac, 0x5f0, 0xb90, 0xb90, 0x18c, 0x5d0, 0xb90, 0xb90
.long 0x16c, 0x5b0, 0xb90, 0xb90, 0x14c, 0x590, 0xb90, 0xb90
.long 0x12c, 0x570, 0xb90, 0xb90, 0x10c, 0x550, 0xb90, 0xb90
.long 0xec, 0x530, 0xb90, 0xb90, 0xcc, 0x510, 0xb90, 0xb90
.long 0xac, 0x4f0, 0xb90, 0xb90, 0x8c, 0x4d0, 0xb90, 0xb90
.long 0x6c, 0x4b0, 0xb90, 0xb90, 0x4c, 0x490, 0xb90, 0xb90
.long 0x21c, 0x660, 0xb90, 0xb90, 0x1fc, 0x640, 0xb90, 0xb90
.long 0x1dc, 0x620, 0xb90, 0xb90, 0x1bc, 0x600, 0xb90, 0xb90
.long 0x19c, 0x5e0, 0xb90, 0xb90, 0x17c, 0x5c0, 0xb90, 0xb90
.long 0x15c, 0x5a0, 0xb90, 0xb90, 0x13c, 0x580, 0xb90, 0xb90
.long 0x11c, 0x560, 0xb90, 0xb90, 0xfc, 0x540, 0xb90, 0xb90
.long 0xdc, 0x520, 0xb90, 0xb90, 0xbc, 0x500, 0xb90, 0xb90
.long 0x9c, 0x4e0, 0xb90, 0xb90, 0x7c, 0x4c0, 0xb90, 0xb90
.long 0x5c, 0x4a0, 0xb90, 0xb90, 0x3c, 0x480, 0x47c, 0xb90
.long 0xb90, 0xb90, 0xb90, 0xb4c, 0xb90, 0xb90, 0xb90, 0xb48
.long 0xb90, 0xb90, 0xb90, 0xb44, 0xb90, 0xb90, 0xb90, 0xb40
.long 0xb90, 0xb90, 0xb90, 0xb3c, 0xb90, 0xb90, 0xb90, 0xb38
.long 0xb90, 0xb90, 0xb90, 0xb34, 0xb90, 0xb90, 0xb90, 0xb30
.long 0xb90, 0xb90, 0xb90, 0xb2c, 0xb90, 0xb90, 0xb90, 0xb28
.long 0xb90, 0xb90, 0xb90, 0xb24, 0xb90, 0xb90, 0xb90, 0xb20
.long 0xb90, 0xb90, 0xb90, 0xb1c, 0xb90, 0xb90, 0xb90, 0xb18
.long 0xb90, 0xb90, 0xb90, 0xb14, 0xb90, 0xb90, 0xb90, 0xb10
.long 0xb90, 0xb90, 0xb90, 0xb4e, 0xb90, 0xb90, 0xb90, 0xb4a
.long 0xb90, 0xb90, 0xb90, 0xb46, 0xb90, 0xb90, 0xb90, 0xb42
.long 0xb90, 0xb90, 0xb90, 0xb3e, 0xb90, 0xb90, 0xb90, 0xb3a
.long 0xb90, 0xb90, 0xb90, 0xb36, 0xb90, 0xb90, 0xb90, 0xb32
.long 0xb90, 0xb90, 0xb90, 0xb2e, 0xb90, 0xb90, 0xb90, 0xb2a
.long 0xb90, 0xb90, 0xb90, 0xb26, 0xb90, 0xb90, 0xb90, 0xb22
.long 0xb90, 0xb90, 0xb90, 0xb1e, 0xb90, 0xb90, 0xb90, 0xb1a
.long 0xb90, 0xb90, 0xb90, 0xb16, 0xb90, 0xb90, 0xb90, 0xb12
.long 0x23c, 0x880, 0xb90, 0x4200, 0xb90, 0xb90, 0xb90, 0x4c50
.long 0xb90, 0xb90, 0xb90, 0x4410, 0xb90, 0xb90, 0xb90, 0x5070
.long 0xb90, 0xb90, 0xb90, 0x5280, 0xb90, 0xb90, 0xb90, 0x4620
.long 0xb90, 0xb90, 0xb90, 0x5490, 0xb90, 0xb90, 0xb90, 0x4830
.long 0xb90, 0xb90, 0xb90, 0x6510, 0xb90, 0xb90, 0xb90, 0x6d50
.long 0xb90, 0xb90, 0xb90, 0x56a0, 0xb90, 0xb90, 0xb90, 0x4a40
.long 0xb90, 0xb90, 0xb90, 0x6720, 0xb90, 0xb90, 0xb90, 0x6b40
.long 0xb90, 0xb90, 0xb90, 0x6930, 0xb90, 0xb90, 0xb90, 0x58b0
.long 0xb90, 0xb90, 0xb90, 0x6300, 0xb90, 0xb90, 0xb90, 0x6300
.long 0xb90, 0xb90, 0xb90, 0x4e60, 0xb90, 0xb90, 0xb90, 0x4a40
.long 0xb90, 0xb90, 0xb90, 0x5ac0, 0xb90, 0xb90, 0xb90, 0x5cd0
.long 0xb90, 0xb90, 0xb90, 0x5ee0, 0xb90, 0xb90, 0xb90, 0x60f0
.long 0xb90, 0xb90, 0xb90, 0x4e60, 0xb90, 0xb90, 0xb90, 0x4200
.long 0xb90, 0xb90, 0xb90, 0x4c50, 0xb90, 0xb90, 0xb90, 0x4410
.long 0xb90, 0xb90, 0xb90, 0x5070, 0xb90, 0xb90, 0xb90, 0x5280
.long 0xb90, 0xb90, 0xb90, 0x4620, 0xb90, 0xb90, 0x3a, 0x5490
.long 0xb0c, 0xacc, 0xa8c, 0x4210, 0xb08, 0xac8, 0xa88, 0x4c60
.long 0xb04, 0xac4, 0xa84, 0x4420, 0xb00, 0xac0, 0xa80, 0x5080
.long 0xafc, 0xabc, 0xa7c, 0x5290, 0xaf8, 0xab8, 0xa78, 0x4630
.long 0xaf4, 0xab4, 0xa74, 0x54a0, 0xaf0, 0xab0, 0xa70, 0x4840
.long 0xaec, 0xaac, 0xa6c, 0x6520, 0xae8, 0xaa8, 0xa68, 0x6d60
.long 0xae4, 0xaa4, 0xa64, 0x56b0, 0xae0, 0xaa0, 0xa60, 0x4a50
.long 0xadc, 0xa9c, 0xa5c, 0x6730, 0xad8, 0xa98, 0xa58, 0x6b50
.long 0xad4, 0xa94, 0xa54, 0x6940, 0xad0, 0xa90, 0xa50, 0x58c0
.long 0xb0e, 0xace, 0xa8e, 0x6310, 0xb0a, 0xaca, 0xa8a, 0x6310
.long 0xb06, 0xac6, 0xa86, 0x4e70, 0xb02, 0xac2, 0xa82, 0x4a50
.long 0xafe, 0xabe, 0xa7e, 0x5ad0, 0xafa, 0xaba, 0xa7a, 0x5ce0
.long 0xaf6, 0xab6, 0xa76, 0x5ef0, 0xaf2, 0xab2, 0xa72, 0x6100
.long 0xaee, 0xaae, 0xa6e, 0x4e70, 0xaea, 0xaaa, 0xa6a, 0x4210
.long 0xae6, 0xaa6, 0xa66, 0x4c60, 0xae2, 0xaa2, 0xa62, 0x4420
.long 0xade, 0xa9e, 0xa5e, 0x5080, 0xada, 0xa9a, 0xa5a, 0x5290
.long 0xad6, 0xa96, 0xa56, 0x4630, 0xad2, 0xa92, 0xa52, 0x54a0
TBLEND:
.size TBL, .-TBL
.section .rodata,"a"
.p2align 6
.amdhsa_kernel sequential_preLN__ssm_conv_s4d__moe_arch_mod__prompt_kernel
  .amdhsa_next_free_vgpr 256
  .amdhsa_next_free_sgpr 102
  .amdhsa_accum_offset 256
  .amdhsa_group_segment_fixed_size 0
  .amdhsa_kernarg_size 120
  .amdhsa_user_sgpr_count 2
  .amdhsa_user_sgpr_kernarg_segment_ptr 1
  .amdhsa_system_sgpr_workgroup_id_x 1
.end_amdhsa_kernel
```

```asm
; @launch grid=(248,1,1) block=(512,1,1) lds=163840
.amdgcn_target "amdgcn-amd-amdhsa--gfx950"
.text
.globl sequential_preLN__ssm_conv_s4d__moe_arch_mod__prompt_kernel
.p2align 8
.type sequential_preLN__ssm_conv_s4d__moe_arch_mod__prompt_kernel,@function
sequential_preLN__ssm_conv_s4d__moe_arch_mod__prompt_kernel:
    s_cmp_ge_u32 s2, 248
    s_cbranch_scc1 END
    s_load_dwordx16 s[4:19], s[0:1], 0
    s_load_dwordx8 s[20:27], s[0:1], 64
    s_load_dwordx2 s[28:29], s[0:1], 96
    s_load_dwordx2 s[30:31], s[0:1], 112
    s_getpc_b64 s[42:43]
PC0:
    v_and_b32 v1, 63, v0
    v_lshrrev_b32 v14, 6, v0
    v_lshlrev_b32 v15, 7, v0
    v_readfirstlane_b32 s3, v14
    s_add_u32 s44, s42, TBL-PC0
    s_addc_u32 s45, s43, 0
    v_lshlrev_b32 v2, 4, v1
    v_lshlrev_b32 v3, 4, v0
    s_sub_u32 s50, s2, 192
    s_cmp_lt_u32 s50, 24
    s_cbranch_scc1 FROLE
    s_and_b32 s51, s3, 3
    s_lshr_b32 s46, s3, 2
    s_sub_u32 s49, s2, 120
    s_cmp_lt_u32 s2, 216
    s_cselect_b32 s49, 255, s49
    s_cmp_lt_u32 s2, 96
    s_cselect_b32 s49, s2, s49
    s_sub_u32 s38, s2, 96
    s_cmp_lt_u32 s49, 128
    s_cselect_b32 s38, s49, s38
    s_cselect_b32 s39, s46, 1
    s_lshl_b32 s48, s38, 1
    s_add_u32 s48, s48, s39
    s_lshl_b32 s48, s48, 3
    s_add_u32 s48, s48, s51
    s_mul_i32 s50, s48, 1152
    v_and_b32 v13, 31, v1
    v_lshrrev_b32 v15, 5, v1
    v_mul_u32_u24 v14, 4608, v15
    v_add_u32 v14, s50, v14
    v_lshlrev_b32 v12, 4, v13
    v_lshlrev_b32 v13, 2, v13
    v_add_u32 v4, v12, v14
    v_add_u32 v5, v13, v14
    s_cmp_ge_u32 s2, 216
    s_cselect_b32 s61, 0, s46
    s_lshl_b32 s52, s2, 2
    s_add_u32 s52, s52, s51
    s_lshl_b32 s53, s52, 8
    s_lshl_b32 s54, s46, 7
    s_add_u32 s53, s53, s54
    v_lshl_add_u32 v34, v1, 1, s53
    v_xor_b32 v35, 128, v34
    v_mov_b32 v28, 0
    v_mov_b32 v29, 0
    v_mov_b32 v30, 0
    v_mov_b32 v31, 0
    v_mov_b32 v32, 0
    v_mov_b32 v33, 0
    s_lshl_b32 s54, s2, 3
    s_cmp_lg_u32 s61, 0
    s_waitcnt lgkmcnt(0)
    s_cbranch_scc1 C_NOX
    global_load_dwordx4 v[16:19], v4, s[4:5] nt
    global_load_dwordx4 v[20:23], v4, s[4:5] offset:512 nt
    global_load_dword v24, v5, s[4:5] offset:1024 nt
C_NOX:
    s_load_dword s40, s[30:31], 0
    s_cmp_ge_u32 s2, 144
    s_cbranch_scc1 C_NOP
    s_load_dwordx2 s[56:57], s[14:15], s54
    global_load_short_d16_hi v28, v34, s[6:7] nt
    global_load_short_d16_hi v29, v34, s[8:9] nt
    global_load_short_d16_hi v30, v34, s[10:11] nt
    global_load_short_d16_hi v31, v34, s[12:13] nt
    global_load_short_d16_hi v32, v35, s[10:11] nt
    global_load_short_d16_hi v33, v35, s[12:13] nt
C_NOP:
    s_mov_b32 s32, s30
    s_and_b32 s33, s31, 0xffff
    s_mov_b32 s34, 0x10000000
    s_mov_b32 s35, 0x00020000
    v_mov_b32 v6, 0x3f80
    v_mov_b32 v7, 1.0
    v_mov_b32 v8, 0x3f803f80
    v_mov_b32 v9, 0xfff8fff8
    v_mov_b32 v11, 0x40004
    v_mul_u32_u24 v15, 4736, v15
    s_and_b32 s46, s3, 4
    s_add_u32 s46, s46, s3
    s_mul_i32 s46, s46, 1184
    s_add_u32 s46, s46, 132608
    v_add_u32 v15, s46, v15
    v_add_u32 v25, v12, v15
    v_add_u32 v26, v13, v15
    s_lshr_b32 s46, s3, 2
    s_lshl_b32 s46, s46, 8
    s_mul_i32 s60, s51, 28512
    s_add_u32 s46, s60, s46
    v_lshl_add_u32 v40, v1, 2, s46
    v_add_u32 v41, 528, v40
    v_add_u32 v42, 1056, v40
    v_add_u32 v43, 1584, v40
    v_add_u32 v44, 2112, v40
    v_add_u32 v45, 2640, v40
    v_add_u32 v46, 3168, v40
    v_add_u32 v47, 3696, v40
    v_add_u32 v48, 4224, v40
    v_add_u32 v49, 4752, v40
    v_add_u32 v50, 5280, v40
    v_add_u32 v51, 5808, v40
    v_add_u32 v52, 6336, v40
    v_add_u32 v53, 6864, v40
    v_add_u32 v54, 7392, v40
    v_add_u32 v55, 7920, v40
    s_mul_i32 s62, s51, 2976
    s_add_u32 s62, s62, 151552
    s_cmp_ge_u32 s2, 144
    s_cbranch_scc1 C_O1
    s_cmp_lg_u32 s61, 0
    s_cbranch_scc1 C_O1
    v_and_b32 v14, 31, v1
    v_mul_u32_u24 v14, 528, v14
    v_lshrrev_b32 v15, 5, v1
    v_lshl_add_u32 v14, v15, 4, v14
    v_add_u32 v253, s60, v14
    v_add_u32 v27, 7168, v2
    v_mov_b32 v37, 0
    global_load_dwordx4 v[184:187], v27, s[44:45] offset:0
    global_load_dwordx4 v[188:191], v27, s[44:45] offset:1024
    global_load_dwordx4 v[192:195], v27, s[44:45] offset:2048
    global_load_dwordx4 v[208:211], v12, s[16:17]
    global_load_dwordx4 v[212:215], v12, s[16:17] offset:512
    global_load_dword v216, v13, s[16:17] offset:1024
    global_load_dwordx4 v[218:221], v12, s[20:21]
    global_load_dwordx4 v[222:225], v12, s[20:21] offset:512
    global_load_dword v226, v13, s[20:21] offset:1024
    s_waitcnt vmcnt(15)
    s_branch C_LN1
C_O1:
    v_bfe_u32 v15, v1, 2, 2
    v_mul_u32_u24 v14, 1184, v15
    v_lshrrev_b32 v15, 4, v1
    v_lshl_add_u32 v14, v15, 5, v14
    v_and_b32 v15, 3, v1
    v_lshl_add_u32 v14, v15, 3, v14
    s_cmp_ge_u32 s2, 216
    s_cselect_b32 s46, s39, 0
    s_mul_i32 s53, s46, 9472
    s_lshl_b32 s55, s51, 7
    s_add_u32 s53, s53, s55
    s_add_u32 s53, s53, 132608
    v_add_u32 v36, s53, v14
    v_lshrrev_b32 v14, 2, v1
    v_lshlrev_b32 v15, 4, v15
    v_lshl_add_u32 v37, v14, 14, v15
    s_cmp_lt_u32 s2, 96
    s_cselect_b32 s46, 0, s39
    s_lshl_b32 s46, s46, 6
    s_lshl_b32 s55, s38, 7
    s_add_u32 s55, s55, s46
    s_lshl_b32 s46, s51, 18
    s_add_u32 s55, s55, s46
    s_add_u32 s55, s55, 1048576
    s_add_u32 s36, s55, 1048576
    s_add_u32 s37, s55, 2097152
    v_mov_b32 v120, 0
    v_mov_b32 v121, 0
    v_mov_b32 v122, 0
    v_mov_b32 v123, 0
    s_lshl_b32 s46, s51, 10
    s_add_u32 s46, s46, 151296
    v_add_u32 v14, s46, v2
    v_max_u32 v15, 151552, v14
    ds_write_b128 v15, v[120:123]
    ds_write_b128 v14, v[120:123] offset:4096
    ds_write_b128 v14, v[120:123] offset:8192
    s_mul_i32 s46, s51, 4640
    s_add_u32 s46, s46, 114048
    v_add_u32 v14, s46, v12
    ds_write_b128 v14, v[120:123]
    s_waitcnt lgkmcnt(0)
    s_add_u32 s40, s40, 1
    s_and_b32 s41, s40, 7
    s_bfe_u32 s46, s40, 0x30003
    s_lshl_b32 s46, s46, 16
    s_or_b32 s41, s41, s46
    v_mov_b32 v10, s41
    s_cmp_eq_u32 s61, 0
    s_cbranch_scc1 C_O2
    s_cmp_ge_u32 s2, 144
    s_cbranch_scc1 C_BA
    s_waitcnt vmcnt(0)
    s_bitcmp1_b32 s51, 1
    s_cselect_b32 s56, s57, s56
    s_lshl_b32 s57, s56, 16
    s_and_b32 s56, s56, 0xffff0000
    s_bitcmp1_b32 s51, 0
    s_cselect_b32 s56, s56, s57
    v_mov_b32 v60, 0x3fb8aa3b
    v_mul_f32 v62, 0x3fb8aa3b, v28
    v_mul_f32 v60, s56, v60
    v_exp_f32 v62, v62
    v_exp_f32 v60, v60
    v_add_f32 v64, |v30|, |v31|
    v_add_f32 v65, |v32|, |v33|
    v_cvt_pk_bf16_f32 v62, 0, v62
    v_cvt_pk_bf16_f32 v60, 0, v60
    v_add_f32 v64, v64, v65
    v_mul_f32 v62, v62, v60
    v_mul_f32 v63, v29, v60
    v_mul_f32 v62, 0xbfb8aa3b, v62
    v_mul_f32 v63, 0.15915494, v63
    v_mul_f32 v104, 0x41000000, v62
    v_add_f32_dpp v64, v64, v64 row_ror:8 row_mask:0xf bank_mask:0xf
    v_mul_f32 v105, 0x41000000, v63
    v_exp_f32 v104, v104
    v_fract_f32 v105, v105
    v_add_f32_dpp v64, v64, v64 row_ror:4 row_mask:0xf bank_mask:0xf
    v_cos_f32 v72, v105
    v_sin_f32 v73, v105
    v_add_f32_dpp v64, v64, v64 row_ror:2 row_mask:0xf bank_mask:0xf
    v_pk_mul_f32 v[72:73], v[72:73], v[104:105] op_sel_hi:[1,0] neg_hi:[1,0]
    v_exp_f32 v106, v62
    v_add_f32_dpp v64, v64, v64 row_ror:1 row_mask:0xf bank_mask:0xf
    v_fract_f32 v107, v63
    v_cos_f32 v66, v107
    v_sin_f32 v67, v107
    v_mov_b32 v65, v64
    v_pk_mul_f32 v[66:67], v[66:67], v[106:107] op_sel_hi:[1,0]
    v_mul_f32 v108, 0x43800000, v62
    v_permlane16_swap_b32 v64, v65
    v_mul_f32 v109, 0x43800000, v63
    v_exp_f32 v108, v108
    v_add_f32 v64, v64, v65
    v_fract_f32 v109, v109
    v_cos_f32 v68, v109
    v_sin_f32 v69, v109
    v_mov_b32 v65, v64
    v_pk_mul_f32 v[68:69], v[68:69], v[108:109] op_sel_hi:[1,0]
    v_mov_b32 v162, 0x3c00
    v_pk_mul_f32 v[74:75], v[72:73], v[72:73] op_sel_hi:[1,0]
    v_permlane32_swap_b32 v64, v65
    v_pk_fma_f32 v[74:75], v[72:73], v[72:73], v[74:75] op_sel:[1,1,0] op_sel_hi:[0,1,1] neg_lo:[1,0,0]
    s_setprio 2
    s_branch C_BA
C_O2:
    global_load_dwordx4 v[208:211], v12, s[16:17]
    global_load_dwordx4 v[212:215], v12, s[16:17] offset:512
    global_load_dword v216, v13, s[16:17] offset:1024
    global_load_dwordx4 v[218:221], v12, s[20:21]
    global_load_dwordx4 v[222:225], v12, s[20:21] offset:512
    global_load_dword v226, v13, s[20:21] offset:1024
    s_waitcnt vmcnt(6)
C_LN1:
    v_dot2_f32_bf16 v120, v16, v8, 0
    v_dot2_f32_bf16 v121, v16, v16, 0
    v_dot2_f32_bf16 v120, v17, v8, v120
    v_dot2_f32_bf16 v121, v17, v17, v121
    v_dot2_f32_bf16 v120, v18, v8, v120
    v_dot2_f32_bf16 v121, v18, v18, v121
    v_dot2_f32_bf16 v120, v19, v8, v120
    v_dot2_f32_bf16 v121, v19, v19, v121
    v_dot2_f32_bf16 v120, v20, v8, v120
    v_dot2_f32_bf16 v121, v20, v20, v121
    v_dot2_f32_bf16 v120, v21, v8, v120
    v_dot2_f32_bf16 v121, v21, v21, v121
    v_dot2_f32_bf16 v120, v22, v8, v120
    v_dot2_f32_bf16 v121, v22, v22, v121
    v_dot2_f32_bf16 v120, v23, v8, v120
    v_dot2_f32_bf16 v121, v23, v23, v121
    v_dot2_f32_bf16 v120, v24, v8, v120
    v_dot2_f32_bf16 v121, v24, v24, v121
    s_nop 2
    v_permlane16_swap_b32 v120, v121
    v_add_f32 v120, v120, v121
    s_nop 1
    v_add_f32_dpp v120, v120, v120 row_ror:8 row_mask:0xf bank_mask:0xf
    s_nop 1
    v_add_f32_dpp v120, v120, v120 row_ror:4 row_mask:0xf bank_mask:0xf
    s_nop 1
    v_add_f32_dpp v120, v120, v120 row_ror:2 row_mask:0xf bank_mask:0xf
    s_nop 1
    v_add_f32_dpp v120, v120, v120 row_ror:1 row_mask:0xf bank_mask:0xf
    v_mov_b32 v121, v120
    s_nop 1
    v_permlane16_swap_b32 v120, v121
    v_mul_f32 v120, 0x3ae38e39, v120
    v_mul_f32 v121, 0x3ae38e39, v121
    v_fma_f32 v121, -v120, v120, v121
    v_cvt_pk_bf16_f32 v122, 0, v120
    v_dot2_f32_bf16 v126, v16, v6, v122 neg_lo:[0,0,1]
    v_max_f32 v121, 0, v121
    v_dot2_f32_bf16 v127, v16, v7, v122 neg_lo:[0,0,1]
    v_dot2_f32_bf16 v128, v17, v6, v122 neg_lo:[0,0,1]
    v_dot2_f32_bf16 v129, v17, v7, v122 neg_lo:[0,0,1]
    v_cvt_pk_bf16_f32 v121, 0, v121
    v_dot2_f32_bf16 v130, v18, v6, v122 neg_lo:[0,0,1]
    v_dot2_f32_bf16 v131, v18, v7, v122 neg_lo:[0,0,1]
    v_add_f32 v121, 0x3727c5ac, v121
    v_dot2_f32_bf16 v132, v19, v6, v122 neg_lo:[0,0,1]
    v_dot2_f32_bf16 v133, v19, v7, v122 neg_lo:[0,0,1]
    v_dot2_f32_bf16 v134, v20, v6, v122 neg_lo:[0,0,1]
    v_cvt_pk_bf16_f32 v121, 0, v121
    v_dot2_f32_bf16 v135, v20, v7, v122 neg_lo:[0,0,1]
    v_dot2_f32_bf16 v136, v21, v6, v122 neg_lo:[0,0,1]
    v_dot2_f32_bf16 v137, v21, v7, v122 neg_lo:[0,0,1]
    v_sqrt_f32 v121, v121
    v_dot2_f32_bf16 v138, v22, v6, v122 neg_lo:[0,0,1]
    v_dot2_f32_bf16 v139, v22, v7, v122 neg_lo:[0,0,1]
    v_cvt_pk_bf16_f32 v121, 0, v121
    v_dot2_f32_bf16 v140, v23, v6, v122 neg_lo:[0,0,1]
    v_dot2_f32_bf16 v141, v23, v7, v122 neg_lo:[0,0,1]
    v_dot2_f32_bf16 v142, v24, v6, v122 neg_lo:[0,0,1]
    v_rcp_f32 v124, v121
    v_dot2_f32_bf16 v143, v24, v7, v122 neg_lo:[0,0,1]
    v_cvt_pk_bf16_f32 v126, 0, v126
    v_cvt_pk_bf16_f32 v127, 0, v127
    v_cvt_pk_bf16_f32 v128, 0, v128
    v_cvt_pk_bf16_f32 v129, 0, v129
    v_cvt_pk_bf16_f32 v130, 0, v130
    v_cvt_pk_bf16_f32 v131, 0, v131
    v_cvt_pk_bf16_f32 v132, 0, v132
    v_cvt_pk_bf16_f32 v133, 0, v133
    v_cvt_pk_bf16_f32 v134, 0, v134
    v_cvt_pk_bf16_f32 v135, 0, v135
    v_cvt_pk_bf16_f32 v136, 0, v136
    v_cvt_pk_bf16_f32 v137, 0, v137
    v_cvt_pk_bf16_f32 v138, 0, v138
    v_cvt_pk_bf16_f32 v139, 0, v139
    v_cvt_pk_bf16_f32 v140, 0, v140
    v_cvt_pk_bf16_f32 v141, 0, v141
    v_cvt_pk_bf16_f32 v142, 0, v142
    v_cvt_pk_bf16_f32 v143, 0, v143
    v_pk_mul_f32 v[126:127], v[126:127], v[124:125] op_sel_hi:[1,0]
    v_pk_mul_f32 v[128:129], v[128:129], v[124:125] op_sel_hi:[1,0]
    v_pk_mul_f32 v[130:131], v[130:131], v[124:125] op_sel_hi:[1,0]
    v_pk_mul_f32 v[132:133], v[132:133], v[124:125] op_sel_hi:[1,0]
    v_pk_mul_f32 v[134:135], v[134:135], v[124:125] op_sel_hi:[1,0]
    v_pk_mul_f32 v[136:137], v[136:137], v[124:125] op_sel_hi:[1,0]
    v_pk_mul_f32 v[138:139], v[138:139], v[124:125] op_sel_hi:[1,0]
    v_pk_mul_f32 v[140:141], v[140:141], v[124:125] op_sel_hi:[1,0]
    v_pk_mul_f32 v[142:143], v[142:143], v[124:125] op_sel_hi:[1,0]
    v_cvt_pkrtz_f16_f32 v144, v126, v127
    v_cvt_pkrtz_f16_f32 v145, v128, v129
    v_cvt_pkrtz_f16_f32 v146, v130, v131
    v_cvt_pkrtz_f16_f32 v147, v132, v133
    v_cvt_pkrtz_f16_f32 v148, v134, v135
    ds_write_b128 v25, v[144:147]
    v_cvt_pkrtz_f16_f32 v149, v136, v137
    v_cvt_pkrtz_f16_f32 v150, v138, v139
    v_cvt_pkrtz_f16_f32 v151, v140, v141
    v_cvt_pkrtz_f16_f32 v152, v142, v143
    ds_write_b128 v25, v[148:151] offset:512
    ds_write_b32 v26, v152 offset:1024
    s_waitcnt lgkmcnt(0)
C_BA:
    s_barrier
    s_cmp_ge_u32 s3, 4
    s_cbranch_scc1 C_US
    s_cmp_lt_u32 s2, 144
    s_cbranch_scc1 C_K1
    s_cmp_ge_u32 s49, 128
    s_cbranch_scc1 FROLE
C_US:
    ds_read_b64_tr_b16 v[228:229], v36 offset:0
    ds_read_b64_tr_b16 v[230:231], v36 offset:4736
    ds_read_b64_tr_b16 v[232:233], v36 offset:512
    ds_read_b64_tr_b16 v[234:235], v36 offset:5248
    ds_read_b64_tr_b16 v[236:237], v36 offset:1024
    ds_read_b64_tr_b16 v[238:239], v36 offset:5760
    s_waitcnt lgkmcnt(4)
    v_add_u32 v228, v11, v228
    v_add_u32 v229, v11, v229
    v_add_u32 v230, v11, v230
    v_add_u32 v231, v11, v231
    v_and_or_b32 v228, v228, v9, v10
    v_and_or_b32 v229, v229, v9, v10
    v_and_or_b32 v230, v230, v9, v10
    v_and_or_b32 v231, v231, v9, v10
    buffer_store_dwordx4 v[228:231], v37, s[32:35], s55 offen sc1
    s_waitcnt lgkmcnt(2)
    v_add_u32 v232, v11, v232
    v_add_u32 v233, v11, v233
    v_add_u32 v234, v11, v234
    v_add_u32 v235, v11, v235
    v_and_or_b32 v232, v232, v9, v10
    v_and_or_b32 v233, v233, v9, v10
    v_and_or_b32 v234, v234, v9, v10
    v_and_or_b32 v235, v235, v9, v10
    buffer_store_dwordx4 v[232:235], v37, s[32:35], s36 offen sc1
    s_cmp_lg_u32 s51, 0
    s_cbranch_scc1 US1
    s_waitcnt lgkmcnt(0)
    v_add_u32 v236, v11, v236
    v_add_u32 v237, v11, v237
    v_add_u32 v238, v11, v238
    v_add_u32 v239, v11, v239
    v_and_or_b32 v236, v236, v9, v10
    v_and_or_b32 v237, v237, v9, v10
    v_and_or_b32 v238, v238, v9, v10
    v_and_or_b32 v239, v239, v9, v10
    buffer_store_dwordx4 v[236:239], v37, s[32:35], s37 offen sc1
US1:
    s_cmp_ge_u32 s2, 144
    s_cbranch_scc1 C_O3
    s_branch C_K2
C_O3:
    s_cmp_lt_u32 s49, 128
    s_cbranch_scc1 C_RL2
    v_subrev_u32 v14, 9472, v25
    v_subrev_u32 v15, 9472, v26
    ds_read_b128 v[140:143], v14
    ds_read_b128 v[144:147], v14 offset:512
    ds_read_b32 v148, v15 offset:1024
    s_mov_b32 s46, 10485760
    s_waitcnt lgkmcnt(0)
    v_add_u32 v140, v11, v140
    v_add_u32 v141, v11, v141
    v_add_u32 v142, v11, v142
    v_add_u32 v143, v11, v143
    v_add_u32 v144, v11, v144
    v_add_u32 v145, v11, v145
    v_add_u32 v146, v11, v146
    v_add_u32 v147, v11, v147
    v_add_u32 v148, v11, v148
    v_and_or_b32 v140, v140, v9, v10
    v_and_or_b32 v141, v141, v9, v10
    v_and_or_b32 v142, v142, v9, v10
    v_and_or_b32 v143, v143, v9, v10
    v_and_or_b32 v144, v144, v9, v10
    v_and_or_b32 v145, v145, v9, v10
    v_and_or_b32 v146, v146, v9, v10
    v_and_or_b32 v147, v147, v9, v10
    v_and_or_b32 v148, v148, v9, v10
    buffer_store_dwordx4 v[140:143], v4, s[32:35], s46 offen sc1
    buffer_store_dwordx4 v[144:147], v4, s[32:35], s46 offen offset:512 sc1
    buffer_store_dword v148, v5, s[32:35], s46 offen offset:1024 sc1
    s_branch FROLE
C_RL2:
    s_waitcnt vmcnt(0)
    s_branch RPREP
C_K1:
    s_add_u32 s40, s40, 1
    s_and_b32 s41, s40, 7
    s_bfe_u32 s46, s40, 0x30003
    s_lshl_b32 s46, s46, 16
    s_or_b32 s41, s41, s46
    v_mov_b32 v10, s41
    s_waitcnt vmcnt(9)
    s_bitcmp1_b32 s51, 1
    s_cselect_b32 s56, s57, s56
    s_lshl_b32 s57, s56, 16
    s_and_b32 s56, s56, 0xffff0000
    s_bitcmp1_b32 s51, 0
    s_cselect_b32 s56, s56, s57
    v_mov_b32 v60, 0x3fb8aa3b
    v_mul_f32 v62, 0x3fb8aa3b, v28
    v_mul_f32 v60, s56, v60
    v_exp_f32 v62, v62
    v_exp_f32 v60, v60
    v_add_f32 v64, |v30|, |v31|
    v_add_f32 v65, |v32|, |v33|
    v_cvt_pk_bf16_f32 v62, 0, v62
    v_cvt_pk_bf16_f32 v60, 0, v60
    v_add_f32 v64, v64, v65
    v_mul_f32 v62, v62, v60
    v_mul_f32 v63, v29, v60
    v_mul_f32 v62, 0xbfb8aa3b, v62
    v_mul_f32 v63, 0.15915494, v63
    v_mul_f32 v104, 0x41000000, v62
    v_add_f32_dpp v64, v64, v64 row_ror:8 row_mask:0xf bank_mask:0xf
    v_mul_f32 v105, 0x41000000, v63
    v_exp_f32 v104, v104
    v_fract_f32 v105, v105
    v_add_f32_dpp v64, v64, v64 row_ror:4 row_mask:0xf bank_mask:0xf
    v_cos_f32 v72, v105
    v_sin_f32 v73, v105
    v_add_f32_dpp v64, v64, v64 row_ror:2 row_mask:0xf bank_mask:0xf
    v_pk_mul_f32 v[72:73], v[72:73], v[104:105] op_sel_hi:[1,0] neg_hi:[1,0]
    v_exp_f32 v106, v62
    v_add_f32_dpp v64, v64, v64 row_ror:1 row_mask:0xf bank_mask:0xf
    v_fract_f32 v107, v63
    v_cos_f32 v66, v107
    v_sin_f32 v67, v107
    v_mov_b32 v65, v64
    v_pk_mul_f32 v[66:67], v[66:67], v[106:107] op_sel_hi:[1,0]
    v_mul_f32 v108, 0x43800000, v62
    v_permlane16_swap_b32 v64, v65
    v_mul_f32 v109, 0x43800000, v63
    v_exp_f32 v108, v108
    v_add_f32 v64, v64, v65
    v_fract_f32 v109, v109
    v_cos_f32 v68, v109
    v_sin_f32 v69, v109
    v_mov_b32 v65, v64
    v_pk_mul_f32 v[68:69], v[68:69], v[108:109] op_sel_hi:[1,0]
    v_mov_b32 v162, 0x3c00
    v_pk_mul_f32 v[74:75], v[72:73], v[72:73] op_sel_hi:[1,0]
    v_permlane32_swap_b32 v64, v65
    v_pk_fma_f32 v[74:75], v[72:73], v[72:73], v[74:75] op_sel:[1,1,0] op_sel_hi:[0,1,1] neg_lo:[1,0,0]
C_K2:
    v_pk_mul_f32 v[76:77], v[74:75], v[72:73] op_sel_hi:[1,0]
    v_pk_mul_f32 v[78:79], v[74:75], v[74:75] op_sel_hi:[1,0]
    v_cvt_pk_f16_f32 v163, v72, v73
    v_cvt_pk_f16_f32 v164, v74, v75
    v_add_f32 v64, v64, v65
    v_pk_fma_f32 v[76:77], v[74:75], v[72:73], v[76:77] op_sel:[1,1,0] op_sel_hi:[0,1,1] neg_lo:[1,0,0]
    v_pk_fma_f32 v[78:79], v[74:75], v[74:75], v[78:79] op_sel:[1,1,0] op_sel_hi:[0,1,1] neg_lo:[1,0,0]
    ds_write2st64_b32 v40, v163, v162 offset0:33 offset1:0
    v_pk_mul_f32 v[80:81], v[78:79], v[72:73] op_sel_hi:[1,0]
    v_pk_mul_f32 v[82:83], v[78:79], v[74:75] op_sel_hi:[1,0]
    v_cvt_pk_f16_f32 v165, v76, v77
    v_cvt_pk_f16_f32 v166, v78, v79
    v_mul_f32 v64, v64, v60
    v_pk_fma_f32 v[80:81], v[78:79], v[72:73], v[80:81] op_sel:[1,1,0] op_sel_hi:[0,1,1] neg_lo:[1,0,0]
    v_pk_fma_f32 v[82:83], v[78:79], v[74:75], v[82:83] op_sel:[1,1,0] op_sel_hi:[0,1,1] neg_lo:[1,0,0]
    ds_write2st64_b32 v41, v165, v164 offset0:33 offset1:0
    v_pk_mul_f32 v[84:85], v[78:79], v[76:77] op_sel_hi:[1,0]
    v_pk_mul_f32 v[86:87], v[78:79], v[78:79] op_sel_hi:[1,0]
    v_cvt_pk_f16_f32 v167, v80, v81
    v_cvt_pk_f16_f32 v56, v82, v83
    v_frexp_exp_i32_f32 v64, v64
    v_pk_fma_f32 v[84:85], v[78:79], v[76:77], v[84:85] op_sel:[1,1,0] op_sel_hi:[0,1,1] neg_lo:[1,0,0]
    v_pk_fma_f32 v[86:87], v[78:79], v[78:79], v[86:87] op_sel:[1,1,0] op_sel_hi:[0,1,1] neg_lo:[1,0,0]
    ds_write2st64_b32 v42, v167, v166 offset0:33 offset1:0
    v_pk_mul_f32 v[88:89], v[86:87], v[72:73] op_sel_hi:[1,0]
    v_pk_mul_f32 v[90:91], v[86:87], v[74:75] op_sel_hi:[1,0]
    v_cvt_pk_f16_f32 v57, v84, v85
    v_cvt_pk_f16_f32 v163, v86, v87
    v_max_i32 v64, -100, v64
    v_pk_fma_f32 v[88:89], v[86:87], v[72:73], v[88:89] op_sel:[1,1,0] op_sel_hi:[0,1,1] neg_lo:[1,0,0]
    v_pk_fma_f32 v[90:91], v[86:87], v[74:75], v[90:91] op_sel:[1,1,0] op_sel_hi:[0,1,1] neg_lo:[1,0,0]
    ds_write2st64_b32 v43, v57, v56 offset0:33 offset1:0
    v_pk_mul_f32 v[92:93], v[86:87], v[76:77] op_sel_hi:[1,0]
    v_pk_mul_f32 v[94:95], v[86:87], v[78:79] op_sel_hi:[1,0]
    v_cvt_pk_f16_f32 v162, v88, v89
    v_cvt_pk_f16_f32 v165, v90, v91
    v_min_i32 v64, 100, v64
    v_pk_fma_f32 v[92:93], v[86:87], v[76:77], v[92:93] op_sel:[1,1,0] op_sel_hi:[0,1,1] neg_lo:[1,0,0]
    v_pk_fma_f32 v[94:95], v[86:87], v[78:79], v[94:95] op_sel:[1,1,0] op_sel_hi:[0,1,1] neg_lo:[1,0,0]
    ds_write2st64_b32 v44, v162, v163 offset0:33 offset1:0
    v_pk_mul_f32 v[96:97], v[86:87], v[80:81] op_sel_hi:[1,0]
    v_pk_mul_f32 v[98:99], v[86:87], v[82:83] op_sel_hi:[1,0]
    v_cvt_pk_f16_f32 v164, v92, v93
    v_cvt_pk_f16_f32 v167, v94, v95
    v_sub_u32 v65, 0, v64
    v_pk_fma_f32 v[96:97], v[86:87], v[80:81], v[96:97] op_sel:[1,1,0] op_sel_hi:[0,1,1] neg_lo:[1,0,0]
    v_pk_fma_f32 v[98:99], v[86:87], v[82:83], v[98:99] op_sel:[1,1,0] op_sel_hi:[0,1,1] neg_lo:[1,0,0]
    ds_write2st64_b32 v45, v164, v165 offset0:33 offset1:0
    v_pk_mul_f32 v[100:101], v[86:87], v[84:85] op_sel_hi:[1,0]
    v_pk_mul_f32 v[102:103], v[86:87], v[86:87] op_sel_hi:[1,0]
    v_cvt_pk_f16_f32 v166, v96, v97
    v_cvt_pk_f16_f32 v57, v98, v99
    v_ldexp_f32 v60, v60, v65
    v_pk_fma_f32 v[100:101], v[86:87], v[84:85], v[100:101] op_sel:[1,1,0] op_sel_hi:[0,1,1] neg_lo:[1,0,0]
    v_pk_fma_f32 v[102:103], v[86:87], v[86:87], v[102:103] op_sel:[1,1,0] op_sel_hi:[0,1,1] neg_lo:[1,0,0]
    ds_write2st64_b32 v46, v166, v167 offset0:33 offset1:0
    v_pk_mul_f32 v[112:113], v[102:103], v[72:73] op_sel_hi:[1,0]
    v_pk_mul_f32 v[114:115], v[102:103], v[74:75] op_sel_hi:[1,0]
    v_cvt_pk_f16_f32 v56, v100, v101
    v_cvt_pk_f16_f32 v162, v102, v103
    v_pk_mul_f32 v[30:31], v[30:31], v[60:61] op_sel_hi:[1,0]
    v_pk_fma_f32 v[112:113], v[102:103], v[72:73], v[112:113] op_sel:[1,1,0] op_sel_hi:[0,1,1] neg_lo:[1,0,0]
    v_pk_fma_f32 v[114:115], v[102:103], v[74:75], v[114:115] op_sel:[1,1,0] op_sel_hi:[0,1,1] neg_lo:[1,0,0]
    ds_write2st64_b32 v47, v56, v57 offset0:33 offset1:0
    v_pk_mul_f32 v[116:117], v[102:103], v[76:77] op_sel_hi:[1,0]
    v_pk_mul_f32 v[110:111], v[102:103], v[78:79] op_sel_hi:[1,0]
    v_cvt_pk_f16_f32 v163, v112, v113
    v_cvt_pk_f16_f32 v164, v114, v115
    v_pk_fma_f32 v[116:117], v[102:103], v[76:77], v[116:117] op_sel:[1,1,0] op_sel_hi:[0,1,1] neg_lo:[1,0,0]
    v_pk_fma_f32 v[110:111], v[102:103], v[78:79], v[110:111] op_sel:[1,1,0] op_sel_hi:[0,1,1] neg_lo:[1,0,0]
    ds_write2st64_b32 v48, v163, v162 offset0:33 offset1:0
    v_pk_mul_f32 v[112:113], v[102:103], v[80:81] op_sel_hi:[1,0]
    v_pk_mul_f32 v[114:115], v[102:103], v[82:83] op_sel_hi:[1,0]
    v_cvt_pk_f16_f32 v165, v116, v117
    v_cvt_pk_f16_f32 v166, v110, v111
    v_pk_fma_f32 v[112:113], v[102:103], v[80:81], v[112:113] op_sel:[1,1,0] op_sel_hi:[0,1,1] neg_lo:[1,0,0]
    v_pk_fma_f32 v[114:115], v[102:103], v[82:83], v[114:115] op_sel:[1,1,0] op_sel_hi:[0,1,1] neg_lo:[1,0,0]
    ds_write2st64_b32 v49, v165, v164 offset0:33 offset1:0
    s_setprio 0
    v_pk_mul_f32 v[120:121], v[30:31], v[66:67] op_sel_hi:[1,0]
    v_cvt_pk_f16_f32 v167, v112, v113
    v_cvt_pk_f16_f32 v56, v114, v115
    v_pk_fma_f32 v[120:121], v[30:31], v[66:67], v[120:121] op_sel:[1,1,0] op_sel_hi:[0,1,1] neg_lo:[1,0,0]
    ds_write2st64_b32 v50, v167, v166 offset0:33 offset1:0
    s_cmp_ge_u32 s3, 4
    s_cbranch_scc1 C_K3
    v_add_u32 v64, 1, v64
    s_and_b32 s46, s40, 0x7fffff
    v_ldexp_f32 v64, 1.0, v64
    s_lshl_b32 s53, s2, 7
    v_or_b32 v64, s46, v64
    s_lshl_b32 s46, s51, 2
    s_add_u32 s46, s46, s53
    s_add_u32 s46, s46, 32768
    s_mov_b64 exec, 1
    buffer_store_dword v64, v2, s[32:35], s46 offen sc1
    s_mov_b64 exec, -1
    s_branch C_K4
C_K3:
    v_add_u32 v27, 4096, v2
    global_load_dwordx4 v[168:171], v27, s[44:45] offset:-4096
    global_load_dwordx4 v[172:175], v27, s[44:45] offset:-3072
    global_load_dwordx4 v[176:179], v27, s[44:45] offset:-2048
    global_load_dwordx4 v[180:183], v27, s[44:45] offset:-1024
    global_load_dwordx4 v[184:187], v27, s[44:45] offset:0
    global_load_dwordx4 v[188:191], v27, s[44:45] offset:1024
    global_load_dwordx4 v[192:195], v27, s[44:45] offset:2048
    s_lshl_b32 s48, s2, 14
    s_lshl_b32 s46, s51, 12
    s_add_u32 s48, s48, s46
    s_add_u32 s48, s48, 1048576
C_K4:
    v_pk_mul_f32 v[136:137], v[30:31], v[68:69] op_sel_hi:[1,0]
    v_pk_mul_f32 v[122:123], v[120:121], v[66:67] op_sel_hi:[1,0]
    v_cvt_pk_f16_f32 v57, v30, v31
    v_cvt_pk_f16_f32 v163, v120, v121
    v_pk_fma_f32 v[136:137], v[30:31], v[68:69], v[136:137] op_sel:[1,1,0] op_sel_hi:[0,1,1] neg_lo:[1,0,0]
    v_pk_fma_f32 v[122:123], v[120:121], v[66:67], v[122:123] op_sel:[1,1,0] op_sel_hi:[0,1,1] neg_lo:[1,0,0]
    ds_write_b32 v46, v57 offset:16896
    v_pk_mul_f32 v[124:125], v[122:123], v[66:67] op_sel_hi:[1,0]
    v_pk_mul_f32 v[138:139], v[122:123], v[68:69] op_sel_hi:[1,0]
    v_cvt_pk_f16_f32 v162, v136, v137
    v_cvt_pk_f16_f32 v165, v122, v123
    v_pk_fma_f32 v[124:125], v[122:123], v[66:67], v[124:125] op_sel:[1,1,0] op_sel_hi:[0,1,1] neg_lo:[1,0,0]
    v_pk_fma_f32 v[138:139], v[122:123], v[68:69], v[138:139] op_sel:[1,1,0] op_sel_hi:[0,1,1] neg_lo:[1,0,0]
    ds_write2st64_b32 v40, v162, v163 offset0:99 offset1:66
    v_pk_mul_f32 v[126:127], v[124:125], v[66:67] op_sel_hi:[1,0]
    v_cvt_pk_f16_f32 v164, v124, v125
    v_cvt_pk_f16_f32 v167, v138, v139
    v_pk_fma_f32 v[126:127], v[124:125], v[66:67], v[126:127] op_sel:[1,1,0] op_sel_hi:[0,1,1] neg_lo:[1,0,0]
    ds_write2st64_b32 v41, v167, v164 offset0:99 offset1:66
    v_pk_mul_f32 v[128:129], v[126:127], v[66:67] op_sel_hi:[1,0]
    v_pk_mul_f32 v[140:141], v[126:127], v[68:69] op_sel_hi:[1,0]
    v_cvt_pk_f16_f32 v166, v126, v127
    v_pk_fma_f32 v[128:129], v[126:127], v[66:67], v[128:129] op_sel:[1,1,0] op_sel_hi:[0,1,1] neg_lo:[1,0,0]
    v_pk_fma_f32 v[140:141], v[126:127], v[68:69], v[140:141] op_sel:[1,1,0] op_sel_hi:[0,1,1] neg_lo:[1,0,0]
    ds_write_b32 v47, v166 offset:16896
    v_pk_mul_f32 v[130:131], v[128:129], v[66:67] op_sel_hi:[1,0]
    v_pk_mul_f32 v[146:147], v[140:141], v[68:69] op_sel_hi:[1,0]
    v_cvt_pk_f16_f32 v57, v128, v129
    v_cvt_pk_f16_f32 v162, v140, v141
    v_pk_fma_f32 v[130:131], v[128:129], v[66:67], v[130:131] op_sel:[1,1,0] op_sel_hi:[0,1,1] neg_lo:[1,0,0]
    v_pk_fma_f32 v[146:147], v[140:141], v[68:69], v[146:147] op_sel:[1,1,0] op_sel_hi:[0,1,1] neg_lo:[1,0,0]
    ds_write_b32 v48, v57 offset:16896
    v_pk_mul_f32 v[132:133], v[130:131], v[66:67] op_sel_hi:[1,0]
    v_pk_mul_f32 v[142:143], v[130:131], v[68:69] op_sel_hi:[1,0]
    v_cvt_pk_f16_f32 v163, v130, v131
    v_cvt_pk_f16_f32 v167, v146, v147
    v_pk_fma_f32 v[132:133], v[130:131], v[66:67], v[132:133] op_sel:[1,1,0] op_sel_hi:[0,1,1] neg_lo:[1,0,0]
    v_pk_fma_f32 v[142:143], v[130:131], v[68:69], v[142:143] op_sel:[1,1,0] op_sel_hi:[0,1,1] neg_lo:[1,0,0]
    ds_write2st64_b32 v45, v162, v165 offset0:99 offset1:66
    v_pk_mul_f32 v[134:135], v[132:133], v[66:67] op_sel_hi:[1,0]
    v_pk_mul_f32 v[150:151], v[146:147], v[68:69] op_sel_hi:[1,0]
    v_cvt_pk_f16_f32 v164, v132, v133
    v_cvt_pk_f16_f32 v166, v142, v143
    v_pk_fma_f32 v[134:135], v[132:133], v[66:67], v[134:135] op_sel:[1,1,0] op_sel_hi:[0,1,1] neg_lo:[1,0,0]
    v_pk_fma_f32 v[150:151], v[146:147], v[68:69], v[150:151] op_sel:[1,1,0] op_sel_hi:[0,1,1] neg_lo:[1,0,0]
    ds_write2st64_b32 v42, v167, v163 offset0:99 offset1:66
    v_pk_mul_f32 v[144:145], v[134:135], v[68:69] op_sel_hi:[1,0]
    v_pk_mul_f32 v[116:117], v[102:103], v[84:85] op_sel_hi:[1,0]
    ds_write_b32 v49, v164 offset:16896
    v_cvt_pk_f16_f32 v57, v134, v135
    v_cvt_pk_f16_f32 v162, v150, v151
    v_pk_fma_f32 v[144:145], v[134:135], v[68:69], v[144:145] op_sel:[1,1,0] op_sel_hi:[0,1,1] neg_lo:[1,0,0]
    v_pk_fma_f32 v[116:117], v[102:103], v[84:85], v[116:117] op_sel:[1,1,0] op_sel_hi:[0,1,1] neg_lo:[1,0,0]
    ds_write_b32 v50, v166 offset:16896
    v_pk_mul_f32 v[148:149], v[144:145], v[68:69] op_sel_hi:[1,0]
    v_pk_mul_f32 v[110:111], v[102:103], v[86:87] op_sel_hi:[1,0]
    v_cvt_pk_f16_f32 v165, v144, v145
    v_cvt_pk_f16_f32 v167, v116, v117
    v_pk_fma_f32 v[148:149], v[144:145], v[68:69], v[148:149] op_sel:[1,1,0] op_sel_hi:[0,1,1] neg_lo:[1,0,0]
    v_pk_fma_f32 v[110:111], v[102:103], v[86:87], v[110:111] op_sel:[1,1,0] op_sel_hi:[0,1,1] neg_lo:[1,0,0]
    ds_write2st64_b32 v43, v162, v57 offset0:99 offset1:66
    v_pk_mul_f32 v[152:153], v[148:149], v[68:69] op_sel_hi:[1,0]
    v_pk_mul_f32 v[112:113], v[102:103], v[88:89] op_sel_hi:[1,0]
    v_cvt_pk_f16_f32 v163, v148, v149
    v_cvt_pk_f16_f32 v164, v110, v111
    v_pk_fma_f32 v[152:153], v[148:149], v[68:69], v[152:153] op_sel:[1,1,0] op_sel_hi:[0,1,1] neg_lo:[1,0,0]
    v_pk_fma_f32 v[112:113], v[102:103], v[88:89], v[112:113] op_sel:[1,1,0] op_sel_hi:[0,1,1] neg_lo:[1,0,0]
    ds_write2st64_b32 v51, v167, v56 offset0:33 offset1:0
    v_pk_mul_f32 v[114:115], v[102:103], v[90:91] op_sel_hi:[1,0]
    v_pk_mul_f32 v[154:155], v[152:153], v[68:69] op_sel_hi:[1,0]
    v_cvt_pk_f16_f32 v166, v152, v153
    v_cvt_pk_f16_f32 v162, v112, v113
    v_pk_fma_f32 v[114:115], v[102:103], v[90:91], v[114:115] op_sel:[1,1,0] op_sel_hi:[0,1,1] neg_lo:[1,0,0]
    v_pk_fma_f32 v[154:155], v[152:153], v[68:69], v[154:155] op_sel:[1,1,0] op_sel_hi:[0,1,1] neg_lo:[1,0,0]
    ds_write2st64_b32 v44, v163, v165 offset0:99 offset1:66
    v_pk_mul_f32 v[116:117], v[102:103], v[92:93] op_sel_hi:[1,0]
    v_pk_mul_f32 v[156:157], v[154:155], v[68:69] op_sel_hi:[1,0]
    ds_write_b32 v51, v166 offset:16896
    v_cvt_pk_f16_f32 v57, v114, v115
    v_cvt_pk_f16_f32 v167, v154, v155
    v_pk_fma_f32 v[116:117], v[102:103], v[92:93], v[116:117] op_sel:[1,1,0] op_sel_hi:[0,1,1] neg_lo:[1,0,0]
    v_pk_fma_f32 v[156:157], v[154:155], v[68:69], v[156:157] op_sel:[1,1,0] op_sel_hi:[0,1,1] neg_lo:[1,0,0]
    ds_write2st64_b32 v52, v162, v164 offset0:33 offset1:0
    v_pk_mul_f32 v[110:111], v[102:103], v[94:95] op_sel_hi:[1,0]
    v_pk_mul_f32 v[112:113], v[102:103], v[96:97] op_sel_hi:[1,0]
    v_cvt_pk_f16_f32 v56, v116, v117
    v_cvt_pk_f16_f32 v163, v156, v157
    v_pk_fma_f32 v[110:111], v[102:103], v[94:95], v[110:111] op_sel:[1,1,0] op_sel_hi:[0,1,1] neg_lo:[1,0,0]
    v_pk_fma_f32 v[112:113], v[102:103], v[96:97], v[112:113] op_sel:[1,1,0] op_sel_hi:[0,1,1] neg_lo:[1,0,0]
    ds_write_b32 v52, v167 offset:16896
    v_pk_mul_f32 v[158:159], v[156:157], v[68:69] op_sel_hi:[1,0]
    v_pk_mul_f32 v[114:115], v[102:103], v[98:99] op_sel_hi:[1,0]
    ds_write2st64_b32 v53, v56, v57 offset0:33 offset1:0
    v_cvt_pk_f16_f32 v165, v110, v111
    v_cvt_pk_f16_f32 v166, v112, v113
    v_pk_fma_f32 v[158:159], v[156:157], v[68:69], v[158:159] op_sel:[1,1,0] op_sel_hi:[0,1,1] neg_lo:[1,0,0]
    v_pk_fma_f32 v[114:115], v[102:103], v[98:99], v[114:115] op_sel:[1,1,0] op_sel_hi:[0,1,1] neg_lo:[1,0,0]
    ds_write_b32 v53, v163 offset:16896
    v_pk_mul_f32 v[160:161], v[158:159], v[68:69] op_sel_hi:[1,0]
    v_pk_mul_f32 v[116:117], v[102:103], v[100:101] op_sel_hi:[1,0]
    v_cvt_pk_f16_f32 v162, v158, v159
    v_cvt_pk_f16_f32 v164, v114, v115
    v_pk_fma_f32 v[160:161], v[158:159], v[68:69], v[160:161] op_sel:[1,1,0] op_sel_hi:[0,1,1] neg_lo:[1,0,0]
    v_pk_fma_f32 v[116:117], v[102:103], v[100:101], v[116:117] op_sel:[1,1,0] op_sel_hi:[0,1,1] neg_lo:[1,0,0]
    ds_write2st64_b32 v54, v166, v165 offset0:33 offset1:0
    v_cvt_pk_f16_f32 v167, v160, v161
    v_cvt_pk_f16_f32 v56, v116, v117
    ds_write_b32 v54, v162 offset:16896
    ds_write_b32 v55, v167 offset:16896
    ds_write2st64_b32 v55, v56, v164 offset0:33 offset1:0
    s_cmp_ge_u32 s3, 4
    s_cbranch_scc1 H_PATH
    s_waitcnt vmcnt(7)
    v_add_u32 v195, s60, v195
    ds_read_b128 v[92:95], v195 offset:0
    ds_read_b128 v[96:99], v253 offset:0
    ds_read_b128 v[100:103], v195 offset:32
    ds_read_b128 v[104:107], v253 offset:32
    s_barrier
    ds_read_b128 v[108:111], v195 offset:64
    ds_read_b128 v[112:115], v253 offset:64
    ds_read_b128 v[116:119], v195 offset:96
    ds_read_b128 v[120:123], v253 offset:96
    ds_read_b128 v[124:127], v195 offset:128
    ds_read_b128 v[128:131], v253 offset:128
    ds_read_b128 v[132:135], v195 offset:160
    ds_read_b128 v[136:139], v253 offset:160
    ds_read_b128 v[140:143], v195 offset:192
    ds_read_b128 v[144:147], v253 offset:192
    s_waitcnt lgkmcnt(12)
    v_mfma_f32_32x32x16_f16 v[168:183], v[92:95], v[96:99], 0
    ds_read_b128 v[148:151], v195 offset:224
    ds_read_b128 v[152:155], v253 offset:224
    v_add_u32 v184, s62, v184
    v_add_u32 v185, s62, v185
    s_waitcnt lgkmcnt(12)
    v_mfma_f32_32x32x16_f16 v[168:183], v[100:103], v[104:107], v[168:183]
    ds_read_b128 v[92:95], v195 offset:256
    ds_read_b128 v[96:99], v253 offset:256
    v_add_u32 v186, s62, v186
    v_add_u32 v187, s62, v187
    s_waitcnt lgkmcnt(12)
    v_mfma_f32_32x32x16_f16 v[168:183], v[108:111], v[112:115], v[168:183]
    ds_read_b128 v[100:103], v195 offset:288
    ds_read_b128 v[104:107], v253 offset:288
    v_add_u32 v188, s62, v188
    v_add_u32 v189, s62, v189
    s_waitcnt lgkmcnt(12)
    v_mfma_f32_32x32x16_f16 v[168:183], v[116:119], v[120:123], v[168:183]
    ds_read_b128 v[108:111], v195 offset:320
    ds_read_b128 v[112:115], v253 offset:320
    v_add_u32 v190, s62, v190
    v_add_u32 v191, s62, v191
    s_waitcnt lgkmcnt(12)
    v_mfma_f32_32x32x16_f16 v[168:183], v[124:127], v[128:131], v[168:183]
    ds_read_b128 v[116:119], v195 offset:352
    ds_read_b128 v[120:123], v253 offset:352
    v_add_u32 v192, s62, v192
    v_add_u32 v193, s62, v193
    s_waitcnt lgkmcnt(12)
    v_mfma_f32_32x32x16_f16 v[168:183], v[132:135], v[136:139], v[168:183]
    ds_read_b128 v[124:127], v195 offset:384
    ds_read_b128 v[128:131], v253 offset:384
    v_add_u32 v194, s62, v194
    v_and_b32 v14, 15, v1
    s_waitcnt lgkmcnt(12)
    v_mfma_f32_32x32x16_f16 v[168:183], v[140:143], v[144:147], v[168:183]
    ds_read_b128 v[132:135], v195 offset:416
    ds_read_b128 v[136:139], v253 offset:416
    v_lshrrev_b32 v15, 4, v1
    s_mul_i32 s46, s51, 4640
    s_waitcnt lgkmcnt(12)
    v_mfma_f32_32x32x16_f16 v[168:183], v[148:151], v[152:155], v[168:183]
    ds_read_b128 v[140:143], v195 offset:448
    ds_read_b128 v[144:147], v253 offset:448
    s_add_u32 s46, s46, 114048
    v_lshlrev_b32 v248, 5, v14
    s_waitcnt lgkmcnt(12)
    v_mfma_f32_32x32x16_f16 v[168:183], v[92:95], v[96:99], v[168:183]
    ds_read_b128 v[148:151], v195 offset:480
    ds_read_b128 v[152:155], v253 offset:480
    v_lshl_add_u32 v248, v15, 4, v248
    v_add_u32 v248, s46, v248
    s_waitcnt lgkmcnt(12)
    v_mfma_f32_32x32x16_f16 v[168:183], v[100:103], v[104:107], v[168:183]
    s_mul_i32 s46, s51, 6144
    s_add_u32 s46, s46, 20480
    v_add_u32 v249, s46, v2
    v_lshlrev_b32 v250, 3, v15
    v_sub_u32 v250, v250, v14
    s_waitcnt lgkmcnt(10)
    v_mfma_f32_32x32x16_f16 v[168:183], v[108:111], v[112:115], v[168:183]
    v_add_u32 v250, 15, v250
    v_and_b32 v34, 1, v250
    v_mul_u32_u24 v34, 1090, v34
    v_lshl_add_u32 v250, v250, 1, v34
    v_add_u32 v250, s62, v250
    s_waitcnt lgkmcnt(8)
    v_mfma_f32_32x32x16_f16 v[168:183], v[116:119], v[120:123], v[168:183]
    v_lshlrev_b32 v251, 3, v14
    v_and_b32 v34, 1, v15
    v_lshl_add_u32 v251, v34, 8, v251
    v_lshrrev_b32 v34, 1, v15
    v_lshl_add_u32 v251, v34, 7, v251
    s_waitcnt lgkmcnt(6)
    v_mfma_f32_32x32x16_f16 v[168:183], v[124:127], v[128:131], v[168:183]
    s_mul_i32 s46, s51, 4128
    v_add_u32 v251, s46, v251
    v_add_u32 v252, 576, v250
    v_add_u32 v250, 64, v250
    s_and_b32 s46, s2, 7
    s_waitcnt lgkmcnt(4)
    v_mfma_f32_32x32x16_f16 v[168:183], v[132:135], v[136:139], v[168:183]
    s_mul_i32 s46, s46, 72
    s_lshr_b32 s53, s2, 3
    s_lshl_b32 s53, s53, 2
    s_add_u32 s46, s46, s53
    s_add_u32 s46, s46, s51
    s_waitcnt lgkmcnt(2)
    v_mfma_f32_32x32x16_f16 v[168:183], v[140:143], v[144:147], v[168:183]
    s_mul_i32 s46, s46, 9216
    s_add_u32 s46, s46, 4096
    v_add_u32 v27, s46, v2
    s_waitcnt lgkmcnt(0)
    v_mfma_f32_32x32x16_f16 v[168:183], v[148:151], v[152:155], v[168:183]
    s_nop 11
    v_cvt_pk_f16_f32 v196, v171, v170
    v_cvt_pk_f16_f32 v197, v169, v168
    v_cvt_pk_f16_f32 v198, v183, v182
    ds_write2_b32 v184, v196, v197 offset0:0 offset1:1
    v_cvt_pk_f16_f32 v199, v181, v180
    v_cvt_pk_f16_f32 v200, v175, v175
    ds_write2_b32 v185, v198, v199 offset0:0 offset1:1
    v_cvt_pk_f16_f32 v201, v174, v173
    v_cvt_pk_f16_f32 v202, v173, v173
    ds_write2_b32 v189, v200, v201 offset0:0 offset1:1
    ds_write_b32 v190, v200
    v_cvt_pk_f16_f32 v203, v172, v176
    ds_write2_b32 v188, v200, v202 offset0:0 offset1:2
    v_cvt_pk_f16_f32 v204, v175, v174
    ds_write2_b32 v189, v202, v203 offset0:2 offset1:3
    v_cvt_pk_f16_f32 v205, v173, v172
    ds_write_b32 v186, v204
    v_cvt_pk_f16_f32 v206, v176, v177
    ds_write_b32 v187, v205
    v_cvt_pk_f16_f32 v207, v178, v179
    ds_write_b16 v191, v206
    ds_write_b16_d16_hi v192, v206
    ds_write_b16 v193, v207
    ds_write_b16_d16_hi v194, v207
    ds_read2_b32 v[44:45], v252 offset0:48 offset1:49
    ds_read2_b32 v[46:47], v252 offset0:50 offset1:51
    ds_read2_b32 v[48:49], v252 offset0:32 offset1:33
    ds_read2_b32 v[50:51], v252 offset0:34 offset1:35
    ds_read2_b32 v[52:53], v252 offset0:16 offset1:17
    ds_read2_b32 v[54:55], v252 offset0:18 offset1:19
    ds_read2_b32 v[56:57], v252 offset0:0 offset1:1
    ds_read2_b32 v[58:59], v252 offset0:2 offset1:3
    ds_read2_b32 v[28:29], v252 offset0:112 offset1:113
    ds_read2_b32 v[30:31], v252 offset0:114 offset1:115
    ds_read2_b32 v[32:33], v252 offset0:96 offset1:97
    ds_read2_b32 v[34:35], v252 offset0:98 offset1:99
    ds_read2_b32 v[36:37], v252 offset0:80 offset1:81
    ds_read2_b32 v[38:39], v252 offset0:82 offset1:83
    ds_read2_b32 v[40:41], v252 offset0:64 offset1:65
    ds_read2_b32 v[42:43], v252 offset0:66 offset1:67
    ds_read2_b32 v[76:77], v250 offset0:48 offset1:49
    ds_read2_b32 v[78:79], v250 offset0:50 offset1:51
    ds_read2_b32 v[80:81], v250 offset0:32 offset1:33
    ds_read2_b32 v[82:83], v250 offset0:34 offset1:35
    ds_read2_b32 v[84:85], v250 offset0:16 offset1:17
    ds_read2_b32 v[86:87], v250 offset0:18 offset1:19
    ds_read2_b32 v[88:89], v250 offset0:0 offset1:1
    ds_read2_b32 v[90:91], v250 offset0:2 offset1:3
    ds_read2_b32 v[60:61], v250 offset0:112 offset1:113
    ds_read2_b32 v[62:63], v250 offset0:114 offset1:115
    ds_read2_b32 v[64:65], v250 offset0:96 offset1:97
    ds_read2_b32 v[66:67], v250 offset0:98 offset1:99
    ds_read2_b32 v[68:69], v250 offset0:80 offset1:81
    ds_read2_b32 v[70:71], v250 offset0:82 offset1:83
    ds_read2_b32 v[72:73], v250 offset0:64 offset1:65
    ds_read2_b32 v[74:75], v250 offset0:66 offset1:67
    s_waitcnt lgkmcnt(15)
    s_barrier
    ds_read_b128 v[92:95], v248 offset:480
    ds_read_b128 v[96:99], v248 offset:416
    ds_read_b128 v[100:103], v248 offset:352
    ds_read_b128 v[104:107], v248 offset:288
    ds_read_b128 v[108:111], v248 offset:992
    ds_read_b128 v[112:115], v248 offset:928
    ds_read_b128 v[116:119], v248 offset:864
    ds_read_b128 v[120:123], v248 offset:800
    s_waitcnt lgkmcnt(15)
    s_waitcnt lgkmcnt(7)
    v_mfma_f32_16x16x32_f16 v[188:191], v[44:47], v[92:95], 0
    s_waitcnt lgkmcnt(6)
    v_mfma_f32_16x16x32_f16 v[188:191], v[48:51], v[96:99], v[188:191]
    s_waitcnt lgkmcnt(5)
    v_mfma_f32_16x16x32_f16 v[188:191], v[52:55], v[100:103], v[188:191]
    s_waitcnt lgkmcnt(4)
    v_mfma_f32_16x16x32_f16 v[188:191], v[56:59], v[104:107], v[188:191]
    v_mfma_f32_16x16x32_f16 v[156:159], v[28:31], v[92:95], 0
    v_mfma_f32_16x16x32_f16 v[156:159], v[32:35], v[96:99], v[156:159]
    v_mfma_f32_16x16x32_f16 v[156:159], v[36:39], v[100:103], v[156:159]
    v_mfma_f32_16x16x32_f16 v[156:159], v[40:43], v[104:107], v[156:159]
    s_waitcnt lgkmcnt(2)
    v_mfma_f32_16x16x32_f16 v[192:195], v[44:47], v[108:111], 0
    ds_read_b128 v[124:127], v248 offset:1504
    v_mfma_f32_16x16x32_f16 v[192:195], v[48:51], v[112:115], v[192:195]
    ds_read_b128 v[128:131], v248 offset:1440
    s_waitcnt lgkmcnt(2)
    v_mfma_f32_16x16x32_f16 v[192:195], v[52:55], v[116:119], v[192:195]
    ds_read_b128 v[132:135], v248 offset:1376
    v_mfma_f32_16x16x32_f16 v[192:195], v[56:59], v[120:123], v[192:195]
    ds_read_b128 v[136:139], v248 offset:1312
    v_mfma_f32_16x16x32_f16 v[192:195], v[76:79], v[92:95], v[192:195]
    v_add_f32_dpp v156, v188, v156 row_ror:8 row_mask:0xf bank_mask:0xc
    v_add_f32_dpp v157, v189, v157 row_ror:8 row_mask:0xf bank_mask:0xc
    v_mfma_f32_16x16x32_f16 v[192:195], v[80:83], v[96:99], v[192:195]
    v_add_f32_dpp v158, v190, v158 row_ror:8 row_mask:0xf bank_mask:0xc
    v_add_f32_dpp v159, v191, v159 row_ror:8 row_mask:0xf bank_mask:0xc
    v_mfma_f32_16x16x32_f16 v[192:195], v[84:87], v[100:103], v[192:195]
    v_cvt_pkrtz_f16_f32 v156, v156, v157
    v_cvt_pkrtz_f16_f32 v157, v158, v159
    v_mfma_f32_16x16x32_f16 v[192:195], v[88:91], v[104:107], v[192:195]
    v_mfma_f32_16x16x32_f16 v[160:163], v[28:31], v[108:111], 0
    ds_write_b64 v251, v[156:157] offset:0
    v_mfma_f32_16x16x32_f16 v[160:163], v[32:35], v[112:115], v[160:163]
    v_mfma_f32_16x16x32_f16 v[160:163], v[36:39], v[116:119], v[160:163]
    v_mfma_f32_16x16x32_f16 v[160:163], v[40:43], v[120:123], v[160:163]
    v_mfma_f32_16x16x32_f16 v[160:163], v[60:63], v[92:95], v[160:163]
    v_mfma_f32_16x16x32_f16 v[160:163], v[64:67], v[96:99], v[160:163]
    s_nop 0
    v_mov_b32_dpp v188, v192 quad_perm:[0,1,2,3] row_mask:0xf bank_mask:0x3
    v_mov_b32_dpp v189, v193 quad_perm:[0,1,2,3] row_mask:0xf bank_mask:0x3
    v_mfma_f32_16x16x32_f16 v[160:163], v[68:71], v[100:103], v[160:163]
    v_mov_b32_dpp v190, v194 quad_perm:[0,1,2,3] row_mask:0xf bank_mask:0x3
    v_mov_b32_dpp v191, v195 quad_perm:[0,1,2,3] row_mask:0xf bank_mask:0x3
    v_mfma_f32_16x16x32_f16 v[160:163], v[72:75], v[104:107], v[160:163]
    s_waitcnt lgkmcnt(3)
    v_mfma_f32_16x16x32_f16 v[196:199], v[44:47], v[124:127], 0
    ds_read_b128 v[92:95], v248 offset:2016
    v_mfma_f32_16x16x32_f16 v[196:199], v[48:51], v[128:131], v[196:199]
    ds_read_b128 v[96:99], v248 offset:1952
    s_waitcnt lgkmcnt(3)
    v_mfma_f32_16x16x32_f16 v[196:199], v[52:55], v[132:135], v[196:199]
    ds_read_b128 v[100:103], v248 offset:1888
    v_mfma_f32_16x16x32_f16 v[196:199], v[56:59], v[136:139], v[196:199]
    ds_read_b128 v[104:107], v248 offset:1824
    v_mfma_f32_16x16x32_f16 v[196:199], v[76:79], v[108:111], v[196:199]
    v_add_f32_dpp v160, v188, v160 row_ror:8 row_mask:0xf bank_mask:0xf
    v_add_f32_dpp v161, v189, v161 row_ror:8 row_mask:0xf bank_mask:0xf
    v_mfma_f32_16x16x32_f16 v[196:199], v[80:83], v[112:115], v[196:199]
    v_add_f32_dpp v162, v190, v162 row_ror:8 row_mask:0xf bank_mask:0xf
    v_add_f32_dpp v163, v191, v163 row_ror:8 row_mask:0xf bank_mask:0xf
    v_mfma_f32_16x16x32_f16 v[196:199], v[84:87], v[116:119], v[196:199]
    v_cvt_pkrtz_f16_f32 v160, v160, v161
    v_cvt_pkrtz_f16_f32 v161, v162, v163
    v_mfma_f32_16x16x32_f16 v[196:199], v[88:91], v[120:123], v[196:199]
    v_mfma_f32_16x16x32_f16 v[164:167], v[28:31], v[124:127], 0
    ds_write_b64 v251, v[160:161] offset:512
    v_mfma_f32_16x16x32_f16 v[164:167], v[32:35], v[128:131], v[164:167]
    v_mfma_f32_16x16x32_f16 v[164:167], v[36:39], v[132:135], v[164:167]
    v_mfma_f32_16x16x32_f16 v[164:167], v[40:43], v[136:139], v[164:167]
    v_mfma_f32_16x16x32_f16 v[164:167], v[60:63], v[108:111], v[164:167]
    v_mfma_f32_16x16x32_f16 v[164:167], v[64:67], v[112:115], v[164:167]
    s_nop 0
    v_mov_b32_dpp v192, v196 quad_perm:[0,1,2,3] row_mask:0xf bank_mask:0x3
    v_mov_b32_dpp v193, v197 quad_perm:[0,1,2,3] row_mask:0xf bank_mask:0x3
    s_waitcnt lgkmcnt(0)
    s_barrier
    ds_read_b128 v[148:151], v249 offset:0
    ds_read_b128 v[152:155], v249 offset:1024
    v_mfma_f32_16x16x32_f16 v[164:167], v[68:71], v[116:119], v[164:167]
    v_mov_b32_dpp v194, v198 quad_perm:[0,1,2,3] row_mask:0xf bank_mask:0x3
    v_mov_b32_dpp v195, v199 quad_perm:[0,1,2,3] row_mask:0xf bank_mask:0x3
    v_mfma_f32_16x16x32_f16 v[164:167], v[72:75], v[120:123], v[164:167]
    v_mfma_f32_16x16x32_f16 v[188:191], v[44:47], v[92:95], 0
    ds_read_b128 v[108:111], v248 offset:2528
    v_mfma_f32_16x16x32_f16 v[188:191], v[48:51], v[96:99], v[188:191]
    ds_read_b128 v[112:115], v248 offset:2464
    v_mfma_f32_16x16x32_f16 v[188:191], v[52:55], v[100:103], v[188:191]
    ds_read_b128 v[116:119], v248 offset:2400
    v_mfma_f32_16x16x32_f16 v[188:191], v[56:59], v[104:107], v[188:191]
    ds_read_b128 v[120:123], v248 offset:2336
    v_mfma_f32_16x16x32_f16 v[188:191], v[76:79], v[124:127], v[188:191]
    v_add_f32_dpp v164, v192, v164 row_ror:8 row_mask:0xf bank_mask:0xf
    v_add_f32_dpp v165, v193, v165 row_ror:8 row_mask:0xf bank_mask:0xf
    v_mfma_f32_16x16x32_f16 v[188:191], v[80:83], v[128:131], v[188:191]
    v_add_f32_dpp v166, v194, v166 row_ror:8 row_mask:0xf bank_mask:0xf
    v_add_f32_dpp v167, v195, v167 row_ror:8 row_mask:0xf bank_mask:0xf
    v_mfma_f32_16x16x32_f16 v[188:191], v[84:87], v[132:135], v[188:191]
    s_waitcnt lgkmcnt(5)
    v_add_f32 v164, v164, v148
    v_add_f32 v165, v165, v149
    v_mfma_f32_16x16x32_f16 v[188:191], v[88:91], v[136:139], v[188:191]
    v_add_f32 v166, v166, v150
    v_add_f32 v167, v167, v151
    s_waitcnt lgkmcnt(4)
    v_mfma_f32_16x16x32_f16 v[152:155], v[28:31], v[92:95], v[152:155]
    v_cvt_pkrtz_f16_f32 v164, v164, v165
    v_cvt_pkrtz_f16_f32 v165, v166, v167
    v_mfma_f32_16x16x32_f16 v[152:155], v[32:35], v[96:99], v[152:155]
    v_mfma_f32_16x16x32_f16 v[152:155], v[36:39], v[100:103], v[152:155]
    ds_write_b64 v251, v[164:165] offset:1024
    v_mfma_f32_16x16x32_f16 v[152:155], v[40:43], v[104:107], v[152:155]
    v_mfma_f32_16x16x32_f16 v[152:155], v[60:63], v[124:127], v[152:155]
    v_mfma_f32_16x16x32_f16 v[152:155], v[64:67], v[128:131], v[152:155]
    v_mov_b32_dpp v196, v188 quad_perm:[0,1,2,3] row_mask:0xf bank_mask:0x3
    v_mov_b32_dpp v197, v189 quad_perm:[0,1,2,3] row_mask:0xf bank_mask:0x3
    v_mfma_f32_16x16x32_f16 v[152:155], v[68:71], v[132:135], v[152:155]
    v_mov_b32_dpp v198, v190 quad_perm:[0,1,2,3] row_mask:0xf bank_mask:0x3
    v_mov_b32_dpp v199, v191 quad_perm:[0,1,2,3] row_mask:0xf bank_mask:0x3
    v_mfma_f32_16x16x32_f16 v[152:155], v[72:75], v[136:139], v[152:155]
    s_waitcnt lgkmcnt(3)
    v_mfma_f32_16x16x32_f16 v[192:195], v[44:47], v[108:111], 0
    ds_read_b128 v[124:127], v248 offset:3040
    v_mfma_f32_16x16x32_f16 v[192:195], v[48:51], v[112:115], v[192:195]
    ds_read_b128 v[128:131], v248 offset:2976
    s_waitcnt lgkmcnt(3)
    v_mfma_f32_16x16x32_f16 v[192:195], v[52:55], v[116:119], v[192:195]
    ds_read_b128 v[132:135], v248 offset:2912
    v_mfma_f32_16x16x32_f16 v[192:195], v[56:59], v[120:123], v[192:195]
    ds_read_b128 v[136:139], v248 offset:2848
    v_mfma_f32_16x16x32_f16 v[192:195], v[76:79], v[92:95], v[192:195]
    v_add_f32_dpp v152, v196, v152 row_ror:8 row_mask:0xf bank_mask:0xf
    v_add_f32_dpp v153, v197, v153 row_ror:8 row_mask:0xf bank_mask:0xf
    v_mfma_f32_16x16x32_f16 v[192:195], v[80:83], v[96:99], v[192:195]
    v_add_f32_dpp v154, v198, v154 row_ror:8 row_mask:0xf bank_mask:0xf
    v_add_f32_dpp v155, v199, v155 row_ror:8 row_mask:0xf bank_mask:0xf
    v_mfma_f32_16x16x32_f16 v[192:195], v[84:87], v[100:103], v[192:195]
    v_cvt_pkrtz_f16_f32 v152, v152, v153
    v_cvt_pkrtz_f16_f32 v153, v154, v155
    v_mfma_f32_16x16x32_f16 v[192:195], v[88:91], v[104:107], v[192:195]
    v_mfma_f32_16x16x32_f16 v[172:175], v[28:31], v[108:111], 0
    ds_write_b64 v251, v[152:153] offset:1536
    v_mfma_f32_16x16x32_f16 v[172:175], v[32:35], v[112:115], v[172:175]
    v_mfma_f32_16x16x32_f16 v[172:175], v[36:39], v[116:119], v[172:175]
    v_mfma_f32_16x16x32_f16 v[172:175], v[40:43], v[120:123], v[172:175]
    v_mfma_f32_16x16x32_f16 v[172:175], v[60:63], v[92:95], v[172:175]
    v_mfma_f32_16x16x32_f16 v[172:175], v[64:67], v[96:99], v[172:175]
    s_nop 0
    v_mov_b32_dpp v188, v192 quad_perm:[0,1,2,3] row_mask:0xf bank_mask:0x3
    v_mov_b32_dpp v189, v193 quad_perm:[0,1,2,3] row_mask:0xf bank_mask:0x3
    s_waitcnt lgkmcnt(0)
    s_barrier
    ds_read_b128 v[140:143], v249 offset:2048
    ds_read_b128 v[144:147], v249 offset:3072
    v_mfma_f32_16x16x32_f16 v[172:175], v[68:71], v[100:103], v[172:175]
    v_mov_b32_dpp v190, v194 quad_perm:[0,1,2,3] row_mask:0xf bank_mask:0x3
    v_mov_b32_dpp v191, v195 quad_perm:[0,1,2,3] row_mask:0xf bank_mask:0x3
    v_mfma_f32_16x16x32_f16 v[172:175], v[72:75], v[104:107], v[172:175]
    v_mfma_f32_16x16x32_f16 v[196:199], v[44:47], v[124:127], 0
    ds_read_b128 v[92:95], v248 offset:3552
    v_mfma_f32_16x16x32_f16 v[196:199], v[48:51], v[128:131], v[196:199]
    ds_read_b128 v[96:99], v248 offset:3488
    v_mfma_f32_16x16x32_f16 v[196:199], v[52:55], v[132:135], v[196:199]
    ds_read_b128 v[100:103], v248 offset:3424
    v_mfma_f32_16x16x32_f16 v[196:199], v[56:59], v[136:139], v[196:199]
    ds_read_b128 v[104:107], v248 offset:3360
    v_mfma_f32_16x16x32_f16 v[196:199], v[76:79], v[108:111], v[196:199]
    v_add_f32_dpp v172, v188, v172 row_ror:8 row_mask:0xf bank_mask:0xf
    v_add_f32_dpp v173, v189, v173 row_ror:8 row_mask:0xf bank_mask:0xf
    v_mfma_f32_16x16x32_f16 v[196:199], v[80:83], v[112:115], v[196:199]
    v_add_f32_dpp v174, v190, v174 row_ror:8 row_mask:0xf bank_mask:0xf
    v_add_f32_dpp v175, v191, v175 row_ror:8 row_mask:0xf bank_mask:0xf
    v_mfma_f32_16x16x32_f16 v[196:199], v[84:87], v[116:119], v[196:199]
    s_waitcnt lgkmcnt(5)
    v_add_f32 v172, v172, v140
    v_add_f32 v173, v173, v141
    v_mfma_f32_16x16x32_f16 v[196:199], v[88:91], v[120:123], v[196:199]
    v_add_f32 v174, v174, v142
    v_add_f32 v175, v175, v143
    s_waitcnt lgkmcnt(4)
    v_mfma_f32_16x16x32_f16 v[144:147], v[28:31], v[124:127], v[144:147]
    v_cvt_pkrtz_f16_f32 v172, v172, v173
    v_cvt_pkrtz_f16_f32 v173, v174, v175
    v_mfma_f32_16x16x32_f16 v[144:147], v[32:35], v[128:131], v[144:147]
    v_mfma_f32_16x16x32_f16 v[144:147], v[36:39], v[132:135], v[144:147]
    ds_write_b64 v251, v[172:173] offset:2048
    v_mfma_f32_16x16x32_f16 v[144:147], v[40:43], v[136:139], v[144:147]
    v_mfma_f32_16x16x32_f16 v[144:147], v[60:63], v[108:111], v[144:147]
    v_mfma_f32_16x16x32_f16 v[144:147], v[64:67], v[112:115], v[144:147]
    v_mov_b32_dpp v192, v196 quad_perm:[0,1,2,3] row_mask:0xf bank_mask:0x3
    v_mov_b32_dpp v193, v197 quad_perm:[0,1,2,3] row_mask:0xf bank_mask:0x3
    v_mfma_f32_16x16x32_f16 v[144:147], v[68:71], v[116:119], v[144:147]
    v_mov_b32_dpp v194, v198 quad_perm:[0,1,2,3] row_mask:0xf bank_mask:0x3
    v_mov_b32_dpp v195, v199 quad_perm:[0,1,2,3] row_mask:0xf bank_mask:0x3
    v_mfma_f32_16x16x32_f16 v[144:147], v[72:75], v[120:123], v[144:147]
    s_waitcnt lgkmcnt(3)
    v_mfma_f32_16x16x32_f16 v[188:191], v[44:47], v[92:95], 0
    ds_read_b128 v[108:111], v248 offset:4064
    v_mfma_f32_16x16x32_f16 v[188:191], v[48:51], v[96:99], v[188:191]
    ds_read_b128 v[112:115], v248 offset:4000
    s_waitcnt lgkmcnt(3)
    v_mfma_f32_16x16x32_f16 v[188:191], v[52:55], v[100:103], v[188:191]
    ds_read_b128 v[116:119], v248 offset:3936
    v_mfma_f32_16x16x32_f16 v[188:191], v[56:59], v[104:107], v[188:191]
    ds_read_b128 v[120:123], v248 offset:3872
    v_mfma_f32_16x16x32_f16 v[188:191], v[76:79], v[124:127], v[188:191]
    v_add_f32_dpp v144, v192, v144 row_ror:8 row_mask:0xf bank_mask:0xf
    v_add_f32_dpp v145, v193, v145 row_ror:8 row_mask:0xf bank_mask:0xf
    v_mfma_f32_16x16x32_f16 v[188:191], v[80:83], v[128:131], v[188:191]
    v_add_f32_dpp v146, v194, v146 row_ror:8 row_mask:0xf bank_mask:0xf
    v_add_f32_dpp v147, v195, v147 row_ror:8 row_mask:0xf bank_mask:0xf
    v_mfma_f32_16x16x32_f16 v[188:191], v[84:87], v[132:135], v[188:191]
    v_cvt_pkrtz_f16_f32 v144, v144, v145
    v_cvt_pkrtz_f16_f32 v145, v146, v147
    v_mfma_f32_16x16x32_f16 v[188:191], v[88:91], v[136:139], v[188:191]
    v_mfma_f32_16x16x32_f16 v[180:183], v[28:31], v[92:95], 0
    ds_write_b64 v251, v[144:145] offset:2560
    v_mfma_f32_16x16x32_f16 v[180:183], v[32:35], v[96:99], v[180:183]
    v_mfma_f32_16x16x32_f16 v[180:183], v[36:39], v[100:103], v[180:183]
    v_mfma_f32_16x16x32_f16 v[180:183], v[40:43], v[104:107], v[180:183]
    v_mfma_f32_16x16x32_f16 v[180:183], v[60:63], v[124:127], v[180:183]
    s_waitcnt lgkmcnt(0)
    s_barrier
    ds_read_b128 v[148:151], v249 offset:4096
    ds_read_b128 v[152:155], v249 offset:5120
    v_mfma_f32_16x16x32_f16 v[180:183], v[64:67], v[128:131], v[180:183]
    v_mov_b32_dpp v196, v188 quad_perm:[0,1,2,3] row_mask:0xf bank_mask:0x3
    v_mov_b32_dpp v197, v189 quad_perm:[0,1,2,3] row_mask:0xf bank_mask:0x3
    v_mfma_f32_16x16x32_f16 v[180:183], v[68:71], v[132:135], v[180:183]
    v_mov_b32_dpp v198, v190 quad_perm:[0,1,2,3] row_mask:0xf bank_mask:0x3
    v_mov_b32_dpp v199, v191 quad_perm:[0,1,2,3] row_mask:0xf bank_mask:0x3
    v_mfma_f32_16x16x32_f16 v[180:183], v[72:75], v[136:139], v[180:183]
    v_mfma_f32_16x16x32_f16 v[192:195], v[44:47], v[108:111], 0
    v_mfma_f32_16x16x32_f16 v[192:195], v[48:51], v[112:115], v[192:195]
    v_mfma_f32_16x16x32_f16 v[192:195], v[52:55], v[116:119], v[192:195]
    v_mfma_f32_16x16x32_f16 v[192:195], v[56:59], v[120:123], v[192:195]
    v_mfma_f32_16x16x32_f16 v[192:195], v[76:79], v[92:95], v[192:195]
    v_mfma_f32_16x16x32_f16 v[192:195], v[80:83], v[96:99], v[192:195]
    s_nop 1
    v_add_f32_dpp v180, v196, v180 row_ror:8 row_mask:0xf bank_mask:0xf
    v_add_f32_dpp v181, v197, v181 row_ror:8 row_mask:0xf bank_mask:0xf
    v_mfma_f32_16x16x32_f16 v[192:195], v[84:87], v[100:103], v[192:195]
    v_add_f32_dpp v182, v198, v182 row_ror:8 row_mask:0xf bank_mask:0xf
    v_add_f32_dpp v183, v199, v183 row_ror:8 row_mask:0xf bank_mask:0xf
    v_mfma_f32_16x16x32_f16 v[192:195], v[88:91], v[104:107], v[192:195]
    s_waitcnt lgkmcnt(1)
    v_add_f32 v180, v180, v148
    v_add_f32 v181, v181, v149
    s_waitcnt lgkmcnt(0)
    v_mfma_f32_16x16x32_f16 v[152:155], v[28:31], v[108:111], v[152:155]
    v_add_f32 v182, v182, v150
    v_add_f32 v183, v183, v151
    v_mfma_f32_16x16x32_f16 v[152:155], v[32:35], v[112:115], v[152:155]
    v_cvt_pkrtz_f16_f32 v180, v180, v181
    v_cvt_pkrtz_f16_f32 v181, v182, v183
    v_mfma_f32_16x16x32_f16 v[152:155], v[36:39], v[116:119], v[152:155]
    v_mfma_f32_16x16x32_f16 v[152:155], v[40:43], v[120:123], v[152:155]
    ds_write_b64 v251, v[180:181] offset:3072
    s_waitcnt lgkmcnt(0)
    s_barrier
    v_mfma_f32_16x16x32_f16 v[152:155], v[60:63], v[92:95], v[152:155]
    v_mfma_f32_16x16x32_f16 v[152:155], v[64:67], v[96:99], v[152:155]
    v_mov_b32_dpp v188, v192 quad_perm:[0,1,2,3] row_mask:0xf bank_mask:0x3
    v_mov_b32_dpp v189, v193 quad_perm:[0,1,2,3] row_mask:0xf bank_mask:0x3
    v_mfma_f32_16x16x32_f16 v[152:155], v[68:71], v[100:103], v[152:155]
    v_mov_b32_dpp v190, v194 quad_perm:[0,1,2,3] row_mask:0xf bank_mask:0x3
    v_mov_b32_dpp v191, v195 quad_perm:[0,1,2,3] row_mask:0xf bank_mask:0x3
    v_mfma_f32_16x16x32_f16 v[152:155], v[72:75], v[104:107], v[152:155]
    s_nop 7
    v_add_f32_dpp v152, v188, v152 row_ror:8 row_mask:0xf bank_mask:0xf
    v_add_f32_dpp v153, v189, v153 row_ror:8 row_mask:0xf bank_mask:0xf
    v_add_f32_dpp v154, v190, v154 row_ror:8 row_mask:0xf bank_mask:0xf
    v_add_f32_dpp v155, v191, v155 row_ror:8 row_mask:0xf bank_mask:0xf
    v_cvt_pkrtz_f16_f32 v152, v152, v153
    v_cvt_pkrtz_f16_f32 v153, v154, v155
    ds_write_b64 v251, v[152:153] offset:3584
    s_waitcnt lgkmcnt(0)
    s_barrier
    s_waitcnt vmcnt(0)
    s_branch RPREP
H_PATH:
    s_waitcnt lgkmcnt(0)
    s_barrier
    buffer_load_dwordx4 v[200:203], v2, s[32:35], s48 offen offset:0 sc1
    buffer_load_dwordx4 v[204:207], v2, s[32:35], s48 offen offset:1024 sc1
    buffer_load_dwordx4 v[208:211], v2, s[32:35], s48 offen offset:2048 sc1
    buffer_load_dwordx4 v[212:215], v2, s[32:35], s48 offen offset:3072 sc1
    v_and_b32 v14, 15, v1
    v_lshrrev_b32 v15, 4, v1
    s_mul_i32 s46, s51, 4640
    s_add_u32 s46, s46, 114048
    v_lshlrev_b32 v248, 5, v14
    v_lshl_add_u32 v248, v15, 4, v248
    v_add_u32 v248, s46, v248
    s_mul_i32 s46, s51, 6144
    s_add_u32 s46, s46, 20480
    v_add_u32 v249, s46, v2
    v_lshlrev_b32 v250, 3, v15
    v_sub_u32 v250, v250, v14
    v_add_u32 v250, 15, v250
    v_and_b32 v34, 1, v250
    v_mul_u32_u24 v34, 1090, v34
    v_lshl_add_u32 v250, v250, 1, v34
    v_add_u32 v250, s62, v250
    v_lshlrev_b32 v251, 2, v15
    v_sub_u32 v251, v251, v14
    v_lshlrev_b32 v251, 2, v251
    s_add_u32 s46, s62, 2252
    v_add_u32 v251, s46, v251
    v_bfe_u32 v34, v1, 2, 2
    v_mul_u32_u24 v34, 4128, v34
    v_and_b32 v35, 1, v1
    v_lshl_add_u32 v34, v35, 7, v34
    v_lshl_add_u32 v34, v15, 4, v34
    v_and_b32 v35, 2, v1
    v_lshl_add_u32 v34, v35, 2, v34
    s_and_b32 s46, s3, 1
    s_lshl_b32 s46, s46, 6
    v_add_u32 v252, s46, v34
    v_lshrrev_b32 v34, 3, v1
    v_mul_u32_u24 v34, 18432, v34
    v_and_b32 v35, 7, v1
    v_lshl_add_u32 v253, v35, 4, v34
    s_and_b32 s46, s3, 1
    s_mul_i32 s46, s46, 147456
    s_lshl_b32 s63, s2, 7
    s_add_u32 s63, s63, s46
    s_add_u32 s63, s63, 4194304
    v_and_b32 v34, 3, v1
    v_mul_u32_u24 v34, 4640, v34
    v_lshrrev_b32 v35, 2, v1
    v_lshl_add_u32 v34, v35, 4, v34
    s_lshl_b32 s46, s51, 10
    s_add_u32 s46, s46, 114560
    v_add_u32 v254, s46, v34
    s_cmp_lt_u32 s49, 128
    s_cbranch_scc1 H_UI
    v_subrev_u32 v14, 9472, v25
    v_subrev_u32 v15, 9472, v26
    ds_read_b128 v[120:123], v14
    ds_read_b128 v[124:127], v14 offset:512
    ds_read_b32 v128, v15 offset:1024
    s_mov_b32 s46, 10485760
    s_waitcnt lgkmcnt(0)
    v_add_u32 v120, v11, v120
    v_add_u32 v121, v11, v121
    v_add_u32 v122, v11, v122
    v_add_u32 v123, v11, v123
    v_add_u32 v124, v11, v124
    v_add_u32 v125, v11, v125
    v_add_u32 v126, v11, v126
    v_add_u32 v127, v11, v127
    v_add_u32 v128, v11, v128
    v_and_or_b32 v120, v120, v9, v10
    v_and_or_b32 v121, v121, v9, v10
    v_and_or_b32 v122, v122, v9, v10
    v_and_or_b32 v123, v123, v9, v10
    v_and_or_b32 v124, v124, v9, v10
    v_and_or_b32 v125, v125, v9, v10
    v_and_or_b32 v126, v126, v9, v10
    v_and_or_b32 v127, v127, v9, v10
    v_and_or_b32 v128, v128, v9, v10
    buffer_store_dwordx4 v[120:123], v4, s[32:35], s46 offen sc1
    buffer_store_dwordx4 v[124:127], v4, s[32:35], s46 offen offset:512 sc1
    buffer_store_dword v128, v5, s[32:35], s46 offen offset:1024 sc1
H_UI:
    s_mov_b32 s47, 0
PL2:
    s_waitcnt vmcnt(0)
    v_xor_b32 v200, v10, v200
    v_xor_b32 v201, v10, v201
    v_xor_b32 v202, v10, v202
    v_xor_b32 v203, v10, v203
    v_xor_b32 v204, v10, v204
    v_xor_b32 v205, v10, v205
    v_xor_b32 v206, v10, v206
    v_xor_b32 v207, v10, v207
    v_xor_b32 v208, v10, v208
    v_xor_b32 v209, v10, v209
    v_xor_b32 v210, v10, v210
    v_xor_b32 v211, v10, v211
    v_xor_b32 v212, v10, v212
    v_xor_b32 v213, v10, v213
    v_xor_b32 v214, v10, v214
    v_xor_b32 v215, v10, v215
    v_or3_b32 v14, v200, v201, v202
    v_or3_b32 v14, v14, v203, v204
    v_or3_b32 v14, v14, v205, v206
    v_or3_b32 v14, v14, v207, v208
    v_or3_b32 v14, v14, v209, v210
    v_or3_b32 v14, v14, v211, v212
    v_or3_b32 v14, v14, v213, v214
    v_or_b32 v14, v14, v215
    v_and_b32 v14, 0x70007, v14
    v_cmp_ne_u32 vcc, 0, v14
    s_cbranch_vccz PD3
    s_add_u32 s47, s47, 1
    s_cmp_ge_u32 s47, 65536
    s_cbranch_scc1 PD3
    s_sleep 2
    buffer_load_dwordx4 v[200:203], v2, s[32:35], s48 offen offset:0 sc1
    buffer_load_dwordx4 v[204:207], v2, s[32:35], s48 offen offset:1024 sc1
    buffer_load_dwordx4 v[208:211], v2, s[32:35], s48 offen offset:2048 sc1
    buffer_load_dwordx4 v[212:215], v2, s[32:35], s48 offen offset:3072 sc1
    s_branch PL2
PD3:
    ds_write_b128 v254, v[200:203] offset:0
    ds_write_b128 v254, v[204:207] offset:256
    ds_write_b128 v254, v[208:211] offset:512
    ds_write_b128 v254, v[212:215] offset:768
    v_mov_b32 v15, s62
    s_setprio 1
    s_waitcnt lgkmcnt(0)
    s_barrier
    ds_read_b128 v[28:31], v248 offset:480
    ds_read_b128 v[32:35], v248 offset:464
    ds_read_b128 v[36:39], v248 offset:992
    ds_read_b128 v[40:43], v248 offset:976
    s_waitcnt lgkmcnt(3)
    v_mfma_f32_16x16x32_f16 v[76:79], v[28:31], v[172:175], 0
    v_mfma_f32_16x16x32_f16 v[80:83], v[28:31], v[168:171], 0
    v_mfma_f32_16x16x32_f16 v[88:91], v[28:31], v[176:179], 0
    s_waitcnt lgkmcnt(2)
    v_mfma_f32_16x16x32_f16 v[84:87], v[32:35], v[180:183], 0
    ds_read_b128 v[44:47], v248 offset:1504
    ds_read_b128 v[48:51], v248 offset:1488
    v_mfma_f32_16x16x32_f16 v[92:95], v[28:31], v[184:187], 0
    s_nop 1
    v_cvt_pk_f16_f32 v100, v76, v80
    v_cvt_pk_f16_f32 v101, v77, v81
    v_mfma_f32_16x16x32_f16 v[96:99], v[32:35], v[188:191], 0
    v_cvt_pk_f16_f32 v102, v78, v82
    v_cvt_pk_f16_f32 v103, v79, v83
    s_waitcnt lgkmcnt(3)
    v_mfma_f32_16x16x32_f16 v[76:79], v[36:39], v[172:175], 0
    v_cvt_pk_f16_f32 v104, v84, v88
    v_cvt_pk_f16_f32 v105, v85, v89
    v_mfma_f32_16x16x32_f16 v[80:83], v[36:39], v[168:171], 0
    v_cvt_pk_f16_f32 v106, v86, v90
    v_cvt_pk_f16_f32 v107, v87, v91
    v_mfma_f32_16x16x32_f16 v[88:91], v[36:39], v[176:179], 0
    v_cvt_pk_f16_f32 v148, v92, v96
    v_cvt_pk_f16_f32 v149, v93, v97
    s_waitcnt lgkmcnt(2)
    v_mfma_f32_16x16x32_f16 v[84:87], v[40:43], v[180:183], 0
    v_cvt_pk_f16_f32 v150, v94, v98
    v_cvt_pk_f16_f32 v151, v95, v99
    ds_read_b128 v[52:55], v248 offset:2016
    ds_read_b128 v[56:59], v248 offset:2000
    v_mfma_f32_16x16x32_f16 v[92:95], v[36:39], v[184:187], 0
    v_cvt_pk_f16_f32 v108, v76, v80
    v_cvt_pk_f16_f32 v109, v77, v81
    v_mfma_f32_16x16x32_f16 v[96:99], v[40:43], v[188:191], 0
    v_cvt_pk_f16_f32 v110, v78, v82
    v_cvt_pk_f16_f32 v111, v79, v83
    s_waitcnt lgkmcnt(3)
    v_mfma_f32_16x16x32_f16 v[76:79], v[44:47], v[172:175], 0
    v_cvt_pk_f16_f32 v112, v84, v88
    v_cvt_pk_f16_f32 v113, v85, v89
    v_mfma_f32_16x16x32_f16 v[80:83], v[44:47], v[168:171], 0
    v_cvt_pk_f16_f32 v114, v86, v90
    v_cvt_pk_f16_f32 v115, v87, v91
    ds_read_b128 v[60:63], v248 offset:2528
    ds_read_b128 v[64:67], v248 offset:2512
    v_mfma_f32_16x16x32_f16 v[88:91], v[44:47], v[176:179], 0
    v_cvt_pk_f16_f32 v152, v92, v96
    v_cvt_pk_f16_f32 v153, v93, v97
    s_waitcnt lgkmcnt(4)
    v_mfma_f32_16x16x32_f16 v[84:87], v[48:51], v[180:183], 0
    v_cvt_pk_f16_f32 v154, v94, v98
    v_cvt_pk_f16_f32 v155, v95, v99
    v_mfma_f32_16x16x32_f16 v[92:95], v[44:47], v[184:187], 0
    v_cvt_pk_f16_f32 v116, v76, v80
    v_cvt_pk_f16_f32 v117, v77, v81
    v_mfma_f32_16x16x32_f16 v[96:99], v[48:51], v[188:191], 0
    v_cvt_pk_f16_f32 v118, v78, v82
    v_cvt_pk_f16_f32 v119, v79, v83
    ds_read_b128 v[68:71], v248 offset:3040
    ds_read_b128 v[72:75], v248 offset:3024
    s_waitcnt lgkmcnt(5)
    v_mfma_f32_16x16x32_f16 v[76:79], v[52:55], v[172:175], 0
    v_cvt_pk_f16_f32 v120, v84, v88
    v_cvt_pk_f16_f32 v121, v85, v89
    v_mfma_f32_16x16x32_f16 v[80:83], v[52:55], v[168:171], 0
    v_cvt_pk_f16_f32 v122, v86, v90
    v_cvt_pk_f16_f32 v123, v87, v91
    v_mfma_f32_16x16x32_f16 v[88:91], v[52:55], v[176:179], 0
    v_cvt_pk_f16_f32 v156, v92, v96
    v_cvt_pk_f16_f32 v157, v93, v97
    s_waitcnt lgkmcnt(4)
    v_mfma_f32_16x16x32_f16 v[84:87], v[56:59], v[180:183], 0
    v_cvt_pk_f16_f32 v158, v94, v98
    v_cvt_pk_f16_f32 v159, v95, v99
    ds_read2_b32 v[196:197], v250 offset0:0 offset1:1
    ds_read2_b32 v[198:199], v250 offset0:2 offset1:3
    v_mfma_f32_16x16x32_f16 v[92:95], v[52:55], v[184:187], 0
    v_cvt_pk_f16_f32 v124, v76, v80
    v_cvt_pk_f16_f32 v125, v77, v81
    v_mfma_f32_16x16x32_f16 v[96:99], v[56:59], v[188:191], 0
    v_cvt_pk_f16_f32 v126, v78, v82
    v_cvt_pk_f16_f32 v127, v79, v83
    ds_read2_b32 v[200:201], v251 offset0:32 offset1:33
    ds_read2_b32 v[202:203], v251 offset0:34 offset1:35
    s_waitcnt lgkmcnt(7)
    v_mfma_f32_16x16x32_f16 v[76:79], v[60:63], v[172:175], 0
    v_cvt_pk_f16_f32 v128, v84, v88
    v_cvt_pk_f16_f32 v129, v85, v89
    v_mfma_f32_16x16x32_f16 v[80:83], v[60:63], v[168:171], 0
    v_cvt_pk_f16_f32 v130, v86, v90
    v_cvt_pk_f16_f32 v131, v87, v91
    ds_read2_b32 v[204:205], v251 offset0:80 offset1:81
    ds_read2_b32 v[206:207], v251 offset0:82 offset1:83
    v_mfma_f32_16x16x32_f16 v[88:91], v[60:63], v[176:179], 0
    v_cvt_pk_f16_f32 v160, v92, v96
    v_cvt_pk_f16_f32 v161, v93, v97
    s_waitcnt lgkmcnt(8)
    v_mfma_f32_16x16x32_f16 v[84:87], v[64:67], v[180:183], 0
    v_cvt_pk_f16_f32 v162, v94, v98
    v_cvt_pk_f16_f32 v163, v95, v99
    ds_read2_b32 v[208:209], v251 offset0:16 offset1:17
    ds_read2_b32 v[210:211], v251 offset0:18 offset1:19
    s_waitcnt lgkmcnt(9)
    v_mfma_f32_16x16x32_f16 v[92:95], v[68:71], v[172:175], 0
    v_cvt_pk_f16_f32 v132, v76, v80
    v_cvt_pk_f16_f32 v133, v77, v81
    v_mfma_f32_16x16x32_f16 v[96:99], v[68:71], v[168:171], 0
    v_cvt_pk_f16_f32 v134, v78, v82
    v_cvt_pk_f16_f32 v135, v79, v83
    ds_read2_b32 v[212:213], v251 offset0:64 offset1:65
    ds_read2_b32 v[214:215], v251 offset0:66 offset1:67
    v_mfma_f32_16x16x32_f16 v[80:83], v[68:71], v[176:179], 0
    v_cvt_pk_f16_f32 v136, v84, v88
    v_cvt_pk_f16_f32 v137, v85, v89
    s_waitcnt lgkmcnt(10)
    v_mfma_f32_16x16x32_f16 v[76:79], v[72:75], v[180:183], 0
    v_cvt_pk_f16_f32 v138, v86, v90
    v_cvt_pk_f16_f32 v139, v87, v91
    ds_read_u16 v15, v15 offset:2448
    s_waitcnt lgkmcnt(9)
    v_mfma_f32_16x16x32_f16 v[164:167], v[196:199], v[28:31], 0
    v_cvt_pk_f16_f32 v140, v92, v96
    v_cvt_pk_f16_f32 v141, v93, v97
    s_waitcnt lgkmcnt(7)
    v_mfma_f32_16x16x32_f16 v[164:167], v[100:103], v[200:203], v[164:167]
    v_cvt_pk_f16_f32 v142, v94, v98
    v_cvt_pk_f16_f32 v143, v95, v99
    s_waitcnt lgkmcnt(5)
    v_mfma_f32_16x16x32_f16 v[164:167], v[104:107], v[204:207], v[164:167]
    v_cvt_pk_f16_f32 v144, v76, v80
    v_cvt_pk_f16_f32 v145, v77, v81
    v_mfma_f32_16x16x32_f16 v[240:243], v[196:199], v[36:39], 0
    v_cvt_pk_f16_f32 v146, v78, v82
    v_cvt_pk_f16_f32 v147, v79, v83
    v_mfma_f32_16x16x32_f16 v[240:243], v[108:111], v[200:203], v[240:243]
    s_waitcnt lgkmcnt(0)
    v_lshl_or_b32 v15, v15, 16, v15
    v_and_b32 v192, v15, v192
    v_and_b32 v193, v15, v193
    v_and_b32 v194, v15, v194
    v_and_b32 v195, v15, v195
    v_mfma_f32_16x16x32_f16 v[240:243], v[112:115], v[204:207], v[240:243]
    ds_read2_b32 v[216:217], v251 offset0:0 offset1:1
    ds_read2_b32 v[218:219], v251 offset0:2 offset1:3
    v_mfma_f32_16x16x32_f16 v[240:243], v[100:103], v[208:211], v[240:243]
    ds_read2_b32 v[220:221], v251 offset0:48 offset1:49
    ds_read2_b32 v[222:223], v251 offset0:50 offset1:51
    v_mfma_f32_16x16x32_f16 v[240:243], v[104:107], v[212:215], v[240:243]
    ds_write_b128 v249, v[164:167] offset:0
    ds_read2_b32 v[224:225], v251 offset0:160 offset1:161
    ds_read2_b32 v[226:227], v251 offset0:162 offset1:163
    s_bitcmp1_b32 s3, 1
    s_cselect_b32 s46, 1, 0
    s_lshl_b32 s50, s46, 9
    v_add_u32 v15, s50, v252
    s_mul_i32 s46, s46, 294912
    s_add_u32 s46, s46, s63
    ds_write_b128 v249, v[240:243] offset:1024
    s_waitcnt lgkmcnt(0)
    s_barrier
    ds_read_b64_tr_b16 v[244:245], v15 offset:0
    ds_read_b64_tr_b16 v[246:247], v15 offset:256
    v_mfma_f32_16x16x32_f16 v[164:167], v[196:199], v[44:47], 0
    ds_read2_b32 v[228:229], v251 offset0:144 offset1:145
    ds_read2_b32 v[230:231], v251 offset0:146 offset1:147
    v_mfma_f32_16x16x32_f16 v[164:167], v[116:119], v[200:203], v[164:167]
    ds_read2_b32 v[232:233], v251 offset0:128 offset1:129
    ds_read2_b32 v[234:235], v251 offset0:130 offset1:131
    v_mfma_f32_16x16x32_f16 v[164:167], v[120:123], v[204:207], v[164:167]
    ds_read2_b32 v[236:237], v251 offset0:112 offset1:113
    ds_read2_b32 v[238:239], v251 offset0:114 offset1:115
    v_mfma_f32_16x16x32_f16 v[164:167], v[108:111], v[208:211], v[164:167]
    s_lshl_b32 s57, s51, 6
    v_add_u32 v14, s57, v1
    v_min_u32 v14, 143, v14
    v_lshlrev_b32 v27, 7, v14
    v_lshlrev_b32 v14, 4, v14
    s_mov_b32 s53, 32768
    buffer_load_dwordx4 v[32:35], v27, s[32:35], s53 offen sc1
    v_mfma_f32_16x16x32_f16 v[164:167], v[112:115], v[212:215], v[164:167]
    v_mfma_f32_16x16x32_f16 v[164:167], v[100:103], v[216:219], v[164:167]
    s_waitcnt lgkmcnt(6)
    v_add_u32 v244, v11, v244
    v_add_u32 v245, v11, v245
    v_add_u32 v246, v11, v246
    v_add_u32 v247, v11, v247
    v_and_or_b32 v244, v244, v9, v10
    v_and_or_b32 v245, v245, v9, v10
    v_and_or_b32 v246, v246, v9, v10
    v_and_or_b32 v247, v247, v9, v10
    buffer_store_dwordx4 v[244:247], v253, s[32:35], s46 offen sc1
    v_mfma_f32_16x16x32_f16 v[164:167], v[104:107], v[220:223], v[164:167]
    v_mfma_f32_16x16x32_f16 v[164:167], v[192:195], v[28:31], v[164:167]
    v_mfma_f32_16x16x32_f16 v[164:167], v[148:151], v[224:227], v[164:167]
    v_mfma_f32_16x16x32_f16 v[240:243], v[196:199], v[52:55], 0
    v_mfma_f32_16x16x32_f16 v[240:243], v[124:127], v[200:203], v[240:243]
    v_mfma_f32_16x16x32_f16 v[240:243], v[128:131], v[204:207], v[240:243]
    v_mfma_f32_16x16x32_f16 v[240:243], v[116:119], v[208:211], v[240:243]
    v_mfma_f32_16x16x32_f16 v[240:243], v[120:123], v[212:215], v[240:243]
    v_mfma_f32_16x16x32_f16 v[240:243], v[108:111], v[216:219], v[240:243]
    v_mfma_f32_16x16x32_f16 v[240:243], v[112:115], v[220:223], v[240:243]
    v_mfma_f32_16x16x32_f16 v[240:243], v[192:195], v[36:39], v[240:243]
    ds_write_b128 v249, v[164:167] offset:2048
    v_mfma_f32_16x16x32_f16 v[240:243], v[152:155], v[224:227], v[240:243]
    s_waitcnt lgkmcnt(5)
    v_mfma_f32_16x16x32_f16 v[240:243], v[148:151], v[228:231], v[240:243]
    v_mfma_f32_16x16x32_f16 v[164:167], v[196:199], v[60:63], 0
    v_mfma_f32_16x16x32_f16 v[164:167], v[132:135], v[200:203], v[164:167]
    v_mfma_f32_16x16x32_f16 v[164:167], v[136:139], v[204:207], v[164:167]
    v_mfma_f32_16x16x32_f16 v[164:167], v[124:127], v[208:211], v[164:167]
    v_mfma_f32_16x16x32_f16 v[164:167], v[128:131], v[212:215], v[164:167]
    v_mfma_f32_16x16x32_f16 v[164:167], v[116:119], v[216:219], v[164:167]
    v_mfma_f32_16x16x32_f16 v[164:167], v[120:123], v[220:223], v[164:167]
    v_mfma_f32_16x16x32_f16 v[164:167], v[192:195], v[44:47], v[164:167]
    ds_write_b128 v249, v[240:243] offset:3072
    v_mfma_f32_16x16x32_f16 v[164:167], v[156:159], v[224:227], v[164:167]
    v_mfma_f32_16x16x32_f16 v[164:167], v[152:155], v[228:231], v[164:167]
    s_waitcnt lgkmcnt(4)
    v_mfma_f32_16x16x32_f16 v[164:167], v[148:151], v[232:235], v[164:167]
    v_mfma_f32_16x16x32_f16 v[240:243], v[196:199], v[68:71], 0
    v_mfma_f32_16x16x32_f16 v[240:243], v[140:143], v[200:203], v[240:243]
    v_mfma_f32_16x16x32_f16 v[240:243], v[144:147], v[204:207], v[240:243]
    v_mfma_f32_16x16x32_f16 v[240:243], v[132:135], v[208:211], v[240:243]
    v_mfma_f32_16x16x32_f16 v[240:243], v[136:139], v[212:215], v[240:243]
    v_mfma_f32_16x16x32_f16 v[240:243], v[124:127], v[216:219], v[240:243]
    v_mfma_f32_16x16x32_f16 v[240:243], v[128:131], v[220:223], v[240:243]
    v_mfma_f32_16x16x32_f16 v[240:243], v[192:195], v[52:55], v[240:243]
    ds_write_b128 v249, v[164:167] offset:4096
    v_mfma_f32_16x16x32_f16 v[240:243], v[160:163], v[224:227], v[240:243]
    v_mfma_f32_16x16x32_f16 v[240:243], v[156:159], v[228:231], v[240:243]
    v_mfma_f32_16x16x32_f16 v[240:243], v[152:155], v[232:235], v[240:243]
    s_waitcnt lgkmcnt(3)
    v_mfma_f32_16x16x32_f16 v[240:243], v[148:151], v[236:239], v[240:243]
    s_bitcmp1_b32 s3, 1
    s_cselect_b32 s46, 3, 2
    s_lshl_b32 s50, s46, 9
    v_add_u32 v15, s50, v252
    s_mul_i32 s46, s46, 294912
    s_add_u32 s46, s46, s63
    s_nop 1
    ds_write_b128 v249, v[240:243] offset:5120
    s_waitcnt lgkmcnt(0)
    s_barrier
    ds_read_b64_tr_b16 v[244:245], v15 offset:0
    ds_read_b64_tr_b16 v[246:247], v15 offset:256
    s_waitcnt lgkmcnt(0)
    v_add_u32 v244, v11, v244
    v_add_u32 v245, v11, v245
    v_add_u32 v246, v11, v246
    v_add_u32 v247, v11, v247
    v_and_or_b32 v244, v244, v9, v10
    v_and_or_b32 v245, v245, v9, v10
    v_and_or_b32 v246, v246, v9, v10
    v_and_or_b32 v247, v247, v9, v10
    buffer_store_dwordx4 v[244:247], v253, s[32:35], s46 offen sc1
    s_setprio 0
    s_and_b32 s56, s40, 0x7fffff
    s_mov_b32 s47, 0
    s_waitcnt vmcnt(2)
SCP4:
    v_xor_b32 v32, s56, v32
    v_xor_b32 v33, s56, v33
    v_xor_b32 v34, s56, v34
    v_xor_b32 v35, s56, v35
    v_or3_b32 v255, v32, v33, v34
    v_or_b32 v255, v255, v35
    v_and_b32 v255, 0x7fffff, v255
    v_cmp_ne_u32 vcc, 0, v255
    s_cbranch_vccz SCD5
    s_add_u32 s47, s47, 1
    s_cmp_ge_u32 s47, 65536
    s_cbranch_scc1 SCD5
    s_sleep 8
    buffer_load_dwordx4 v[32:35], v27, s[32:35], s53 offen sc1
    s_waitcnt vmcnt(0)
    s_branch SCP4
SCD5:
    ds_write_b128 v14, v[32:35] offset:46080
    s_cmp_ge_u32 s49, 128
    s_cbranch_scc1 H_NOR
    global_load_dwordx4 v[208:211], v12, s[16:17]
    global_load_dwordx4 v[212:215], v12, s[16:17] offset:512
    global_load_dword v216, v13, s[16:17] offset:1024
    global_load_dwordx4 v[218:221], v12, s[20:21]
    global_load_dwordx4 v[222:225], v12, s[20:21] offset:512
    global_load_dword v226, v13, s[20:21] offset:1024
    s_mov_b32 s57, 10485760
    buffer_load_dwordx4 v[72:75], v4, s[32:35], s57 offen sc1
    buffer_load_dwordx4 v[76:79], v4, s[32:35], s57 offen offset:512 sc1
    buffer_load_dword v80, v5, s[32:35], s57 offen offset:1024 sc1
    global_load_dwordx4 v[16:19], v4, s[4:5]
    global_load_dwordx4 v[20:23], v4, s[4:5] offset:512
    global_load_dword v24, v5, s[4:5] offset:1024
H_NOR:
    s_bitcmp1_b32 s3, 1
    s_cselect_b32 s46, 5, 4
    s_lshl_b32 s50, s46, 9
    v_add_u32 v15, s50, v252
    s_mul_i32 s46, s46, 294912
    s_add_u32 s46, s46, s63
    s_waitcnt lgkmcnt(0)
    s_barrier
    ds_read_b64_tr_b16 v[244:245], v15 offset:0
    ds_read_b64_tr_b16 v[246:247], v15 offset:256
    s_waitcnt lgkmcnt(0)
    v_add_u32 v244, v11, v244
    v_add_u32 v245, v11, v245
    v_add_u32 v246, v11, v246
    v_add_u32 v247, v11, v247
    v_and_or_b32 v244, v244, v9, v10
    v_and_or_b32 v245, v245, v9, v10
    v_and_or_b32 v246, v246, v9, v10
    v_and_or_b32 v247, v247, v9, v10
    buffer_store_dwordx4 v[244:247], v253, s[32:35], s46 offen sc1
    s_add_u32 s46, s63, 1769472
    s_bitcmp1_b32 s3, 1
    s_waitcnt lgkmcnt(0)
    s_barrier
    s_cbranch_scc1 YS6
    ds_read_b64_tr_b16 v[244:245], v252 offset:3072
    ds_read_b64_tr_b16 v[246:247], v252 offset:3328
    s_waitcnt lgkmcnt(0)
    v_add_u32 v244, v11, v244
    v_add_u32 v245, v11, v245
    v_add_u32 v246, v11, v246
    v_add_u32 v247, v11, v247
    v_and_or_b32 v244, v244, v9, v10
    v_and_or_b32 v245, v245, v9, v10
    v_and_or_b32 v246, v246, v9, v10
    v_and_or_b32 v247, v247, v9, v10
    buffer_store_dwordx4 v[244:247], v253, s[32:35], s46 offen sc1
YS6:
    s_add_u32 s46, s63, 2064384
    s_bitcmp1_b32 s3, 1
    s_waitcnt lgkmcnt(0)
    s_barrier
    s_cbranch_scc0 YS7
    ds_read_b64_tr_b16 v[244:245], v252 offset:3584
    ds_read_b64_tr_b16 v[246:247], v252 offset:3840
    s_waitcnt lgkmcnt(0)
    v_add_u32 v244, v11, v244
    v_add_u32 v245, v11, v245
    v_add_u32 v246, v11, v246
    v_add_u32 v247, v11, v247
    v_and_or_b32 v244, v244, v9, v10
    v_and_or_b32 v245, v245, v9, v10
    v_and_or_b32 v246, v246, v9, v10
    v_and_or_b32 v247, v247, v9, v10
    buffer_store_dwordx4 v[244:247], v253, s[32:35], s46 offen sc1
YS7:
RPREP:
    s_cmp_ge_u32 s49, 128
    s_cbranch_scc1 ZROLE
    s_cmp_lg_u32 s61, 0
    s_cselect_b32 s39, 1, 0
    s_cbranch_scc1 RP_U0
    ds_read_b128 v[72:75], v25
    ds_read_b128 v[76:79], v25 offset:512
    ds_read_b32 v80, v26 offset:1024
RP_U0:
    v_lshlrev_b32 v38, 1, v12
    v_lshlrev_b32 v39, 1, v13
    s_mul_i32 s60, s49, 18432
    s_add_u32 s60, s60, 4194304
    s_add_u32 s61, s60, 8192
    s_add_u32 s62, s60, 16384
    v_mov_b32 v204, 0
    s_waitcnt vmcnt(2)
    s_cmp_ge_u32 s49, 64
    s_cbranch_scc1 RP_0
    buffer_load_dwordx4 v[140:143], v3, s[32:35], s60 offen sc1
    buffer_load_dwordx4 v[144:147], v3, s[32:35], s61 offen sc1
    s_cmp_ge_u32 s3, 2
    s_cbranch_scc1 YL8
    buffer_load_dwordx4 v[148:151], v3, s[32:35], s62 offen sc1
YL8:
RP_0:
    v_lshlrev_b32 v84, 16, v208
    v_and_b32 v85, 0xffff0000, v208
    v_lshlrev_b32 v120, 16, v218
    v_and_b32 v121, 0xffff0000, v218
    v_dot2c_f32_bf16 v204, v218, v8
    v_lshlrev_b32 v86, 16, v209
    v_and_b32 v87, 0xffff0000, v209
    v_lshlrev_b32 v122, 16, v219
    v_and_b32 v123, 0xffff0000, v219
    v_dot2c_f32_bf16 v204, v219, v8
    v_lshlrev_b32 v88, 16, v210
    v_and_b32 v89, 0xffff0000, v210
    v_lshlrev_b32 v124, 16, v220
    v_and_b32 v125, 0xffff0000, v220
    v_dot2c_f32_bf16 v204, v220, v8
    v_lshlrev_b32 v90, 16, v211
    v_and_b32 v91, 0xffff0000, v211
    v_lshlrev_b32 v126, 16, v221
    v_and_b32 v127, 0xffff0000, v221
    v_dot2c_f32_bf16 v204, v221, v8
    v_lshlrev_b32 v92, 16, v212
    v_and_b32 v93, 0xffff0000, v212
    v_lshlrev_b32 v128, 16, v222
    v_and_b32 v129, 0xffff0000, v222
    v_dot2c_f32_bf16 v204, v222, v8
    v_lshlrev_b32 v94, 16, v213
    v_and_b32 v95, 0xffff0000, v213
    v_lshlrev_b32 v130, 16, v223
    v_and_b32 v131, 0xffff0000, v223
    v_dot2c_f32_bf16 v204, v223, v8
    v_lshlrev_b32 v96, 16, v214
    v_and_b32 v97, 0xffff0000, v214
    v_lshlrev_b32 v132, 16, v224
    v_and_b32 v133, 0xffff0000, v224
    v_dot2c_f32_bf16 v204, v224, v8
    v_lshlrev_b32 v98, 16, v215
    v_and_b32 v99, 0xffff0000, v215
    v_lshlrev_b32 v134, 16, v225
    v_and_b32 v135, 0xffff0000, v225
    v_dot2c_f32_bf16 v204, v225, v8
    v_lshlrev_b32 v100, 16, v216
    v_and_b32 v101, 0xffff0000, v216
    v_lshlrev_b32 v136, 16, v226
    v_and_b32 v137, 0xffff0000, v226
    v_dot2c_f32_bf16 v204, v226, v8
    s_waitcnt lgkmcnt(0)
    s_cmp_lg_u32 s39, 0
    s_cbranch_scc1 RP_U1
    v_add_u32 v72, v11, v72
    v_add_u32 v73, v11, v73
    v_add_u32 v74, v11, v74
    v_add_u32 v75, v11, v75
    v_add_u32 v76, v11, v76
    v_add_u32 v77, v11, v77
    v_add_u32 v78, v11, v78
    v_add_u32 v79, v11, v79
    v_add_u32 v80, v11, v80
    v_and_b32 v72, v9, v72
    v_and_b32 v73, v9, v73
    v_and_b32 v74, v9, v74
    v_and_b32 v75, v9, v75
    v_and_b32 v76, v9, v76
    v_and_b32 v77, v9, v77
    v_and_b32 v78, v9, v78
    v_and_b32 v79, v9, v79
    v_and_b32 v80, v9, v80
    s_branch RP_U2
RP_U1:
    s_mov_b32 s47, 0
RP_U3:
    v_xor_b32 v72, v10, v72
    v_xor_b32 v73, v10, v73
    v_xor_b32 v74, v10, v74
    v_xor_b32 v75, v10, v75
    v_xor_b32 v76, v10, v76
    v_xor_b32 v77, v10, v77
    v_xor_b32 v78, v10, v78
    v_xor_b32 v79, v10, v79
    v_xor_b32 v80, v10, v80
    v_or3_b32 v37, v72, v73, v74
    v_or3_b32 v37, v37, v75, v76
    v_or3_b32 v37, v37, v77, v78
    v_or3_b32 v37, v37, v79, v80
    v_and_b32 v37, 0x70007, v37
    v_cmp_ne_u32 vcc, 0, v37
    s_cbranch_vccz RP_U2
    s_add_u32 s47, s47, 1
    s_cmp_ge_u32 s47, 65536
    s_cbranch_scc1 RP_U2
    s_sleep 4
    s_mov_b32 s57, 10485760
    buffer_load_dwordx4 v[72:75], v4, s[32:35], s57 offen sc1
    buffer_load_dwordx4 v[76:79], v4, s[32:35], s57 offen offset:512 sc1
    buffer_load_dword v80, v5, s[32:35], s57 offen offset:1024 sc1
    s_waitcnt vmcnt(0)
    s_branch RP_U3
RP_U2:
    v_fma_mix_f32 v84, v72, v84, 0 op_sel:[0,0,0] op_sel_hi:[1,0,0]
    v_fma_mix_f32 v85, v72, v85, 0 op_sel:[1,0,0] op_sel_hi:[1,0,0]
    v_fma_mix_f32 v86, v73, v86, 0 op_sel:[0,0,0] op_sel_hi:[1,0,0]
    v_add_f32_dpp v204, v204, v204 row_ror:8 row_mask:0xf bank_mask:0xf
    v_fma_mix_f32 v87, v73, v87, 0 op_sel:[1,0,0] op_sel_hi:[1,0,0]
    v_fma_mix_f32 v88, v74, v88, 0 op_sel:[0,0,0] op_sel_hi:[1,0,0]
    v_fma_mix_f32 v89, v74, v89, 0 op_sel:[1,0,0] op_sel_hi:[1,0,0]
    v_fma_mix_f32 v90, v75, v90, 0 op_sel:[0,0,0] op_sel_hi:[1,0,0]
    v_fma_mix_f32 v91, v75, v91, 0 op_sel:[1,0,0] op_sel_hi:[1,0,0]
    v_add_f32_dpp v204, v204, v204 row_ror:4 row_mask:0xf bank_mask:0xf
    v_fma_mix_f32 v92, v76, v92, 0 op_sel:[0,0,0] op_sel_hi:[1,0,0]
    v_fma_mix_f32 v93, v76, v93, 0 op_sel:[1,0,0] op_sel_hi:[1,0,0]
    v_fma_mix_f32 v94, v77, v94, 0 op_sel:[0,0,0] op_sel_hi:[1,0,0]
    v_fma_mix_f32 v95, v77, v95, 0 op_sel:[1,0,0] op_sel_hi:[1,0,0]
    v_fma_mix_f32 v96, v78, v96, 0 op_sel:[0,0,0] op_sel_hi:[1,0,0]
    v_add_f32_dpp v204, v204, v204 row_ror:2 row_mask:0xf bank_mask:0xf
    v_fma_mix_f32 v97, v78, v97, 0 op_sel:[1,0,0] op_sel_hi:[1,0,0]
    v_fma_mix_f32 v98, v79, v98, 0 op_sel:[0,0,0] op_sel_hi:[1,0,0]
    v_fma_mix_f32 v99, v79, v99, 0 op_sel:[1,0,0] op_sel_hi:[1,0,0]
    v_fma_mix_f32 v100, v80, v100, 0 op_sel:[0,0,0] op_sel_hi:[1,0,0]
    v_fma_mix_f32 v101, v80, v101, 0 op_sel:[1,0,0] op_sel_hi:[1,0,0]
    v_add_f32_dpp v204, v204, v204 row_ror:1 row_mask:0xf bank_mask:0xf
    v_cvt_pk_bf16_f32 v84, 0, v84
    v_cvt_pk_bf16_f32 v85, 0, v85
    v_cvt_pk_bf16_f32 v86, 0, v86
    v_cvt_pk_bf16_f32 v87, 0, v87
    v_cvt_pk_bf16_f32 v88, 0, v88
    v_mov_b32 v37, v204
    v_cvt_pk_bf16_f32 v89, 0, v89
    v_cvt_pk_bf16_f32 v90, 0, v90
    v_cvt_pk_bf16_f32 v91, 0, v91
    v_cvt_pk_bf16_f32 v92, 0, v92
    v_cvt_pk_bf16_f32 v93, 0, v93
    v_permlane16_swap_b32 v204, v37
    v_cvt_pk_bf16_f32 v94, 0, v94
    v_cvt_pk_bf16_f32 v95, 0, v95
    v_cvt_pk_bf16_f32 v96, 0, v96
    v_cvt_pk_bf16_f32 v97, 0, v97
    v_cvt_pk_bf16_f32 v98, 0, v98
    v_add_f32 v204, v204, v37
    v_cvt_pk_bf16_f32 v99, 0, v99
    v_cvt_pk_bf16_f32 v100, 0, v100
    v_cvt_pk_bf16_f32 v101, 0, v101
    v_dot2_f32_bf16 v102, v16, v6, v84
    v_dot2_f32_bf16 v103, v16, v7, v85
    v_dot2_f32_bf16 v104, v17, v6, v86
    v_dot2_f32_bf16 v105, v17, v7, v87
    v_dot2_f32_bf16 v106, v18, v6, v88
    v_dot2_f32_bf16 v107, v18, v7, v89
    v_dot2_f32_bf16 v108, v19, v6, v90
    v_dot2_f32_bf16 v109, v19, v7, v91
    v_dot2_f32_bf16 v110, v20, v6, v92
    v_dot2_f32_bf16 v111, v20, v7, v93
    v_dot2_f32_bf16 v112, v21, v6, v94
    v_dot2_f32_bf16 v113, v21, v7, v95
    v_dot2_f32_bf16 v114, v22, v6, v96
    v_dot2_f32_bf16 v115, v22, v7, v97
    v_dot2_f32_bf16 v116, v23, v6, v98
    v_dot2_f32_bf16 v117, v23, v7, v99
    v_dot2_f32_bf16 v118, v24, v6, v100
    v_dot2_f32_bf16 v119, v24, v7, v101
    s_cmp_lt_u32 s2, 144
    s_cbranch_scc1 RP_1
    s_and_b32 s46, s2, 7
    s_sub_u32 s48, s2, 216
    s_lshr_b32 s48, s48, 3
    v_lshrrev_b32 v37, 3, v0
    v_mul_u32_u24 v37, 9216, v37
    v_and_b32 v36, 7, v0
    v_lshl_add_u32 v37, v36, 4, v37
    s_cmp_ge_u32 s46, 4
    s_cselect_b32 s50, 1, 0
    s_add_u32 s50, s50, s46
    s_lshl_b32 s50, s50, 10
    s_add_u32 s50, s50, 384
    s_lshr_b32 s53, s48, 1
    s_sub_u32 s53, 8, s53
    s_mul_i32 s53, s53, 589824
    s_add_u32 s50, s50, s53
    v_add_u32 v36, s50, v37
    s_bitcmp1_b32 s48, 0
    s_cselect_b32 s56, s24, s22
    s_cselect_b32 s57, s25, s23
    global_load_dwordx4 v[140:143], v36, s[56:57] nt
    s_cmp_lg_u32 s46, 3
    s_cbranch_scc1 PF_0
    global_load_dwordx4 v[144:147], v36, s[56:57] offset:1024 nt
PF_0:
    v_subrev_u32 v36, 1179648, v36
    global_load_dwordx4 v[140:143], v36, s[56:57] nt
    s_cmp_lg_u32 s46, 3
    s_cbranch_scc1 PF_1
    global_load_dwordx4 v[144:147], v36, s[56:57] offset:1024 nt
PF_1:
    v_subrev_u32 v36, 1179648, v36
    global_load_dwordx4 v[140:143], v36, s[56:57] nt
    s_cmp_lg_u32 s46, 3
    s_cbranch_scc1 PF_2
    global_load_dwordx4 v[144:147], v36, s[56:57] offset:1024 nt
PF_2:
    v_subrev_u32 v36, 1179648, v36
    s_waitcnt vmcnt(0)
    s_cmp_ge_u32 s3, 4
    s_cbranch_scc1 RP_S
    s_lshl_b32 s57, s51, 6
    v_add_u32 v14, s57, v1
    v_min_u32 v14, 143, v14
    v_lshlrev_b32 v27, 7, v14
    v_lshlrev_b32 v14, 4, v14
    s_mov_b32 s53, 32768
    buffer_load_dwordx4 v[32:35], v27, s[32:35], s53 offen sc1
    s_and_b32 s56, s40, 0x7fffff
    s_mov_b32 s47, 0
    s_waitcnt vmcnt(0)
SCP9:
    v_xor_b32 v32, s56, v32
    v_xor_b32 v33, s56, v33
    v_xor_b32 v34, s56, v34
    v_xor_b32 v35, s56, v35
    v_or3_b32 v255, v32, v33, v34
    v_or_b32 v255, v255, v35
    v_and_b32 v255, 0x7fffff, v255
    v_cmp_ne_u32 vcc, 0, v255
    s_cbranch_vccz SCD10
    s_add_u32 s47, s47, 1
    s_cmp_ge_u32 s47, 65536
    s_cbranch_scc1 SCD10
    s_sleep 8
    buffer_load_dwordx4 v[32:35], v27, s[32:35], s53 offen sc1
    s_waitcnt vmcnt(0)
    s_branch SCP9
SCD10:
    ds_write_b128 v14, v[32:35] offset:46080
RP_S:
    s_waitcnt lgkmcnt(0)
    s_barrier
RP_1:
    s_cmp_lt_u32 s49, 64
    s_cbranch_scc1 RP_2
    buffer_load_dwordx4 v[140:143], v3, s[32:35], s60 offen sc1
    buffer_load_dwordx4 v[144:147], v3, s[32:35], s61 offen sc1
    s_cmp_ge_u32 s3, 2
    s_cbranch_scc1 YL11
    buffer_load_dwordx4 v[148:151], v3, s[32:35], s62 offen sc1
YL11:
RP_2:
    ds_read_b128 v[52:55], v38 offset:46080
    ds_read_b128 v[56:59], v38 offset:46096
    ds_read_b128 v[60:63], v38 offset:47104
    ds_read_b128 v[64:67], v38 offset:47120
    ds_read_b64 v[68:69], v39 offset:48128
    v_and_b32 v36, 7, v0
    v_mul_u32_u24 v36, 2320, v36
    v_lshrrev_b32 v37, 3, v0
    v_lshl_add_u32 v36, v37, 4, v36
    v_lshrrev_b32 v37, 5, v1
    s_mul_i32 s46, s3, 2320
    s_add_u32 s46, s46, 49152
    v_lshl_add_u32 v37, v37, 3, s46
    v_lshl_add_u32 v38, v12, 1, v37
    v_bfe_u32 v39, v1, 1, 4
    v_lshl_add_u32 v39, v39, 4, v37
    v_and_b32 v37, 1, v1
    v_lshl_add_u32 v39, v37, 2, v39
    v_lshrrev_b32 v35, 5, v1
    v_lshlrev_b32 v35, 4, v35
    s_and_b32 s52, s3, 4
    s_add_u32 s52, s52, s3
    s_lshl_b32 s46, s52, 2
    s_add_u32 s46, s46, 163456
    v_add_u32 v35, s46, v35
    v_and_b32 v40, 15, v1
    v_lshlrev_b32 v34, 2, v40
    v_add_u32 v34, 163456, v34
    v_and_b32 v42, 48, v2
    v_add_u32 v41, 163456, v42
    v_lshrrev_b32 v43, 2, v1
    v_lshl_add_u32 v42, v43, 14, v42
    s_and_b32 s63, s40, 0xffff
    s_or_b32 s53, s63, 0x80000000
    s_lshl_b32 s54, s49, 6
    s_add_u32 s54, s54, 9437184
    s_mov_b32 s58, 1
    s_mov_b32 s59, 1
    s_lshl_b32 s46, s49, 4
    s_sub_u32 s46, 0xffff, s46
    v_sub_u32 v44, s46, v40
    v_mov_b32 v45, 0xffff0000
    v_lshrrev_b32 v46, 5, v1
    v_mul_u32_u24 v46, 6144, v46
    s_mul_i32 s46, s52, 1536
    v_add3_u32 v46, v46, v12, s46
    v_lshrrev_b32 v47, 2, v0
    v_and_b32 v48, 3, v0
    v_lshlrev_b32 v48, 4, v48
    v_lshl_add_u32 v47, v47, 6, v48
    v_mov_b32 v183, s40
    v_mov_b32 v187, s40
    v_mov_b32 v191, s40
    v_lshlrev_b32 v49, 2, v0
    v_sub_u32 v232, 0xffff, v49
    v_subrev_u32 v233, 1, v232
    v_subrev_u32 v234, 2, v232
    v_subrev_u32 v235, 3, v232
    v_mov_b32 v48, s63
    v_mov_b32 v49, 163520
    v_mov_b32 v50, -1
    s_cmp_ge_u32 s3, 2
    s_cbranch_scc1 RP_3
    s_mov_b32 s47, 0
PL12:
    s_waitcnt vmcnt(0)
    v_xor_b32 v140, v10, v140
    v_xor_b32 v141, v10, v141
    v_xor_b32 v142, v10, v142
    v_xor_b32 v143, v10, v143
    v_xor_b32 v144, v10, v144
    v_xor_b32 v145, v10, v145
    v_xor_b32 v146, v10, v146
    v_xor_b32 v147, v10, v147
    v_xor_b32 v148, v10, v148
    v_xor_b32 v149, v10, v149
    v_xor_b32 v150, v10, v150
    v_xor_b32 v151, v10, v151
    v_or3_b32 v37, v140, v141, v142
    v_or3_b32 v37, v37, v143, v144
    v_or3_b32 v37, v37, v145, v146
    v_or3_b32 v37, v37, v147, v148
    v_or3_b32 v37, v37, v149, v150
    v_or_b32 v37, v37, v151
    v_and_b32 v37, 0x70007, v37
    v_cmp_ne_u32 vcc, 0, v37
    s_cbranch_vccz PD13
    s_add_u32 s47, s47, 1
    s_cmp_ge_u32 s47, 65536
    s_cbranch_scc1 PD13
    s_sleep 1
    buffer_load_dwordx4 v[140:143], v3, s[32:35], s60 offen sc1
    buffer_load_dwordx4 v[144:147], v3, s[32:35], s61 offen sc1
    buffer_load_dwordx4 v[148:151], v3, s[32:35], s62 offen sc1
    s_branch PL12
PD13:
    ds_write_b128 v36, v[148:151] offset:51200
    s_branch RP_4
RP_3:
    s_mov_b32 s47, 0
PL14:
    s_waitcnt vmcnt(0)
    v_xor_b32 v140, v10, v140
    v_xor_b32 v141, v10, v141
    v_xor_b32 v142, v10, v142
    v_xor_b32 v143, v10, v143
    v_xor_b32 v144, v10, v144
    v_xor_b32 v145, v10, v145
    v_xor_b32 v146, v10, v146
    v_xor_b32 v147, v10, v147
    v_or3_b32 v37, v140, v141, v142
    v_or3_b32 v37, v37, v143, v144
    v_or3_b32 v37, v37, v145, v146
    v_or_b32 v37, v37, v147
    v_and_b32 v37, 0x70007, v37
    v_cmp_ne_u32 vcc, 0, v37
    s_cbranch_vccz PD15
    s_add_u32 s47, s47, 1
    s_cmp_ge_u32 s47, 65536
    s_cbranch_scc1 PD15
    s_sleep 1
    buffer_load_dwordx4 v[140:143], v3, s[32:35], s60 offen sc1
    buffer_load_dwordx4 v[144:147], v3, s[32:35], s61 offen sc1
    s_branch PL14
PD15:
RP_4:
    ds_write_b128 v36, v[140:143] offset:49152
    ds_write_b128 v36, v[144:147] offset:50176
    s_waitcnt lgkmcnt(0)
    s_barrier
    ds_read2_b64 v[152:155], v38 offset0:0 offset1:2
    ds_read2_b64 v[156:159], v38 offset0:128 offset1:130
    ds_read_b32 v160, v39 offset:2048
    s_getreg_b32 s60, hwreg(HW_REG_XCC_ID, 0, 3)
    s_mul_i32 s60, s60, 16384
    s_add_u32 s60, s60, 9437184
    s_lshl_b32 s61, s3, 14
    s_add_u32 s61, s61, 9830400
    s_waitcnt lgkmcnt(2)
    v_fma_mix_f32 v162, v152, v52, v102 op_sel:[0,0,0] op_sel_hi:[1,0,0]
    v_fma_mix_f32 v163, v152, v53, v103 op_sel:[1,0,0] op_sel_hi:[1,0,0]
    v_fma_mix_f32 v164, v153, v54, v104 op_sel:[0,0,0] op_sel_hi:[1,0,0]
    v_fma_mix_f32 v165, v153, v55, v105 op_sel:[1,0,0] op_sel_hi:[1,0,0]
    v_pk_mul_f32 v[30:31], v[162:163], v[162:163]
    v_pk_mul_f32 v[32:33], v[162:163], v[120:121]
    v_fma_mix_f32 v166, v154, v56, v106 op_sel:[0,0,0] op_sel_hi:[1,0,0]
    v_fma_mix_f32 v167, v154, v57, v107 op_sel:[1,0,0] op_sel_hi:[1,0,0]
    v_pk_add_f32 v[28:29], v[162:163], v[164:165]
    v_pk_fma_f32 v[30:31], v[164:165], v[164:165], v[30:31]
    v_pk_fma_f32 v[32:33], v[164:165], v[122:123], v[32:33]
    v_fma_mix_f32 v168, v155, v58, v108 op_sel:[0,0,0] op_sel_hi:[1,0,0]
    v_fma_mix_f32 v169, v155, v59, v109 op_sel:[1,0,0] op_sel_hi:[1,0,0]
    v_pk_add_f32 v[28:29], v[28:29], v[166:167]
    v_pk_fma_f32 v[30:31], v[166:167], v[166:167], v[30:31]
    v_pk_fma_f32 v[32:33], v[166:167], v[124:125], v[32:33]
    s_waitcnt lgkmcnt(1)
    v_fma_mix_f32 v170, v156, v60, v110 op_sel:[0,0,0] op_sel_hi:[1,0,0]
    v_fma_mix_f32 v171, v156, v61, v111 op_sel:[1,0,0] op_sel_hi:[1,0,0]
    v_pk_add_f32 v[28:29], v[28:29], v[168:169]
    v_pk_fma_f32 v[30:31], v[168:169], v[168:169], v[30:31]
    v_pk_fma_f32 v[32:33], v[168:169], v[126:127], v[32:33]
    v_fma_mix_f32 v172, v157, v62, v112 op_sel:[0,0,0] op_sel_hi:[1,0,0]
    v_fma_mix_f32 v173, v157, v63, v113 op_sel:[1,0,0] op_sel_hi:[1,0,0]
    v_pk_add_f32 v[28:29], v[28:29], v[170:171]
    v_pk_fma_f32 v[30:31], v[170:171], v[170:171], v[30:31]
    v_pk_fma_f32 v[32:33], v[170:171], v[128:129], v[32:33]
    v_fma_mix_f32 v174, v158, v64, v114 op_sel:[0,0,0] op_sel_hi:[1,0,0]
    v_fma_mix_f32 v175, v158, v65, v115 op_sel:[1,0,0] op_sel_hi:[1,0,0]
    v_pk_add_f32 v[28:29], v[28:29], v[172:173]
    v_pk_fma_f32 v[30:31], v[172:173], v[172:173], v[30:31]
    v_pk_fma_f32 v[32:33], v[172:173], v[130:131], v[32:33]
    v_fma_mix_f32 v176, v159, v66, v116 op_sel:[0,0,0] op_sel_hi:[1,0,0]
    v_fma_mix_f32 v177, v159, v67, v117 op_sel:[1,0,0] op_sel_hi:[1,0,0]
    v_pk_add_f32 v[28:29], v[28:29], v[174:175]
    v_pk_fma_f32 v[30:31], v[174:175], v[174:175], v[30:31]
    v_pk_fma_f32 v[32:33], v[174:175], v[132:133], v[32:33]
    s_waitcnt lgkmcnt(0)
    v_fma_mix_f32 v178, v160, v68, v118 op_sel:[0,0,0] op_sel_hi:[1,0,0]
    v_fma_mix_f32 v179, v160, v69, v119 op_sel:[1,0,0] op_sel_hi:[1,0,0]
    v_pk_add_f32 v[28:29], v[28:29], v[176:177]
    v_pk_fma_f32 v[30:31], v[176:177], v[176:177], v[30:31]
    v_pk_fma_f32 v[32:33], v[176:177], v[134:135], v[32:33]
    v_pk_add_f32 v[28:29], v[28:29], v[178:179]
    v_pk_fma_f32 v[30:31], v[178:179], v[178:179], v[30:31]
    v_pk_fma_f32 v[32:33], v[178:179], v[136:137], v[32:33]
    v_add_f32 v28, v28, v29
    v_add_f32 v30, v30, v31
    v_add_f32 v32, v32, v33
    s_nop 0
    v_permlane16_swap_b32 v28, v30
    v_add_f32 v28, v28, v30
    v_add_f32_dpp v32, v32, v32 row_ror:8 row_mask:0xf bank_mask:0xf
    s_nop 0
    v_add_f32_dpp v28, v28, v28 row_ror:8 row_mask:0xf bank_mask:0xf
    v_add_f32_dpp v32, v32, v32 row_ror:4 row_mask:0xf bank_mask:0xf
    s_nop 0
    v_add_f32_dpp v28, v28, v28 row_ror:4 row_mask:0xf bank_mask:0xf
    v_add_f32_dpp v32, v32, v32 row_ror:2 row_mask:0xf bank_mask:0xf
    s_nop 0
    v_add_f32_dpp v28, v28, v28 row_ror:2 row_mask:0xf bank_mask:0xf
    v_add_f32_dpp v32, v32, v32 row_ror:1 row_mask:0xf bank_mask:0xf
    s_nop 0
    v_add_f32_dpp v28, v28, v28 row_ror:1 row_mask:0xf bank_mask:0xf
    v_mov_b32 v33, v32
    v_mov_b32 v30, v28
    s_nop 1
    v_permlane16_swap_b32 v28, v30
    v_permlane16_swap_b32 v32, v33
    v_add_f32 v32, v32, v33
    v_mul_f32 v28, 0x3ae38e39, v28
    v_mul_f32 v30, 0x3ae38e39, v30
    v_fma_f32 v30, -v28, v28, v30
    v_cvt_pk_bf16_f32 v200, 0, v28
    v_max_f32 v30, 0, v30
    v_cvt_pk_bf16_f32 v30, 0, v30
    v_add_f32 v30, 0x3727c5ac, v30
    v_cvt_pk_bf16_f32 v30, 0, v30
    v_sqrt_f32 v30, v30
    s_nop 0
    v_cvt_pk_bf16_f32 v30, 0, v30
    v_rcp_f32 v202, v30
    v_fma_f32 v32, -v200, v204, v32
    v_mul_f32 v32, v32, v202
    v_cvt_pk_bf16_f32 v236, 0, v32
    v_ashrrev_i32 v28, 31, v236
    v_and_b32 v28, 0x7fff0000, v28
    v_xor_b32 v28, v28, v236
    v_xor_b32 v28, s53, v28
    s_mov_b64 exec, s[58:59]
    ds_write_b32 v35, v28
    s_mov_b64 exec, -1
    s_waitcnt lgkmcnt(0)
    s_barrier
    s_cmp_lg_u32 s3, 0
    s_cbranch_scc1 L2_NOKEY
    s_mov_b32 exec_hi, 0
    ds_read_b128 v[28:31], v41
    s_waitcnt lgkmcnt(0)
    buffer_store_dwordx4 v[28:31], v42, s[32:35], s54 offen sc1
    s_mov_b64 exec, -1
L2_NOKEY:
    ds_read_b32 v205, v34
    v_fma_mix_f32 v162, v152, v52, v84 op_sel:[0,0,0] op_sel_hi:[1,0,0]
    v_fma_mix_f32 v163, v152, v53, v85 op_sel:[1,0,0] op_sel_hi:[1,0,0]
    v_fma_mix_f32 v164, v153, v54, v86 op_sel:[0,0,0] op_sel_hi:[1,0,0]
    v_fma_mix_f32 v165, v153, v55, v87 op_sel:[1,0,0] op_sel_hi:[1,0,0]
    v_fma_mix_f32 v166, v154, v56, v88 op_sel:[0,0,0] op_sel_hi:[1,0,0]
    v_fma_mix_f32 v167, v154, v57, v89 op_sel:[1,0,0] op_sel_hi:[1,0,0]
    v_fma_mix_f32 v168, v155, v58, v90 op_sel:[0,0,0] op_sel_hi:[1,0,0]
    v_fma_mix_f32 v169, v155, v59, v91 op_sel:[1,0,0] op_sel_hi:[1,0,0]
    v_fma_mix_f32 v170, v156, v60, v92 op_sel:[0,0,0] op_sel_hi:[1,0,0]
    v_fma_mix_f32 v171, v156, v61, v93 op_sel:[1,0,0] op_sel_hi:[1,0,0]
    v_fma_mix_f32 v172, v157, v62, v94 op_sel:[0,0,0] op_sel_hi:[1,0,0]
    v_fma_mix_f32 v173, v157, v63, v95 op_sel:[1,0,0] op_sel_hi:[1,0,0]
    v_fma_mix_f32 v174, v158, v64, v96 op_sel:[0,0,0] op_sel_hi:[1,0,0]
    v_fma_mix_f32 v175, v158, v65, v97 op_sel:[1,0,0] op_sel_hi:[1,0,0]
    v_fma_mix_f32 v176, v159, v66, v98 op_sel:[0,0,0] op_sel_hi:[1,0,0]
    v_fma_mix_f32 v177, v159, v67, v99 op_sel:[1,0,0] op_sel_hi:[1,0,0]
    v_fma_mix_f32 v178, v160, v68, v100 op_sel:[0,0,0] op_sel_hi:[1,0,0]
    v_fma_mix_f32 v179, v160, v69, v101 op_sel:[1,0,0] op_sel_hi:[1,0,0]
    v_cvt_pk_bf16_f32 v162, 0, v162
    v_cvt_pk_bf16_f32 v163, 0, v163
    v_cvt_pk_bf16_f32 v164, 0, v164
    v_cvt_pk_bf16_f32 v165, 0, v165
    v_cvt_pk_bf16_f32 v166, 0, v166
    v_cvt_pk_bf16_f32 v167, 0, v167
    v_cvt_pk_bf16_f32 v168, 0, v168
    v_cvt_pk_bf16_f32 v169, 0, v169
    v_cvt_pk_bf16_f32 v170, 0, v170
    v_cvt_pk_bf16_f32 v171, 0, v171
    v_cvt_pk_bf16_f32 v172, 0, v172
    v_cvt_pk_bf16_f32 v173, 0, v173
    v_cvt_pk_bf16_f32 v174, 0, v174
    v_cvt_pk_bf16_f32 v175, 0, v175
    v_cvt_pk_bf16_f32 v176, 0, v176
    v_cvt_pk_bf16_f32 v177, 0, v177
    v_cvt_pk_bf16_f32 v178, 0, v178
    v_cvt_pk_bf16_f32 v179, 0, v179
    v_dot2_f32_bf16 v162, v16, v6, v162
    v_dot2_f32_bf16 v163, v16, v7, v163
    v_dot2_f32_bf16 v164, v17, v6, v164
    v_dot2_f32_bf16 v165, v17, v7, v165
    v_dot2_f32_bf16 v166, v18, v6, v166
    v_dot2_f32_bf16 v167, v18, v7, v167
    v_dot2_f32_bf16 v168, v19, v6, v168
    v_dot2_f32_bf16 v169, v19, v7, v169
    v_dot2_f32_bf16 v170, v20, v6, v170
    v_dot2_f32_bf16 v171, v20, v7, v171
    v_dot2_f32_bf16 v172, v21, v6, v172
    v_dot2_f32_bf16 v173, v21, v7, v173
    v_dot2_f32_bf16 v174, v22, v6, v174
    v_dot2_f32_bf16 v175, v22, v7, v175
    v_dot2_f32_bf16 v176, v23, v6, v176
    v_dot2_f32_bf16 v177, v23, v7, v177
    v_dot2_f32_bf16 v178, v24, v6, v178
    v_dot2_f32_bf16 v179, v24, v7, v179
    v_cvt_pk_bf16_f32 v162, 0, v162
    v_cvt_pk_bf16_f32 v163, 0, v163
    v_cvt_pk_bf16_f32 v164, 0, v164
    v_cvt_pk_bf16_f32 v165, 0, v165
    v_cvt_pk_bf16_f32 v166, 0, v166
    v_cvt_pk_bf16_f32 v167, 0, v167
    v_cvt_pk_bf16_f32 v168, 0, v168
    v_cvt_pk_bf16_f32 v169, 0, v169
    v_cvt_pk_bf16_f32 v170, 0, v170
    v_cvt_pk_bf16_f32 v171, 0, v171
    v_cvt_pk_bf16_f32 v172, 0, v172
    v_cvt_pk_bf16_f32 v173, 0, v173
    v_cvt_pk_bf16_f32 v174, 0, v174
    v_cvt_pk_bf16_f32 v175, 0, v175
    v_cvt_pk_bf16_f32 v176, 0, v176
    v_cvt_pk_bf16_f32 v177, 0, v177
    v_cvt_pk_bf16_f32 v178, 0, v178
    v_cvt_pk_bf16_f32 v179, 0, v179
    v_pk_add_f32 v[102:103], v[162:163], v[200:201] op_sel_hi:[1,0] neg_lo:[0,1] neg_hi:[0,1]
    v_pk_add_f32 v[104:105], v[164:165], v[200:201] op_sel_hi:[1,0] neg_lo:[0,1] neg_hi:[0,1]
    v_pk_add_f32 v[106:107], v[166:167], v[200:201] op_sel_hi:[1,0] neg_lo:[0,1] neg_hi:[0,1]
    v_pk_add_f32 v[108:109], v[168:169], v[200:201] op_sel_hi:[1,0] neg_lo:[0,1] neg_hi:[0,1]
    v_pk_add_f32 v[110:111], v[170:171], v[200:201] op_sel_hi:[1,0] neg_lo:[0,1] neg_hi:[0,1]
    v_pk_add_f32 v[112:113], v[172:173], v[200:201] op_sel_hi:[1,0] neg_lo:[0,1] neg_hi:[0,1]
    v_pk_add_f32 v[114:115], v[174:175], v[200:201] op_sel_hi:[1,0] neg_lo:[0,1] neg_hi:[0,1]
    v_pk_add_f32 v[116:117], v[176:177], v[200:201] op_sel_hi:[1,0] neg_lo:[0,1] neg_hi:[0,1]
    v_pk_add_f32 v[118:119], v[178:179], v[200:201] op_sel_hi:[1,0] neg_lo:[0,1] neg_hi:[0,1]
    v_cvt_pk_bf16_f32 v102, 0, v102
    v_cvt_pk_bf16_f32 v103, 0, v103
    v_cvt_pk_bf16_f32 v104, 0, v104
    v_cvt_pk_bf16_f32 v105, 0, v105
    v_cvt_pk_bf16_f32 v106, 0, v106
    v_cvt_pk_bf16_f32 v107, 0, v107
    v_cvt_pk_bf16_f32 v108, 0, v108
    v_cvt_pk_bf16_f32 v109, 0, v109
    v_cvt_pk_bf16_f32 v110, 0, v110
    buffer_load_dwordx4 v[228:231], v47, s[32:35], s60 offen sc1
    v_cvt_pk_bf16_f32 v111, 0, v111
    v_cvt_pk_bf16_f32 v112, 0, v112
    v_cvt_pk_bf16_f32 v113, 0, v113
    v_cvt_pk_bf16_f32 v114, 0, v114
    v_cvt_pk_bf16_f32 v115, 0, v115
    v_cvt_pk_bf16_f32 v116, 0, v116
    v_cvt_pk_bf16_f32 v117, 0, v117
    v_cvt_pk_bf16_f32 v118, 0, v118
    v_cvt_pk_bf16_f32 v119, 0, v119
    v_pk_mul_f32 v[102:103], v[102:103], v[202:203] op_sel_hi:[1,0]
    v_pk_mul_f32 v[104:105], v[104:105], v[202:203] op_sel_hi:[1,0]
    v_pk_mul_f32 v[106:107], v[106:107], v[202:203] op_sel_hi:[1,0]
    v_pk_mul_f32 v[108:109], v[108:109], v[202:203] op_sel_hi:[1,0]
    v_pk_mul_f32 v[110:111], v[110:111], v[202:203] op_sel_hi:[1,0]
    v_pk_mul_f32 v[112:113], v[112:113], v[202:203] op_sel_hi:[1,0]
    v_pk_mul_f32 v[114:115], v[114:115], v[202:203] op_sel_hi:[1,0]
    v_pk_mul_f32 v[116:117], v[116:117], v[202:203] op_sel_hi:[1,0]
    v_pk_mul_f32 v[118:119], v[118:119], v[202:203] op_sel_hi:[1,0]
    s_waitcnt lgkmcnt(0)
    v_and_or_b32 v205, v205, v45, v44
    v_mov_b32 v206, v205
    v_cvt_pk_bf16_f32 v180, v102, v103
    s_nop 0
    v_max_u32_dpp v206, v206, v206 row_ror:8 row_mask:0xf bank_mask:0xf
    v_cvt_pk_bf16_f32 v181, v104, v105
    s_nop 0
    v_max_u32_dpp v206, v206, v206 row_ror:4 row_mask:0xf bank_mask:0xf
    v_cvt_pk_bf16_f32 v182, v106, v107
    s_nop 0
    v_max_u32_dpp v206, v206, v206 row_ror:2 row_mask:0xf bank_mask:0xf
    s_nop 1
    v_max_u32_dpp v206, v206, v206 row_ror:1 row_mask:0xf bank_mask:0xf
    ds_write_b128 v46, v[180:183]
    v_readfirstlane_b32 s56, v206
    v_cvt_pk_bf16_f32 v184, v108, v109
    v_cmp_ne_u32 vcc, v206, v205
    v_cvt_pk_bf16_f32 v185, v110, v111
    s_nop 0
    v_cndmask_b32 v205, 0, v205, vcc
    v_mov_b32 v206, v205
    v_cvt_pk_bf16_f32 v186, v112, v113
    s_nop 0
    v_max_u32_dpp v206, v206, v206 row_ror:8 row_mask:0xf bank_mask:0xf
    ds_write_b128 v46, v[184:187] offset:512
    s_nop 0
    v_max_u32_dpp v206, v206, v206 row_ror:4 row_mask:0xf bank_mask:0xf
    v_cvt_pk_bf16_f32 v188, v114, v115
    s_nop 0
    v_max_u32_dpp v206, v206, v206 row_ror:2 row_mask:0xf bank_mask:0xf
    s_nop 1
    v_max_u32_dpp v206, v206, v206 row_ror:1 row_mask:0xf bank_mask:0xf
    v_cvt_pk_bf16_f32 v189, v116, v117
    v_readfirstlane_b32 s57, v206
    v_cvt_pk_bf16_f32 v190, v118, v119
    v_cmp_ne_u32 vcc, v206, v205
    ds_write_b128 v46, v[188:191] offset:1024
    s_nop 0
    v_cndmask_b32 v205, 0, v205, vcc
    s_waitcnt lgkmcnt(0)
    s_barrier
    s_andn2_b32 s46, 15, s56
    s_mul_i32 s46, s46, 1536
    v_add_u32 v37, s46, v2
    ds_read_b128 v[120:123], v37
    ds_read_b128 v[124:127], v37 offset:1024
    s_andn2_b32 s46, 15, s57
    s_mul_i32 s46, s46, 1536
    v_add_u32 v37, s46, v2
    ds_read_b128 v[128:131], v37
    ds_read_b128 v[132:135], v37 offset:1024
    s_mov_b32 s47, 0
PL16:
    s_waitcnt vmcnt(0)
    v_xor_b32 v228, v48, v228
    v_xor_b32 v229, v48, v229
    v_xor_b32 v230, v48, v230
    v_xor_b32 v231, v48, v231
    v_or3_b32 v37, v228, v229, v230
    v_or_b32 v37, v37, v231
    v_and_b32 v37, 0xffff, v37
    v_cmp_ne_u32 vcc, 0, v37
    s_cbranch_vccz PD17
    s_add_u32 s47, s47, 1
    s_cmp_ge_u32 s47, 65536
    s_cbranch_scc1 PD17
    s_sleep 1
    buffer_load_dwordx4 v[228:231], v47, s[32:35], s60 offen sc1
    s_branch PL16
PD17:
    v_or_b32 v228, v228, v232
    v_or_b32 v229, v229, v233
    v_or_b32 v230, v230, v234
    v_or_b32 v231, v231, v235
RK_LOOP:
    v_cmp_lt_u32 s[4:5], s56, v228
    v_cmp_lt_u32 s[6:7], s56, v229
    v_cmp_lt_u32 s[8:9], s56, v230
    v_cmp_lt_u32 s[10:11], s56, v231
    v_cmp_lt_u32 s[12:13], s57, v228
    v_cmp_lt_u32 s[14:15], s57, v229
    v_cmp_lt_u32 s[16:17], s57, v230
    v_cmp_lt_u32 s[18:19], s57, v231
    s_bcnt1_i32_b64 s4, s[4:5]
    s_bcnt1_i32_b64 s6, s[6:7]
    s_bcnt1_i32_b64 s8, s[8:9]
    s_bcnt1_i32_b64 s10, s[10:11]
    s_add_u32 s4, s4, s6
    s_add_u32 s8, s8, s10
    s_add_u32 s46, s4, s8
    s_bcnt1_i32_b64 s12, s[12:13]
    s_bcnt1_i32_b64 s14, s[14:15]
    s_bcnt1_i32_b64 s16, s[16:17]
    s_bcnt1_i32_b64 s18, s[18:19]
    s_add_u32 s12, s12, s14
    s_add_u32 s16, s16, s18
    s_add_u32 s48, s12, s16
    s_pack_ll_b32_b16 s46, s46, s48
    v_mov_b32 v37, s46
    s_mov_b64 exec, 1
    ds_add_u32 v49, v37
    s_mov_b64 exec, -1
    s_waitcnt lgkmcnt(0)
    s_barrier
    ds_read_b32 v37, v49
    v_add_u32 v49, 4, v49
    s_waitcnt lgkmcnt(0)
    v_readfirstlane_b32 s53, v37
    s_and_b32 s54, s53, 0xffff
    s_cmp_ge_u32 s54, 8
    s_cbranch_scc1 RK_DONE
    s_mul_i32 s48, s54, 1536
    s_add_u32 s48, s48, s61
    buffer_store_dwordx4 v[120:123], v2, s[32:35], s48 offen sc1
    s_mov_b32 exec_hi, 0
    buffer_store_dwordx4 v[124:127], v2, s[32:35], s48 offen offset:1024 sc1
    s_mov_b64 exec, -1
    s_andn2_b32 s46, 0xffff, s56
    s_and_b32 s48, s46, 11
    s_cmp_lg_u32 s48, s52
    s_cbranch_scc1 RK_N18
    s_bitcmp1_b32 s46, 2
    s_cselect_b32 exec_lo, 0, -1
    s_cselect_b32 exec_hi, -1, 0
    v_mov_b32 v50, s54
    v_mov_b32 v51, s46
    s_mov_b64 exec, -1
RK_N18:
    s_lshr_b32 s54, s53, 16
    s_cmp_ge_u32 s54, 8
    s_cbranch_scc1 RK_DONE
    s_mul_i32 s48, s54, 1536
    s_add_u32 s48, s48, s61
    buffer_store_dwordx4 v[128:131], v2, s[32:35], s48 offen sc1
    s_mov_b32 exec_hi, 0
    buffer_store_dwordx4 v[132:135], v2, s[32:35], s48 offen offset:1024 sc1
    s_mov_b64 exec, -1
    s_andn2_b32 s46, 0xffff, s57
    s_and_b32 s48, s46, 11
    s_cmp_lg_u32 s48, s52
    s_cbranch_scc1 RK_N19
    s_bitcmp1_b32 s46, 2
    s_cselect_b32 exec_lo, 0, -1
    s_cselect_b32 exec_hi, -1, 0
    v_mov_b32 v50, s54
    v_mov_b32 v51, s46
    s_mov_b64 exec, -1
RK_N19:
    v_mov_b32 v206, v205
    s_nop 1
    v_max_u32_dpp v206, v206, v206 row_ror:8 row_mask:0xf bank_mask:0xf
    s_nop 1
    v_max_u32_dpp v206, v206, v206 row_ror:4 row_mask:0xf bank_mask:0xf
    s_nop 1
    v_max_u32_dpp v206, v206, v206 row_ror:2 row_mask:0xf bank_mask:0xf
    s_nop 1
    v_max_u32_dpp v206, v206, v206 row_ror:1 row_mask:0xf bank_mask:0xf
    s_nop 0
    v_readfirstlane_b32 s56, v206
    v_cmp_ne_u32 vcc, v206, v205
    s_nop 1
    v_cndmask_b32 v205, 0, v205, vcc
    v_mov_b32 v206, v205
    s_nop 1
    v_max_u32_dpp v206, v206, v206 row_ror:8 row_mask:0xf bank_mask:0xf
    s_nop 1
    v_max_u32_dpp v206, v206, v206 row_ror:4 row_mask:0xf bank_mask:0xf
    s_nop 1
    v_max_u32_dpp v206, v206, v206 row_ror:2 row_mask:0xf bank_mask:0xf
    s_nop 1
    v_max_u32_dpp v206, v206, v206 row_ror:1 row_mask:0xf bank_mask:0xf
    s_nop 0
    v_readfirstlane_b32 s57, v206
    v_cmp_ne_u32 vcc, v206, v205
    s_nop 1
    v_cndmask_b32 v205, 0, v205, vcc
    s_andn2_b32 s46, 15, s56
    s_mul_i32 s46, s46, 1536
    v_add_u32 v37, s46, v2
    ds_read_b128 v[120:123], v37
    ds_read_b128 v[124:127], v37 offset:1024
    s_andn2_b32 s46, 15, s57
    s_mul_i32 s46, s46, 1536
    v_add_u32 v37, s46, v2
    ds_read_b128 v[128:131], v37
    ds_read_b128 v[132:135], v37 offset:1024
    s_branch RK_LOOP
RK_DONE:
    v_cmp_gt_u32 vcc, 8, v50
    s_andn2_b64 s[58:59], -1, vcc
    s_and_b64 exec, vcc, -1
    s_cbranch_execz RK_NOSEL
    v_mul_f32 v30, 0xbfb8aa3b, v236
    v_exp_f32 v30, v30
    v_mov_b32 v31, s40
    v_add_f32 v30, 1.0, v30
    v_rcp_f32 v30, v30
    v_mov_b32 v35, s40
    v_cvt_pk_bf16_f32 v30, 0, v30
    v_or_b32 v30, v51, v30
    v_mov_b32 v34, v30
    v_mul_u32_u24 v50, 4608, v50
    v_add_u32 v50, v50, v12
    s_mov_b32 s48, 131072
    s_mov_b32 s55, 131584
    v_or_b32_sdwa v28, v162, v180 dst_sel:DWORD dst_unused:UNUSED_PAD src0_sel:DWORD src1_sel:WORD_0
    v_or_b32_sdwa v29, v163, v180 dst_sel:DWORD dst_unused:UNUSED_PAD src0_sel:DWORD src1_sel:WORD_1
    buffer_store_dwordx4 v[28:31], v50, s[32:35], s48 offen offset:0 sc1
    v_or_b32_sdwa v32, v164, v181 dst_sel:DWORD dst_unused:UNUSED_PAD src0_sel:DWORD src1_sel:WORD_0
    v_or_b32_sdwa v33, v165, v181 dst_sel:DWORD dst_unused:UNUSED_PAD src0_sel:DWORD src1_sel:WORD_1
    buffer_store_dwordx4 v[32:35], v50, s[32:35], s55 offen offset:0 sc1
    v_or_b32_sdwa v28, v166, v182 dst_sel:DWORD dst_unused:UNUSED_PAD src0_sel:DWORD src1_sel:WORD_0
    v_or_b32_sdwa v29, v167, v182 dst_sel:DWORD dst_unused:UNUSED_PAD src0_sel:DWORD src1_sel:WORD_1
    buffer_store_dwordx4 v[28:31], v50, s[32:35], s55 offen offset:512 sc1
    v_or_b32_sdwa v32, v168, v184 dst_sel:DWORD dst_unused:UNUSED_PAD src0_sel:DWORD src1_sel:WORD_0
    v_or_b32_sdwa v33, v169, v184 dst_sel:DWORD dst_unused:UNUSED_PAD src0_sel:DWORD src1_sel:WORD_1
    buffer_store_dwordx4 v[32:35], v50, s[32:35], s55 offen offset:1024 sc1
    v_or_b32_sdwa v28, v170, v185 dst_sel:DWORD dst_unused:UNUSED_PAD src0_sel:DWORD src1_sel:WORD_0
    v_or_b32_sdwa v29, v171, v185 dst_sel:DWORD dst_unused:UNUSED_PAD src0_sel:DWORD src1_sel:WORD_1
    buffer_store_dwordx4 v[28:31], v50, s[32:35], s55 offen offset:1536 sc1
    v_or_b32_sdwa v32, v172, v186 dst_sel:DWORD dst_unused:UNUSED_PAD src0_sel:DWORD src1_sel:WORD_0
    v_or_b32_sdwa v33, v173, v186 dst_sel:DWORD dst_unused:UNUSED_PAD src0_sel:DWORD src1_sel:WORD_1
    buffer_store_dwordx4 v[32:35], v50, s[32:35], s55 offen offset:2048 sc1
    v_or_b32_sdwa v28, v174, v188 dst_sel:DWORD dst_unused:UNUSED_PAD src0_sel:DWORD src1_sel:WORD_0
    v_or_b32_sdwa v29, v175, v188 dst_sel:DWORD dst_unused:UNUSED_PAD src0_sel:DWORD src1_sel:WORD_1
    buffer_store_dwordx4 v[28:31], v50, s[32:35], s55 offen offset:2560 sc1
    v_or_b32_sdwa v32, v176, v189 dst_sel:DWORD dst_unused:UNUSED_PAD src0_sel:DWORD src1_sel:WORD_0
    v_or_b32_sdwa v33, v177, v189 dst_sel:DWORD dst_unused:UNUSED_PAD src0_sel:DWORD src1_sel:WORD_1
    buffer_store_dwordx4 v[32:35], v50, s[32:35], s55 offen offset:3072 sc1
    v_or_b32_sdwa v28, v178, v190 dst_sel:DWORD dst_unused:UNUSED_PAD src0_sel:DWORD src1_sel:WORD_0
    v_or_b32_sdwa v29, v179, v190 dst_sel:DWORD dst_unused:UNUSED_PAD src0_sel:DWORD src1_sel:WORD_1
    buffer_store_dwordx4 v[28:31], v50, s[32:35], s55 offen offset:3584 sc1
RK_NOSEL:
    s_mov_b64 exec, -1
    v_dot2_f32_bf16 v162, v180, v6, v162
    v_dot2_f32_bf16 v163, v180, v7, v163
    v_dot2_f32_bf16 v164, v181, v6, v164
    v_dot2_f32_bf16 v165, v181, v7, v165
    v_dot2_f32_bf16 v166, v182, v6, v166
    v_dot2_f32_bf16 v167, v182, v7, v167
    v_dot2_f32_bf16 v168, v184, v6, v168
    v_dot2_f32_bf16 v169, v184, v7, v169
    v_dot2_f32_bf16 v170, v185, v6, v170
    v_dot2_f32_bf16 v171, v185, v7, v171
    v_dot2_f32_bf16 v172, v186, v6, v172
    v_dot2_f32_bf16 v173, v186, v7, v173
    v_dot2_f32_bf16 v174, v188, v6, v174
    v_dot2_f32_bf16 v175, v188, v7, v175
    v_dot2_f32_bf16 v176, v189, v6, v176
    v_dot2_f32_bf16 v177, v189, v7, v177
    v_dot2_f32_bf16 v178, v190, v6, v178
    v_dot2_f32_bf16 v179, v190, v7, v179
    v_cvt_pk_bf16_f32 v16, v162, v163
    v_cvt_pk_bf16_f32 v17, v164, v165
    v_cvt_pk_bf16_f32 v18, v166, v167
    v_cvt_pk_bf16_f32 v19, v168, v169
    v_cvt_pk_bf16_f32 v20, v170, v171
    v_cvt_pk_bf16_f32 v21, v172, v173
    v_cvt_pk_bf16_f32 v22, v174, v175
    v_cvt_pk_bf16_f32 v23, v176, v177
    v_cvt_pk_bf16_f32 v24, v178, v179
    s_mov_b64 exec, s[58:59]
    s_cbranch_execz RK_NOOUT
    global_store_dwordx4 v4, v[16:19], s[28:29] sc1
    global_store_dwordx4 v4, v[20:23], s[28:29] offset:512 sc1
    global_store_dword v5, v24, s[28:29] offset:1024 sc1
RK_NOOUT:
    s_mov_b64 exec, -1
    s_cmp_ge_u32 s2, 144
    s_cbranch_scc1 DUMP
ZROLE:
    s_cmp_lg_u32 s3, 0
    s_cbranch_scc1 DUMP
    s_and_b32 s50, s2, 7
    s_mul_i32 s50, s50, 18
    s_lshr_b32 s46, s2, 3
    s_add_u32 s50, s50, s46
    v_and_b32 v12, 7, v1
    v_mul_u32_u24 v12, 4608, v12
    v_bfe_u32 v13, v1, 4, 1
    v_lshrrev_b32 v14, 5, v1
    v_lshl_add_u32 v13, v13, 1, v14
    s_lshl_b32 s46, s50, 2
    v_add_u32 v13, s46, v13
    v_bfe_u32 v14, v13, 3, 5
    v_and_b32 v15, 7, v13
    v_lshrrev_b32 v36, 8, v13
    v_lshl_add_u32 v15, v36, 3, v15
    s_cmp_lt_u32 s50, 128
    s_cbranch_scc1 Z_A
    v_bfe_u32 v14, v13, 1, 5
    v_and_b32 v15, 1, v13
    v_add_u32 v15, 16, v15
Z_A:
    v_lshrrev_b32 v36, 1, v15
    v_and_b32 v15, 1, v15
    v_lshl_add_u32 v14, v14, 4, v12
    v_lshl_add_u32 v14, v36, 9, v14
    v_cmp_eq_u32 s[52:53], 1, v15
    s_mul_i32 s60, s50, 9216
    s_add_u32 s60, s60, 7340032
    s_add_u32 s61, s60, 4096
    s_add_u32 s62, s60, 8192
    s_mov_b32 s63, 131072
    s_and_b32 s46, s40, 63
    v_mov_b32 v36, s46
    s_getreg_b32 s48, hwreg(HW_REG_XCC_ID, 0, 3)
    s_lshl_b32 s48, s48, 14
    s_add_u32 s48, s48, 9699328
    s_add_u32 s59, s48, 8192
    v_lshlrev_b32 v80, 7, v1
    v_and_b32 v81, 7, v1
    v_lshlrev_b32 v81, 7, v81
    buffer_load_dword v38, v80, s[32:35], s48 offen sc1
    buffer_load_dword v39, v81, s[32:35], s59 offen sc1
    s_mov_b32 s47, 0
PL20:
    s_waitcnt vmcnt(0)
    v_cmp_ne_u32 vcc, s40, v38
    v_cmp_ne_u32 s[56:57], s40, v39
    s_or_b64 vcc, vcc, s[56:57]
    s_cbranch_vccz PD21
    s_add_u32 s47, s47, 1
    s_cmp_ge_u32 s47, 65536
    s_cbranch_scc1 PD21
    s_sleep 2
    buffer_load_dword v38, v80, s[32:35], s48 offen sc1
    buffer_load_dword v39, v81, s[32:35], s59 offen sc1
    s_branch PL20
PD21:
    buffer_load_dwordx4 v[32:35], v14, s[32:35], s63 offen sc1
    s_mov_b32 s47, 0
PL22:
    s_waitcnt vmcnt(0)
    v_cmp_ne_u32 vcc, s40, v35
    s_cbranch_vccz PD23
    s_add_u32 s47, s47, 1
    s_cmp_ge_u32 s47, 65536
    s_cbranch_scc1 PD23
    s_sleep 2
    buffer_load_dwordx4 v[32:35], v14, s[32:35], s63 offen sc1
    s_branch PL22
PD23:
    v_mov_b32 v38, 0
    s_mov_b32 s47, 0
ZL24:
    buffer_load_dwordx4 v[40:43], v2, s[32:35], s60 offen offset:0 sc1
    buffer_load_dwordx4 v[44:47], v2, s[32:35], s60 offen offset:1024 sc1
    buffer_load_dwordx4 v[48:51], v2, s[32:35], s60 offen offset:2048 sc1
    buffer_load_dwordx4 v[52:55], v2, s[32:35], s60 offen offset:3072 sc1
    buffer_load_dwordx4 v[56:59], v2, s[32:35], s61 offen offset:0 sc1
    buffer_load_dwordx4 v[60:63], v2, s[32:35], s61 offen offset:1024 sc1
    buffer_load_dwordx4 v[64:67], v2, s[32:35], s61 offen offset:2048 sc1
    buffer_load_dwordx4 v[68:71], v2, s[32:35], s61 offen offset:3072 sc1
    buffer_load_dwordx4 v[72:75], v2, s[32:35], s62 offen offset:0 sc1
    s_cmp_lg_u32 s47, 0
    s_cbranch_scc1 Z_NS
    v_cndmask_b32 v32, v32, v33, s[52:53]
    v_and_b32 v33, 0xffff0000, v34
    v_and_b32 v28, 2047, v34
    v_mul_u32_u24 v28, 1152, v28
    v_lshl_add_u32 v28, v13, 1, v28
    v_lshlrev_b32 v34, 16, v32
    v_and_b32 v35, 0xffff0000, v32
Z_NS:
    s_waitcnt vmcnt(8)
    v_xor_b32 v40, v36, v40
    v_xor_b32 v41, v36, v41
    v_xor_b32 v42, v36, v42
    v_xor_b32 v43, v36, v43
    v_or3_b32 v37, v40, v41, v42
    v_or_b32 v37, v37, v43
    s_waitcnt vmcnt(7)
    v_xor_b32 v44, v36, v44
    v_xor_b32 v45, v36, v45
    v_xor_b32 v46, v36, v46
    v_xor_b32 v47, v36, v47
    v_or3_b32 v37, v37, v44, v45
    v_or3_b32 v37, v37, v46, v47
    v_pk_add_f32 v[40:41], v[40:41], v[44:45]
    v_pk_add_f32 v[42:43], v[42:43], v[46:47]
    s_waitcnt vmcnt(6)
    v_xor_b32 v48, v36, v48
    v_xor_b32 v49, v36, v49
    v_xor_b32 v50, v36, v50
    v_xor_b32 v51, v36, v51
    v_or3_b32 v37, v37, v48, v49
    v_or3_b32 v37, v37, v50, v51
    v_pk_add_f32 v[40:41], v[40:41], v[48:49]
    v_pk_add_f32 v[42:43], v[42:43], v[50:51]
    s_waitcnt vmcnt(5)
    v_xor_b32 v52, v36, v52
    v_xor_b32 v53, v36, v53
    v_xor_b32 v54, v36, v54
    v_xor_b32 v55, v36, v55
    v_or3_b32 v37, v37, v52, v53
    v_or3_b32 v37, v37, v54, v55
    v_pk_add_f32 v[40:41], v[40:41], v[52:53]
    v_pk_add_f32 v[42:43], v[42:43], v[54:55]
    s_waitcnt vmcnt(4)
    v_xor_b32 v56, v36, v56
    v_xor_b32 v57, v36, v57
    v_xor_b32 v58, v36, v58
    v_xor_b32 v59, v36, v59
    v_or3_b32 v37, v37, v56, v57
    v_or3_b32 v37, v37, v58, v59
    v_pk_add_f32 v[40:41], v[40:41], v[56:57]
    v_pk_add_f32 v[42:43], v[42:43], v[58:59]
    s_waitcnt vmcnt(3)
    v_xor_b32 v60, v36, v60
    v_xor_b32 v61, v36, v61
    v_xor_b32 v62, v36, v62
    v_xor_b32 v63, v36, v63
    v_or3_b32 v37, v37, v60, v61
    v_or3_b32 v37, v37, v62, v63
    v_pk_add_f32 v[40:41], v[40:41], v[60:61]
    v_pk_add_f32 v[42:43], v[42:43], v[62:63]
    s_waitcnt vmcnt(2)
    v_xor_b32 v64, v36, v64
    v_xor_b32 v65, v36, v65
    v_xor_b32 v66, v36, v66
    v_xor_b32 v67, v36, v67
    v_or3_b32 v37, v37, v64, v65
    v_or3_b32 v37, v37, v66, v67
    v_pk_add_f32 v[40:41], v[40:41], v[64:65]
    v_pk_add_f32 v[42:43], v[42:43], v[66:67]
    s_waitcnt vmcnt(1)
    v_xor_b32 v68, v36, v68
    v_xor_b32 v69, v36, v69
    v_xor_b32 v70, v36, v70
    v_xor_b32 v71, v36, v71
    v_or3_b32 v37, v37, v68, v69
    v_or3_b32 v37, v37, v70, v71
    v_pk_add_f32 v[40:41], v[40:41], v[68:69]
    v_pk_add_f32 v[42:43], v[42:43], v[70:71]
    s_waitcnt vmcnt(0)
    v_xor_b32 v72, v36, v72
    v_xor_b32 v73, v36, v73
    v_xor_b32 v74, v36, v74
    v_xor_b32 v75, v36, v75
    v_or3_b32 v37, v37, v72, v73
    v_or3_b32 v37, v37, v74, v75
    v_pk_add_f32 v[40:41], v[40:41], v[72:73]
    v_pk_add_f32 v[42:43], v[42:43], v[74:75]
    v_and_or_b32 v37, v37, 63, v38
    v_cmp_ne_u32 vcc, 0, v37
    s_cbranch_vccz ZD25
    s_add_u32 s47, s47, 1
    s_cmp_ge_u32 s47, 65536
    s_cbranch_scc1 ZD25
    s_sleep 2
    s_branch ZL24
ZD25:
    v_permlane32_swap_b32 v40, v41
    v_permlane32_swap_b32 v42, v43
    v_add_f32 v40, v40, v41
    v_add_f32 v42, v42, v43
    s_nop 1
    v_permlane16_swap_b32 v40, v42
    v_add_f32 v40, v40, v42
    s_nop 1
    v_add_f32_dpp v40, v40, v40 row_ror:8 row_mask:0xf bank_mask:0xf
    v_cvt_pk_bf16_f32 v40, 0, v40
    v_mul_f32 v40, v40, v33
    v_cvt_pk_bf16_f32 v40, 0, v40
    v_add_f32 v40, v40, v34
    v_cvt_pk_bf16_f32 v40, 0, v40
    v_add_f32 v40, v40, v35
    v_cvt_pk_bf16_f32 v40, v40, v40
    s_mov_b32 exec_lo, 0x00ff00ff
    s_mov_b32 exec_hi, 0x00ff00ff
    global_store_short v28, v40, s[28:29]
    s_cmp_lg_u32 s50, 0
    s_cbranch_scc1 DUMP
    s_mov_b64 exec, 1
    v_mov_b32 v36, s40
    buffer_store_dword v36, v2, s[32:35], 0 offen
    s_branch DUMP
FROLE:
    s_sub_u32 s50, s2, 144
    s_cmp_lt_u32 s50, 48
    s_cbranch_scc1 F_NT
    v_cmp_gt_u32 vcc, TBLEND-PC0, v15
    s_and_saveexec_b64 s[58:59], vcc
    s_cbranch_execz F_NT
    global_load_dword v255, v15, s[42:43]
F_NT:
    s_mov_b64 exec, -1
    s_and_b32 s46, s50, 7
    s_sub_u32 s48, 3, s46
    s_and_b32 s48, s48, 7
    s_lshr_b32 s50, s50, 3
    s_add_u32 s50, s50, s48
    s_add_u32 s50, s50, 2
    s_cmp_ge_u32 s50, 9
    s_cselect_b32 s48, 9, 0
    s_sub_u32 s50, s50, s48
    s_mul_i32 s46, s46, 9
    s_add_u32 s50, s50, s46
    v_lshrrev_b32 v12, 3, v0
    v_and_b32 v13, 7, v0
    v_lshlrev_b32 v13, 4, v13
    v_mul_u32_u24 v4, 9216, v12
    v_add_u32 v4, v4, v13
    v_mul_u32_u24 v5, 1152, v12
    v_add_u32 v5, v5, v13
    s_lshl_b32 s46, s50, 7
    s_mul_i32 s48, s50, 73728
    s_mov_b32 s38, 5308416
    s_mov_b32 s39, 0x00020000
    s_mov_b32 s54, 5308416
    s_mov_b32 s55, 0x00020000
    s_mov_b32 s58, 5308416
    s_mov_b32 s59, 0x00020000
    s_waitcnt lgkmcnt(0)
    s_mov_b32 s36, s22
    s_and_b32 s37, s23, 0xffff
    s_mov_b32 s52, s24
    s_and_b32 s53, s25, 0xffff
    s_mov_b32 s56, s26
    s_and_b32 s57, s27, 0xffff
    s_load_dword s40, s[30:31], 0
    s_cmp_ge_u32 s2, 192
    s_cbranch_scc1 F_L1
    s_barrier
    s_lshl_b32 s49, s50, 7
    buffer_load_dwordx4 v[16:19], v4, s[36:39], s49 offen nt
    buffer_load_dwordx4 v[20:23], v4, s[52:55], s49 offen nt
    s_add_u32 s49, s49, 589824
    buffer_load_dwordx4 v[24:27], v4, s[36:39], s49 offen nt
    buffer_load_dwordx4 v[28:31], v4, s[52:55], s49 offen nt
    s_add_u32 s49, s49, 589824
    buffer_load_dwordx4 v[32:35], v4, s[36:39], s49 offen nt
    buffer_load_dwordx4 v[36:39], v4, s[52:55], s49 offen nt
    s_add_u32 s49, s49, 589824
    buffer_load_dwordx4 v[40:43], v4, s[36:39], s49 offen nt
    buffer_load_dwordx4 v[44:47], v4, s[52:55], s49 offen nt
    s_add_u32 s49, s49, 589824
F_L1:
    s_mov_b32 s32, s30
    s_and_b32 s33, s31, 0xffff
    s_mov_b32 s34, 0x10000000
    s_mov_b32 s35, 0x00020000
    v_mul_u32_u24 v6, 272, v12
    v_add_u32 v6, v6, v13
    v_lshrrev_b32 v14, 4, v1
    v_bfe_u32 v15, v1, 2, 2
    v_lshl_add_u32 v7, v14, 3, v15
    v_mul_u32_u24 v7, 272, v7
    v_and_b32 v8, 2, v1
    v_lshl_add_u32 v7, v8, 6, v7
    v_and_b32 v8, 1, v1
    v_lshl_add_u32 v7, v8, 3, v7
    s_lshl_b32 s46, s3, 4
    v_add_u32 v7, s46, v7
    v_bfe_u32 v8, v1, 3, 3
    v_mul_u32_u24 v8, 1184, v8
    v_add_u32 v8, v8, v13
    s_mul_i32 s46, s3, 9600
    v_add_u32 v8, s46, v8
    v_mul_u32_u24 v9, 9600, v14
    v_mul_u32_u24 v15, 1184, v15
    v_add_u32 v9, v9, v15
    v_and_b32 v15, 3, v1
    v_lshl_add_u32 v9, v15, 3, v9
    s_lshl_b32 s46, s3, 5
    v_add_u32 v9, s46, v9
    v_add_u32 v242, 0, v0
    v_mul_u32_u24 v243, 683, v242
    v_lshrrev_b32 v243, 16, v243
    v_mul_u32_u24 v244, 96, v243
    v_sub_u32 v242, v242, v244
    v_mul_u32_u24 v243, 1168, v243
    v_add_u32 v243, 81920, v243
    v_and_b32 v244, 31, v242
    v_lshrrev_b32 v242, 5, v242
    v_lshl_add_u32 v245, v244, 4, v243
    v_lshl_add_u32 v246, v244, 2, v243
    v_add_u32 v246, 1024, v246
    v_cmp_eq_u32 s[60:61], 1, v242
    v_cmp_eq_u32 s[62:63], 2, v242
    v_mov_b32 v247, 0
    v_mov_b32 v248, 12
    v_cndmask_b32 v247, v247, v248, s[60:61]
    v_mov_b32 v248, 520
    v_cndmask_b32 v247, v247, v248, s[62:63]
    v_add_u32 v236, v247, v245
    v_mov_b32 v247, 4
    v_mov_b32 v248, 512
    v_cndmask_b32 v247, v247, v248, s[60:61]
    v_mov_b32 v248, 524
    v_cndmask_b32 v247, v247, v248, s[62:63]
    v_add_u32 v237, v247, v245
    v_mov_b32 v247, 8
    v_mov_b32 v248, 516
    v_cndmask_b32 v247, v247, v248, s[60:61]
    v_add_u32 v247, v247, v245
    v_cndmask_b32 v238, v247, v246, s[62:63]
    v_add_u32 v242, 512, v0
    v_mul_u32_u24 v243, 683, v242
    v_lshrrev_b32 v243, 16, v243
    v_mul_u32_u24 v244, 96, v243
    v_sub_u32 v242, v242, v244
    v_mul_u32_u24 v243, 1168, v243
    v_add_u32 v243, 81920, v243
    v_and_b32 v244, 31, v242
    v_lshrrev_b32 v242, 5, v242
    v_lshl_add_u32 v245, v244, 4, v243
    v_lshl_add_u32 v246, v244, 2, v243
    v_add_u32 v246, 1024, v246
    v_cmp_eq_u32 s[60:61], 1, v242
    v_cmp_eq_u32 s[62:63], 2, v242
    v_mov_b32 v247, 0
    v_mov_b32 v248, 12
    v_cndmask_b32 v247, v247, v248, s[60:61]
    v_mov_b32 v248, 520
    v_cndmask_b32 v247, v247, v248, s[62:63]
    v_add_u32 v239, v247, v245
    v_mov_b32 v247, 4
    v_mov_b32 v248, 512
    v_cndmask_b32 v247, v247, v248, s[60:61]
    v_mov_b32 v248, 524
    v_cndmask_b32 v247, v247, v248, s[62:63]
    v_add_u32 v240, v247, v245
    v_mov_b32 v247, 8
    v_mov_b32 v248, 516
    v_cndmask_b32 v247, v247, v248, s[60:61]
    v_add_u32 v247, v247, v245
    v_cndmask_b32 v241, v247, v246, s[62:63]
    v_and_b32 v15, 7, v1
    v_mul_u32_u24 v10, 1168, v15
    v_lshl_add_u32 v10, v14, 4, v10
    v_add_u32 v10, 81920, v10
    v_mul_u32_u24 v11, 144, v15
    v_add_u32 v11, 98304, v11
    v_lshl_add_u32 v242, v14, 4, v11
    v_bfe_u32 v243, v1, 4, 1
    v_lshl_add_u32 v11, v243, 3, v11
    v_bfe_u32 v243, v1, 3, 1
    v_lshl_add_u32 v11, v243, 2, v11
    v_lshrrev_b32 v244, 5, v1
    v_lshl_add_u32 v11, v244, 1, v11
    s_lshl_b32 s46, s3, 4
    v_add_u32 v11, s46, v11
    v_lshl_add_u32 v243, v243, 5, v14
    v_mul_u32_u24 v243, 9216, v243
    v_lshl_add_u32 v243, v15, 4, v243
    s_mul_i32 s62, s3, 36864
    s_lshl_b32 s46, s50, 7
    s_add_u32 s62, s62, s46
    s_add_u32 s62, s62, 7340032
    v_and_b32 v244, 8, v1
    v_cmp_eq_u32 s[60:61], 0, v244
    s_waitcnt lgkmcnt(0)
    s_add_u32 s40, s40, 1
    s_and_b32 s46, s40, 63
    v_mov_b32 v245, s46
    v_mov_b32 v246, 0xffffffc0
    v_mov_b32 v249, s40
    v_lshlrev_b32 v250, 14, v1
    s_lshl_b32 s63, s50, 7
    s_add_u32 s63, s63, 9699328
    s_cmp_lt_u32 s2, 192
    s_cbranch_scc1 F_L2
    s_lshl_b32 s49, s50, 7
    buffer_load_dwordx4 v[16:19], v4, s[36:39], s49 offen nt
    buffer_load_dwordx4 v[20:23], v4, s[52:55], s49 offen nt
    s_add_u32 s49, s49, 589824
    buffer_load_dwordx4 v[24:27], v4, s[36:39], s49 offen nt
    buffer_load_dwordx4 v[28:31], v4, s[52:55], s49 offen nt
    s_add_u32 s49, s49, 589824
    buffer_load_dwordx4 v[32:35], v4, s[36:39], s49 offen nt
    buffer_load_dwordx4 v[36:39], v4, s[52:55], s49 offen nt
    s_add_u32 s49, s49, 589824
    buffer_load_dwordx4 v[40:43], v4, s[36:39], s49 offen nt
    buffer_load_dwordx4 v[44:47], v4, s[52:55], s49 offen nt
    s_add_u32 s49, s49, 589824
F_L2:
    buffer_load_dwordx4 v[48:51], v4, s[36:39], s49 offen nt
    buffer_load_dwordx4 v[52:55], v4, s[52:55], s49 offen nt
    s_add_u32 s49, s49, 589824
    s_waitcnt vmcnt(8)
    ds_write_b128 v6, v[16:19] offset:0
    ds_write_b128 v6, v[20:23] offset:128
    s_waitcnt lgkmcnt(0)
    s_barrier
    ds_read_b64_tr_b16 v[124:125], v7 offset:0
    ds_read_b64_tr_b16 v[126:127], v7 offset:1088
    ds_read_b64_tr_b16 v[128:129], v7 offset:8704
    ds_read_b64_tr_b16 v[130:131], v7 offset:9792
    buffer_load_dwordx4 v[56:59], v4, s[36:39], s49 offen nt
    buffer_load_dwordx4 v[60:63], v4, s[52:55], s49 offen nt
    s_add_u32 s49, s49, 589824
    s_waitcnt vmcnt(8)
    ds_write_b128 v6, v[24:27] offset:17408
    ds_write_b128 v6, v[28:31] offset:17536
    s_waitcnt lgkmcnt(0)
    s_barrier
    ds_read_b64_tr_b16 v[132:133], v7 offset:17408
    ds_read_b64_tr_b16 v[134:135], v7 offset:18496
    ds_read_b64_tr_b16 v[136:137], v7 offset:26112
    ds_read_b64_tr_b16 v[138:139], v7 offset:27200
    buffer_load_dwordx4 v[64:67], v4, s[36:39], s49 offen nt
    buffer_load_dwordx4 v[68:71], v4, s[52:55], s49 offen nt
    s_add_u32 s49, s49, 589824
    s_waitcnt vmcnt(8)
    ds_write_b128 v6, v[32:35] offset:34816
    ds_write_b128 v6, v[36:39] offset:34944
    s_waitcnt lgkmcnt(0)
    s_barrier
    ds_read_b64_tr_b16 v[140:141], v7 offset:34816
    ds_read_b64_tr_b16 v[142:143], v7 offset:35904
    ds_read_b64_tr_b16 v[144:145], v7 offset:43520
    ds_read_b64_tr_b16 v[146:147], v7 offset:44608
    buffer_load_dwordx4 v[72:75], v4, s[36:39], s49 offen nt
    buffer_load_dwordx4 v[76:79], v4, s[52:55], s49 offen nt
    s_add_u32 s49, s49, 589824
    s_waitcnt vmcnt(8)
    v_add_u32 v6, 52224, v6
    v_add_u32 v7, 52224, v7
    ds_write_b128 v6, v[40:43] offset:0
    ds_write_b128 v6, v[44:47] offset:128
    s_waitcnt lgkmcnt(0)
    s_barrier
    ds_read_b64_tr_b16 v[148:149], v7 offset:0
    ds_read_b64_tr_b16 v[150:151], v7 offset:1088
    ds_read_b64_tr_b16 v[152:153], v7 offset:8704
    ds_read_b64_tr_b16 v[154:155], v7 offset:9792
    buffer_load_dwordx4 v[80:83], v4, s[36:39], s49 offen nt
    buffer_load_dwordx4 v[84:87], v4, s[52:55], s49 offen nt
    s_add_u32 s49, s49, 589824
    s_waitcnt vmcnt(8)
    ds_write_b128 v6, v[48:51] offset:17408
    ds_write_b128 v6, v[52:55] offset:17536
    s_waitcnt lgkmcnt(0)
    s_barrier
    ds_read_b64_tr_b16 v[156:157], v7 offset:17408
    ds_read_b64_tr_b16 v[158:159], v7 offset:18496
    ds_read_b64_tr_b16 v[160:161], v7 offset:26112
    ds_read_b64_tr_b16 v[162:163], v7 offset:27200
    buffer_load_dwordx4 v[88:91], v5, s[56:59], s48 offen offset:0 nt
    buffer_load_dwordx4 v[92:95], v5, s[56:59], s48 offen offset:128 nt
    s_waitcnt vmcnt(8)
    ds_write_b128 v6, v[56:59] offset:34816
    ds_write_b128 v6, v[60:63] offset:34944
    s_waitcnt lgkmcnt(0)
    s_barrier
    ds_read_b64_tr_b16 v[164:165], v7 offset:34816
    ds_read_b64_tr_b16 v[166:167], v7 offset:35904
    ds_read_b64_tr_b16 v[168:169], v7 offset:43520
    ds_read_b64_tr_b16 v[170:171], v7 offset:44608
    buffer_load_dwordx4 v[96:99], v5, s[56:59], s48 offen offset:256 nt
    buffer_load_dwordx4 v[100:103], v5, s[56:59], s48 offen offset:384 nt
    s_waitcnt vmcnt(8)
    v_add_u32 v6, 52224, v6
    v_add_u32 v7, 52224, v7
    ds_write_b128 v6, v[64:67] offset:0
    ds_write_b128 v6, v[68:71] offset:128
    s_waitcnt lgkmcnt(0)
    s_barrier
    ds_read_b64_tr_b16 v[172:173], v7 offset:0
    ds_read_b64_tr_b16 v[174:175], v7 offset:1088
    ds_read_b64_tr_b16 v[176:177], v7 offset:8704
    ds_read_b64_tr_b16 v[178:179], v7 offset:9792
    buffer_load_dwordx4 v[104:107], v5, s[56:59], s48 offen offset:512 nt
    buffer_load_dwordx4 v[108:111], v5, s[56:59], s48 offen offset:640 nt
    s_waitcnt vmcnt(8)
    ds_write_b128 v6, v[72:75] offset:17408
    ds_write_b128 v6, v[76:79] offset:17536
    s_waitcnt lgkmcnt(0)
    s_barrier
    ds_read_b64_tr_b16 v[180:181], v7 offset:17408
    ds_read_b64_tr_b16 v[182:183], v7 offset:18496
    ds_read_b64_tr_b16 v[184:185], v7 offset:26112
    ds_read_b64_tr_b16 v[186:187], v7 offset:27200
    buffer_load_dwordx4 v[112:115], v5, s[56:59], s48 offen offset:768 nt
    buffer_load_dwordx4 v[116:119], v5, s[56:59], s48 offen offset:896 nt
    s_waitcnt vmcnt(8)
    ds_write_b128 v6, v[80:83] offset:34816
    ds_write_b128 v6, v[84:87] offset:34944
    s_waitcnt lgkmcnt(0)
    s_barrier
    ds_read_b64_tr_b16 v[188:189], v7 offset:34816
    ds_read_b64_tr_b16 v[190:191], v7 offset:35904
    ds_read_b64_tr_b16 v[192:193], v7 offset:43520
    ds_read_b64_tr_b16 v[194:195], v7 offset:44608
    buffer_load_dwordx4 v[120:123], v5, s[56:59], s48 offen offset:1024 nt
    s_waitcnt vmcnt(7)
    ds_write_b128 v8, v[88:91] offset:0
    ds_write_b128 v8, v[92:95] offset:128
    s_waitcnt lgkmcnt(0)
    s_barrier
    ds_read_b64_tr_b16 v[196:197], v9 offset:0
    ds_read_b64_tr_b16 v[198:199], v9 offset:4736
    ds_read_b64_tr_b16 v[200:201], v9 offset:38400
    ds_read_b64_tr_b16 v[202:203], v9 offset:43136
    s_waitcnt vmcnt(5)
    ds_write_b128 v8, v[96:99] offset:256
    ds_write_b128 v8, v[100:103] offset:384
    s_waitcnt lgkmcnt(0)
    s_barrier
    ds_read_b64_tr_b16 v[204:205], v9 offset:256
    ds_read_b64_tr_b16 v[206:207], v9 offset:4992
    ds_read_b64_tr_b16 v[208:209], v9 offset:38656
    ds_read_b64_tr_b16 v[210:211], v9 offset:43392
    s_waitcnt vmcnt(3)
    ds_write_b128 v8, v[104:107] offset:512
    ds_write_b128 v8, v[108:111] offset:640
    s_waitcnt lgkmcnt(0)
    s_barrier
    ds_read_b64_tr_b16 v[212:213], v9 offset:512
    ds_read_b64_tr_b16 v[214:215], v9 offset:5248
    ds_read_b64_tr_b16 v[216:217], v9 offset:38912
    ds_read_b64_tr_b16 v[218:219], v9 offset:43648
    s_waitcnt vmcnt(1)
    ds_write_b128 v8, v[112:115] offset:768
    ds_write_b128 v8, v[116:119] offset:896
    s_waitcnt lgkmcnt(0)
    s_barrier
    ds_read_b64_tr_b16 v[220:221], v9 offset:768
    ds_read_b64_tr_b16 v[222:223], v9 offset:5504
    ds_read_b64_tr_b16 v[224:225], v9 offset:39168
    ds_read_b64_tr_b16 v[226:227], v9 offset:43904
    s_waitcnt vmcnt(0)
    ds_write_b128 v8, v[120:123] offset:1024
    s_waitcnt lgkmcnt(0)
    s_barrier
    ds_read_b64_tr_b16 v[228:229], v9 offset:1024
    ds_read_b64_tr_b16 v[230:231], v9 offset:5760
    ds_read_b64_tr_b16 v[232:233], v9 offset:39424
    ds_read_b64_tr_b16 v[234:235], v9 offset:44160
    s_getreg_b32 s48, hwreg(HW_REG_XCC_ID, 0, 3)
    s_mul_i32 s48, s48, 16384
    s_add_u32 s48, s48, 9830400
    s_add_u32 s49, s48, 8192
    s_waitcnt lgkmcnt(0)
    s_cmp_ge_u32 s3, 4
    s_cbranch_scc1 F_P1
    buffer_load_dwordx4 v[16:19], v3, s[32:35], s48 offen sc1
    buffer_load_dwordx4 v[20:23], v3, s[32:35], s49 offen sc1
    s_mov_b32 s47, 0
PL26:
    s_waitcnt vmcnt(0)
    v_cmp_ne_u32 vcc, s40, v19
    v_cmp_ne_u32 s[52:53], s40, v23
    s_or_b64 vcc, vcc, s[52:53]
    s_cbranch_vccz PD27
    s_add_u32 s47, s47, 1
    s_cmp_ge_u32 s47, 65536
    s_cbranch_scc1 PD27
    s_sleep 1
    buffer_load_dwordx4 v[16:19], v3, s[32:35], s48 offen sc1
    buffer_load_dwordx4 v[20:23], v3, s[32:35], s49 offen sc1
    s_branch PL26
PD27:
    ds_write_b32 v239, v20
    ds_write_b32 v240, v21
    ds_write_b32 v241, v22
    s_branch F_P2
F_P1:
    buffer_load_dwordx4 v[16:19], v3, s[32:35], s48 offen sc1
    s_mov_b32 s47, 0
PL28:
    s_waitcnt vmcnt(0)
    v_cmp_ne_u32 vcc, s40, v19
    s_cbranch_vccz PD29
    s_add_u32 s47, s47, 1
    s_cmp_ge_u32 s47, 65536
    s_cbranch_scc1 PD29
    s_sleep 1
    buffer_load_dwordx4 v[16:19], v3, s[32:35], s48 offen sc1
    s_branch PL28
PD29:
F_P2:
    ds_write_b32 v236, v16
    ds_write_b32 v237, v17
    ds_write_b32 v238, v18
    s_waitcnt lgkmcnt(0)
    s_barrier
    ds_read_b128 v[32:35], v10 offset:0
    ds_read_b128 v[36:39], v10 offset:64
    ds_read_b128 v[40:43], v10 offset:128
    ds_read_b128 v[44:47], v10 offset:192
    s_cmp_lg_u32 s3, 7
    s_cbranch_scc1 FH30
    s_mov_b64 exec, 0xff
    buffer_store_dword v249, v250, s[32:35], s63 offen sc1
    s_mov_b64 exec, -1
FH30:
    ds_read_b128 v[48:51], v10 offset:256
    ds_read_b128 v[52:55], v10 offset:320
    ds_read_b128 v[56:59], v10 offset:384
    s_waitcnt lgkmcnt(6)
    v_mfma_f32_16x16x32_bf16 v[24:27], v[124:127], v[32:35], 0
    ds_read_b128 v[60:63], v10 offset:448
    s_waitcnt lgkmcnt(6)
    v_mfma_f32_16x16x32_bf16 v[24:27], v[128:131], v[36:39], v[24:27]
    ds_read_b128 v[64:67], v10 offset:512
    s_waitcnt lgkmcnt(6)
    v_mfma_f32_16x16x32_bf16 v[24:27], v[132:135], v[40:43], v[24:27]
    ds_read_b128 v[68:71], v10 offset:576
    s_waitcnt lgkmcnt(6)
    v_mfma_f32_16x16x32_bf16 v[24:27], v[136:139], v[44:47], v[24:27]
    ds_read_b128 v[72:75], v10 offset:640
    s_waitcnt lgkmcnt(6)
    v_mfma_f32_16x16x32_bf16 v[24:27], v[140:143], v[48:51], v[24:27]
    ds_read_b128 v[76:79], v10 offset:704
    s_waitcnt lgkmcnt(6)
    v_mfma_f32_16x16x32_bf16 v[24:27], v[144:147], v[52:55], v[24:27]
    ds_read_b128 v[80:83], v10 offset:768
    s_waitcnt lgkmcnt(6)
    v_mfma_f32_16x16x32_bf16 v[24:27], v[148:151], v[56:59], v[24:27]
    ds_read_b128 v[84:87], v10 offset:832
    s_waitcnt lgkmcnt(6)
    v_mfma_f32_16x16x32_bf16 v[24:27], v[152:155], v[60:63], v[24:27]
    ds_read_b128 v[88:91], v10 offset:896
    s_waitcnt lgkmcnt(6)
    v_mfma_f32_16x16x32_bf16 v[24:27], v[156:159], v[64:67], v[24:27]
    ds_read_b128 v[92:95], v10 offset:960
    s_waitcnt lgkmcnt(6)
    v_mfma_f32_16x16x32_bf16 v[24:27], v[160:163], v[68:71], v[24:27]
    ds_read_b128 v[96:99], v10 offset:1024
    s_waitcnt lgkmcnt(6)
    v_mfma_f32_16x16x32_bf16 v[24:27], v[164:167], v[72:75], v[24:27]
    ds_read_b128 v[100:103], v10 offset:1088
    s_waitcnt lgkmcnt(6)
    v_mfma_f32_16x16x32_bf16 v[24:27], v[168:171], v[76:79], v[24:27]
    s_waitcnt lgkmcnt(5)
    v_mfma_f32_16x16x32_bf16 v[24:27], v[172:175], v[80:83], v[24:27]
    s_waitcnt lgkmcnt(4)
    v_mfma_f32_16x16x32_bf16 v[24:27], v[176:179], v[84:87], v[24:27]
    s_waitcnt lgkmcnt(3)
    v_mfma_f32_16x16x32_bf16 v[24:27], v[180:183], v[88:91], v[24:27]
    s_waitcnt lgkmcnt(2)
    v_mfma_f32_16x16x32_bf16 v[24:27], v[184:187], v[92:95], v[24:27]
    s_waitcnt lgkmcnt(1)
    v_mfma_f32_16x16x32_bf16 v[24:27], v[188:191], v[96:99], v[24:27]
    s_waitcnt lgkmcnt(0)
    v_mfma_f32_16x16x32_bf16 v[24:27], v[192:195], v[100:103], v[24:27]
    s_nop 7
    v_cndmask_b32 v28, v26, v24, s[60:61]
    v_cndmask_b32 v29, v27, v25, s[60:61]
    v_cvt_pk_bf16_f32 v28, 0, v28
    v_cvt_pk_bf16_f32 v29, 0, v29
    s_nop 1
    v_permlane32_swap_b32 v28, v29
    v_mul_f32 v30, 0xbfb8aa3b, v28
    v_exp_f32 v30, v30
    s_nop 0
    v_add_f32 v30, 1.0, v30
    v_rcp_f32 v30, v30
    s_nop 0
    v_mul_f32 v28, v28, v30
    v_cvt_pk_bf16_f32 v28, 0, v28
    v_mul_f32 v28, v28, v29
    v_cvt_pk_bf16_f32 v28, v28, v28
    ds_write_b16 v11, v28
    s_waitcnt lgkmcnt(0)
    s_barrier
    ds_read_b128 v[16:19], v242
    ds_read_b128 v[20:23], v242 offset:64
    s_waitcnt lgkmcnt(1)
    v_mfma_f32_16x16x32_bf16 v[32:35], v[196:199], v[16:19], 0
    v_mfma_f32_16x16x32_bf16 v[36:39], v[204:207], v[16:19], 0
    v_mfma_f32_16x16x32_bf16 v[40:43], v[212:215], v[16:19], 0
    v_mfma_f32_16x16x32_bf16 v[44:47], v[220:223], v[16:19], 0
    v_mfma_f32_16x16x32_bf16 v[48:51], v[228:231], v[16:19], 0
    s_waitcnt lgkmcnt(0)
    v_mfma_f32_16x16x32_bf16 v[32:35], v[200:203], v[20:23], v[32:35]
    v_mfma_f32_16x16x32_bf16 v[36:39], v[208:211], v[20:23], v[36:39]
    v_mfma_f32_16x16x32_bf16 v[40:43], v[216:219], v[20:23], v[40:43]
    v_mfma_f32_16x16x32_bf16 v[44:47], v[224:227], v[20:23], v[44:47]
    v_mfma_f32_16x16x32_bf16 v[48:51], v[232:235], v[20:23], v[48:51]
    s_nop 4
    v_cndmask_b32 v32, v36, v32, s[60:61]
    v_cndmask_b32 v33, v37, v33, s[60:61]
    v_cndmask_b32 v34, v38, v34, s[60:61]
    v_cndmask_b32 v35, v39, v35, s[60:61]
    v_and_or_b32 v32, v32, v246, v245
    v_and_or_b32 v33, v33, v246, v245
    v_and_or_b32 v34, v34, v246, v245
    v_and_or_b32 v35, v35, v246, v245
    buffer_store_dwordx4 v[32:35], v243, s[32:35], s62 offen sc1
    s_add_u32 s62, s62, 589824
    v_cndmask_b32 v40, v44, v40, s[60:61]
    v_cndmask_b32 v41, v45, v41, s[60:61]
    v_cndmask_b32 v42, v46, v42, s[60:61]
    v_cndmask_b32 v43, v47, v43, s[60:61]
    v_and_or_b32 v40, v40, v246, v245
    v_and_or_b32 v41, v41, v246, v245
    v_and_or_b32 v42, v42, v246, v245
    v_and_or_b32 v43, v43, v246, v245
    buffer_store_dwordx4 v[40:43], v243, s[32:35], s62 offen sc1
    s_add_u32 s62, s62, 589824
    s_cmp_ge_u32 s3, 4
    s_cbranch_scc1 DUMP
    v_and_or_b32 v48, v48, v246, v245
    v_and_or_b32 v49, v49, v246, v245
    v_and_or_b32 v50, v50, v246, v245
    v_and_or_b32 v51, v51, v246, v245
    s_mov_b64 exec, s[60:61]
    buffer_store_dwordx4 v[48:51], v243, s[32:35], s62 offen sc1
DUMP:
END:
    s_endpgm
.p2align 7
.type TBL,@object
TBL:
.long 0x0, 0x0, 0x0, 0x0, 0x0, 0x0, 0x0, 0x0
.long 0x0, 0x0, 0x0, 0x0, 0x0, 0x0, 0x0, 0x0
.long 0x0, 0x0, 0x0, 0x0, 0x0, 0x0, 0x0, 0x0
.long 0x0, 0x0, 0x0, 0x0, 0x0, 0x0, 0x0, 0x0
.long 0x0, 0x0, 0x0, 0x0, 0x0, 0x0, 0x0, 0x0
.long 0x0, 0x0, 0x0, 0x0, 0x0, 0x0, 0x0, 0x0
.long 0x0, 0x0, 0x0, 0x0, 0x0, 0x0, 0x0, 0x0
.long 0x0, 0x0, 0x0, 0x0, 0x0, 0x0, 0x0, 0x0
.long 0x0, 0x3c000000, 0x3c003c00, 0x0, 0x0, 0x0, 0x3c003c00, 0x3c00
.long 0x0, 0x0, 0x3c000000, 0x3c003c00, 0x0, 0x0, 0x0, 0x3c003c00
.long 0x0, 0x0, 0x0, 0x3c000000, 0x0, 0x0, 0x0, 0x0
.long 0x0, 0x0, 0x0, 0x0, 0x0, 0x0, 0x0, 0x0
.long 0x0, 0x0, 0x0, 0x0, 0x0, 0x0, 0x0, 0x0
.long 0x0, 0x0, 0x0, 0x0, 0x0, 0x0, 0x0, 0x0
.long 0x0, 0x0, 0x0, 0x0, 0x0, 0x0, 0x0, 0x0
.long 0x0, 0x0, 0x0, 0x0, 0x0, 0x0, 0x0, 0x0
.long 0x0, 0x0, 0x0, 0x0, 0x0, 0x0, 0x0, 0x0
.long 0x0, 0x0, 0x0, 0x0, 0x3c00, 0x0, 0x0, 0x0
.long 0x3c003c00, 0x0, 0x0, 0x0, 0x3c003c00, 0x3c00, 0x0, 0x0
.long 0x3c000000, 0x3c003c00, 0x0, 0x0, 0x0, 0x3c003c00, 0x3c00, 0x0
.long 0x0, 0x3c000000, 0x3c003c00, 0x0, 0x0, 0x0, 0x3c003c00, 0x3c00
.long 0x0, 0x0, 0x3c000000, 0x3c003c00, 0x0, 0x0, 0x0, 0x3c003c00
.long 0x0, 0x0, 0x0, 0x3c000000, 0x0, 0x0, 0x0, 0x0
.long 0x0, 0x0, 0x0, 0x0, 0x0, 0x0, 0x0, 0x0
.long 0x0, 0x0, 0x0, 0x0, 0x0, 0x0, 0x0, 0x0
.long 0x0, 0x0, 0x0, 0x0, 0x0, 0x0, 0x0, 0x0
.long 0x0, 0x0, 0x0, 0x0, 0x0, 0x0, 0x0, 0x0
.long 0x0, 0x0, 0x0, 0x0, 0x0, 0x0, 0x0, 0x0
.long 0x0, 0x0, 0x0, 0x0, 0x0, 0x0, 0x0, 0x0
.long 0x0, 0x0, 0x0, 0x0, 0x3c00, 0x0, 0x0, 0x0
.long 0x3c003c00, 0x0, 0x0, 0x0, 0x3c003c00, 0x3c00, 0x0, 0x0
.long 0x3c000000, 0x3c003c00, 0x0, 0x0, 0x0, 0x3c003c00, 0x3c00, 0x0
.long 0x0, 0x0, 0x0, 0x3c003c00, 0x0, 0x0, 0x0, 0x3c000000
.long 0x0, 0x0, 0x0, 0x0, 0x0, 0x0, 0x0, 0x0
.long 0x0, 0x0, 0x0, 0x0, 0x0, 0x0, 0x0, 0x0
.long 0x0, 0x0, 0x0, 0x0, 0x0, 0x0, 0x0, 0x0
.long 0x0, 0x0, 0x0, 0x0, 0x0, 0x0, 0x0, 0x0
.long 0x0, 0x0, 0x0, 0x0, 0x0, 0x0, 0x0, 0x0
.long 0x0, 0x0, 0x0, 0x0, 0x0, 0x0, 0x0, 0x0
.long 0x0, 0x0, 0x0, 0x0, 0x0, 0x0, 0x0, 0x0
.long 0x3c003c00, 0x3c00, 0x0, 0x0, 0x3c003c00, 0x3c003c00, 0x0, 0x0
.long 0x3c003c00, 0x3c003c00, 0x3c00, 0x0, 0x3c000000, 0x3c003c00, 0x3c003c00, 0x0
.long 0x0, 0x3c003c00, 0x3c003c00, 0x3c00, 0x0, 0x3c000000, 0x3c003c00, 0x3c003c00
.long 0x0, 0x0, 0x3c003c00, 0x3c003c00, 0x0, 0x0, 0x3c000000, 0x3c003c00
.long 0x0, 0x0, 0x0, 0x3c003c00, 0x0, 0x0, 0x0, 0x3c000000
.long 0x0, 0x0, 0x0, 0x0, 0x0, 0x0, 0x0, 0x0
.long 0x0, 0x0, 0x0, 0x0, 0x0, 0x0, 0x0, 0x0
.long 0x0, 0x0, 0x0, 0x0, 0x0, 0x0, 0x0, 0x0
.long 0x0, 0x0, 0x0, 0x0, 0x0, 0x0, 0x0, 0x0
.long 0x0, 0x0, 0x0, 0x0, 0x0, 0x0, 0x0, 0x0
.long 0x0, 0x0, 0x0, 0x0, 0x0, 0x0, 0x0, 0x0
.long 0x3c00, 0x0, 0x0, 0x0, 0x3c003c00, 0x0, 0x0, 0x0
.long 0x3c003c00, 0x3c00, 0x0, 0x0, 0x3c003c00, 0x3c003c00, 0x0, 0x0
.long 0x3c003c00, 0x3c003c00, 0x3c00, 0x0, 0x3c000000, 0x3c003c00, 0x3c003c00, 0x0
.long 0x0, 0x3c003c00, 0x3c003c00, 0x3c00, 0x0, 0x3c000000, 0x3c003c00, 0x3c003c00
.long 0x0, 0x0, 0x3c003c00, 0x3c003c00, 0x0, 0x0, 0x3c000000, 0x3c003c00
.long 0x0, 0x0, 0x0, 0x0, 0x0, 0x0, 0x0, 0x0
.long 0x0, 0x0, 0x0, 0x0, 0x0, 0x0, 0x0, 0x0
.long 0x0, 0x0, 0x0, 0x0, 0x0, 0x0, 0x0, 0x0
.long 0x0, 0x0, 0x0, 0x0, 0x0, 0x0, 0x0, 0x0
.long 0x0, 0x0, 0x0, 0x0, 0x0, 0x0, 0x0, 0x0
.long 0x0, 0x0, 0x0, 0x0, 0x0, 0x0, 0x0, 0x0
.long 0x0, 0x0, 0x0, 0x0, 0x0, 0x0, 0x0, 0x0
.long 0x3c00, 0x0, 0x0, 0x0, 0x3c003c00, 0x0, 0x0, 0x0
.long 0x0, 0x3c000000, 0x3c003c00, 0x0, 0x0, 0x0, 0x3c003c00, 0x3c00
.long 0x0, 0x0, 0x3c000000, 0x3c003c00, 0x0, 0x0, 0x0, 0x3c003c00
.long 0x0, 0x0, 0x0, 0x3c000000, 0x0, 0x0, 0x0, 0x0
.long 0x0, 0x0, 0x0, 0x0, 0x0, 0x0, 0x0, 0x0
.long 0x0, 0x0, 0x0, 0x0, 0x0, 0x0, 0x0, 0x0
.long 0x0, 0x0, 0x0, 0x0, 0x0, 0x0, 0x0, 0x0
.long 0x0, 0x0, 0x0, 0x0, 0x0, 0x0, 0x0, 0x0
.long 0x0, 0x0, 0x0, 0x0, 0x0, 0x0, 0x0, 0x0
.long 0x0, 0x0, 0x0, 0x0, 0x0, 0x0, 0x0, 0x0
.long 0x0, 0x0, 0x0, 0x0, 0x3c00, 0x0, 0x0, 0x0
.long 0x3c003c00, 0x0, 0x0, 0x0, 0x3c003c00, 0x3c00, 0x0, 0x0
.long 0x3c000000, 0x3c003c00, 0x0, 0x0, 0x0, 0x3c003c00, 0x3c00, 0x0
.long 0x0, 0x3c000000, 0x3c003c00, 0x0, 0x0, 0x0, 0x3c003c00, 0x3c00
.long 0x0, 0x0, 0x3c000000, 0x3c003c00, 0x0, 0x0, 0x0, 0x3c003c00
.long 0x0, 0x0, 0x0, 0x3c000000, 0x0, 0x0, 0x0, 0x0
.long 0x0, 0x0, 0x0, 0x0, 0x0, 0x0, 0x0, 0x0
.long 0x0, 0x0, 0x0, 0x0, 0x0, 0x0, 0x0, 0x0
.long 0x0, 0x0, 0x0, 0x0, 0x0, 0x0, 0x0, 0x0
.long 0x0, 0x0, 0x0, 0x0, 0x0, 0x0, 0x0, 0x0
.long 0x0, 0x0, 0x0, 0x0, 0x0, 0x0, 0x0, 0x0
.long 0x0, 0x0, 0x0, 0x0, 0x0, 0x0, 0x0, 0x0
.long 0x0, 0x0, 0x0, 0x0, 0x3c00, 0x0, 0x0, 0x0
.long 0x3c003c00, 0x0, 0x0, 0x0, 0x3c003c00, 0x3c00, 0x0, 0x0
.long 0x3c000000, 0x3c003c00, 0x0, 0x0, 0x0, 0x3c003c00, 0x3c00, 0x0
.long 0x0, 0x0, 0x0, 0x0, 0x0, 0x0, 0x0, 0x0
.long 0x0, 0x0, 0x0, 0x0, 0x0, 0x0, 0x0, 0x0
.long 0x0, 0x0, 0x0, 0x0, 0x0, 0x0, 0x0, 0x0
.long 0x0, 0x0, 0x0, 0x0, 0x0, 0x0, 0x0, 0x0
.long 0x0, 0x0, 0x0, 0x0, 0x0, 0x0, 0x0, 0x0
.long 0x0, 0x0, 0x0, 0x0, 0x0, 0x0, 0x0, 0x0
.long 0x0, 0x0, 0x0, 0x0, 0x0, 0x0, 0x0, 0x0
.long 0x0, 0x0, 0x0, 0x0, 0x0, 0x0, 0x0, 0x0
.long 0x0, 0x0, 0x0, 0x3c003c00, 0x0, 0x0, 0x0, 0x3c000000
.long 0x0, 0x0, 0x0, 0x0, 0x0, 0x0, 0x0, 0x0
.long 0x0, 0x0, 0x0, 0x0, 0x0, 0x0, 0x0, 0x0
.long 0x0, 0x0, 0x0, 0x0, 0x0, 0x0, 0x0, 0x0
.long 0x0, 0x0, 0x0, 0x0, 0x0, 0x0, 0x0, 0x0
.long 0x0, 0x0, 0x0, 0x0, 0x0, 0x0, 0x0, 0x0
.long 0x0, 0x0, 0x0, 0x0, 0x0, 0x0, 0x0, 0x0
.long 0x0, 0x0, 0x0, 0x0, 0x0, 0x0, 0x0, 0x0
.long 0x3c003c00, 0x3c00, 0x0, 0x0, 0x3c003c00, 0x3c003c00, 0x0, 0x0
.long 0x3c003c00, 0x3c003c00, 0x3c00, 0x0, 0x3c000000, 0x3c003c00, 0x3c003c00, 0x0
.long 0x0, 0x3c003c00, 0x3c003c00, 0x3c00, 0x0, 0x3c000000, 0x3c003c00, 0x3c003c00
.long 0x0, 0x0, 0x3c003c00, 0x3c003c00, 0x0, 0x0, 0x3c000000, 0x3c003c00
.long 0x0, 0x0, 0x0, 0x3c003c00, 0x0, 0x0, 0x0, 0x3c000000
.long 0x0, 0x0, 0x0, 0x0, 0x0, 0x0, 0x0, 0x0
.long 0x0, 0x0, 0x0, 0x0, 0x0, 0x0, 0x0, 0x0
.long 0x0, 0x0, 0x0, 0x0, 0x0, 0x0, 0x0, 0x0
.long 0x0, 0x0, 0x0, 0x0, 0x0, 0x0, 0x0, 0x0
.long 0x0, 0x0, 0x0, 0x0, 0x0, 0x0, 0x0, 0x0
.long 0x0, 0x0, 0x0, 0x0, 0x0, 0x0, 0x0, 0x0
.long 0x3c00, 0x0, 0x0, 0x0, 0x3c003c00, 0x0, 0x0, 0x0
.long 0x3c003c00, 0x3c00, 0x0, 0x0, 0x3c003c00, 0x3c003c00, 0x0, 0x0
.long 0x3c003c00, 0x3c003c00, 0x3c00, 0x0, 0x3c000000, 0x3c003c00, 0x3c003c00, 0x0
.long 0x0, 0x3c003c00, 0x3c003c00, 0x3c00, 0x0, 0x3c000000, 0x3c003c00, 0x3c003c00
.long 0x0, 0x0, 0x3c003c00, 0x3c003c00, 0x0, 0x0, 0x3c000000, 0x3c003c00
.long 0x0, 0x0, 0x0, 0x0, 0x0, 0x0, 0x0, 0x0
.long 0x0, 0x0, 0x0, 0x0, 0x0, 0x0, 0x0, 0x0
.long 0x0, 0x0, 0x0, 0x0, 0x0, 0x0, 0x0, 0x0
.long 0x0, 0x0, 0x0, 0x0, 0x0, 0x0, 0x0, 0x0
.long 0x0, 0x0, 0x0, 0x0, 0x0, 0x0, 0x0, 0x0
.long 0x0, 0x0, 0x0, 0x0, 0x0, 0x0, 0x0, 0x0
.long 0x0, 0x0, 0x0, 0x0, 0x0, 0x0, 0x0, 0x0
.long 0x3c00, 0x0, 0x0, 0x0, 0x3c003c00, 0x0, 0x0, 0x0
.long 0x0, 0x0, 0x3c000000, 0x3c003c00, 0x0, 0x0, 0x0, 0x3c003c00
.long 0x0, 0x0, 0x0, 0x3c000000, 0x0, 0x0, 0x0, 0x0
.long 0x0, 0x0, 0x0, 0x0, 0x0, 0x0, 0x0, 0x0
.long 0x0, 0x0, 0x0, 0x0, 0x0, 0x0, 0x0, 0x0
.long 0x0, 0x0, 0x0, 0x0, 0x0, 0x0, 0x0, 0x0
.long 0x0, 0x0, 0x0, 0x0, 0x0, 0x0, 0x0, 0x0
.long 0x0, 0x0, 0x0, 0x0, 0x0, 0x0, 0x0, 0x0
.long 0x0, 0x0, 0x0, 0x0, 0x0, 0x0, 0x0, 0x0
.long 0x3c003c00, 0x3c003c00, 0x0, 0x0, 0x3c003c00, 0x3c003c00, 0x3c00, 0x0
.long 0x3c003c00, 0x3c003c00, 0x3c003c00, 0x0, 0x3c003c00, 0x3c003c00, 0x3c003c00, 0x3c00
.long 0x3c000000, 0x3c003c00, 0x3c003c00, 0x3c003c00, 0x0, 0x3c003c00, 0x3c003c00, 0x3c003c00
.long 0x0, 0x3c000000, 0x3c003c00, 0x3c003c00, 0x0, 0x0, 0x3c003c00, 0x3c003c00
.long 0x0, 0x0, 0x3c000000, 0x3c003c00, 0x0, 0x0, 0x0, 0x3c003c00
.long 0x0, 0x0, 0x0, 0x3c000000, 0x0, 0x0, 0x0, 0x0
.long 0x0, 0x0, 0x0, 0x0, 0x0, 0x0, 0x0, 0x0
.long 0x0, 0x0, 0x0, 0x0, 0x0, 0x0, 0x0, 0x0
.long 0x0, 0x0, 0x0, 0x0, 0x0, 0x0, 0x0, 0x0
.long 0x0, 0x0, 0x0, 0x0, 0x0, 0x0, 0x0, 0x0
.long 0x0, 0x0, 0x0, 0x0, 0x3c00, 0x0, 0x0, 0x0
.long 0x3c003c00, 0x0, 0x0, 0x0, 0x3c003c00, 0x3c00, 0x0, 0x0
.long 0x3c003c00, 0x3c003c00, 0x0, 0x0, 0x3c003c00, 0x3c003c00, 0x3c00, 0x0
.long 0x3c003c00, 0x3c003c00, 0x3c003c00, 0x0, 0x3c003c00, 0x3c003c00, 0x3c003c00, 0x3c00
.long 0x3c000000, 0x3c003c00, 0x3c003c00, 0x3c003c00, 0x0, 0x3c003c00, 0x3c003c00, 0x3c003c00
.long 0x0, 0x3c000000, 0x3c003c00, 0x3c003c00, 0x0, 0x0, 0x3c003c00, 0x3c003c00
.long 0x0, 0x0, 0x0, 0x0, 0x0, 0x0, 0x0, 0x0
.long 0x0, 0x0, 0x0, 0x0, 0x0, 0x0, 0x0, 0x0
.long 0x0, 0x0, 0x0, 0x0, 0x0, 0x0, 0x0, 0x0
.long 0x0, 0x0, 0x0, 0x0, 0x0, 0x0, 0x0, 0x0
.long 0x0, 0x0, 0x0, 0x0, 0x0, 0x0, 0x0, 0x0
.long 0x0, 0x0, 0x0, 0x0, 0x0, 0x0, 0x0, 0x0
.long 0x0, 0x0, 0x0, 0x0, 0x3c00, 0x0, 0x0, 0x0
.long 0x3c003c00, 0x0, 0x0, 0x0, 0x3c003c00, 0x3c00, 0x0, 0x0
.long 0x0, 0x0, 0x3c003c00, 0x3c003c00, 0x0, 0x0, 0x3c000000, 0x3c003c00
.long 0x0, 0x0, 0x0, 0x3c003c00, 0x0, 0x0, 0x0, 0x3c000000
.long 0x0, 0x0, 0x0, 0x0, 0x0, 0x0, 0x0, 0x0
.long 0x0, 0x0, 0x0, 0x0, 0x0, 0x0, 0x0, 0x0
.long 0x0, 0x0, 0x0, 0x0, 0x0, 0x0, 0x0, 0x0
.long 0x0, 0x0, 0x0, 0x0, 0x0, 0x0, 0x0, 0x0
.long 0x0, 0x0, 0x0, 0x0, 0x0, 0x0, 0x0, 0x0
.long 0x0, 0x0, 0x0, 0x0, 0x0, 0x0, 0x0, 0x0
.long 0x3c003c00, 0x3c003c00, 0x3c00, 0x0, 0x3c003c00, 0x3c003c00, 0x3c003c00, 0x0
.long 0x3c003c00, 0x3c003c00, 0x3c003c00, 0x3c00, 0x3c003c00, 0x3c003c00, 0x3c003c00, 0x3c003c00
.long 0x3c003c00, 0x3c003c00, 0x3c003c00, 0x3c003c00, 0x3c000000, 0x3c003c00, 0x3c003c00, 0x3c003c00
.long 0x0, 0x3c003c00, 0x3c003c00, 0x3c003c00, 0x0, 0x3c000000, 0x3c003c00, 0x3c003c00
.long 0x0, 0x0, 0x3c003c00, 0x3c003c00, 0x0, 0x0, 0x3c000000, 0x3c003c00
.long 0x0, 0x0, 0x0, 0x3c003c00, 0x0, 0x0, 0x0, 0x3c000000
.long 0x0, 0x0, 0x0, 0x0, 0x0, 0x0, 0x0, 0x0
.long 0x0, 0x0, 0x0, 0x0, 0x0, 0x0, 0x0, 0x0
.long 0x0, 0x0, 0x0, 0x0, 0x0, 0x0, 0x0, 0x0
.long 0x0, 0x0, 0x0, 0x0, 0x0, 0x0, 0x0, 0x0
.long 0x3c00, 0x0, 0x0, 0x0, 0x3c003c00, 0x0, 0x0, 0x0
.long 0x3c003c00, 0x3c00, 0x0, 0x0, 0x3c003c00, 0x3c003c00, 0x0, 0x0
.long 0x3c003c00, 0x3c003c00, 0x3c00, 0x0, 0x3c003c00, 0x3c003c00, 0x3c003c00, 0x0
.long 0x3c003c00, 0x3c003c00, 0x3c003c00, 0x3c00, 0x3c003c00, 0x3c003c00, 0x3c003c00, 0x3c003c00
.long 0x3c003c00, 0x3c003c00, 0x3c003c00, 0x3c003c00, 0x3c000000, 0x3c003c00, 0x3c003c00, 0x3c003c00
.long 0x0, 0x3c003c00, 0x3c003c00, 0x3c003c00, 0x0, 0x3c000000, 0x3c003c00, 0x3c003c00
.long 0x0, 0x0, 0x0, 0x0, 0x0, 0x0, 0x0, 0x0
.long 0x0, 0x0, 0x0, 0x0, 0x0, 0x0, 0x0, 0x0
.long 0x0, 0x0, 0x0, 0x0, 0x0, 0x0, 0x0, 0x0
.long 0x0, 0x0, 0x0, 0x0, 0x0, 0x0, 0x0, 0x0
.long 0x0, 0x0, 0x0, 0x0, 0x0, 0x0, 0x0, 0x0
.long 0x0, 0x0, 0x0, 0x0, 0x0, 0x0, 0x0, 0x0
.long 0x3c00, 0x0, 0x0, 0x0, 0x3c003c00, 0x0, 0x0, 0x0
.long 0x3c003c00, 0x3c00, 0x0, 0x0, 0x3c003c00, 0x3c003c00, 0x0, 0x0
.long 0x0, 0x0, 0x0, 0x0, 0x0, 0x0, 0x0, 0x0
.long 0x0, 0x0, 0x0, 0x0, 0x0, 0x0, 0x0, 0x0
.long 0x0, 0x0, 0x0, 0x0, 0x0, 0x0, 0x0, 0x0
.long 0x0, 0x0, 0x0, 0x0, 0x0, 0x0, 0x0, 0x0
.long 0x0, 0x0, 0x0, 0x0, 0x0, 0x0, 0x0, 0x0
.long 0x0, 0x0, 0x0, 0x0, 0x0, 0x0, 0x0, 0x0
.long 0x0, 0x0, 0x0, 0x0, 0x0, 0x0, 0x0, 0x0
.long 0x0, 0x0, 0x0, 0x0, 0x0, 0x0, 0x0, 0x0
.long 0x0, 0x0, 0xffffffff, 0x0, 0x0, 0x0, 0xffff0000, 0xffff
.long 0x0, 0x0, 0x0, 0xffffffff, 0x0, 0x0, 0x0, 0xffff0000
.long 0x0, 0x0, 0x0, 0x0, 0x0, 0x0, 0x0, 0x0
.long 0x0, 0x0, 0x0, 0x0, 0x0, 0x0, 0x0, 0x0
.long 0x0, 0x0, 0x0, 0x0, 0x0, 0x0, 0x0, 0x0
.long 0x0, 0x0, 0x0, 0x0, 0x0, 0x0, 0x0, 0x0
.long 0x0, 0x0, 0x0, 0x0, 0x0, 0x0, 0x0, 0x0
.long 0x0, 0x0, 0x0, 0x0, 0x0, 0x0, 0x0, 0x0
.long 0x0, 0x0, 0x0, 0x0, 0x0, 0x0, 0x0, 0x0
.long 0x0, 0x0, 0x0, 0x0, 0xffff, 0x0, 0x0, 0x0
.long 0xffffffff, 0x0, 0x0, 0x0, 0xffff0000, 0xffff, 0x0, 0x0
.long 0x0, 0xffffffff, 0x0, 0x0, 0x0, 0xffff0000, 0xffff, 0x0
.long 0x0, 0x0, 0xffffffff, 0x0, 0x0, 0x0, 0xffff0000, 0xffff
.long 0x0, 0x0, 0x0, 0xffffffff, 0x0, 0x0, 0x0, 0xffff0000
.long 0x0, 0x0, 0x0, 0x0, 0x0, 0x0, 0x0, 0x0
.long 0x0, 0x0, 0x0, 0x0, 0x0, 0x0, 0x0, 0x0
.long 0x0, 0x0, 0x0, 0x0, 0x0, 0x0, 0x0, 0x0
.long 0x0, 0x0, 0x0, 0x0, 0x0, 0x0, 0x0, 0x0
.long 0x0, 0x0, 0x0, 0x0, 0x0, 0x0, 0x0, 0x0
.long 0x0, 0x0, 0x0, 0x0, 0x0, 0x0, 0x0, 0x0
.long 0x0, 0x0, 0x0, 0x0, 0x0, 0x0, 0x0, 0x0
.long 0x0, 0x0, 0x0, 0x0, 0xffff, 0x0, 0x0, 0x0
.long 0xffffffff, 0x0, 0x0, 0x0, 0xffff0000, 0xffff, 0x0, 0x0
.long 0x0, 0xffffffff, 0x0, 0x0, 0x0, 0xffff0000, 0xffff, 0x0
.long 0x878, 0x438, 0x230, 0x238, 0x858, 0x418, 0x210, 0x218
.long 0x838, 0x3f8, 0x1f0, 0x1f8, 0x818, 0x3d8, 0x1d0, 0x1d8
.long 0x7f8, 0x3b8, 0x1b0, 0x1b8, 0x7d8, 0x398, 0x190, 0x198
.long 0x7b8, 0x378, 0x170, 0x178, 0x798, 0x358, 0x150, 0x158
.long 0x778, 0x338, 0x130, 0x138, 0x758, 0x318, 0x110, 0x118
.long 0x738, 0x2f8, 0xf0, 0xf8, 0x718, 0x2d8, 0xd0, 0xd8
.long 0x6f8, 0x2b8, 0xb0, 0xb8, 0x6d8, 0x298, 0x90, 0x98
.long 0x6b8, 0x278, 0x70, 0x78, 0x698, 0x258, 0x50, 0x58
.long 0x868, 0x428, 0x220, 0x228, 0x848, 0x408, 0x200, 0x208
.long 0x828, 0x3e8, 0x1e0, 0x1e8, 0x808, 0x3c8, 0x1c0, 0x1c8
.long 0x7e8, 0x3a8, 0x1a0, 0x1a8, 0x7c8, 0x388, 0x180, 0x188
.long 0x7a8, 0x368, 0x160, 0x168, 0x788, 0x348, 0x140, 0x148
.long 0x768, 0x328, 0x120, 0x128, 0x748, 0x308, 0x100, 0x108
.long 0x728, 0x2e8, 0xe0, 0xe8, 0x708, 0x2c8, 0xc0, 0xc8
.long 0x6e8, 0x2a8, 0xa0, 0xa8, 0x6c8, 0x288, 0x80, 0x88
.long 0x6a8, 0x268, 0x60, 0x68, 0x688, 0x248, 0x40, 0x48
.long 0x870, 0x430, 0x90c, 0x94c, 0x850, 0x410, 0x908, 0x948
.long 0x830, 0x3f0, 0x904, 0x944, 0x810, 0x3d0, 0x900, 0x940
.long 0x7f0, 0x3b0, 0x8fc, 0x93c, 0x7d0, 0x390, 0x8f8, 0x938
.long 0x7b0, 0x370, 0x8f4, 0x934, 0x790, 0x350, 0x8f0, 0x930
.long 0x770, 0x330, 0x8ec, 0x92c, 0x750, 0x310, 0x8e8, 0x928
.long 0x730, 0x2f0, 0x8e4, 0x924, 0x710, 0x2d0, 0x8e0, 0x920
.long 0x6f0, 0x2b0, 0x8dc, 0x91c, 0x6d0, 0x290, 0x8d8, 0x918
.long 0x6b0, 0x270, 0x8d4, 0x914, 0x690, 0x250, 0x8d0, 0x910
.long 0x860, 0x420, 0x9cc, 0xa0c, 0x840, 0x400, 0x9c8, 0xa08
.long 0x820, 0x3e0, 0x9c4, 0xa04, 0x800, 0x3c0, 0x9c0, 0xa00
.long 0x7e0, 0x3a0, 0x9bc, 0x9fc, 0x7c0, 0x380, 0x9b8, 0x9f8
.long 0x7a0, 0x360, 0x9b4, 0x9f4, 0x780, 0x340, 0x9b0, 0x9f0
.long 0x760, 0x320, 0x9ac, 0x9ec, 0x740, 0x300, 0x9a8, 0x9e8
.long 0x720, 0x2e0, 0x9a4, 0x9e4, 0x700, 0x2c0, 0x9a0, 0x9e0
.long 0x6e0, 0x2a0, 0x99c, 0x9dc, 0x6c0, 0x280, 0x998, 0x9d8
.long 0x6a0, 0x260, 0x994, 0x9d4, 0x680, 0x240, 0x990, 0x9d0
.long 0x22c, 0x670, 0xb90, 0x23e, 0x20c, 0x650, 0xb90, 0xb90
.long 0x1ec, 0x630, 0xb90, 0xb90, 0x1cc, 0x610, 0xb90, 0xb90
.long 0x1ac, 0x5f0, 0xb90, 0xb90, 0x18c, 0x5d0, 0xb90, 0xb90
.long 0x16c, 0x5b0, 0xb90, 0xb90, 0x14c, 0x590, 0xb90, 0xb90
.long 0x12c, 0x570, 0xb90, 0xb90, 0x10c, 0x550, 0xb90, 0xb90
.long 0xec, 0x530, 0xb90, 0xb90, 0xcc, 0x510, 0xb90, 0xb90
.long 0xac, 0x4f0, 0xb90, 0xb90, 0x8c, 0x4d0, 0xb90, 0xb90
.long 0x6c, 0x4b0, 0xb90, 0xb90, 0x4c, 0x490, 0xb90, 0xb90
.long 0x21c, 0x660, 0xb90, 0xb90, 0x1fc, 0x640, 0xb90, 0xb90
.long 0x1dc, 0x620, 0xb90, 0xb90, 0x1bc, 0x600, 0xb90, 0xb90
.long 0x19c, 0x5e0, 0xb90, 0xb90, 0x17c, 0x5c0, 0xb90, 0xb90
.long 0x15c, 0x5a0, 0xb90, 0xb90, 0x13c, 0x580, 0xb90, 0xb90
.long 0x11c, 0x560, 0xb90, 0xb90, 0xfc, 0x540, 0xb90, 0xb90
.long 0xdc, 0x520, 0xb90, 0xb90, 0xbc, 0x500, 0xb90, 0xb90
.long 0x9c, 0x4e0, 0xb90, 0xb90, 0x7c, 0x4c0, 0xb90, 0xb90
.long 0x5c, 0x4a0, 0xb90, 0xb90, 0x3c, 0x480, 0x47c, 0xb90
.long 0xb90, 0xb90, 0xb90, 0xb4c, 0xb90, 0xb90, 0xb90, 0xb48
.long 0xb90, 0xb90, 0xb90, 0xb44, 0xb90, 0xb90, 0xb90, 0xb40
.long 0xb90, 0xb90, 0xb90, 0xb3c, 0xb90, 0xb90, 0xb90, 0xb38
.long 0xb90, 0xb90, 0xb90, 0xb34, 0xb90, 0xb90, 0xb90, 0xb30
.long 0xb90, 0xb90, 0xb90, 0xb2c, 0xb90, 0xb90, 0xb90, 0xb28
.long 0xb90, 0xb90, 0xb90, 0xb24, 0xb90, 0xb90, 0xb90, 0xb20
.long 0xb90, 0xb90, 0xb90, 0xb1c, 0xb90, 0xb90, 0xb90, 0xb18
.long 0xb90, 0xb90, 0xb90, 0xb14, 0xb90, 0xb90, 0xb90, 0xb10
.long 0xb90, 0xb90, 0xb90, 0xb4e, 0xb90, 0xb90, 0xb90, 0xb4a
.long 0xb90, 0xb90, 0xb90, 0xb46, 0xb90, 0xb90, 0xb90, 0xb42
.long 0xb90, 0xb90, 0xb90, 0xb3e, 0xb90, 0xb90, 0xb90, 0xb3a
.long 0xb90, 0xb90, 0xb90, 0xb36, 0xb90, 0xb90, 0xb90, 0xb32
.long 0xb90, 0xb90, 0xb90, 0xb2e, 0xb90, 0xb90, 0xb90, 0xb2a
.long 0xb90, 0xb90, 0xb90, 0xb26, 0xb90, 0xb90, 0xb90, 0xb22
.long 0xb90, 0xb90, 0xb90, 0xb1e, 0xb90, 0xb90, 0xb90, 0xb1a
.long 0xb90, 0xb90, 0xb90, 0xb16, 0xb90, 0xb90, 0xb90, 0xb12
.long 0x23c, 0x880, 0xb90, 0x4200, 0xb90, 0xb90, 0xb90, 0x4c50
.long 0xb90, 0xb90, 0xb90, 0x4410, 0xb90, 0xb90, 0xb90, 0x5070
.long 0xb90, 0xb90, 0xb90, 0x5280, 0xb90, 0xb90, 0xb90, 0x4620
.long 0xb90, 0xb90, 0xb90, 0x5490, 0xb90, 0xb90, 0xb90, 0x4830
.long 0xb90, 0xb90, 0xb90, 0x6510, 0xb90, 0xb90, 0xb90, 0x6d50
.long 0xb90, 0xb90, 0xb90, 0x56a0, 0xb90, 0xb90, 0xb90, 0x4a40
.long 0xb90, 0xb90, 0xb90, 0x6720, 0xb90, 0xb90, 0xb90, 0x6b40
.long 0xb90, 0xb90, 0xb90, 0x6930, 0xb90, 0xb90, 0xb90, 0x58b0
.long 0xb90, 0xb90, 0xb90, 0x6300, 0xb90, 0xb90, 0xb90, 0x6300
.long 0xb90, 0xb90, 0xb90, 0x4e60, 0xb90, 0xb90, 0xb90, 0x4a40
.long 0xb90, 0xb90, 0xb90, 0x5ac0, 0xb90, 0xb90, 0xb90, 0x5cd0
.long 0xb90, 0xb90, 0xb90, 0x5ee0, 0xb90, 0xb90, 0xb90, 0x60f0
.long 0xb90, 0xb90, 0xb90, 0x4e60, 0xb90, 0xb90, 0xb90, 0x4200
.long 0xb90, 0xb90, 0xb90, 0x4c50, 0xb90, 0xb90, 0xb90, 0x4410
.long 0xb90, 0xb90, 0xb90, 0x5070, 0xb90, 0xb90, 0xb90, 0x5280
.long 0xb90, 0xb90, 0xb90, 0x4620, 0xb90, 0xb90, 0x3a, 0x5490
.long 0xb0c, 0xacc, 0xa8c, 0x4210, 0xb08, 0xac8, 0xa88, 0x4c60
.long 0xb04, 0xac4, 0xa84, 0x4420, 0xb00, 0xac0, 0xa80, 0x5080
.long 0xafc, 0xabc, 0xa7c, 0x5290, 0xaf8, 0xab8, 0xa78, 0x4630
.long 0xaf4, 0xab4, 0xa74, 0x54a0, 0xaf0, 0xab0, 0xa70, 0x4840
.long 0xaec, 0xaac, 0xa6c, 0x6520, 0xae8, 0xaa8, 0xa68, 0x6d60
.long 0xae4, 0xaa4, 0xa64, 0x56b0, 0xae0, 0xaa0, 0xa60, 0x4a50
.long 0xadc, 0xa9c, 0xa5c, 0x6730, 0xad8, 0xa98, 0xa58, 0x6b50
.long 0xad4, 0xa94, 0xa54, 0x6940, 0xad0, 0xa90, 0xa50, 0x58c0
.long 0xb0e, 0xace, 0xa8e, 0x6310, 0xb0a, 0xaca, 0xa8a, 0x6310
.long 0xb06, 0xac6, 0xa86, 0x4e70, 0xb02, 0xac2, 0xa82, 0x4a50
.long 0xafe, 0xabe, 0xa7e, 0x5ad0, 0xafa, 0xaba, 0xa7a, 0x5ce0
.long 0xaf6, 0xab6, 0xa76, 0x5ef0, 0xaf2, 0xab2, 0xa72, 0x6100
.long 0xaee, 0xaae, 0xa6e, 0x4e70, 0xaea, 0xaaa, 0xa6a, 0x4210
.long 0xae6, 0xaa6, 0xa66, 0x4c60, 0xae2, 0xaa2, 0xa62, 0x4420
.long 0xade, 0xa9e, 0xa5e, 0x5080, 0xada, 0xa9a, 0xa5a, 0x5290
.long 0xad6, 0xa96, 0xa56, 0x4630, 0xad2, 0xa92, 0xa52, 0x54a0
TBLEND:
.size TBL, .-TBL
.section .rodata,"a"
.p2align 6
.amdhsa_kernel sequential_preLN__ssm_conv_s4d__moe_arch_mod__prompt_kernel
  .amdhsa_next_free_vgpr 256
  .amdhsa_next_free_sgpr 102
  .amdhsa_accum_offset 256
  .amdhsa_group_segment_fixed_size 0
  .amdhsa_kernarg_size 120
  .amdhsa_user_sgpr_count 2
  .amdhsa_user_sgpr_kernarg_segment_ptr 1
  .amdhsa_system_sgpr_workgroup_id_x 1
.end_amdhsa_kernel
```

```asm
; @launch grid=(248,1,1) block=(512,1,1) lds=163840
.amdgcn_target "amdgcn-amd-amdhsa--gfx950"
.text
.globl sequential_preLN__ssm_conv_s4d__moe_arch_mod__prompt_kernel
.p2align 8
.type sequential_preLN__ssm_conv_s4d__moe_arch_mod__prompt_kernel,@function
sequential_preLN__ssm_conv_s4d__moe_arch_mod__prompt_kernel:
    s_cmp_ge_u32 s2, 248
    s_cbranch_scc1 END
    s_load_dwordx16 s[4:19], s[0:1], 0
    s_load_dwordx8 s[20:27], s[0:1], 64
    s_load_dwordx2 s[28:29], s[0:1], 96
    s_load_dwordx2 s[30:31], s[0:1], 112
    s_getpc_b64 s[42:43]
PC0:
    v_and_b32 v1, 63, v0
    v_lshrrev_b32 v14, 6, v0
    v_lshlrev_b32 v15, 7, v0
    v_readfirstlane_b32 s3, v14
    s_add_u32 s44, s42, TBL-PC0
    s_addc_u32 s45, s43, 0
    v_lshlrev_b32 v2, 4, v1
    v_lshlrev_b32 v3, 4, v0
    s_sub_u32 s50, s2, 192
    s_cmp_lt_u32 s50, 24
    s_cbranch_scc1 FROLE
    s_and_b32 s51, s3, 3
    s_lshr_b32 s46, s3, 2
    s_sub_u32 s49, s2, 120
    s_cmp_lt_u32 s2, 216
    s_cselect_b32 s49, 255, s49
    s_cmp_lt_u32 s2, 96
    s_cselect_b32 s49, s2, s49
    s_sub_u32 s38, s2, 96
    s_cmp_lt_u32 s49, 128
    s_cselect_b32 s38, s49, s38
    s_cselect_b32 s39, s46, 1
    s_lshl_b32 s48, s38, 1
    s_add_u32 s48, s48, s39
    s_lshl_b32 s48, s48, 3
    s_add_u32 s48, s48, s51
    s_mul_i32 s50, s48, 1152
    v_and_b32 v13, 31, v1
    v_lshrrev_b32 v15, 5, v1
    v_mul_u32_u24 v14, 4608, v15
    v_add_u32 v14, s50, v14
    v_lshlrev_b32 v12, 4, v13
    v_lshlrev_b32 v13, 2, v13
    v_add_u32 v4, v12, v14
    v_add_u32 v5, v13, v14
    s_cmp_ge_u32 s2, 216
    s_cselect_b32 s61, 0, s46
    s_lshl_b32 s52, s2, 2
    s_add_u32 s52, s52, s51
    s_lshl_b32 s53, s52, 8
    s_lshl_b32 s54, s46, 7
    s_add_u32 s53, s53, s54
    v_lshl_add_u32 v34, v1, 1, s53
    v_xor_b32 v35, 128, v34
    v_mov_b32 v28, 0
    v_mov_b32 v29, 0
    v_mov_b32 v30, 0
    v_mov_b32 v31, 0
    v_mov_b32 v32, 0
    v_mov_b32 v33, 0
    s_lshl_b32 s54, s2, 3
    s_cmp_lg_u32 s61, 0
    s_waitcnt lgkmcnt(0)
    s_cbranch_scc1 C_NOX
    global_load_dwordx4 v[16:19], v4, s[4:5] nt
    global_load_dwordx4 v[20:23], v4, s[4:5] offset:512 nt
    global_load_dword v24, v5, s[4:5] offset:1024 nt
C_NOX:
    s_load_dword s40, s[30:31], 0
    s_cmp_ge_u32 s2, 144
    s_cbranch_scc1 C_NOP
    s_load_dwordx2 s[56:57], s[14:15], s54
    global_load_short_d16_hi v28, v34, s[6:7] nt
    global_load_short_d16_hi v29, v34, s[8:9] nt
    global_load_short_d16_hi v30, v34, s[10:11] nt
    global_load_short_d16_hi v31, v34, s[12:13] nt
    global_load_short_d16_hi v32, v35, s[10:11] nt
    global_load_short_d16_hi v33, v35, s[12:13] nt
C_NOP:
    s_mov_b32 s32, s30
    s_and_b32 s33, s31, 0xffff
    s_mov_b32 s34, 0x10000000
    s_mov_b32 s35, 0x00020000
    v_mov_b32 v6, 0x3f80
    v_mov_b32 v7, 1.0
    v_mov_b32 v8, 0x3f803f80
    v_mov_b32 v9, 0xfff8fff8
    v_mov_b32 v11, 0x40004
    v_mul_u32_u24 v15, 4736, v15
    s_and_b32 s46, s3, 4
    s_add_u32 s46, s46, s3
    s_mul_i32 s46, s46, 1184
    s_add_u32 s46, s46, 132608
    v_add_u32 v15, s46, v15
    v_add_u32 v25, v12, v15
    v_add_u32 v26, v13, v15
    s_lshr_b32 s46, s3, 2
    s_lshl_b32 s46, s46, 8
    s_mul_i32 s60, s51, 28512
    s_add_u32 s46, s60, s46
    v_lshl_add_u32 v40, v1, 2, s46
    v_add_u32 v41, 528, v40
    v_add_u32 v42, 1056, v40
    v_add_u32 v43, 1584, v40
    v_add_u32 v44, 2112, v40
    v_add_u32 v45, 2640, v40
    v_add_u32 v46, 3168, v40
    v_add_u32 v47, 3696, v40
    v_add_u32 v48, 4224, v40
    v_add_u32 v49, 4752, v40
    v_add_u32 v50, 5280, v40
    v_add_u32 v51, 5808, v40
    v_add_u32 v52, 6336, v40
    v_add_u32 v53, 6864, v40
    v_add_u32 v54, 7392, v40
    v_add_u32 v55, 7920, v40
    s_mul_i32 s62, s51, 2976
    s_add_u32 s62, s62, 151552
    s_cmp_ge_u32 s2, 144
    s_cbranch_scc1 C_O1
    s_cmp_lg_u32 s61, 0
    s_cbranch_scc1 C_O1
    v_and_b32 v14, 31, v1
    v_mul_u32_u24 v14, 528, v14
    v_lshrrev_b32 v15, 5, v1
    v_lshl_add_u32 v14, v15, 4, v14
    v_add_u32 v253, s60, v14
    v_add_u32 v27, 7168, v2
    v_mov_b32 v37, 0
    global_load_dwordx4 v[184:187], v27, s[44:45] offset:0
    global_load_dwordx4 v[188:191], v27, s[44:45] offset:1024
    global_load_dwordx4 v[192:195], v27, s[44:45] offset:2048
    global_load_dwordx4 v[208:211], v12, s[16:17]
    global_load_dwordx4 v[212:215], v12, s[16:17] offset:512
    global_load_dword v216, v13, s[16:17] offset:1024
    global_load_dwordx4 v[218:221], v12, s[20:21]
    global_load_dwordx4 v[222:225], v12, s[20:21] offset:512
    global_load_dword v226, v13, s[20:21] offset:1024
    s_waitcnt vmcnt(15)
    s_branch C_LN1
C_O1:
    v_bfe_u32 v15, v1, 2, 2
    v_mul_u32_u24 v14, 1184, v15
    v_lshrrev_b32 v15, 4, v1
    v_lshl_add_u32 v14, v15, 5, v14
    v_and_b32 v15, 3, v1
    v_lshl_add_u32 v14, v15, 3, v14
    s_cmp_ge_u32 s2, 216
    s_cselect_b32 s46, s39, 0
    s_mul_i32 s53, s46, 9472
    s_lshl_b32 s55, s51, 7
    s_add_u32 s53, s53, s55
    s_add_u32 s53, s53, 132608
    v_add_u32 v36, s53, v14
    v_lshrrev_b32 v14, 2, v1
    v_lshlrev_b32 v15, 4, v15
    v_lshl_add_u32 v37, v14, 14, v15
    s_cmp_lt_u32 s2, 96
    s_cselect_b32 s46, 0, s39
    s_lshl_b32 s46, s46, 6
    s_lshl_b32 s55, s38, 7
    s_add_u32 s55, s55, s46
    s_lshl_b32 s46, s51, 18
    s_add_u32 s55, s55, s46
    s_add_u32 s55, s55, 1048576
    s_add_u32 s36, s55, 1048576
    s_add_u32 s37, s55, 2097152
    v_mov_b32 v120, 0
    v_mov_b32 v121, 0
    v_mov_b32 v122, 0
    v_mov_b32 v123, 0
    s_lshl_b32 s46, s51, 10
    s_add_u32 s46, s46, 151296
    v_add_u32 v14, s46, v2
    v_max_u32 v15, 151552, v14
    ds_write_b128 v15, v[120:123]
    ds_write_b128 v14, v[120:123] offset:4096
    ds_write_b128 v14, v[120:123] offset:8192
    s_mul_i32 s46, s51, 4640
    s_add_u32 s46, s46, 114048
    v_add_u32 v14, s46, v12
    ds_write_b128 v14, v[120:123]
    s_waitcnt lgkmcnt(0)
    s_add_u32 s40, s40, 1
    s_and_b32 s41, s40, 7
    s_bfe_u32 s46, s40, 0x30003
    s_lshl_b32 s46, s46, 16
    s_or_b32 s41, s41, s46
    v_mov_b32 v10, s41
    s_cmp_eq_u32 s61, 0
    s_cbranch_scc1 C_O2
    s_cmp_ge_u32 s2, 144
    s_cbranch_scc1 C_BA
    s_waitcnt vmcnt(0)
    s_bitcmp1_b32 s51, 1
    s_cselect_b32 s56, s57, s56
    s_lshl_b32 s57, s56, 16
    s_and_b32 s56, s56, 0xffff0000
    s_bitcmp1_b32 s51, 0
    s_cselect_b32 s56, s56, s57
    v_mov_b32 v60, 0x3fb8aa3b
    v_mul_f32 v62, 0x3fb8aa3b, v28
    v_mul_f32 v60, s56, v60
    v_exp_f32 v62, v62
    v_exp_f32 v60, v60
    v_add_f32 v64, |v30|, |v31|
    v_add_f32 v65, |v32|, |v33|
    v_cvt_pk_bf16_f32 v62, 0, v62
    v_cvt_pk_bf16_f32 v60, 0, v60
    v_add_f32 v64, v64, v65
    v_mul_f32 v62, v62, v60
    v_mul_f32 v63, v29, v60
    v_mul_f32 v62, 0xbfb8aa3b, v62
    v_mul_f32 v63, 0.15915494, v63
    v_mul_f32 v104, 0x41000000, v62
    v_add_f32_dpp v64, v64, v64 row_ror:8 row_mask:0xf bank_mask:0xf
    v_mul_f32 v105, 0x41000000, v63
    v_exp_f32 v104, v104
    v_fract_f32 v105, v105
    v_add_f32_dpp v64, v64, v64 row_ror:4 row_mask:0xf bank_mask:0xf
    v_cos_f32 v72, v105
    v_sin_f32 v73, v105
    v_add_f32_dpp v64, v64, v64 row_ror:2 row_mask:0xf bank_mask:0xf
    v_pk_mul_f32 v[72:73], v[72:73], v[104:105] op_sel_hi:[1,0] neg_hi:[1,0]
    v_exp_f32 v106, v62
    v_add_f32_dpp v64, v64, v64 row_ror:1 row_mask:0xf bank_mask:0xf
    v_fract_f32 v107, v63
    v_cos_f32 v66, v107
    v_sin_f32 v67, v107
    v_mov_b32 v65, v64
    v_pk_mul_f32 v[66:67], v[66:67], v[106:107] op_sel_hi:[1,0]
    v_mul_f32 v108, 0x43800000, v62
    v_permlane16_swap_b32 v64, v65
    v_mul_f32 v109, 0x43800000, v63
    v_exp_f32 v108, v108
    v_add_f32 v64, v64, v65
    v_fract_f32 v109, v109
    v_cos_f32 v68, v109
    v_sin_f32 v69, v109
    v_mov_b32 v65, v64
    v_pk_mul_f32 v[68:69], v[68:69], v[108:109] op_sel_hi:[1,0]
    v_mov_b32 v162, 0x3c00
    v_pk_mul_f32 v[74:75], v[72:73], v[72:73] op_sel_hi:[1,0]
    v_permlane32_swap_b32 v64, v65
    v_pk_fma_f32 v[74:75], v[72:73], v[72:73], v[74:75] op_sel:[1,1,0] op_sel_hi:[0,1,1] neg_lo:[1,0,0]
    s_setprio 2
    s_branch C_BA
C_O2:
    global_load_dwordx4 v[208:211], v12, s[16:17]
    global_load_dwordx4 v[212:215], v12, s[16:17] offset:512
    global_load_dword v216, v13, s[16:17] offset:1024
    global_load_dwordx4 v[218:221], v12, s[20:21]
    global_load_dwordx4 v[222:225], v12, s[20:21] offset:512
    global_load_dword v226, v13, s[20:21] offset:1024
    s_waitcnt vmcnt(6)
C_LN1:
    v_dot2_f32_bf16 v120, v16, v8, 0
    v_dot2_f32_bf16 v121, v16, v16, 0
    v_dot2_f32_bf16 v120, v17, v8, v120
    v_dot2_f32_bf16 v121, v17, v17, v121
    v_dot2_f32_bf16 v120, v18, v8, v120
    v_dot2_f32_bf16 v121, v18, v18, v121
    v_dot2_f32_bf16 v120, v19, v8, v120
    v_dot2_f32_bf16 v121, v19, v19, v121
    v_dot2_f32_bf16 v120, v20, v8, v120
    v_dot2_f32_bf16 v121, v20, v20, v121
    v_dot2_f32_bf16 v120, v21, v8, v120
    v_dot2_f32_bf16 v121, v21, v21, v121
    v_dot2_f32_bf16 v120, v22, v8, v120
    v_dot2_f32_bf16 v121, v22, v22, v121
    v_dot2_f32_bf16 v120, v23, v8, v120
    v_dot2_f32_bf16 v121, v23, v23, v121
    v_dot2_f32_bf16 v120, v24, v8, v120
    v_dot2_f32_bf16 v121, v24, v24, v121
    s_nop 2
    v_permlane16_swap_b32 v120, v121
    v_add_f32 v120, v120, v121
    s_nop 1
    v_add_f32_dpp v120, v120, v120 row_ror:8 row_mask:0xf bank_mask:0xf
    s_nop 1
    v_add_f32_dpp v120, v120, v120 row_ror:4 row_mask:0xf bank_mask:0xf
    s_nop 1
    v_add_f32_dpp v120, v120, v120 row_ror:2 row_mask:0xf bank_mask:0xf
    s_nop 1
    v_add_f32_dpp v120, v120, v120 row_ror:1 row_mask:0xf bank_mask:0xf
    v_mov_b32 v121, v120
    s_nop 1
    v_permlane16_swap_b32 v120, v121
    v_mul_f32 v120, 0x3ae38e39, v120
    v_mul_f32 v121, 0x3ae38e39, v121
    v_fma_f32 v121, -v120, v120, v121
    v_cvt_pk_bf16_f32 v122, 0, v120
    v_dot2_f32_bf16 v126, v16, v6, v122 neg_lo:[0,0,1]
    v_max_f32 v121, 0, v121
    v_dot2_f32_bf16 v127, v16, v7, v122 neg_lo:[0,0,1]
    v_dot2_f32_bf16 v128, v17, v6, v122 neg_lo:[0,0,1]
    v_dot2_f32_bf16 v129, v17, v7, v122 neg_lo:[0,0,1]
    v_cvt_pk_bf16_f32 v121, 0, v121
    v_dot2_f32_bf16 v130, v18, v6, v122 neg_lo:[0,0,1]
    v_dot2_f32_bf16 v131, v18, v7, v122 neg_lo:[0,0,1]
    v_add_f32 v121, 0x3727c5ac, v121
    v_dot2_f32_bf16 v132, v19, v6, v122 neg_lo:[0,0,1]
    v_dot2_f32_bf16 v133, v19, v7, v122 neg_lo:[0,0,1]
    v_dot2_f32_bf16 v134, v20, v6, v122 neg_lo:[0,0,1]
    v_cvt_pk_bf16_f32 v121, 0, v121
    v_dot2_f32_bf16 v135, v20, v7, v122 neg_lo:[0,0,1]
    v_dot2_f32_bf16 v136, v21, v6, v122 neg_lo:[0,0,1]
    v_dot2_f32_bf16 v137, v21, v7, v122 neg_lo:[0,0,1]
    v_sqrt_f32 v121, v121
    v_dot2_f32_bf16 v138, v22, v6, v122 neg_lo:[0,0,1]
    v_dot2_f32_bf16 v139, v22, v7, v122 neg_lo:[0,0,1]
    v_cvt_pk_bf16_f32 v121, 0, v121
    v_dot2_f32_bf16 v140, v23, v6, v122 neg_lo:[0,0,1]
    v_dot2_f32_bf16 v141, v23, v7, v122 neg_lo:[0,0,1]
    v_dot2_f32_bf16 v142, v24, v6, v122 neg_lo:[0,0,1]
    v_rcp_f32 v124, v121
    v_dot2_f32_bf16 v143, v24, v7, v122 neg_lo:[0,0,1]
    v_cvt_pk_bf16_f32 v126, 0, v126
    v_cvt_pk_bf16_f32 v127, 0, v127
    v_cvt_pk_bf16_f32 v128, 0, v128
    v_cvt_pk_bf16_f32 v129, 0, v129
    v_cvt_pk_bf16_f32 v130, 0, v130
    v_cvt_pk_bf16_f32 v131, 0, v131
    v_cvt_pk_bf16_f32 v132, 0, v132
    v_cvt_pk_bf16_f32 v133, 0, v133
    v_cvt_pk_bf16_f32 v134, 0, v134
    v_cvt_pk_bf16_f32 v135, 0, v135
    v_cvt_pk_bf16_f32 v136, 0, v136
    v_cvt_pk_bf16_f32 v137, 0, v137
    v_cvt_pk_bf16_f32 v138, 0, v138
    v_cvt_pk_bf16_f32 v139, 0, v139
    v_cvt_pk_bf16_f32 v140, 0, v140
    v_cvt_pk_bf16_f32 v141, 0, v141
    v_cvt_pk_bf16_f32 v142, 0, v142
    v_cvt_pk_bf16_f32 v143, 0, v143
    v_pk_mul_f32 v[126:127], v[126:127], v[124:125] op_sel_hi:[1,0]
    v_pk_mul_f32 v[128:129], v[128:129], v[124:125] op_sel_hi:[1,0]
    v_pk_mul_f32 v[130:131], v[130:131], v[124:125] op_sel_hi:[1,0]
    v_pk_mul_f32 v[132:133], v[132:133], v[124:125] op_sel_hi:[1,0]
    v_pk_mul_f32 v[134:135], v[134:135], v[124:125] op_sel_hi:[1,0]
    v_pk_mul_f32 v[136:137], v[136:137], v[124:125] op_sel_hi:[1,0]
    v_pk_mul_f32 v[138:139], v[138:139], v[124:125] op_sel_hi:[1,0]
    v_pk_mul_f32 v[140:141], v[140:141], v[124:125] op_sel_hi:[1,0]
    v_pk_mul_f32 v[142:143], v[142:143], v[124:125] op_sel_hi:[1,0]
    v_cvt_pkrtz_f16_f32 v144, v126, v127
    v_cvt_pkrtz_f16_f32 v145, v128, v129
    v_cvt_pkrtz_f16_f32 v146, v130, v131
    v_cvt_pkrtz_f16_f32 v147, v132, v133
    v_cvt_pkrtz_f16_f32 v148, v134, v135
    ds_write_b128 v25, v[144:147]
    v_cvt_pkrtz_f16_f32 v149, v136, v137
    v_cvt_pkrtz_f16_f32 v150, v138, v139
    v_cvt_pkrtz_f16_f32 v151, v140, v141
    v_cvt_pkrtz_f16_f32 v152, v142, v143
    ds_write_b128 v25, v[148:151] offset:512
    ds_write_b32 v26, v152 offset:1024
    s_waitcnt lgkmcnt(0)
C_BA:
    s_barrier
    s_cmp_ge_u32 s3, 4
    s_cbranch_scc1 C_US
    s_cmp_lt_u32 s2, 144
    s_cbranch_scc1 C_K1
    s_cmp_ge_u32 s49, 128
    s_cbranch_scc1 FROLE
C_US:
    ds_read_b64_tr_b16 v[228:229], v36 offset:0
    ds_read_b64_tr_b16 v[230:231], v36 offset:4736
    ds_read_b64_tr_b16 v[232:233], v36 offset:512
    ds_read_b64_tr_b16 v[234:235], v36 offset:5248
    ds_read_b64_tr_b16 v[236:237], v36 offset:1024
    ds_read_b64_tr_b16 v[238:239], v36 offset:5760
    s_waitcnt lgkmcnt(4)
    v_add_u32 v228, v11, v228
    v_add_u32 v229, v11, v229
    v_add_u32 v230, v11, v230
    v_add_u32 v231, v11, v231
    v_and_or_b32 v228, v228, v9, v10
    v_and_or_b32 v229, v229, v9, v10
    v_and_or_b32 v230, v230, v9, v10
    v_and_or_b32 v231, v231, v9, v10
    buffer_store_dwordx4 v[228:231], v37, s[32:35], s55 offen sc1
    s_waitcnt lgkmcnt(2)
    v_add_u32 v232, v11, v232
    v_add_u32 v233, v11, v233
    v_add_u32 v234, v11, v234
    v_add_u32 v235, v11, v235
    v_and_or_b32 v232, v232, v9, v10
    v_and_or_b32 v233, v233, v9, v10
    v_and_or_b32 v234, v234, v9, v10
    v_and_or_b32 v235, v235, v9, v10
    buffer_store_dwordx4 v[232:235], v37, s[32:35], s36 offen sc1
    s_cmp_lg_u32 s51, 0
    s_cbranch_scc1 US1
    s_waitcnt lgkmcnt(0)
    v_add_u32 v236, v11, v236
    v_add_u32 v237, v11, v237
    v_add_u32 v238, v11, v238
    v_add_u32 v239, v11, v239
    v_and_or_b32 v236, v236, v9, v10
    v_and_or_b32 v237, v237, v9, v10
    v_and_or_b32 v238, v238, v9, v10
    v_and_or_b32 v239, v239, v9, v10
    buffer_store_dwordx4 v[236:239], v37, s[32:35], s37 offen sc1
US1:
    s_cmp_ge_u32 s2, 144
    s_cbranch_scc1 C_O3
    s_branch C_K2
C_O3:
    s_cmp_lt_u32 s49, 128
    s_cbranch_scc1 C_RL2
    v_subrev_u32 v14, 9472, v25
    v_subrev_u32 v15, 9472, v26
    ds_read_b128 v[140:143], v14
    ds_read_b128 v[144:147], v14 offset:512
    ds_read_b32 v148, v15 offset:1024
    s_mov_b32 s46, 10485760
    s_waitcnt lgkmcnt(0)
    v_add_u32 v140, v11, v140
    v_add_u32 v141, v11, v141
    v_add_u32 v142, v11, v142
    v_add_u32 v143, v11, v143
    v_add_u32 v144, v11, v144
    v_add_u32 v145, v11, v145
    v_add_u32 v146, v11, v146
    v_add_u32 v147, v11, v147
    v_add_u32 v148, v11, v148
    v_and_or_b32 v140, v140, v9, v10
    v_and_or_b32 v141, v141, v9, v10
    v_and_or_b32 v142, v142, v9, v10
    v_and_or_b32 v143, v143, v9, v10
    v_and_or_b32 v144, v144, v9, v10
    v_and_or_b32 v145, v145, v9, v10
    v_and_or_b32 v146, v146, v9, v10
    v_and_or_b32 v147, v147, v9, v10
    v_and_or_b32 v148, v148, v9, v10
    buffer_store_dwordx4 v[140:143], v4, s[32:35], s46 offen sc1
    buffer_store_dwordx4 v[144:147], v4, s[32:35], s46 offen offset:512 sc1
    buffer_store_dword v148, v5, s[32:35], s46 offen offset:1024 sc1
    s_branch FROLE
C_RL2:
    s_waitcnt vmcnt(0)
    s_branch RPREP
C_K1:
    s_add_u32 s40, s40, 1
    s_and_b32 s41, s40, 7
    s_bfe_u32 s46, s40, 0x30003
    s_lshl_b32 s46, s46, 16
    s_or_b32 s41, s41, s46
    v_mov_b32 v10, s41
    s_waitcnt vmcnt(9)
    s_bitcmp1_b32 s51, 1
    s_cselect_b32 s56, s57, s56
    s_lshl_b32 s57, s56, 16
    s_and_b32 s56, s56, 0xffff0000
    s_bitcmp1_b32 s51, 0
    s_cselect_b32 s56, s56, s57
    v_mov_b32 v60, 0x3fb8aa3b
    v_mul_f32 v62, 0x3fb8aa3b, v28
    v_mul_f32 v60, s56, v60
    v_exp_f32 v62, v62
    v_exp_f32 v60, v60
    v_add_f32 v64, |v30|, |v31|
    v_add_f32 v65, |v32|, |v33|
    v_cvt_pk_bf16_f32 v62, 0, v62
    v_cvt_pk_bf16_f32 v60, 0, v60
    v_add_f32 v64, v64, v65
    v_mul_f32 v62, v62, v60
    v_mul_f32 v63, v29, v60
    v_mul_f32 v62, 0xbfb8aa3b, v62
    v_mul_f32 v63, 0.15915494, v63
    v_mul_f32 v104, 0x41000000, v62
    v_add_f32_dpp v64, v64, v64 row_ror:8 row_mask:0xf bank_mask:0xf
    v_mul_f32 v105, 0x41000000, v63
    v_exp_f32 v104, v104
    v_fract_f32 v105, v105
    v_add_f32_dpp v64, v64, v64 row_ror:4 row_mask:0xf bank_mask:0xf
    v_cos_f32 v72, v105
    v_sin_f32 v73, v105
    v_add_f32_dpp v64, v64, v64 row_ror:2 row_mask:0xf bank_mask:0xf
    v_pk_mul_f32 v[72:73], v[72:73], v[104:105] op_sel_hi:[1,0] neg_hi:[1,0]
    v_exp_f32 v106, v62
    v_add_f32_dpp v64, v64, v64 row_ror:1 row_mask:0xf bank_mask:0xf
    v_fract_f32 v107, v63
    v_cos_f32 v66, v107
    v_sin_f32 v67, v107
    v_mov_b32 v65, v64
    v_pk_mul_f32 v[66:67], v[66:67], v[106:107] op_sel_hi:[1,0]
    v_mul_f32 v108, 0x43800000, v62
    v_permlane16_swap_b32 v64, v65
    v_mul_f32 v109, 0x43800000, v63
    v_exp_f32 v108, v108
    v_add_f32 v64, v64, v65
    v_fract_f32 v109, v109
    v_cos_f32 v68, v109
    v_sin_f32 v69, v109
    v_mov_b32 v65, v64
    v_pk_mul_f32 v[68:69], v[68:69], v[108:109] op_sel_hi:[1,0]
    v_mov_b32 v162, 0x3c00
    v_pk_mul_f32 v[74:75], v[72:73], v[72:73] op_sel_hi:[1,0]
    v_permlane32_swap_b32 v64, v65
    v_pk_fma_f32 v[74:75], v[72:73], v[72:73], v[74:75] op_sel:[1,1,0] op_sel_hi:[0,1,1] neg_lo:[1,0,0]
C_K2:
    v_pk_mul_f32 v[76:77], v[74:75], v[72:73] op_sel_hi:[1,0]
    v_pk_mul_f32 v[78:79], v[74:75], v[74:75] op_sel_hi:[1,0]
    v_cvt_pk_f16_f32 v163, v72, v73
    v_cvt_pk_f16_f32 v164, v74, v75
    v_add_f32 v64, v64, v65
    v_pk_fma_f32 v[76:77], v[74:75], v[72:73], v[76:77] op_sel:[1,1,0] op_sel_hi:[0,1,1] neg_lo:[1,0,0]
    v_pk_fma_f32 v[78:79], v[74:75], v[74:75], v[78:79] op_sel:[1,1,0] op_sel_hi:[0,1,1] neg_lo:[1,0,0]
    ds_write2st64_b32 v40, v163, v162 offset0:33 offset1:0
    v_pk_mul_f32 v[80:81], v[78:79], v[72:73] op_sel_hi:[1,0]
    v_pk_mul_f32 v[82:83], v[78:79], v[74:75] op_sel_hi:[1,0]
    v_cvt_pk_f16_f32 v165, v76, v77
    v_cvt_pk_f16_f32 v166, v78, v79
    v_mul_f32 v64, v64, v60
    v_pk_fma_f32 v[80:81], v[78:79], v[72:73], v[80:81] op_sel:[1,1,0] op_sel_hi:[0,1,1] neg_lo:[1,0,0]
    v_pk_fma_f32 v[82:83], v[78:79], v[74:75], v[82:83] op_sel:[1,1,0] op_sel_hi:[0,1,1] neg_lo:[1,0,0]
    ds_write2st64_b32 v41, v165, v164 offset0:33 offset1:0
    v_pk_mul_f32 v[84:85], v[78:79], v[76:77] op_sel_hi:[1,0]
    v_pk_mul_f32 v[86:87], v[78:79], v[78:79] op_sel_hi:[1,0]
    v_cvt_pk_f16_f32 v167, v80, v81
    v_cvt_pk_f16_f32 v56, v82, v83
    v_frexp_exp_i32_f32 v64, v64
    v_pk_fma_f32 v[84:85], v[78:79], v[76:77], v[84:85] op_sel:[1,1,0] op_sel_hi:[0,1,1] neg_lo:[1,0,0]
    v_pk_fma_f32 v[86:87], v[78:79], v[78:79], v[86:87] op_sel:[1,1,0] op_sel_hi:[0,1,1] neg_lo:[1,0,0]
    ds_write2st64_b32 v42, v167, v166 offset0:33 offset1:0
    v_pk_mul_f32 v[88:89], v[86:87], v[72:73] op_sel_hi:[1,0]
    v_pk_mul_f32 v[90:91], v[86:87], v[74:75] op_sel_hi:[1,0]
    v_cvt_pk_f16_f32 v57, v84, v85
    v_cvt_pk_f16_f32 v163, v86, v87
    v_max_i32 v64, -100, v64
    v_pk_fma_f32 v[88:89], v[86:87], v[72:73], v[88:89] op_sel:[1,1,0] op_sel_hi:[0,1,1] neg_lo:[1,0,0]
    v_pk_fma_f32 v[90:91], v[86:87], v[74:75], v[90:91] op_sel:[1,1,0] op_sel_hi:[0,1,1] neg_lo:[1,0,0]
    ds_write2st64_b32 v43, v57, v56 offset0:33 offset1:0
    v_pk_mul_f32 v[92:93], v[86:87], v[76:77] op_sel_hi:[1,0]
    v_pk_mul_f32 v[94:95], v[86:87], v[78:79] op_sel_hi:[1,0]
    v_cvt_pk_f16_f32 v162, v88, v89
    v_cvt_pk_f16_f32 v165, v90, v91
    v_min_i32 v64, 100, v64
    v_pk_fma_f32 v[92:93], v[86:87], v[76:77], v[92:93] op_sel:[1,1,0] op_sel_hi:[0,1,1] neg_lo:[1,0,0]
    v_pk_fma_f32 v[94:95], v[86:87], v[78:79], v[94:95] op_sel:[1,1,0] op_sel_hi:[0,1,1] neg_lo:[1,0,0]
    ds_write2st64_b32 v44, v162, v163 offset0:33 offset1:0
    v_pk_mul_f32 v[96:97], v[86:87], v[80:81] op_sel_hi:[1,0]
    v_pk_mul_f32 v[98:99], v[86:87], v[82:83] op_sel_hi:[1,0]
    v_cvt_pk_f16_f32 v164, v92, v93
    v_cvt_pk_f16_f32 v167, v94, v95
    v_sub_u32 v65, 0, v64
    v_pk_fma_f32 v[96:97], v[86:87], v[80:81], v[96:97] op_sel:[1,1,0] op_sel_hi:[0,1,1] neg_lo:[1,0,0]
    v_pk_fma_f32 v[98:99], v[86:87], v[82:83], v[98:99] op_sel:[1,1,0] op_sel_hi:[0,1,1] neg_lo:[1,0,0]
    ds_write2st64_b32 v45, v164, v165 offset0:33 offset1:0
    v_pk_mul_f32 v[100:101], v[86:87], v[84:85] op_sel_hi:[1,0]
    v_pk_mul_f32 v[102:103], v[86:87], v[86:87] op_sel_hi:[1,0]
    v_cvt_pk_f16_f32 v166, v96, v97
    v_cvt_pk_f16_f32 v57, v98, v99
    v_ldexp_f32 v60, v60, v65
    v_pk_fma_f32 v[100:101], v[86:87], v[84:85], v[100:101] op_sel:[1,1,0] op_sel_hi:[0,1,1] neg_lo:[1,0,0]
    v_pk_fma_f32 v[102:103], v[86:87], v[86:87], v[102:103] op_sel:[1,1,0] op_sel_hi:[0,1,1] neg_lo:[1,0,0]
    ds_write2st64_b32 v46, v166, v167 offset0:33 offset1:0
    v_pk_mul_f32 v[112:113], v[102:103], v[72:73] op_sel_hi:[1,0]
    v_pk_mul_f32 v[114:115], v[102:103], v[74:75] op_sel_hi:[1,0]
    v_cvt_pk_f16_f32 v56, v100, v101
    v_cvt_pk_f16_f32 v162, v102, v103
    v_pk_mul_f32 v[30:31], v[30:31], v[60:61] op_sel_hi:[1,0]
    v_pk_fma_f32 v[112:113], v[102:103], v[72:73], v[112:113] op_sel:[1,1,0] op_sel_hi:[0,1,1] neg_lo:[1,0,0]
    v_pk_fma_f32 v[114:115], v[102:103], v[74:75], v[114:115] op_sel:[1,1,0] op_sel_hi:[0,1,1] neg_lo:[1,0,0]
    ds_write2st64_b32 v47, v56, v57 offset0:33 offset1:0
    v_pk_mul_f32 v[116:117], v[102:103], v[76:77] op_sel_hi:[1,0]
    v_pk_mul_f32 v[110:111], v[102:103], v[78:79] op_sel_hi:[1,0]
    v_cvt_pk_f16_f32 v163, v112, v113
    v_cvt_pk_f16_f32 v164, v114, v115
    v_pk_fma_f32 v[116:117], v[102:103], v[76:77], v[116:117] op_sel:[1,1,0] op_sel_hi:[0,1,1] neg_lo:[1,0,0]
    v_pk_fma_f32 v[110:111], v[102:103], v[78:79], v[110:111] op_sel:[1,1,0] op_sel_hi:[0,1,1] neg_lo:[1,0,0]
    ds_write2st64_b32 v48, v163, v162 offset0:33 offset1:0
    v_pk_mul_f32 v[112:113], v[102:103], v[80:81] op_sel_hi:[1,0]
    v_pk_mul_f32 v[114:115], v[102:103], v[82:83] op_sel_hi:[1,0]
    v_cvt_pk_f16_f32 v165, v116, v117
    v_cvt_pk_f16_f32 v166, v110, v111
    v_pk_fma_f32 v[112:113], v[102:103], v[80:81], v[112:113] op_sel:[1,1,0] op_sel_hi:[0,1,1] neg_lo:[1,0,0]
    v_pk_fma_f32 v[114:115], v[102:103], v[82:83], v[114:115] op_sel:[1,1,0] op_sel_hi:[0,1,1] neg_lo:[1,0,0]
    ds_write2st64_b32 v49, v165, v164 offset0:33 offset1:0
    s_setprio 0
    v_pk_mul_f32 v[120:121], v[30:31], v[66:67] op_sel_hi:[1,0]
    v_cvt_pk_f16_f32 v167, v112, v113
    v_cvt_pk_f16_f32 v56, v114, v115
    v_pk_fma_f32 v[120:121], v[30:31], v[66:67], v[120:121] op_sel:[1,1,0] op_sel_hi:[0,1,1] neg_lo:[1,0,0]
    ds_write2st64_b32 v50, v167, v166 offset0:33 offset1:0
    s_cmp_ge_u32 s3, 4
    s_cbranch_scc1 C_K3
    v_add_u32 v64, 1, v64
    s_and_b32 s46, s40, 0x7fffff
    v_ldexp_f32 v64, 1.0, v64
    s_lshl_b32 s53, s2, 7
    v_or_b32 v64, s46, v64
    s_lshl_b32 s46, s51, 2
    s_add_u32 s46, s46, s53
    s_add_u32 s46, s46, 32768
    s_mov_b64 exec, 1
    buffer_store_dword v64, v2, s[32:35], s46 offen sc1
    s_mov_b64 exec, -1
    s_branch C_K4
C_K3:
    v_add_u32 v27, 4096, v2
    global_load_dwordx4 v[168:171], v27, s[44:45] offset:-4096
    global_load_dwordx4 v[172:175], v27, s[44:45] offset:-3072
    global_load_dwordx4 v[176:179], v27, s[44:45] offset:-2048
    global_load_dwordx4 v[180:183], v27, s[44:45] offset:-1024
    global_load_dwordx4 v[184:187], v27, s[44:45] offset:0
    global_load_dwordx4 v[188:191], v27, s[44:45] offset:1024
    global_load_dwordx4 v[192:195], v27, s[44:45] offset:2048
    s_lshl_b32 s48, s2, 14
    s_add_u32 s48, s48, 1048576
    s_lshl_b32 s46, s51, 10
    s_add_u32 s59, s48, s46
    s_add_u32 s59, s59, 12288
    s_mul_i32 s46, s51, 3072
    s_add_u32 s48, s48, s46
C_K4:
    v_pk_mul_f32 v[136:137], v[30:31], v[68:69] op_sel_hi:[1,0]
    v_pk_mul_f32 v[122:123], v[120:121], v[66:67] op_sel_hi:[1,0]
    v_cvt_pk_f16_f32 v57, v30, v31
    v_cvt_pk_f16_f32 v163, v120, v121
    v_pk_fma_f32 v[136:137], v[30:31], v[68:69], v[136:137] op_sel:[1,1,0] op_sel_hi:[0,1,1] neg_lo:[1,0,0]
    v_pk_fma_f32 v[122:123], v[120:121], v[66:67], v[122:123] op_sel:[1,1,0] op_sel_hi:[0,1,1] neg_lo:[1,0,0]
    ds_write_b32 v46, v57 offset:16896
    v_pk_mul_f32 v[124:125], v[122:123], v[66:67] op_sel_hi:[1,0]
    v_pk_mul_f32 v[138:139], v[122:123], v[68:69] op_sel_hi:[1,0]
    v_cvt_pk_f16_f32 v162, v136, v137
    v_cvt_pk_f16_f32 v165, v122, v123
    v_pk_fma_f32 v[124:125], v[122:123], v[66:67], v[124:125] op_sel:[1,1,0] op_sel_hi:[0,1,1] neg_lo:[1,0,0]
    v_pk_fma_f32 v[138:139], v[122:123], v[68:69], v[138:139] op_sel:[1,1,0] op_sel_hi:[0,1,1] neg_lo:[1,0,0]
    ds_write2st64_b32 v40, v162, v163 offset0:99 offset1:66
    v_pk_mul_f32 v[126:127], v[124:125], v[66:67] op_sel_hi:[1,0]
    v_cvt_pk_f16_f32 v164, v124, v125
    v_cvt_pk_f16_f32 v167, v138, v139
    v_pk_fma_f32 v[126:127], v[124:125], v[66:67], v[126:127] op_sel:[1,1,0] op_sel_hi:[0,1,1] neg_lo:[1,0,0]
    ds_write2st64_b32 v41, v167, v164 offset0:99 offset1:66
    v_pk_mul_f32 v[128:129], v[126:127], v[66:67] op_sel_hi:[1,0]
    v_pk_mul_f32 v[140:141], v[126:127], v[68:69] op_sel_hi:[1,0]
    v_cvt_pk_f16_f32 v166, v126, v127
    v_pk_fma_f32 v[128:129], v[126:127], v[66:67], v[128:129] op_sel:[1,1,0] op_sel_hi:[0,1,1] neg_lo:[1,0,0]
    v_pk_fma_f32 v[140:141], v[126:127], v[68:69], v[140:141] op_sel:[1,1,0] op_sel_hi:[0,1,1] neg_lo:[1,0,0]
    ds_write_b32 v47, v166 offset:16896
    v_pk_mul_f32 v[130:131], v[128:129], v[66:67] op_sel_hi:[1,0]
    v_pk_mul_f32 v[146:147], v[140:141], v[68:69] op_sel_hi:[1,0]
    v_cvt_pk_f16_f32 v57, v128, v129
    v_cvt_pk_f16_f32 v162, v140, v141
    v_pk_fma_f32 v[130:131], v[128:129], v[66:67], v[130:131] op_sel:[1,1,0] op_sel_hi:[0,1,1] neg_lo:[1,0,0]
    v_pk_fma_f32 v[146:147], v[140:141], v[68:69], v[146:147] op_sel:[1,1,0] op_sel_hi:[0,1,1] neg_lo:[1,0,0]
    ds_write_b32 v48, v57 offset:16896
    v_pk_mul_f32 v[132:133], v[130:131], v[66:67] op_sel_hi:[1,0]
    v_pk_mul_f32 v[142:143], v[130:131], v[68:69] op_sel_hi:[1,0]
    v_cvt_pk_f16_f32 v163, v130, v131
    v_cvt_pk_f16_f32 v167, v146, v147
    v_pk_fma_f32 v[132:133], v[130:131], v[66:67], v[132:133] op_sel:[1,1,0] op_sel_hi:[0,1,1] neg_lo:[1,0,0]
    v_pk_fma_f32 v[142:143], v[130:131], v[68:69], v[142:143] op_sel:[1,1,0] op_sel_hi:[0,1,1] neg_lo:[1,0,0]
    ds_write2st64_b32 v45, v162, v165 offset0:99 offset1:66
    v_pk_mul_f32 v[134:135], v[132:133], v[66:67] op_sel_hi:[1,0]
    v_pk_mul_f32 v[150:151], v[146:147], v[68:69] op_sel_hi:[1,0]
    v_cvt_pk_f16_f32 v164, v132, v133
    v_cvt_pk_f16_f32 v166, v142, v143
    v_pk_fma_f32 v[134:135], v[132:133], v[66:67], v[134:135] op_sel:[1,1,0] op_sel_hi:[0,1,1] neg_lo:[1,0,0]
    v_pk_fma_f32 v[150:151], v[146:147], v[68:69], v[150:151] op_sel:[1,1,0] op_sel_hi:[0,1,1] neg_lo:[1,0,0]
    ds_write2st64_b32 v42, v167, v163 offset0:99 offset1:66
    v_pk_mul_f32 v[144:145], v[134:135], v[68:69] op_sel_hi:[1,0]
    v_pk_mul_f32 v[116:117], v[102:103], v[84:85] op_sel_hi:[1,0]
    ds_write_b32 v49, v164 offset:16896
    v_cvt_pk_f16_f32 v57, v134, v135
    v_cvt_pk_f16_f32 v162, v150, v151
    v_pk_fma_f32 v[144:145], v[134:135], v[68:69], v[144:145] op_sel:[1,1,0] op_sel_hi:[0,1,1] neg_lo:[1,0,0]
    v_pk_fma_f32 v[116:117], v[102:103], v[84:85], v[116:117] op_sel:[1,1,0] op_sel_hi:[0,1,1] neg_lo:[1,0,0]
    ds_write_b32 v50, v166 offset:16896
    v_pk_mul_f32 v[148:149], v[144:145], v[68:69] op_sel_hi:[1,0]
    v_pk_mul_f32 v[110:111], v[102:103], v[86:87] op_sel_hi:[1,0]
    v_cvt_pk_f16_f32 v165, v144, v145
    v_cvt_pk_f16_f32 v167, v116, v117
    v_pk_fma_f32 v[148:149], v[144:145], v[68:69], v[148:149] op_sel:[1,1,0] op_sel_hi:[0,1,1] neg_lo:[1,0,0]
    v_pk_fma_f32 v[110:111], v[102:103], v[86:87], v[110:111] op_sel:[1,1,0] op_sel_hi:[0,1,1] neg_lo:[1,0,0]
    ds_write2st64_b32 v43, v162, v57 offset0:99 offset1:66
    v_pk_mul_f32 v[152:153], v[148:149], v[68:69] op_sel_hi:[1,0]
    v_pk_mul_f32 v[112:113], v[102:103], v[88:89] op_sel_hi:[1,0]
    v_cvt_pk_f16_f32 v163, v148, v149
    v_cvt_pk_f16_f32 v164, v110, v111
    v_pk_fma_f32 v[152:153], v[148:149], v[68:69], v[152:153] op_sel:[1,1,0] op_sel_hi:[0,1,1] neg_lo:[1,0,0]
    v_pk_fma_f32 v[112:113], v[102:103], v[88:89], v[112:113] op_sel:[1,1,0] op_sel_hi:[0,1,1] neg_lo:[1,0,0]
    ds_write2st64_b32 v51, v167, v56 offset0:33 offset1:0
    v_pk_mul_f32 v[114:115], v[102:103], v[90:91] op_sel_hi:[1,0]
    v_pk_mul_f32 v[154:155], v[152:153], v[68:69] op_sel_hi:[1,0]
    v_cvt_pk_f16_f32 v166, v152, v153
    v_cvt_pk_f16_f32 v162, v112, v113
    v_pk_fma_f32 v[114:115], v[102:103], v[90:91], v[114:115] op_sel:[1,1,0] op_sel_hi:[0,1,1] neg_lo:[1,0,0]
    v_pk_fma_f32 v[154:155], v[152:153], v[68:69], v[154:155] op_sel:[1,1,0] op_sel_hi:[0,1,1] neg_lo:[1,0,0]
    ds_write2st64_b32 v44, v163, v165 offset0:99 offset1:66
    v_pk_mul_f32 v[116:117], v[102:103], v[92:93] op_sel_hi:[1,0]
    v_pk_mul_f32 v[156:157], v[154:155], v[68:69] op_sel_hi:[1,0]
    ds_write_b32 v51, v166 offset:16896
    v_cvt_pk_f16_f32 v57, v114, v115
    v_cvt_pk_f16_f32 v167, v154, v155
    v_pk_fma_f32 v[116:117], v[102:103], v[92:93], v[116:117] op_sel:[1,1,0] op_sel_hi:[0,1,1] neg_lo:[1,0,0]
    v_pk_fma_f32 v[156:157], v[154:155], v[68:69], v[156:157] op_sel:[1,1,0] op_sel_hi:[0,1,1] neg_lo:[1,0,0]
    ds_write2st64_b32 v52, v162, v164 offset0:33 offset1:0
    s_cmp_lt_u32 s3, 4
    s_cbranch_scc1 C_K6
    buffer_load_dwordx4 v[200:203], v2, s[32:35], s48 offen offset:0 sc1
    buffer_load_dwordx4 v[204:207], v2, s[32:35], s48 offen offset:1024 sc1
    buffer_load_dwordx4 v[208:211], v2, s[32:35], s48 offen offset:2048 sc1
C_K6:
    v_pk_mul_f32 v[110:111], v[102:103], v[94:95] op_sel_hi:[1,0]
    v_pk_mul_f32 v[112:113], v[102:103], v[96:97] op_sel_hi:[1,0]
    v_cvt_pk_f16_f32 v56, v116, v117
    v_cvt_pk_f16_f32 v163, v156, v157
    v_pk_fma_f32 v[110:111], v[102:103], v[94:95], v[110:111] op_sel:[1,1,0] op_sel_hi:[0,1,1] neg_lo:[1,0,0]
    v_pk_fma_f32 v[112:113], v[102:103], v[96:97], v[112:113] op_sel:[1,1,0] op_sel_hi:[0,1,1] neg_lo:[1,0,0]
    ds_write_b32 v52, v167 offset:16896
    v_pk_mul_f32 v[158:159], v[156:157], v[68:69] op_sel_hi:[1,0]
    v_pk_mul_f32 v[114:115], v[102:103], v[98:99] op_sel_hi:[1,0]
    ds_write2st64_b32 v53, v56, v57 offset0:33 offset1:0
    v_cvt_pk_f16_f32 v165, v110, v111
    v_cvt_pk_f16_f32 v166, v112, v113
    v_pk_fma_f32 v[158:159], v[156:157], v[68:69], v[158:159] op_sel:[1,1,0] op_sel_hi:[0,1,1] neg_lo:[1,0,0]
    v_pk_fma_f32 v[114:115], v[102:103], v[98:99], v[114:115] op_sel:[1,1,0] op_sel_hi:[0,1,1] neg_lo:[1,0,0]
    ds_write_b32 v53, v163 offset:16896
    v_pk_mul_f32 v[160:161], v[158:159], v[68:69] op_sel_hi:[1,0]
    v_pk_mul_f32 v[116:117], v[102:103], v[100:101] op_sel_hi:[1,0]
    v_cvt_pk_f16_f32 v162, v158, v159
    v_cvt_pk_f16_f32 v164, v114, v115
    v_pk_fma_f32 v[160:161], v[158:159], v[68:69], v[160:161] op_sel:[1,1,0] op_sel_hi:[0,1,1] neg_lo:[1,0,0]
    v_pk_fma_f32 v[116:117], v[102:103], v[100:101], v[116:117] op_sel:[1,1,0] op_sel_hi:[0,1,1] neg_lo:[1,0,0]
    ds_write2st64_b32 v54, v166, v165 offset0:33 offset1:0
    v_cvt_pk_f16_f32 v167, v160, v161
    v_cvt_pk_f16_f32 v56, v116, v117
    ds_write_b32 v54, v162 offset:16896
    ds_write_b32 v55, v167 offset:16896
    ds_write2st64_b32 v55, v56, v164 offset0:33 offset1:0
    s_cmp_ge_u32 s3, 4
    s_cbranch_scc1 H_PATH
    s_waitcnt vmcnt(7)
    v_add_u32 v195, s60, v195
    ds_read_b128 v[92:95], v195 offset:0
    ds_read_b128 v[96:99], v253 offset:0
    ds_read_b128 v[100:103], v195 offset:32
    ds_read_b128 v[104:107], v253 offset:32
    s_barrier
    ds_read_b128 v[108:111], v195 offset:64
    ds_read_b128 v[112:115], v253 offset:64
    ds_read_b128 v[116:119], v195 offset:96
    ds_read_b128 v[120:123], v253 offset:96
    ds_read_b128 v[124:127], v195 offset:128
    ds_read_b128 v[128:131], v253 offset:128
    ds_read_b128 v[132:135], v195 offset:160
    ds_read_b128 v[136:139], v253 offset:160
    ds_read_b128 v[140:143], v195 offset:192
    ds_read_b128 v[144:147], v253 offset:192
    s_waitcnt lgkmcnt(12)
    v_mfma_f32_32x32x16_f16 v[168:183], v[92:95], v[96:99], 0
    ds_read_b128 v[148:151], v195 offset:224
    ds_read_b128 v[152:155], v253 offset:224
    v_add_u32 v184, s62, v184
    v_add_u32 v185, s62, v185
    s_waitcnt lgkmcnt(12)
    v_mfma_f32_32x32x16_f16 v[168:183], v[100:103], v[104:107], v[168:183]
    ds_read_b128 v[92:95], v195 offset:256
    ds_read_b128 v[96:99], v253 offset:256
    v_add_u32 v186, s62, v186
    v_add_u32 v187, s62, v187
    s_waitcnt lgkmcnt(12)
    v_mfma_f32_32x32x16_f16 v[168:183], v[108:111], v[112:115], v[168:183]
    ds_read_b128 v[100:103], v195 offset:288
    ds_read_b128 v[104:107], v253 offset:288
    v_add_u32 v188, s62, v188
    v_add_u32 v189, s62, v189
    s_waitcnt lgkmcnt(12)
    v_mfma_f32_32x32x16_f16 v[168:183], v[116:119], v[120:123], v[168:183]
    ds_read_b128 v[108:111], v195 offset:320
    ds_read_b128 v[112:115], v253 offset:320
    v_add_u32 v190, s62, v190
    v_add_u32 v191, s62, v191
    s_waitcnt lgkmcnt(12)
    v_mfma_f32_32x32x16_f16 v[168:183], v[124:127], v[128:131], v[168:183]
    ds_read_b128 v[116:119], v195 offset:352
    ds_read_b128 v[120:123], v253 offset:352
    v_add_u32 v192, s62, v192
    v_add_u32 v193, s62, v193
    s_waitcnt lgkmcnt(12)
    v_mfma_f32_32x32x16_f16 v[168:183], v[132:135], v[136:139], v[168:183]
    ds_read_b128 v[124:127], v195 offset:384
    ds_read_b128 v[128:131], v253 offset:384
    v_add_u32 v194, s62, v194
    v_and_b32 v14, 15, v1
    s_waitcnt lgkmcnt(12)
    v_mfma_f32_32x32x16_f16 v[168:183], v[140:143], v[144:147], v[168:183]
    ds_read_b128 v[132:135], v195 offset:416
    ds_read_b128 v[136:139], v253 offset:416
    v_lshrrev_b32 v15, 4, v1
    s_mul_i32 s46, s51, 4640
    s_waitcnt lgkmcnt(12)
    v_mfma_f32_32x32x16_f16 v[168:183], v[148:151], v[152:155], v[168:183]
    ds_read_b128 v[140:143], v195 offset:448
    ds_read_b128 v[144:147], v253 offset:448
    s_add_u32 s46, s46, 114048
    v_lshlrev_b32 v248, 5, v14
    s_waitcnt lgkmcnt(12)
    v_mfma_f32_32x32x16_f16 v[168:183], v[92:95], v[96:99], v[168:183]
    ds_read_b128 v[148:151], v195 offset:480
    ds_read_b128 v[152:155], v253 offset:480
    v_lshl_add_u32 v248, v15, 4, v248
    v_add_u32 v248, s46, v248
    s_waitcnt lgkmcnt(12)
    v_mfma_f32_32x32x16_f16 v[168:183], v[100:103], v[104:107], v[168:183]
    s_mul_i32 s46, s51, 6144
    s_add_u32 s46, s46, 20480
    v_add_u32 v249, s46, v2
    v_lshlrev_b32 v250, 3, v15
    v_sub_u32 v250, v250, v14
    s_waitcnt lgkmcnt(10)
    v_mfma_f32_32x32x16_f16 v[168:183], v[108:111], v[112:115], v[168:183]
    v_add_u32 v250, 15, v250
    v_and_b32 v34, 1, v250
    v_mul_u32_u24 v34, 1090, v34
    v_lshl_add_u32 v250, v250, 1, v34
    v_add_u32 v250, s62, v250
    s_waitcnt lgkmcnt(8)
    v_mfma_f32_32x32x16_f16 v[168:183], v[116:119], v[120:123], v[168:183]
    v_lshlrev_b32 v251, 3, v14
    v_and_b32 v34, 1, v15
    v_lshl_add_u32 v251, v34, 8, v251
    v_lshrrev_b32 v34, 1, v15
    v_lshl_add_u32 v251, v34, 7, v251
    s_waitcnt lgkmcnt(6)
    v_mfma_f32_32x32x16_f16 v[168:183], v[124:127], v[128:131], v[168:183]
    s_mul_i32 s46, s51, 4128
    v_add_u32 v251, s46, v251
    v_add_u32 v252, 576, v250
    v_add_u32 v250, 64, v250
    s_and_b32 s46, s2, 7
    s_waitcnt lgkmcnt(4)
    v_mfma_f32_32x32x16_f16 v[168:183], v[132:135], v[136:139], v[168:183]
    s_mul_i32 s46, s46, 72
    s_lshr_b32 s53, s2, 3
    s_lshl_b32 s53, s53, 2
    s_add_u32 s46, s46, s53
    s_add_u32 s46, s46, s51
    s_waitcnt lgkmcnt(2)
    v_mfma_f32_32x32x16_f16 v[168:183], v[140:143], v[144:147], v[168:183]
    s_mul_i32 s46, s46, 9216
    s_add_u32 s46, s46, 4096
    v_add_u32 v27, s46, v2
    s_waitcnt lgkmcnt(0)
    v_mfma_f32_32x32x16_f16 v[168:183], v[148:151], v[152:155], v[168:183]
    s_nop 11
    v_cvt_pk_f16_f32 v196, v171, v170
    v_cvt_pk_f16_f32 v197, v169, v168
    v_cvt_pk_f16_f32 v198, v183, v182
    ds_write2_b32 v184, v196, v197 offset0:0 offset1:1
    v_cvt_pk_f16_f32 v199, v181, v180
    v_cvt_pk_f16_f32 v200, v175, v175
    ds_write2_b32 v185, v198, v199 offset0:0 offset1:1
    v_cvt_pk_f16_f32 v201, v174, v173
    v_cvt_pk_f16_f32 v202, v173, v173
    ds_write2_b32 v189, v200, v201 offset0:0 offset1:1
    ds_write_b32 v190, v200
    v_cvt_pk_f16_f32 v203, v172, v176
    ds_write2_b32 v188, v200, v202 offset0:0 offset1:2
    v_cvt_pk_f16_f32 v204, v175, v174
    ds_write2_b32 v189, v202, v203 offset0:2 offset1:3
    v_cvt_pk_f16_f32 v205, v173, v172
    ds_write_b32 v186, v204
    v_cvt_pk_f16_f32 v206, v176, v177
    ds_write_b32 v187, v205
    v_cvt_pk_f16_f32 v207, v178, v179
    ds_write_b16 v191, v206
    ds_write_b16_d16_hi v192, v206
    ds_write_b16 v193, v207
    ds_write_b16_d16_hi v194, v207
    ds_read2_b32 v[44:45], v252 offset0:48 offset1:49
    ds_read2_b32 v[46:47], v252 offset0:50 offset1:51
    ds_read2_b32 v[48:49], v252 offset0:32 offset1:33
    ds_read2_b32 v[50:51], v252 offset0:34 offset1:35
    ds_read2_b32 v[52:53], v252 offset0:16 offset1:17
    ds_read2_b32 v[54:55], v252 offset0:18 offset1:19
    ds_read2_b32 v[56:57], v252 offset0:0 offset1:1
    ds_read2_b32 v[58:59], v252 offset0:2 offset1:3
    ds_read2_b32 v[28:29], v252 offset0:112 offset1:113
    ds_read2_b32 v[30:31], v252 offset0:114 offset1:115
    ds_read2_b32 v[32:33], v252 offset0:96 offset1:97
    ds_read2_b32 v[34:35], v252 offset0:98 offset1:99
    ds_read2_b32 v[36:37], v252 offset0:80 offset1:81
    ds_read2_b32 v[38:39], v252 offset0:82 offset1:83
    ds_read2_b32 v[40:41], v252 offset0:64 offset1:65
    ds_read2_b32 v[42:43], v252 offset0:66 offset1:67
    s_waitcnt lgkmcnt(15)
    s_barrier
    ds_read_b128 v[92:95], v248 offset:480
    ds_read_b128 v[96:99], v248 offset:416
    ds_read_b128 v[100:103], v248 offset:352
    ds_read_b128 v[104:107], v248 offset:288
    ds_read_b128 v[108:111], v248 offset:992
    ds_read_b128 v[112:115], v248 offset:928
    ds_read_b128 v[116:119], v248 offset:864
    ds_read_b128 v[120:123], v248 offset:800
    s_waitcnt lgkmcnt(15)
    s_waitcnt lgkmcnt(7)
    v_mfma_f32_16x16x32_f16 v[188:191], v[44:47], v[92:95], 0
    ds_read2_b32 v[76:77], v250 offset0:48 offset1:49
    ds_read2_b32 v[78:79], v250 offset0:50 offset1:51
    s_waitcnt lgkmcnt(8)
    v_mfma_f32_16x16x32_f16 v[188:191], v[48:51], v[96:99], v[188:191]
    ds_read2_b32 v[80:81], v250 offset0:32 offset1:33
    ds_read2_b32 v[82:83], v250 offset0:34 offset1:35
    s_waitcnt lgkmcnt(9)
    v_mfma_f32_16x16x32_f16 v[188:191], v[52:55], v[100:103], v[188:191]
    ds_read2_b32 v[84:85], v250 offset0:16 offset1:17
    ds_read2_b32 v[86:87], v250 offset0:18 offset1:19
    s_waitcnt lgkmcnt(10)
    v_mfma_f32_16x16x32_f16 v[188:191], v[56:59], v[104:107], v[188:191]
    ds_read2_b32 v[88:89], v250 offset0:0 offset1:1
    ds_read2_b32 v[90:91], v250 offset0:2 offset1:3
    v_mfma_f32_16x16x32_f16 v[156:159], v[28:31], v[92:95], 0
    ds_read2_b32 v[60:61], v250 offset0:112 offset1:113
    ds_read2_b32 v[62:63], v250 offset0:114 offset1:115
    v_mfma_f32_16x16x32_f16 v[156:159], v[32:35], v[96:99], v[156:159]
    ds_read2_b32 v[64:65], v250 offset0:96 offset1:97
    ds_read2_b32 v[66:67], v250 offset0:98 offset1:99
    v_mfma_f32_16x16x32_f16 v[156:159], v[36:39], v[100:103], v[156:159]
    ds_read2_b32 v[68:69], v250 offset0:80 offset1:81
    ds_read2_b32 v[70:71], v250 offset0:82 offset1:83
    v_mfma_f32_16x16x32_f16 v[156:159], v[40:43], v[104:107], v[156:159]
    ds_read2_b32 v[72:73], v250 offset0:64 offset1:65
    ds_read2_b32 v[74:75], v250 offset0:66 offset1:67
    s_waitcnt lgkmcnt(15)
    v_mfma_f32_16x16x32_f16 v[192:195], v[44:47], v[108:111], 0
    ds_read_b128 v[124:127], v248 offset:1504
    v_mfma_f32_16x16x32_f16 v[192:195], v[48:51], v[112:115], v[192:195]
    ds_read_b128 v[128:131], v248 offset:1440
    s_waitcnt lgkmcnt(15)
    v_mfma_f32_16x16x32_f16 v[192:195], v[52:55], v[116:119], v[192:195]
    ds_read_b128 v[132:135], v248 offset:1376
    v_mfma_f32_16x16x32_f16 v[192:195], v[56:59], v[120:123], v[192:195]
    ds_read_b128 v[136:139], v248 offset:1312
    s_waitcnt lgkmcnt(15)
    v_mfma_f32_16x16x32_f16 v[192:195], v[76:79], v[92:95], v[192:195]
    v_add_f32_dpp v156, v188, v156 row_ror:8 row_mask:0xf bank_mask:0xc
    v_add_f32_dpp v157, v189, v157 row_ror:8 row_mask:0xf bank_mask:0xc
    s_waitcnt lgkmcnt(15)
    v_mfma_f32_16x16x32_f16 v[192:195], v[80:83], v[96:99], v[192:195]
    v_add_f32_dpp v158, v190, v158 row_ror:8 row_mask:0xf bank_mask:0xc
    v_add_f32_dpp v159, v191, v159 row_ror:8 row_mask:0xf bank_mask:0xc
    s_waitcnt lgkmcnt(14)
    v_mfma_f32_16x16x32_f16 v[192:195], v[84:87], v[100:103], v[192:195]
    v_cvt_pkrtz_f16_f32 v156, v156, v157
    v_cvt_pkrtz_f16_f32 v157, v158, v159
    s_waitcnt lgkmcnt(12)
    v_mfma_f32_16x16x32_f16 v[192:195], v[88:91], v[104:107], v[192:195]
    v_mfma_f32_16x16x32_f16 v[160:163], v[28:31], v[108:111], 0
    ds_write_b64 v251, v[156:157] offset:0
    v_mfma_f32_16x16x32_f16 v[160:163], v[32:35], v[112:115], v[160:163]
    v_mfma_f32_16x16x32_f16 v[160:163], v[36:39], v[116:119], v[160:163]
    v_mfma_f32_16x16x32_f16 v[160:163], v[40:43], v[120:123], v[160:163]
    s_waitcnt lgkmcnt(11)
    v_mfma_f32_16x16x32_f16 v[160:163], v[60:63], v[92:95], v[160:163]
    s_waitcnt lgkmcnt(9)
    v_mfma_f32_16x16x32_f16 v[160:163], v[64:67], v[96:99], v[160:163]
    v_mov_b32_dpp v188, v192 quad_perm:[0,1,2,3] row_mask:0xf bank_mask:0x3
    v_mov_b32_dpp v189, v193 quad_perm:[0,1,2,3] row_mask:0xf bank_mask:0x3
    s_waitcnt lgkmcnt(7)
    v_mfma_f32_16x16x32_f16 v[160:163], v[68:71], v[100:103], v[160:163]
    v_mov_b32_dpp v190, v194 quad_perm:[0,1,2,3] row_mask:0xf bank_mask:0x3
    v_mov_b32_dpp v191, v195 quad_perm:[0,1,2,3] row_mask:0xf bank_mask:0x3
    s_waitcnt lgkmcnt(5)
    v_mfma_f32_16x16x32_f16 v[160:163], v[72:75], v[104:107], v[160:163]
    s_waitcnt lgkmcnt(3)
    v_mfma_f32_16x16x32_f16 v[196:199], v[44:47], v[124:127], 0
    ds_read_b128 v[92:95], v248 offset:2016
    v_mfma_f32_16x16x32_f16 v[196:199], v[48:51], v[128:131], v[196:199]
    ds_read_b128 v[96:99], v248 offset:1952
    s_waitcnt lgkmcnt(3)
    v_mfma_f32_16x16x32_f16 v[196:199], v[52:55], v[132:135], v[196:199]
    ds_read_b128 v[100:103], v248 offset:1888
    v_mfma_f32_16x16x32_f16 v[196:199], v[56:59], v[136:139], v[196:199]
    ds_read_b128 v[104:107], v248 offset:1824
    v_mfma_f32_16x16x32_f16 v[196:199], v[76:79], v[108:111], v[196:199]
    v_add_f32_dpp v160, v188, v160 row_ror:8 row_mask:0xf bank_mask:0xf
    v_add_f32_dpp v161, v189, v161 row_ror:8 row_mask:0xf bank_mask:0xf
    v_mfma_f32_16x16x32_f16 v[196:199], v[80:83], v[112:115], v[196:199]
    v_add_f32_dpp v162, v190, v162 row_ror:8 row_mask:0xf bank_mask:0xf
    v_add_f32_dpp v163, v191, v163 row_ror:8 row_mask:0xf bank_mask:0xf
    v_mfma_f32_16x16x32_f16 v[196:199], v[84:87], v[116:119], v[196:199]
    v_cvt_pkrtz_f16_f32 v160, v160, v161
    v_cvt_pkrtz_f16_f32 v161, v162, v163
    v_mfma_f32_16x16x32_f16 v[196:199], v[88:91], v[120:123], v[196:199]
    v_mfma_f32_16x16x32_f16 v[164:167], v[28:31], v[124:127], 0
    ds_write_b64 v251, v[160:161] offset:512
    v_mfma_f32_16x16x32_f16 v[164:167], v[32:35], v[128:131], v[164:167]
    v_mfma_f32_16x16x32_f16 v[164:167], v[36:39], v[132:135], v[164:167]
    v_mfma_f32_16x16x32_f16 v[164:167], v[40:43], v[136:139], v[164:167]
    v_mfma_f32_16x16x32_f16 v[164:167], v[60:63], v[108:111], v[164:167]
    v_mfma_f32_16x16x32_f16 v[164:167], v[64:67], v[112:115], v[164:167]
    s_nop 0
    v_mov_b32_dpp v192, v196 quad_perm:[0,1,2,3] row_mask:0xf bank_mask:0x3
    v_mov_b32_dpp v193, v197 quad_perm:[0,1,2,3] row_mask:0xf bank_mask:0x3
    s_waitcnt lgkmcnt(0)
    s_barrier
    ds_read_b128 v[148:151], v249 offset:0
    ds_read_b128 v[152:155], v249 offset:1024
    v_mfma_f32_16x16x32_f16 v[164:167], v[68:71], v[116:119], v[164:167]
    v_mov_b32_dpp v194, v198 quad_perm:[0,1,2,3] row_mask:0xf bank_mask:0x3
    v_mov_b32_dpp v195, v199 quad_perm:[0,1,2,3] row_mask:0xf bank_mask:0x3
    v_mfma_f32_16x16x32_f16 v[164:167], v[72:75], v[120:123], v[164:167]
    v_mfma_f32_16x16x32_f16 v[188:191], v[44:47], v[92:95], 0
    ds_read_b128 v[108:111], v248 offset:2528
    v_mfma_f32_16x16x32_f16 v[188:191], v[48:51], v[96:99], v[188:191]
    ds_read_b128 v[112:115], v248 offset:2464
    v_mfma_f32_16x16x32_f16 v[188:191], v[52:55], v[100:103], v[188:191]
    ds_read_b128 v[116:119], v248 offset:2400
    v_mfma_f32_16x16x32_f16 v[188:191], v[56:59], v[104:107], v[188:191]
    ds_read_b128 v[120:123], v248 offset:2336
    v_mfma_f32_16x16x32_f16 v[188:191], v[76:79], v[124:127], v[188:191]
    v_add_f32_dpp v164, v192, v164 row_ror:8 row_mask:0xf bank_mask:0xf
    v_add_f32_dpp v165, v193, v165 row_ror:8 row_mask:0xf bank_mask:0xf
    v_mfma_f32_16x16x32_f16 v[188:191], v[80:83], v[128:131], v[188:191]
    v_add_f32_dpp v166, v194, v166 row_ror:8 row_mask:0xf bank_mask:0xf
    v_add_f32_dpp v167, v195, v167 row_ror:8 row_mask:0xf bank_mask:0xf
    v_mfma_f32_16x16x32_f16 v[188:191], v[84:87], v[132:135], v[188:191]
    s_waitcnt lgkmcnt(5)
    v_add_f32 v164, v164, v148
    v_add_f32 v165, v165, v149
    v_mfma_f32_16x16x32_f16 v[188:191], v[88:91], v[136:139], v[188:191]
    v_add_f32 v166, v166, v150
    v_add_f32 v167, v167, v151
    s_waitcnt lgkmcnt(4)
    v_mfma_f32_16x16x32_f16 v[152:155], v[28:31], v[92:95], v[152:155]
    v_cvt_pkrtz_f16_f32 v164, v164, v165
    v_cvt_pkrtz_f16_f32 v165, v166, v167
    v_mfma_f32_16x16x32_f16 v[152:155], v[32:35], v[96:99], v[152:155]
    v_mfma_f32_16x16x32_f16 v[152:155], v[36:39], v[100:103], v[152:155]
    ds_write_b64 v251, v[164:165] offset:1024
    v_mfma_f32_16x16x32_f16 v[152:155], v[40:43], v[104:107], v[152:155]
    v_mfma_f32_16x16x32_f16 v[152:155], v[60:63], v[124:127], v[152:155]
    v_mfma_f32_16x16x32_f16 v[152:155], v[64:67], v[128:131], v[152:155]
    v_mov_b32_dpp v196, v188 quad_perm:[0,1,2,3] row_mask:0xf bank_mask:0x3
    v_mov_b32_dpp v197, v189 quad_perm:[0,1,2,3] row_mask:0xf bank_mask:0x3
    v_mfma_f32_16x16x32_f16 v[152:155], v[68:71], v[132:135], v[152:155]
    v_mov_b32_dpp v198, v190 quad_perm:[0,1,2,3] row_mask:0xf bank_mask:0x3
    v_mov_b32_dpp v199, v191 quad_perm:[0,1,2,3] row_mask:0xf bank_mask:0x3
    v_mfma_f32_16x16x32_f16 v[152:155], v[72:75], v[136:139], v[152:155]
    s_waitcnt lgkmcnt(3)
    v_mfma_f32_16x16x32_f16 v[192:195], v[44:47], v[108:111], 0
    ds_read_b128 v[124:127], v248 offset:3040
    v_mfma_f32_16x16x32_f16 v[192:195], v[48:51], v[112:115], v[192:195]
    ds_read_b128 v[128:131], v248 offset:2976
    s_waitcnt lgkmcnt(3)
    v_mfma_f32_16x16x32_f16 v[192:195], v[52:55], v[116:119], v[192:195]
    ds_read_b128 v[132:135], v248 offset:2912
    v_mfma_f32_16x16x32_f16 v[192:195], v[56:59], v[120:123], v[192:195]
    ds_read_b128 v[136:139], v248 offset:2848
    v_mfma_f32_16x16x32_f16 v[192:195], v[76:79], v[92:95], v[192:195]
    v_add_f32_dpp v152, v196, v152 row_ror:8 row_mask:0xf bank_mask:0xf
    v_add_f32_dpp v153, v197, v153 row_ror:8 row_mask:0xf bank_mask:0xf
    v_mfma_f32_16x16x32_f16 v[192:195], v[80:83], v[96:99], v[192:195]
    v_add_f32_dpp v154, v198, v154 row_ror:8 row_mask:0xf bank_mask:0xf
    v_add_f32_dpp v155, v199, v155 row_ror:8 row_mask:0xf bank_mask:0xf
    v_mfma_f32_16x16x32_f16 v[192:195], v[84:87], v[100:103], v[192:195]
    v_cvt_pkrtz_f16_f32 v152, v152, v153
    v_cvt_pkrtz_f16_f32 v153, v154, v155
    v_mfma_f32_16x16x32_f16 v[192:195], v[88:91], v[104:107], v[192:195]
    v_mfma_f32_16x16x32_f16 v[172:175], v[28:31], v[108:111], 0
    ds_write_b64 v251, v[152:153] offset:1536
    v_mfma_f32_16x16x32_f16 v[172:175], v[32:35], v[112:115], v[172:175]
    v_mfma_f32_16x16x32_f16 v[172:175], v[36:39], v[116:119], v[172:175]
    v_mfma_f32_16x16x32_f16 v[172:175], v[40:43], v[120:123], v[172:175]
    v_mfma_f32_16x16x32_f16 v[172:175], v[60:63], v[92:95], v[172:175]
    v_mfma_f32_16x16x32_f16 v[172:175], v[64:67], v[96:99], v[172:175]
    s_nop 0
    v_mov_b32_dpp v188, v192 quad_perm:[0,1,2,3] row_mask:0xf bank_mask:0x3
    v_mov_b32_dpp v189, v193 quad_perm:[0,1,2,3] row_mask:0xf bank_mask:0x3
    s_waitcnt lgkmcnt(0)
    s_barrier
    ds_read_b128 v[140:143], v249 offset:2048
    ds_read_b128 v[144:147], v249 offset:3072
    v_mfma_f32_16x16x32_f16 v[172:175], v[68:71], v[100:103], v[172:175]
    v_mov_b32_dpp v190, v194 quad_perm:[0,1,2,3] row_mask:0xf bank_mask:0x3
    v_mov_b32_dpp v191, v195 quad_perm:[0,1,2,3] row_mask:0xf bank_mask:0x3
    v_mfma_f32_16x16x32_f16 v[172:175], v[72:75], v[104:107], v[172:175]
    v_mfma_f32_16x16x32_f16 v[196:199], v[44:47], v[124:127], 0
    ds_read_b128 v[92:95], v248 offset:3552
    v_mfma_f32_16x16x32_f16 v[196:199], v[48:51], v[128:131], v[196:199]
    ds_read_b128 v[96:99], v248 offset:3488
    v_mfma_f32_16x16x32_f16 v[196:199], v[52:55], v[132:135], v[196:199]
    ds_read_b128 v[100:103], v248 offset:3424
    v_mfma_f32_16x16x32_f16 v[196:199], v[56:59], v[136:139], v[196:199]
    ds_read_b128 v[104:107], v248 offset:3360
    v_mfma_f32_16x16x32_f16 v[196:199], v[76:79], v[108:111], v[196:199]
    v_add_f32_dpp v172, v188, v172 row_ror:8 row_mask:0xf bank_mask:0xf
    v_add_f32_dpp v173, v189, v173 row_ror:8 row_mask:0xf bank_mask:0xf
    v_mfma_f32_16x16x32_f16 v[196:199], v[80:83], v[112:115], v[196:199]
    v_add_f32_dpp v174, v190, v174 row_ror:8 row_mask:0xf bank_mask:0xf
    v_add_f32_dpp v175, v191, v175 row_ror:8 row_mask:0xf bank_mask:0xf
    v_mfma_f32_16x16x32_f16 v[196:199], v[84:87], v[116:119], v[196:199]
    s_waitcnt lgkmcnt(5)
    v_add_f32 v172, v172, v140
    v_add_f32 v173, v173, v141
    v_mfma_f32_16x16x32_f16 v[196:199], v[88:91], v[120:123], v[196:199]
    v_add_f32 v174, v174, v142
    v_add_f32 v175, v175, v143
    s_waitcnt lgkmcnt(4)
    v_mfma_f32_16x16x32_f16 v[144:147], v[28:31], v[124:127], v[144:147]
    v_cvt_pkrtz_f16_f32 v172, v172, v173
    v_cvt_pkrtz_f16_f32 v173, v174, v175
    v_mfma_f32_16x16x32_f16 v[144:147], v[32:35], v[128:131], v[144:147]
    v_mfma_f32_16x16x32_f16 v[144:147], v[36:39], v[132:135], v[144:147]
    ds_write_b64 v251, v[172:173] offset:2048
    v_mfma_f32_16x16x32_f16 v[144:147], v[40:43], v[136:139], v[144:147]
    v_mfma_f32_16x16x32_f16 v[144:147], v[60:63], v[108:111], v[144:147]
    v_mfma_f32_16x16x32_f16 v[144:147], v[64:67], v[112:115], v[144:147]
    v_mov_b32_dpp v192, v196 quad_perm:[0,1,2,3] row_mask:0xf bank_mask:0x3
    v_mov_b32_dpp v193, v197 quad_perm:[0,1,2,3] row_mask:0xf bank_mask:0x3
    v_mfma_f32_16x16x32_f16 v[144:147], v[68:71], v[116:119], v[144:147]
    v_mov_b32_dpp v194, v198 quad_perm:[0,1,2,3] row_mask:0xf bank_mask:0x3
    v_mov_b32_dpp v195, v199 quad_perm:[0,1,2,3] row_mask:0xf bank_mask:0x3
    v_mfma_f32_16x16x32_f16 v[144:147], v[72:75], v[120:123], v[144:147]
    s_waitcnt lgkmcnt(3)
    v_mfma_f32_16x16x32_f16 v[188:191], v[44:47], v[92:95], 0
    ds_read_b128 v[108:111], v248 offset:4064
    v_mfma_f32_16x16x32_f16 v[188:191], v[48:51], v[96:99], v[188:191]
    ds_read_b128 v[112:115], v248 offset:4000
    s_waitcnt lgkmcnt(3)
    v_mfma_f32_16x16x32_f16 v[188:191], v[52:55], v[100:103], v[188:191]
    ds_read_b128 v[116:119], v248 offset:3936
    v_mfma_f32_16x16x32_f16 v[188:191], v[56:59], v[104:107], v[188:191]
    ds_read_b128 v[120:123], v248 offset:3872
    v_mfma_f32_16x16x32_f16 v[188:191], v[76:79], v[124:127], v[188:191]
    v_add_f32_dpp v144, v192, v144 row_ror:8 row_mask:0xf bank_mask:0xf
    v_add_f32_dpp v145, v193, v145 row_ror:8 row_mask:0xf bank_mask:0xf
    v_mfma_f32_16x16x32_f16 v[188:191], v[80:83], v[128:131], v[188:191]
    v_add_f32_dpp v146, v194, v146 row_ror:8 row_mask:0xf bank_mask:0xf
    v_add_f32_dpp v147, v195, v147 row_ror:8 row_mask:0xf bank_mask:0xf
    v_mfma_f32_16x16x32_f16 v[188:191], v[84:87], v[132:135], v[188:191]
    v_cvt_pkrtz_f16_f32 v144, v144, v145
    v_cvt_pkrtz_f16_f32 v145, v146, v147
    v_mfma_f32_16x16x32_f16 v[188:191], v[88:91], v[136:139], v[188:191]
    v_mfma_f32_16x16x32_f16 v[180:183], v[28:31], v[92:95], 0
    ds_write_b64 v251, v[144:145] offset:2560
    v_mfma_f32_16x16x32_f16 v[180:183], v[32:35], v[96:99], v[180:183]
    v_mfma_f32_16x16x32_f16 v[180:183], v[36:39], v[100:103], v[180:183]
    v_mfma_f32_16x16x32_f16 v[180:183], v[40:43], v[104:107], v[180:183]
    v_mfma_f32_16x16x32_f16 v[180:183], v[60:63], v[124:127], v[180:183]
    s_waitcnt lgkmcnt(0)
    s_barrier
    ds_read_b128 v[148:151], v249 offset:4096
    ds_read_b128 v[152:155], v249 offset:5120
    v_mfma_f32_16x16x32_f16 v[180:183], v[64:67], v[128:131], v[180:183]
    v_mov_b32_dpp v196, v188 quad_perm:[0,1,2,3] row_mask:0xf bank_mask:0x3
    v_mov_b32_dpp v197, v189 quad_perm:[0,1,2,3] row_mask:0xf bank_mask:0x3
    v_mfma_f32_16x16x32_f16 v[180:183], v[68:71], v[132:135], v[180:183]
    v_mov_b32_dpp v198, v190 quad_perm:[0,1,2,3] row_mask:0xf bank_mask:0x3
    v_mov_b32_dpp v199, v191 quad_perm:[0,1,2,3] row_mask:0xf bank_mask:0x3
    v_mfma_f32_16x16x32_f16 v[180:183], v[72:75], v[136:139], v[180:183]
    v_mfma_f32_16x16x32_f16 v[192:195], v[44:47], v[108:111], 0
    v_mfma_f32_16x16x32_f16 v[192:195], v[48:51], v[112:115], v[192:195]
    v_mfma_f32_16x16x32_f16 v[192:195], v[52:55], v[116:119], v[192:195]
    v_mfma_f32_16x16x32_f16 v[192:195], v[56:59], v[120:123], v[192:195]
    v_mfma_f32_16x16x32_f16 v[192:195], v[76:79], v[92:95], v[192:195]
    v_mfma_f32_16x16x32_f16 v[192:195], v[80:83], v[96:99], v[192:195]
    s_nop 1
    v_add_f32_dpp v180, v196, v180 row_ror:8 row_mask:0xf bank_mask:0xf
    v_add_f32_dpp v181, v197, v181 row_ror:8 row_mask:0xf bank_mask:0xf
    v_mfma_f32_16x16x32_f16 v[192:195], v[84:87], v[100:103], v[192:195]
    v_add_f32_dpp v182, v198, v182 row_ror:8 row_mask:0xf bank_mask:0xf
    v_add_f32_dpp v183, v199, v183 row_ror:8 row_mask:0xf bank_mask:0xf
    v_mfma_f32_16x16x32_f16 v[192:195], v[88:91], v[104:107], v[192:195]
    s_waitcnt lgkmcnt(1)
    v_add_f32 v180, v180, v148
    v_add_f32 v181, v181, v149
    s_waitcnt lgkmcnt(0)
    v_mfma_f32_16x16x32_f16 v[152:155], v[28:31], v[108:111], v[152:155]
    v_add_f32 v182, v182, v150
    v_add_f32 v183, v183, v151
    v_mfma_f32_16x16x32_f16 v[152:155], v[32:35], v[112:115], v[152:155]
    v_cvt_pkrtz_f16_f32 v180, v180, v181
    v_cvt_pkrtz_f16_f32 v181, v182, v183
    v_mfma_f32_16x16x32_f16 v[152:155], v[36:39], v[116:119], v[152:155]
    v_mfma_f32_16x16x32_f16 v[152:155], v[40:43], v[120:123], v[152:155]
    ds_write_b64 v251, v[180:181] offset:3072
    s_waitcnt lgkmcnt(0)
    s_barrier
    v_mfma_f32_16x16x32_f16 v[152:155], v[60:63], v[92:95], v[152:155]
    v_mfma_f32_16x16x32_f16 v[152:155], v[64:67], v[96:99], v[152:155]
    v_mov_b32_dpp v188, v192 quad_perm:[0,1,2,3] row_mask:0xf bank_mask:0x3
    v_mov_b32_dpp v189, v193 quad_perm:[0,1,2,3] row_mask:0xf bank_mask:0x3
    v_mfma_f32_16x16x32_f16 v[152:155], v[68:71], v[100:103], v[152:155]
    v_mov_b32_dpp v190, v194 quad_perm:[0,1,2,3] row_mask:0xf bank_mask:0x3
    v_mov_b32_dpp v191, v195 quad_perm:[0,1,2,3] row_mask:0xf bank_mask:0x3
    v_mfma_f32_16x16x32_f16 v[152:155], v[72:75], v[104:107], v[152:155]
    s_nop 7
    v_add_f32_dpp v152, v188, v152 row_ror:8 row_mask:0xf bank_mask:0xf
    v_add_f32_dpp v153, v189, v153 row_ror:8 row_mask:0xf bank_mask:0xf
    v_add_f32_dpp v154, v190, v154 row_ror:8 row_mask:0xf bank_mask:0xf
    v_add_f32_dpp v155, v191, v155 row_ror:8 row_mask:0xf bank_mask:0xf
    v_cvt_pkrtz_f16_f32 v152, v152, v153
    v_cvt_pkrtz_f16_f32 v153, v154, v155
    ds_write_b64 v251, v[152:153] offset:3584
    s_waitcnt lgkmcnt(0)
    s_barrier
    s_waitcnt vmcnt(0)
    s_branch RPREP
H_PATH:
    s_waitcnt lgkmcnt(0)
    s_barrier
    v_and_b32 v14, 15, v1
    v_lshrrev_b32 v15, 4, v1
    s_mul_i32 s46, s51, 4640
    s_add_u32 s46, s46, 114048
    v_lshlrev_b32 v248, 5, v14
    v_lshl_add_u32 v248, v15, 4, v248
    v_add_u32 v248, s46, v248
    s_mul_i32 s46, s51, 6144
    s_add_u32 s46, s46, 20480
    v_add_u32 v249, s46, v2
    v_lshlrev_b32 v250, 3, v15
    v_sub_u32 v250, v250, v14
    v_add_u32 v250, 15, v250
    v_and_b32 v34, 1, v250
    v_mul_u32_u24 v34, 1090, v34
    v_lshl_add_u32 v250, v250, 1, v34
    v_add_u32 v250, s62, v250
    v_lshlrev_b32 v251, 2, v15
    v_sub_u32 v251, v251, v14
    v_lshlrev_b32 v251, 2, v251
    s_add_u32 s46, s62, 2252
    v_add_u32 v251, s46, v251
    v_bfe_u32 v34, v1, 2, 2
    v_mul_u32_u24 v34, 4128, v34
    v_and_b32 v35, 1, v1
    v_lshl_add_u32 v34, v35, 7, v34
    v_lshl_add_u32 v34, v15, 4, v34
    v_and_b32 v35, 2, v1
    v_lshl_add_u32 v34, v35, 2, v34
    s_and_b32 s46, s3, 1
    s_lshl_b32 s46, s46, 6
    v_add_u32 v252, s46, v34
    v_lshrrev_b32 v34, 3, v1
    v_mul_u32_u24 v34, 18432, v34
    v_and_b32 v35, 7, v1
    v_lshl_add_u32 v253, v35, 4, v34
    s_and_b32 s46, s3, 1
    s_mul_i32 s46, s46, 147456
    s_lshl_b32 s63, s2, 7
    s_add_u32 s63, s63, s46
    s_add_u32 s63, s63, 4194304
    v_and_b32 v34, 3, v1
    v_mul_u32_u24 v34, 4640, v34
    v_lshrrev_b32 v35, 2, v1
    v_lshl_add_u32 v34, v35, 4, v34
    s_mul_i32 s46, s51, 768
    s_add_u32 s46, s46, 114560
    v_add_u32 v254, s46, v34
    s_cmp_lt_u32 s49, 128
    s_cbranch_scc1 H_UI
    v_subrev_u32 v14, 9472, v25
    v_subrev_u32 v15, 9472, v26
    ds_read_b128 v[120:123], v14
    ds_read_b128 v[124:127], v14 offset:512
    ds_read_b32 v128, v15 offset:1024
    s_mov_b32 s46, 10485760
    s_waitcnt lgkmcnt(0)
    v_add_u32 v120, v11, v120
    v_add_u32 v121, v11, v121
    v_add_u32 v122, v11, v122
    v_add_u32 v123, v11, v123
    v_add_u32 v124, v11, v124
    v_add_u32 v125, v11, v125
    v_add_u32 v126, v11, v126
    v_add_u32 v127, v11, v127
    v_add_u32 v128, v11, v128
    v_and_or_b32 v120, v120, v9, v10
    v_and_or_b32 v121, v121, v9, v10
    v_and_or_b32 v122, v122, v9, v10
    v_and_or_b32 v123, v123, v9, v10
    v_and_or_b32 v124, v124, v9, v10
    v_and_or_b32 v125, v125, v9, v10
    v_and_or_b32 v126, v126, v9, v10
    v_and_or_b32 v127, v127, v9, v10
    v_and_or_b32 v128, v128, v9, v10
    buffer_store_dwordx4 v[120:123], v4, s[32:35], s46 offen sc1
    buffer_store_dwordx4 v[124:127], v4, s[32:35], s46 offen offset:512 sc1
    buffer_store_dword v128, v5, s[32:35], s46 offen offset:1024 sc1
H_UI:
    s_mov_b32 s47, 0
PL2:
    s_waitcnt vmcnt(0)
    v_xor_b32 v200, v10, v200
    v_xor_b32 v201, v10, v201
    v_xor_b32 v202, v10, v202
    v_xor_b32 v203, v10, v203
    v_xor_b32 v204, v10, v204
    v_xor_b32 v205, v10, v205
    v_xor_b32 v206, v10, v206
    v_xor_b32 v207, v10, v207
    v_xor_b32 v208, v10, v208
    v_xor_b32 v209, v10, v209
    v_xor_b32 v210, v10, v210
    v_xor_b32 v211, v10, v211
    v_or3_b32 v14, v200, v201, v202
    v_or3_b32 v14, v14, v203, v204
    v_or3_b32 v14, v14, v205, v206
    v_or3_b32 v14, v14, v207, v208
    v_or3_b32 v14, v14, v209, v210
    v_or_b32 v14, v14, v211
    v_and_b32 v14, 0x70007, v14
    v_cmp_ne_u32 vcc, 0, v14
    s_cbranch_vccz PD3
    s_add_u32 s47, s47, 1
    s_cmp_ge_u32 s47, 65536
    s_cbranch_scc1 PD3
    s_sleep 2
    buffer_load_dwordx4 v[200:203], v2, s[32:35], s48 offen offset:0 sc1
    buffer_load_dwordx4 v[204:207], v2, s[32:35], s48 offen offset:1024 sc1
    buffer_load_dwordx4 v[208:211], v2, s[32:35], s48 offen offset:2048 sc1
    s_branch PL2
PD3:
    ds_write_b128 v254, v[200:203] offset:0
    ds_write_b128 v254, v[204:207] offset:256
    ds_write_b128 v254, v[208:211] offset:512
    buffer_load_dwordx4 v[244:247], v2, s[32:35], s59 offen sc1
    s_lshl_b32 s46, s51, 9
    v_subrev_u32 v254, s46, v254
    v_mov_b32 v15, s62
    s_setprio 1
    s_waitcnt lgkmcnt(0)
    s_barrier
    ds_read_b128 v[28:31], v248 offset:480
    ds_read_b128 v[32:35], v248 offset:464
    ds_read_b128 v[36:39], v248 offset:992
    ds_read_b128 v[40:43], v248 offset:976
    s_waitcnt lgkmcnt(3)
    v_mfma_f32_16x16x32_f16 v[76:79], v[28:31], v[172:175], 0
    v_mfma_f32_16x16x32_f16 v[80:83], v[28:31], v[168:171], 0
    v_mfma_f32_16x16x32_f16 v[88:91], v[28:31], v[176:179], 0
    s_waitcnt lgkmcnt(2)
    v_mfma_f32_16x16x32_f16 v[84:87], v[32:35], v[180:183], 0
    ds_read_b128 v[44:47], v248 offset:1504
    ds_read_b128 v[48:51], v248 offset:1488
    v_mfma_f32_16x16x32_f16 v[92:95], v[28:31], v[184:187], 0
    s_nop 1
    v_cvt_pk_f16_f32 v100, v76, v80
    v_cvt_pk_f16_f32 v101, v77, v81
    v_mfma_f32_16x16x32_f16 v[96:99], v[32:35], v[188:191], 0
    v_cvt_pk_f16_f32 v102, v78, v82
    v_cvt_pk_f16_f32 v103, v79, v83
    s_waitcnt lgkmcnt(3)
    v_mfma_f32_16x16x32_f16 v[76:79], v[36:39], v[172:175], 0
    v_cvt_pk_f16_f32 v104, v84, v88
    v_cvt_pk_f16_f32 v105, v85, v89
    v_mfma_f32_16x16x32_f16 v[80:83], v[36:39], v[168:171], 0
    v_cvt_pk_f16_f32 v106, v86, v90
    v_cvt_pk_f16_f32 v107, v87, v91
    v_mfma_f32_16x16x32_f16 v[88:91], v[36:39], v[176:179], 0
    v_cvt_pk_f16_f32 v148, v92, v96
    v_cvt_pk_f16_f32 v149, v93, v97
    s_waitcnt lgkmcnt(2)
    v_mfma_f32_16x16x32_f16 v[84:87], v[40:43], v[180:183], 0
    v_cvt_pk_f16_f32 v150, v94, v98
    v_cvt_pk_f16_f32 v151, v95, v99
    ds_read_b128 v[52:55], v248 offset:2016
    ds_read_b128 v[56:59], v248 offset:2000
    v_mfma_f32_16x16x32_f16 v[92:95], v[36:39], v[184:187], 0
    v_cvt_pk_f16_f32 v108, v76, v80
    v_cvt_pk_f16_f32 v109, v77, v81
    v_mfma_f32_16x16x32_f16 v[96:99], v[40:43], v[188:191], 0
    v_cvt_pk_f16_f32 v110, v78, v82
    v_cvt_pk_f16_f32 v111, v79, v83
    s_waitcnt lgkmcnt(3)
    v_mfma_f32_16x16x32_f16 v[76:79], v[44:47], v[172:175], 0
    v_cvt_pk_f16_f32 v112, v84, v88
    v_cvt_pk_f16_f32 v113, v85, v89
    v_mfma_f32_16x16x32_f16 v[80:83], v[44:47], v[168:171], 0
    v_cvt_pk_f16_f32 v114, v86, v90
    v_cvt_pk_f16_f32 v115, v87, v91
    ds_read_b128 v[60:63], v248 offset:2528
    ds_read_b128 v[64:67], v248 offset:2512
    v_mfma_f32_16x16x32_f16 v[88:91], v[44:47], v[176:179], 0
    v_cvt_pk_f16_f32 v152, v92, v96
    v_cvt_pk_f16_f32 v153, v93, v97
    s_waitcnt lgkmcnt(4)
    v_mfma_f32_16x16x32_f16 v[84:87], v[48:51], v[180:183], 0
    v_cvt_pk_f16_f32 v154, v94, v98
    v_cvt_pk_f16_f32 v155, v95, v99
    v_mfma_f32_16x16x32_f16 v[92:95], v[44:47], v[184:187], 0
    v_cvt_pk_f16_f32 v116, v76, v80
    v_cvt_pk_f16_f32 v117, v77, v81
    v_mfma_f32_16x16x32_f16 v[96:99], v[48:51], v[188:191], 0
    v_cvt_pk_f16_f32 v118, v78, v82
    v_cvt_pk_f16_f32 v119, v79, v83
    ds_read_b128 v[68:71], v248 offset:3040
    ds_read_b128 v[72:75], v248 offset:3024
    s_waitcnt lgkmcnt(5)
    v_mfma_f32_16x16x32_f16 v[76:79], v[52:55], v[172:175], 0
    v_cvt_pk_f16_f32 v120, v84, v88
    v_cvt_pk_f16_f32 v121, v85, v89
    v_mfma_f32_16x16x32_f16 v[80:83], v[52:55], v[168:171], 0
    v_cvt_pk_f16_f32 v122, v86, v90
    v_cvt_pk_f16_f32 v123, v87, v91
    v_mfma_f32_16x16x32_f16 v[88:91], v[52:55], v[176:179], 0
    v_cvt_pk_f16_f32 v156, v92, v96
    v_cvt_pk_f16_f32 v157, v93, v97
    s_waitcnt lgkmcnt(4)
    v_mfma_f32_16x16x32_f16 v[84:87], v[56:59], v[180:183], 0
    v_cvt_pk_f16_f32 v158, v94, v98
    v_cvt_pk_f16_f32 v159, v95, v99
    ds_read2_b32 v[196:197], v250 offset0:0 offset1:1
    ds_read2_b32 v[198:199], v250 offset0:2 offset1:3
    v_mfma_f32_16x16x32_f16 v[92:95], v[52:55], v[184:187], 0
    v_cvt_pk_f16_f32 v124, v76, v80
    v_cvt_pk_f16_f32 v125, v77, v81
    v_mfma_f32_16x16x32_f16 v[96:99], v[56:59], v[188:191], 0
    v_cvt_pk_f16_f32 v126, v78, v82
    v_cvt_pk_f16_f32 v127, v79, v83
    ds_read2_b32 v[200:201], v251 offset0:32 offset1:33
    ds_read2_b32 v[202:203], v251 offset0:34 offset1:35
    s_waitcnt lgkmcnt(7)
    v_mfma_f32_16x16x32_f16 v[76:79], v[60:63], v[172:175], 0
    v_cvt_pk_f16_f32 v128, v84, v88
    v_cvt_pk_f16_f32 v129, v85, v89
    v_mfma_f32_16x16x32_f16 v[80:83], v[60:63], v[168:171], 0
    v_cvt_pk_f16_f32 v130, v86, v90
    v_cvt_pk_f16_f32 v131, v87, v91
    ds_read2_b32 v[204:205], v251 offset0:80 offset1:81
    ds_read2_b32 v[206:207], v251 offset0:82 offset1:83
    v_mfma_f32_16x16x32_f16 v[88:91], v[60:63], v[176:179], 0
    v_cvt_pk_f16_f32 v160, v92, v96
    v_cvt_pk_f16_f32 v161, v93, v97
    s_waitcnt lgkmcnt(8)
    v_mfma_f32_16x16x32_f16 v[84:87], v[64:67], v[180:183], 0
    v_cvt_pk_f16_f32 v162, v94, v98
    v_cvt_pk_f16_f32 v163, v95, v99
    ds_read2_b32 v[208:209], v251 offset0:16 offset1:17
    ds_read2_b32 v[210:211], v251 offset0:18 offset1:19
    s_waitcnt lgkmcnt(9)
    v_mfma_f32_16x16x32_f16 v[92:95], v[68:71], v[172:175], 0
    v_cvt_pk_f16_f32 v132, v76, v80
    v_cvt_pk_f16_f32 v133, v77, v81
    v_mfma_f32_16x16x32_f16 v[96:99], v[68:71], v[168:171], 0
    v_cvt_pk_f16_f32 v134, v78, v82
    v_cvt_pk_f16_f32 v135, v79, v83
    ds_read2_b32 v[212:213], v251 offset0:64 offset1:65
    ds_read2_b32 v[214:215], v251 offset0:66 offset1:67
    v_mfma_f32_16x16x32_f16 v[80:83], v[68:71], v[176:179], 0
    v_cvt_pk_f16_f32 v136, v84, v88
    v_cvt_pk_f16_f32 v137, v85, v89
    s_waitcnt lgkmcnt(10)
    v_mfma_f32_16x16x32_f16 v[76:79], v[72:75], v[180:183], 0
    v_cvt_pk_f16_f32 v138, v86, v90
    v_cvt_pk_f16_f32 v139, v87, v91
    ds_read_u16 v15, v15 offset:2448
    s_waitcnt lgkmcnt(9)
    v_mfma_f32_16x16x32_f16 v[164:167], v[196:199], v[28:31], 0
    v_cvt_pk_f16_f32 v140, v92, v96
    v_cvt_pk_f16_f32 v141, v93, v97
    s_waitcnt lgkmcnt(7)
    v_mfma_f32_16x16x32_f16 v[164:167], v[100:103], v[200:203], v[164:167]
    v_cvt_pk_f16_f32 v142, v94, v98
    v_cvt_pk_f16_f32 v143, v95, v99
    s_waitcnt lgkmcnt(5)
    v_mfma_f32_16x16x32_f16 v[164:167], v[104:107], v[204:207], v[164:167]
    v_cvt_pk_f16_f32 v144, v76, v80
    v_cvt_pk_f16_f32 v145, v77, v81
    v_mfma_f32_16x16x32_f16 v[240:243], v[196:199], v[36:39], 0
    v_cvt_pk_f16_f32 v146, v78, v82
    v_cvt_pk_f16_f32 v147, v79, v83
    v_mfma_f32_16x16x32_f16 v[240:243], v[108:111], v[200:203], v[240:243]
    s_waitcnt lgkmcnt(0)
    v_lshl_or_b32 v15, v15, 16, v15
    v_and_b32 v192, v15, v192
    v_and_b32 v193, v15, v193
    v_and_b32 v194, v15, v194
    v_and_b32 v195, v15, v195
    v_mfma_f32_16x16x32_f16 v[240:243], v[112:115], v[204:207], v[240:243]
    ds_read2_b32 v[216:217], v251 offset0:0 offset1:1
    ds_read2_b32 v[218:219], v251 offset0:2 offset1:3
    v_mfma_f32_16x16x32_f16 v[240:243], v[100:103], v[208:211], v[240:243]
    ds_read2_b32 v[220:221], v251 offset0:48 offset1:49
    ds_read2_b32 v[222:223], v251 offset0:50 offset1:51
    v_mfma_f32_16x16x32_f16 v[240:243], v[104:107], v[212:215], v[240:243]
    ds_write_b128 v249, v[164:167] offset:0
    ds_read2_b32 v[224:225], v251 offset0:160 offset1:161
    ds_read2_b32 v[226:227], v251 offset0:162 offset1:163
    s_mov_b32 s47, 0
PL4:
    s_waitcnt vmcnt(0)
    v_xor_b32 v244, v10, v244
    v_xor_b32 v245, v10, v245
    v_xor_b32 v246, v10, v246
    v_xor_b32 v247, v10, v247
    v_or3_b32 v14, v244, v245, v246
    v_or_b32 v14, v14, v247
    v_and_b32 v14, 0x70007, v14
    v_cmp_ne_u32 vcc, 0, v14
    s_cbranch_vccz PD5
    s_add_u32 s47, s47, 1
    s_cmp_ge_u32 s47, 65536
    s_cbranch_scc1 PD5
    s_sleep 2
    buffer_load_dwordx4 v[244:247], v2, s[32:35], s59 offen sc1
    s_branch PL4
PD5:
    ds_write_b128 v254, v[244:247] offset:3072
    s_bitcmp1_b32 s3, 1
    s_cselect_b32 s46, 1, 0
    s_lshl_b32 s50, s46, 9
    v_add_u32 v15, s50, v252
    s_mul_i32 s46, s46, 294912
    s_add_u32 s46, s46, s63
    ds_write_b128 v249, v[240:243] offset:1024
    s_waitcnt lgkmcnt(0)
    s_barrier
    ds_read_b64_tr_b16 v[244:245], v15 offset:0
    ds_read_b64_tr_b16 v[246:247], v15 offset:256
    v_mfma_f32_16x16x32_f16 v[164:167], v[196:199], v[44:47], 0
    ds_read2_b32 v[228:229], v251 offset0:144 offset1:145
    ds_read2_b32 v[230:231], v251 offset0:146 offset1:147
    v_mfma_f32_16x16x32_f16 v[164:167], v[116:119], v[200:203], v[164:167]
    ds_read2_b32 v[232:233], v251 offset0:128 offset1:129
    ds_read2_b32 v[234:235], v251 offset0:130 offset1:131
    v_mfma_f32_16x16x32_f16 v[164:167], v[120:123], v[204:207], v[164:167]
    s_mov_b32 s57, 10485760
    buffer_load_dwordx4 v[72:75], v4, s[32:35], s57 offen sc1
    buffer_load_dwordx4 v[76:79], v4, s[32:35], s57 offen offset:512 sc1
    buffer_load_dword v80, v5, s[32:35], s57 offen offset:1024 sc1
    global_load_dwordx4 v[16:19], v4, s[4:5]
    global_load_dwordx4 v[20:23], v4, s[4:5] offset:512
    global_load_dword v24, v5, s[4:5] offset:1024
    v_mfma_f32_16x16x32_f16 v[164:167], v[108:111], v[208:211], v[164:167]
    ds_read2_b32 v[236:237], v251 offset0:112 offset1:113
    ds_read2_b32 v[238:239], v251 offset0:114 offset1:115
    v_mfma_f32_16x16x32_f16 v[164:167], v[112:115], v[212:215], v[164:167]
    s_lshl_b32 s57, s51, 6
    v_add_u32 v14, s57, v1
    v_min_u32 v14, 143, v14
    v_lshlrev_b32 v27, 7, v14
    v_lshlrev_b32 v14, 4, v14
    s_mov_b32 s53, 32768
    buffer_load_dwordx4 v[32:35], v27, s[32:35], s53 offen sc1
    v_mfma_f32_16x16x32_f16 v[164:167], v[100:103], v[216:219], v[164:167]
    v_mfma_f32_16x16x32_f16 v[164:167], v[104:107], v[220:223], v[164:167]
    s_waitcnt lgkmcnt(6)
    v_add_u32 v244, v11, v244
    v_add_u32 v245, v11, v245
    v_add_u32 v246, v11, v246
    v_add_u32 v247, v11, v247
    v_and_or_b32 v244, v244, v9, v10
    v_and_or_b32 v245, v245, v9, v10
    v_and_or_b32 v246, v246, v9, v10
    v_and_or_b32 v247, v247, v9, v10
    buffer_store_dwordx4 v[244:247], v253, s[32:35], s46 offen sc1
    v_mfma_f32_16x16x32_f16 v[164:167], v[192:195], v[28:31], v[164:167]
    v_mfma_f32_16x16x32_f16 v[164:167], v[148:151], v[224:227], v[164:167]
    v_mfma_f32_16x16x32_f16 v[240:243], v[196:199], v[52:55], 0
    v_mfma_f32_16x16x32_f16 v[240:243], v[124:127], v[200:203], v[240:243]
    v_mfma_f32_16x16x32_f16 v[240:243], v[128:131], v[204:207], v[240:243]
    v_mfma_f32_16x16x32_f16 v[240:243], v[116:119], v[208:211], v[240:243]
    v_mfma_f32_16x16x32_f16 v[240:243], v[120:123], v[212:215], v[240:243]
    v_mfma_f32_16x16x32_f16 v[240:243], v[108:111], v[216:219], v[240:243]
    v_mfma_f32_16x16x32_f16 v[240:243], v[112:115], v[220:223], v[240:243]
    v_mfma_f32_16x16x32_f16 v[240:243], v[192:195], v[36:39], v[240:243]
    ds_write_b128 v249, v[164:167] offset:2048
    v_mfma_f32_16x16x32_f16 v[240:243], v[152:155], v[224:227], v[240:243]
    s_waitcnt lgkmcnt(5)
    v_mfma_f32_16x16x32_f16 v[240:243], v[148:151], v[228:231], v[240:243]
    v_mfma_f32_16x16x32_f16 v[164:167], v[196:199], v[60:63], 0
    v_mfma_f32_16x16x32_f16 v[164:167], v[132:135], v[200:203], v[164:167]
    v_mfma_f32_16x16x32_f16 v[164:167], v[136:139], v[204:207], v[164:167]
    v_mfma_f32_16x16x32_f16 v[164:167], v[124:127], v[208:211], v[164:167]
    v_mfma_f32_16x16x32_f16 v[164:167], v[128:131], v[212:215], v[164:167]
    v_mfma_f32_16x16x32_f16 v[164:167], v[116:119], v[216:219], v[164:167]
    v_mfma_f32_16x16x32_f16 v[164:167], v[120:123], v[220:223], v[164:167]
    v_mfma_f32_16x16x32_f16 v[164:167], v[192:195], v[44:47], v[164:167]
    ds_write_b128 v249, v[240:243] offset:3072
    v_mfma_f32_16x16x32_f16 v[164:167], v[156:159], v[224:227], v[164:167]
    v_mfma_f32_16x16x32_f16 v[164:167], v[152:155], v[228:231], v[164:167]
    s_waitcnt lgkmcnt(4)
    v_mfma_f32_16x16x32_f16 v[164:167], v[148:151], v[232:235], v[164:167]
    v_mfma_f32_16x16x32_f16 v[240:243], v[196:199], v[68:71], 0
    v_mfma_f32_16x16x32_f16 v[240:243], v[140:143], v[200:203], v[240:243]
    v_mfma_f32_16x16x32_f16 v[240:243], v[144:147], v[204:207], v[240:243]
    v_mfma_f32_16x16x32_f16 v[240:243], v[132:135], v[208:211], v[240:243]
    v_mfma_f32_16x16x32_f16 v[240:243], v[136:139], v[212:215], v[240:243]
    v_mfma_f32_16x16x32_f16 v[240:243], v[124:127], v[216:219], v[240:243]
    v_mfma_f32_16x16x32_f16 v[240:243], v[128:131], v[220:223], v[240:243]
    v_mfma_f32_16x16x32_f16 v[240:243], v[192:195], v[52:55], v[240:243]
    ds_write_b128 v249, v[164:167] offset:4096
    v_mfma_f32_16x16x32_f16 v[240:243], v[160:163], v[224:227], v[240:243]
    v_mfma_f32_16x16x32_f16 v[240:243], v[156:159], v[228:231], v[240:243]
    v_mfma_f32_16x16x32_f16 v[240:243], v[152:155], v[232:235], v[240:243]
    s_waitcnt lgkmcnt(3)
    v_mfma_f32_16x16x32_f16 v[240:243], v[148:151], v[236:239], v[240:243]
    s_bitcmp1_b32 s3, 1
    s_cselect_b32 s46, 3, 2
    s_lshl_b32 s50, s46, 9
    v_add_u32 v15, s50, v252
    s_mul_i32 s46, s46, 294912
    s_add_u32 s46, s46, s63
    s_nop 1
    ds_write_b128 v249, v[240:243] offset:5120
    s_waitcnt lgkmcnt(0)
    s_barrier
    ds_read_b64_tr_b16 v[244:245], v15 offset:0
    ds_read_b64_tr_b16 v[246:247], v15 offset:256
    s_waitcnt lgkmcnt(0)
    v_add_u32 v244, v11, v244
    v_add_u32 v245, v11, v245
    v_add_u32 v246, v11, v246
    v_add_u32 v247, v11, v247
    v_and_or_b32 v244, v244, v9, v10
    v_and_or_b32 v245, v245, v9, v10
    v_and_or_b32 v246, v246, v9, v10
    v_and_or_b32 v247, v247, v9, v10
    buffer_store_dwordx4 v[244:247], v253, s[32:35], s46 offen sc1
    s_setprio 0
    s_and_b32 s56, s40, 0x7fffff
    s_mov_b32 s47, 0
    s_waitcnt vmcnt(2)
SCP6:
    v_xor_b32 v32, s56, v32
    v_xor_b32 v33, s56, v33
    v_xor_b32 v34, s56, v34
    v_xor_b32 v35, s56, v35
    v_or3_b32 v255, v32, v33, v34
    v_or_b32 v255, v255, v35
    v_and_b32 v255, 0x7fffff, v255
    v_cmp_ne_u32 vcc, 0, v255
    s_cbranch_vccz SCD7
    s_add_u32 s47, s47, 1
    s_cmp_ge_u32 s47, 65536
    s_cbranch_scc1 SCD7
    s_sleep 8
    buffer_load_dwordx4 v[32:35], v27, s[32:35], s53 offen sc1
    s_waitcnt vmcnt(0)
    s_branch SCP6
SCD7:
    ds_write_b128 v14, v[32:35] offset:46080
    s_cmp_ge_u32 s49, 128
    s_cbranch_scc1 H_NOR
    global_load_dwordx4 v[208:211], v12, s[16:17]
    global_load_dwordx4 v[212:215], v12, s[16:17] offset:512
    global_load_dword v216, v13, s[16:17] offset:1024
    global_load_dwordx4 v[218:221], v12, s[20:21]
    global_load_dwordx4 v[222:225], v12, s[20:21] offset:512
    global_load_dword v226, v13, s[20:21] offset:1024
H_NOR:
    s_bitcmp1_b32 s3, 1
    s_cselect_b32 s46, 5, 4
    s_lshl_b32 s50, s46, 9
    v_add_u32 v15, s50, v252
    s_mul_i32 s46, s46, 294912
    s_add_u32 s46, s46, s63
    s_waitcnt lgkmcnt(0)
    s_barrier
    ds_read_b64_tr_b16 v[244:245], v15 offset:0
    ds_read_b64_tr_b16 v[246:247], v15 offset:256
    s_waitcnt lgkmcnt(0)
    v_add_u32 v244, v11, v244
    v_add_u32 v245, v11, v245
    v_add_u32 v246, v11, v246
    v_add_u32 v247, v11, v247
    v_and_or_b32 v244, v244, v9, v10
    v_and_or_b32 v245, v245, v9, v10
    v_and_or_b32 v246, v246, v9, v10
    v_and_or_b32 v247, v247, v9, v10
    buffer_store_dwordx4 v[244:247], v253, s[32:35], s46 offen sc1
    s_add_u32 s46, s63, 1769472
    s_bitcmp1_b32 s3, 1
    s_waitcnt lgkmcnt(0)
    s_barrier
    s_cbranch_scc1 YS8
    ds_read_b64_tr_b16 v[244:245], v252 offset:3072
    ds_read_b64_tr_b16 v[246:247], v252 offset:3328
    s_waitcnt lgkmcnt(0)
    v_add_u32 v244, v11, v244
    v_add_u32 v245, v11, v245
    v_add_u32 v246, v11, v246
    v_add_u32 v247, v11, v247
    v_and_or_b32 v244, v244, v9, v10
    v_and_or_b32 v245, v245, v9, v10
    v_and_or_b32 v246, v246, v9, v10
    v_and_or_b32 v247, v247, v9, v10
    buffer_store_dwordx4 v[244:247], v253, s[32:35], s46 offen sc1
YS8:
    s_add_u32 s46, s63, 2064384
    s_bitcmp1_b32 s3, 1
    s_waitcnt lgkmcnt(0)
    s_barrier
    s_cbranch_scc0 YS9
    ds_read_b64_tr_b16 v[244:245], v252 offset:3584
    ds_read_b64_tr_b16 v[246:247], v252 offset:3840
    s_waitcnt lgkmcnt(0)
    v_add_u32 v244, v11, v244
    v_add_u32 v245, v11, v245
    v_add_u32 v246, v11, v246
    v_add_u32 v247, v11, v247
    v_and_or_b32 v244, v244, v9, v10
    v_and_or_b32 v245, v245, v9, v10
    v_and_or_b32 v246, v246, v9, v10
    v_and_or_b32 v247, v247, v9, v10
    buffer_store_dwordx4 v[244:247], v253, s[32:35], s46 offen sc1
YS9:
RPREP:
    s_cmp_ge_u32 s49, 128
    s_cbranch_scc1 ZROLE
    s_cmp_lg_u32 s61, 0
    s_cselect_b32 s39, 1, 0
    s_cbranch_scc1 RP_U0
    ds_read_b128 v[72:75], v25
    ds_read_b128 v[76:79], v25 offset:512
    ds_read_b32 v80, v26 offset:1024
RP_U0:
    v_lshlrev_b32 v38, 1, v12
    v_lshlrev_b32 v39, 1, v13
    s_mul_i32 s60, s49, 18432
    s_add_u32 s60, s60, 4194304
    s_add_u32 s61, s60, 8192
    s_add_u32 s62, s60, 16384
    v_mov_b32 v204, 0
    s_waitcnt vmcnt(2)
    s_cmp_ge_u32 s49, 64
    s_cbranch_scc1 RP_0
    buffer_load_dwordx4 v[140:143], v3, s[32:35], s60 offen sc1
    buffer_load_dwordx4 v[144:147], v3, s[32:35], s61 offen sc1
    s_cmp_ge_u32 s3, 2
    s_cbranch_scc1 YL10
    buffer_load_dwordx4 v[148:151], v3, s[32:35], s62 offen sc1
YL10:
RP_0:
    v_lshlrev_b32 v84, 16, v208
    v_and_b32 v85, 0xffff0000, v208
    v_lshlrev_b32 v120, 16, v218
    v_and_b32 v121, 0xffff0000, v218
    v_dot2c_f32_bf16 v204, v218, v8
    v_lshlrev_b32 v86, 16, v209
    v_and_b32 v87, 0xffff0000, v209
    v_lshlrev_b32 v122, 16, v219
    v_and_b32 v123, 0xffff0000, v219
    v_dot2c_f32_bf16 v204, v219, v8
    v_lshlrev_b32 v88, 16, v210
    v_and_b32 v89, 0xffff0000, v210
    v_lshlrev_b32 v124, 16, v220
    v_and_b32 v125, 0xffff0000, v220
    v_dot2c_f32_bf16 v204, v220, v8
    v_lshlrev_b32 v90, 16, v211
    v_and_b32 v91, 0xffff0000, v211
    v_lshlrev_b32 v126, 16, v221
    v_and_b32 v127, 0xffff0000, v221
    v_dot2c_f32_bf16 v204, v221, v8
    v_lshlrev_b32 v92, 16, v212
    v_and_b32 v93, 0xffff0000, v212
    v_lshlrev_b32 v128, 16, v222
    v_and_b32 v129, 0xffff0000, v222
    v_dot2c_f32_bf16 v204, v222, v8
    v_lshlrev_b32 v94, 16, v213
    v_and_b32 v95, 0xffff0000, v213
    v_lshlrev_b32 v130, 16, v223
    v_and_b32 v131, 0xffff0000, v223
    v_dot2c_f32_bf16 v204, v223, v8
    v_lshlrev_b32 v96, 16, v214
    v_and_b32 v97, 0xffff0000, v214
    v_lshlrev_b32 v132, 16, v224
    v_and_b32 v133, 0xffff0000, v224
    v_dot2c_f32_bf16 v204, v224, v8
    v_lshlrev_b32 v98, 16, v215
    v_and_b32 v99, 0xffff0000, v215
    v_lshlrev_b32 v134, 16, v225
    v_and_b32 v135, 0xffff0000, v225
    v_dot2c_f32_bf16 v204, v225, v8
    v_lshlrev_b32 v100, 16, v216
    v_and_b32 v101, 0xffff0000, v216
    v_lshlrev_b32 v136, 16, v226
    v_and_b32 v137, 0xffff0000, v226
    v_dot2c_f32_bf16 v204, v226, v8
    s_waitcnt lgkmcnt(0)
    s_cmp_lg_u32 s39, 0
    s_cbranch_scc1 RP_U1
    v_add_u32 v72, v11, v72
    v_add_u32 v73, v11, v73
    v_add_u32 v74, v11, v74
    v_add_u32 v75, v11, v75
    v_add_u32 v76, v11, v76
    v_add_u32 v77, v11, v77
    v_add_u32 v78, v11, v78
    v_add_u32 v79, v11, v79
    v_add_u32 v80, v11, v80
    v_and_b32 v72, v9, v72
    v_and_b32 v73, v9, v73
    v_and_b32 v74, v9, v74
    v_and_b32 v75, v9, v75
    v_and_b32 v76, v9, v76
    v_and_b32 v77, v9, v77
    v_and_b32 v78, v9, v78
    v_and_b32 v79, v9, v79
    v_and_b32 v80, v9, v80
    s_branch RP_U2
RP_U1:
    s_mov_b32 s47, 0
RP_U3:
    v_xor_b32 v72, v10, v72
    v_xor_b32 v73, v10, v73
    v_xor_b32 v74, v10, v74
    v_xor_b32 v75, v10, v75
    v_xor_b32 v76, v10, v76
    v_xor_b32 v77, v10, v77
    v_xor_b32 v78, v10, v78
    v_xor_b32 v79, v10, v79
    v_xor_b32 v80, v10, v80
    v_or3_b32 v37, v72, v73, v74
    v_or3_b32 v37, v37, v75, v76
    v_or3_b32 v37, v37, v77, v78
    v_or3_b32 v37, v37, v79, v80
    v_and_b32 v37, 0x70007, v37
    v_cmp_ne_u32 vcc, 0, v37
    s_cbranch_vccz RP_U2
    s_add_u32 s47, s47, 1
    s_cmp_ge_u32 s47, 65536
    s_cbranch_scc1 RP_U2
    s_sleep 4
    s_mov_b32 s57, 10485760
    buffer_load_dwordx4 v[72:75], v4, s[32:35], s57 offen sc1
    buffer_load_dwordx4 v[76:79], v4, s[32:35], s57 offen offset:512 sc1
    buffer_load_dword v80, v5, s[32:35], s57 offen offset:1024 sc1
    s_waitcnt vmcnt(0)
    s_branch RP_U3
RP_U2:
    v_fma_mix_f32 v84, v72, v84, 0 op_sel:[0,0,0] op_sel_hi:[1,0,0]
    v_fma_mix_f32 v85, v72, v85, 0 op_sel:[1,0,0] op_sel_hi:[1,0,0]
    v_fma_mix_f32 v86, v73, v86, 0 op_sel:[0,0,0] op_sel_hi:[1,0,0]
    v_add_f32_dpp v204, v204, v204 row_ror:8 row_mask:0xf bank_mask:0xf
    v_fma_mix_f32 v87, v73, v87, 0 op_sel:[1,0,0] op_sel_hi:[1,0,0]
    v_fma_mix_f32 v88, v74, v88, 0 op_sel:[0,0,0] op_sel_hi:[1,0,0]
    v_fma_mix_f32 v89, v74, v89, 0 op_sel:[1,0,0] op_sel_hi:[1,0,0]
    v_fma_mix_f32 v90, v75, v90, 0 op_sel:[0,0,0] op_sel_hi:[1,0,0]
    v_fma_mix_f32 v91, v75, v91, 0 op_sel:[1,0,0] op_sel_hi:[1,0,0]
    v_add_f32_dpp v204, v204, v204 row_ror:4 row_mask:0xf bank_mask:0xf
    v_fma_mix_f32 v92, v76, v92, 0 op_sel:[0,0,0] op_sel_hi:[1,0,0]
    v_fma_mix_f32 v93, v76, v93, 0 op_sel:[1,0,0] op_sel_hi:[1,0,0]
    v_fma_mix_f32 v94, v77, v94, 0 op_sel:[0,0,0] op_sel_hi:[1,0,0]
    v_fma_mix_f32 v95, v77, v95, 0 op_sel:[1,0,0] op_sel_hi:[1,0,0]
    v_fma_mix_f32 v96, v78, v96, 0 op_sel:[0,0,0] op_sel_hi:[1,0,0]
    v_add_f32_dpp v204, v204, v204 row_ror:2 row_mask:0xf bank_mask:0xf
    v_fma_mix_f32 v97, v78, v97, 0 op_sel:[1,0,0] op_sel_hi:[1,0,0]
    v_fma_mix_f32 v98, v79, v98, 0 op_sel:[0,0,0] op_sel_hi:[1,0,0]
    v_fma_mix_f32 v99, v79, v99, 0 op_sel:[1,0,0] op_sel_hi:[1,0,0]
    v_fma_mix_f32 v100, v80, v100, 0 op_sel:[0,0,0] op_sel_hi:[1,0,0]
    v_fma_mix_f32 v101, v80, v101, 0 op_sel:[1,0,0] op_sel_hi:[1,0,0]
    v_add_f32_dpp v204, v204, v204 row_ror:1 row_mask:0xf bank_mask:0xf
    v_cvt_pk_bf16_f32 v84, 0, v84
    v_cvt_pk_bf16_f32 v85, 0, v85
    v_cvt_pk_bf16_f32 v86, 0, v86
    v_cvt_pk_bf16_f32 v87, 0, v87
    v_cvt_pk_bf16_f32 v88, 0, v88
    v_mov_b32 v37, v204
    v_cvt_pk_bf16_f32 v89, 0, v89
    v_cvt_pk_bf16_f32 v90, 0, v90
    v_cvt_pk_bf16_f32 v91, 0, v91
    v_cvt_pk_bf16_f32 v92, 0, v92
    v_cvt_pk_bf16_f32 v93, 0, v93
    v_permlane16_swap_b32 v204, v37
    v_cvt_pk_bf16_f32 v94, 0, v94
    v_cvt_pk_bf16_f32 v95, 0, v95
    v_cvt_pk_bf16_f32 v96, 0, v96
    v_cvt_pk_bf16_f32 v97, 0, v97
    v_cvt_pk_bf16_f32 v98, 0, v98
    v_add_f32 v204, v204, v37
    v_cvt_pk_bf16_f32 v99, 0, v99
    v_cvt_pk_bf16_f32 v100, 0, v100
    v_cvt_pk_bf16_f32 v101, 0, v101
    v_dot2_f32_bf16 v102, v16, v6, v84
    v_dot2_f32_bf16 v103, v16, v7, v85
    v_dot2_f32_bf16 v104, v17, v6, v86
    v_dot2_f32_bf16 v105, v17, v7, v87
    v_dot2_f32_bf16 v106, v18, v6, v88
    v_dot2_f32_bf16 v107, v18, v7, v89
    v_dot2_f32_bf16 v108, v19, v6, v90
    v_dot2_f32_bf16 v109, v19, v7, v91
    v_dot2_f32_bf16 v110, v20, v6, v92
    v_dot2_f32_bf16 v111, v20, v7, v93
    v_dot2_f32_bf16 v112, v21, v6, v94
    v_dot2_f32_bf16 v113, v21, v7, v95
    v_dot2_f32_bf16 v114, v22, v6, v96
    v_dot2_f32_bf16 v115, v22, v7, v97
    v_dot2_f32_bf16 v116, v23, v6, v98
    v_dot2_f32_bf16 v117, v23, v7, v99
    v_dot2_f32_bf16 v118, v24, v6, v100
    v_dot2_f32_bf16 v119, v24, v7, v101
    s_cmp_lt_u32 s2, 144
    s_cbranch_scc1 RP_1
    s_and_b32 s46, s2, 7
    s_sub_u32 s48, s2, 216
    s_lshr_b32 s48, s48, 3
    v_lshrrev_b32 v37, 3, v0
    v_mul_u32_u24 v37, 9216, v37
    v_and_b32 v36, 7, v0
    v_lshl_add_u32 v37, v36, 4, v37
    s_cmp_ge_u32 s46, 4
    s_cselect_b32 s50, 1, 0
    s_add_u32 s50, s50, s46
    s_lshl_b32 s50, s50, 10
    s_add_u32 s50, s50, 384
    s_lshr_b32 s53, s48, 1
    s_sub_u32 s53, 8, s53
    s_mul_i32 s53, s53, 589824
    s_add_u32 s50, s50, s53
    v_add_u32 v36, s50, v37
    s_bitcmp1_b32 s48, 0
    s_cselect_b32 s56, s24, s22
    s_cselect_b32 s57, s25, s23
    global_load_dwordx4 v[140:143], v36, s[56:57] nt
    s_cmp_lg_u32 s46, 3
    s_cbranch_scc1 PF_0
    global_load_dwordx4 v[144:147], v36, s[56:57] offset:1024 nt
PF_0:
    v_subrev_u32 v36, 1179648, v36
    global_load_dwordx4 v[140:143], v36, s[56:57] nt
    s_cmp_lg_u32 s46, 3
    s_cbranch_scc1 PF_1
    global_load_dwordx4 v[144:147], v36, s[56:57] offset:1024 nt
PF_1:
    v_subrev_u32 v36, 1179648, v36
    global_load_dwordx4 v[140:143], v36, s[56:57] nt
    s_cmp_lg_u32 s46, 3
    s_cbranch_scc1 PF_2
    global_load_dwordx4 v[144:147], v36, s[56:57] offset:1024 nt
PF_2:
    v_subrev_u32 v36, 1179648, v36
    s_waitcnt vmcnt(0)
    s_cmp_ge_u32 s3, 4
    s_cbranch_scc1 RP_S
    s_lshl_b32 s57, s51, 6
    v_add_u32 v14, s57, v1
    v_min_u32 v14, 143, v14
    v_lshlrev_b32 v27, 7, v14
    v_lshlrev_b32 v14, 4, v14
    s_mov_b32 s53, 32768
    buffer_load_dwordx4 v[32:35], v27, s[32:35], s53 offen sc1
    s_and_b32 s56, s40, 0x7fffff
    s_mov_b32 s47, 0
    s_waitcnt vmcnt(0)
SCP11:
    v_xor_b32 v32, s56, v32
    v_xor_b32 v33, s56, v33
    v_xor_b32 v34, s56, v34
    v_xor_b32 v35, s56, v35
    v_or3_b32 v255, v32, v33, v34
    v_or_b32 v255, v255, v35
    v_and_b32 v255, 0x7fffff, v255
    v_cmp_ne_u32 vcc, 0, v255
    s_cbranch_vccz SCD12
    s_add_u32 s47, s47, 1
    s_cmp_ge_u32 s47, 65536
    s_cbranch_scc1 SCD12
    s_sleep 8
    buffer_load_dwordx4 v[32:35], v27, s[32:35], s53 offen sc1
    s_waitcnt vmcnt(0)
    s_branch SCP11
SCD12:
    ds_write_b128 v14, v[32:35] offset:46080
RP_S:
    s_waitcnt lgkmcnt(0)
    s_barrier
RP_1:
    s_cmp_lt_u32 s49, 64
    s_cbranch_scc1 RP_2
    buffer_load_dwordx4 v[140:143], v3, s[32:35], s60 offen sc1
    buffer_load_dwordx4 v[144:147], v3, s[32:35], s61 offen sc1
    s_cmp_ge_u32 s3, 2
    s_cbranch_scc1 YL13
    buffer_load_dwordx4 v[148:151], v3, s[32:35], s62 offen sc1
YL13:
RP_2:
    ds_read_b128 v[52:55], v38 offset:46080
    ds_read_b128 v[56:59], v38 offset:46096
    ds_read_b128 v[60:63], v38 offset:47104
    ds_read_b128 v[64:67], v38 offset:47120
    ds_read_b64 v[68:69], v39 offset:48128
    v_and_b32 v36, 7, v0
    v_mul_u32_u24 v36, 2320, v36
    v_lshrrev_b32 v37, 3, v0
    v_lshl_add_u32 v36, v37, 4, v36
    v_lshrrev_b32 v37, 5, v1
    s_mul_i32 s46, s3, 2320
    s_add_u32 s46, s46, 49152
    v_lshl_add_u32 v37, v37, 3, s46
    v_lshl_add_u32 v38, v12, 1, v37
    v_bfe_u32 v39, v1, 1, 4
    v_lshl_add_u32 v39, v39, 4, v37
    v_and_b32 v37, 1, v1
    v_lshl_add_u32 v39, v37, 2, v39
    v_lshrrev_b32 v35, 5, v1
    v_lshlrev_b32 v35, 4, v35
    s_and_b32 s52, s3, 4
    s_add_u32 s52, s52, s3
    s_lshl_b32 s46, s52, 2
    s_add_u32 s46, s46, 163456
    v_add_u32 v35, s46, v35
    v_and_b32 v40, 15, v1
    v_lshlrev_b32 v34, 2, v40
    v_add_u32 v34, 163456, v34
    v_and_b32 v42, 48, v2
    v_add_u32 v41, 163456, v42
    v_lshrrev_b32 v43, 2, v1
    v_lshl_add_u32 v42, v43, 14, v42
    s_and_b32 s63, s40, 0xffff
    s_or_b32 s53, s63, 0x80000000
    s_lshl_b32 s54, s49, 6
    s_add_u32 s54, s54, 9437184
    s_mov_b32 s58, 1
    s_mov_b32 s59, 1
    s_lshl_b32 s46, s49, 4
    s_sub_u32 s46, 0xffff, s46
    v_sub_u32 v44, s46, v40
    v_mov_b32 v45, 0xffff0000
    v_lshrrev_b32 v46, 5, v1
    v_mul_u32_u24 v46, 6144, v46
    s_mul_i32 s46, s52, 1536
    v_add3_u32 v46, v46, v12, s46
    v_lshrrev_b32 v47, 2, v0
    v_and_b32 v48, 3, v0
    v_lshlrev_b32 v48, 4, v48
    v_lshl_add_u32 v47, v47, 6, v48
    v_mov_b32 v183, s40
    v_mov_b32 v187, s40
    v_mov_b32 v191, s40
    v_lshlrev_b32 v49, 2, v0
    v_sub_u32 v232, 0xffff, v49
    v_subrev_u32 v233, 1, v232
    v_subrev_u32 v234, 2, v232
    v_subrev_u32 v235, 3, v232
    v_mov_b32 v48, s63
    v_mov_b32 v49, 163520
    v_mov_b32 v50, -1
    s_cmp_ge_u32 s3, 2
    s_cbranch_scc1 RP_3
    s_mov_b32 s47, 0
PL14:
    s_waitcnt vmcnt(0)
    v_xor_b32 v140, v10, v140
    v_xor_b32 v141, v10, v141
    v_xor_b32 v142, v10, v142
    v_xor_b32 v143, v10, v143
    v_xor_b32 v144, v10, v144
    v_xor_b32 v145, v10, v145
    v_xor_b32 v146, v10, v146
    v_xor_b32 v147, v10, v147
    v_xor_b32 v148, v10, v148
    v_xor_b32 v149, v10, v149
    v_xor_b32 v150, v10, v150
    v_xor_b32 v151, v10, v151
    v_or3_b32 v37, v140, v141, v142
    v_or3_b32 v37, v37, v143, v144
    v_or3_b32 v37, v37, v145, v146
    v_or3_b32 v37, v37, v147, v148
    v_or3_b32 v37, v37, v149, v150
    v_or_b32 v37, v37, v151
    v_and_b32 v37, 0x70007, v37
    v_cmp_ne_u32 vcc, 0, v37
    s_cbranch_vccz PD15
    s_add_u32 s47, s47, 1
    s_cmp_ge_u32 s47, 65536
    s_cbranch_scc1 PD15
    s_sleep 1
    buffer_load_dwordx4 v[140:143], v3, s[32:35], s60 offen sc1
    buffer_load_dwordx4 v[144:147], v3, s[32:35], s61 offen sc1
    buffer_load_dwordx4 v[148:151], v3, s[32:35], s62 offen sc1
    s_branch PL14
PD15:
    ds_write_b128 v36, v[148:151] offset:51200
    s_branch RP_4
RP_3:
    s_mov_b32 s47, 0
PL16:
    s_waitcnt vmcnt(0)
    v_xor_b32 v140, v10, v140
    v_xor_b32 v141, v10, v141
    v_xor_b32 v142, v10, v142
    v_xor_b32 v143, v10, v143
    v_xor_b32 v144, v10, v144
    v_xor_b32 v145, v10, v145
    v_xor_b32 v146, v10, v146
    v_xor_b32 v147, v10, v147
    v_or3_b32 v37, v140, v141, v142
    v_or3_b32 v37, v37, v143, v144
    v_or3_b32 v37, v37, v145, v146
    v_or_b32 v37, v37, v147
    v_and_b32 v37, 0x70007, v37
    v_cmp_ne_u32 vcc, 0, v37
    s_cbranch_vccz PD17
    s_add_u32 s47, s47, 1
    s_cmp_ge_u32 s47, 65536
    s_cbranch_scc1 PD17
    s_sleep 1
    buffer_load_dwordx4 v[140:143], v3, s[32:35], s60 offen sc1
    buffer_load_dwordx4 v[144:147], v3, s[32:35], s61 offen sc1
    s_branch PL16
PD17:
RP_4:
    ds_write_b128 v36, v[140:143] offset:49152
    ds_write_b128 v36, v[144:147] offset:50176
    s_waitcnt lgkmcnt(0)
    s_barrier
    ds_read2_b64 v[152:155], v38 offset0:0 offset1:2
    ds_read2_b64 v[156:159], v38 offset0:128 offset1:130
    ds_read_b32 v160, v39 offset:2048
    s_getreg_b32 s60, hwreg(HW_REG_XCC_ID, 0, 3)
    s_mul_i32 s60, s60, 16384
    s_add_u32 s60, s60, 9437184
    s_lshl_b32 s61, s3, 14
    s_add_u32 s61, s61, 9830400
    s_waitcnt lgkmcnt(2)
    v_fma_mix_f32 v162, v152, v52, v102 op_sel:[0,0,0] op_sel_hi:[1,0,0]
    v_fma_mix_f32 v163, v152, v53, v103 op_sel:[1,0,0] op_sel_hi:[1,0,0]
    v_fma_mix_f32 v164, v153, v54, v104 op_sel:[0,0,0] op_sel_hi:[1,0,0]
    v_fma_mix_f32 v165, v153, v55, v105 op_sel:[1,0,0] op_sel_hi:[1,0,0]
    v_pk_mul_f32 v[30:31], v[162:163], v[162:163]
    v_pk_mul_f32 v[32:33], v[162:163], v[120:121]
    v_fma_mix_f32 v166, v154, v56, v106 op_sel:[0,0,0] op_sel_hi:[1,0,0]
    v_fma_mix_f32 v167, v154, v57, v107 op_sel:[1,0,0] op_sel_hi:[1,0,0]
    v_pk_add_f32 v[28:29], v[162:163], v[164:165]
    v_pk_fma_f32 v[30:31], v[164:165], v[164:165], v[30:31]
    v_pk_fma_f32 v[32:33], v[164:165], v[122:123], v[32:33]
    v_fma_mix_f32 v168, v155, v58, v108 op_sel:[0,0,0] op_sel_hi:[1,0,0]
    v_fma_mix_f32 v169, v155, v59, v109 op_sel:[1,0,0] op_sel_hi:[1,0,0]
    v_pk_add_f32 v[28:29], v[28:29], v[166:167]
    v_pk_fma_f32 v[30:31], v[166:167], v[166:167], v[30:31]
    v_pk_fma_f32 v[32:33], v[166:167], v[124:125], v[32:33]
    s_waitcnt lgkmcnt(1)
    v_fma_mix_f32 v170, v156, v60, v110 op_sel:[0,0,0] op_sel_hi:[1,0,0]
    v_fma_mix_f32 v171, v156, v61, v111 op_sel:[1,0,0] op_sel_hi:[1,0,0]
    v_pk_add_f32 v[28:29], v[28:29], v[168:169]
    v_pk_fma_f32 v[30:31], v[168:169], v[168:169], v[30:31]
    v_pk_fma_f32 v[32:33], v[168:169], v[126:127], v[32:33]
    v_fma_mix_f32 v172, v157, v62, v112 op_sel:[0,0,0] op_sel_hi:[1,0,0]
    v_fma_mix_f32 v173, v157, v63, v113 op_sel:[1,0,0] op_sel_hi:[1,0,0]
    v_pk_add_f32 v[28:29], v[28:29], v[170:171]
    v_pk_fma_f32 v[30:31], v[170:171], v[170:171], v[30:31]
    v_pk_fma_f32 v[32:33], v[170:171], v[128:129], v[32:33]
    v_fma_mix_f32 v174, v158, v64, v114 op_sel:[0,0,0] op_sel_hi:[1,0,0]
    v_fma_mix_f32 v175, v158, v65, v115 op_sel:[1,0,0] op_sel_hi:[1,0,0]
    v_pk_add_f32 v[28:29], v[28:29], v[172:173]
    v_pk_fma_f32 v[30:31], v[172:173], v[172:173], v[30:31]
    v_pk_fma_f32 v[32:33], v[172:173], v[130:131], v[32:33]
    v_fma_mix_f32 v176, v159, v66, v116 op_sel:[0,0,0] op_sel_hi:[1,0,0]
    v_fma_mix_f32 v177, v159, v67, v117 op_sel:[1,0,0] op_sel_hi:[1,0,0]
    v_pk_add_f32 v[28:29], v[28:29], v[174:175]
    v_pk_fma_f32 v[30:31], v[174:175], v[174:175], v[30:31]
    v_pk_fma_f32 v[32:33], v[174:175], v[132:133], v[32:33]
    s_waitcnt lgkmcnt(0)
    v_fma_mix_f32 v178, v160, v68, v118 op_sel:[0,0,0] op_sel_hi:[1,0,0]
    v_fma_mix_f32 v179, v160, v69, v119 op_sel:[1,0,0] op_sel_hi:[1,0,0]
    v_pk_add_f32 v[28:29], v[28:29], v[176:177]
    v_pk_fma_f32 v[30:31], v[176:177], v[176:177], v[30:31]
    v_pk_fma_f32 v[32:33], v[176:177], v[134:135], v[32:33]
    v_pk_add_f32 v[28:29], v[28:29], v[178:179]
    v_pk_fma_f32 v[30:31], v[178:179], v[178:179], v[30:31]
    v_pk_fma_f32 v[32:33], v[178:179], v[136:137], v[32:33]
    v_add_f32 v28, v28, v29
    v_add_f32 v30, v30, v31
    v_add_f32 v32, v32, v33
    s_nop 0
    v_permlane16_swap_b32 v28, v30
    v_add_f32 v28, v28, v30
    v_add_f32_dpp v32, v32, v32 row_ror:8 row_mask:0xf bank_mask:0xf
    s_nop 0
    v_add_f32_dpp v28, v28, v28 row_ror:8 row_mask:0xf bank_mask:0xf
    v_add_f32_dpp v32, v32, v32 row_ror:4 row_mask:0xf bank_mask:0xf
    s_nop 0
    v_add_f32_dpp v28, v28, v28 row_ror:4 row_mask:0xf bank_mask:0xf
    v_add_f32_dpp v32, v32, v32 row_ror:2 row_mask:0xf bank_mask:0xf
    s_nop 0
    v_add_f32_dpp v28, v28, v28 row_ror:2 row_mask:0xf bank_mask:0xf
    v_add_f32_dpp v32, v32, v32 row_ror:1 row_mask:0xf bank_mask:0xf
    s_nop 0
    v_add_f32_dpp v28, v28, v28 row_ror:1 row_mask:0xf bank_mask:0xf
    v_mov_b32 v33, v32
    v_mov_b32 v30, v28
    s_nop 1
    v_permlane16_swap_b32 v28, v30
    v_permlane16_swap_b32 v32, v33
    v_add_f32 v32, v32, v33
    v_mul_f32 v28, 0x3ae38e39, v28
    v_mul_f32 v30, 0x3ae38e39, v30
    v_fma_f32 v30, -v28, v28, v30
    v_cvt_pk_bf16_f32 v200, 0, v28
    v_max_f32 v30, 0, v30
    v_cvt_pk_bf16_f32 v30, 0, v30
    v_add_f32 v30, 0x3727c5ac, v30
    v_cvt_pk_bf16_f32 v30, 0, v30
    v_sqrt_f32 v30, v30
    s_nop 0
    v_cvt_pk_bf16_f32 v30, 0, v30
    v_rcp_f32 v202, v30
    v_fma_f32 v32, -v200, v204, v32
    v_mul_f32 v32, v32, v202
    v_cvt_pk_bf16_f32 v236, 0, v32
    v_ashrrev_i32 v28, 31, v236
    v_and_b32 v28, 0x7fff0000, v28
    v_xor_b32 v28, v28, v236
    v_xor_b32 v28, s53, v28
    s_mov_b64 exec, s[58:59]
    ds_write_b32 v35, v28
    s_mov_b64 exec, -1
    s_waitcnt lgkmcnt(0)
    s_barrier
    s_cmp_lg_u32 s3, 0
    s_cbranch_scc1 L2_NOKEY
    s_mov_b32 exec_hi, 0
    ds_read_b128 v[28:31], v41
    s_waitcnt lgkmcnt(0)
    buffer_store_dwordx4 v[28:31], v42, s[32:35], s54 offen sc1
    s_mov_b64 exec, -1
L2_NOKEY:
    ds_read_b32 v205, v34
    v_fma_mix_f32 v162, v152, v52, v84 op_sel:[0,0,0] op_sel_hi:[1,0,0]
    v_fma_mix_f32 v163, v152, v53, v85 op_sel:[1,0,0] op_sel_hi:[1,0,0]
    v_fma_mix_f32 v164, v153, v54, v86 op_sel:[0,0,0] op_sel_hi:[1,0,0]
    v_fma_mix_f32 v165, v153, v55, v87 op_sel:[1,0,0] op_sel_hi:[1,0,0]
    v_fma_mix_f32 v166, v154, v56, v88 op_sel:[0,0,0] op_sel_hi:[1,0,0]
    v_fma_mix_f32 v167, v154, v57, v89 op_sel:[1,0,0] op_sel_hi:[1,0,0]
    v_fma_mix_f32 v168, v155, v58, v90 op_sel:[0,0,0] op_sel_hi:[1,0,0]
    v_fma_mix_f32 v169, v155, v59, v91 op_sel:[1,0,0] op_sel_hi:[1,0,0]
    v_fma_mix_f32 v170, v156, v60, v92 op_sel:[0,0,0] op_sel_hi:[1,0,0]
    v_fma_mix_f32 v171, v156, v61, v93 op_sel:[1,0,0] op_sel_hi:[1,0,0]
    v_fma_mix_f32 v172, v157, v62, v94 op_sel:[0,0,0] op_sel_hi:[1,0,0]
    v_fma_mix_f32 v173, v157, v63, v95 op_sel:[1,0,0] op_sel_hi:[1,0,0]
    v_fma_mix_f32 v174, v158, v64, v96 op_sel:[0,0,0] op_sel_hi:[1,0,0]
    v_fma_mix_f32 v175, v158, v65, v97 op_sel:[1,0,0] op_sel_hi:[1,0,0]
    v_fma_mix_f32 v176, v159, v66, v98 op_sel:[0,0,0] op_sel_hi:[1,0,0]
    v_fma_mix_f32 v177, v159, v67, v99 op_sel:[1,0,0] op_sel_hi:[1,0,0]
    v_fma_mix_f32 v178, v160, v68, v100 op_sel:[0,0,0] op_sel_hi:[1,0,0]
    v_fma_mix_f32 v179, v160, v69, v101 op_sel:[1,0,0] op_sel_hi:[1,0,0]
    v_cvt_pk_bf16_f32 v162, 0, v162
    v_cvt_pk_bf16_f32 v163, 0, v163
    v_cvt_pk_bf16_f32 v164, 0, v164
    v_cvt_pk_bf16_f32 v165, 0, v165
    v_cvt_pk_bf16_f32 v166, 0, v166
    v_cvt_pk_bf16_f32 v167, 0, v167
    v_cvt_pk_bf16_f32 v168, 0, v168
    v_cvt_pk_bf16_f32 v169, 0, v169
    v_cvt_pk_bf16_f32 v170, 0, v170
    v_cvt_pk_bf16_f32 v171, 0, v171
    v_cvt_pk_bf16_f32 v172, 0, v172
    v_cvt_pk_bf16_f32 v173, 0, v173
    v_cvt_pk_bf16_f32 v174, 0, v174
    v_cvt_pk_bf16_f32 v175, 0, v175
    v_cvt_pk_bf16_f32 v176, 0, v176
    v_cvt_pk_bf16_f32 v177, 0, v177
    v_cvt_pk_bf16_f32 v178, 0, v178
    v_cvt_pk_bf16_f32 v179, 0, v179
    v_dot2_f32_bf16 v162, v16, v6, v162
    v_dot2_f32_bf16 v163, v16, v7, v163
    v_dot2_f32_bf16 v164, v17, v6, v164
    v_dot2_f32_bf16 v165, v17, v7, v165
    v_dot2_f32_bf16 v166, v18, v6, v166
    v_dot2_f32_bf16 v167, v18, v7, v167
    v_dot2_f32_bf16 v168, v19, v6, v168
    v_dot2_f32_bf16 v169, v19, v7, v169
    v_dot2_f32_bf16 v170, v20, v6, v170
    v_dot2_f32_bf16 v171, v20, v7, v171
    v_dot2_f32_bf16 v172, v21, v6, v172
    v_dot2_f32_bf16 v173, v21, v7, v173
    v_dot2_f32_bf16 v174, v22, v6, v174
    v_dot2_f32_bf16 v175, v22, v7, v175
    v_dot2_f32_bf16 v176, v23, v6, v176
    v_dot2_f32_bf16 v177, v23, v7, v177
    v_dot2_f32_bf16 v178, v24, v6, v178
    v_dot2_f32_bf16 v179, v24, v7, v179
    v_cvt_pk_bf16_f32 v162, 0, v162
    v_cvt_pk_bf16_f32 v163, 0, v163
    v_cvt_pk_bf16_f32 v164, 0, v164
    v_cvt_pk_bf16_f32 v165, 0, v165
    v_cvt_pk_bf16_f32 v166, 0, v166
    v_cvt_pk_bf16_f32 v167, 0, v167
    v_cvt_pk_bf16_f32 v168, 0, v168
    v_cvt_pk_bf16_f32 v169, 0, v169
    v_cvt_pk_bf16_f32 v170, 0, v170
    v_cvt_pk_bf16_f32 v171, 0, v171
    v_cvt_pk_bf16_f32 v172, 0, v172
    v_cvt_pk_bf16_f32 v173, 0, v173
    v_cvt_pk_bf16_f32 v174, 0, v174
    v_cvt_pk_bf16_f32 v175, 0, v175
    v_cvt_pk_bf16_f32 v176, 0, v176
    v_cvt_pk_bf16_f32 v177, 0, v177
    v_cvt_pk_bf16_f32 v178, 0, v178
    v_cvt_pk_bf16_f32 v179, 0, v179
    v_pk_add_f32 v[102:103], v[162:163], v[200:201] op_sel_hi:[1,0] neg_lo:[0,1] neg_hi:[0,1]
    v_pk_add_f32 v[104:105], v[164:165], v[200:201] op_sel_hi:[1,0] neg_lo:[0,1] neg_hi:[0,1]
    v_pk_add_f32 v[106:107], v[166:167], v[200:201] op_sel_hi:[1,0] neg_lo:[0,1] neg_hi:[0,1]
    v_pk_add_f32 v[108:109], v[168:169], v[200:201] op_sel_hi:[1,0] neg_lo:[0,1] neg_hi:[0,1]
    v_pk_add_f32 v[110:111], v[170:171], v[200:201] op_sel_hi:[1,0] neg_lo:[0,1] neg_hi:[0,1]
    v_pk_add_f32 v[112:113], v[172:173], v[200:201] op_sel_hi:[1,0] neg_lo:[0,1] neg_hi:[0,1]
    v_pk_add_f32 v[114:115], v[174:175], v[200:201] op_sel_hi:[1,0] neg_lo:[0,1] neg_hi:[0,1]
    v_pk_add_f32 v[116:117], v[176:177], v[200:201] op_sel_hi:[1,0] neg_lo:[0,1] neg_hi:[0,1]
    v_pk_add_f32 v[118:119], v[178:179], v[200:201] op_sel_hi:[1,0] neg_lo:[0,1] neg_hi:[0,1]
    v_cvt_pk_bf16_f32 v102, 0, v102
    v_cvt_pk_bf16_f32 v103, 0, v103
    v_cvt_pk_bf16_f32 v104, 0, v104
    v_cvt_pk_bf16_f32 v105, 0, v105
    v_cvt_pk_bf16_f32 v106, 0, v106
    v_cvt_pk_bf16_f32 v107, 0, v107
    v_cvt_pk_bf16_f32 v108, 0, v108
    v_cvt_pk_bf16_f32 v109, 0, v109
    v_cvt_pk_bf16_f32 v110, 0, v110
    buffer_load_dwordx4 v[228:231], v47, s[32:35], s60 offen sc1
    v_cvt_pk_bf16_f32 v111, 0, v111
    v_cvt_pk_bf16_f32 v112, 0, v112
    v_cvt_pk_bf16_f32 v113, 0, v113
    v_cvt_pk_bf16_f32 v114, 0, v114
    v_cvt_pk_bf16_f32 v115, 0, v115
    v_cvt_pk_bf16_f32 v116, 0, v116
    v_cvt_pk_bf16_f32 v117, 0, v117
    v_cvt_pk_bf16_f32 v118, 0, v118
    v_cvt_pk_bf16_f32 v119, 0, v119
    v_pk_mul_f32 v[102:103], v[102:103], v[202:203] op_sel_hi:[1,0]
    v_pk_mul_f32 v[104:105], v[104:105], v[202:203] op_sel_hi:[1,0]
    v_pk_mul_f32 v[106:107], v[106:107], v[202:203] op_sel_hi:[1,0]
    v_pk_mul_f32 v[108:109], v[108:109], v[202:203] op_sel_hi:[1,0]
    v_pk_mul_f32 v[110:111], v[110:111], v[202:203] op_sel_hi:[1,0]
    v_pk_mul_f32 v[112:113], v[112:113], v[202:203] op_sel_hi:[1,0]
    v_pk_mul_f32 v[114:115], v[114:115], v[202:203] op_sel_hi:[1,0]
    v_pk_mul_f32 v[116:117], v[116:117], v[202:203] op_sel_hi:[1,0]
    v_pk_mul_f32 v[118:119], v[118:119], v[202:203] op_sel_hi:[1,0]
    s_waitcnt lgkmcnt(0)
    v_and_or_b32 v205, v205, v45, v44
    v_mov_b32 v206, v205
    v_cvt_pk_bf16_f32 v180, v102, v103
    s_nop 0
    v_max_u32_dpp v206, v206, v206 row_ror:8 row_mask:0xf bank_mask:0xf
    v_cvt_pk_bf16_f32 v181, v104, v105
    s_nop 0
    v_max_u32_dpp v206, v206, v206 row_ror:4 row_mask:0xf bank_mask:0xf
    v_cvt_pk_bf16_f32 v182, v106, v107
    s_nop 0
    v_max_u32_dpp v206, v206, v206 row_ror:2 row_mask:0xf bank_mask:0xf
    s_nop 1
    v_max_u32_dpp v206, v206, v206 row_ror:1 row_mask:0xf bank_mask:0xf
    ds_write_b128 v46, v[180:183]
    v_readfirstlane_b32 s56, v206
    v_cvt_pk_bf16_f32 v184, v108, v109
    v_cmp_ne_u32 vcc, v206, v205
    v_cvt_pk_bf16_f32 v185, v110, v111
    s_nop 0
    v_cndmask_b32 v205, 0, v205, vcc
    v_mov_b32 v206, v205
    v_cvt_pk_bf16_f32 v186, v112, v113
    s_nop 0
    v_max_u32_dpp v206, v206, v206 row_ror:8 row_mask:0xf bank_mask:0xf
    ds_write_b128 v46, v[184:187] offset:512
    s_nop 0
    v_max_u32_dpp v206, v206, v206 row_ror:4 row_mask:0xf bank_mask:0xf
    v_cvt_pk_bf16_f32 v188, v114, v115
    s_nop 0
    v_max_u32_dpp v206, v206, v206 row_ror:2 row_mask:0xf bank_mask:0xf
    s_nop 1
    v_max_u32_dpp v206, v206, v206 row_ror:1 row_mask:0xf bank_mask:0xf
    v_cvt_pk_bf16_f32 v189, v116, v117
    v_readfirstlane_b32 s57, v206
    v_cvt_pk_bf16_f32 v190, v118, v119
    v_cmp_ne_u32 vcc, v206, v205
    ds_write_b128 v46, v[188:191] offset:1024
    s_nop 0
    v_cndmask_b32 v205, 0, v205, vcc
    s_waitcnt lgkmcnt(0)
    s_barrier
    s_andn2_b32 s46, 15, s56
    s_mul_i32 s46, s46, 1536
    v_add_u32 v37, s46, v2
    ds_read_b128 v[120:123], v37
    ds_read_b128 v[124:127], v37 offset:1024
    s_andn2_b32 s46, 15, s57
    s_mul_i32 s46, s46, 1536
    v_add_u32 v37, s46, v2
    ds_read_b128 v[128:131], v37
    ds_read_b128 v[132:135], v37 offset:1024
    s_mov_b32 s47, 0
PL18:
    s_waitcnt vmcnt(0)
    v_xor_b32 v228, v48, v228
    v_xor_b32 v229, v48, v229
    v_xor_b32 v230, v48, v230
    v_xor_b32 v231, v48, v231
    v_or3_b32 v37, v228, v229, v230
    v_or_b32 v37, v37, v231
    v_and_b32 v37, 0xffff, v37
    v_cmp_ne_u32 vcc, 0, v37
    s_cbranch_vccz PD19
    s_add_u32 s47, s47, 1
    s_cmp_ge_u32 s47, 65536
    s_cbranch_scc1 PD19
    s_sleep 1
    buffer_load_dwordx4 v[228:231], v47, s[32:35], s60 offen sc1
    s_branch PL18
PD19:
    v_or_b32 v228, v228, v232
    v_or_b32 v229, v229, v233
    v_or_b32 v230, v230, v234
    v_or_b32 v231, v231, v235
RK_LOOP:
    v_cmp_lt_u32 s[4:5], s56, v228
    v_cmp_lt_u32 s[6:7], s56, v229
    v_cmp_lt_u32 s[8:9], s56, v230
    v_cmp_lt_u32 s[10:11], s56, v231
    v_cmp_lt_u32 s[12:13], s57, v228
    v_cmp_lt_u32 s[14:15], s57, v229
    v_cmp_lt_u32 s[16:17], s57, v230
    v_cmp_lt_u32 s[18:19], s57, v231
    s_bcnt1_i32_b64 s4, s[4:5]
    s_bcnt1_i32_b64 s6, s[6:7]
    s_bcnt1_i32_b64 s8, s[8:9]
    s_bcnt1_i32_b64 s10, s[10:11]
    s_add_u32 s4, s4, s6
    s_add_u32 s8, s8, s10
    s_add_u32 s46, s4, s8
    s_bcnt1_i32_b64 s12, s[12:13]
    s_bcnt1_i32_b64 s14, s[14:15]
    s_bcnt1_i32_b64 s16, s[16:17]
    s_bcnt1_i32_b64 s18, s[18:19]
    s_add_u32 s12, s12, s14
    s_add_u32 s16, s16, s18
    s_add_u32 s48, s12, s16
    s_pack_ll_b32_b16 s46, s46, s48
    v_mov_b32 v37, s46
    s_mov_b64 exec, 1
    ds_add_u32 v49, v37
    s_mov_b64 exec, -1
    s_waitcnt lgkmcnt(0)
    s_barrier
    ds_read_b32 v37, v49
    v_add_u32 v49, 4, v49
    s_waitcnt lgkmcnt(0)
    v_readfirstlane_b32 s53, v37
    s_and_b32 s54, s53, 0xffff
    s_cmp_ge_u32 s54, 8
    s_cbranch_scc1 RK_DONE
    s_mul_i32 s48, s54, 1536
    s_add_u32 s48, s48, s61
    buffer_store_dwordx4 v[120:123], v2, s[32:35], s48 offen sc1
    s_mov_b32 exec_hi, 0
    buffer_store_dwordx4 v[124:127], v2, s[32:35], s48 offen offset:1024 sc1
    s_mov_b64 exec, -1
    s_andn2_b32 s46, 0xffff, s56
    s_and_b32 s48, s46, 11
    s_cmp_lg_u32 s48, s52
    s_cbranch_scc1 RK_N20
    s_bitcmp1_b32 s46, 2
    s_cselect_b32 exec_lo, 0, -1
    s_cselect_b32 exec_hi, -1, 0
    v_mov_b32 v50, s54
    v_mov_b32 v51, s46
    s_mov_b64 exec, -1
RK_N20:
    s_lshr_b32 s54, s53, 16
    s_cmp_ge_u32 s54, 8
    s_cbranch_scc1 RK_DONE
    s_mul_i32 s48, s54, 1536
    s_add_u32 s48, s48, s61
    buffer_store_dwordx4 v[128:131], v2, s[32:35], s48 offen sc1
    s_mov_b32 exec_hi, 0
    buffer_store_dwordx4 v[132:135], v2, s[32:35], s48 offen offset:1024 sc1
    s_mov_b64 exec, -1
    s_andn2_b32 s46, 0xffff, s57
    s_and_b32 s48, s46, 11
    s_cmp_lg_u32 s48, s52
    s_cbranch_scc1 RK_N21
    s_bitcmp1_b32 s46, 2
    s_cselect_b32 exec_lo, 0, -1
    s_cselect_b32 exec_hi, -1, 0
    v_mov_b32 v50, s54
    v_mov_b32 v51, s46
    s_mov_b64 exec, -1
RK_N21:
    v_mov_b32 v206, v205
    s_nop 1
    v_max_u32_dpp v206, v206, v206 row_ror:8 row_mask:0xf bank_mask:0xf
    s_nop 1
    v_max_u32_dpp v206, v206, v206 row_ror:4 row_mask:0xf bank_mask:0xf
    s_nop 1
    v_max_u32_dpp v206, v206, v206 row_ror:2 row_mask:0xf bank_mask:0xf
    s_nop 1
    v_max_u32_dpp v206, v206, v206 row_ror:1 row_mask:0xf bank_mask:0xf
    s_nop 0
    v_readfirstlane_b32 s56, v206
    v_cmp_ne_u32 vcc, v206, v205
    s_nop 1
    v_cndmask_b32 v205, 0, v205, vcc
    v_mov_b32 v206, v205
    s_nop 1
    v_max_u32_dpp v206, v206, v206 row_ror:8 row_mask:0xf bank_mask:0xf
    s_nop 1
    v_max_u32_dpp v206, v206, v206 row_ror:4 row_mask:0xf bank_mask:0xf
    s_nop 1
    v_max_u32_dpp v206, v206, v206 row_ror:2 row_mask:0xf bank_mask:0xf
    s_nop 1
    v_max_u32_dpp v206, v206, v206 row_ror:1 row_mask:0xf bank_mask:0xf
    s_nop 0
    v_readfirstlane_b32 s57, v206
    v_cmp_ne_u32 vcc, v206, v205
    s_nop 1
    v_cndmask_b32 v205, 0, v205, vcc
    s_andn2_b32 s46, 15, s56
    s_mul_i32 s46, s46, 1536
    v_add_u32 v37, s46, v2
    ds_read_b128 v[120:123], v37
    ds_read_b128 v[124:127], v37 offset:1024
    s_andn2_b32 s46, 15, s57
    s_mul_i32 s46, s46, 1536
    v_add_u32 v37, s46, v2
    ds_read_b128 v[128:131], v37
    ds_read_b128 v[132:135], v37 offset:1024
    s_branch RK_LOOP
RK_DONE:
    v_cmp_gt_u32 vcc, 8, v50
    s_andn2_b64 s[58:59], -1, vcc
    s_and_b64 exec, vcc, -1
    s_cbranch_execz RK_NOSEL
    v_mul_f32 v30, 0xbfb8aa3b, v236
    v_exp_f32 v30, v30
    v_mov_b32 v31, s40
    v_add_f32 v30, 1.0, v30
    v_rcp_f32 v30, v30
    v_mov_b32 v35, s40
    v_cvt_pk_bf16_f32 v30, 0, v30
    v_or_b32 v30, v51, v30
    v_mov_b32 v34, v30
    v_mul_u32_u24 v50, 4608, v50
    v_add_u32 v50, v50, v12
    s_mov_b32 s48, 131072
    s_mov_b32 s55, 131584
    v_or_b32_sdwa v28, v162, v180 dst_sel:DWORD dst_unused:UNUSED_PAD src0_sel:DWORD src1_sel:WORD_0
    v_or_b32_sdwa v29, v163, v180 dst_sel:DWORD dst_unused:UNUSED_PAD src0_sel:DWORD src1_sel:WORD_1
    buffer_store_dwordx4 v[28:31], v50, s[32:35], s48 offen offset:0 sc1
    v_or_b32_sdwa v32, v164, v181 dst_sel:DWORD dst_unused:UNUSED_PAD src0_sel:DWORD src1_sel:WORD_0
    v_or_b32_sdwa v33, v165, v181 dst_sel:DWORD dst_unused:UNUSED_PAD src0_sel:DWORD src1_sel:WORD_1
    buffer_store_dwordx4 v[32:35], v50, s[32:35], s55 offen offset:0 sc1
    v_or_b32_sdwa v28, v166, v182 dst_sel:DWORD dst_unused:UNUSED_PAD src0_sel:DWORD src1_sel:WORD_0
    v_or_b32_sdwa v29, v167, v182 dst_sel:DWORD dst_unused:UNUSED_PAD src0_sel:DWORD src1_sel:WORD_1
    buffer_store_dwordx4 v[28:31], v50, s[32:35], s55 offen offset:512 sc1
    v_or_b32_sdwa v32, v168, v184 dst_sel:DWORD dst_unused:UNUSED_PAD src0_sel:DWORD src1_sel:WORD_0
    v_or_b32_sdwa v33, v169, v184 dst_sel:DWORD dst_unused:UNUSED_PAD src0_sel:DWORD src1_sel:WORD_1
    buffer_store_dwordx4 v[32:35], v50, s[32:35], s55 offen offset:1024 sc1
    v_or_b32_sdwa v28, v170, v185 dst_sel:DWORD dst_unused:UNUSED_PAD src0_sel:DWORD src1_sel:WORD_0
    v_or_b32_sdwa v29, v171, v185 dst_sel:DWORD dst_unused:UNUSED_PAD src0_sel:DWORD src1_sel:WORD_1
    buffer_store_dwordx4 v[28:31], v50, s[32:35], s55 offen offset:1536 sc1
    v_or_b32_sdwa v32, v172, v186 dst_sel:DWORD dst_unused:UNUSED_PAD src0_sel:DWORD src1_sel:WORD_0
    v_or_b32_sdwa v33, v173, v186 dst_sel:DWORD dst_unused:UNUSED_PAD src0_sel:DWORD src1_sel:WORD_1
    buffer_store_dwordx4 v[32:35], v50, s[32:35], s55 offen offset:2048 sc1
    v_or_b32_sdwa v28, v174, v188 dst_sel:DWORD dst_unused:UNUSED_PAD src0_sel:DWORD src1_sel:WORD_0
    v_or_b32_sdwa v29, v175, v188 dst_sel:DWORD dst_unused:UNUSED_PAD src0_sel:DWORD src1_sel:WORD_1
    buffer_store_dwordx4 v[28:31], v50, s[32:35], s55 offen offset:2560 sc1
    v_or_b32_sdwa v32, v176, v189 dst_sel:DWORD dst_unused:UNUSED_PAD src0_sel:DWORD src1_sel:WORD_0
    v_or_b32_sdwa v33, v177, v189 dst_sel:DWORD dst_unused:UNUSED_PAD src0_sel:DWORD src1_sel:WORD_1
    buffer_store_dwordx4 v[32:35], v50, s[32:35], s55 offen offset:3072 sc1
    v_or_b32_sdwa v28, v178, v190 dst_sel:DWORD dst_unused:UNUSED_PAD src0_sel:DWORD src1_sel:WORD_0
    v_or_b32_sdwa v29, v179, v190 dst_sel:DWORD dst_unused:UNUSED_PAD src0_sel:DWORD src1_sel:WORD_1
    buffer_store_dwordx4 v[28:31], v50, s[32:35], s55 offen offset:3584 sc1
RK_NOSEL:
    s_mov_b64 exec, -1
    v_dot2_f32_bf16 v162, v180, v6, v162
    v_dot2_f32_bf16 v163, v180, v7, v163
    v_dot2_f32_bf16 v164, v181, v6, v164
    v_dot2_f32_bf16 v165, v181, v7, v165
    v_dot2_f32_bf16 v166, v182, v6, v166
    v_dot2_f32_bf16 v167, v182, v7, v167
    v_dot2_f32_bf16 v168, v184, v6, v168
    v_dot2_f32_bf16 v169, v184, v7, v169
    v_dot2_f32_bf16 v170, v185, v6, v170
    v_dot2_f32_bf16 v171, v185, v7, v171
    v_dot2_f32_bf16 v172, v186, v6, v172
    v_dot2_f32_bf16 v173, v186, v7, v173
    v_dot2_f32_bf16 v174, v188, v6, v174
    v_dot2_f32_bf16 v175, v188, v7, v175
    v_dot2_f32_bf16 v176, v189, v6, v176
    v_dot2_f32_bf16 v177, v189, v7, v177
    v_dot2_f32_bf16 v178, v190, v6, v178
    v_dot2_f32_bf16 v179, v190, v7, v179
    v_cvt_pk_bf16_f32 v16, v162, v163
    v_cvt_pk_bf16_f32 v17, v164, v165
    v_cvt_pk_bf16_f32 v18, v166, v167
    v_cvt_pk_bf16_f32 v19, v168, v169
    v_cvt_pk_bf16_f32 v20, v170, v171
    v_cvt_pk_bf16_f32 v21, v172, v173
    v_cvt_pk_bf16_f32 v22, v174, v175
    v_cvt_pk_bf16_f32 v23, v176, v177
    v_cvt_pk_bf16_f32 v24, v178, v179
    s_mov_b64 exec, s[58:59]
    s_cbranch_execz RK_NOOUT
    global_store_dwordx4 v4, v[16:19], s[28:29] sc1
    global_store_dwordx4 v4, v[20:23], s[28:29] offset:512 sc1
    global_store_dword v5, v24, s[28:29] offset:1024 sc1
RK_NOOUT:
    s_mov_b64 exec, -1
    s_cmp_ge_u32 s2, 144
    s_cbranch_scc1 DUMP
ZROLE:
    s_and_b32 s50, s2, 7
    s_mul_i32 s50, s50, 18
    s_lshr_b32 s46, s2, 3
    s_add_u32 s50, s50, s46
    s_mul_i32 s60, s50, 9216
    s_add_u32 s60, s60, 7340032
    s_and_b32 s46, s40, 63
    v_mov_b32 v36, s46
    v_lshlrev_b32 v82, 2, v0
    s_cmp_lg_u32 s3, 0
    s_cbranch_scc1 Z_W
    v_and_b32 v12, 7, v1
    v_mul_u32_u24 v12, 4608, v12
    v_bfe_u32 v13, v1, 4, 1
    v_lshrrev_b32 v14, 5, v1
    v_lshl_add_u32 v13, v13, 1, v14
    s_lshl_b32 s46, s50, 2
    v_add_u32 v13, s46, v13
    v_bfe_u32 v14, v13, 3, 5
    v_and_b32 v15, 7, v13
    v_lshrrev_b32 v36, 8, v13
    v_lshl_add_u32 v15, v36, 3, v15
    s_cmp_lt_u32 s50, 128
    s_cbranch_scc1 Z_A
    v_bfe_u32 v14, v13, 1, 5
    v_and_b32 v15, 1, v13
    v_add_u32 v15, 16, v15
Z_A:
    v_lshrrev_b32 v36, 1, v15
    v_and_b32 v15, 1, v15
    v_lshl_add_u32 v14, v14, 4, v12
    v_lshl_add_u32 v14, v36, 9, v14
    v_cmp_eq_u32 s[52:53], 1, v15
    s_mul_i32 s60, s50, 9216
    s_add_u32 s60, s60, 7340032
    s_add_u32 s61, s60, 4096
    s_add_u32 s62, s60, 8192
    s_mov_b32 s63, 131072
    s_and_b32 s46, s40, 63
    v_mov_b32 v36, s46
    s_getreg_b32 s48, hwreg(HW_REG_XCC_ID, 0, 3)
    s_lshl_b32 s48, s48, 14
    s_add_u32 s48, s48, 9699328
    s_add_u32 s59, s48, 8192
    v_lshlrev_b32 v80, 7, v1
    v_and_b32 v81, 7, v1
    v_lshlrev_b32 v81, 7, v81
    buffer_load_dword v38, v80, s[32:35], s48 offen sc1
    buffer_load_dword v39, v81, s[32:35], s59 offen sc1
    s_mov_b32 s47, 0
PL22:
    s_waitcnt vmcnt(0)
    v_cmp_ne_u32 vcc, s40, v38
    v_cmp_ne_u32 s[56:57], s40, v39
    s_or_b64 vcc, vcc, s[56:57]
    s_cbranch_vccz PD23
    s_add_u32 s47, s47, 1
    s_cmp_ge_u32 s47, 65536
    s_cbranch_scc1 PD23
    s_sleep 1
    buffer_load_dword v38, v80, s[32:35], s48 offen sc1
    buffer_load_dword v39, v81, s[32:35], s59 offen sc1
    s_branch PL22
PD23:
    buffer_load_dwordx4 v[32:35], v14, s[32:35], s63 offen sc1
    s_mov_b32 s47, 0
PL24:
    s_waitcnt vmcnt(0)
    v_cmp_ne_u32 vcc, s40, v35
    s_cbranch_vccz PD25
    s_add_u32 s47, s47, 1
    s_cmp_ge_u32 s47, 65536
    s_cbranch_scc1 PD25
    s_sleep 2
    buffer_load_dwordx4 v[32:35], v14, s[32:35], s63 offen sc1
    s_branch PL24
PD25:
    v_mov_b32 v38, 0
    s_barrier
    buffer_load_dwordx4 v[40:43], v3, s[32:35], s60 offen sc1
    buffer_load_dwordx4 v[44:47], v3, s[32:35], s62 offen sc1
    v_cndmask_b32 v32, v32, v33, s[52:53]
    v_and_b32 v33, 0xffff0000, v34
    v_and_b32 v28, 2047, v34
    v_mul_u32_u24 v28, 1152, v28
    v_lshl_add_u32 v28, v13, 1, v28
    v_lshlrev_b32 v34, 16, v32
    v_and_b32 v35, 0xffff0000, v32
    s_mov_b32 s47, 0
PL26:
    s_waitcnt vmcnt(0)
    v_xor_b32 v40, v36, v40
    v_xor_b32 v41, v36, v41
    v_xor_b32 v42, v36, v42
    v_xor_b32 v43, v36, v43
    v_xor_b32 v44, v36, v44
    v_xor_b32 v45, v36, v45
    v_xor_b32 v46, v36, v46
    v_xor_b32 v47, v36, v47
    v_or3_b32 v37, v40, v41, v42
    v_or3_b32 v37, v37, v44, v45
    v_or3_b32 v37, v37, v46, v47
    v_or_b32 v37, v37, v43
    v_and_b32 v37, 63, v37
    v_cmp_ne_u32 vcc, 0, v37
    s_cbranch_vccz PD27
    s_add_u32 s47, s47, 1
    s_cmp_ge_u32 s47, 65536
    s_cbranch_scc1 PD27
    s_mov_b64 exec, vcc
    buffer_load_dwordx4 v[40:43], v3, s[32:35], s60 offen sc1
    buffer_load_dwordx4 v[44:47], v3, s[32:35], s62 offen sc1
    s_branch PL26
PD27:
    s_mov_b64 exec, -1
    v_pk_add_f32 v[40:41], v[40:41], v[44:45]
    v_pk_add_f32 v[42:43], v[42:43], v[46:47]
    s_nop 0
    v_permlane32_swap_b32 v40, v41
    v_permlane32_swap_b32 v42, v43
    v_add_f32 v40, v40, v41
    v_add_f32 v42, v42, v43
    s_nop 1
    v_permlane16_swap_b32 v40, v42
    v_add_f32 v40, v40, v42
    s_barrier
    ds_read2st64_b32 v[44:45], v82 offset0:1 offset1:2
    ds_read2st64_b32 v[46:47], v82 offset0:3 offset1:4
    ds_read2st64_b32 v[48:49], v82 offset0:5 offset1:6
    ds_read_b32 v50, v82 offset:1792
    s_waitcnt lgkmcnt(2)
    v_add_f32 v44, v44, v45
    v_add_f32 v46, v46, v47
    v_add_f32 v40, v40, v44
    s_waitcnt lgkmcnt(0)
    v_add_f32 v48, v48, v49
    v_add_f32 v46, v46, v50
    v_add_f32 v40, v40, v48
    v_add_f32 v40, v40, v46
    s_nop 1
    v_add_f32_dpp v40, v40, v40 row_ror:8 row_mask:0xf bank_mask:0xf
    v_cvt_pk_bf16_f32 v40, 0, v40
    v_mul_f32 v40, v40, v33
    v_cvt_pk_bf16_f32 v40, 0, v40
    v_add_f32 v40, v40, v34
    v_cvt_pk_bf16_f32 v40, 0, v40
    v_add_f32 v40, v40, v35
    v_cvt_pk_bf16_f32 v40, v40, v40
    s_mov_b32 exec_lo, 0x00ff00ff
    s_mov_b32 exec_hi, 0x00ff00ff
    global_store_short v28, v40, s[28:29]
    s_cmp_lg_u32 s50, 0
    s_cbranch_scc1 DUMP
    s_mov_b64 exec, 1
    v_mov_b32 v36, s40
    buffer_store_dword v36, v2, s[32:35], 0 offen
    s_branch DUMP
Z_W:
    s_barrier
    buffer_load_dwordx4 v[40:43], v3, s[32:35], s60 offen sc1
    s_mov_b32 s47, 0
PL28:
    s_waitcnt vmcnt(0)
    v_xor_b32 v40, v36, v40
    v_xor_b32 v41, v36, v41
    v_xor_b32 v42, v36, v42
    v_xor_b32 v43, v36, v43
    v_or3_b32 v37, v40, v41, v42
    v_or_b32 v37, v37, v43
    v_and_b32 v37, 63, v37
    v_cmp_ne_u32 vcc, 0, v37
    s_cbranch_vccz PD29
    s_add_u32 s47, s47, 1
    s_cmp_ge_u32 s47, 65536
    s_cbranch_scc1 PD29
    s_mov_b64 exec, vcc
    buffer_load_dwordx4 v[40:43], v3, s[32:35], s60 offen sc1
    s_branch PL28
PD29:
    s_mov_b64 exec, -1
    v_permlane32_swap_b32 v40, v41
    v_permlane32_swap_b32 v42, v43
    v_add_f32 v40, v40, v41
    v_add_f32 v42, v42, v43
    s_nop 1
    v_permlane16_swap_b32 v40, v42
    v_add_f32 v40, v40, v42
    ds_write_b32 v82, v40
    s_waitcnt lgkmcnt(0)
    s_barrier
    s_branch DUMP
FROLE:
    s_sub_u32 s50, s2, 144
    s_cmp_lt_u32 s50, 48
    s_cbranch_scc1 F_NT
    v_cmp_gt_u32 vcc, TBLEND-PC0, v15
    s_and_saveexec_b64 s[58:59], vcc
    s_cbranch_execz F_NT
    global_load_dword v255, v15, s[42:43]
F_NT:
    s_mov_b64 exec, -1
    s_and_b32 s46, s50, 7
    s_sub_u32 s48, 3, s46
    s_and_b32 s48, s48, 7
    s_lshr_b32 s50, s50, 3
    s_add_u32 s50, s50, s48
    s_add_u32 s50, s50, 2
    s_cmp_ge_u32 s50, 9
    s_cselect_b32 s48, 9, 0
    s_sub_u32 s50, s50, s48
    s_mul_i32 s46, s46, 9
    s_add_u32 s50, s50, s46
    v_lshrrev_b32 v12, 3, v0
    v_and_b32 v13, 7, v0
    v_lshlrev_b32 v13, 4, v13
    v_mul_u32_u24 v4, 9216, v12
    v_add_u32 v4, v4, v13
    v_mul_u32_u24 v5, 1152, v12
    v_add_u32 v5, v5, v13
    s_lshl_b32 s46, s50, 7
    s_mul_i32 s48, s50, 73728
    s_mov_b32 s38, 5308416
    s_mov_b32 s39, 0x00020000
    s_mov_b32 s54, 5308416
    s_mov_b32 s55, 0x00020000
    s_mov_b32 s58, 5308416
    s_mov_b32 s59, 0x00020000
    s_waitcnt lgkmcnt(0)
    s_mov_b32 s36, s22
    s_and_b32 s37, s23, 0xffff
    s_mov_b32 s52, s24
    s_and_b32 s53, s25, 0xffff
    s_mov_b32 s56, s26
    s_and_b32 s57, s27, 0xffff
    s_load_dword s40, s[30:31], 0
    s_cmp_ge_u32 s2, 192
    s_cbranch_scc1 F_L1
    s_barrier
    s_lshl_b32 s49, s50, 7
    buffer_load_dwordx4 v[16:19], v4, s[36:39], s49 offen nt
    buffer_load_dwordx4 v[20:23], v4, s[52:55], s49 offen nt
    s_add_u32 s49, s49, 589824
    buffer_load_dwordx4 v[24:27], v4, s[36:39], s49 offen nt
    buffer_load_dwordx4 v[28:31], v4, s[52:55], s49 offen nt
    s_add_u32 s49, s49, 589824
    buffer_load_dwordx4 v[32:35], v4, s[36:39], s49 offen nt
    buffer_load_dwordx4 v[36:39], v4, s[52:55], s49 offen nt
    s_add_u32 s49, s49, 589824
    buffer_load_dwordx4 v[40:43], v4, s[36:39], s49 offen nt
    buffer_load_dwordx4 v[44:47], v4, s[52:55], s49 offen nt
    s_add_u32 s49, s49, 589824
F_L1:
    s_mov_b32 s32, s30
    s_and_b32 s33, s31, 0xffff
    s_mov_b32 s34, 0x10000000
    s_mov_b32 s35, 0x00020000
    v_mul_u32_u24 v6, 272, v12
    v_add_u32 v6, v6, v13
    v_lshrrev_b32 v14, 4, v1
    v_bfe_u32 v15, v1, 2, 2
    v_lshl_add_u32 v7, v14, 3, v15
    v_mul_u32_u24 v7, 272, v7
    v_and_b32 v8, 2, v1
    v_lshl_add_u32 v7, v8, 6, v7
    v_and_b32 v8, 1, v1
    v_lshl_add_u32 v7, v8, 3, v7
    s_lshl_b32 s46, s3, 4
    v_add_u32 v7, s46, v7
    v_bfe_u32 v8, v1, 3, 3
    v_mul_u32_u24 v8, 1184, v8
    v_add_u32 v8, v8, v13
    s_mul_i32 s46, s3, 9600
    v_add_u32 v8, s46, v8
    v_mul_u32_u24 v9, 9600, v14
    v_mul_u32_u24 v15, 1184, v15
    v_add_u32 v9, v9, v15
    v_and_b32 v15, 3, v1
    v_lshl_add_u32 v9, v15, 3, v9
    s_lshl_b32 s46, s3, 5
    v_add_u32 v9, s46, v9
    v_add_u32 v242, 0, v0
    v_mul_u32_u24 v243, 683, v242
    v_lshrrev_b32 v243, 16, v243
    v_mul_u32_u24 v244, 96, v243
    v_sub_u32 v242, v242, v244
    v_mul_u32_u24 v243, 1168, v243
    v_add_u32 v243, 81920, v243
    v_and_b32 v244, 31, v242
    v_lshrrev_b32 v242, 5, v242
    v_lshl_add_u32 v245, v244, 4, v243
    v_lshl_add_u32 v246, v244, 2, v243
    v_add_u32 v246, 1024, v246
    v_cmp_eq_u32 s[60:61], 1, v242
    v_cmp_eq_u32 s[62:63], 2, v242
    v_mov_b32 v247, 0
    v_mov_b32 v248, 12
    v_cndmask_b32 v247, v247, v248, s[60:61]
    v_mov_b32 v248, 520
    v_cndmask_b32 v247, v247, v248, s[62:63]
    v_add_u32 v236, v247, v245
    v_mov_b32 v247, 4
    v_mov_b32 v248, 512
    v_cndmask_b32 v247, v247, v248, s[60:61]
    v_mov_b32 v248, 524
    v_cndmask_b32 v247, v247, v248, s[62:63]
    v_add_u32 v237, v247, v245
    v_mov_b32 v247, 8
    v_mov_b32 v248, 516
    v_cndmask_b32 v247, v247, v248, s[60:61]
    v_add_u32 v247, v247, v245
    v_cndmask_b32 v238, v247, v246, s[62:63]
    v_add_u32 v242, 512, v0
    v_mul_u32_u24 v243, 683, v242
    v_lshrrev_b32 v243, 16, v243
    v_mul_u32_u24 v244, 96, v243
    v_sub_u32 v242, v242, v244
    v_mul_u32_u24 v243, 1168, v243
    v_add_u32 v243, 81920, v243
    v_and_b32 v244, 31, v242
    v_lshrrev_b32 v242, 5, v242
    v_lshl_add_u32 v245, v244, 4, v243
    v_lshl_add_u32 v246, v244, 2, v243
    v_add_u32 v246, 1024, v246
    v_cmp_eq_u32 s[60:61], 1, v242
    v_cmp_eq_u32 s[62:63], 2, v242
    v_mov_b32 v247, 0
    v_mov_b32 v248, 12
    v_cndmask_b32 v247, v247, v248, s[60:61]
    v_mov_b32 v248, 520
    v_cndmask_b32 v247, v247, v248, s[62:63]
    v_add_u32 v239, v247, v245
    v_mov_b32 v247, 4
    v_mov_b32 v248, 512
    v_cndmask_b32 v247, v247, v248, s[60:61]
    v_mov_b32 v248, 524
    v_cndmask_b32 v247, v247, v248, s[62:63]
    v_add_u32 v240, v247, v245
    v_mov_b32 v247, 8
    v_mov_b32 v248, 516
    v_cndmask_b32 v247, v247, v248, s[60:61]
    v_add_u32 v247, v247, v245
    v_cndmask_b32 v241, v247, v246, s[62:63]
    v_and_b32 v15, 7, v1
    v_mul_u32_u24 v10, 1168, v15
    v_lshl_add_u32 v10, v14, 4, v10
    v_add_u32 v10, 81920, v10
    v_mul_u32_u24 v11, 144, v15
    v_add_u32 v11, 98304, v11
    v_lshl_add_u32 v242, v14, 4, v11
    v_bfe_u32 v243, v1, 4, 1
    v_lshl_add_u32 v11, v243, 3, v11
    v_bfe_u32 v243, v1, 3, 1
    v_lshl_add_u32 v11, v243, 2, v11
    v_lshrrev_b32 v244, 5, v1
    v_lshl_add_u32 v11, v244, 1, v11
    s_lshl_b32 s46, s3, 4
    v_add_u32 v11, s46, v11
    v_lshl_add_u32 v243, v243, 5, v14
    v_mul_u32_u24 v243, 9216, v243
    v_lshl_add_u32 v243, v15, 4, v243
    s_mul_i32 s62, s3, 36864
    s_lshl_b32 s46, s50, 7
    s_add_u32 s62, s62, s46
    s_add_u32 s62, s62, 7340032
    v_and_b32 v244, 8, v1
    v_cmp_eq_u32 s[60:61], 0, v244
    s_waitcnt lgkmcnt(0)
    s_add_u32 s40, s40, 1
    s_and_b32 s46, s40, 63
    v_mov_b32 v245, s46
    v_mov_b32 v246, 0xffffffc0
    v_mov_b32 v249, s40
    v_lshlrev_b32 v250, 14, v1
    s_lshl_b32 s63, s50, 7
    s_add_u32 s63, s63, 9699328
    s_cmp_lt_u32 s2, 192
    s_cbranch_scc1 F_L2
    s_lshl_b32 s49, s50, 7
    buffer_load_dwordx4 v[16:19], v4, s[36:39], s49 offen nt
    buffer_load_dwordx4 v[20:23], v4, s[52:55], s49 offen nt
    s_add_u32 s49, s49, 589824
    buffer_load_dwordx4 v[24:27], v4, s[36:39], s49 offen nt
    buffer_load_dwordx4 v[28:31], v4, s[52:55], s49 offen nt
    s_add_u32 s49, s49, 589824
    buffer_load_dwordx4 v[32:35], v4, s[36:39], s49 offen nt
    buffer_load_dwordx4 v[36:39], v4, s[52:55], s49 offen nt
    s_add_u32 s49, s49, 589824
    buffer_load_dwordx4 v[40:43], v4, s[36:39], s49 offen nt
    buffer_load_dwordx4 v[44:47], v4, s[52:55], s49 offen nt
    s_add_u32 s49, s49, 589824
F_L2:
    buffer_load_dwordx4 v[48:51], v4, s[36:39], s49 offen nt
    buffer_load_dwordx4 v[52:55], v4, s[52:55], s49 offen nt
    s_add_u32 s49, s49, 589824
    s_waitcnt vmcnt(8)
    ds_write_b128 v6, v[16:19] offset:0
    ds_write_b128 v6, v[20:23] offset:128
    s_waitcnt lgkmcnt(0)
    s_barrier
    ds_read_b64_tr_b16 v[124:125], v7 offset:0
    ds_read_b64_tr_b16 v[126:127], v7 offset:1088
    ds_read_b64_tr_b16 v[128:129], v7 offset:8704
    ds_read_b64_tr_b16 v[130:131], v7 offset:9792
    buffer_load_dwordx4 v[56:59], v4, s[36:39], s49 offen nt
    buffer_load_dwordx4 v[60:63], v4, s[52:55], s49 offen nt
    s_add_u32 s49, s49, 589824
    s_waitcnt vmcnt(8)
    ds_write_b128 v6, v[24:27] offset:17408
    ds_write_b128 v6, v[28:31] offset:17536
    s_waitcnt lgkmcnt(0)
    s_barrier
    ds_read_b64_tr_b16 v[132:133], v7 offset:17408
    ds_read_b64_tr_b16 v[134:135], v7 offset:18496
    ds_read_b64_tr_b16 v[136:137], v7 offset:26112
    ds_read_b64_tr_b16 v[138:139], v7 offset:27200
    buffer_load_dwordx4 v[64:67], v4, s[36:39], s49 offen nt
    buffer_load_dwordx4 v[68:71], v4, s[52:55], s49 offen nt
    s_add_u32 s49, s49, 589824
    s_waitcnt vmcnt(8)
    ds_write_b128 v6, v[32:35] offset:34816
    ds_write_b128 v6, v[36:39] offset:34944
    s_waitcnt lgkmcnt(0)
    s_barrier
    ds_read_b64_tr_b16 v[140:141], v7 offset:34816
    ds_read_b64_tr_b16 v[142:143], v7 offset:35904
    ds_read_b64_tr_b16 v[144:145], v7 offset:43520
    ds_read_b64_tr_b16 v[146:147], v7 offset:44608
    buffer_load_dwordx4 v[72:75], v4, s[36:39], s49 offen nt
    buffer_load_dwordx4 v[76:79], v4, s[52:55], s49 offen nt
    s_add_u32 s49, s49, 589824
    s_waitcnt vmcnt(8)
    v_add_u32 v6, 52224, v6
    v_add_u32 v7, 52224, v7
    ds_write_b128 v6, v[40:43] offset:0
    ds_write_b128 v6, v[44:47] offset:128
    s_waitcnt lgkmcnt(0)
    s_barrier
    ds_read_b64_tr_b16 v[148:149], v7 offset:0
    ds_read_b64_tr_b16 v[150:151], v7 offset:1088
    ds_read_b64_tr_b16 v[152:153], v7 offset:8704
    ds_read_b64_tr_b16 v[154:155], v7 offset:9792
    buffer_load_dwordx4 v[80:83], v4, s[36:39], s49 offen nt
    buffer_load_dwordx4 v[84:87], v4, s[52:55], s49 offen nt
    s_add_u32 s49, s49, 589824
    s_waitcnt vmcnt(8)
    ds_write_b128 v6, v[48:51] offset:17408
    ds_write_b128 v6, v[52:55] offset:17536
    s_waitcnt lgkmcnt(0)
    s_barrier
    ds_read_b64_tr_b16 v[156:157], v7 offset:17408
    ds_read_b64_tr_b16 v[158:159], v7 offset:18496
    ds_read_b64_tr_b16 v[160:161], v7 offset:26112
    ds_read_b64_tr_b16 v[162:163], v7 offset:27200
    buffer_load_dwordx4 v[88:91], v5, s[56:59], s48 offen offset:0 nt
    buffer_load_dwordx4 v[92:95], v5, s[56:59], s48 offen offset:128 nt
    s_waitcnt vmcnt(8)
    ds_write_b128 v6, v[56:59] offset:34816
    ds_write_b128 v6, v[60:63] offset:34944
    s_waitcnt lgkmcnt(0)
    s_barrier
    ds_read_b64_tr_b16 v[164:165], v7 offset:34816
    ds_read_b64_tr_b16 v[166:167], v7 offset:35904
    ds_read_b64_tr_b16 v[168:169], v7 offset:43520
    ds_read_b64_tr_b16 v[170:171], v7 offset:44608
    buffer_load_dwordx4 v[96:99], v5, s[56:59], s48 offen offset:256 nt
    buffer_load_dwordx4 v[100:103], v5, s[56:59], s48 offen offset:384 nt
    s_waitcnt vmcnt(8)
    v_add_u32 v6, 52224, v6
    v_add_u32 v7, 52224, v7
    ds_write_b128 v6, v[64:67] offset:0
    ds_write_b128 v6, v[68:71] offset:128
    s_waitcnt lgkmcnt(0)
    s_barrier
    ds_read_b64_tr_b16 v[172:173], v7 offset:0
    ds_read_b64_tr_b16 v[174:175], v7 offset:1088
    ds_read_b64_tr_b16 v[176:177], v7 offset:8704
    ds_read_b64_tr_b16 v[178:179], v7 offset:9792
    buffer_load_dwordx4 v[104:107], v5, s[56:59], s48 offen offset:512 nt
    buffer_load_dwordx4 v[108:111], v5, s[56:59], s48 offen offset:640 nt
    s_waitcnt vmcnt(8)
    ds_write_b128 v6, v[72:75] offset:17408
    ds_write_b128 v6, v[76:79] offset:17536
    s_waitcnt lgkmcnt(0)
    s_barrier
    ds_read_b64_tr_b16 v[180:181], v7 offset:17408
    ds_read_b64_tr_b16 v[182:183], v7 offset:18496
    ds_read_b64_tr_b16 v[184:185], v7 offset:26112
    ds_read_b64_tr_b16 v[186:187], v7 offset:27200
    buffer_load_dwordx4 v[112:115], v5, s[56:59], s48 offen offset:768 nt
    buffer_load_dwordx4 v[116:119], v5, s[56:59], s48 offen offset:896 nt
    s_waitcnt vmcnt(8)
    ds_write_b128 v6, v[80:83] offset:34816
    ds_write_b128 v6, v[84:87] offset:34944
    s_waitcnt lgkmcnt(0)
    s_barrier
    ds_read_b64_tr_b16 v[188:189], v7 offset:34816
    ds_read_b64_tr_b16 v[190:191], v7 offset:35904
    ds_read_b64_tr_b16 v[192:193], v7 offset:43520
    ds_read_b64_tr_b16 v[194:195], v7 offset:44608
    buffer_load_dwordx4 v[120:123], v5, s[56:59], s48 offen offset:1024 nt
    s_waitcnt vmcnt(7)
    ds_write_b128 v8, v[88:91] offset:0
    ds_write_b128 v8, v[92:95] offset:128
    s_waitcnt lgkmcnt(0)
    s_barrier
    ds_read_b64_tr_b16 v[196:197], v9 offset:0
    ds_read_b64_tr_b16 v[198:199], v9 offset:4736
    ds_read_b64_tr_b16 v[200:201], v9 offset:38400
    ds_read_b64_tr_b16 v[202:203], v9 offset:43136
    s_waitcnt vmcnt(5)
    ds_write_b128 v8, v[96:99] offset:256
    ds_write_b128 v8, v[100:103] offset:384
    s_waitcnt lgkmcnt(0)
    s_barrier
    ds_read_b64_tr_b16 v[204:205], v9 offset:256
    ds_read_b64_tr_b16 v[206:207], v9 offset:4992
    ds_read_b64_tr_b16 v[208:209], v9 offset:38656
    ds_read_b64_tr_b16 v[210:211], v9 offset:43392
    s_waitcnt vmcnt(3)
    ds_write_b128 v8, v[104:107] offset:512
    ds_write_b128 v8, v[108:111] offset:640
    s_waitcnt lgkmcnt(0)
    s_barrier
    ds_read_b64_tr_b16 v[212:213], v9 offset:512
    ds_read_b64_tr_b16 v[214:215], v9 offset:5248
    ds_read_b64_tr_b16 v[216:217], v9 offset:38912
    ds_read_b64_tr_b16 v[218:219], v9 offset:43648
    s_waitcnt vmcnt(1)
    ds_write_b128 v8, v[112:115] offset:768
    ds_write_b128 v8, v[116:119] offset:896
    s_waitcnt lgkmcnt(0)
    s_barrier
    ds_read_b64_tr_b16 v[220:221], v9 offset:768
    ds_read_b64_tr_b16 v[222:223], v9 offset:5504
    ds_read_b64_tr_b16 v[224:225], v9 offset:39168
    ds_read_b64_tr_b16 v[226:227], v9 offset:43904
    s_waitcnt vmcnt(0)
    ds_write_b128 v8, v[120:123] offset:1024
    s_waitcnt lgkmcnt(0)
    s_barrier
    ds_read_b64_tr_b16 v[228:229], v9 offset:1024
    ds_read_b64_tr_b16 v[230:231], v9 offset:5760
    ds_read_b64_tr_b16 v[232:233], v9 offset:39424
    ds_read_b64_tr_b16 v[234:235], v9 offset:44160
    s_getreg_b32 s48, hwreg(HW_REG_XCC_ID, 0, 3)
    s_mul_i32 s48, s48, 16384
    s_add_u32 s48, s48, 9830400
    s_add_u32 s49, s48, 8192
    s_waitcnt lgkmcnt(0)
    v_xor_b32 v24, 1, v245
    v_xor_b32 v25, 1, v245
    v_xor_b32 v26, 1, v245
    v_xor_b32 v27, 1, v245
    s_add_u32 s52, s62, 589824
    s_add_u32 s53, s62, 1179648
    buffer_store_dwordx4 v[24:27], v243, s[32:35], s62 offen sc1
    buffer_store_dwordx4 v[24:27], v243, s[32:35], s52 offen sc1
    s_cmp_ge_u32 s3, 4
    s_cbranch_scc1 F_P1
    s_mov_b64 exec, s[60:61]
    buffer_store_dwordx4 v[24:27], v243, s[32:35], s53 offen sc1
    s_mov_b64 exec, -1
    s_cmp_ge_u32 s3, 4
    s_cbranch_scc1 F_P1
    buffer_load_dwordx4 v[16:19], v3, s[32:35], s48 offen sc1
    buffer_load_dwordx4 v[20:23], v3, s[32:35], s49 offen sc1
    s_mov_b32 s47, 0
PL30:
    s_waitcnt vmcnt(0)
    v_cmp_ne_u32 vcc, s40, v19
    v_cmp_ne_u32 s[52:53], s40, v23
    s_or_b64 vcc, vcc, s[52:53]
    s_cbranch_vccz PD31
    s_add_u32 s47, s47, 1
    s_cmp_ge_u32 s47, 65536
    s_cbranch_scc1 PD31
    s_sleep 1
    buffer_load_dwordx4 v[16:19], v3, s[32:35], s48 offen sc1
    buffer_load_dwordx4 v[20:23], v3, s[32:35], s49 offen sc1
    s_branch PL30
PD31:
    ds_write_b32 v239, v20
    ds_write_b32 v240, v21
    ds_write_b32 v241, v22
    s_branch F_P2
F_P1:
    buffer_load_dwordx4 v[16:19], v3, s[32:35], s48 offen sc1
    s_mov_b32 s47, 0
PL32:
    s_waitcnt vmcnt(0)
    v_cmp_ne_u32 vcc, s40, v19
    s_cbranch_vccz PD33
    s_add_u32 s47, s47, 1
    s_cmp_ge_u32 s47, 65536
    s_cbranch_scc1 PD33
    s_sleep 1
    buffer_load_dwordx4 v[16:19], v3, s[32:35], s48 offen sc1
    s_branch PL32
PD33:
F_P2:
    ds_write_b32 v236, v16
    ds_write_b32 v237, v17
    ds_write_b32 v238, v18
    s_waitcnt lgkmcnt(0)
    s_barrier
    s_cmp_lg_u32 s3, 7
    s_cbranch_scc1 FH34
    s_mov_b64 exec, 0xff
    buffer_store_dword v249, v250, s[32:35], s63 offen sc1
    s_mov_b64 exec, -1
FH34:
    ds_read_b128 v[32:35], v10 offset:0
    ds_read_b128 v[36:39], v10 offset:64
    ds_read_b128 v[40:43], v10 offset:128
    ds_read_b128 v[44:47], v10 offset:192
    ds_read_b128 v[48:51], v10 offset:256
    ds_read_b128 v[52:55], v10 offset:320
    ds_read_b128 v[56:59], v10 offset:384
    s_waitcnt lgkmcnt(6)
    v_mfma_f32_16x16x32_bf16 v[24:27], v[124:127], v[32:35], 0
    ds_read_b128 v[60:63], v10 offset:448
    s_waitcnt lgkmcnt(6)
    v_mfma_f32_16x16x32_bf16 v[24:27], v[128:131], v[36:39], v[24:27]
    ds_read_b128 v[64:67], v10 offset:512
    s_waitcnt lgkmcnt(6)
    v_mfma_f32_16x16x32_bf16 v[24:27], v[132:135], v[40:43], v[24:27]
    ds_read_b128 v[68:71], v10 offset:576
    s_waitcnt lgkmcnt(6)
    v_mfma_f32_16x16x32_bf16 v[24:27], v[136:139], v[44:47], v[24:27]
    ds_read_b128 v[72:75], v10 offset:640
    s_waitcnt lgkmcnt(6)
    v_mfma_f32_16x16x32_bf16 v[24:27], v[140:143], v[48:51], v[24:27]
    ds_read_b128 v[76:79], v10 offset:704
    s_waitcnt lgkmcnt(6)
    v_mfma_f32_16x16x32_bf16 v[24:27], v[144:147], v[52:55], v[24:27]
    ds_read_b128 v[80:83], v10 offset:768
    s_waitcnt lgkmcnt(6)
    v_mfma_f32_16x16x32_bf16 v[24:27], v[148:151], v[56:59], v[24:27]
    ds_read_b128 v[84:87], v10 offset:832
    s_waitcnt lgkmcnt(6)
    v_mfma_f32_16x16x32_bf16 v[24:27], v[152:155], v[60:63], v[24:27]
    ds_read_b128 v[88:91], v10 offset:896
    s_waitcnt lgkmcnt(6)
    v_mfma_f32_16x16x32_bf16 v[24:27], v[156:159], v[64:67], v[24:27]
    ds_read_b128 v[92:95], v10 offset:960
    s_waitcnt lgkmcnt(6)
    v_mfma_f32_16x16x32_bf16 v[24:27], v[160:163], v[68:71], v[24:27]
    ds_read_b128 v[96:99], v10 offset:1024
    s_waitcnt lgkmcnt(6)
    v_mfma_f32_16x16x32_bf16 v[24:27], v[164:167], v[72:75], v[24:27]
    ds_read_b128 v[100:103], v10 offset:1088
    s_waitcnt lgkmcnt(6)
    v_mfma_f32_16x16x32_bf16 v[24:27], v[168:171], v[76:79], v[24:27]
    s_waitcnt lgkmcnt(5)
    v_mfma_f32_16x16x32_bf16 v[24:27], v[172:175], v[80:83], v[24:27]
    s_waitcnt lgkmcnt(4)
    v_mfma_f32_16x16x32_bf16 v[24:27], v[176:179], v[84:87], v[24:27]
    s_waitcnt lgkmcnt(3)
    v_mfma_f32_16x16x32_bf16 v[24:27], v[180:183], v[88:91], v[24:27]
    s_waitcnt lgkmcnt(2)
    v_mfma_f32_16x16x32_bf16 v[24:27], v[184:187], v[92:95], v[24:27]
    s_waitcnt lgkmcnt(1)
    v_mfma_f32_16x16x32_bf16 v[24:27], v[188:191], v[96:99], v[24:27]
    s_waitcnt lgkmcnt(0)
    v_mfma_f32_16x16x32_bf16 v[24:27], v[192:195], v[100:103], v[24:27]
    s_nop 7
    v_cndmask_b32 v28, v26, v24, s[60:61]
    v_cndmask_b32 v29, v27, v25, s[60:61]
    v_cvt_pk_bf16_f32 v28, 0, v28
    v_cvt_pk_bf16_f32 v29, 0, v29
    s_nop 1
    v_permlane32_swap_b32 v28, v29
    v_mul_f32 v30, 0xbfb8aa3b, v28
    v_exp_f32 v30, v30
    s_nop 0
    v_add_f32 v30, 1.0, v30
    v_rcp_f32 v30, v30
    s_nop 0
    v_mul_f32 v28, v28, v30
    v_cvt_pk_bf16_f32 v28, 0, v28
    v_mul_f32 v28, v28, v29
    v_cvt_pk_bf16_f32 v28, v28, v28
    ds_write_b16 v11, v28
    s_waitcnt lgkmcnt(0)
    s_barrier
    ds_read_b128 v[16:19], v242
    ds_read_b128 v[20:23], v242 offset:64
    s_waitcnt lgkmcnt(1)
    v_mfma_f32_16x16x32_bf16 v[32:35], v[196:199], v[16:19], 0
    v_mfma_f32_16x16x32_bf16 v[36:39], v[204:207], v[16:19], 0
    v_mfma_f32_16x16x32_bf16 v[40:43], v[212:215], v[16:19], 0
    v_mfma_f32_16x16x32_bf16 v[44:47], v[220:223], v[16:19], 0
    v_mfma_f32_16x16x32_bf16 v[48:51], v[228:231], v[16:19], 0
    s_waitcnt lgkmcnt(0)
    v_mfma_f32_16x16x32_bf16 v[32:35], v[200:203], v[20:23], v[32:35]
    v_mfma_f32_16x16x32_bf16 v[36:39], v[208:211], v[20:23], v[36:39]
    v_mfma_f32_16x16x32_bf16 v[40:43], v[216:219], v[20:23], v[40:43]
    v_mfma_f32_16x16x32_bf16 v[44:47], v[224:227], v[20:23], v[44:47]
    v_mfma_f32_16x16x32_bf16 v[48:51], v[232:235], v[20:23], v[48:51]
    s_nop 4
    v_cndmask_b32 v32, v36, v32, s[60:61]
    v_cndmask_b32 v33, v37, v33, s[60:61]
    v_cndmask_b32 v34, v38, v34, s[60:61]
    v_cndmask_b32 v35, v39, v35, s[60:61]
    v_and_or_b32 v32, v32, v246, v245
    v_and_or_b32 v33, v33, v246, v245
    v_and_or_b32 v34, v34, v246, v245
    v_and_or_b32 v35, v35, v246, v245
    buffer_store_dwordx4 v[32:35], v243, s[32:35], s62 offen sc1
    s_add_u32 s62, s62, 589824
    v_cndmask_b32 v40, v44, v40, s[60:61]
    v_cndmask_b32 v41, v45, v41, s[60:61]
    v_cndmask_b32 v42, v46, v42, s[60:61]
    v_cndmask_b32 v43, v47, v43, s[60:61]
    v_and_or_b32 v40, v40, v246, v245
    v_and_or_b32 v41, v41, v246, v245
    v_and_or_b32 v42, v42, v246, v245
    v_and_or_b32 v43, v43, v246, v245
    buffer_store_dwordx4 v[40:43], v243, s[32:35], s62 offen sc1
    s_add_u32 s62, s62, 589824
    s_cmp_ge_u32 s3, 4
    s_cbranch_scc1 DUMP
    v_and_or_b32 v48, v48, v246, v245
    v_and_or_b32 v49, v49, v246, v245
    v_and_or_b32 v50, v50, v246, v245
    v_and_or_b32 v51, v51, v246, v245
    s_mov_b64 exec, s[60:61]
    buffer_store_dwordx4 v[48:51], v243, s[32:35], s62 offen sc1
DUMP:
END:
    s_endpgm
.p2align 7
.type TBL,@object
TBL:
.long 0x0, 0x0, 0x0, 0x0, 0x0, 0x0, 0x0, 0x0
.long 0x0, 0x0, 0x0, 0x0, 0x0, 0x0, 0x0, 0x0
.long 0x0, 0x0, 0x0, 0x0, 0x0, 0x0, 0x0, 0x0
.long 0x0, 0x0, 0x0, 0x0, 0x0, 0x0, 0x0, 0x0
.long 0x0, 0x0, 0x0, 0x0, 0x0, 0x0, 0x0, 0x0
.long 0x0, 0x0, 0x0, 0x0, 0x0, 0x0, 0x0, 0x0
.long 0x0, 0x0, 0x0, 0x0, 0x0, 0x0, 0x0, 0x0
.long 0x0, 0x0, 0x0, 0x0, 0x0, 0x0, 0x0, 0x0
.long 0x0, 0x3c000000, 0x3c003c00, 0x0, 0x0, 0x0, 0x3c003c00, 0x3c00
.long 0x0, 0x0, 0x3c000000, 0x3c003c00, 0x0, 0x0, 0x0, 0x3c003c00
.long 0x0, 0x0, 0x0, 0x3c000000, 0x0, 0x0, 0x0, 0x0
.long 0x0, 0x0, 0x0, 0x0, 0x0, 0x0, 0x0, 0x0
.long 0x0, 0x0, 0x0, 0x0, 0x0, 0x0, 0x0, 0x0
.long 0x0, 0x0, 0x0, 0x0, 0x0, 0x0, 0x0, 0x0
.long 0x0, 0x0, 0x0, 0x0, 0x0, 0x0, 0x0, 0x0
.long 0x0, 0x0, 0x0, 0x0, 0x0, 0x0, 0x0, 0x0
.long 0x0, 0x0, 0x0, 0x0, 0x0, 0x0, 0x0, 0x0
.long 0x0, 0x0, 0x0, 0x0, 0x3c00, 0x0, 0x0, 0x0
.long 0x3c003c00, 0x0, 0x0, 0x0, 0x3c003c00, 0x3c00, 0x0, 0x0
.long 0x3c000000, 0x3c003c00, 0x0, 0x0, 0x0, 0x3c003c00, 0x3c00, 0x0
.long 0x0, 0x3c000000, 0x3c003c00, 0x0, 0x0, 0x0, 0x3c003c00, 0x3c00
.long 0x0, 0x0, 0x3c000000, 0x3c003c00, 0x0, 0x0, 0x0, 0x3c003c00
.long 0x0, 0x0, 0x0, 0x3c000000, 0x0, 0x0, 0x0, 0x0
.long 0x0, 0x0, 0x0, 0x0, 0x0, 0x0, 0x0, 0x0
.long 0x0, 0x0, 0x0, 0x0, 0x0, 0x0, 0x0, 0x0
.long 0x0, 0x0, 0x0, 0x0, 0x0, 0x0, 0x0, 0x0
.long 0x0, 0x0, 0x0, 0x0, 0x0, 0x0, 0x0, 0x0
.long 0x0, 0x0, 0x0, 0x0, 0x0, 0x0, 0x0, 0x0
.long 0x0, 0x0, 0x0, 0x0, 0x0, 0x0, 0x0, 0x0
.long 0x0, 0x0, 0x0, 0x0, 0x3c00, 0x0, 0x0, 0x0
.long 0x3c003c00, 0x0, 0x0, 0x0, 0x3c003c00, 0x3c00, 0x0, 0x0
.long 0x3c000000, 0x3c003c00, 0x0, 0x0, 0x0, 0x3c003c00, 0x3c00, 0x0
.long 0x0, 0x0, 0x0, 0x3c003c00, 0x0, 0x0, 0x0, 0x3c000000
.long 0x0, 0x0, 0x0, 0x0, 0x0, 0x0, 0x0, 0x0
.long 0x0, 0x0, 0x0, 0x0, 0x0, 0x0, 0x0, 0x0
.long 0x0, 0x0, 0x0, 0x0, 0x0, 0x0, 0x0, 0x0
.long 0x0, 0x0, 0x0, 0x0, 0x0, 0x0, 0x0, 0x0
.long 0x0, 0x0, 0x0, 0x0, 0x0, 0x0, 0x0, 0x0
.long 0x0, 0x0, 0x0, 0x0, 0x0, 0x0, 0x0, 0x0
.long 0x0, 0x0, 0x0, 0x0, 0x0, 0x0, 0x0, 0x0
.long 0x3c003c00, 0x3c00, 0x0, 0x0, 0x3c003c00, 0x3c003c00, 0x0, 0x0
.long 0x3c003c00, 0x3c003c00, 0x3c00, 0x0, 0x3c000000, 0x3c003c00, 0x3c003c00, 0x0
.long 0x0, 0x3c003c00, 0x3c003c00, 0x3c00, 0x0, 0x3c000000, 0x3c003c00, 0x3c003c00
.long 0x0, 0x0, 0x3c003c00, 0x3c003c00, 0x0, 0x0, 0x3c000000, 0x3c003c00
.long 0x0, 0x0, 0x0, 0x3c003c00, 0x0, 0x0, 0x0, 0x3c000000
.long 0x0, 0x0, 0x0, 0x0, 0x0, 0x0, 0x0, 0x0
.long 0x0, 0x0, 0x0, 0x0, 0x0, 0x0, 0x0, 0x0
.long 0x0, 0x0, 0x0, 0x0, 0x0, 0x0, 0x0, 0x0
.long 0x0, 0x0, 0x0, 0x0, 0x0, 0x0, 0x0, 0x0
.long 0x0, 0x0, 0x0, 0x0, 0x0, 0x0, 0x0, 0x0
.long 0x0, 0x0, 0x0, 0x0, 0x0, 0x0, 0x0, 0x0
.long 0x3c00, 0x0, 0x0, 0x0, 0x3c003c00, 0x0, 0x0, 0x0
.long 0x3c003c00, 0x3c00, 0x0, 0x0, 0x3c003c00, 0x3c003c00, 0x0, 0x0
.long 0x3c003c00, 0x3c003c00, 0x3c00, 0x0, 0x3c000000, 0x3c003c00, 0x3c003c00, 0x0
.long 0x0, 0x3c003c00, 0x3c003c00, 0x3c00, 0x0, 0x3c000000, 0x3c003c00, 0x3c003c00
.long 0x0, 0x0, 0x3c003c00, 0x3c003c00, 0x0, 0x0, 0x3c000000, 0x3c003c00
.long 0x0, 0x0, 0x0, 0x0, 0x0, 0x0, 0x0, 0x0
.long 0x0, 0x0, 0x0, 0x0, 0x0, 0x0, 0x0, 0x0
.long 0x0, 0x0, 0x0, 0x0, 0x0, 0x0, 0x0, 0x0
.long 0x0, 0x0, 0x0, 0x0, 0x0, 0x0, 0x0, 0x0
.long 0x0, 0x0, 0x0, 0x0, 0x0, 0x0, 0x0, 0x0
.long 0x0, 0x0, 0x0, 0x0, 0x0, 0x0, 0x0, 0x0
.long 0x0, 0x0, 0x0, 0x0, 0x0, 0x0, 0x0, 0x0
.long 0x3c00, 0x0, 0x0, 0x0, 0x3c003c00, 0x0, 0x0, 0x0
.long 0x0, 0x3c000000, 0x3c003c00, 0x0, 0x0, 0x0, 0x3c003c00, 0x3c00
.long 0x0, 0x0, 0x3c000000, 0x3c003c00, 0x0, 0x0, 0x0, 0x3c003c00
.long 0x0, 0x0, 0x0, 0x3c000000, 0x0, 0x0, 0x0, 0x0
.long 0x0, 0x0, 0x0, 0x0, 0x0, 0x0, 0x0, 0x0
.long 0x0, 0x0, 0x0, 0x0, 0x0, 0x0, 0x0, 0x0
.long 0x0, 0x0, 0x0, 0x0, 0x0, 0x0, 0x0, 0x0
.long 0x0, 0x0, 0x0, 0x0, 0x0, 0x0, 0x0, 0x0
.long 0x0, 0x0, 0x0, 0x0, 0x0, 0x0, 0x0, 0x0
.long 0x0, 0x0, 0x0, 0x0, 0x0, 0x0, 0x0, 0x0
.long 0x0, 0x0, 0x0, 0x0, 0x3c00, 0x0, 0x0, 0x0
.long 0x3c003c00, 0x0, 0x0, 0x0, 0x3c003c00, 0x3c00, 0x0, 0x0
.long 0x3c000000, 0x3c003c00, 0x0, 0x0, 0x0, 0x3c003c00, 0x3c00, 0x0
.long 0x0, 0x3c000000, 0x3c003c00, 0x0, 0x0, 0x0, 0x3c003c00, 0x3c00
.long 0x0, 0x0, 0x3c000000, 0x3c003c00, 0x0, 0x0, 0x0, 0x3c003c00
.long 0x0, 0x0, 0x0, 0x3c000000, 0x0, 0x0, 0x0, 0x0
.long 0x0, 0x0, 0x0, 0x0, 0x0, 0x0, 0x0, 0x0
.long 0x0, 0x0, 0x0, 0x0, 0x0, 0x0, 0x0, 0x0
.long 0x0, 0x0, 0x0, 0x0, 0x0, 0x0, 0x0, 0x0
.long 0x0, 0x0, 0x0, 0x0, 0x0, 0x0, 0x0, 0x0
.long 0x0, 0x0, 0x0, 0x0, 0x0, 0x0, 0x0, 0x0
.long 0x0, 0x0, 0x0, 0x0, 0x0, 0x0, 0x0, 0x0
.long 0x0, 0x0, 0x0, 0x0, 0x3c00, 0x0, 0x0, 0x0
.long 0x3c003c00, 0x0, 0x0, 0x0, 0x3c003c00, 0x3c00, 0x0, 0x0
.long 0x3c000000, 0x3c003c00, 0x0, 0x0, 0x0, 0x3c003c00, 0x3c00, 0x0
.long 0x0, 0x0, 0x0, 0x0, 0x0, 0x0, 0x0, 0x0
.long 0x0, 0x0, 0x0, 0x0, 0x0, 0x0, 0x0, 0x0
.long 0x0, 0x0, 0x0, 0x0, 0x0, 0x0, 0x0, 0x0
.long 0x0, 0x0, 0x0, 0x0, 0x0, 0x0, 0x0, 0x0
.long 0x0, 0x0, 0x0, 0x0, 0x0, 0x0, 0x0, 0x0
.long 0x0, 0x0, 0x0, 0x0, 0x0, 0x0, 0x0, 0x0
.long 0x0, 0x0, 0x0, 0x0, 0x0, 0x0, 0x0, 0x0
.long 0x0, 0x0, 0x0, 0x0, 0x0, 0x0, 0x0, 0x0
.long 0x0, 0x0, 0x0, 0x3c003c00, 0x0, 0x0, 0x0, 0x3c000000
.long 0x0, 0x0, 0x0, 0x0, 0x0, 0x0, 0x0, 0x0
.long 0x0, 0x0, 0x0, 0x0, 0x0, 0x0, 0x0, 0x0
.long 0x0, 0x0, 0x0, 0x0, 0x0, 0x0, 0x0, 0x0
.long 0x0, 0x0, 0x0, 0x0, 0x0, 0x0, 0x0, 0x0
.long 0x0, 0x0, 0x0, 0x0, 0x0, 0x0, 0x0, 0x0
.long 0x0, 0x0, 0x0, 0x0, 0x0, 0x0, 0x0, 0x0
.long 0x0, 0x0, 0x0, 0x0, 0x0, 0x0, 0x0, 0x0
.long 0x3c003c00, 0x3c00, 0x0, 0x0, 0x3c003c00, 0x3c003c00, 0x0, 0x0
.long 0x3c003c00, 0x3c003c00, 0x3c00, 0x0, 0x3c000000, 0x3c003c00, 0x3c003c00, 0x0
.long 0x0, 0x3c003c00, 0x3c003c00, 0x3c00, 0x0, 0x3c000000, 0x3c003c00, 0x3c003c00
.long 0x0, 0x0, 0x3c003c00, 0x3c003c00, 0x0, 0x0, 0x3c000000, 0x3c003c00
.long 0x0, 0x0, 0x0, 0x3c003c00, 0x0, 0x0, 0x0, 0x3c000000
.long 0x0, 0x0, 0x0, 0x0, 0x0, 0x0, 0x0, 0x0
.long 0x0, 0x0, 0x0, 0x0, 0x0, 0x0, 0x0, 0x0
.long 0x0, 0x0, 0x0, 0x0, 0x0, 0x0, 0x0, 0x0
.long 0x0, 0x0, 0x0, 0x0, 0x0, 0x0, 0x0, 0x0
.long 0x0, 0x0, 0x0, 0x0, 0x0, 0x0, 0x0, 0x0
.long 0x0, 0x0, 0x0, 0x0, 0x0, 0x0, 0x0, 0x0
.long 0x3c00, 0x0, 0x0, 0x0, 0x3c003c00, 0x0, 0x0, 0x0
.long 0x3c003c00, 0x3c00, 0x0, 0x0, 0x3c003c00, 0x3c003c00, 0x0, 0x0
.long 0x3c003c00, 0x3c003c00, 0x3c00, 0x0, 0x3c000000, 0x3c003c00, 0x3c003c00, 0x0
.long 0x0, 0x3c003c00, 0x3c003c00, 0x3c00, 0x0, 0x3c000000, 0x3c003c00, 0x3c003c00
.long 0x0, 0x0, 0x3c003c00, 0x3c003c00, 0x0, 0x0, 0x3c000000, 0x3c003c00
.long 0x0, 0x0, 0x0, 0x0, 0x0, 0x0, 0x0, 0x0
.long 0x0, 0x0, 0x0, 0x0, 0x0, 0x0, 0x0, 0x0
.long 0x0, 0x0, 0x0, 0x0, 0x0, 0x0, 0x0, 0x0
.long 0x0, 0x0, 0x0, 0x0, 0x0, 0x0, 0x0, 0x0
.long 0x0, 0x0, 0x0, 0x0, 0x0, 0x0, 0x0, 0x0
.long 0x0, 0x0, 0x0, 0x0, 0x0, 0x0, 0x0, 0x0
.long 0x0, 0x0, 0x0, 0x0, 0x0, 0x0, 0x0, 0x0
.long 0x3c00, 0x0, 0x0, 0x0, 0x3c003c00, 0x0, 0x0, 0x0
.long 0x0, 0x0, 0x3c000000, 0x3c003c00, 0x0, 0x0, 0x0, 0x3c003c00
.long 0x0, 0x0, 0x0, 0x3c000000, 0x0, 0x0, 0x0, 0x0
.long 0x0, 0x0, 0x0, 0x0, 0x0, 0x0, 0x0, 0x0
.long 0x0, 0x0, 0x0, 0x0, 0x0, 0x0, 0x0, 0x0
.long 0x0, 0x0, 0x0, 0x0, 0x0, 0x0, 0x0, 0x0
.long 0x0, 0x0, 0x0, 0x0, 0x0, 0x0, 0x0, 0x0
.long 0x0, 0x0, 0x0, 0x0, 0x0, 0x0, 0x0, 0x0
.long 0x0, 0x0, 0x0, 0x0, 0x0, 0x0, 0x0, 0x0
.long 0x3c003c00, 0x3c003c00, 0x0, 0x0, 0x3c003c00, 0x3c003c00, 0x3c00, 0x0
.long 0x3c003c00, 0x3c003c00, 0x3c003c00, 0x0, 0x3c003c00, 0x3c003c00, 0x3c003c00, 0x3c00
.long 0x3c000000, 0x3c003c00, 0x3c003c00, 0x3c003c00, 0x0, 0x3c003c00, 0x3c003c00, 0x3c003c00
.long 0x0, 0x3c000000, 0x3c003c00, 0x3c003c00, 0x0, 0x0, 0x3c003c00, 0x3c003c00
.long 0x0, 0x0, 0x3c000000, 0x3c003c00, 0x0, 0x0, 0x0, 0x3c003c00
.long 0x0, 0x0, 0x0, 0x3c000000, 0x0, 0x0, 0x0, 0x0
.long 0x0, 0x0, 0x0, 0x0, 0x0, 0x0, 0x0, 0x0
.long 0x0, 0x0, 0x0, 0x0, 0x0, 0x0, 0x0, 0x0
.long 0x0, 0x0, 0x0, 0x0, 0x0, 0x0, 0x0, 0x0
.long 0x0, 0x0, 0x0, 0x0, 0x0, 0x0, 0x0, 0x0
.long 0x0, 0x0, 0x0, 0x0, 0x3c00, 0x0, 0x0, 0x0
.long 0x3c003c00, 0x0, 0x0, 0x0, 0x3c003c00, 0x3c00, 0x0, 0x0
.long 0x3c003c00, 0x3c003c00, 0x0, 0x0, 0x3c003c00, 0x3c003c00, 0x3c00, 0x0
.long 0x3c003c00, 0x3c003c00, 0x3c003c00, 0x0, 0x3c003c00, 0x3c003c00, 0x3c003c00, 0x3c00
.long 0x3c000000, 0x3c003c00, 0x3c003c00, 0x3c003c00, 0x0, 0x3c003c00, 0x3c003c00, 0x3c003c00
.long 0x0, 0x3c000000, 0x3c003c00, 0x3c003c00, 0x0, 0x0, 0x3c003c00, 0x3c003c00
.long 0x0, 0x0, 0x0, 0x0, 0x0, 0x0, 0x0, 0x0
.long 0x0, 0x0, 0x0, 0x0, 0x0, 0x0, 0x0, 0x0
.long 0x0, 0x0, 0x0, 0x0, 0x0, 0x0, 0x0, 0x0
.long 0x0, 0x0, 0x0, 0x0, 0x0, 0x0, 0x0, 0x0
.long 0x0, 0x0, 0x0, 0x0, 0x0, 0x0, 0x0, 0x0
.long 0x0, 0x0, 0x0, 0x0, 0x0, 0x0, 0x0, 0x0
.long 0x0, 0x0, 0x0, 0x0, 0x3c00, 0x0, 0x0, 0x0
.long 0x3c003c00, 0x0, 0x0, 0x0, 0x3c003c00, 0x3c00, 0x0, 0x0
.long 0x0, 0x0, 0x3c003c00, 0x3c003c00, 0x0, 0x0, 0x3c000000, 0x3c003c00
.long 0x0, 0x0, 0x0, 0x3c003c00, 0x0, 0x0, 0x0, 0x3c000000
.long 0x0, 0x0, 0x0, 0x0, 0x0, 0x0, 0x0, 0x0
.long 0x0, 0x0, 0x0, 0x0, 0x0, 0x0, 0x0, 0x0
.long 0x0, 0x0, 0x0, 0x0, 0x0, 0x0, 0x0, 0x0
.long 0x0, 0x0, 0x0, 0x0, 0x0, 0x0, 0x0, 0x0
.long 0x0, 0x0, 0x0, 0x0, 0x0, 0x0, 0x0, 0x0
.long 0x0, 0x0, 0x0, 0x0, 0x0, 0x0, 0x0, 0x0
.long 0x3c003c00, 0x3c003c00, 0x3c00, 0x0, 0x3c003c00, 0x3c003c00, 0x3c003c00, 0x0
.long 0x3c003c00, 0x3c003c00, 0x3c003c00, 0x3c00, 0x3c003c00, 0x3c003c00, 0x3c003c00, 0x3c003c00
.long 0x3c003c00, 0x3c003c00, 0x3c003c00, 0x3c003c00, 0x3c000000, 0x3c003c00, 0x3c003c00, 0x3c003c00
.long 0x0, 0x3c003c00, 0x3c003c00, 0x3c003c00, 0x0, 0x3c000000, 0x3c003c00, 0x3c003c00
.long 0x0, 0x0, 0x3c003c00, 0x3c003c00, 0x0, 0x0, 0x3c000000, 0x3c003c00
.long 0x0, 0x0, 0x0, 0x3c003c00, 0x0, 0x0, 0x0, 0x3c000000
.long 0x0, 0x0, 0x0, 0x0, 0x0, 0x0, 0x0, 0x0
.long 0x0, 0x0, 0x0, 0x0, 0x0, 0x0, 0x0, 0x0
.long 0x0, 0x0, 0x0, 0x0, 0x0, 0x0, 0x0, 0x0
.long 0x0, 0x0, 0x0, 0x0, 0x0, 0x0, 0x0, 0x0
.long 0x3c00, 0x0, 0x0, 0x0, 0x3c003c00, 0x0, 0x0, 0x0
.long 0x3c003c00, 0x3c00, 0x0, 0x0, 0x3c003c00, 0x3c003c00, 0x0, 0x0
.long 0x3c003c00, 0x3c003c00, 0x3c00, 0x0, 0x3c003c00, 0x3c003c00, 0x3c003c00, 0x0
.long 0x3c003c00, 0x3c003c00, 0x3c003c00, 0x3c00, 0x3c003c00, 0x3c003c00, 0x3c003c00, 0x3c003c00
.long 0x3c003c00, 0x3c003c00, 0x3c003c00, 0x3c003c00, 0x3c000000, 0x3c003c00, 0x3c003c00, 0x3c003c00
.long 0x0, 0x3c003c00, 0x3c003c00, 0x3c003c00, 0x0, 0x3c000000, 0x3c003c00, 0x3c003c00
.long 0x0, 0x0, 0x0, 0x0, 0x0, 0x0, 0x0, 0x0
.long 0x0, 0x0, 0x0, 0x0, 0x0, 0x0, 0x0, 0x0
.long 0x0, 0x0, 0x0, 0x0, 0x0, 0x0, 0x0, 0x0
.long 0x0, 0x0, 0x0, 0x0, 0x0, 0x0, 0x0, 0x0
.long 0x0, 0x0, 0x0, 0x0, 0x0, 0x0, 0x0, 0x0
.long 0x0, 0x0, 0x0, 0x0, 0x0, 0x0, 0x0, 0x0
.long 0x3c00, 0x0, 0x0, 0x0, 0x3c003c00, 0x0, 0x0, 0x0
.long 0x3c003c00, 0x3c00, 0x0, 0x0, 0x3c003c00, 0x3c003c00, 0x0, 0x0
.long 0x0, 0x0, 0x0, 0x0, 0x0, 0x0, 0x0, 0x0
.long 0x0, 0x0, 0x0, 0x0, 0x0, 0x0, 0x0, 0x0
.long 0x0, 0x0, 0x0, 0x0, 0x0, 0x0, 0x0, 0x0
.long 0x0, 0x0, 0x0, 0x0, 0x0, 0x0, 0x0, 0x0
.long 0x0, 0x0, 0x0, 0x0, 0x0, 0x0, 0x0, 0x0
.long 0x0, 0x0, 0x0, 0x0, 0x0, 0x0, 0x0, 0x0
.long 0x0, 0x0, 0x0, 0x0, 0x0, 0x0, 0x0, 0x0
.long 0x0, 0x0, 0x0, 0x0, 0x0, 0x0, 0x0, 0x0
.long 0x0, 0x0, 0xffffffff, 0x0, 0x0, 0x0, 0xffff0000, 0xffff
.long 0x0, 0x0, 0x0, 0xffffffff, 0x0, 0x0, 0x0, 0xffff0000
.long 0x0, 0x0, 0x0, 0x0, 0x0, 0x0, 0x0, 0x0
.long 0x0, 0x0, 0x0, 0x0, 0x0, 0x0, 0x0, 0x0
.long 0x0, 0x0, 0x0, 0x0, 0x0, 0x0, 0x0, 0x0
.long 0x0, 0x0, 0x0, 0x0, 0x0, 0x0, 0x0, 0x0
.long 0x0, 0x0, 0x0, 0x0, 0x0, 0x0, 0x0, 0x0
.long 0x0, 0x0, 0x0, 0x0, 0x0, 0x0, 0x0, 0x0
.long 0x0, 0x0, 0x0, 0x0, 0x0, 0x0, 0x0, 0x0
.long 0x0, 0x0, 0x0, 0x0, 0xffff, 0x0, 0x0, 0x0
.long 0xffffffff, 0x0, 0x0, 0x0, 0xffff0000, 0xffff, 0x0, 0x0
.long 0x0, 0xffffffff, 0x0, 0x0, 0x0, 0xffff0000, 0xffff, 0x0
.long 0x0, 0x0, 0xffffffff, 0x0, 0x0, 0x0, 0xffff0000, 0xffff
.long 0x0, 0x0, 0x0, 0xffffffff, 0x0, 0x0, 0x0, 0xffff0000
.long 0x0, 0x0, 0x0, 0x0, 0x0, 0x0, 0x0, 0x0
.long 0x0, 0x0, 0x0, 0x0, 0x0, 0x0, 0x0, 0x0
.long 0x0, 0x0, 0x0, 0x0, 0x0, 0x0, 0x0, 0x0
.long 0x0, 0x0, 0x0, 0x0, 0x0, 0x0, 0x0, 0x0
.long 0x0, 0x0, 0x0, 0x0, 0x0, 0x0, 0x0, 0x0
.long 0x0, 0x0, 0x0, 0x0, 0x0, 0x0, 0x0, 0x0
.long 0x0, 0x0, 0x0, 0x0, 0x0, 0x0, 0x0, 0x0
.long 0x0, 0x0, 0x0, 0x0, 0xffff, 0x0, 0x0, 0x0
.long 0xffffffff, 0x0, 0x0, 0x0, 0xffff0000, 0xffff, 0x0, 0x0
.long 0x0, 0xffffffff, 0x0, 0x0, 0x0, 0xffff0000, 0xffff, 0x0
.long 0x878, 0x438, 0x230, 0x238, 0x858, 0x418, 0x210, 0x218
.long 0x838, 0x3f8, 0x1f0, 0x1f8, 0x818, 0x3d8, 0x1d0, 0x1d8
.long 0x7f8, 0x3b8, 0x1b0, 0x1b8, 0x7d8, 0x398, 0x190, 0x198
.long 0x7b8, 0x378, 0x170, 0x178, 0x798, 0x358, 0x150, 0x158
.long 0x778, 0x338, 0x130, 0x138, 0x758, 0x318, 0x110, 0x118
.long 0x738, 0x2f8, 0xf0, 0xf8, 0x718, 0x2d8, 0xd0, 0xd8
.long 0x6f8, 0x2b8, 0xb0, 0xb8, 0x6d8, 0x298, 0x90, 0x98
.long 0x6b8, 0x278, 0x70, 0x78, 0x698, 0x258, 0x50, 0x58
.long 0x868, 0x428, 0x220, 0x228, 0x848, 0x408, 0x200, 0x208
.long 0x828, 0x3e8, 0x1e0, 0x1e8, 0x808, 0x3c8, 0x1c0, 0x1c8
.long 0x7e8, 0x3a8, 0x1a0, 0x1a8, 0x7c8, 0x388, 0x180, 0x188
.long 0x7a8, 0x368, 0x160, 0x168, 0x788, 0x348, 0x140, 0x148
.long 0x768, 0x328, 0x120, 0x128, 0x748, 0x308, 0x100, 0x108
.long 0x728, 0x2e8, 0xe0, 0xe8, 0x708, 0x2c8, 0xc0, 0xc8
.long 0x6e8, 0x2a8, 0xa0, 0xa8, 0x6c8, 0x288, 0x80, 0x88
.long 0x6a8, 0x268, 0x60, 0x68, 0x688, 0x248, 0x40, 0x48
.long 0x870, 0x430, 0x90c, 0x94c, 0x850, 0x410, 0x908, 0x948
.long 0x830, 0x3f0, 0x904, 0x944, 0x810, 0x3d0, 0x900, 0x940
.long 0x7f0, 0x3b0, 0x8fc, 0x93c, 0x7d0, 0x390, 0x8f8, 0x938
.long 0x7b0, 0x370, 0x8f4, 0x934, 0x790, 0x350, 0x8f0, 0x930
.long 0x770, 0x330, 0x8ec, 0x92c, 0x750, 0x310, 0x8e8, 0x928
.long 0x730, 0x2f0, 0x8e4, 0x924, 0x710, 0x2d0, 0x8e0, 0x920
.long 0x6f0, 0x2b0, 0x8dc, 0x91c, 0x6d0, 0x290, 0x8d8, 0x918
.long 0x6b0, 0x270, 0x8d4, 0x914, 0x690, 0x250, 0x8d0, 0x910
.long 0x860, 0x420, 0x9cc, 0xa0c, 0x840, 0x400, 0x9c8, 0xa08
.long 0x820, 0x3e0, 0x9c4, 0xa04, 0x800, 0x3c0, 0x9c0, 0xa00
.long 0x7e0, 0x3a0, 0x9bc, 0x9fc, 0x7c0, 0x380, 0x9b8, 0x9f8
.long 0x7a0, 0x360, 0x9b4, 0x9f4, 0x780, 0x340, 0x9b0, 0x9f0
.long 0x760, 0x320, 0x9ac, 0x9ec, 0x740, 0x300, 0x9a8, 0x9e8
.long 0x720, 0x2e0, 0x9a4, 0x9e4, 0x700, 0x2c0, 0x9a0, 0x9e0
.long 0x6e0, 0x2a0, 0x99c, 0x9dc, 0x6c0, 0x280, 0x998, 0x9d8
.long 0x6a0, 0x260, 0x994, 0x9d4, 0x680, 0x240, 0x990, 0x9d0
.long 0x22c, 0x670, 0xb90, 0x23e, 0x20c, 0x650, 0xb90, 0xb90
.long 0x1ec, 0x630, 0xb90, 0xb90, 0x1cc, 0x610, 0xb90, 0xb90
.long 0x1ac, 0x5f0, 0xb90, 0xb90, 0x18c, 0x5d0, 0xb90, 0xb90
.long 0x16c, 0x5b0, 0xb90, 0xb90, 0x14c, 0x590, 0xb90, 0xb90
.long 0x12c, 0x570, 0xb90, 0xb90, 0x10c, 0x550, 0xb90, 0xb90
.long 0xec, 0x530, 0xb90, 0xb90, 0xcc, 0x510, 0xb90, 0xb90
.long 0xac, 0x4f0, 0xb90, 0xb90, 0x8c, 0x4d0, 0xb90, 0xb90
.long 0x6c, 0x4b0, 0xb90, 0xb90, 0x4c, 0x490, 0xb90, 0xb90
.long 0x21c, 0x660, 0xb90, 0xb90, 0x1fc, 0x640, 0xb90, 0xb90
.long 0x1dc, 0x620, 0xb90, 0xb90, 0x1bc, 0x600, 0xb90, 0xb90
.long 0x19c, 0x5e0, 0xb90, 0xb90, 0x17c, 0x5c0, 0xb90, 0xb90
.long 0x15c, 0x5a0, 0xb90, 0xb90, 0x13c, 0x580, 0xb90, 0xb90
.long 0x11c, 0x560, 0xb90, 0xb90, 0xfc, 0x540, 0xb90, 0xb90
.long 0xdc, 0x520, 0xb90, 0xb90, 0xbc, 0x500, 0xb90, 0xb90
.long 0x9c, 0x4e0, 0xb90, 0xb90, 0x7c, 0x4c0, 0xb90, 0xb90
.long 0x5c, 0x4a0, 0xb90, 0xb90, 0x3c, 0x480, 0x47c, 0xb90
.long 0xb90, 0xb90, 0xb90, 0xb4c, 0xb90, 0xb90, 0xb90, 0xb48
.long 0xb90, 0xb90, 0xb90, 0xb44, 0xb90, 0xb90, 0xb90, 0xb40
.long 0xb90, 0xb90, 0xb90, 0xb3c, 0xb90, 0xb90, 0xb90, 0xb38
.long 0xb90, 0xb90, 0xb90, 0xb34, 0xb90, 0xb90, 0xb90, 0xb30
.long 0xb90, 0xb90, 0xb90, 0xb2c, 0xb90, 0xb90, 0xb90, 0xb28
.long 0xb90, 0xb90, 0xb90, 0xb24, 0xb90, 0xb90, 0xb90, 0xb20
.long 0xb90, 0xb90, 0xb90, 0xb1c, 0xb90, 0xb90, 0xb90, 0xb18
.long 0xb90, 0xb90, 0xb90, 0xb14, 0xb90, 0xb90, 0xb90, 0xb10
.long 0xb90, 0xb90, 0xb90, 0xb4e, 0xb90, 0xb90, 0xb90, 0xb4a
.long 0xb90, 0xb90, 0xb90, 0xb46, 0xb90, 0xb90, 0xb90, 0xb42
.long 0xb90, 0xb90, 0xb90, 0xb3e, 0xb90, 0xb90, 0xb90, 0xb3a
.long 0xb90, 0xb90, 0xb90, 0xb36, 0xb90, 0xb90, 0xb90, 0xb32
.long 0xb90, 0xb90, 0xb90, 0xb2e, 0xb90, 0xb90, 0xb90, 0xb2a
.long 0xb90, 0xb90, 0xb90, 0xb26, 0xb90, 0xb90, 0xb90, 0xb22
.long 0xb90, 0xb90, 0xb90, 0xb1e, 0xb90, 0xb90, 0xb90, 0xb1a
.long 0xb90, 0xb90, 0xb90, 0xb16, 0xb90, 0xb90, 0xb90, 0xb12
.long 0x23c, 0x880, 0xb90, 0x4200, 0xb90, 0xb90, 0xb90, 0x4c50
.long 0xb90, 0xb90, 0xb90, 0x4410, 0xb90, 0xb90, 0xb90, 0x5070
.long 0xb90, 0xb90, 0xb90, 0x5280, 0xb90, 0xb90, 0xb90, 0x4620
.long 0xb90, 0xb90, 0xb90, 0x5490, 0xb90, 0xb90, 0xb90, 0x4830
.long 0xb90, 0xb90, 0xb90, 0x6510, 0xb90, 0xb90, 0xb90, 0x6d50
.long 0xb90, 0xb90, 0xb90, 0x56a0, 0xb90, 0xb90, 0xb90, 0x4a40
.long 0xb90, 0xb90, 0xb90, 0x6720, 0xb90, 0xb90, 0xb90, 0x6b40
.long 0xb90, 0xb90, 0xb90, 0x6930, 0xb90, 0xb90, 0xb90, 0x58b0
.long 0xb90, 0xb90, 0xb90, 0x6300, 0xb90, 0xb90, 0xb90, 0x6300
.long 0xb90, 0xb90, 0xb90, 0x4e60, 0xb90, 0xb90, 0xb90, 0x4a40
.long 0xb90, 0xb90, 0xb90, 0x5ac0, 0xb90, 0xb90, 0xb90, 0x5cd0
.long 0xb90, 0xb90, 0xb90, 0x5ee0, 0xb90, 0xb90, 0xb90, 0x60f0
.long 0xb90, 0xb90, 0xb90, 0x4e60, 0xb90, 0xb90, 0xb90, 0x4200
.long 0xb90, 0xb90, 0xb90, 0x4c50, 0xb90, 0xb90, 0xb90, 0x4410
.long 0xb90, 0xb90, 0xb90, 0x5070, 0xb90, 0xb90, 0xb90, 0x5280
.long 0xb90, 0xb90, 0xb90, 0x4620, 0xb90, 0xb90, 0x3a, 0x5490
.long 0xb0c, 0xacc, 0xa8c, 0x4210, 0xb08, 0xac8, 0xa88, 0x4c60
.long 0xb04, 0xac4, 0xa84, 0x4420, 0xb00, 0xac0, 0xa80, 0x5080
.long 0xafc, 0xabc, 0xa7c, 0x5290, 0xaf8, 0xab8, 0xa78, 0x4630
.long 0xaf4, 0xab4, 0xa74, 0x54a0, 0xaf0, 0xab0, 0xa70, 0x4840
.long 0xaec, 0xaac, 0xa6c, 0x6520, 0xae8, 0xaa8, 0xa68, 0x6d60
.long 0xae4, 0xaa4, 0xa64, 0x56b0, 0xae0, 0xaa0, 0xa60, 0x4a50
.long 0xadc, 0xa9c, 0xa5c, 0x6730, 0xad8, 0xa98, 0xa58, 0x6b50
.long 0xad4, 0xa94, 0xa54, 0x6940, 0xad0, 0xa90, 0xa50, 0x58c0
.long 0xb0e, 0xace, 0xa8e, 0x6310, 0xb0a, 0xaca, 0xa8a, 0x6310
.long 0xb06, 0xac6, 0xa86, 0x4e70, 0xb02, 0xac2, 0xa82, 0x4a50
.long 0xafe, 0xabe, 0xa7e, 0x5ad0, 0xafa, 0xaba, 0xa7a, 0x5ce0
.long 0xaf6, 0xab6, 0xa76, 0x5ef0, 0xaf2, 0xab2, 0xa72, 0x6100
.long 0xaee, 0xaae, 0xa6e, 0x4e70, 0xaea, 0xaaa, 0xa6a, 0x4210
.long 0xae6, 0xaa6, 0xa66, 0x4c60, 0xae2, 0xaa2, 0xa62, 0x4420
.long 0xade, 0xa9e, 0xa5e, 0x5080, 0xada, 0xa9a, 0xa5a, 0x5290
.long 0xad6, 0xa96, 0xa56, 0x4630, 0xad2, 0xa92, 0xa52, 0x54a0
TBLEND:
.size TBL, .-TBL
.section .rodata,"a"
.p2align 6
.amdhsa_kernel sequential_preLN__ssm_conv_s4d__moe_arch_mod__prompt_kernel
  .amdhsa_next_free_vgpr 256
  .amdhsa_next_free_sgpr 102
  .amdhsa_accum_offset 256
  .amdhsa_group_segment_fixed_size 0
  .amdhsa_kernarg_size 120
  .amdhsa_user_sgpr_count 2
  .amdhsa_user_sgpr_kernarg_segment_ptr 1
  .amdhsa_system_sgpr_workgroup_id_x 1
.end_amdhsa_kernel
```

```asm
; @launch grid=(248,1,1) block=(512,1,1) lds=163840
.amdgcn_target "amdgcn-amd-amdhsa--gfx950"
.text
.globl sequential_preLN__ssm_conv_s4d__moe_arch_mod__prompt_kernel
.p2align 8
.type sequential_preLN__ssm_conv_s4d__moe_arch_mod__prompt_kernel,@function
sequential_preLN__ssm_conv_s4d__moe_arch_mod__prompt_kernel:
    s_cmp_ge_u32 s2, 248
    s_cbranch_scc1 END
    s_load_dwordx16 s[4:19], s[0:1], 0
    s_load_dwordx8 s[20:27], s[0:1], 64
    s_load_dwordx2 s[28:29], s[0:1], 96
    s_load_dwordx2 s[30:31], s[0:1], 112
    s_getpc_b64 s[42:43]
PC0:
    v_and_b32 v1, 63, v0
    v_lshrrev_b32 v14, 6, v0
    v_lshlrev_b32 v15, 7, v0
    v_readfirstlane_b32 s3, v14
    s_add_u32 s44, s42, TBL-PC0
    s_addc_u32 s45, s43, 0
    v_lshlrev_b32 v2, 4, v1
    v_lshlrev_b32 v3, 4, v0
    s_sub_u32 s50, s2, 192
    s_cmp_lt_u32 s50, 24
    s_cbranch_scc1 FROLE
    s_and_b32 s51, s3, 3
    s_lshr_b32 s46, s3, 2
    s_sub_u32 s49, s2, 120
    s_cmp_lt_u32 s2, 216
    s_cselect_b32 s49, 255, s49
    s_cmp_lt_u32 s2, 96
    s_cselect_b32 s49, s2, s49
    s_sub_u32 s38, s2, 96
    s_cmp_lt_u32 s49, 128
    s_cselect_b32 s38, s49, s38
    s_cselect_b32 s39, s46, 1
    s_lshl_b32 s48, s38, 1
    s_add_u32 s48, s48, s39
    s_lshl_b32 s48, s48, 3
    s_add_u32 s48, s48, s51
    s_mul_i32 s50, s48, 1152
    v_and_b32 v13, 31, v1
    v_lshrrev_b32 v15, 5, v1
    v_mul_u32_u24 v14, 4608, v15
    v_add_u32 v14, s50, v14
    v_lshlrev_b32 v12, 4, v13
    v_lshlrev_b32 v13, 2, v13
    v_add_u32 v4, v12, v14
    v_add_u32 v5, v13, v14
    s_cmp_ge_u32 s2, 216
    s_cselect_b32 s61, 0, s46
    s_lshl_b32 s52, s2, 2
    s_add_u32 s52, s52, s51
    s_lshl_b32 s53, s52, 8
    s_lshl_b32 s54, s46, 7
    s_add_u32 s53, s53, s54
    v_lshl_add_u32 v34, v1, 1, s53
    v_xor_b32 v35, 128, v34
    v_mov_b32 v28, 0
    v_mov_b32 v29, 0
    v_mov_b32 v30, 0
    v_mov_b32 v31, 0
    v_mov_b32 v32, 0
    v_mov_b32 v33, 0
    s_lshl_b32 s54, s2, 3
    s_cmp_lg_u32 s61, 0
    s_waitcnt lgkmcnt(0)
    s_cbranch_scc1 C_NOX
    global_load_dwordx4 v[16:19], v4, s[4:5] nt
    global_load_dwordx4 v[20:23], v4, s[4:5] offset:512 nt
    global_load_dword v24, v5, s[4:5] offset:1024 nt
C_NOX:
    s_load_dword s40, s[30:31], 0
    s_cmp_ge_u32 s2, 144
    s_cbranch_scc1 C_NOP
    s_load_dwordx2 s[56:57], s[14:15], s54
    global_load_short_d16_hi v28, v34, s[6:7] nt
    global_load_short_d16_hi v29, v34, s[8:9] nt
    global_load_short_d16_hi v30, v34, s[10:11] nt
    global_load_short_d16_hi v31, v34, s[12:13] nt
    global_load_short_d16_hi v32, v35, s[10:11] nt
    global_load_short_d16_hi v33, v35, s[12:13] nt
C_NOP:
    s_mov_b32 s32, s30
    s_and_b32 s33, s31, 0xffff
    s_mov_b32 s34, 0x10000000
    s_mov_b32 s35, 0x00020000
    v_mov_b32 v6, 0x3f80
    v_mov_b32 v7, 1.0
    v_mov_b32 v8, 0x3f803f80
    v_mov_b32 v9, 0xfff8fff8
    v_mov_b32 v11, 0x40004
    v_mul_u32_u24 v15, 4736, v15
    s_and_b32 s46, s3, 4
    s_add_u32 s46, s46, s3
    s_mul_i32 s46, s46, 1184
    s_add_u32 s46, s46, 132608
    v_add_u32 v15, s46, v15
    v_add_u32 v25, v12, v15
    v_add_u32 v26, v13, v15
    s_lshr_b32 s46, s3, 2
    s_lshl_b32 s46, s46, 8
    s_mul_i32 s60, s51, 28512
    s_add_u32 s46, s60, s46
    v_lshl_add_u32 v40, v1, 2, s46
    v_add_u32 v41, 528, v40
    v_add_u32 v42, 1056, v40
    v_add_u32 v43, 1584, v40
    v_add_u32 v44, 2112, v40
    v_add_u32 v45, 2640, v40
    v_add_u32 v46, 3168, v40
    v_add_u32 v47, 3696, v40
    v_add_u32 v48, 4224, v40
    v_add_u32 v49, 4752, v40
    v_add_u32 v50, 5280, v40
    v_add_u32 v51, 5808, v40
    v_add_u32 v52, 6336, v40
    v_add_u32 v53, 6864, v40
    v_add_u32 v54, 7392, v40
    v_add_u32 v55, 7920, v40
    s_mul_i32 s62, s51, 2976
    s_add_u32 s62, s62, 151552
    s_cmp_ge_u32 s2, 144
    s_cbranch_scc1 C_O1
    s_cmp_lg_u32 s61, 0
    s_cbranch_scc1 C_O1
    v_and_b32 v14, 31, v1
    v_mul_u32_u24 v14, 528, v14
    v_lshrrev_b32 v15, 5, v1
    v_lshl_add_u32 v14, v15, 4, v14
    v_add_u32 v253, s60, v14
    v_add_u32 v27, 7168, v2
    v_mov_b32 v37, 0
    global_load_dwordx4 v[184:187], v27, s[44:45] offset:0
    global_load_dwordx4 v[188:191], v27, s[44:45] offset:1024
    global_load_dwordx4 v[192:195], v27, s[44:45] offset:2048
    global_load_dwordx4 v[208:211], v12, s[16:17]
    global_load_dwordx4 v[212:215], v12, s[16:17] offset:512
    global_load_dword v216, v13, s[16:17] offset:1024
    global_load_dwordx4 v[218:221], v12, s[20:21]
    global_load_dwordx4 v[222:225], v12, s[20:21] offset:512
    global_load_dword v226, v13, s[20:21] offset:1024
    s_waitcnt vmcnt(15)
    s_branch C_LN1
C_O1:
    v_bfe_u32 v15, v1, 2, 2
    v_mul_u32_u24 v14, 1184, v15
    v_lshrrev_b32 v15, 4, v1
    v_lshl_add_u32 v14, v15, 5, v14
    v_and_b32 v15, 3, v1
    v_lshl_add_u32 v14, v15, 3, v14
    s_cmp_ge_u32 s2, 216
    s_cselect_b32 s46, s39, 0
    s_mul_i32 s53, s46, 9472
    s_lshl_b32 s55, s51, 7
    s_add_u32 s53, s53, s55
    s_add_u32 s53, s53, 132608
    v_add_u32 v36, s53, v14
    v_lshrrev_b32 v14, 2, v1
    v_lshlrev_b32 v15, 4, v15
    v_lshl_add_u32 v37, v14, 14, v15
    s_cmp_lt_u32 s2, 96
    s_cselect_b32 s46, 0, s39
    s_lshl_b32 s46, s46, 6
    s_lshl_b32 s55, s38, 7
    s_add_u32 s55, s55, s46
    s_lshl_b32 s46, s51, 18
    s_add_u32 s55, s55, s46
    s_add_u32 s55, s55, 1048576
    s_add_u32 s36, s55, 1048576
    s_add_u32 s37, s55, 2097152
    v_mov_b32 v120, 0
    v_mov_b32 v121, 0
    v_mov_b32 v122, 0
    v_mov_b32 v123, 0
    s_lshl_b32 s46, s51, 10
    s_add_u32 s46, s46, 151296
    v_add_u32 v14, s46, v2
    v_max_u32 v15, 151552, v14
    ds_write_b128 v15, v[120:123]
    ds_write_b128 v14, v[120:123] offset:4096
    ds_write_b128 v14, v[120:123] offset:8192
    s_mul_i32 s46, s51, 4640
    s_add_u32 s46, s46, 114048
    v_add_u32 v14, s46, v12
    ds_write_b128 v14, v[120:123]
    s_waitcnt lgkmcnt(0)
    s_add_u32 s40, s40, 1
    s_and_b32 s41, s40, 7
    s_bfe_u32 s46, s40, 0x30003
    s_lshl_b32 s46, s46, 16
    s_or_b32 s41, s41, s46
    v_mov_b32 v10, s41
    s_cmp_eq_u32 s61, 0
    s_cbranch_scc1 C_O2
    s_cmp_ge_u32 s2, 144
    s_cbranch_scc1 C_BA
    s_waitcnt vmcnt(0)
    s_bitcmp1_b32 s51, 1
    s_cselect_b32 s56, s57, s56
    s_lshl_b32 s57, s56, 16
    s_and_b32 s56, s56, 0xffff0000
    s_bitcmp1_b32 s51, 0
    s_cselect_b32 s56, s56, s57
    v_mov_b32 v60, 0x3fb8aa3b
    v_mul_f32 v62, 0x3fb8aa3b, v28
    v_mul_f32 v60, s56, v60
    v_exp_f32 v62, v62
    v_exp_f32 v60, v60
    v_add_f32 v64, |v30|, |v31|
    v_add_f32 v65, |v32|, |v33|
    v_cvt_pk_bf16_f32 v62, 0, v62
    v_cvt_pk_bf16_f32 v60, 0, v60
    v_add_f32 v64, v64, v65
    v_mul_f32 v62, v62, v60
    v_mul_f32 v63, v29, v60
    v_mul_f32 v62, 0xbfb8aa3b, v62
    v_mul_f32 v63, 0.15915494, v63
    v_mul_f32 v104, 0x41000000, v62
    v_add_f32_dpp v64, v64, v64 row_ror:8 row_mask:0xf bank_mask:0xf
    v_mul_f32 v105, 0x41000000, v63
    v_exp_f32 v104, v104
    v_fract_f32 v105, v105
    v_add_f32_dpp v64, v64, v64 row_ror:4 row_mask:0xf bank_mask:0xf
    v_cos_f32 v72, v105
    v_sin_f32 v73, v105
    v_add_f32_dpp v64, v64, v64 row_ror:2 row_mask:0xf bank_mask:0xf
    v_pk_mul_f32 v[72:73], v[72:73], v[104:105] op_sel_hi:[1,0] neg_hi:[1,0]
    v_exp_f32 v106, v62
    v_add_f32_dpp v64, v64, v64 row_ror:1 row_mask:0xf bank_mask:0xf
    v_fract_f32 v107, v63
    v_cos_f32 v66, v107
    v_sin_f32 v67, v107
    v_mov_b32 v65, v64
    v_pk_mul_f32 v[66:67], v[66:67], v[106:107] op_sel_hi:[1,0]
    v_mul_f32 v108, 0x43800000, v62
    v_permlane16_swap_b32 v64, v65
    v_mul_f32 v109, 0x43800000, v63
    v_exp_f32 v108, v108
    v_add_f32 v64, v64, v65
    v_fract_f32 v109, v109
    v_cos_f32 v68, v109
    v_sin_f32 v69, v109
    v_mov_b32 v65, v64
    v_pk_mul_f32 v[68:69], v[68:69], v[108:109] op_sel_hi:[1,0]
    v_mov_b32 v162, 0x3c00
    v_pk_mul_f32 v[74:75], v[72:73], v[72:73] op_sel_hi:[1,0]
    v_permlane32_swap_b32 v64, v65
    v_pk_fma_f32 v[74:75], v[72:73], v[72:73], v[74:75] op_sel:[1,1,0] op_sel_hi:[0,1,1] neg_lo:[1,0,0]
    s_setprio 2
    s_branch C_BA
C_O2:
    global_load_dwordx4 v[208:211], v12, s[16:17]
    global_load_dwordx4 v[212:215], v12, s[16:17] offset:512
    global_load_dword v216, v13, s[16:17] offset:1024
    global_load_dwordx4 v[218:221], v12, s[20:21]
    global_load_dwordx4 v[222:225], v12, s[20:21] offset:512
    global_load_dword v226, v13, s[20:21] offset:1024
    s_waitcnt vmcnt(6)
C_LN1:
    v_dot2_f32_bf16 v120, v16, v8, 0
    v_dot2_f32_bf16 v121, v16, v16, 0
    v_dot2_f32_bf16 v120, v17, v8, v120
    v_dot2_f32_bf16 v121, v17, v17, v121
    v_dot2_f32_bf16 v120, v18, v8, v120
    v_dot2_f32_bf16 v121, v18, v18, v121
    v_dot2_f32_bf16 v120, v19, v8, v120
    v_dot2_f32_bf16 v121, v19, v19, v121
    v_dot2_f32_bf16 v120, v20, v8, v120
    v_dot2_f32_bf16 v121, v20, v20, v121
    v_dot2_f32_bf16 v120, v21, v8, v120
    v_dot2_f32_bf16 v121, v21, v21, v121
    v_dot2_f32_bf16 v120, v22, v8, v120
    v_dot2_f32_bf16 v121, v22, v22, v121
    v_dot2_f32_bf16 v120, v23, v8, v120
    v_dot2_f32_bf16 v121, v23, v23, v121
    v_dot2_f32_bf16 v120, v24, v8, v120
    v_dot2_f32_bf16 v121, v24, v24, v121
    s_nop 2
    v_permlane16_swap_b32 v120, v121
    v_add_f32 v120, v120, v121
    s_nop 1
    v_add_f32_dpp v120, v120, v120 row_ror:8 row_mask:0xf bank_mask:0xf
    s_nop 1
    v_add_f32_dpp v120, v120, v120 row_ror:4 row_mask:0xf bank_mask:0xf
    s_nop 1
    v_add_f32_dpp v120, v120, v120 row_ror:2 row_mask:0xf bank_mask:0xf
    s_nop 1
    v_add_f32_dpp v120, v120, v120 row_ror:1 row_mask:0xf bank_mask:0xf
    v_mov_b32 v121, v120
    s_nop 1
    v_permlane16_swap_b32 v120, v121
    v_mul_f32 v120, 0x3ae38e39, v120
    v_mul_f32 v121, 0x3ae38e39, v121
    v_fma_f32 v121, -v120, v120, v121
    v_cvt_pk_bf16_f32 v122, 0, v120
    v_dot2_f32_bf16 v126, v16, v6, v122 neg_lo:[0,0,1]
    v_max_f32 v121, 0, v121
    v_dot2_f32_bf16 v127, v16, v7, v122 neg_lo:[0,0,1]
    v_dot2_f32_bf16 v128, v17, v6, v122 neg_lo:[0,0,1]
    v_dot2_f32_bf16 v129, v17, v7, v122 neg_lo:[0,0,1]
    v_cvt_pk_bf16_f32 v121, 0, v121
    v_dot2_f32_bf16 v130, v18, v6, v122 neg_lo:[0,0,1]
    v_dot2_f32_bf16 v131, v18, v7, v122 neg_lo:[0,0,1]
    v_add_f32 v121, 0x3727c5ac, v121
    v_dot2_f32_bf16 v132, v19, v6, v122 neg_lo:[0,0,1]
    v_dot2_f32_bf16 v133, v19, v7, v122 neg_lo:[0,0,1]
    v_dot2_f32_bf16 v134, v20, v6, v122 neg_lo:[0,0,1]
    v_cvt_pk_bf16_f32 v121, 0, v121
    v_dot2_f32_bf16 v135, v20, v7, v122 neg_lo:[0,0,1]
    v_dot2_f32_bf16 v136, v21, v6, v122 neg_lo:[0,0,1]
    v_dot2_f32_bf16 v137, v21, v7, v122 neg_lo:[0,0,1]
    v_sqrt_f32 v121, v121
    v_dot2_f32_bf16 v138, v22, v6, v122 neg_lo:[0,0,1]
    v_dot2_f32_bf16 v139, v22, v7, v122 neg_lo:[0,0,1]
    v_cvt_pk_bf16_f32 v121, 0, v121
    v_dot2_f32_bf16 v140, v23, v6, v122 neg_lo:[0,0,1]
    v_dot2_f32_bf16 v141, v23, v7, v122 neg_lo:[0,0,1]
    v_dot2_f32_bf16 v142, v24, v6, v122 neg_lo:[0,0,1]
    v_rcp_f32 v124, v121
    v_dot2_f32_bf16 v143, v24, v7, v122 neg_lo:[0,0,1]
    v_cvt_pk_bf16_f32 v126, 0, v126
    v_cvt_pk_bf16_f32 v127, 0, v127
    v_cvt_pk_bf16_f32 v128, 0, v128
    v_cvt_pk_bf16_f32 v129, 0, v129
    v_cvt_pk_bf16_f32 v130, 0, v130
    v_cvt_pk_bf16_f32 v131, 0, v131
    v_cvt_pk_bf16_f32 v132, 0, v132
    v_cvt_pk_bf16_f32 v133, 0, v133
    v_cvt_pk_bf16_f32 v134, 0, v134
    v_cvt_pk_bf16_f32 v135, 0, v135
    v_cvt_pk_bf16_f32 v136, 0, v136
    v_cvt_pk_bf16_f32 v137, 0, v137
    v_cvt_pk_bf16_f32 v138, 0, v138
    v_cvt_pk_bf16_f32 v139, 0, v139
    v_cvt_pk_bf16_f32 v140, 0, v140
    v_cvt_pk_bf16_f32 v141, 0, v141
    v_cvt_pk_bf16_f32 v142, 0, v142
    v_cvt_pk_bf16_f32 v143, 0, v143
    v_pk_mul_f32 v[126:127], v[126:127], v[124:125] op_sel_hi:[1,0]
    v_pk_mul_f32 v[128:129], v[128:129], v[124:125] op_sel_hi:[1,0]
    v_pk_mul_f32 v[130:131], v[130:131], v[124:125] op_sel_hi:[1,0]
    v_pk_mul_f32 v[132:133], v[132:133], v[124:125] op_sel_hi:[1,0]
    v_pk_mul_f32 v[134:135], v[134:135], v[124:125] op_sel_hi:[1,0]
    v_pk_mul_f32 v[136:137], v[136:137], v[124:125] op_sel_hi:[1,0]
    v_pk_mul_f32 v[138:139], v[138:139], v[124:125] op_sel_hi:[1,0]
    v_pk_mul_f32 v[140:141], v[140:141], v[124:125] op_sel_hi:[1,0]
    v_pk_mul_f32 v[142:143], v[142:143], v[124:125] op_sel_hi:[1,0]
    v_cvt_pkrtz_f16_f32 v144, v126, v127
    v_cvt_pkrtz_f16_f32 v145, v128, v129
    v_cvt_pkrtz_f16_f32 v146, v130, v131
    v_cvt_pkrtz_f16_f32 v147, v132, v133
    v_cvt_pkrtz_f16_f32 v148, v134, v135
    ds_write_b128 v25, v[144:147]
    v_cvt_pkrtz_f16_f32 v149, v136, v137
    v_cvt_pkrtz_f16_f32 v150, v138, v139
    v_cvt_pkrtz_f16_f32 v151, v140, v141
    v_cvt_pkrtz_f16_f32 v152, v142, v143
    ds_write_b128 v25, v[148:151] offset:512
    ds_write_b32 v26, v152 offset:1024
    s_waitcnt lgkmcnt(0)
C_BA:
    s_barrier
    s_cmp_ge_u32 s3, 4
    s_cbranch_scc1 C_US
    s_cmp_lt_u32 s2, 144
    s_cbranch_scc1 C_K1
    s_cmp_ge_u32 s49, 128
    s_cbranch_scc1 FROLE
C_US:
    ds_read_b64_tr_b16 v[228:229], v36 offset:0
    ds_read_b64_tr_b16 v[230:231], v36 offset:4736
    ds_read_b64_tr_b16 v[232:233], v36 offset:512
    ds_read_b64_tr_b16 v[234:235], v36 offset:5248
    ds_read_b64_tr_b16 v[236:237], v36 offset:1024
    ds_read_b64_tr_b16 v[238:239], v36 offset:5760
    s_waitcnt lgkmcnt(4)
    v_add_u32 v228, v11, v228
    v_add_u32 v229, v11, v229
    v_add_u32 v230, v11, v230
    v_add_u32 v231, v11, v231
    v_and_or_b32 v228, v228, v9, v10
    v_and_or_b32 v229, v229, v9, v10
    v_and_or_b32 v230, v230, v9, v10
    v_and_or_b32 v231, v231, v9, v10
    buffer_store_dwordx4 v[228:231], v37, s[32:35], s55 offen sc1
    s_waitcnt lgkmcnt(2)
    v_add_u32 v232, v11, v232
    v_add_u32 v233, v11, v233
    v_add_u32 v234, v11, v234
    v_add_u32 v235, v11, v235
    v_and_or_b32 v232, v232, v9, v10
    v_and_or_b32 v233, v233, v9, v10
    v_and_or_b32 v234, v234, v9, v10
    v_and_or_b32 v235, v235, v9, v10
    buffer_store_dwordx4 v[232:235], v37, s[32:35], s36 offen sc1
    s_cmp_lg_u32 s51, 0
    s_cbranch_scc1 US1
    s_waitcnt lgkmcnt(0)
    v_add_u32 v236, v11, v236
    v_add_u32 v237, v11, v237
    v_add_u32 v238, v11, v238
    v_add_u32 v239, v11, v239
    v_and_or_b32 v236, v236, v9, v10
    v_and_or_b32 v237, v237, v9, v10
    v_and_or_b32 v238, v238, v9, v10
    v_and_or_b32 v239, v239, v9, v10
    buffer_store_dwordx4 v[236:239], v37, s[32:35], s37 offen sc1
US1:
    s_cmp_ge_u32 s2, 144
    s_cbranch_scc1 C_O3
    s_branch C_K2
C_O3:
    s_cmp_lt_u32 s49, 128
    s_cbranch_scc1 C_RL2
    v_subrev_u32 v14, 9472, v25
    v_subrev_u32 v15, 9472, v26
    ds_read_b128 v[140:143], v14
    ds_read_b128 v[144:147], v14 offset:512
    ds_read_b32 v148, v15 offset:1024
    s_mov_b32 s46, 10485760
    s_waitcnt lgkmcnt(0)
    v_add_u32 v140, v11, v140
    v_add_u32 v141, v11, v141
    v_add_u32 v142, v11, v142
    v_add_u32 v143, v11, v143
    v_add_u32 v144, v11, v144
    v_add_u32 v145, v11, v145
    v_add_u32 v146, v11, v146
    v_add_u32 v147, v11, v147
    v_add_u32 v148, v11, v148
    v_and_or_b32 v140, v140, v9, v10
    v_and_or_b32 v141, v141, v9, v10
    v_and_or_b32 v142, v142, v9, v10
    v_and_or_b32 v143, v143, v9, v10
    v_and_or_b32 v144, v144, v9, v10
    v_and_or_b32 v145, v145, v9, v10
    v_and_or_b32 v146, v146, v9, v10
    v_and_or_b32 v147, v147, v9, v10
    v_and_or_b32 v148, v148, v9, v10
    buffer_store_dwordx4 v[140:143], v4, s[32:35], s46 offen sc1
    buffer_store_dwordx4 v[144:147], v4, s[32:35], s46 offen offset:512 sc1
    buffer_store_dword v148, v5, s[32:35], s46 offen offset:1024 sc1
    s_branch FROLE
C_RL2:
    s_waitcnt vmcnt(0)
    s_branch RPREP
C_K1:
    s_add_u32 s40, s40, 1
    s_and_b32 s41, s40, 7
    s_bfe_u32 s46, s40, 0x30003
    s_lshl_b32 s46, s46, 16
    s_or_b32 s41, s41, s46
    v_mov_b32 v10, s41
    s_waitcnt vmcnt(9)
    s_bitcmp1_b32 s51, 1
    s_cselect_b32 s56, s57, s56
    s_lshl_b32 s57, s56, 16
    s_and_b32 s56, s56, 0xffff0000
    s_bitcmp1_b32 s51, 0
    s_cselect_b32 s56, s56, s57
    v_mov_b32 v60, 0x3fb8aa3b
    v_mul_f32 v62, 0x3fb8aa3b, v28
    v_mul_f32 v60, s56, v60
    v_exp_f32 v62, v62
    v_exp_f32 v60, v60
    v_add_f32 v64, |v30|, |v31|
    v_add_f32 v65, |v32|, |v33|
    v_cvt_pk_bf16_f32 v62, 0, v62
    v_cvt_pk_bf16_f32 v60, 0, v60
    v_add_f32 v64, v64, v65
    v_mul_f32 v62, v62, v60
    v_mul_f32 v63, v29, v60
    v_mul_f32 v62, 0xbfb8aa3b, v62
    v_mul_f32 v63, 0.15915494, v63
    v_mul_f32 v104, 0x41000000, v62
    v_add_f32_dpp v64, v64, v64 row_ror:8 row_mask:0xf bank_mask:0xf
    v_mul_f32 v105, 0x41000000, v63
    v_exp_f32 v104, v104
    v_fract_f32 v105, v105
    v_add_f32_dpp v64, v64, v64 row_ror:4 row_mask:0xf bank_mask:0xf
    v_cos_f32 v72, v105
    v_sin_f32 v73, v105
    v_add_f32_dpp v64, v64, v64 row_ror:2 row_mask:0xf bank_mask:0xf
    v_pk_mul_f32 v[72:73], v[72:73], v[104:105] op_sel_hi:[1,0] neg_hi:[1,0]
    v_exp_f32 v106, v62
    v_add_f32_dpp v64, v64, v64 row_ror:1 row_mask:0xf bank_mask:0xf
    v_fract_f32 v107, v63
    v_cos_f32 v66, v107
    v_sin_f32 v67, v107
    v_mov_b32 v65, v64
    v_pk_mul_f32 v[66:67], v[66:67], v[106:107] op_sel_hi:[1,0]
    v_mul_f32 v108, 0x43800000, v62
    v_permlane16_swap_b32 v64, v65
    v_mul_f32 v109, 0x43800000, v63
    v_exp_f32 v108, v108
    v_add_f32 v64, v64, v65
    v_fract_f32 v109, v109
    v_cos_f32 v68, v109
    v_sin_f32 v69, v109
    v_mov_b32 v65, v64
    v_pk_mul_f32 v[68:69], v[68:69], v[108:109] op_sel_hi:[1,0]
    v_mov_b32 v162, 0x3c00
    v_pk_mul_f32 v[74:75], v[72:73], v[72:73] op_sel_hi:[1,0]
    v_permlane32_swap_b32 v64, v65
    v_pk_fma_f32 v[74:75], v[72:73], v[72:73], v[74:75] op_sel:[1,1,0] op_sel_hi:[0,1,1] neg_lo:[1,0,0]
C_K2:
    v_pk_mul_f32 v[76:77], v[74:75], v[72:73] op_sel_hi:[1,0]
    v_pk_mul_f32 v[78:79], v[74:75], v[74:75] op_sel_hi:[1,0]
    v_cvt_pk_f16_f32 v163, v72, v73
    v_cvt_pk_f16_f32 v164, v74, v75
    v_add_f32 v64, v64, v65
    v_pk_fma_f32 v[76:77], v[74:75], v[72:73], v[76:77] op_sel:[1,1,0] op_sel_hi:[0,1,1] neg_lo:[1,0,0]
    v_pk_fma_f32 v[78:79], v[74:75], v[74:75], v[78:79] op_sel:[1,1,0] op_sel_hi:[0,1,1] neg_lo:[1,0,0]
    ds_write2st64_b32 v40, v163, v162 offset0:33 offset1:0
    v_pk_mul_f32 v[80:81], v[78:79], v[72:73] op_sel_hi:[1,0]
    v_pk_mul_f32 v[82:83], v[78:79], v[74:75] op_sel_hi:[1,0]
    v_cvt_pk_f16_f32 v165, v76, v77
    v_cvt_pk_f16_f32 v166, v78, v79
    v_mul_f32 v64, v64, v60
    v_pk_fma_f32 v[80:81], v[78:79], v[72:73], v[80:81] op_sel:[1,1,0] op_sel_hi:[0,1,1] neg_lo:[1,0,0]
    v_pk_fma_f32 v[82:83], v[78:79], v[74:75], v[82:83] op_sel:[1,1,0] op_sel_hi:[0,1,1] neg_lo:[1,0,0]
    ds_write2st64_b32 v41, v165, v164 offset0:33 offset1:0
    v_pk_mul_f32 v[84:85], v[78:79], v[76:77] op_sel_hi:[1,0]
    v_pk_mul_f32 v[86:87], v[78:79], v[78:79] op_sel_hi:[1,0]
    v_cvt_pk_f16_f32 v167, v80, v81
    v_cvt_pk_f16_f32 v56, v82, v83
    v_frexp_exp_i32_f32 v64, v64
    v_pk_fma_f32 v[84:85], v[78:79], v[76:77], v[84:85] op_sel:[1,1,0] op_sel_hi:[0,1,1] neg_lo:[1,0,0]
    v_pk_fma_f32 v[86:87], v[78:79], v[78:79], v[86:87] op_sel:[1,1,0] op_sel_hi:[0,1,1] neg_lo:[1,0,0]
    ds_write2st64_b32 v42, v167, v166 offset0:33 offset1:0
    v_pk_mul_f32 v[88:89], v[86:87], v[72:73] op_sel_hi:[1,0]
    v_pk_mul_f32 v[90:91], v[86:87], v[74:75] op_sel_hi:[1,0]
    v_cvt_pk_f16_f32 v57, v84, v85
    v_cvt_pk_f16_f32 v163, v86, v87
    v_max_i32 v64, -100, v64
    v_pk_fma_f32 v[88:89], v[86:87], v[72:73], v[88:89] op_sel:[1,1,0] op_sel_hi:[0,1,1] neg_lo:[1,0,0]
    v_pk_fma_f32 v[90:91], v[86:87], v[74:75], v[90:91] op_sel:[1,1,0] op_sel_hi:[0,1,1] neg_lo:[1,0,0]
    ds_write2st64_b32 v43, v57, v56 offset0:33 offset1:0
    v_pk_mul_f32 v[92:93], v[86:87], v[76:77] op_sel_hi:[1,0]
    v_pk_mul_f32 v[94:95], v[86:87], v[78:79] op_sel_hi:[1,0]
    v_cvt_pk_f16_f32 v162, v88, v89
    v_cvt_pk_f16_f32 v165, v90, v91
    v_min_i32 v64, 100, v64
    v_pk_fma_f32 v[92:93], v[86:87], v[76:77], v[92:93] op_sel:[1,1,0] op_sel_hi:[0,1,1] neg_lo:[1,0,0]
    v_pk_fma_f32 v[94:95], v[86:87], v[78:79], v[94:95] op_sel:[1,1,0] op_sel_hi:[0,1,1] neg_lo:[1,0,0]
    ds_write2st64_b32 v44, v162, v163 offset0:33 offset1:0
    v_pk_mul_f32 v[96:97], v[86:87], v[80:81] op_sel_hi:[1,0]
    v_pk_mul_f32 v[98:99], v[86:87], v[82:83] op_sel_hi:[1,0]
    v_cvt_pk_f16_f32 v164, v92, v93
    v_cvt_pk_f16_f32 v167, v94, v95
    v_sub_u32 v65, 0, v64
    v_pk_fma_f32 v[96:97], v[86:87], v[80:81], v[96:97] op_sel:[1,1,0] op_sel_hi:[0,1,1] neg_lo:[1,0,0]
    v_pk_fma_f32 v[98:99], v[86:87], v[82:83], v[98:99] op_sel:[1,1,0] op_sel_hi:[0,1,1] neg_lo:[1,0,0]
    ds_write2st64_b32 v45, v164, v165 offset0:33 offset1:0
    v_pk_mul_f32 v[100:101], v[86:87], v[84:85] op_sel_hi:[1,0]
    v_pk_mul_f32 v[102:103], v[86:87], v[86:87] op_sel_hi:[1,0]
    v_cvt_pk_f16_f32 v166, v96, v97
    v_cvt_pk_f16_f32 v57, v98, v99
    v_ldexp_f32 v60, v60, v65
    v_pk_fma_f32 v[100:101], v[86:87], v[84:85], v[100:101] op_sel:[1,1,0] op_sel_hi:[0,1,1] neg_lo:[1,0,0]
    v_pk_fma_f32 v[102:103], v[86:87], v[86:87], v[102:103] op_sel:[1,1,0] op_sel_hi:[0,1,1] neg_lo:[1,0,0]
    ds_write2st64_b32 v46, v166, v167 offset0:33 offset1:0
    v_pk_mul_f32 v[112:113], v[102:103], v[72:73] op_sel_hi:[1,0]
    v_pk_mul_f32 v[114:115], v[102:103], v[74:75] op_sel_hi:[1,0]
    v_cvt_pk_f16_f32 v56, v100, v101
    v_cvt_pk_f16_f32 v162, v102, v103
    v_pk_mul_f32 v[30:31], v[30:31], v[60:61] op_sel_hi:[1,0]
    v_pk_fma_f32 v[112:113], v[102:103], v[72:73], v[112:113] op_sel:[1,1,0] op_sel_hi:[0,1,1] neg_lo:[1,0,0]
    v_pk_fma_f32 v[114:115], v[102:103], v[74:75], v[114:115] op_sel:[1,1,0] op_sel_hi:[0,1,1] neg_lo:[1,0,0]
    ds_write2st64_b32 v47, v56, v57 offset0:33 offset1:0
    v_pk_mul_f32 v[116:117], v[102:103], v[76:77] op_sel_hi:[1,0]
    v_pk_mul_f32 v[110:111], v[102:103], v[78:79] op_sel_hi:[1,0]
    v_cvt_pk_f16_f32 v163, v112, v113
    v_cvt_pk_f16_f32 v164, v114, v115
    v_pk_fma_f32 v[116:117], v[102:103], v[76:77], v[116:117] op_sel:[1,1,0] op_sel_hi:[0,1,1] neg_lo:[1,0,0]
    v_pk_fma_f32 v[110:111], v[102:103], v[78:79], v[110:111] op_sel:[1,1,0] op_sel_hi:[0,1,1] neg_lo:[1,0,0]
    ds_write2st64_b32 v48, v163, v162 offset0:33 offset1:0
    v_pk_mul_f32 v[112:113], v[102:103], v[80:81] op_sel_hi:[1,0]
    v_pk_mul_f32 v[114:115], v[102:103], v[82:83] op_sel_hi:[1,0]
    v_cvt_pk_f16_f32 v165, v116, v117
    v_cvt_pk_f16_f32 v166, v110, v111
    v_pk_fma_f32 v[112:113], v[102:103], v[80:81], v[112:113] op_sel:[1,1,0] op_sel_hi:[0,1,1] neg_lo:[1,0,0]
    v_pk_fma_f32 v[114:115], v[102:103], v[82:83], v[114:115] op_sel:[1,1,0] op_sel_hi:[0,1,1] neg_lo:[1,0,0]
    ds_write2st64_b32 v49, v165, v164 offset0:33 offset1:0
    s_setprio 0
    v_pk_mul_f32 v[120:121], v[30:31], v[66:67] op_sel_hi:[1,0]
    v_cvt_pk_f16_f32 v167, v112, v113
    v_cvt_pk_f16_f32 v56, v114, v115
    v_pk_fma_f32 v[120:121], v[30:31], v[66:67], v[120:121] op_sel:[1,1,0] op_sel_hi:[0,1,1] neg_lo:[1,0,0]
    ds_write2st64_b32 v50, v167, v166 offset0:33 offset1:0
    s_cmp_ge_u32 s3, 4
    s_cbranch_scc1 C_K3
    v_add_u32 v64, 1, v64
    s_and_b32 s46, s40, 0x7fffff
    v_ldexp_f32 v64, 1.0, v64
    s_lshl_b32 s53, s2, 7
    v_or_b32 v64, s46, v64
    s_lshl_b32 s46, s51, 2
    s_add_u32 s46, s46, s53
    s_add_u32 s46, s46, 32768
    s_mov_b64 exec, 1
    buffer_store_dword v64, v2, s[32:35], s46 offen sc1
    s_mov_b64 exec, -1
    s_branch C_K4
C_K3:
    v_add_u32 v27, 4096, v2
    global_load_dwordx4 v[168:171], v27, s[44:45] offset:-4096
    global_load_dwordx4 v[172:175], v27, s[44:45] offset:-3072
    global_load_dwordx4 v[176:179], v27, s[44:45] offset:-2048
    global_load_dwordx4 v[180:183], v27, s[44:45] offset:-1024
    global_load_dwordx4 v[184:187], v27, s[44:45] offset:0
    global_load_dwordx4 v[188:191], v27, s[44:45] offset:1024
    global_load_dwordx4 v[192:195], v27, s[44:45] offset:2048
    s_lshl_b32 s48, s2, 14
    s_add_u32 s48, s48, 1048576
    s_lshl_b32 s46, s51, 10
    s_add_u32 s59, s48, s46
    s_add_u32 s59, s59, 12288
    s_mul_i32 s46, s51, 3072
    s_add_u32 s48, s48, s46
C_K4:
    v_pk_mul_f32 v[136:137], v[30:31], v[68:69] op_sel_hi:[1,0]
    v_pk_mul_f32 v[122:123], v[120:121], v[66:67] op_sel_hi:[1,0]
    v_cvt_pk_f16_f32 v57, v30, v31
    v_cvt_pk_f16_f32 v163, v120, v121
    v_pk_fma_f32 v[136:137], v[30:31], v[68:69], v[136:137] op_sel:[1,1,0] op_sel_hi:[0,1,1] neg_lo:[1,0,0]
    v_pk_fma_f32 v[122:123], v[120:121], v[66:67], v[122:123] op_sel:[1,1,0] op_sel_hi:[0,1,1] neg_lo:[1,0,0]
    ds_write_b32 v46, v57 offset:16896
    v_pk_mul_f32 v[124:125], v[122:123], v[66:67] op_sel_hi:[1,0]
    v_pk_mul_f32 v[138:139], v[122:123], v[68:69] op_sel_hi:[1,0]
    v_cvt_pk_f16_f32 v162, v136, v137
    v_cvt_pk_f16_f32 v165, v122, v123
    v_pk_fma_f32 v[124:125], v[122:123], v[66:67], v[124:125] op_sel:[1,1,0] op_sel_hi:[0,1,1] neg_lo:[1,0,0]
    v_pk_fma_f32 v[138:139], v[122:123], v[68:69], v[138:139] op_sel:[1,1,0] op_sel_hi:[0,1,1] neg_lo:[1,0,0]
    ds_write2st64_b32 v40, v162, v163 offset0:99 offset1:66
    v_pk_mul_f32 v[126:127], v[124:125], v[66:67] op_sel_hi:[1,0]
    v_cvt_pk_f16_f32 v164, v124, v125
    v_cvt_pk_f16_f32 v167, v138, v139
    v_pk_fma_f32 v[126:127], v[124:125], v[66:67], v[126:127] op_sel:[1,1,0] op_sel_hi:[0,1,1] neg_lo:[1,0,0]
    ds_write2st64_b32 v41, v167, v164 offset0:99 offset1:66
    v_pk_mul_f32 v[128:129], v[126:127], v[66:67] op_sel_hi:[1,0]
    v_pk_mul_f32 v[140:141], v[126:127], v[68:69] op_sel_hi:[1,0]
    v_cvt_pk_f16_f32 v166, v126, v127
    v_pk_fma_f32 v[128:129], v[126:127], v[66:67], v[128:129] op_sel:[1,1,0] op_sel_hi:[0,1,1] neg_lo:[1,0,0]
    v_pk_fma_f32 v[140:141], v[126:127], v[68:69], v[140:141] op_sel:[1,1,0] op_sel_hi:[0,1,1] neg_lo:[1,0,0]
    ds_write_b32 v47, v166 offset:16896
    v_pk_mul_f32 v[130:131], v[128:129], v[66:67] op_sel_hi:[1,0]
    v_pk_mul_f32 v[146:147], v[140:141], v[68:69] op_sel_hi:[1,0]
    v_cvt_pk_f16_f32 v57, v128, v129
    v_cvt_pk_f16_f32 v162, v140, v141
    v_pk_fma_f32 v[130:131], v[128:129], v[66:67], v[130:131] op_sel:[1,1,0] op_sel_hi:[0,1,1] neg_lo:[1,0,0]
    v_pk_fma_f32 v[146:147], v[140:141], v[68:69], v[146:147] op_sel:[1,1,0] op_sel_hi:[0,1,1] neg_lo:[1,0,0]
    ds_write_b32 v48, v57 offset:16896
    v_pk_mul_f32 v[132:133], v[130:131], v[66:67] op_sel_hi:[1,0]
    v_pk_mul_f32 v[142:143], v[130:131], v[68:69] op_sel_hi:[1,0]
    v_cvt_pk_f16_f32 v163, v130, v131
    v_cvt_pk_f16_f32 v167, v146, v147
    v_pk_fma_f32 v[132:133], v[130:131], v[66:67], v[132:133] op_sel:[1,1,0] op_sel_hi:[0,1,1] neg_lo:[1,0,0]
    v_pk_fma_f32 v[142:143], v[130:131], v[68:69], v[142:143] op_sel:[1,1,0] op_sel_hi:[0,1,1] neg_lo:[1,0,0]
    ds_write2st64_b32 v45, v162, v165 offset0:99 offset1:66
    v_pk_mul_f32 v[134:135], v[132:133], v[66:67] op_sel_hi:[1,0]
    v_pk_mul_f32 v[150:151], v[146:147], v[68:69] op_sel_hi:[1,0]
    v_cvt_pk_f16_f32 v164, v132, v133
    v_cvt_pk_f16_f32 v166, v142, v143
    v_pk_fma_f32 v[134:135], v[132:133], v[66:67], v[134:135] op_sel:[1,1,0] op_sel_hi:[0,1,1] neg_lo:[1,0,0]
    v_pk_fma_f32 v[150:151], v[146:147], v[68:69], v[150:151] op_sel:[1,1,0] op_sel_hi:[0,1,1] neg_lo:[1,0,0]
    ds_write2st64_b32 v42, v167, v163 offset0:99 offset1:66
    v_pk_mul_f32 v[144:145], v[134:135], v[68:69] op_sel_hi:[1,0]
    v_pk_mul_f32 v[116:117], v[102:103], v[84:85] op_sel_hi:[1,0]
    ds_write_b32 v49, v164 offset:16896
    v_cvt_pk_f16_f32 v57, v134, v135
    v_cvt_pk_f16_f32 v162, v150, v151
    v_pk_fma_f32 v[144:145], v[134:135], v[68:69], v[144:145] op_sel:[1,1,0] op_sel_hi:[0,1,1] neg_lo:[1,0,0]
    v_pk_fma_f32 v[116:117], v[102:103], v[84:85], v[116:117] op_sel:[1,1,0] op_sel_hi:[0,1,1] neg_lo:[1,0,0]
    ds_write_b32 v50, v166 offset:16896
    v_pk_mul_f32 v[148:149], v[144:145], v[68:69] op_sel_hi:[1,0]
    v_pk_mul_f32 v[110:111], v[102:103], v[86:87] op_sel_hi:[1,0]
    v_cvt_pk_f16_f32 v165, v144, v145
    v_cvt_pk_f16_f32 v167, v116, v117
    v_pk_fma_f32 v[148:149], v[144:145], v[68:69], v[148:149] op_sel:[1,1,0] op_sel_hi:[0,1,1] neg_lo:[1,0,0]
    v_pk_fma_f32 v[110:111], v[102:103], v[86:87], v[110:111] op_sel:[1,1,0] op_sel_hi:[0,1,1] neg_lo:[1,0,0]
    ds_write2st64_b32 v43, v162, v57 offset0:99 offset1:66
    v_pk_mul_f32 v[152:153], v[148:149], v[68:69] op_sel_hi:[1,0]
    v_pk_mul_f32 v[112:113], v[102:103], v[88:89] op_sel_hi:[1,0]
    v_cvt_pk_f16_f32 v163, v148, v149
    v_cvt_pk_f16_f32 v164, v110, v111
    v_pk_fma_f32 v[152:153], v[148:149], v[68:69], v[152:153] op_sel:[1,1,0] op_sel_hi:[0,1,1] neg_lo:[1,0,0]
    v_pk_fma_f32 v[112:113], v[102:103], v[88:89], v[112:113] op_sel:[1,1,0] op_sel_hi:[0,1,1] neg_lo:[1,0,0]
    ds_write2st64_b32 v51, v167, v56 offset0:33 offset1:0
    v_pk_mul_f32 v[114:115], v[102:103], v[90:91] op_sel_hi:[1,0]
    v_pk_mul_f32 v[154:155], v[152:153], v[68:69] op_sel_hi:[1,0]
    v_cvt_pk_f16_f32 v166, v152, v153
    v_cvt_pk_f16_f32 v162, v112, v113
    v_pk_fma_f32 v[114:115], v[102:103], v[90:91], v[114:115] op_sel:[1,1,0] op_sel_hi:[0,1,1] neg_lo:[1,0,0]
    v_pk_fma_f32 v[154:155], v[152:153], v[68:69], v[154:155] op_sel:[1,1,0] op_sel_hi:[0,1,1] neg_lo:[1,0,0]
    ds_write2st64_b32 v44, v163, v165 offset0:99 offset1:66
    v_pk_mul_f32 v[116:117], v[102:103], v[92:93] op_sel_hi:[1,0]
    v_pk_mul_f32 v[156:157], v[154:155], v[68:69] op_sel_hi:[1,0]
    ds_write_b32 v51, v166 offset:16896
    v_cvt_pk_f16_f32 v57, v114, v115
    v_cvt_pk_f16_f32 v167, v154, v155
    v_pk_fma_f32 v[116:117], v[102:103], v[92:93], v[116:117] op_sel:[1,1,0] op_sel_hi:[0,1,1] neg_lo:[1,0,0]
    v_pk_fma_f32 v[156:157], v[154:155], v[68:69], v[156:157] op_sel:[1,1,0] op_sel_hi:[0,1,1] neg_lo:[1,0,0]
    ds_write2st64_b32 v52, v162, v164 offset0:33 offset1:0
    s_cmp_lt_u32 s3, 4
    s_cbranch_scc1 C_K6
    buffer_load_dwordx4 v[200:203], v2, s[32:35], s48 offen offset:0 sc1
    buffer_load_dwordx4 v[204:207], v2, s[32:35], s48 offen offset:1024 sc1
    buffer_load_dwordx4 v[208:211], v2, s[32:35], s48 offen offset:2048 sc1
C_K6:
    v_pk_mul_f32 v[110:111], v[102:103], v[94:95] op_sel_hi:[1,0]
    v_pk_mul_f32 v[112:113], v[102:103], v[96:97] op_sel_hi:[1,0]
    v_cvt_pk_f16_f32 v56, v116, v117
    v_cvt_pk_f16_f32 v163, v156, v157
    v_pk_fma_f32 v[110:111], v[102:103], v[94:95], v[110:111] op_sel:[1,1,0] op_sel_hi:[0,1,1] neg_lo:[1,0,0]
    v_pk_fma_f32 v[112:113], v[102:103], v[96:97], v[112:113] op_sel:[1,1,0] op_sel_hi:[0,1,1] neg_lo:[1,0,0]
    ds_write_b32 v52, v167 offset:16896
    v_pk_mul_f32 v[158:159], v[156:157], v[68:69] op_sel_hi:[1,0]
    v_pk_mul_f32 v[114:115], v[102:103], v[98:99] op_sel_hi:[1,0]
    ds_write2st64_b32 v53, v56, v57 offset0:33 offset1:0
    v_cvt_pk_f16_f32 v165, v110, v111
    v_cvt_pk_f16_f32 v166, v112, v113
    v_pk_fma_f32 v[158:159], v[156:157], v[68:69], v[158:159] op_sel:[1,1,0] op_sel_hi:[0,1,1] neg_lo:[1,0,0]
    v_pk_fma_f32 v[114:115], v[102:103], v[98:99], v[114:115] op_sel:[1,1,0] op_sel_hi:[0,1,1] neg_lo:[1,0,0]
    ds_write_b32 v53, v163 offset:16896
    v_pk_mul_f32 v[160:161], v[158:159], v[68:69] op_sel_hi:[1,0]
    v_pk_mul_f32 v[116:117], v[102:103], v[100:101] op_sel_hi:[1,0]
    v_cvt_pk_f16_f32 v162, v158, v159
    v_cvt_pk_f16_f32 v164, v114, v115
    v_pk_fma_f32 v[160:161], v[158:159], v[68:69], v[160:161] op_sel:[1,1,0] op_sel_hi:[0,1,1] neg_lo:[1,0,0]
    v_pk_fma_f32 v[116:117], v[102:103], v[100:101], v[116:117] op_sel:[1,1,0] op_sel_hi:[0,1,1] neg_lo:[1,0,0]
    ds_write2st64_b32 v54, v166, v165 offset0:33 offset1:0
    v_cvt_pk_f16_f32 v167, v160, v161
    v_cvt_pk_f16_f32 v56, v116, v117
    ds_write_b32 v54, v162 offset:16896
    ds_write_b32 v55, v167 offset:16896
    ds_write2st64_b32 v55, v56, v164 offset0:33 offset1:0
    s_cmp_ge_u32 s3, 4
    s_cbranch_scc1 H_PATH
    s_waitcnt vmcnt(7)
    v_add_u32 v195, s60, v195
    ds_read_b128 v[92:95], v195 offset:0
    ds_read_b128 v[96:99], v253 offset:0
    ds_read_b128 v[100:103], v195 offset:32
    ds_read_b128 v[104:107], v253 offset:32
    s_barrier
    ds_read_b128 v[108:111], v195 offset:64
    ds_read_b128 v[112:115], v253 offset:64
    ds_read_b128 v[116:119], v195 offset:96
    ds_read_b128 v[120:123], v253 offset:96
    ds_read_b128 v[124:127], v195 offset:128
    ds_read_b128 v[128:131], v253 offset:128
    ds_read_b128 v[132:135], v195 offset:160
    ds_read_b128 v[136:139], v253 offset:160
    ds_read_b128 v[140:143], v195 offset:192
    ds_read_b128 v[144:147], v253 offset:192
    s_waitcnt lgkmcnt(12)
    v_mfma_f32_32x32x16_f16 v[168:183], v[92:95], v[96:99], 0
    ds_read_b128 v[148:151], v195 offset:224
    ds_read_b128 v[152:155], v253 offset:224
    v_add_u32 v184, s62, v184
    v_add_u32 v185, s62, v185
    s_waitcnt lgkmcnt(12)
    v_mfma_f32_32x32x16_f16 v[168:183], v[100:103], v[104:107], v[168:183]
    ds_read_b128 v[92:95], v195 offset:256
    ds_read_b128 v[96:99], v253 offset:256
    v_add_u32 v186, s62, v186
    v_add_u32 v187, s62, v187
    s_waitcnt lgkmcnt(12)
    v_mfma_f32_32x32x16_f16 v[168:183], v[108:111], v[112:115], v[168:183]
    ds_read_b128 v[100:103], v195 offset:288
    ds_read_b128 v[104:107], v253 offset:288
    v_add_u32 v188, s62, v188
    v_add_u32 v189, s62, v189
    s_waitcnt lgkmcnt(12)
    v_mfma_f32_32x32x16_f16 v[168:183], v[116:119], v[120:123], v[168:183]
    ds_read_b128 v[108:111], v195 offset:320
    ds_read_b128 v[112:115], v253 offset:320
    v_add_u32 v190, s62, v190
    v_add_u32 v191, s62, v191
    s_waitcnt lgkmcnt(12)
    v_mfma_f32_32x32x16_f16 v[168:183], v[124:127], v[128:131], v[168:183]
    ds_read_b128 v[116:119], v195 offset:352
    ds_read_b128 v[120:123], v253 offset:352
    v_add_u32 v192, s62, v192
    v_add_u32 v193, s62, v193
    s_waitcnt lgkmcnt(12)
    v_mfma_f32_32x32x16_f16 v[168:183], v[132:135], v[136:139], v[168:183]
    ds_read_b128 v[124:127], v195 offset:384
    ds_read_b128 v[128:131], v253 offset:384
    v_add_u32 v194, s62, v194
    v_and_b32 v14, 15, v1
    s_waitcnt lgkmcnt(12)
    v_mfma_f32_32x32x16_f16 v[168:183], v[140:143], v[144:147], v[168:183]
    ds_read_b128 v[132:135], v195 offset:416
    ds_read_b128 v[136:139], v253 offset:416
    v_lshrrev_b32 v15, 4, v1
    s_mul_i32 s46, s51, 4640
    s_waitcnt lgkmcnt(12)
    v_mfma_f32_32x32x16_f16 v[168:183], v[148:151], v[152:155], v[168:183]
    ds_read_b128 v[140:143], v195 offset:448
    ds_read_b128 v[144:147], v253 offset:448
    s_add_u32 s46, s46, 114048
    v_lshlrev_b32 v248, 5, v14
    s_waitcnt lgkmcnt(12)
    v_mfma_f32_32x32x16_f16 v[168:183], v[92:95], v[96:99], v[168:183]
    ds_read_b128 v[148:151], v195 offset:480
    ds_read_b128 v[152:155], v253 offset:480
    v_lshl_add_u32 v248, v15, 4, v248
    v_add_u32 v248, s46, v248
    s_waitcnt lgkmcnt(12)
    v_mfma_f32_32x32x16_f16 v[168:183], v[100:103], v[104:107], v[168:183]
    s_mul_i32 s46, s51, 6144
    s_add_u32 s46, s46, 20480
    v_add_u32 v249, s46, v2
    v_lshlrev_b32 v250, 3, v15
    v_sub_u32 v250, v250, v14
    s_waitcnt lgkmcnt(10)
    v_mfma_f32_32x32x16_f16 v[168:183], v[108:111], v[112:115], v[168:183]
    v_add_u32 v250, 15, v250
    v_and_b32 v34, 1, v250
    v_mul_u32_u24 v34, 1090, v34
    v_lshl_add_u32 v250, v250, 1, v34
    v_add_u32 v250, s62, v250
    s_waitcnt lgkmcnt(8)
    v_mfma_f32_32x32x16_f16 v[168:183], v[116:119], v[120:123], v[168:183]
    v_lshlrev_b32 v251, 3, v14
    v_and_b32 v34, 1, v15
    v_lshl_add_u32 v251, v34, 8, v251
    v_lshrrev_b32 v34, 1, v15
    v_lshl_add_u32 v251, v34, 7, v251
    s_waitcnt lgkmcnt(6)
    v_mfma_f32_32x32x16_f16 v[168:183], v[124:127], v[128:131], v[168:183]
    s_mul_i32 s46, s51, 4128
    v_add_u32 v251, s46, v251
    v_add_u32 v252, 576, v250
    v_add_u32 v250, 64, v250
    s_and_b32 s46, s2, 7
    s_waitcnt lgkmcnt(4)
    v_mfma_f32_32x32x16_f16 v[168:183], v[132:135], v[136:139], v[168:183]
    s_mul_i32 s46, s46, 72
    s_lshr_b32 s53, s2, 3
    s_lshl_b32 s53, s53, 2
    s_add_u32 s46, s46, s53
    s_add_u32 s46, s46, s51
    s_waitcnt lgkmcnt(2)
    v_mfma_f32_32x32x16_f16 v[168:183], v[140:143], v[144:147], v[168:183]
    s_mul_i32 s46, s46, 9216
    s_add_u32 s46, s46, 4096
    v_add_u32 v27, s46, v2
    s_waitcnt lgkmcnt(0)
    v_mfma_f32_32x32x16_f16 v[168:183], v[148:151], v[152:155], v[168:183]
    s_nop 11
    v_cvt_pk_f16_f32 v196, v171, v170
    v_cvt_pk_f16_f32 v197, v169, v168
    v_cvt_pk_f16_f32 v198, v183, v182
    ds_write2_b32 v184, v196, v197 offset0:0 offset1:1
    v_cvt_pk_f16_f32 v199, v181, v180
    v_cvt_pk_f16_f32 v200, v175, v175
    ds_write2_b32 v185, v198, v199 offset0:0 offset1:1
    v_cvt_pk_f16_f32 v201, v174, v173
    v_cvt_pk_f16_f32 v202, v173, v173
    ds_write2_b32 v189, v200, v201 offset0:0 offset1:1
    ds_write_b32 v190, v200
    v_cvt_pk_f16_f32 v203, v172, v176
    ds_write2_b32 v188, v200, v202 offset0:0 offset1:2
    v_cvt_pk_f16_f32 v204, v175, v174
    ds_write2_b32 v189, v202, v203 offset0:2 offset1:3
    v_cvt_pk_f16_f32 v205, v173, v172
    ds_write_b32 v186, v204
    v_cvt_pk_f16_f32 v206, v176, v177
    ds_write_b32 v187, v205
    v_cvt_pk_f16_f32 v207, v178, v179
    ds_write_b16 v191, v206
    ds_write_b16_d16_hi v192, v206
    ds_write_b16 v193, v207
    ds_write_b16_d16_hi v194, v207
    ds_read2_b32 v[44:45], v252 offset0:48 offset1:49
    ds_read2_b32 v[46:47], v252 offset0:50 offset1:51
    ds_read2_b32 v[48:49], v252 offset0:32 offset1:33
    ds_read2_b32 v[50:51], v252 offset0:34 offset1:35
    ds_read2_b32 v[52:53], v252 offset0:16 offset1:17
    ds_read2_b32 v[54:55], v252 offset0:18 offset1:19
    ds_read2_b32 v[56:57], v252 offset0:0 offset1:1
    ds_read2_b32 v[58:59], v252 offset0:2 offset1:3
    ds_read2_b32 v[28:29], v252 offset0:112 offset1:113
    ds_read2_b32 v[30:31], v252 offset0:114 offset1:115
    ds_read2_b32 v[32:33], v252 offset0:96 offset1:97
    ds_read2_b32 v[34:35], v252 offset0:98 offset1:99
    ds_read2_b32 v[36:37], v252 offset0:80 offset1:81
    ds_read2_b32 v[38:39], v252 offset0:82 offset1:83
    ds_read2_b32 v[40:41], v252 offset0:64 offset1:65
    ds_read2_b32 v[42:43], v252 offset0:66 offset1:67
    s_waitcnt lgkmcnt(15)
    s_barrier
    ds_read_b128 v[92:95], v248 offset:480
    ds_read_b128 v[96:99], v248 offset:416
    ds_read_b128 v[100:103], v248 offset:352
    ds_read_b128 v[104:107], v248 offset:288
    ds_read_b128 v[108:111], v248 offset:992
    ds_read_b128 v[112:115], v248 offset:928
    ds_read_b128 v[116:119], v248 offset:864
    ds_read_b128 v[120:123], v248 offset:800
    s_waitcnt lgkmcnt(15)
    s_waitcnt lgkmcnt(7)
    v_mfma_f32_16x16x32_f16 v[188:191], v[44:47], v[92:95], 0
    ds_read2_b32 v[76:77], v250 offset0:48 offset1:49
    ds_read2_b32 v[78:79], v250 offset0:50 offset1:51
    s_waitcnt lgkmcnt(8)
    v_mfma_f32_16x16x32_f16 v[188:191], v[48:51], v[96:99], v[188:191]
    ds_read2_b32 v[80:81], v250 offset0:32 offset1:33
    ds_read2_b32 v[82:83], v250 offset0:34 offset1:35
    s_waitcnt lgkmcnt(9)
    v_mfma_f32_16x16x32_f16 v[188:191], v[52:55], v[100:103], v[188:191]
    ds_read2_b32 v[84:85], v250 offset0:16 offset1:17
    ds_read2_b32 v[86:87], v250 offset0:18 offset1:19
    s_waitcnt lgkmcnt(10)
    v_mfma_f32_16x16x32_f16 v[188:191], v[56:59], v[104:107], v[188:191]
    ds_read2_b32 v[88:89], v250 offset0:0 offset1:1
    ds_read2_b32 v[90:91], v250 offset0:2 offset1:3
    v_mfma_f32_16x16x32_f16 v[156:159], v[28:31], v[92:95], 0
    ds_read2_b32 v[60:61], v250 offset0:112 offset1:113
    ds_read2_b32 v[62:63], v250 offset0:114 offset1:115
    v_mfma_f32_16x16x32_f16 v[156:159], v[32:35], v[96:99], v[156:159]
    ds_read2_b32 v[64:65], v250 offset0:96 offset1:97
    ds_read2_b32 v[66:67], v250 offset0:98 offset1:99
    v_mfma_f32_16x16x32_f16 v[156:159], v[36:39], v[100:103], v[156:159]
    ds_read2_b32 v[68:69], v250 offset0:80 offset1:81
    ds_read2_b32 v[70:71], v250 offset0:82 offset1:83
    v_mfma_f32_16x16x32_f16 v[156:159], v[40:43], v[104:107], v[156:159]
    ds_read2_b32 v[72:73], v250 offset0:64 offset1:65
    ds_read2_b32 v[74:75], v250 offset0:66 offset1:67
    s_waitcnt lgkmcnt(15)
    v_mfma_f32_16x16x32_f16 v[192:195], v[44:47], v[108:111], 0
    ds_read_b128 v[124:127], v248 offset:1504
    v_mfma_f32_16x16x32_f16 v[192:195], v[48:51], v[112:115], v[192:195]
    ds_read_b128 v[128:131], v248 offset:1440
    s_waitcnt lgkmcnt(15)
    v_mfma_f32_16x16x32_f16 v[192:195], v[52:55], v[116:119], v[192:195]
    ds_read_b128 v[132:135], v248 offset:1376
    v_mfma_f32_16x16x32_f16 v[192:195], v[56:59], v[120:123], v[192:195]
    ds_read_b128 v[136:139], v248 offset:1312
    s_waitcnt lgkmcnt(15)
    v_mfma_f32_16x16x32_f16 v[192:195], v[76:79], v[92:95], v[192:195]
    v_add_f32_dpp v156, v188, v156 row_ror:8 row_mask:0xf bank_mask:0xc
    v_add_f32_dpp v157, v189, v157 row_ror:8 row_mask:0xf bank_mask:0xc
    s_waitcnt lgkmcnt(15)
    v_mfma_f32_16x16x32_f16 v[192:195], v[80:83], v[96:99], v[192:195]
    v_add_f32_dpp v158, v190, v158 row_ror:8 row_mask:0xf bank_mask:0xc
    v_add_f32_dpp v159, v191, v159 row_ror:8 row_mask:0xf bank_mask:0xc
    s_waitcnt lgkmcnt(14)
    v_mfma_f32_16x16x32_f16 v[192:195], v[84:87], v[100:103], v[192:195]
    v_cvt_pkrtz_f16_f32 v156, v156, v157
    v_cvt_pkrtz_f16_f32 v157, v158, v159
    s_waitcnt lgkmcnt(12)
    v_mfma_f32_16x16x32_f16 v[192:195], v[88:91], v[104:107], v[192:195]
    v_mfma_f32_16x16x32_f16 v[160:163], v[28:31], v[108:111], 0
    ds_write_b64 v251, v[156:157] offset:0
    v_mfma_f32_16x16x32_f16 v[160:163], v[32:35], v[112:115], v[160:163]
    v_mfma_f32_16x16x32_f16 v[160:163], v[36:39], v[116:119], v[160:163]
    v_mfma_f32_16x16x32_f16 v[160:163], v[40:43], v[120:123], v[160:163]
    s_waitcnt lgkmcnt(11)
    v_mfma_f32_16x16x32_f16 v[160:163], v[60:63], v[92:95], v[160:163]
    s_waitcnt lgkmcnt(9)
    v_mfma_f32_16x16x32_f16 v[160:163], v[64:67], v[96:99], v[160:163]
    v_mov_b32_dpp v188, v192 quad_perm:[0,1,2,3] row_mask:0xf bank_mask:0x3
    v_mov_b32_dpp v189, v193 quad_perm:[0,1,2,3] row_mask:0xf bank_mask:0x3
    s_waitcnt lgkmcnt(7)
    v_mfma_f32_16x16x32_f16 v[160:163], v[68:71], v[100:103], v[160:163]
    v_mov_b32_dpp v190, v194 quad_perm:[0,1,2,3] row_mask:0xf bank_mask:0x3
    v_mov_b32_dpp v191, v195 quad_perm:[0,1,2,3] row_mask:0xf bank_mask:0x3
    s_waitcnt lgkmcnt(5)
    v_mfma_f32_16x16x32_f16 v[160:163], v[72:75], v[104:107], v[160:163]
    s_waitcnt lgkmcnt(3)
    v_mfma_f32_16x16x32_f16 v[196:199], v[44:47], v[124:127], 0
    ds_read_b128 v[92:95], v248 offset:2016
    v_mfma_f32_16x16x32_f16 v[196:199], v[48:51], v[128:131], v[196:199]
    ds_read_b128 v[96:99], v248 offset:1952
    s_waitcnt lgkmcnt(3)
    v_mfma_f32_16x16x32_f16 v[196:199], v[52:55], v[132:135], v[196:199]
    ds_read_b128 v[100:103], v248 offset:1888
    v_mfma_f32_16x16x32_f16 v[196:199], v[56:59], v[136:139], v[196:199]
    ds_read_b128 v[104:107], v248 offset:1824
    v_mfma_f32_16x16x32_f16 v[196:199], v[76:79], v[108:111], v[196:199]
    v_add_f32_dpp v160, v188, v160 row_ror:8 row_mask:0xf bank_mask:0xf
    v_add_f32_dpp v161, v189, v161 row_ror:8 row_mask:0xf bank_mask:0xf
    v_mfma_f32_16x16x32_f16 v[196:199], v[80:83], v[112:115], v[196:199]
    v_add_f32_dpp v162, v190, v162 row_ror:8 row_mask:0xf bank_mask:0xf
    v_add_f32_dpp v163, v191, v163 row_ror:8 row_mask:0xf bank_mask:0xf
    v_mfma_f32_16x16x32_f16 v[196:199], v[84:87], v[116:119], v[196:199]
    v_cvt_pkrtz_f16_f32 v160, v160, v161
    v_cvt_pkrtz_f16_f32 v161, v162, v163
    v_mfma_f32_16x16x32_f16 v[196:199], v[88:91], v[120:123], v[196:199]
    v_mfma_f32_16x16x32_f16 v[164:167], v[28:31], v[124:127], 0
    ds_write_b64 v251, v[160:161] offset:512
    v_mfma_f32_16x16x32_f16 v[164:167], v[32:35], v[128:131], v[164:167]
    v_mfma_f32_16x16x32_f16 v[164:167], v[36:39], v[132:135], v[164:167]
    v_mfma_f32_16x16x32_f16 v[164:167], v[40:43], v[136:139], v[164:167]
    v_mfma_f32_16x16x32_f16 v[164:167], v[60:63], v[108:111], v[164:167]
    v_mfma_f32_16x16x32_f16 v[164:167], v[64:67], v[112:115], v[164:167]
    s_nop 0
    v_mov_b32_dpp v192, v196 quad_perm:[0,1,2,3] row_mask:0xf bank_mask:0x3
    v_mov_b32_dpp v193, v197 quad_perm:[0,1,2,3] row_mask:0xf bank_mask:0x3
    s_waitcnt lgkmcnt(0)
    s_barrier
    ds_read_b128 v[148:151], v249 offset:0
    ds_read_b128 v[152:155], v249 offset:1024
    v_mfma_f32_16x16x32_f16 v[164:167], v[68:71], v[116:119], v[164:167]
    v_mov_b32_dpp v194, v198 quad_perm:[0,1,2,3] row_mask:0xf bank_mask:0x3
    v_mov_b32_dpp v195, v199 quad_perm:[0,1,2,3] row_mask:0xf bank_mask:0x3
    v_mfma_f32_16x16x32_f16 v[164:167], v[72:75], v[120:123], v[164:167]
    v_mfma_f32_16x16x32_f16 v[188:191], v[44:47], v[92:95], 0
    ds_read_b128 v[108:111], v248 offset:2528
    v_mfma_f32_16x16x32_f16 v[188:191], v[48:51], v[96:99], v[188:191]
    ds_read_b128 v[112:115], v248 offset:2464
    v_mfma_f32_16x16x32_f16 v[188:191], v[52:55], v[100:103], v[188:191]
    ds_read_b128 v[116:119], v248 offset:2400
    v_mfma_f32_16x16x32_f16 v[188:191], v[56:59], v[104:107], v[188:191]
    ds_read_b128 v[120:123], v248 offset:2336
    v_mfma_f32_16x16x32_f16 v[188:191], v[76:79], v[124:127], v[188:191]
    v_add_f32_dpp v164, v192, v164 row_ror:8 row_mask:0xf bank_mask:0xf
    v_add_f32_dpp v165, v193, v165 row_ror:8 row_mask:0xf bank_mask:0xf
    v_mfma_f32_16x16x32_f16 v[188:191], v[80:83], v[128:131], v[188:191]
    v_add_f32_dpp v166, v194, v166 row_ror:8 row_mask:0xf bank_mask:0xf
    v_add_f32_dpp v167, v195, v167 row_ror:8 row_mask:0xf bank_mask:0xf
    v_mfma_f32_16x16x32_f16 v[188:191], v[84:87], v[132:135], v[188:191]
    s_waitcnt lgkmcnt(5)
    v_add_f32 v164, v164, v148
    v_add_f32 v165, v165, v149
    v_mfma_f32_16x16x32_f16 v[188:191], v[88:91], v[136:139], v[188:191]
    v_add_f32 v166, v166, v150
    v_add_f32 v167, v167, v151
    s_waitcnt lgkmcnt(4)
    v_mfma_f32_16x16x32_f16 v[152:155], v[28:31], v[92:95], v[152:155]
    v_cvt_pkrtz_f16_f32 v164, v164, v165
    v_cvt_pkrtz_f16_f32 v165, v166, v167
    v_mfma_f32_16x16x32_f16 v[152:155], v[32:35], v[96:99], v[152:155]
    v_mfma_f32_16x16x32_f16 v[152:155], v[36:39], v[100:103], v[152:155]
    ds_write_b64 v251, v[164:165] offset:1024
    v_mfma_f32_16x16x32_f16 v[152:155], v[40:43], v[104:107], v[152:155]
    v_mfma_f32_16x16x32_f16 v[152:155], v[60:63], v[124:127], v[152:155]
    v_mfma_f32_16x16x32_f16 v[152:155], v[64:67], v[128:131], v[152:155]
    v_mov_b32_dpp v196, v188 quad_perm:[0,1,2,3] row_mask:0xf bank_mask:0x3
    v_mov_b32_dpp v197, v189 quad_perm:[0,1,2,3] row_mask:0xf bank_mask:0x3
    v_mfma_f32_16x16x32_f16 v[152:155], v[68:71], v[132:135], v[152:155]
    v_mov_b32_dpp v198, v190 quad_perm:[0,1,2,3] row_mask:0xf bank_mask:0x3
    v_mov_b32_dpp v199, v191 quad_perm:[0,1,2,3] row_mask:0xf bank_mask:0x3
    v_mfma_f32_16x16x32_f16 v[152:155], v[72:75], v[136:139], v[152:155]
    s_waitcnt lgkmcnt(3)
    v_mfma_f32_16x16x32_f16 v[192:195], v[44:47], v[108:111], 0
    ds_read_b128 v[124:127], v248 offset:3040
    v_mfma_f32_16x16x32_f16 v[192:195], v[48:51], v[112:115], v[192:195]
    ds_read_b128 v[128:131], v248 offset:2976
    s_waitcnt lgkmcnt(3)
    v_mfma_f32_16x16x32_f16 v[192:195], v[52:55], v[116:119], v[192:195]
    ds_read_b128 v[132:135], v248 offset:2912
    v_mfma_f32_16x16x32_f16 v[192:195], v[56:59], v[120:123], v[192:195]
    ds_read_b128 v[136:139], v248 offset:2848
    v_mfma_f32_16x16x32_f16 v[192:195], v[76:79], v[92:95], v[192:195]
    v_add_f32_dpp v152, v196, v152 row_ror:8 row_mask:0xf bank_mask:0xf
    v_add_f32_dpp v153, v197, v153 row_ror:8 row_mask:0xf bank_mask:0xf
    v_mfma_f32_16x16x32_f16 v[192:195], v[80:83], v[96:99], v[192:195]
    v_add_f32_dpp v154, v198, v154 row_ror:8 row_mask:0xf bank_mask:0xf
    v_add_f32_dpp v155, v199, v155 row_ror:8 row_mask:0xf bank_mask:0xf
    v_mfma_f32_16x16x32_f16 v[192:195], v[84:87], v[100:103], v[192:195]
    v_cvt_pkrtz_f16_f32 v152, v152, v153
    v_cvt_pkrtz_f16_f32 v153, v154, v155
    v_mfma_f32_16x16x32_f16 v[192:195], v[88:91], v[104:107], v[192:195]
    v_mfma_f32_16x16x32_f16 v[172:175], v[28:31], v[108:111], 0
    ds_write_b64 v251, v[152:153] offset:1536
    v_mfma_f32_16x16x32_f16 v[172:175], v[32:35], v[112:115], v[172:175]
    v_mfma_f32_16x16x32_f16 v[172:175], v[36:39], v[116:119], v[172:175]
    v_mfma_f32_16x16x32_f16 v[172:175], v[40:43], v[120:123], v[172:175]
    v_mfma_f32_16x16x32_f16 v[172:175], v[60:63], v[92:95], v[172:175]
    v_mfma_f32_16x16x32_f16 v[172:175], v[64:67], v[96:99], v[172:175]
    s_nop 0
    v_mov_b32_dpp v188, v192 quad_perm:[0,1,2,3] row_mask:0xf bank_mask:0x3
    v_mov_b32_dpp v189, v193 quad_perm:[0,1,2,3] row_mask:0xf bank_mask:0x3
    s_waitcnt lgkmcnt(0)
    s_barrier
    ds_read_b128 v[140:143], v249 offset:2048
    ds_read_b128 v[144:147], v249 offset:3072
    v_mfma_f32_16x16x32_f16 v[172:175], v[68:71], v[100:103], v[172:175]
    v_mov_b32_dpp v190, v194 quad_perm:[0,1,2,3] row_mask:0xf bank_mask:0x3
    v_mov_b32_dpp v191, v195 quad_perm:[0,1,2,3] row_mask:0xf bank_mask:0x3
    v_mfma_f32_16x16x32_f16 v[172:175], v[72:75], v[104:107], v[172:175]
    v_mfma_f32_16x16x32_f16 v[196:199], v[44:47], v[124:127], 0
    ds_read_b128 v[92:95], v248 offset:3552
    v_mfma_f32_16x16x32_f16 v[196:199], v[48:51], v[128:131], v[196:199]
    ds_read_b128 v[96:99], v248 offset:3488
    v_mfma_f32_16x16x32_f16 v[196:199], v[52:55], v[132:135], v[196:199]
    ds_read_b128 v[100:103], v248 offset:3424
    v_mfma_f32_16x16x32_f16 v[196:199], v[56:59], v[136:139], v[196:199]
    ds_read_b128 v[104:107], v248 offset:3360
    v_mfma_f32_16x16x32_f16 v[196:199], v[76:79], v[108:111], v[196:199]
    v_add_f32_dpp v172, v188, v172 row_ror:8 row_mask:0xf bank_mask:0xf
    v_add_f32_dpp v173, v189, v173 row_ror:8 row_mask:0xf bank_mask:0xf
    v_mfma_f32_16x16x32_f16 v[196:199], v[80:83], v[112:115], v[196:199]
    v_add_f32_dpp v174, v190, v174 row_ror:8 row_mask:0xf bank_mask:0xf
    v_add_f32_dpp v175, v191, v175 row_ror:8 row_mask:0xf bank_mask:0xf
    v_mfma_f32_16x16x32_f16 v[196:199], v[84:87], v[116:119], v[196:199]
    s_waitcnt lgkmcnt(5)
    v_add_f32 v172, v172, v140
    v_add_f32 v173, v173, v141
    v_mfma_f32_16x16x32_f16 v[196:199], v[88:91], v[120:123], v[196:199]
    v_add_f32 v174, v174, v142
    v_add_f32 v175, v175, v143
    s_waitcnt lgkmcnt(4)
    v_mfma_f32_16x16x32_f16 v[144:147], v[28:31], v[124:127], v[144:147]
    v_cvt_pkrtz_f16_f32 v172, v172, v173
    v_cvt_pkrtz_f16_f32 v173, v174, v175
    v_mfma_f32_16x16x32_f16 v[144:147], v[32:35], v[128:131], v[144:147]
    v_mfma_f32_16x16x32_f16 v[144:147], v[36:39], v[132:135], v[144:147]
    ds_write_b64 v251, v[172:173] offset:2048
    v_mfma_f32_16x16x32_f16 v[144:147], v[40:43], v[136:139], v[144:147]
    v_mfma_f32_16x16x32_f16 v[144:147], v[60:63], v[108:111], v[144:147]
    v_mfma_f32_16x16x32_f16 v[144:147], v[64:67], v[112:115], v[144:147]
    v_mov_b32_dpp v192, v196 quad_perm:[0,1,2,3] row_mask:0xf bank_mask:0x3
    v_mov_b32_dpp v193, v197 quad_perm:[0,1,2,3] row_mask:0xf bank_mask:0x3
    v_mfma_f32_16x16x32_f16 v[144:147], v[68:71], v[116:119], v[144:147]
    v_mov_b32_dpp v194, v198 quad_perm:[0,1,2,3] row_mask:0xf bank_mask:0x3
    v_mov_b32_dpp v195, v199 quad_perm:[0,1,2,3] row_mask:0xf bank_mask:0x3
    v_mfma_f32_16x16x32_f16 v[144:147], v[72:75], v[120:123], v[144:147]
    s_waitcnt lgkmcnt(3)
    v_mfma_f32_16x16x32_f16 v[188:191], v[44:47], v[92:95], 0
    ds_read_b128 v[108:111], v248 offset:4064
    v_mfma_f32_16x16x32_f16 v[188:191], v[48:51], v[96:99], v[188:191]
    ds_read_b128 v[112:115], v248 offset:4000
    s_waitcnt lgkmcnt(3)
    v_mfma_f32_16x16x32_f16 v[188:191], v[52:55], v[100:103], v[188:191]
    ds_read_b128 v[116:119], v248 offset:3936
    v_mfma_f32_16x16x32_f16 v[188:191], v[56:59], v[104:107], v[188:191]
    ds_read_b128 v[120:123], v248 offset:3872
    v_mfma_f32_16x16x32_f16 v[188:191], v[76:79], v[124:127], v[188:191]
    v_add_f32_dpp v144, v192, v144 row_ror:8 row_mask:0xf bank_mask:0xf
    v_add_f32_dpp v145, v193, v145 row_ror:8 row_mask:0xf bank_mask:0xf
    v_mfma_f32_16x16x32_f16 v[188:191], v[80:83], v[128:131], v[188:191]
    v_add_f32_dpp v146, v194, v146 row_ror:8 row_mask:0xf bank_mask:0xf
    v_add_f32_dpp v147, v195, v147 row_ror:8 row_mask:0xf bank_mask:0xf
    v_mfma_f32_16x16x32_f16 v[188:191], v[84:87], v[132:135], v[188:191]
    v_cvt_pkrtz_f16_f32 v144, v144, v145
    v_cvt_pkrtz_f16_f32 v145, v146, v147
    v_mfma_f32_16x16x32_f16 v[188:191], v[88:91], v[136:139], v[188:191]
    v_mfma_f32_16x16x32_f16 v[180:183], v[28:31], v[92:95], 0
    ds_write_b64 v251, v[144:145] offset:2560
    v_mfma_f32_16x16x32_f16 v[180:183], v[32:35], v[96:99], v[180:183]
    v_mfma_f32_16x16x32_f16 v[180:183], v[36:39], v[100:103], v[180:183]
    v_mfma_f32_16x16x32_f16 v[180:183], v[40:43], v[104:107], v[180:183]
    v_mfma_f32_16x16x32_f16 v[180:183], v[60:63], v[124:127], v[180:183]
    s_waitcnt lgkmcnt(0)
    s_barrier
    ds_read_b128 v[148:151], v249 offset:4096
    ds_read_b128 v[152:155], v249 offset:5120
    v_mfma_f32_16x16x32_f16 v[180:183], v[64:67], v[128:131], v[180:183]
    v_mov_b32_dpp v196, v188 quad_perm:[0,1,2,3] row_mask:0xf bank_mask:0x3
    v_mov_b32_dpp v197, v189 quad_perm:[0,1,2,3] row_mask:0xf bank_mask:0x3
    v_mfma_f32_16x16x32_f16 v[180:183], v[68:71], v[132:135], v[180:183]
    v_mov_b32_dpp v198, v190 quad_perm:[0,1,2,3] row_mask:0xf bank_mask:0x3
    v_mov_b32_dpp v199, v191 quad_perm:[0,1,2,3] row_mask:0xf bank_mask:0x3
    v_mfma_f32_16x16x32_f16 v[180:183], v[72:75], v[136:139], v[180:183]
    v_mfma_f32_16x16x32_f16 v[192:195], v[44:47], v[108:111], 0
    v_mfma_f32_16x16x32_f16 v[192:195], v[48:51], v[112:115], v[192:195]
    v_mfma_f32_16x16x32_f16 v[192:195], v[52:55], v[116:119], v[192:195]
    v_mfma_f32_16x16x32_f16 v[192:195], v[56:59], v[120:123], v[192:195]
    v_mfma_f32_16x16x32_f16 v[192:195], v[76:79], v[92:95], v[192:195]
    v_mfma_f32_16x16x32_f16 v[192:195], v[80:83], v[96:99], v[192:195]
    s_nop 1
    v_add_f32_dpp v180, v196, v180 row_ror:8 row_mask:0xf bank_mask:0xf
    v_add_f32_dpp v181, v197, v181 row_ror:8 row_mask:0xf bank_mask:0xf
    v_mfma_f32_16x16x32_f16 v[192:195], v[84:87], v[100:103], v[192:195]
    v_add_f32_dpp v182, v198, v182 row_ror:8 row_mask:0xf bank_mask:0xf
    v_add_f32_dpp v183, v199, v183 row_ror:8 row_mask:0xf bank_mask:0xf
    v_mfma_f32_16x16x32_f16 v[192:195], v[88:91], v[104:107], v[192:195]
    s_waitcnt lgkmcnt(1)
    v_add_f32 v180, v180, v148
    v_add_f32 v181, v181, v149
    s_waitcnt lgkmcnt(0)
    v_mfma_f32_16x16x32_f16 v[152:155], v[28:31], v[108:111], v[152:155]
    v_add_f32 v182, v182, v150
    v_add_f32 v183, v183, v151
    v_mfma_f32_16x16x32_f16 v[152:155], v[32:35], v[112:115], v[152:155]
    v_cvt_pkrtz_f16_f32 v180, v180, v181
    v_cvt_pkrtz_f16_f32 v181, v182, v183
    v_mfma_f32_16x16x32_f16 v[152:155], v[36:39], v[116:119], v[152:155]
    v_mfma_f32_16x16x32_f16 v[152:155], v[40:43], v[120:123], v[152:155]
    ds_write_b64 v251, v[180:181] offset:3072
    s_waitcnt lgkmcnt(0)
    s_barrier
    v_mfma_f32_16x16x32_f16 v[152:155], v[60:63], v[92:95], v[152:155]
    v_mfma_f32_16x16x32_f16 v[152:155], v[64:67], v[96:99], v[152:155]
    v_mov_b32_dpp v188, v192 quad_perm:[0,1,2,3] row_mask:0xf bank_mask:0x3
    v_mov_b32_dpp v189, v193 quad_perm:[0,1,2,3] row_mask:0xf bank_mask:0x3
    v_mfma_f32_16x16x32_f16 v[152:155], v[68:71], v[100:103], v[152:155]
    v_mov_b32_dpp v190, v194 quad_perm:[0,1,2,3] row_mask:0xf bank_mask:0x3
    v_mov_b32_dpp v191, v195 quad_perm:[0,1,2,3] row_mask:0xf bank_mask:0x3
    v_mfma_f32_16x16x32_f16 v[152:155], v[72:75], v[104:107], v[152:155]
    s_nop 7
    v_add_f32_dpp v152, v188, v152 row_ror:8 row_mask:0xf bank_mask:0xf
    v_add_f32_dpp v153, v189, v153 row_ror:8 row_mask:0xf bank_mask:0xf
    v_add_f32_dpp v154, v190, v154 row_ror:8 row_mask:0xf bank_mask:0xf
    v_add_f32_dpp v155, v191, v155 row_ror:8 row_mask:0xf bank_mask:0xf
    v_cvt_pkrtz_f16_f32 v152, v152, v153
    v_cvt_pkrtz_f16_f32 v153, v154, v155
    ds_write_b64 v251, v[152:153] offset:3584
    s_waitcnt lgkmcnt(0)
    s_barrier
    s_waitcnt vmcnt(0)
    s_branch RPREP
H_PATH:
    s_waitcnt lgkmcnt(0)
    s_barrier
    v_and_b32 v14, 15, v1
    v_lshrrev_b32 v15, 4, v1
    s_mul_i32 s46, s51, 4640
    s_add_u32 s46, s46, 114048
    v_lshlrev_b32 v248, 5, v14
    v_lshl_add_u32 v248, v15, 4, v248
    v_add_u32 v248, s46, v248
    s_mul_i32 s46, s51, 6144
    s_add_u32 s46, s46, 20480
    v_add_u32 v249, s46, v2
    v_lshlrev_b32 v250, 3, v15
    v_sub_u32 v250, v250, v14
    v_add_u32 v250, 15, v250
    v_and_b32 v34, 1, v250
    v_mul_u32_u24 v34, 1090, v34
    v_lshl_add_u32 v250, v250, 1, v34
    v_add_u32 v250, s62, v250
    v_lshlrev_b32 v251, 2, v15
    v_sub_u32 v251, v251, v14
    v_lshlrev_b32 v251, 2, v251
    s_add_u32 s46, s62, 2252
    v_add_u32 v251, s46, v251
    v_bfe_u32 v34, v1, 2, 2
    v_mul_u32_u24 v34, 4128, v34
    v_and_b32 v35, 1, v1
    v_lshl_add_u32 v34, v35, 7, v34
    v_lshl_add_u32 v34, v15, 4, v34
    v_and_b32 v35, 2, v1
    v_lshl_add_u32 v34, v35, 2, v34
    s_and_b32 s46, s3, 1
    s_lshl_b32 s46, s46, 6
    v_add_u32 v252, s46, v34
    v_lshrrev_b32 v34, 3, v1
    v_mul_u32_u24 v34, 18432, v34
    v_and_b32 v35, 7, v1
    v_lshl_add_u32 v253, v35, 4, v34
    s_and_b32 s46, s3, 1
    s_mul_i32 s46, s46, 147456
    s_lshl_b32 s63, s2, 7
    s_add_u32 s63, s63, s46
    s_add_u32 s63, s63, 4194304
    v_and_b32 v34, 3, v1
    v_mul_u32_u24 v34, 4640, v34
    v_lshrrev_b32 v35, 2, v1
    v_lshl_add_u32 v34, v35, 4, v34
    s_mul_i32 s46, s51, 768
    s_add_u32 s46, s46, 114560
    v_add_u32 v254, s46, v34
    s_cmp_lt_u32 s49, 128
    s_cbranch_scc1 H_UI
    v_subrev_u32 v14, 9472, v25
    v_subrev_u32 v15, 9472, v26
    ds_read_b128 v[120:123], v14
    ds_read_b128 v[124:127], v14 offset:512
    ds_read_b32 v128, v15 offset:1024
    s_mov_b32 s46, 10485760
    s_waitcnt lgkmcnt(0)
    v_add_u32 v120, v11, v120
    v_add_u32 v121, v11, v121
    v_add_u32 v122, v11, v122
    v_add_u32 v123, v11, v123
    v_add_u32 v124, v11, v124
    v_add_u32 v125, v11, v125
    v_add_u32 v126, v11, v126
    v_add_u32 v127, v11, v127
    v_add_u32 v128, v11, v128
    v_and_or_b32 v120, v120, v9, v10
    v_and_or_b32 v121, v121, v9, v10
    v_and_or_b32 v122, v122, v9, v10
    v_and_or_b32 v123, v123, v9, v10
    v_and_or_b32 v124, v124, v9, v10
    v_and_or_b32 v125, v125, v9, v10
    v_and_or_b32 v126, v126, v9, v10
    v_and_or_b32 v127, v127, v9, v10
    v_and_or_b32 v128, v128, v9, v10
    buffer_store_dwordx4 v[120:123], v4, s[32:35], s46 offen sc1
    buffer_store_dwordx4 v[124:127], v4, s[32:35], s46 offen offset:512 sc1
    buffer_store_dword v128, v5, s[32:35], s46 offen offset:1024 sc1
H_UI:
    s_mov_b32 s47, 0
PL2:
    s_waitcnt vmcnt(0)
    v_xor_b32 v200, v10, v200
    v_xor_b32 v201, v10, v201
    v_xor_b32 v202, v10, v202
    v_xor_b32 v203, v10, v203
    v_xor_b32 v204, v10, v204
    v_xor_b32 v205, v10, v205
    v_xor_b32 v206, v10, v206
    v_xor_b32 v207, v10, v207
    v_xor_b32 v208, v10, v208
    v_xor_b32 v209, v10, v209
    v_xor_b32 v210, v10, v210
    v_xor_b32 v211, v10, v211
    v_or3_b32 v14, v200, v201, v202
    v_or3_b32 v14, v14, v203, v204
    v_or3_b32 v14, v14, v205, v206
    v_or3_b32 v14, v14, v207, v208
    v_or3_b32 v14, v14, v209, v210
    v_or_b32 v14, v14, v211
    v_and_b32 v14, 0x70007, v14
    v_cmp_ne_u32 vcc, 0, v14
    s_cbranch_vccz PD3
    s_add_u32 s47, s47, 1
    s_cmp_ge_u32 s47, 65536
    s_cbranch_scc1 PD3
    s_sleep 2
    buffer_load_dwordx4 v[200:203], v2, s[32:35], s48 offen offset:0 sc1
    buffer_load_dwordx4 v[204:207], v2, s[32:35], s48 offen offset:1024 sc1
    buffer_load_dwordx4 v[208:211], v2, s[32:35], s48 offen offset:2048 sc1
    s_branch PL2
PD3:
    ds_write_b128 v254, v[200:203] offset:0
    ds_write_b128 v254, v[204:207] offset:256
    ds_write_b128 v254, v[208:211] offset:512
    buffer_load_dwordx4 v[244:247], v2, s[32:35], s59 offen sc1
    s_lshl_b32 s46, s51, 9
    v_subrev_u32 v254, s46, v254
    v_mov_b32 v15, s62
    s_setprio 1
    s_waitcnt lgkmcnt(0)
    s_barrier
    ds_read_b128 v[28:31], v248 offset:480
    ds_read_b128 v[32:35], v248 offset:464
    ds_read_b128 v[36:39], v248 offset:992
    ds_read_b128 v[40:43], v248 offset:976
    s_waitcnt lgkmcnt(3)
    v_mfma_f32_16x16x32_f16 v[76:79], v[28:31], v[172:175], 0
    v_mfma_f32_16x16x32_f16 v[80:83], v[28:31], v[168:171], 0
    v_mfma_f32_16x16x32_f16 v[88:91], v[28:31], v[176:179], 0
    s_waitcnt lgkmcnt(2)
    v_mfma_f32_16x16x32_f16 v[84:87], v[32:35], v[180:183], 0
    ds_read_b128 v[44:47], v248 offset:1504
    ds_read_b128 v[48:51], v248 offset:1488
    v_mfma_f32_16x16x32_f16 v[92:95], v[28:31], v[184:187], 0
    s_nop 1
    v_cvt_pk_f16_f32 v100, v76, v80
    v_cvt_pk_f16_f32 v101, v77, v81
    v_mfma_f32_16x16x32_f16 v[96:99], v[32:35], v[188:191], 0
    v_cvt_pk_f16_f32 v102, v78, v82
    v_cvt_pk_f16_f32 v103, v79, v83
    s_waitcnt lgkmcnt(3)
    v_mfma_f32_16x16x32_f16 v[76:79], v[36:39], v[172:175], 0
    v_cvt_pk_f16_f32 v104, v84, v88
    v_cvt_pk_f16_f32 v105, v85, v89
    v_mfma_f32_16x16x32_f16 v[80:83], v[36:39], v[168:171], 0
    v_cvt_pk_f16_f32 v106, v86, v90
    v_cvt_pk_f16_f32 v107, v87, v91
    v_mfma_f32_16x16x32_f16 v[88:91], v[36:39], v[176:179], 0
    v_cvt_pk_f16_f32 v148, v92, v96
    v_cvt_pk_f16_f32 v149, v93, v97
    s_waitcnt lgkmcnt(2)
    v_mfma_f32_16x16x32_f16 v[84:87], v[40:43], v[180:183], 0
    v_cvt_pk_f16_f32 v150, v94, v98
    v_cvt_pk_f16_f32 v151, v95, v99
    ds_read_b128 v[52:55], v248 offset:2016
    ds_read_b128 v[56:59], v248 offset:2000
    v_mfma_f32_16x16x32_f16 v[92:95], v[36:39], v[184:187], 0
    v_cvt_pk_f16_f32 v108, v76, v80
    v_cvt_pk_f16_f32 v109, v77, v81
    v_mfma_f32_16x16x32_f16 v[96:99], v[40:43], v[188:191], 0
    v_cvt_pk_f16_f32 v110, v78, v82
    v_cvt_pk_f16_f32 v111, v79, v83
    s_waitcnt lgkmcnt(3)
    v_mfma_f32_16x16x32_f16 v[76:79], v[44:47], v[172:175], 0
    v_cvt_pk_f16_f32 v112, v84, v88
    v_cvt_pk_f16_f32 v113, v85, v89
    v_mfma_f32_16x16x32_f16 v[80:83], v[44:47], v[168:171], 0
    v_cvt_pk_f16_f32 v114, v86, v90
    v_cvt_pk_f16_f32 v115, v87, v91
    ds_read_b128 v[60:63], v248 offset:2528
    ds_read_b128 v[64:67], v248 offset:2512
    v_mfma_f32_16x16x32_f16 v[88:91], v[44:47], v[176:179], 0
    v_cvt_pk_f16_f32 v152, v92, v96
    v_cvt_pk_f16_f32 v153, v93, v97
    s_waitcnt lgkmcnt(4)
    v_mfma_f32_16x16x32_f16 v[84:87], v[48:51], v[180:183], 0
    v_cvt_pk_f16_f32 v154, v94, v98
    v_cvt_pk_f16_f32 v155, v95, v99
    v_mfma_f32_16x16x32_f16 v[92:95], v[44:47], v[184:187], 0
    v_cvt_pk_f16_f32 v116, v76, v80
    v_cvt_pk_f16_f32 v117, v77, v81
    v_mfma_f32_16x16x32_f16 v[96:99], v[48:51], v[188:191], 0
    v_cvt_pk_f16_f32 v118, v78, v82
    v_cvt_pk_f16_f32 v119, v79, v83
    ds_read_b128 v[68:71], v248 offset:3040
    ds_read_b128 v[72:75], v248 offset:3024
    s_waitcnt lgkmcnt(5)
    v_mfma_f32_16x16x32_f16 v[76:79], v[52:55], v[172:175], 0
    v_cvt_pk_f16_f32 v120, v84, v88
    v_cvt_pk_f16_f32 v121, v85, v89
    v_mfma_f32_16x16x32_f16 v[80:83], v[52:55], v[168:171], 0
    v_cvt_pk_f16_f32 v122, v86, v90
    v_cvt_pk_f16_f32 v123, v87, v91
    v_mfma_f32_16x16x32_f16 v[88:91], v[52:55], v[176:179], 0
    v_cvt_pk_f16_f32 v156, v92, v96
    v_cvt_pk_f16_f32 v157, v93, v97
    s_waitcnt lgkmcnt(4)
    v_mfma_f32_16x16x32_f16 v[84:87], v[56:59], v[180:183], 0
    v_cvt_pk_f16_f32 v158, v94, v98
    v_cvt_pk_f16_f32 v159, v95, v99
    ds_read2_b32 v[196:197], v250 offset0:0 offset1:1
    ds_read2_b32 v[198:199], v250 offset0:2 offset1:3
    v_mfma_f32_16x16x32_f16 v[92:95], v[52:55], v[184:187], 0
    v_cvt_pk_f16_f32 v124, v76, v80
    v_cvt_pk_f16_f32 v125, v77, v81
    v_mfma_f32_16x16x32_f16 v[96:99], v[56:59], v[188:191], 0
    v_cvt_pk_f16_f32 v126, v78, v82
    v_cvt_pk_f16_f32 v127, v79, v83
    ds_read2_b32 v[200:201], v251 offset0:32 offset1:33
    ds_read2_b32 v[202:203], v251 offset0:34 offset1:35
    s_waitcnt lgkmcnt(7)
    v_mfma_f32_16x16x32_f16 v[76:79], v[60:63], v[172:175], 0
    v_cvt_pk_f16_f32 v128, v84, v88
    v_cvt_pk_f16_f32 v129, v85, v89
    v_mfma_f32_16x16x32_f16 v[80:83], v[60:63], v[168:171], 0
    v_cvt_pk_f16_f32 v130, v86, v90
    v_cvt_pk_f16_f32 v131, v87, v91
    ds_read2_b32 v[204:205], v251 offset0:80 offset1:81
    ds_read2_b32 v[206:207], v251 offset0:82 offset1:83
    v_mfma_f32_16x16x32_f16 v[88:91], v[60:63], v[176:179], 0
    v_cvt_pk_f16_f32 v160, v92, v96
    v_cvt_pk_f16_f32 v161, v93, v97
    s_waitcnt lgkmcnt(8)
    v_mfma_f32_16x16x32_f16 v[84:87], v[64:67], v[180:183], 0
    v_cvt_pk_f16_f32 v162, v94, v98
    v_cvt_pk_f16_f32 v163, v95, v99
    ds_read2_b32 v[208:209], v251 offset0:16 offset1:17
    ds_read2_b32 v[210:211], v251 offset0:18 offset1:19
    s_waitcnt lgkmcnt(9)
    v_mfma_f32_16x16x32_f16 v[92:95], v[68:71], v[172:175], 0
    v_cvt_pk_f16_f32 v132, v76, v80
    v_cvt_pk_f16_f32 v133, v77, v81
    v_mfma_f32_16x16x32_f16 v[96:99], v[68:71], v[168:171], 0
    v_cvt_pk_f16_f32 v134, v78, v82
    v_cvt_pk_f16_f32 v135, v79, v83
    ds_read2_b32 v[212:213], v251 offset0:64 offset1:65
    ds_read2_b32 v[214:215], v251 offset0:66 offset1:67
    v_mfma_f32_16x16x32_f16 v[80:83], v[68:71], v[176:179], 0
    v_cvt_pk_f16_f32 v136, v84, v88
    v_cvt_pk_f16_f32 v137, v85, v89
    s_waitcnt lgkmcnt(10)
    v_mfma_f32_16x16x32_f16 v[76:79], v[72:75], v[180:183], 0
    v_cvt_pk_f16_f32 v138, v86, v90
    v_cvt_pk_f16_f32 v139, v87, v91
    ds_read_u16 v15, v15 offset:2448
    s_waitcnt lgkmcnt(9)
    v_mfma_f32_16x16x32_f16 v[164:167], v[196:199], v[28:31], 0
    v_cvt_pk_f16_f32 v140, v92, v96
    v_cvt_pk_f16_f32 v141, v93, v97
    s_waitcnt lgkmcnt(7)
    v_mfma_f32_16x16x32_f16 v[164:167], v[100:103], v[200:203], v[164:167]
    v_cvt_pk_f16_f32 v142, v94, v98
    v_cvt_pk_f16_f32 v143, v95, v99
    s_waitcnt lgkmcnt(5)
    v_mfma_f32_16x16x32_f16 v[164:167], v[104:107], v[204:207], v[164:167]
    v_cvt_pk_f16_f32 v144, v76, v80
    v_cvt_pk_f16_f32 v145, v77, v81
    v_mfma_f32_16x16x32_f16 v[240:243], v[196:199], v[36:39], 0
    v_cvt_pk_f16_f32 v146, v78, v82
    v_cvt_pk_f16_f32 v147, v79, v83
    v_mfma_f32_16x16x32_f16 v[240:243], v[108:111], v[200:203], v[240:243]
    s_waitcnt lgkmcnt(0)
    v_lshl_or_b32 v15, v15, 16, v15
    v_and_b32 v192, v15, v192
    v_and_b32 v193, v15, v193
    v_and_b32 v194, v15, v194
    v_and_b32 v195, v15, v195
    v_mfma_f32_16x16x32_f16 v[240:243], v[112:115], v[204:207], v[240:243]
    ds_read2_b32 v[216:217], v251 offset0:0 offset1:1
    ds_read2_b32 v[218:219], v251 offset0:2 offset1:3
    v_mfma_f32_16x16x32_f16 v[240:243], v[100:103], v[208:211], v[240:243]
    ds_read2_b32 v[220:221], v251 offset0:48 offset1:49
    ds_read2_b32 v[222:223], v251 offset0:50 offset1:51
    v_mfma_f32_16x16x32_f16 v[240:243], v[104:107], v[212:215], v[240:243]
    ds_write_b128 v249, v[164:167] offset:0
    ds_read2_b32 v[224:225], v251 offset0:160 offset1:161
    ds_read2_b32 v[226:227], v251 offset0:162 offset1:163
    s_mov_b32 s47, 0
PL4:
    s_waitcnt vmcnt(0)
    v_xor_b32 v244, v10, v244
    v_xor_b32 v245, v10, v245
    v_xor_b32 v246, v10, v246
    v_xor_b32 v247, v10, v247
    v_or3_b32 v14, v244, v245, v246
    v_or_b32 v14, v14, v247
    v_and_b32 v14, 0x70007, v14
    v_cmp_ne_u32 vcc, 0, v14
    s_cbranch_vccz PD5
    s_add_u32 s47, s47, 1
    s_cmp_ge_u32 s47, 65536
    s_cbranch_scc1 PD5
    s_sleep 2
    buffer_load_dwordx4 v[244:247], v2, s[32:35], s59 offen sc1
    s_branch PL4
PD5:
    ds_write_b128 v254, v[244:247] offset:3072
    s_bitcmp1_b32 s3, 1
    s_cselect_b32 s46, 1, 0
    s_lshl_b32 s50, s46, 9
    v_add_u32 v15, s50, v252
    s_mul_i32 s46, s46, 294912
    s_add_u32 s46, s46, s63
    ds_write_b128 v249, v[240:243] offset:1024
    s_waitcnt lgkmcnt(0)
    s_barrier
    ds_read_b64_tr_b16 v[244:245], v15 offset:0
    ds_read_b64_tr_b16 v[246:247], v15 offset:256
    v_mfma_f32_16x16x32_f16 v[164:167], v[196:199], v[44:47], 0
    ds_read2_b32 v[228:229], v251 offset0:144 offset1:145
    ds_read2_b32 v[230:231], v251 offset0:146 offset1:147
    v_mfma_f32_16x16x32_f16 v[164:167], v[116:119], v[200:203], v[164:167]
    ds_read2_b32 v[232:233], v251 offset0:128 offset1:129
    ds_read2_b32 v[234:235], v251 offset0:130 offset1:131
    v_mfma_f32_16x16x32_f16 v[164:167], v[120:123], v[204:207], v[164:167]
    s_mov_b32 s57, 10485760
    buffer_load_dwordx4 v[72:75], v4, s[32:35], s57 offen sc1
    buffer_load_dwordx4 v[76:79], v4, s[32:35], s57 offen offset:512 sc1
    buffer_load_dword v80, v5, s[32:35], s57 offen offset:1024 sc1
    global_load_dwordx4 v[16:19], v4, s[4:5]
    global_load_dwordx4 v[20:23], v4, s[4:5] offset:512
    global_load_dword v24, v5, s[4:5] offset:1024
    v_mfma_f32_16x16x32_f16 v[164:167], v[108:111], v[208:211], v[164:167]
    ds_read2_b32 v[236:237], v251 offset0:112 offset1:113
    ds_read2_b32 v[238:239], v251 offset0:114 offset1:115
    v_mfma_f32_16x16x32_f16 v[164:167], v[112:115], v[212:215], v[164:167]
    s_lshl_b32 s57, s51, 6
    v_add_u32 v14, s57, v1
    v_min_u32 v14, 143, v14
    v_lshlrev_b32 v27, 7, v14
    v_lshlrev_b32 v14, 4, v14
    s_mov_b32 s53, 32768
    buffer_load_dwordx4 v[32:35], v27, s[32:35], s53 offen sc1
    v_mfma_f32_16x16x32_f16 v[164:167], v[100:103], v[216:219], v[164:167]
    v_mfma_f32_16x16x32_f16 v[164:167], v[104:107], v[220:223], v[164:167]
    s_waitcnt lgkmcnt(6)
    v_add_u32 v244, v11, v244
    v_add_u32 v245, v11, v245
    v_add_u32 v246, v11, v246
    v_add_u32 v247, v11, v247
    v_and_or_b32 v244, v244, v9, v10
    v_and_or_b32 v245, v245, v9, v10
    v_and_or_b32 v246, v246, v9, v10
    v_and_or_b32 v247, v247, v9, v10
    buffer_store_dwordx4 v[244:247], v253, s[32:35], s46 offen sc1
    v_mfma_f32_16x16x32_f16 v[164:167], v[192:195], v[28:31], v[164:167]
    v_mfma_f32_16x16x32_f16 v[164:167], v[148:151], v[224:227], v[164:167]
    v_mfma_f32_16x16x32_f16 v[240:243], v[196:199], v[52:55], 0
    v_mfma_f32_16x16x32_f16 v[240:243], v[124:127], v[200:203], v[240:243]
    v_mfma_f32_16x16x32_f16 v[240:243], v[128:131], v[204:207], v[240:243]
    v_mfma_f32_16x16x32_f16 v[240:243], v[116:119], v[208:211], v[240:243]
    v_mfma_f32_16x16x32_f16 v[240:243], v[120:123], v[212:215], v[240:243]
    v_mfma_f32_16x16x32_f16 v[240:243], v[108:111], v[216:219], v[240:243]
    v_mfma_f32_16x16x32_f16 v[240:243], v[112:115], v[220:223], v[240:243]
    v_mfma_f32_16x16x32_f16 v[240:243], v[192:195], v[36:39], v[240:243]
    ds_write_b128 v249, v[164:167] offset:2048
    v_mfma_f32_16x16x32_f16 v[240:243], v[152:155], v[224:227], v[240:243]
    s_waitcnt lgkmcnt(5)
    v_mfma_f32_16x16x32_f16 v[240:243], v[148:151], v[228:231], v[240:243]
    v_mfma_f32_16x16x32_f16 v[164:167], v[196:199], v[60:63], 0
    v_mfma_f32_16x16x32_f16 v[164:167], v[132:135], v[200:203], v[164:167]
    v_mfma_f32_16x16x32_f16 v[164:167], v[136:139], v[204:207], v[164:167]
    v_mfma_f32_16x16x32_f16 v[164:167], v[124:127], v[208:211], v[164:167]
    v_mfma_f32_16x16x32_f16 v[164:167], v[128:131], v[212:215], v[164:167]
    v_mfma_f32_16x16x32_f16 v[164:167], v[116:119], v[216:219], v[164:167]
    v_mfma_f32_16x16x32_f16 v[164:167], v[120:123], v[220:223], v[164:167]
    v_mfma_f32_16x16x32_f16 v[164:167], v[192:195], v[44:47], v[164:167]
    ds_write_b128 v249, v[240:243] offset:3072
    v_mfma_f32_16x16x32_f16 v[164:167], v[156:159], v[224:227], v[164:167]
    v_mfma_f32_16x16x32_f16 v[164:167], v[152:155], v[228:231], v[164:167]
    s_waitcnt lgkmcnt(4)
    v_mfma_f32_16x16x32_f16 v[164:167], v[148:151], v[232:235], v[164:167]
    v_mfma_f32_16x16x32_f16 v[240:243], v[196:199], v[68:71], 0
    v_mfma_f32_16x16x32_f16 v[240:243], v[140:143], v[200:203], v[240:243]
    v_mfma_f32_16x16x32_f16 v[240:243], v[144:147], v[204:207], v[240:243]
    v_mfma_f32_16x16x32_f16 v[240:243], v[132:135], v[208:211], v[240:243]
    v_mfma_f32_16x16x32_f16 v[240:243], v[136:139], v[212:215], v[240:243]
    v_mfma_f32_16x16x32_f16 v[240:243], v[124:127], v[216:219], v[240:243]
    v_mfma_f32_16x16x32_f16 v[240:243], v[128:131], v[220:223], v[240:243]
    v_mfma_f32_16x16x32_f16 v[240:243], v[192:195], v[52:55], v[240:243]
    ds_write_b128 v249, v[164:167] offset:4096
    v_mfma_f32_16x16x32_f16 v[240:243], v[160:163], v[224:227], v[240:243]
    v_mfma_f32_16x16x32_f16 v[240:243], v[156:159], v[228:231], v[240:243]
    v_mfma_f32_16x16x32_f16 v[240:243], v[152:155], v[232:235], v[240:243]
    s_waitcnt lgkmcnt(3)
    v_mfma_f32_16x16x32_f16 v[240:243], v[148:151], v[236:239], v[240:243]
    s_bitcmp1_b32 s3, 1
    s_cselect_b32 s46, 3, 2
    s_lshl_b32 s50, s46, 9
    v_add_u32 v15, s50, v252
    s_mul_i32 s46, s46, 294912
    s_add_u32 s46, s46, s63
    s_nop 1
    ds_write_b128 v249, v[240:243] offset:5120
    s_waitcnt lgkmcnt(0)
    s_barrier
    ds_read_b64_tr_b16 v[244:245], v15 offset:0
    ds_read_b64_tr_b16 v[246:247], v15 offset:256
    s_waitcnt lgkmcnt(0)
    v_add_u32 v244, v11, v244
    v_add_u32 v245, v11, v245
    v_add_u32 v246, v11, v246
    v_add_u32 v247, v11, v247
    v_and_or_b32 v244, v244, v9, v10
    v_and_or_b32 v245, v245, v9, v10
    v_and_or_b32 v246, v246, v9, v10
    v_and_or_b32 v247, v247, v9, v10
    buffer_store_dwordx4 v[244:247], v253, s[32:35], s46 offen sc1
    s_setprio 0
    s_and_b32 s56, s40, 0x7fffff
    s_mov_b32 s47, 0
    s_waitcnt vmcnt(2)
SCP6:
    v_xor_b32 v32, s56, v32
    v_xor_b32 v33, s56, v33
    v_xor_b32 v34, s56, v34
    v_xor_b32 v35, s56, v35
    v_or3_b32 v255, v32, v33, v34
    v_or_b32 v255, v255, v35
    v_and_b32 v255, 0x7fffff, v255
    v_cmp_ne_u32 vcc, 0, v255
    s_cbranch_vccz SCD7
    s_add_u32 s47, s47, 1
    s_cmp_ge_u32 s47, 65536
    s_cbranch_scc1 SCD7
    s_sleep 8
    buffer_load_dwordx4 v[32:35], v27, s[32:35], s53 offen sc1
    s_waitcnt vmcnt(0)
    s_branch SCP6
SCD7:
    ds_write_b128 v14, v[32:35] offset:46080
    s_cmp_ge_u32 s49, 128
    s_cbranch_scc1 H_NOR
    global_load_dwordx4 v[208:211], v12, s[16:17]
    global_load_dwordx4 v[212:215], v12, s[16:17] offset:512
    global_load_dword v216, v13, s[16:17] offset:1024
    global_load_dwordx4 v[218:221], v12, s[20:21]
    global_load_dwordx4 v[222:225], v12, s[20:21] offset:512
    global_load_dword v226, v13, s[20:21] offset:1024
H_NOR:
    s_bitcmp1_b32 s3, 1
    s_cselect_b32 s46, 5, 4
    s_lshl_b32 s50, s46, 9
    v_add_u32 v15, s50, v252
    s_mul_i32 s46, s46, 294912
    s_add_u32 s46, s46, s63
    s_waitcnt lgkmcnt(0)
    s_barrier
    ds_read_b64_tr_b16 v[244:245], v15 offset:0
    ds_read_b64_tr_b16 v[246:247], v15 offset:256
    s_waitcnt lgkmcnt(0)
    v_add_u32 v244, v11, v244
    v_add_u32 v245, v11, v245
    v_add_u32 v246, v11, v246
    v_add_u32 v247, v11, v247
    v_and_or_b32 v244, v244, v9, v10
    v_and_or_b32 v245, v245, v9, v10
    v_and_or_b32 v246, v246, v9, v10
    v_and_or_b32 v247, v247, v9, v10
    buffer_store_dwordx4 v[244:247], v253, s[32:35], s46 offen sc1
    s_add_u32 s46, s63, 1769472
    s_bitcmp1_b32 s3, 1
    s_waitcnt lgkmcnt(0)
    s_barrier
    s_cbranch_scc1 YS8
    ds_read_b64_tr_b16 v[244:245], v252 offset:3072
    ds_read_b64_tr_b16 v[246:247], v252 offset:3328
    s_waitcnt lgkmcnt(0)
    v_add_u32 v244, v11, v244
    v_add_u32 v245, v11, v245
    v_add_u32 v246, v11, v246
    v_add_u32 v247, v11, v247
    v_and_or_b32 v244, v244, v9, v10
    v_and_or_b32 v245, v245, v9, v10
    v_and_or_b32 v246, v246, v9, v10
    v_and_or_b32 v247, v247, v9, v10
    buffer_store_dwordx4 v[244:247], v253, s[32:35], s46 offen sc1
YS8:
    s_add_u32 s46, s63, 2064384
    s_bitcmp1_b32 s3, 1
    s_waitcnt lgkmcnt(0)
    s_barrier
    s_cbranch_scc0 YS9
    ds_read_b64_tr_b16 v[244:245], v252 offset:3584
    ds_read_b64_tr_b16 v[246:247], v252 offset:3840
    s_waitcnt lgkmcnt(0)
    v_add_u32 v244, v11, v244
    v_add_u32 v245, v11, v245
    v_add_u32 v246, v11, v246
    v_add_u32 v247, v11, v247
    v_and_or_b32 v244, v244, v9, v10
    v_and_or_b32 v245, v245, v9, v10
    v_and_or_b32 v246, v246, v9, v10
    v_and_or_b32 v247, v247, v9, v10
    buffer_store_dwordx4 v[244:247], v253, s[32:35], s46 offen sc1
YS9:
RPREP:
    s_cmp_ge_u32 s49, 128
    s_cbranch_scc1 ZROLE
    s_cmp_lg_u32 s61, 0
    s_cselect_b32 s39, 1, 0
    s_cbranch_scc1 RP_U0
    ds_read_b128 v[72:75], v25
    ds_read_b128 v[76:79], v25 offset:512
    ds_read_b32 v80, v26 offset:1024
RP_U0:
    v_lshlrev_b32 v38, 1, v12
    v_lshlrev_b32 v39, 1, v13
    s_mul_i32 s60, s49, 18432
    s_add_u32 s60, s60, 4194304
    s_add_u32 s61, s60, 8192
    s_add_u32 s62, s60, 16384
    v_mov_b32 v204, 0
    s_waitcnt vmcnt(2)
    s_cmp_ge_u32 s49, 64
    s_cbranch_scc1 RP_0
    buffer_load_dwordx4 v[140:143], v3, s[32:35], s60 offen sc1
    buffer_load_dwordx4 v[144:147], v3, s[32:35], s61 offen sc1
    s_cmp_ge_u32 s3, 2
    s_cbranch_scc1 YL10
    buffer_load_dwordx4 v[148:151], v3, s[32:35], s62 offen sc1
YL10:
RP_0:
    v_lshlrev_b32 v84, 16, v208
    v_and_b32 v85, 0xffff0000, v208
    v_lshlrev_b32 v120, 16, v218
    v_and_b32 v121, 0xffff0000, v218
    v_dot2c_f32_bf16 v204, v218, v8
    v_lshlrev_b32 v86, 16, v209
    v_and_b32 v87, 0xffff0000, v209
    v_lshlrev_b32 v122, 16, v219
    v_and_b32 v123, 0xffff0000, v219
    v_dot2c_f32_bf16 v204, v219, v8
    v_lshlrev_b32 v88, 16, v210
    v_and_b32 v89, 0xffff0000, v210
    v_lshlrev_b32 v124, 16, v220
    v_and_b32 v125, 0xffff0000, v220
    v_dot2c_f32_bf16 v204, v220, v8
    v_lshlrev_b32 v90, 16, v211
    v_and_b32 v91, 0xffff0000, v211
    v_lshlrev_b32 v126, 16, v221
    v_and_b32 v127, 0xffff0000, v221
    v_dot2c_f32_bf16 v204, v221, v8
    v_lshlrev_b32 v92, 16, v212
    v_and_b32 v93, 0xffff0000, v212
    v_lshlrev_b32 v128, 16, v222
    v_and_b32 v129, 0xffff0000, v222
    v_dot2c_f32_bf16 v204, v222, v8
    v_lshlrev_b32 v94, 16, v213
    v_and_b32 v95, 0xffff0000, v213
    v_lshlrev_b32 v130, 16, v223
    v_and_b32 v131, 0xffff0000, v223
    v_dot2c_f32_bf16 v204, v223, v8
    v_lshlrev_b32 v96, 16, v214
    v_and_b32 v97, 0xffff0000, v214
    v_lshlrev_b32 v132, 16, v224
    v_and_b32 v133, 0xffff0000, v224
    v_dot2c_f32_bf16 v204, v224, v8
    v_lshlrev_b32 v98, 16, v215
    v_and_b32 v99, 0xffff0000, v215
    v_lshlrev_b32 v134, 16, v225
    v_and_b32 v135, 0xffff0000, v225
    v_dot2c_f32_bf16 v204, v225, v8
    v_lshlrev_b32 v100, 16, v216
    v_and_b32 v101, 0xffff0000, v216
    v_lshlrev_b32 v136, 16, v226
    v_and_b32 v137, 0xffff0000, v226
    v_dot2c_f32_bf16 v204, v226, v8
    s_waitcnt lgkmcnt(0)
    s_cmp_lg_u32 s39, 0
    s_cbranch_scc1 RP_U1
    v_add_u32 v72, v11, v72
    v_add_u32 v73, v11, v73
    v_add_u32 v74, v11, v74
    v_add_u32 v75, v11, v75
    v_add_u32 v76, v11, v76
    v_add_u32 v77, v11, v77
    v_add_u32 v78, v11, v78
    v_add_u32 v79, v11, v79
    v_add_u32 v80, v11, v80
    v_and_b32 v72, v9, v72
    v_and_b32 v73, v9, v73
    v_and_b32 v74, v9, v74
    v_and_b32 v75, v9, v75
    v_and_b32 v76, v9, v76
    v_and_b32 v77, v9, v77
    v_and_b32 v78, v9, v78
    v_and_b32 v79, v9, v79
    v_and_b32 v80, v9, v80
    s_branch RP_U2
RP_U1:
    s_mov_b32 s47, 0
RP_U3:
    v_xor_b32 v72, v10, v72
    v_xor_b32 v73, v10, v73
    v_xor_b32 v74, v10, v74
    v_xor_b32 v75, v10, v75
    v_xor_b32 v76, v10, v76
    v_xor_b32 v77, v10, v77
    v_xor_b32 v78, v10, v78
    v_xor_b32 v79, v10, v79
    v_xor_b32 v80, v10, v80
    v_or3_b32 v37, v72, v73, v74
    v_or3_b32 v37, v37, v75, v76
    v_or3_b32 v37, v37, v77, v78
    v_or3_b32 v37, v37, v79, v80
    v_and_b32 v37, 0x70007, v37
    v_cmp_ne_u32 vcc, 0, v37
    s_cbranch_vccz RP_U2
    s_add_u32 s47, s47, 1
    s_cmp_ge_u32 s47, 65536
    s_cbranch_scc1 RP_U2
    s_sleep 4
    s_mov_b32 s57, 10485760
    buffer_load_dwordx4 v[72:75], v4, s[32:35], s57 offen sc1
    buffer_load_dwordx4 v[76:79], v4, s[32:35], s57 offen offset:512 sc1
    buffer_load_dword v80, v5, s[32:35], s57 offen offset:1024 sc1
    s_waitcnt vmcnt(0)
    s_branch RP_U3
RP_U2:
    v_fma_mix_f32 v84, v72, v84, 0 op_sel:[0,0,0] op_sel_hi:[1,0,0]
    v_fma_mix_f32 v85, v72, v85, 0 op_sel:[1,0,0] op_sel_hi:[1,0,0]
    v_fma_mix_f32 v86, v73, v86, 0 op_sel:[0,0,0] op_sel_hi:[1,0,0]
    v_add_f32_dpp v204, v204, v204 row_ror:8 row_mask:0xf bank_mask:0xf
    v_fma_mix_f32 v87, v73, v87, 0 op_sel:[1,0,0] op_sel_hi:[1,0,0]
    v_fma_mix_f32 v88, v74, v88, 0 op_sel:[0,0,0] op_sel_hi:[1,0,0]
    v_fma_mix_f32 v89, v74, v89, 0 op_sel:[1,0,0] op_sel_hi:[1,0,0]
    v_fma_mix_f32 v90, v75, v90, 0 op_sel:[0,0,0] op_sel_hi:[1,0,0]
    v_fma_mix_f32 v91, v75, v91, 0 op_sel:[1,0,0] op_sel_hi:[1,0,0]
    v_add_f32_dpp v204, v204, v204 row_ror:4 row_mask:0xf bank_mask:0xf
    v_fma_mix_f32 v92, v76, v92, 0 op_sel:[0,0,0] op_sel_hi:[1,0,0]
    v_fma_mix_f32 v93, v76, v93, 0 op_sel:[1,0,0] op_sel_hi:[1,0,0]
    v_fma_mix_f32 v94, v77, v94, 0 op_sel:[0,0,0] op_sel_hi:[1,0,0]
    v_fma_mix_f32 v95, v77, v95, 0 op_sel:[1,0,0] op_sel_hi:[1,0,0]
    v_fma_mix_f32 v96, v78, v96, 0 op_sel:[0,0,0] op_sel_hi:[1,0,0]
    v_add_f32_dpp v204, v204, v204 row_ror:2 row_mask:0xf bank_mask:0xf
    v_fma_mix_f32 v97, v78, v97, 0 op_sel:[1,0,0] op_sel_hi:[1,0,0]
    v_fma_mix_f32 v98, v79, v98, 0 op_sel:[0,0,0] op_sel_hi:[1,0,0]
    v_fma_mix_f32 v99, v79, v99, 0 op_sel:[1,0,0] op_sel_hi:[1,0,0]
    v_fma_mix_f32 v100, v80, v100, 0 op_sel:[0,0,0] op_sel_hi:[1,0,0]
    v_fma_mix_f32 v101, v80, v101, 0 op_sel:[1,0,0] op_sel_hi:[1,0,0]
    v_add_f32_dpp v204, v204, v204 row_ror:1 row_mask:0xf bank_mask:0xf
    v_cvt_pk_bf16_f32 v84, 0, v84
    v_cvt_pk_bf16_f32 v85, 0, v85
    v_cvt_pk_bf16_f32 v86, 0, v86
    v_cvt_pk_bf16_f32 v87, 0, v87
    v_cvt_pk_bf16_f32 v88, 0, v88
    v_mov_b32 v37, v204
    v_cvt_pk_bf16_f32 v89, 0, v89
    v_cvt_pk_bf16_f32 v90, 0, v90
    v_cvt_pk_bf16_f32 v91, 0, v91
    v_cvt_pk_bf16_f32 v92, 0, v92
    v_cvt_pk_bf16_f32 v93, 0, v93
    v_permlane16_swap_b32 v204, v37
    v_cvt_pk_bf16_f32 v94, 0, v94
    v_cvt_pk_bf16_f32 v95, 0, v95
    v_cvt_pk_bf16_f32 v96, 0, v96
    v_cvt_pk_bf16_f32 v97, 0, v97
    v_cvt_pk_bf16_f32 v98, 0, v98
    v_add_f32 v204, v204, v37
    v_cvt_pk_bf16_f32 v99, 0, v99
    v_cvt_pk_bf16_f32 v100, 0, v100
    v_cvt_pk_bf16_f32 v101, 0, v101
    v_dot2_f32_bf16 v102, v16, v6, v84
    v_dot2_f32_bf16 v103, v16, v7, v85
    v_dot2_f32_bf16 v104, v17, v6, v86
    v_dot2_f32_bf16 v105, v17, v7, v87
    v_dot2_f32_bf16 v106, v18, v6, v88
    v_dot2_f32_bf16 v107, v18, v7, v89
    v_dot2_f32_bf16 v108, v19, v6, v90
    v_dot2_f32_bf16 v109, v19, v7, v91
    v_dot2_f32_bf16 v110, v20, v6, v92
    v_dot2_f32_bf16 v111, v20, v7, v93
    v_dot2_f32_bf16 v112, v21, v6, v94
    v_dot2_f32_bf16 v113, v21, v7, v95
    v_dot2_f32_bf16 v114, v22, v6, v96
    v_dot2_f32_bf16 v115, v22, v7, v97
    v_dot2_f32_bf16 v116, v23, v6, v98
    v_dot2_f32_bf16 v117, v23, v7, v99
    v_dot2_f32_bf16 v118, v24, v6, v100
    v_dot2_f32_bf16 v119, v24, v7, v101
    s_cmp_lt_u32 s2, 144
    s_cbranch_scc1 RP_1
    s_and_b32 s46, s2, 7
    s_sub_u32 s48, s2, 216
    s_lshr_b32 s48, s48, 3
    v_lshrrev_b32 v37, 3, v0
    v_mul_u32_u24 v37, 9216, v37
    v_and_b32 v36, 7, v0
    v_lshl_add_u32 v37, v36, 4, v37
    s_cmp_ge_u32 s46, 4
    s_cselect_b32 s50, 1, 0
    s_add_u32 s50, s50, s46
    s_lshl_b32 s50, s50, 10
    s_add_u32 s50, s50, 384
    s_lshr_b32 s53, s48, 1
    s_sub_u32 s53, 8, s53
    s_mul_i32 s53, s53, 589824
    s_add_u32 s50, s50, s53
    v_add_u32 v36, s50, v37
    s_bitcmp1_b32 s48, 0
    s_cselect_b32 s56, s24, s22
    s_cselect_b32 s57, s25, s23
    global_load_dwordx4 v[140:143], v36, s[56:57] nt
    s_cmp_lg_u32 s46, 3
    s_cbranch_scc1 PF_0
    global_load_dwordx4 v[144:147], v36, s[56:57] offset:1024 nt
PF_0:
    v_subrev_u32 v36, 1179648, v36
    global_load_dwordx4 v[140:143], v36, s[56:57] nt
    s_cmp_lg_u32 s46, 3
    s_cbranch_scc1 PF_1
    global_load_dwordx4 v[144:147], v36, s[56:57] offset:1024 nt
PF_1:
    v_subrev_u32 v36, 1179648, v36
    global_load_dwordx4 v[140:143], v36, s[56:57] nt
    s_cmp_lg_u32 s46, 3
    s_cbranch_scc1 PF_2
    global_load_dwordx4 v[144:147], v36, s[56:57] offset:1024 nt
PF_2:
    v_subrev_u32 v36, 1179648, v36
    s_waitcnt vmcnt(0)
    s_cmp_ge_u32 s3, 4
    s_cbranch_scc1 RP_S
    s_lshl_b32 s57, s51, 6
    v_add_u32 v14, s57, v1
    v_min_u32 v14, 143, v14
    v_lshlrev_b32 v27, 7, v14
    v_lshlrev_b32 v14, 4, v14
    s_mov_b32 s53, 32768
    buffer_load_dwordx4 v[32:35], v27, s[32:35], s53 offen sc1
    s_and_b32 s56, s40, 0x7fffff
    s_mov_b32 s47, 0
    s_waitcnt vmcnt(0)
SCP11:
    v_xor_b32 v32, s56, v32
    v_xor_b32 v33, s56, v33
    v_xor_b32 v34, s56, v34
    v_xor_b32 v35, s56, v35
    v_or3_b32 v255, v32, v33, v34
    v_or_b32 v255, v255, v35
    v_and_b32 v255, 0x7fffff, v255
    v_cmp_ne_u32 vcc, 0, v255
    s_cbranch_vccz SCD12
    s_add_u32 s47, s47, 1
    s_cmp_ge_u32 s47, 65536
    s_cbranch_scc1 SCD12
    s_sleep 8
    buffer_load_dwordx4 v[32:35], v27, s[32:35], s53 offen sc1
    s_waitcnt vmcnt(0)
    s_branch SCP11
SCD12:
    ds_write_b128 v14, v[32:35] offset:46080
RP_S:
    s_waitcnt lgkmcnt(0)
    s_barrier
RP_1:
    s_cmp_lt_u32 s49, 64
    s_cbranch_scc1 RP_2
    buffer_load_dwordx4 v[140:143], v3, s[32:35], s60 offen sc1
    buffer_load_dwordx4 v[144:147], v3, s[32:35], s61 offen sc1
    s_cmp_ge_u32 s3, 2
    s_cbranch_scc1 YL13
    buffer_load_dwordx4 v[148:151], v3, s[32:35], s62 offen sc1
YL13:
RP_2:
    ds_read_b128 v[52:55], v38 offset:46080
    ds_read_b128 v[56:59], v38 offset:46096
    ds_read_b128 v[60:63], v38 offset:47104
    ds_read_b128 v[64:67], v38 offset:47120
    ds_read_b64 v[68:69], v39 offset:48128
    v_and_b32 v36, 7, v0
    v_mul_u32_u24 v36, 2320, v36
    v_lshrrev_b32 v37, 3, v0
    v_lshl_add_u32 v36, v37, 4, v36
    v_lshrrev_b32 v37, 5, v1
    s_mul_i32 s46, s3, 2320
    s_add_u32 s46, s46, 49152
    v_lshl_add_u32 v37, v37, 3, s46
    v_lshl_add_u32 v38, v12, 1, v37
    v_bfe_u32 v39, v1, 1, 4
    v_lshl_add_u32 v39, v39, 4, v37
    v_and_b32 v37, 1, v1
    v_lshl_add_u32 v39, v37, 2, v39
    v_lshrrev_b32 v35, 5, v1
    v_lshlrev_b32 v35, 4, v35
    s_and_b32 s52, s3, 4
    s_add_u32 s52, s52, s3
    s_lshl_b32 s46, s52, 2
    s_add_u32 s46, s46, 163456
    v_add_u32 v35, s46, v35
    v_and_b32 v40, 15, v1
    v_lshlrev_b32 v34, 2, v40
    v_add_u32 v34, 163456, v34
    v_and_b32 v42, 48, v2
    v_add_u32 v41, 163456, v42
    v_lshrrev_b32 v43, 2, v1
    v_lshl_add_u32 v42, v43, 14, v42
    s_and_b32 s63, s40, 0xffff
    s_or_b32 s53, s63, 0x80000000
    s_lshl_b32 s54, s49, 6
    s_add_u32 s54, s54, 9437184
    s_mov_b32 s58, 1
    s_mov_b32 s59, 1
    s_lshl_b32 s46, s49, 4
    s_sub_u32 s46, 0xffff, s46
    v_sub_u32 v44, s46, v40
    v_mov_b32 v45, 0xffff0000
    v_lshrrev_b32 v46, 5, v1
    v_mul_u32_u24 v46, 6144, v46
    s_mul_i32 s46, s52, 1536
    v_add3_u32 v46, v46, v12, s46
    v_lshrrev_b32 v47, 2, v0
    v_and_b32 v48, 3, v0
    v_lshlrev_b32 v48, 4, v48
    v_lshl_add_u32 v47, v47, 6, v48
    v_mov_b32 v183, s40
    v_mov_b32 v187, s40
    v_mov_b32 v191, s40
    v_lshlrev_b32 v49, 2, v0
    v_sub_u32 v232, 0xffff, v49
    v_subrev_u32 v233, 1, v232
    v_subrev_u32 v234, 2, v232
    v_subrev_u32 v235, 3, v232
    v_mov_b32 v48, s63
    v_mov_b32 v49, 163520
    v_mov_b32 v50, -1
    s_cmp_ge_u32 s3, 2
    s_cbranch_scc1 RP_3
    s_mov_b32 s47, 0
PL14:
    s_waitcnt vmcnt(0)
    v_xor_b32 v140, v10, v140
    v_xor_b32 v141, v10, v141
    v_xor_b32 v142, v10, v142
    v_xor_b32 v143, v10, v143
    v_xor_b32 v144, v10, v144
    v_xor_b32 v145, v10, v145
    v_xor_b32 v146, v10, v146
    v_xor_b32 v147, v10, v147
    v_xor_b32 v148, v10, v148
    v_xor_b32 v149, v10, v149
    v_xor_b32 v150, v10, v150
    v_xor_b32 v151, v10, v151
    v_or3_b32 v37, v140, v141, v142
    v_or3_b32 v37, v37, v143, v144
    v_or3_b32 v37, v37, v145, v146
    v_or3_b32 v37, v37, v147, v148
    v_or3_b32 v37, v37, v149, v150
    v_or_b32 v37, v37, v151
    v_and_b32 v37, 0x70007, v37
    v_cmp_ne_u32 vcc, 0, v37
    s_cbranch_vccz PD15
    s_add_u32 s47, s47, 1
    s_cmp_ge_u32 s47, 65536
    s_cbranch_scc1 PD15
    s_sleep 1
    buffer_load_dwordx4 v[140:143], v3, s[32:35], s60 offen sc1
    buffer_load_dwordx4 v[144:147], v3, s[32:35], s61 offen sc1
    buffer_load_dwordx4 v[148:151], v3, s[32:35], s62 offen sc1
    s_branch PL14
PD15:
    ds_write_b128 v36, v[148:151] offset:51200
    s_branch RP_4
RP_3:
    s_mov_b32 s47, 0
PL16:
    s_waitcnt vmcnt(0)
    v_xor_b32 v140, v10, v140
    v_xor_b32 v141, v10, v141
    v_xor_b32 v142, v10, v142
    v_xor_b32 v143, v10, v143
    v_xor_b32 v144, v10, v144
    v_xor_b32 v145, v10, v145
    v_xor_b32 v146, v10, v146
    v_xor_b32 v147, v10, v147
    v_or3_b32 v37, v140, v141, v142
    v_or3_b32 v37, v37, v143, v144
    v_or3_b32 v37, v37, v145, v146
    v_or_b32 v37, v37, v147
    v_and_b32 v37, 0x70007, v37
    v_cmp_ne_u32 vcc, 0, v37
    s_cbranch_vccz PD17
    s_add_u32 s47, s47, 1
    s_cmp_ge_u32 s47, 65536
    s_cbranch_scc1 PD17
    s_sleep 1
    buffer_load_dwordx4 v[140:143], v3, s[32:35], s60 offen sc1
    buffer_load_dwordx4 v[144:147], v3, s[32:35], s61 offen sc1
    s_branch PL16
PD17:
RP_4:
    ds_write_b128 v36, v[140:143] offset:49152
    ds_write_b128 v36, v[144:147] offset:50176
    s_waitcnt lgkmcnt(0)
    s_barrier
    ds_read2_b64 v[152:155], v38 offset0:0 offset1:2
    ds_read2_b64 v[156:159], v38 offset0:128 offset1:130
    ds_read_b32 v160, v39 offset:2048
    s_getreg_b32 s60, hwreg(HW_REG_XCC_ID, 0, 3)
    s_mul_i32 s60, s60, 16384
    s_add_u32 s60, s60, 9437184
    s_lshl_b32 s61, s3, 14
    s_add_u32 s61, s61, 9830400
    s_waitcnt lgkmcnt(2)
    v_fma_mix_f32 v162, v152, v52, v102 op_sel:[0,0,0] op_sel_hi:[1,0,0]
    v_fma_mix_f32 v163, v152, v53, v103 op_sel:[1,0,0] op_sel_hi:[1,0,0]
    v_fma_mix_f32 v164, v153, v54, v104 op_sel:[0,0,0] op_sel_hi:[1,0,0]
    v_fma_mix_f32 v165, v153, v55, v105 op_sel:[1,0,0] op_sel_hi:[1,0,0]
    v_pk_mul_f32 v[30:31], v[162:163], v[162:163]
    v_pk_mul_f32 v[32:33], v[162:163], v[120:121]
    v_fma_mix_f32 v166, v154, v56, v106 op_sel:[0,0,0] op_sel_hi:[1,0,0]
    v_fma_mix_f32 v167, v154, v57, v107 op_sel:[1,0,0] op_sel_hi:[1,0,0]
    v_pk_add_f32 v[28:29], v[162:163], v[164:165]
    v_pk_fma_f32 v[30:31], v[164:165], v[164:165], v[30:31]
    v_pk_fma_f32 v[32:33], v[164:165], v[122:123], v[32:33]
    v_fma_mix_f32 v168, v155, v58, v108 op_sel:[0,0,0] op_sel_hi:[1,0,0]
    v_fma_mix_f32 v169, v155, v59, v109 op_sel:[1,0,0] op_sel_hi:[1,0,0]
    v_pk_add_f32 v[28:29], v[28:29], v[166:167]
    v_pk_fma_f32 v[30:31], v[166:167], v[166:167], v[30:31]
    v_pk_fma_f32 v[32:33], v[166:167], v[124:125], v[32:33]
    s_waitcnt lgkmcnt(1)
    v_fma_mix_f32 v170, v156, v60, v110 op_sel:[0,0,0] op_sel_hi:[1,0,0]
    v_fma_mix_f32 v171, v156, v61, v111 op_sel:[1,0,0] op_sel_hi:[1,0,0]
    v_pk_add_f32 v[28:29], v[28:29], v[168:169]
    v_pk_fma_f32 v[30:31], v[168:169], v[168:169], v[30:31]
    v_pk_fma_f32 v[32:33], v[168:169], v[126:127], v[32:33]
    v_fma_mix_f32 v172, v157, v62, v112 op_sel:[0,0,0] op_sel_hi:[1,0,0]
    v_fma_mix_f32 v173, v157, v63, v113 op_sel:[1,0,0] op_sel_hi:[1,0,0]
    v_pk_add_f32 v[28:29], v[28:29], v[170:171]
    v_pk_fma_f32 v[30:31], v[170:171], v[170:171], v[30:31]
    v_pk_fma_f32 v[32:33], v[170:171], v[128:129], v[32:33]
    v_fma_mix_f32 v174, v158, v64, v114 op_sel:[0,0,0] op_sel_hi:[1,0,0]
    v_fma_mix_f32 v175, v158, v65, v115 op_sel:[1,0,0] op_sel_hi:[1,0,0]
    v_pk_add_f32 v[28:29], v[28:29], v[172:173]
    v_pk_fma_f32 v[30:31], v[172:173], v[172:173], v[30:31]
    v_pk_fma_f32 v[32:33], v[172:173], v[130:131], v[32:33]
    v_fma_mix_f32 v176, v159, v66, v116 op_sel:[0,0,0] op_sel_hi:[1,0,0]
    v_fma_mix_f32 v177, v159, v67, v117 op_sel:[1,0,0] op_sel_hi:[1,0,0]
    v_pk_add_f32 v[28:29], v[28:29], v[174:175]
    v_pk_fma_f32 v[30:31], v[174:175], v[174:175], v[30:31]
    v_pk_fma_f32 v[32:33], v[174:175], v[132:133], v[32:33]
    s_waitcnt lgkmcnt(0)
    v_fma_mix_f32 v178, v160, v68, v118 op_sel:[0,0,0] op_sel_hi:[1,0,0]
    v_fma_mix_f32 v179, v160, v69, v119 op_sel:[1,0,0] op_sel_hi:[1,0,0]
    v_pk_add_f32 v[28:29], v[28:29], v[176:177]
    v_pk_fma_f32 v[30:31], v[176:177], v[176:177], v[30:31]
    v_pk_fma_f32 v[32:33], v[176:177], v[134:135], v[32:33]
    v_pk_add_f32 v[28:29], v[28:29], v[178:179]
    v_pk_fma_f32 v[30:31], v[178:179], v[178:179], v[30:31]
    v_pk_fma_f32 v[32:33], v[178:179], v[136:137], v[32:33]
    v_add_f32 v28, v28, v29
    v_add_f32 v30, v30, v31
    v_add_f32 v32, v32, v33
    s_nop 0
    v_permlane16_swap_b32 v28, v30
    v_add_f32 v28, v28, v30
    v_add_f32_dpp v32, v32, v32 row_ror:8 row_mask:0xf bank_mask:0xf
    s_nop 0
    v_add_f32_dpp v28, v28, v28 row_ror:8 row_mask:0xf bank_mask:0xf
    v_add_f32_dpp v32, v32, v32 row_ror:4 row_mask:0xf bank_mask:0xf
    s_nop 0
    v_add_f32_dpp v28, v28, v28 row_ror:4 row_mask:0xf bank_mask:0xf
    v_add_f32_dpp v32, v32, v32 row_ror:2 row_mask:0xf bank_mask:0xf
    s_nop 0
    v_add_f32_dpp v28, v28, v28 row_ror:2 row_mask:0xf bank_mask:0xf
    v_add_f32_dpp v32, v32, v32 row_ror:1 row_mask:0xf bank_mask:0xf
    s_nop 0
    v_add_f32_dpp v28, v28, v28 row_ror:1 row_mask:0xf bank_mask:0xf
    v_mov_b32 v33, v32
    v_mov_b32 v30, v28
    s_nop 1
    v_permlane16_swap_b32 v28, v30
    v_permlane16_swap_b32 v32, v33
    v_add_f32 v32, v32, v33
    v_mul_f32 v28, 0x3ae38e39, v28
    v_mul_f32 v30, 0x3ae38e39, v30
    v_fma_f32 v30, -v28, v28, v30
    v_cvt_pk_bf16_f32 v200, 0, v28
    v_max_f32 v30, 0, v30
    v_cvt_pk_bf16_f32 v30, 0, v30
    v_add_f32 v30, 0x3727c5ac, v30
    v_cvt_pk_bf16_f32 v30, 0, v30
    v_sqrt_f32 v30, v30
    s_nop 0
    v_cvt_pk_bf16_f32 v30, 0, v30
    v_rcp_f32 v202, v30
    v_fma_f32 v32, -v200, v204, v32
    v_mul_f32 v32, v32, v202
    v_cvt_pk_bf16_f32 v236, 0, v32
    v_ashrrev_i32 v28, 31, v236
    v_and_b32 v28, 0x7fff0000, v28
    v_xor_b32 v28, v28, v236
    v_xor_b32 v28, s53, v28
    s_mov_b64 exec, s[58:59]
    ds_write_b32 v35, v28
    s_mov_b64 exec, -1
    s_waitcnt lgkmcnt(0)
    s_barrier
    s_cmp_lg_u32 s3, 0
    s_cbranch_scc1 L2_NOKEY
    s_mov_b32 exec_hi, 0
    ds_read_b128 v[28:31], v41
    s_waitcnt lgkmcnt(0)
    buffer_store_dwordx4 v[28:31], v42, s[32:35], s54 offen sc1
    s_mov_b64 exec, -1
L2_NOKEY:
    ds_read_b32 v205, v34
    v_fma_mix_f32 v162, v152, v52, v84 op_sel:[0,0,0] op_sel_hi:[1,0,0]
    v_fma_mix_f32 v163, v152, v53, v85 op_sel:[1,0,0] op_sel_hi:[1,0,0]
    v_fma_mix_f32 v164, v153, v54, v86 op_sel:[0,0,0] op_sel_hi:[1,0,0]
    v_fma_mix_f32 v165, v153, v55, v87 op_sel:[1,0,0] op_sel_hi:[1,0,0]
    v_fma_mix_f32 v166, v154, v56, v88 op_sel:[0,0,0] op_sel_hi:[1,0,0]
    v_fma_mix_f32 v167, v154, v57, v89 op_sel:[1,0,0] op_sel_hi:[1,0,0]
    v_fma_mix_f32 v168, v155, v58, v90 op_sel:[0,0,0] op_sel_hi:[1,0,0]
    v_fma_mix_f32 v169, v155, v59, v91 op_sel:[1,0,0] op_sel_hi:[1,0,0]
    v_fma_mix_f32 v170, v156, v60, v92 op_sel:[0,0,0] op_sel_hi:[1,0,0]
    v_fma_mix_f32 v171, v156, v61, v93 op_sel:[1,0,0] op_sel_hi:[1,0,0]
    v_fma_mix_f32 v172, v157, v62, v94 op_sel:[0,0,0] op_sel_hi:[1,0,0]
    v_fma_mix_f32 v173, v157, v63, v95 op_sel:[1,0,0] op_sel_hi:[1,0,0]
    v_fma_mix_f32 v174, v158, v64, v96 op_sel:[0,0,0] op_sel_hi:[1,0,0]
    v_fma_mix_f32 v175, v158, v65, v97 op_sel:[1,0,0] op_sel_hi:[1,0,0]
    v_fma_mix_f32 v176, v159, v66, v98 op_sel:[0,0,0] op_sel_hi:[1,0,0]
    v_fma_mix_f32 v177, v159, v67, v99 op_sel:[1,0,0] op_sel_hi:[1,0,0]
    v_fma_mix_f32 v178, v160, v68, v100 op_sel:[0,0,0] op_sel_hi:[1,0,0]
    v_fma_mix_f32 v179, v160, v69, v101 op_sel:[1,0,0] op_sel_hi:[1,0,0]
    v_cvt_pk_bf16_f32 v162, 0, v162
    v_cvt_pk_bf16_f32 v163, 0, v163
    v_cvt_pk_bf16_f32 v164, 0, v164
    v_cvt_pk_bf16_f32 v165, 0, v165
    v_cvt_pk_bf16_f32 v166, 0, v166
    v_cvt_pk_bf16_f32 v167, 0, v167
    v_cvt_pk_bf16_f32 v168, 0, v168
    v_cvt_pk_bf16_f32 v169, 0, v169
    v_cvt_pk_bf16_f32 v170, 0, v170
    v_cvt_pk_bf16_f32 v171, 0, v171
    v_cvt_pk_bf16_f32 v172, 0, v172
    v_cvt_pk_bf16_f32 v173, 0, v173
    v_cvt_pk_bf16_f32 v174, 0, v174
    v_cvt_pk_bf16_f32 v175, 0, v175
    v_cvt_pk_bf16_f32 v176, 0, v176
    v_cvt_pk_bf16_f32 v177, 0, v177
    v_cvt_pk_bf16_f32 v178, 0, v178
    v_cvt_pk_bf16_f32 v179, 0, v179
    v_dot2_f32_bf16 v162, v16, v6, v162
    v_dot2_f32_bf16 v163, v16, v7, v163
    v_dot2_f32_bf16 v164, v17, v6, v164
    v_dot2_f32_bf16 v165, v17, v7, v165
    v_dot2_f32_bf16 v166, v18, v6, v166
    v_dot2_f32_bf16 v167, v18, v7, v167
    v_dot2_f32_bf16 v168, v19, v6, v168
    v_dot2_f32_bf16 v169, v19, v7, v169
    v_dot2_f32_bf16 v170, v20, v6, v170
    v_dot2_f32_bf16 v171, v20, v7, v171
    v_dot2_f32_bf16 v172, v21, v6, v172
    v_dot2_f32_bf16 v173, v21, v7, v173
    v_dot2_f32_bf16 v174, v22, v6, v174
    v_dot2_f32_bf16 v175, v22, v7, v175
    v_dot2_f32_bf16 v176, v23, v6, v176
    v_dot2_f32_bf16 v177, v23, v7, v177
    v_dot2_f32_bf16 v178, v24, v6, v178
    v_dot2_f32_bf16 v179, v24, v7, v179
    v_cvt_pk_bf16_f32 v162, 0, v162
    v_cvt_pk_bf16_f32 v163, 0, v163
    v_cvt_pk_bf16_f32 v164, 0, v164
    v_cvt_pk_bf16_f32 v165, 0, v165
    v_cvt_pk_bf16_f32 v166, 0, v166
    v_cvt_pk_bf16_f32 v167, 0, v167
    v_cvt_pk_bf16_f32 v168, 0, v168
    v_cvt_pk_bf16_f32 v169, 0, v169
    v_cvt_pk_bf16_f32 v170, 0, v170
    v_cvt_pk_bf16_f32 v171, 0, v171
    v_cvt_pk_bf16_f32 v172, 0, v172
    v_cvt_pk_bf16_f32 v173, 0, v173
    v_cvt_pk_bf16_f32 v174, 0, v174
    v_cvt_pk_bf16_f32 v175, 0, v175
    v_cvt_pk_bf16_f32 v176, 0, v176
    v_cvt_pk_bf16_f32 v177, 0, v177
    v_cvt_pk_bf16_f32 v178, 0, v178
    v_cvt_pk_bf16_f32 v179, 0, v179
    v_pk_add_f32 v[102:103], v[162:163], v[200:201] op_sel_hi:[1,0] neg_lo:[0,1] neg_hi:[0,1]
    v_pk_add_f32 v[104:105], v[164:165], v[200:201] op_sel_hi:[1,0] neg_lo:[0,1] neg_hi:[0,1]
    v_pk_add_f32 v[106:107], v[166:167], v[200:201] op_sel_hi:[1,0] neg_lo:[0,1] neg_hi:[0,1]
    v_pk_add_f32 v[108:109], v[168:169], v[200:201] op_sel_hi:[1,0] neg_lo:[0,1] neg_hi:[0,1]
    v_pk_add_f32 v[110:111], v[170:171], v[200:201] op_sel_hi:[1,0] neg_lo:[0,1] neg_hi:[0,1]
    v_pk_add_f32 v[112:113], v[172:173], v[200:201] op_sel_hi:[1,0] neg_lo:[0,1] neg_hi:[0,1]
    v_pk_add_f32 v[114:115], v[174:175], v[200:201] op_sel_hi:[1,0] neg_lo:[0,1] neg_hi:[0,1]
    v_pk_add_f32 v[116:117], v[176:177], v[200:201] op_sel_hi:[1,0] neg_lo:[0,1] neg_hi:[0,1]
    v_pk_add_f32 v[118:119], v[178:179], v[200:201] op_sel_hi:[1,0] neg_lo:[0,1] neg_hi:[0,1]
    v_cvt_pk_bf16_f32 v102, 0, v102
    v_cvt_pk_bf16_f32 v103, 0, v103
    v_cvt_pk_bf16_f32 v104, 0, v104
    v_cvt_pk_bf16_f32 v105, 0, v105
    v_cvt_pk_bf16_f32 v106, 0, v106
    v_cvt_pk_bf16_f32 v107, 0, v107
    v_cvt_pk_bf16_f32 v108, 0, v108
    v_cvt_pk_bf16_f32 v109, 0, v109
    v_cvt_pk_bf16_f32 v110, 0, v110
    buffer_load_dwordx4 v[228:231], v47, s[32:35], s60 offen sc1
    v_cvt_pk_bf16_f32 v111, 0, v111
    v_cvt_pk_bf16_f32 v112, 0, v112
    v_cvt_pk_bf16_f32 v113, 0, v113
    v_cvt_pk_bf16_f32 v114, 0, v114
    v_cvt_pk_bf16_f32 v115, 0, v115
    v_cvt_pk_bf16_f32 v116, 0, v116
    v_cvt_pk_bf16_f32 v117, 0, v117
    v_cvt_pk_bf16_f32 v118, 0, v118
    v_cvt_pk_bf16_f32 v119, 0, v119
    v_pk_mul_f32 v[102:103], v[102:103], v[202:203] op_sel_hi:[1,0]
    v_pk_mul_f32 v[104:105], v[104:105], v[202:203] op_sel_hi:[1,0]
    v_pk_mul_f32 v[106:107], v[106:107], v[202:203] op_sel_hi:[1,0]
    v_pk_mul_f32 v[108:109], v[108:109], v[202:203] op_sel_hi:[1,0]
    v_pk_mul_f32 v[110:111], v[110:111], v[202:203] op_sel_hi:[1,0]
    v_pk_mul_f32 v[112:113], v[112:113], v[202:203] op_sel_hi:[1,0]
    v_pk_mul_f32 v[114:115], v[114:115], v[202:203] op_sel_hi:[1,0]
    v_pk_mul_f32 v[116:117], v[116:117], v[202:203] op_sel_hi:[1,0]
    v_pk_mul_f32 v[118:119], v[118:119], v[202:203] op_sel_hi:[1,0]
    s_waitcnt lgkmcnt(0)
    v_and_or_b32 v205, v205, v45, v44
    v_mov_b32 v206, v205
    v_cvt_pk_bf16_f32 v180, v102, v103
    s_nop 0
    v_max_u32_dpp v206, v206, v206 row_ror:8 row_mask:0xf bank_mask:0xf
    v_cvt_pk_bf16_f32 v181, v104, v105
    s_nop 0
    v_max_u32_dpp v206, v206, v206 row_ror:4 row_mask:0xf bank_mask:0xf
    v_cvt_pk_bf16_f32 v182, v106, v107
    s_nop 0
    v_max_u32_dpp v206, v206, v206 row_ror:2 row_mask:0xf bank_mask:0xf
    s_nop 1
    v_max_u32_dpp v206, v206, v206 row_ror:1 row_mask:0xf bank_mask:0xf
    ds_write_b128 v46, v[180:183]
    v_readfirstlane_b32 s56, v206
    v_cvt_pk_bf16_f32 v184, v108, v109
    v_cmp_ne_u32 vcc, v206, v205
    v_cvt_pk_bf16_f32 v185, v110, v111
    s_nop 0
    v_cndmask_b32 v205, 0, v205, vcc
    v_mov_b32 v206, v205
    v_cvt_pk_bf16_f32 v186, v112, v113
    s_nop 0
    v_max_u32_dpp v206, v206, v206 row_ror:8 row_mask:0xf bank_mask:0xf
    ds_write_b128 v46, v[184:187] offset:512
    s_nop 0
    v_max_u32_dpp v206, v206, v206 row_ror:4 row_mask:0xf bank_mask:0xf
    v_cvt_pk_bf16_f32 v188, v114, v115
    s_nop 0
    v_max_u32_dpp v206, v206, v206 row_ror:2 row_mask:0xf bank_mask:0xf
    s_nop 1
    v_max_u32_dpp v206, v206, v206 row_ror:1 row_mask:0xf bank_mask:0xf
    v_cvt_pk_bf16_f32 v189, v116, v117
    v_readfirstlane_b32 s57, v206
    v_cvt_pk_bf16_f32 v190, v118, v119
    v_cmp_ne_u32 vcc, v206, v205
    ds_write_b128 v46, v[188:191] offset:1024
    s_nop 0
    v_cndmask_b32 v205, 0, v205, vcc
    s_waitcnt lgkmcnt(0)
    s_barrier
    s_andn2_b32 s46, 15, s56
    s_mul_i32 s46, s46, 1536
    v_add_u32 v37, s46, v2
    ds_read_b128 v[120:123], v37
    ds_read_b128 v[124:127], v37 offset:1024
    s_andn2_b32 s46, 15, s57
    s_mul_i32 s46, s46, 1536
    v_add_u32 v37, s46, v2
    ds_read_b128 v[128:131], v37
    ds_read_b128 v[132:135], v37 offset:1024
    s_mov_b32 s47, 0
PL18:
    s_waitcnt vmcnt(0)
    v_xor_b32 v228, v48, v228
    v_xor_b32 v229, v48, v229
    v_xor_b32 v230, v48, v230
    v_xor_b32 v231, v48, v231
    v_or3_b32 v37, v228, v229, v230
    v_or_b32 v37, v37, v231
    v_and_b32 v37, 0xffff, v37
    v_cmp_ne_u32 vcc, 0, v37
    s_cbranch_vccz PD19
    s_add_u32 s47, s47, 1
    s_cmp_ge_u32 s47, 65536
    s_cbranch_scc1 PD19
    s_sleep 1
    buffer_load_dwordx4 v[228:231], v47, s[32:35], s60 offen sc1
    s_branch PL18
PD19:
    v_or_b32 v228, v228, v232
    v_or_b32 v229, v229, v233
    v_or_b32 v230, v230, v234
    v_or_b32 v231, v231, v235
RK_LOOP:
    v_cmp_lt_u32 s[4:5], s56, v228
    v_cmp_lt_u32 s[6:7], s56, v229
    v_cmp_lt_u32 s[8:9], s56, v230
    v_cmp_lt_u32 s[10:11], s56, v231
    v_cmp_lt_u32 s[12:13], s57, v228
    v_cmp_lt_u32 s[14:15], s57, v229
    v_cmp_lt_u32 s[16:17], s57, v230
    v_cmp_lt_u32 s[18:19], s57, v231
    s_bcnt1_i32_b64 s4, s[4:5]
    s_bcnt1_i32_b64 s6, s[6:7]
    s_bcnt1_i32_b64 s8, s[8:9]
    s_bcnt1_i32_b64 s10, s[10:11]
    s_add_u32 s4, s4, s6
    s_add_u32 s8, s8, s10
    s_add_u32 s46, s4, s8
    s_bcnt1_i32_b64 s12, s[12:13]
    s_bcnt1_i32_b64 s14, s[14:15]
    s_bcnt1_i32_b64 s16, s[16:17]
    s_bcnt1_i32_b64 s18, s[18:19]
    s_add_u32 s12, s12, s14
    s_add_u32 s16, s16, s18
    s_add_u32 s48, s12, s16
    s_pack_ll_b32_b16 s46, s46, s48
    v_mov_b32 v37, s46
    s_mov_b64 exec, 1
    ds_add_u32 v49, v37
    s_mov_b64 exec, -1
    s_waitcnt lgkmcnt(0)
    s_barrier
    ds_read_b32 v37, v49
    v_add_u32 v49, 4, v49
    s_waitcnt lgkmcnt(0)
    v_readfirstlane_b32 s53, v37
    s_and_b32 s54, s53, 0xffff
    s_cmp_ge_u32 s54, 8
    s_cbranch_scc1 RK_DONE
    s_mul_i32 s48, s54, 1536
    s_add_u32 s48, s48, s61
    buffer_store_dwordx4 v[120:123], v2, s[32:35], s48 offen sc1
    s_mov_b32 exec_hi, 0
    buffer_store_dwordx4 v[124:127], v2, s[32:35], s48 offen offset:1024 sc1
    s_mov_b64 exec, -1
    s_andn2_b32 s46, 0xffff, s56
    s_and_b32 s48, s46, 11
    s_cmp_lg_u32 s48, s52
    s_cbranch_scc1 RK_N20
    s_bitcmp1_b32 s46, 2
    s_cselect_b32 exec_lo, 0, -1
    s_cselect_b32 exec_hi, -1, 0
    v_mov_b32 v50, s54
    v_mov_b32 v51, s46
    s_mov_b64 exec, -1
RK_N20:
    s_lshr_b32 s54, s53, 16
    s_cmp_ge_u32 s54, 8
    s_cbranch_scc1 RK_DONE
    s_mul_i32 s48, s54, 1536
    s_add_u32 s48, s48, s61
    buffer_store_dwordx4 v[128:131], v2, s[32:35], s48 offen sc1
    s_mov_b32 exec_hi, 0
    buffer_store_dwordx4 v[132:135], v2, s[32:35], s48 offen offset:1024 sc1
    s_mov_b64 exec, -1
    s_andn2_b32 s46, 0xffff, s57
    s_and_b32 s48, s46, 11
    s_cmp_lg_u32 s48, s52
    s_cbranch_scc1 RK_N21
    s_bitcmp1_b32 s46, 2
    s_cselect_b32 exec_lo, 0, -1
    s_cselect_b32 exec_hi, -1, 0
    v_mov_b32 v50, s54
    v_mov_b32 v51, s46
    s_mov_b64 exec, -1
RK_N21:
    v_mov_b32 v206, v205
    s_nop 1
    v_max_u32_dpp v206, v206, v206 row_ror:8 row_mask:0xf bank_mask:0xf
    s_nop 1
    v_max_u32_dpp v206, v206, v206 row_ror:4 row_mask:0xf bank_mask:0xf
    s_nop 1
    v_max_u32_dpp v206, v206, v206 row_ror:2 row_mask:0xf bank_mask:0xf
    s_nop 1
    v_max_u32_dpp v206, v206, v206 row_ror:1 row_mask:0xf bank_mask:0xf
    s_nop 0
    v_readfirstlane_b32 s56, v206
    v_cmp_ne_u32 vcc, v206, v205
    s_nop 1
    v_cndmask_b32 v205, 0, v205, vcc
    v_mov_b32 v206, v205
    s_nop 1
    v_max_u32_dpp v206, v206, v206 row_ror:8 row_mask:0xf bank_mask:0xf
    s_nop 1
    v_max_u32_dpp v206, v206, v206 row_ror:4 row_mask:0xf bank_mask:0xf
    s_nop 1
    v_max_u32_dpp v206, v206, v206 row_ror:2 row_mask:0xf bank_mask:0xf
    s_nop 1
    v_max_u32_dpp v206, v206, v206 row_ror:1 row_mask:0xf bank_mask:0xf
    s_nop 0
    v_readfirstlane_b32 s57, v206
    v_cmp_ne_u32 vcc, v206, v205
    s_nop 1
    v_cndmask_b32 v205, 0, v205, vcc
    s_andn2_b32 s46, 15, s56
    s_mul_i32 s46, s46, 1536
    v_add_u32 v37, s46, v2
    ds_read_b128 v[120:123], v37
    ds_read_b128 v[124:127], v37 offset:1024
    s_andn2_b32 s46, 15, s57
    s_mul_i32 s46, s46, 1536
    v_add_u32 v37, s46, v2
    ds_read_b128 v[128:131], v37
    ds_read_b128 v[132:135], v37 offset:1024
    s_branch RK_LOOP
RK_DONE:
    v_cmp_gt_u32 vcc, 8, v50
    s_andn2_b64 s[58:59], -1, vcc
    s_and_b64 exec, vcc, -1
    s_cbranch_execz RK_NOSEL
    v_mul_f32 v30, 0xbfb8aa3b, v236
    v_exp_f32 v30, v30
    v_mov_b32 v31, s40
    v_add_f32 v30, 1.0, v30
    v_rcp_f32 v30, v30
    v_mov_b32 v35, s40
    v_cvt_pk_bf16_f32 v30, 0, v30
    v_or_b32 v30, v51, v30
    v_mov_b32 v34, v30
    v_mul_u32_u24 v50, 4608, v50
    v_add_u32 v50, v50, v12
    s_mov_b32 s48, 131072
    s_mov_b32 s55, 131584
    v_or_b32_sdwa v28, v162, v180 dst_sel:DWORD dst_unused:UNUSED_PAD src0_sel:DWORD src1_sel:WORD_0
    v_or_b32_sdwa v29, v163, v180 dst_sel:DWORD dst_unused:UNUSED_PAD src0_sel:DWORD src1_sel:WORD_1
    buffer_store_dwordx4 v[28:31], v50, s[32:35], s48 offen offset:0 sc1
    v_or_b32_sdwa v32, v164, v181 dst_sel:DWORD dst_unused:UNUSED_PAD src0_sel:DWORD src1_sel:WORD_0
    v_or_b32_sdwa v33, v165, v181 dst_sel:DWORD dst_unused:UNUSED_PAD src0_sel:DWORD src1_sel:WORD_1
    buffer_store_dwordx4 v[32:35], v50, s[32:35], s55 offen offset:0 sc1
    v_or_b32_sdwa v28, v166, v182 dst_sel:DWORD dst_unused:UNUSED_PAD src0_sel:DWORD src1_sel:WORD_0
    v_or_b32_sdwa v29, v167, v182 dst_sel:DWORD dst_unused:UNUSED_PAD src0_sel:DWORD src1_sel:WORD_1
    buffer_store_dwordx4 v[28:31], v50, s[32:35], s55 offen offset:512 sc1
    v_or_b32_sdwa v32, v168, v184 dst_sel:DWORD dst_unused:UNUSED_PAD src0_sel:DWORD src1_sel:WORD_0
    v_or_b32_sdwa v33, v169, v184 dst_sel:DWORD dst_unused:UNUSED_PAD src0_sel:DWORD src1_sel:WORD_1
    buffer_store_dwordx4 v[32:35], v50, s[32:35], s55 offen offset:1024 sc1
    v_or_b32_sdwa v28, v170, v185 dst_sel:DWORD dst_unused:UNUSED_PAD src0_sel:DWORD src1_sel:WORD_0
    v_or_b32_sdwa v29, v171, v185 dst_sel:DWORD dst_unused:UNUSED_PAD src0_sel:DWORD src1_sel:WORD_1
    buffer_store_dwordx4 v[28:31], v50, s[32:35], s55 offen offset:1536 sc1
    v_or_b32_sdwa v32, v172, v186 dst_sel:DWORD dst_unused:UNUSED_PAD src0_sel:DWORD src1_sel:WORD_0
    v_or_b32_sdwa v33, v173, v186 dst_sel:DWORD dst_unused:UNUSED_PAD src0_sel:DWORD src1_sel:WORD_1
    buffer_store_dwordx4 v[32:35], v50, s[32:35], s55 offen offset:2048 sc1
    v_or_b32_sdwa v28, v174, v188 dst_sel:DWORD dst_unused:UNUSED_PAD src0_sel:DWORD src1_sel:WORD_0
    v_or_b32_sdwa v29, v175, v188 dst_sel:DWORD dst_unused:UNUSED_PAD src0_sel:DWORD src1_sel:WORD_1
    buffer_store_dwordx4 v[28:31], v50, s[32:35], s55 offen offset:2560 sc1
    v_or_b32_sdwa v32, v176, v189 dst_sel:DWORD dst_unused:UNUSED_PAD src0_sel:DWORD src1_sel:WORD_0
    v_or_b32_sdwa v33, v177, v189 dst_sel:DWORD dst_unused:UNUSED_PAD src0_sel:DWORD src1_sel:WORD_1
    buffer_store_dwordx4 v[32:35], v50, s[32:35], s55 offen offset:3072 sc1
    v_or_b32_sdwa v28, v178, v190 dst_sel:DWORD dst_unused:UNUSED_PAD src0_sel:DWORD src1_sel:WORD_0
    v_or_b32_sdwa v29, v179, v190 dst_sel:DWORD dst_unused:UNUSED_PAD src0_sel:DWORD src1_sel:WORD_1
    buffer_store_dwordx4 v[28:31], v50, s[32:35], s55 offen offset:3584 sc1
RK_NOSEL:
    s_mov_b64 exec, -1
    v_dot2_f32_bf16 v162, v180, v6, v162
    v_dot2_f32_bf16 v163, v180, v7, v163
    v_dot2_f32_bf16 v164, v181, v6, v164
    v_dot2_f32_bf16 v165, v181, v7, v165
    v_dot2_f32_bf16 v166, v182, v6, v166
    v_dot2_f32_bf16 v167, v182, v7, v167
    v_dot2_f32_bf16 v168, v184, v6, v168
    v_dot2_f32_bf16 v169, v184, v7, v169
    v_dot2_f32_bf16 v170, v185, v6, v170
    v_dot2_f32_bf16 v171, v185, v7, v171
    v_dot2_f32_bf16 v172, v186, v6, v172
    v_dot2_f32_bf16 v173, v186, v7, v173
    v_dot2_f32_bf16 v174, v188, v6, v174
    v_dot2_f32_bf16 v175, v188, v7, v175
    v_dot2_f32_bf16 v176, v189, v6, v176
    v_dot2_f32_bf16 v177, v189, v7, v177
    v_dot2_f32_bf16 v178, v190, v6, v178
    v_dot2_f32_bf16 v179, v190, v7, v179
    v_cvt_pk_bf16_f32 v16, v162, v163
    v_cvt_pk_bf16_f32 v17, v164, v165
    v_cvt_pk_bf16_f32 v18, v166, v167
    v_cvt_pk_bf16_f32 v19, v168, v169
    v_cvt_pk_bf16_f32 v20, v170, v171
    v_cvt_pk_bf16_f32 v21, v172, v173
    v_cvt_pk_bf16_f32 v22, v174, v175
    v_cvt_pk_bf16_f32 v23, v176, v177
    v_cvt_pk_bf16_f32 v24, v178, v179
    s_mov_b64 exec, s[58:59]
    s_cbranch_execz RK_NOOUT
    global_store_dwordx4 v4, v[16:19], s[28:29] sc1
    global_store_dwordx4 v4, v[20:23], s[28:29] offset:512 sc1
    global_store_dword v5, v24, s[28:29] offset:1024 sc1
RK_NOOUT:
    s_mov_b64 exec, -1
    s_cmp_ge_u32 s2, 144
    s_cbranch_scc1 DUMP
ZROLE:
    s_and_b32 s50, s2, 7
    s_mul_i32 s50, s50, 18
    s_lshr_b32 s46, s2, 3
    s_add_u32 s50, s50, s46
    s_mul_i32 s60, s50, 9216
    s_add_u32 s60, s60, 7340032
    s_and_b32 s46, s40, 63
    v_mov_b32 v36, s46
    v_lshlrev_b32 v82, 2, v0
    s_cmp_lg_u32 s3, 0
    s_cbranch_scc1 Z_W
    v_and_b32 v12, 7, v1
    v_mul_u32_u24 v12, 4608, v12
    v_bfe_u32 v13, v1, 4, 1
    v_lshrrev_b32 v14, 5, v1
    v_lshl_add_u32 v13, v13, 1, v14
    s_lshl_b32 s46, s50, 2
    v_add_u32 v13, s46, v13
    v_bfe_u32 v14, v13, 3, 5
    v_and_b32 v15, 7, v13
    v_lshrrev_b32 v36, 8, v13
    v_lshl_add_u32 v15, v36, 3, v15
    s_cmp_lt_u32 s50, 128
    s_cbranch_scc1 Z_A
    v_bfe_u32 v14, v13, 1, 5
    v_and_b32 v15, 1, v13
    v_add_u32 v15, 16, v15
Z_A:
    v_lshrrev_b32 v36, 1, v15
    v_and_b32 v15, 1, v15
    v_lshl_add_u32 v14, v14, 4, v12
    v_lshl_add_u32 v14, v36, 9, v14
    v_cmp_eq_u32 s[52:53], 1, v15
    s_mul_i32 s60, s50, 9216
    s_add_u32 s60, s60, 7340032
    s_add_u32 s61, s60, 4096
    s_add_u32 s62, s60, 8192
    s_mov_b32 s63, 131072
    s_and_b32 s46, s40, 63
    v_mov_b32 v36, s46
    s_getreg_b32 s48, hwreg(HW_REG_XCC_ID, 0, 3)
    s_lshl_b32 s48, s48, 14
    s_add_u32 s48, s48, 9699328
    s_add_u32 s59, s48, 8192
    v_lshlrev_b32 v80, 7, v1
    v_and_b32 v81, 7, v1
    v_lshlrev_b32 v81, 7, v81
    buffer_load_dword v38, v80, s[32:35], s48 offen sc1
    buffer_load_dword v39, v81, s[32:35], s59 offen sc1
    s_mov_b32 s47, 0
PL22:
    s_waitcnt vmcnt(0)
    v_cmp_ne_u32 vcc, s40, v38
    v_cmp_ne_u32 s[56:57], s40, v39
    s_or_b64 vcc, vcc, s[56:57]
    s_cbranch_vccz PD23
    s_add_u32 s47, s47, 1
    s_cmp_ge_u32 s47, 65536
    s_cbranch_scc1 PD23
    s_sleep 1
    buffer_load_dword v38, v80, s[32:35], s48 offen sc1
    buffer_load_dword v39, v81, s[32:35], s59 offen sc1
    s_branch PL22
PD23:
    s_barrier
    buffer_load_dwordx4 v[40:43], v3, s[32:35], s60 offen sc1
    buffer_load_dwordx4 v[44:47], v3, s[32:35], s62 offen sc1
    buffer_load_dwordx4 v[32:35], v14, s[32:35], s63 offen sc1
    s_mov_b32 s47, 0
PL24:
    s_waitcnt vmcnt(0)
    v_xor_b32 v40, v36, v40
    v_xor_b32 v41, v36, v41
    v_xor_b32 v42, v36, v42
    v_xor_b32 v43, v36, v43
    v_xor_b32 v44, v36, v44
    v_xor_b32 v45, v36, v45
    v_xor_b32 v46, v36, v46
    v_xor_b32 v47, v36, v47
    v_or3_b32 v37, v40, v41, v42
    v_or3_b32 v37, v37, v44, v45
    v_or3_b32 v37, v37, v46, v47
    v_or_b32 v37, v37, v43
    v_and_b32 v37, 63, v37
    v_cmp_ne_u32 vcc, 0, v37
    s_cbranch_vccz PD25
    s_add_u32 s47, s47, 1
    s_cmp_ge_u32 s47, 65536
    s_cbranch_scc1 PD25
    s_mov_b64 exec, vcc
    buffer_load_dwordx4 v[40:43], v3, s[32:35], s60 offen sc1
    buffer_load_dwordx4 v[44:47], v3, s[32:35], s62 offen sc1
    s_branch PL24
PD25:
    s_mov_b64 exec, -1
    s_mov_b32 s47, 0
PL26:
    s_waitcnt vmcnt(0)
    v_cmp_ne_u32 vcc, s40, v35
    s_cbranch_vccz PD27
    s_add_u32 s47, s47, 1
    s_cmp_ge_u32 s47, 65536
    s_cbranch_scc1 PD27
    s_sleep 2
    buffer_load_dwordx4 v[32:35], v14, s[32:35], s63 offen sc1
    s_branch PL26
PD27:
    v_cndmask_b32 v32, v32, v33, s[52:53]
    v_and_b32 v33, 0xffff0000, v34
    v_and_b32 v28, 2047, v34
    v_mul_u32_u24 v28, 1152, v28
    v_lshl_add_u32 v28, v13, 1, v28
    v_lshlrev_b32 v34, 16, v32
    v_and_b32 v35, 0xffff0000, v32
    v_pk_add_f32 v[40:41], v[40:41], v[44:45]
    v_pk_add_f32 v[42:43], v[42:43], v[46:47]
    s_nop 0
    v_permlane32_swap_b32 v40, v41
    v_permlane32_swap_b32 v42, v43
    v_add_f32 v40, v40, v41
    v_add_f32 v42, v42, v43
    s_nop 1
    v_permlane16_swap_b32 v40, v42
    v_add_f32 v40, v40, v42
    s_barrier
    ds_read2st64_b32 v[44:45], v82 offset0:1 offset1:2
    ds_read2st64_b32 v[46:47], v82 offset0:3 offset1:4
    ds_read2st64_b32 v[48:49], v82 offset0:5 offset1:6
    ds_read_b32 v50, v82 offset:1792
    s_waitcnt lgkmcnt(2)
    v_add_f32 v44, v44, v45
    v_add_f32 v46, v46, v47
    v_add_f32 v40, v40, v44
    s_waitcnt lgkmcnt(0)
    v_add_f32 v48, v48, v49
    v_add_f32 v46, v46, v50
    v_add_f32 v40, v40, v48
    v_add_f32 v40, v40, v46
    s_nop 1
    v_add_f32_dpp v40, v40, v40 row_ror:8 row_mask:0xf bank_mask:0xf
    v_cvt_pk_bf16_f32 v40, 0, v40
    v_mul_f32 v40, v40, v33
    v_cvt_pk_bf16_f32 v40, 0, v40
    v_add_f32 v40, v40, v34
    v_cvt_pk_bf16_f32 v40, 0, v40
    v_add_f32 v40, v40, v35
    v_cvt_pk_bf16_f32 v40, v40, v40
    s_mov_b32 exec_lo, 0x00ff00ff
    s_mov_b32 exec_hi, 0x00ff00ff
    global_store_short v28, v40, s[28:29]
    s_cmp_lg_u32 s50, 0
    s_cbranch_scc1 DUMP
    s_mov_b64 exec, 1
    v_mov_b32 v36, s40
    buffer_store_dword v36, v2, s[32:35], 0 offen
    s_branch DUMP
Z_W:
    s_barrier
    buffer_load_dwordx4 v[40:43], v3, s[32:35], s60 offen sc1
    s_mov_b32 s47, 0
PL28:
    s_waitcnt vmcnt(0)
    v_xor_b32 v40, v36, v40
    v_xor_b32 v41, v36, v41
    v_xor_b32 v42, v36, v42
    v_xor_b32 v43, v36, v43
    v_or3_b32 v37, v40, v41, v42
    v_or_b32 v37, v37, v43
    v_and_b32 v37, 63, v37
    v_cmp_ne_u32 vcc, 0, v37
    s_cbranch_vccz PD29
    s_add_u32 s47, s47, 1
    s_cmp_ge_u32 s47, 65536
    s_cbranch_scc1 PD29
    s_mov_b64 exec, vcc
    buffer_load_dwordx4 v[40:43], v3, s[32:35], s60 offen sc1
    s_branch PL28
PD29:
    s_mov_b64 exec, -1
    v_permlane32_swap_b32 v40, v41
    v_permlane32_swap_b32 v42, v43
    v_add_f32 v40, v40, v41
    v_add_f32 v42, v42, v43
    s_nop 1
    v_permlane16_swap_b32 v40, v42
    v_add_f32 v40, v40, v42
    ds_write_b32 v82, v40
    s_waitcnt lgkmcnt(0)
    s_barrier
    s_branch DUMP
FROLE:
    s_sub_u32 s50, s2, 144
    s_cmp_lt_u32 s50, 48
    s_cbranch_scc1 F_NT
    v_cmp_gt_u32 vcc, TBLEND-PC0, v15
    s_and_saveexec_b64 s[58:59], vcc
    s_cbranch_execz F_NT
    global_load_dword v255, v15, s[42:43]
F_NT:
    s_mov_b64 exec, -1
    s_and_b32 s46, s50, 7
    s_sub_u32 s48, 3, s46
    s_and_b32 s48, s48, 7
    s_lshr_b32 s50, s50, 3
    s_add_u32 s50, s50, s48
    s_add_u32 s50, s50, 2
    s_cmp_ge_u32 s50, 9
    s_cselect_b32 s48, 9, 0
    s_sub_u32 s50, s50, s48
    s_mul_i32 s46, s46, 9
    s_add_u32 s50, s50, s46
    v_lshrrev_b32 v12, 3, v0
    v_and_b32 v13, 7, v0
    v_lshlrev_b32 v13, 4, v13
    v_mul_u32_u24 v4, 9216, v12
    v_add_u32 v4, v4, v13
    v_mul_u32_u24 v5, 1152, v12
    v_add_u32 v5, v5, v13
    s_lshl_b32 s46, s50, 7
    s_mul_i32 s48, s50, 73728
    s_mov_b32 s38, 5308416
    s_mov_b32 s39, 0x00020000
    s_mov_b32 s54, 5308416
    s_mov_b32 s55, 0x00020000
    s_mov_b32 s58, 5308416
    s_mov_b32 s59, 0x00020000
    s_waitcnt lgkmcnt(0)
    s_mov_b32 s36, s22
    s_and_b32 s37, s23, 0xffff
    s_mov_b32 s52, s24
    s_and_b32 s53, s25, 0xffff
    s_mov_b32 s56, s26
    s_and_b32 s57, s27, 0xffff
    s_load_dword s40, s[30:31], 0
    s_cmp_ge_u32 s2, 192
    s_cbranch_scc1 F_L1
    s_barrier
    s_lshl_b32 s49, s50, 7
    buffer_load_dwordx4 v[16:19], v4, s[36:39], s49 offen nt
    buffer_load_dwordx4 v[20:23], v4, s[52:55], s49 offen nt
    s_add_u32 s49, s49, 589824
    buffer_load_dwordx4 v[24:27], v4, s[36:39], s49 offen nt
    buffer_load_dwordx4 v[28:31], v4, s[52:55], s49 offen nt
    s_add_u32 s49, s49, 589824
    buffer_load_dwordx4 v[32:35], v4, s[36:39], s49 offen nt
    buffer_load_dwordx4 v[36:39], v4, s[52:55], s49 offen nt
    s_add_u32 s49, s49, 589824
    buffer_load_dwordx4 v[40:43], v4, s[36:39], s49 offen nt
    buffer_load_dwordx4 v[44:47], v4, s[52:55], s49 offen nt
    s_add_u32 s49, s49, 589824
F_L1:
    s_mov_b32 s32, s30
    s_and_b32 s33, s31, 0xffff
    s_mov_b32 s34, 0x10000000
    s_mov_b32 s35, 0x00020000
    v_mul_u32_u24 v6, 272, v12
    v_add_u32 v6, v6, v13
    v_lshrrev_b32 v14, 4, v1
    v_bfe_u32 v15, v1, 2, 2
    v_lshl_add_u32 v7, v14, 3, v15
    v_mul_u32_u24 v7, 272, v7
    v_and_b32 v8, 2, v1
    v_lshl_add_u32 v7, v8, 6, v7
    v_and_b32 v8, 1, v1
    v_lshl_add_u32 v7, v8, 3, v7
    s_lshl_b32 s46, s3, 4
    v_add_u32 v7, s46, v7
    v_bfe_u32 v8, v1, 3, 3
    v_mul_u32_u24 v8, 1184, v8
    v_add_u32 v8, v8, v13
    s_mul_i32 s46, s3, 9600
    v_add_u32 v8, s46, v8
    v_mul_u32_u24 v9, 9600, v14
    v_mul_u32_u24 v15, 1184, v15
    v_add_u32 v9, v9, v15
    v_and_b32 v15, 3, v1
    v_lshl_add_u32 v9, v15, 3, v9
    s_lshl_b32 s46, s3, 5
    v_add_u32 v9, s46, v9
    v_add_u32 v242, 0, v0
    v_mul_u32_u24 v243, 683, v242
    v_lshrrev_b32 v243, 16, v243
    v_mul_u32_u24 v244, 96, v243
    v_sub_u32 v242, v242, v244
    v_mul_u32_u24 v243, 1216, v243
    v_add_u32 v243, 81920, v243
    v_and_b32 v244, 31, v242
    v_lshrrev_b32 v242, 5, v242
    v_lshl_add_u32 v245, v244, 4, v243
    v_lshl_add_u32 v246, v244, 2, v243
    v_add_u32 v246, 1024, v246
    v_cmp_eq_u32 s[60:61], 1, v242
    v_cmp_eq_u32 s[62:63], 2, v242
    v_mov_b32 v247, 0
    v_mov_b32 v248, 12
    v_cndmask_b32 v247, v247, v248, s[60:61]
    v_mov_b32 v248, 520
    v_cndmask_b32 v247, v247, v248, s[62:63]
    v_add_u32 v236, v247, v245
    v_mov_b32 v247, 4
    v_mov_b32 v248, 512
    v_cndmask_b32 v247, v247, v248, s[60:61]
    v_mov_b32 v248, 524
    v_cndmask_b32 v247, v247, v248, s[62:63]
    v_add_u32 v237, v247, v245
    v_mov_b32 v247, 8
    v_mov_b32 v248, 516
    v_cndmask_b32 v247, v247, v248, s[60:61]
    v_add_u32 v247, v247, v245
    v_cndmask_b32 v238, v247, v246, s[62:63]
    v_add_u32 v242, 512, v0
    v_mul_u32_u24 v243, 683, v242
    v_lshrrev_b32 v243, 16, v243
    v_mul_u32_u24 v244, 96, v243
    v_sub_u32 v242, v242, v244
    v_mul_u32_u24 v243, 1216, v243
    v_add_u32 v243, 81920, v243
    v_and_b32 v244, 31, v242
    v_lshrrev_b32 v242, 5, v242
    v_lshl_add_u32 v245, v244, 4, v243
    v_lshl_add_u32 v246, v244, 2, v243
    v_add_u32 v246, 1024, v246
    v_cmp_eq_u32 s[60:61], 1, v242
    v_cmp_eq_u32 s[62:63], 2, v242
    v_mov_b32 v247, 0
    v_mov_b32 v248, 12
    v_cndmask_b32 v247, v247, v248, s[60:61]
    v_mov_b32 v248, 520
    v_cndmask_b32 v247, v247, v248, s[62:63]
    v_add_u32 v239, v247, v245
    v_mov_b32 v247, 4
    v_mov_b32 v248, 512
    v_cndmask_b32 v247, v247, v248, s[60:61]
    v_mov_b32 v248, 524
    v_cndmask_b32 v247, v247, v248, s[62:63]
    v_add_u32 v240, v247, v245
    v_mov_b32 v247, 8
    v_mov_b32 v248, 516
    v_cndmask_b32 v247, v247, v248, s[60:61]
    v_add_u32 v247, v247, v245
    v_cndmask_b32 v241, v247, v246, s[62:63]
    v_bfe_u32 v247, v236, 2, 1
    v_bfe_u32 v248, v236, 3, 2
    v_and_b32 v236, 0xffffffe3, v236
    v_lshl_add_u32 v236, v247, 4, v236
    v_lshl_add_u32 v236, v248, 2, v236
    v_bfe_u32 v247, v237, 2, 1
    v_bfe_u32 v248, v237, 3, 2
    v_and_b32 v237, 0xffffffe3, v237
    v_lshl_add_u32 v237, v247, 4, v237
    v_lshl_add_u32 v237, v248, 2, v237
    v_bfe_u32 v247, v238, 2, 1
    v_bfe_u32 v248, v238, 3, 2
    v_and_b32 v238, 0xffffffe3, v238
    v_lshl_add_u32 v238, v247, 4, v238
    v_lshl_add_u32 v238, v248, 2, v238
    v_bfe_u32 v247, v239, 2, 1
    v_bfe_u32 v248, v239, 3, 2
    v_and_b32 v239, 0xffffffe3, v239
    v_lshl_add_u32 v239, v247, 4, v239
    v_lshl_add_u32 v239, v248, 2, v239
    v_bfe_u32 v247, v240, 2, 1
    v_bfe_u32 v248, v240, 3, 2
    v_and_b32 v240, 0xffffffe3, v240
    v_lshl_add_u32 v240, v247, 4, v240
    v_lshl_add_u32 v240, v248, 2, v240
    v_bfe_u32 v247, v241, 2, 1
    v_bfe_u32 v248, v241, 3, 2
    v_and_b32 v241, 0xffffffe3, v241
    v_lshl_add_u32 v241, v247, 4, v241
    v_lshl_add_u32 v241, v248, 2, v241
    v_and_b32 v15, 7, v1
    v_mul_u32_u24 v10, 1216, v15
    v_lshl_add_u32 v10, v14, 5, v10
    v_and_b32 v247, 8, v1
    v_lshl_add_u32 v10, v247, 1, v10
    v_add_u32 v10, 81920, v10
    v_mul_u32_u24 v11, 144, v15
    v_add_u32 v11, 98304, v11
    v_lshl_add_u32 v242, v14, 4, v11
    v_bfe_u32 v243, v1, 3, 2
    v_lshrrev_b32 v244, 5, v1
    v_lshl_add_u32 v243, v243, 1, v244
    v_mul_u32_u24 v11, 144, v243
    v_lshl_add_u32 v11, v15, 1, v11
    s_lshl_b32 s46, s3, 4
    s_add_u32 s46, s46, 98304
    v_add_u32 v11, s46, v11
    v_bfe_u32 v243, v1, 3, 1
    v_lshl_add_u32 v243, v243, 5, v14
    v_mul_u32_u24 v243, 9216, v243
    v_lshl_add_u32 v243, v15, 4, v243
    s_mul_i32 s62, s3, 36864
    s_lshl_b32 s46, s50, 7
    s_add_u32 s62, s62, s46
    s_add_u32 s62, s62, 7340032
    v_and_b32 v244, 8, v1
    v_cmp_eq_u32 s[60:61], 0, v244
    v_mov_b32 v251, 0xeeee
    v_mov_b32 v252, 0x4444
    v_cndmask_b32 v251, v251, v252, s[60:61]
    s_waitcnt lgkmcnt(0)
    s_add_u32 s40, s40, 1
    s_and_b32 s46, s40, 63
    v_mov_b32 v245, s46
    v_mov_b32 v246, 0xffffffc0
    v_mov_b32 v249, s40
    v_lshlrev_b32 v250, 14, v1
    s_lshl_b32 s63, s50, 7
    s_add_u32 s63, s63, 9699328
    s_cmp_lt_u32 s2, 192
    s_cbranch_scc1 F_L2
    s_lshl_b32 s49, s50, 7
    buffer_load_dwordx4 v[16:19], v4, s[36:39], s49 offen nt
    buffer_load_dwordx4 v[20:23], v4, s[52:55], s49 offen nt
    s_add_u32 s49, s49, 589824
    buffer_load_dwordx4 v[24:27], v4, s[36:39], s49 offen nt
    buffer_load_dwordx4 v[28:31], v4, s[52:55], s49 offen nt
    s_add_u32 s49, s49, 589824
    buffer_load_dwordx4 v[32:35], v4, s[36:39], s49 offen nt
    buffer_load_dwordx4 v[36:39], v4, s[52:55], s49 offen nt
    s_add_u32 s49, s49, 589824
    buffer_load_dwordx4 v[40:43], v4, s[36:39], s49 offen nt
    buffer_load_dwordx4 v[44:47], v4, s[52:55], s49 offen nt
    s_add_u32 s49, s49, 589824
F_L2:
    buffer_load_dwordx4 v[48:51], v4, s[36:39], s49 offen nt
    buffer_load_dwordx4 v[52:55], v4, s[52:55], s49 offen nt
    s_add_u32 s49, s49, 589824
    s_waitcnt vmcnt(8)
    ds_write_b128 v6, v[16:19] offset:0
    ds_write_b128 v6, v[20:23] offset:128
    s_waitcnt lgkmcnt(0)
    s_barrier
    ds_read_b64_tr_b16 v[124:125], v7 offset:0
    ds_read_b64_tr_b16 v[126:127], v7 offset:1088
    ds_read_b64_tr_b16 v[128:129], v7 offset:8704
    ds_read_b64_tr_b16 v[130:131], v7 offset:9792
    buffer_load_dwordx4 v[56:59], v4, s[36:39], s49 offen nt
    buffer_load_dwordx4 v[60:63], v4, s[52:55], s49 offen nt
    s_add_u32 s49, s49, 589824
    s_waitcnt vmcnt(8)
    ds_write_b128 v6, v[24:27] offset:17408
    ds_write_b128 v6, v[28:31] offset:17536
    s_waitcnt lgkmcnt(0)
    s_barrier
    ds_read_b64_tr_b16 v[132:133], v7 offset:17408
    ds_read_b64_tr_b16 v[134:135], v7 offset:18496
    ds_read_b64_tr_b16 v[136:137], v7 offset:26112
    ds_read_b64_tr_b16 v[138:139], v7 offset:27200
    buffer_load_dwordx4 v[64:67], v4, s[36:39], s49 offen nt
    buffer_load_dwordx4 v[68:71], v4, s[52:55], s49 offen nt
    s_add_u32 s49, s49, 589824
    s_waitcnt vmcnt(8)
    ds_write_b128 v6, v[32:35] offset:34816
    ds_write_b128 v6, v[36:39] offset:34944
    s_waitcnt lgkmcnt(0)
    s_barrier
    ds_read_b64_tr_b16 v[140:141], v7 offset:34816
    ds_read_b64_tr_b16 v[142:143], v7 offset:35904
    ds_read_b64_tr_b16 v[144:145], v7 offset:43520
    ds_read_b64_tr_b16 v[146:147], v7 offset:44608
    buffer_load_dwordx4 v[72:75], v4, s[36:39], s49 offen nt
    buffer_load_dwordx4 v[76:79], v4, s[52:55], s49 offen nt
    s_add_u32 s49, s49, 589824
    s_waitcnt vmcnt(8)
    v_add_u32 v6, 52224, v6
    v_add_u32 v7, 52224, v7
    ds_write_b128 v6, v[40:43] offset:0
    ds_write_b128 v6, v[44:47] offset:128
    s_waitcnt lgkmcnt(0)
    s_barrier
    ds_read_b64_tr_b16 v[148:149], v7 offset:0
    ds_read_b64_tr_b16 v[150:151], v7 offset:1088
    ds_read_b64_tr_b16 v[152:153], v7 offset:8704
    ds_read_b64_tr_b16 v[154:155], v7 offset:9792
    buffer_load_dwordx4 v[80:83], v4, s[36:39], s49 offen nt
    buffer_load_dwordx4 v[84:87], v4, s[52:55], s49 offen nt
    s_add_u32 s49, s49, 589824
    s_waitcnt vmcnt(8)
    ds_write_b128 v6, v[48:51] offset:17408
    ds_write_b128 v6, v[52:55] offset:17536
    s_waitcnt lgkmcnt(0)
    s_barrier
    ds_read_b64_tr_b16 v[156:157], v7 offset:17408
    ds_read_b64_tr_b16 v[158:159], v7 offset:18496
    ds_read_b64_tr_b16 v[160:161], v7 offset:26112
    ds_read_b64_tr_b16 v[162:163], v7 offset:27200
    buffer_load_dwordx4 v[88:91], v5, s[56:59], s48 offen offset:0 nt
    buffer_load_dwordx4 v[92:95], v5, s[56:59], s48 offen offset:128 nt
    s_waitcnt vmcnt(8)
    ds_write_b128 v6, v[56:59] offset:34816
    ds_write_b128 v6, v[60:63] offset:34944
    s_waitcnt lgkmcnt(0)
    s_barrier
    ds_read_b64_tr_b16 v[164:165], v7 offset:34816
    ds_read_b64_tr_b16 v[166:167], v7 offset:35904
    ds_read_b64_tr_b16 v[168:169], v7 offset:43520
    ds_read_b64_tr_b16 v[170:171], v7 offset:44608
    buffer_load_dwordx4 v[96:99], v5, s[56:59], s48 offen offset:256 nt
    buffer_load_dwordx4 v[100:103], v5, s[56:59], s48 offen offset:384 nt
    s_waitcnt vmcnt(8)
    v_add_u32 v6, 52224, v6
    v_add_u32 v7, 52224, v7
    ds_write_b128 v6, v[64:67] offset:0
    ds_write_b128 v6, v[68:71] offset:128
    s_waitcnt lgkmcnt(0)
    s_barrier
    ds_read_b64_tr_b16 v[172:173], v7 offset:0
    ds_read_b64_tr_b16 v[174:175], v7 offset:1088
    ds_read_b64_tr_b16 v[176:177], v7 offset:8704
    ds_read_b64_tr_b16 v[178:179], v7 offset:9792
    buffer_load_dwordx4 v[104:107], v5, s[56:59], s48 offen offset:512 nt
    buffer_load_dwordx4 v[108:111], v5, s[56:59], s48 offen offset:640 nt
    s_waitcnt vmcnt(8)
    ds_write_b128 v6, v[72:75] offset:17408
    ds_write_b128 v6, v[76:79] offset:17536
    s_waitcnt lgkmcnt(0)
    s_barrier
    ds_read_b64_tr_b16 v[180:181], v7 offset:17408
    ds_read_b64_tr_b16 v[182:183], v7 offset:18496
    ds_read_b64_tr_b16 v[184:185], v7 offset:26112
    ds_read_b64_tr_b16 v[186:187], v7 offset:27200
    buffer_load_dwordx4 v[112:115], v5, s[56:59], s48 offen offset:768 nt
    buffer_load_dwordx4 v[116:119], v5, s[56:59], s48 offen offset:896 nt
    s_waitcnt vmcnt(8)
    ds_write_b128 v6, v[80:83] offset:34816
    ds_write_b128 v6, v[84:87] offset:34944
    s_waitcnt lgkmcnt(0)
    s_barrier
    ds_read_b64_tr_b16 v[188:189], v7 offset:34816
    ds_read_b64_tr_b16 v[190:191], v7 offset:35904
    ds_read_b64_tr_b16 v[192:193], v7 offset:43520
    ds_read_b64_tr_b16 v[194:195], v7 offset:44608
    buffer_load_dwordx4 v[120:123], v5, s[56:59], s48 offen offset:1024 nt
    s_waitcnt vmcnt(7)
    ds_write_b128 v8, v[88:91] offset:0
    ds_write_b128 v8, v[92:95] offset:128
    s_waitcnt lgkmcnt(0)
    s_barrier
    ds_read_b64_tr_b16 v[196:197], v9 offset:0
    ds_read_b64_tr_b16 v[198:199], v9 offset:4736
    ds_read_b64_tr_b16 v[200:201], v9 offset:38400
    ds_read_b64_tr_b16 v[202:203], v9 offset:43136
    s_waitcnt vmcnt(5)
    ds_write_b128 v8, v[96:99] offset:256
    ds_write_b128 v8, v[100:103] offset:384
    s_waitcnt lgkmcnt(0)
    s_barrier
    ds_read_b64_tr_b16 v[204:205], v9 offset:256
    ds_read_b64_tr_b16 v[206:207], v9 offset:4992
    ds_read_b64_tr_b16 v[208:209], v9 offset:38656
    ds_read_b64_tr_b16 v[210:211], v9 offset:43392
    s_waitcnt vmcnt(3)
    ds_write_b128 v8, v[104:107] offset:512
    ds_write_b128 v8, v[108:111] offset:640
    s_waitcnt lgkmcnt(0)
    s_barrier
    ds_read_b64_tr_b16 v[212:213], v9 offset:512
    ds_read_b64_tr_b16 v[214:215], v9 offset:5248
    ds_read_b64_tr_b16 v[216:217], v9 offset:38912
    ds_read_b64_tr_b16 v[218:219], v9 offset:43648
    s_waitcnt vmcnt(1)
    ds_write_b128 v8, v[112:115] offset:768
    ds_write_b128 v8, v[116:119] offset:896
    s_waitcnt lgkmcnt(0)
    s_barrier
    ds_read_b64_tr_b16 v[220:221], v9 offset:768
    ds_read_b64_tr_b16 v[222:223], v9 offset:5504
    ds_read_b64_tr_b16 v[224:225], v9 offset:39168
    ds_read_b64_tr_b16 v[226:227], v9 offset:43904
    s_waitcnt vmcnt(0)
    ds_write_b128 v8, v[120:123] offset:1024
    s_waitcnt lgkmcnt(0)
    s_barrier
    ds_read_b64_tr_b16 v[228:229], v9 offset:1024
    ds_read_b64_tr_b16 v[230:231], v9 offset:5760
    ds_read_b64_tr_b16 v[232:233], v9 offset:39424
    ds_read_b64_tr_b16 v[234:235], v9 offset:44160
    s_getreg_b32 s48, hwreg(HW_REG_XCC_ID, 0, 3)
    s_mul_i32 s48, s48, 16384
    s_add_u32 s48, s48, 9830400
    s_add_u32 s49, s48, 8192
    s_waitcnt lgkmcnt(0)
    v_mov_b32 v68, 0
    v_mov_b32 v69, 0
    v_mov_b32 v70, 0
    v_mov_b32 v71, 0
    s_add_u32 s54, s62, 589824
    s_add_u32 s55, s62, 1179648
    v_xor_b32 v24, 1, v245
    v_xor_b32 v25, 1, v245
    v_xor_b32 v26, 1, v245
    v_xor_b32 v27, 1, v245
    s_add_u32 s52, s62, 589824
    s_add_u32 s53, s62, 1179648
    buffer_store_dwordx4 v[24:27], v243, s[32:35], s62 offen sc1
    buffer_store_dwordx4 v[24:27], v243, s[32:35], s52 offen sc1
    s_cmp_ge_u32 s3, 4
    s_cbranch_scc1 F_P1
    s_mov_b64 exec, s[60:61]
    buffer_store_dwordx4 v[24:27], v243, s[32:35], s53 offen sc1
    s_mov_b64 exec, -1
    s_cmp_ge_u32 s3, 4
    s_cbranch_scc1 F_P1
    buffer_load_dwordx4 v[16:19], v3, s[32:35], s48 offen sc1
    buffer_load_dwordx4 v[20:23], v3, s[32:35], s49 offen sc1
    s_mov_b32 s47, 0
PL30:
    s_waitcnt vmcnt(0)
    v_cmp_ne_u32 vcc, s40, v19
    v_cmp_ne_u32 s[52:53], s40, v23
    s_or_b64 vcc, vcc, s[52:53]
    s_cbranch_vccz PD31
    s_add_u32 s47, s47, 1
    s_cmp_ge_u32 s47, 65536
    s_cbranch_scc1 PD31
    s_sleep 1
    buffer_load_dwordx4 v[16:19], v3, s[32:35], s48 offen sc1
    buffer_load_dwordx4 v[20:23], v3, s[32:35], s49 offen sc1
    s_branch PL30
PD31:
    ds_write_b32 v239, v20
    ds_write_b32 v240, v21
    ds_write_b32 v241, v22
    s_branch F_P2
F_P1:
    buffer_load_dwordx4 v[16:19], v3, s[32:35], s48 offen sc1
    s_mov_b32 s47, 0
PL32:
    s_waitcnt vmcnt(0)
    v_cmp_ne_u32 vcc, s40, v19
    s_cbranch_vccz PD33
    s_add_u32 s47, s47, 1
    s_cmp_ge_u32 s47, 65536
    s_cbranch_scc1 PD33
    s_sleep 1
    buffer_load_dwordx4 v[16:19], v3, s[32:35], s48 offen sc1
    s_branch PL32
PD33:
F_P2:
    ds_write_b32 v236, v16
    ds_write_b32 v237, v17
    ds_write_b32 v238, v18
    s_waitcnt lgkmcnt(0)
    s_barrier
    s_cmp_lg_u32 s3, 7
    s_cbranch_scc1 FH34
    s_mov_b64 exec, 0xff
    buffer_store_dword v249, v250, s[32:35], s63 offen sc1
    s_mov_b64 exec, -1
FH34:
    ds_read_b128 v[32:35], v10 offset:0
    ds_read_b128 v[36:39], v10 offset:128
    ds_read_b128 v[40:43], v10 offset:256
    ds_read_b128 v[44:47], v10 offset:384
    ds_read_b128 v[48:51], v10 offset:512
    ds_read_b128 v[52:55], v10 offset:640
    ds_read_b128 v[56:59], v10 offset:768
    ds_read_b128 v[60:63], v10 offset:896
    ds_read_b128 v[64:67], v10 offset:1024
    s_waitcnt lgkmcnt(8)
    v_smfmac_f32_16x16x64_bf16 v[68:71], v[32:35], v[124:131], v251
    s_waitcnt lgkmcnt(7)
    v_smfmac_f32_16x16x64_bf16 v[68:71], v[36:39], v[132:139], v251
    s_waitcnt lgkmcnt(6)
    v_smfmac_f32_16x16x64_bf16 v[68:71], v[40:43], v[140:147], v251
    s_waitcnt lgkmcnt(5)
    v_smfmac_f32_16x16x64_bf16 v[68:71], v[44:47], v[148:155], v251
    s_waitcnt lgkmcnt(4)
    v_smfmac_f32_16x16x64_bf16 v[68:71], v[48:51], v[156:163], v251
    s_waitcnt lgkmcnt(3)
    v_smfmac_f32_16x16x64_bf16 v[68:71], v[52:55], v[164:171], v251
    s_waitcnt lgkmcnt(2)
    v_smfmac_f32_16x16x64_bf16 v[68:71], v[56:59], v[172:179], v251
    s_waitcnt lgkmcnt(1)
    v_smfmac_f32_16x16x64_bf16 v[68:71], v[60:63], v[180:187], v251
    s_waitcnt lgkmcnt(0)
    v_smfmac_f32_16x16x64_bf16 v[68:71], v[64:67], v[188:195], v251
    s_nop 7
    v_permlane32_swap_b32 v68, v69
    v_permlane32_swap_b32 v70, v71
    v_add_f32 v28, v68, v69
    v_add_f32 v29, v70, v71
    v_cvt_pk_bf16_f32 v30, 0, v28
    v_cvt_pk_bf16_f32 v29, 0, v29
    v_cvt_pk_bf16_f32 v28, 0, v28
    s_nop 0
    v_mov_b32_dpp v28, v29 row_ror:8 row_mask:0xf bank_mask:0xc
    v_mov_b32_dpp v29, v30 row_ror:8 row_mask:0xf bank_mask:0x3
    v_mul_f32 v30, 0xbfb8aa3b, v28
    v_exp_f32 v30, v30
    s_nop 0
    v_add_f32 v30, 1.0, v30
    v_rcp_f32 v30, v30
    s_nop 0
    v_mul_f32 v28, v28, v30
    v_cvt_pk_bf16_f32 v28, 0, v28
    v_mul_f32 v28, v28, v29
    v_cvt_pk_bf16_f32 v28, v28, v28
    ds_write_b16 v11, v28
    s_waitcnt lgkmcnt(0)
    s_barrier
    ds_read_b128 v[16:19], v242
    ds_read_b128 v[20:23], v242 offset:64
    s_waitcnt lgkmcnt(1)
    v_mfma_f32_16x16x32_bf16 v[32:35], v[196:199], v[16:19], 0
    v_mfma_f32_16x16x32_bf16 v[36:39], v[204:207], v[16:19], 0
    s_waitcnt lgkmcnt(0)
    v_mfma_f32_16x16x32_bf16 v[32:35], v[200:203], v[20:23], v[32:35]
    v_mfma_f32_16x16x32_bf16 v[36:39], v[208:211], v[20:23], v[36:39]
    v_mfma_f32_16x16x32_bf16 v[40:43], v[212:215], v[16:19], 0
    v_mfma_f32_16x16x32_bf16 v[44:47], v[220:223], v[16:19], 0
    v_mfma_f32_16x16x32_bf16 v[40:43], v[216:219], v[20:23], v[40:43]
    v_mfma_f32_16x16x32_bf16 v[44:47], v[224:227], v[20:23], v[44:47]
    s_cmp_ge_u32 s3, 4
    s_cbranch_scc1 F_T4
    v_mfma_f32_16x16x32_bf16 v[48:51], v[228:231], v[16:19], 0
    v_mfma_f32_16x16x32_bf16 v[48:51], v[232:235], v[20:23], v[48:51]
    v_cndmask_b32 v32, v36, v32, s[60:61]
    v_cndmask_b32 v33, v37, v33, s[60:61]
    v_cndmask_b32 v34, v38, v34, s[60:61]
    v_cndmask_b32 v35, v39, v35, s[60:61]
    v_and_or_b32 v32, v32, v246, v245
    v_and_or_b32 v33, v33, v246, v245
    v_and_or_b32 v34, v34, v246, v245
    v_and_or_b32 v35, v35, v246, v245
    buffer_store_dwordx4 v[32:35], v243, s[32:35], s62 offen sc1
    v_cndmask_b32 v40, v44, v40, s[60:61]
    v_cndmask_b32 v41, v45, v41, s[60:61]
    v_cndmask_b32 v42, v46, v42, s[60:61]
    v_cndmask_b32 v43, v47, v43, s[60:61]
    v_and_or_b32 v40, v40, v246, v245
    v_and_or_b32 v41, v41, v246, v245
    v_and_or_b32 v42, v42, v246, v245
    v_and_or_b32 v43, v43, v246, v245
    buffer_store_dwordx4 v[40:43], v243, s[32:35], s54 offen sc1
    v_and_or_b32 v48, v48, v246, v245
    v_and_or_b32 v49, v49, v246, v245
    v_and_or_b32 v50, v50, v246, v245
    v_and_or_b32 v51, v51, v246, v245
    s_mov_b64 exec, s[60:61]
    buffer_store_dwordx4 v[48:51], v243, s[32:35], s55 offen sc1
    s_branch DUMP
F_T4:
    s_nop 1
    v_cndmask_b32 v32, v36, v32, s[60:61]
    v_cndmask_b32 v33, v37, v33, s[60:61]
    v_cndmask_b32 v34, v38, v34, s[60:61]
    v_cndmask_b32 v35, v39, v35, s[60:61]
    v_and_or_b32 v32, v32, v246, v245
    v_and_or_b32 v33, v33, v246, v245
    v_and_or_b32 v34, v34, v246, v245
    v_and_or_b32 v35, v35, v246, v245
    buffer_store_dwordx4 v[32:35], v243, s[32:35], s62 offen sc1
    v_cndmask_b32 v40, v44, v40, s[60:61]
    v_cndmask_b32 v41, v45, v41, s[60:61]
    v_cndmask_b32 v42, v46, v42, s[60:61]
    v_cndmask_b32 v43, v47, v43, s[60:61]
    v_and_or_b32 v40, v40, v246, v245
    v_and_or_b32 v41, v41, v246, v245
    v_and_or_b32 v42, v42, v246, v245
    v_and_or_b32 v43, v43, v246, v245
    buffer_store_dwordx4 v[40:43], v243, s[32:35], s54 offen sc1
DUMP:
END:
    s_endpgm
.p2align 7
.type TBL,@object
TBL:
.long 0x0, 0x0, 0x0, 0x0, 0x0, 0x0, 0x0, 0x0
.long 0x0, 0x0, 0x0, 0x0, 0x0, 0x0, 0x0, 0x0
.long 0x0, 0x0, 0x0, 0x0, 0x0, 0x0, 0x0, 0x0
.long 0x0, 0x0, 0x0, 0x0, 0x0, 0x0, 0x0, 0x0
.long 0x0, 0x0, 0x0, 0x0, 0x0, 0x0, 0x0, 0x0
.long 0x0, 0x0, 0x0, 0x0, 0x0, 0x0, 0x0, 0x0
.long 0x0, 0x0, 0x0, 0x0, 0x0, 0x0, 0x0, 0x0
.long 0x0, 0x0, 0x0, 0x0, 0x0, 0x0, 0x0, 0x0
.long 0x0, 0x3c000000, 0x3c003c00, 0x0, 0x0, 0x0, 0x3c003c00, 0x3c00
.long 0x0, 0x0, 0x3c000000, 0x3c003c00, 0x0, 0x0, 0x0, 0x3c003c00
.long 0x0, 0x0, 0x0, 0x3c000000, 0x0, 0x0, 0x0, 0x0
.long 0x0, 0x0, 0x0, 0x0, 0x0, 0x0, 0x0, 0x0
.long 0x0, 0x0, 0x0, 0x0, 0x0, 0x0, 0x0, 0x0
.long 0x0, 0x0, 0x0, 0x0, 0x0, 0x0, 0x0, 0x0
.long 0x0, 0x0, 0x0, 0x0, 0x0, 0x0, 0x0, 0x0
.long 0x0, 0x0, 0x0, 0x0, 0x0, 0x0, 0x0, 0x0
.long 0x0, 0x0, 0x0, 0x0, 0x0, 0x0, 0x0, 0x0
.long 0x0, 0x0, 0x0, 0x0, 0x3c00, 0x0, 0x0, 0x0
.long 0x3c003c00, 0x0, 0x0, 0x0, 0x3c003c00, 0x3c00, 0x0, 0x0
.long 0x3c000000, 0x3c003c00, 0x0, 0x0, 0x0, 0x3c003c00, 0x3c00, 0x0
.long 0x0, 0x3c000000, 0x3c003c00, 0x0, 0x0, 0x0, 0x3c003c00, 0x3c00
.long 0x0, 0x0, 0x3c000000, 0x3c003c00, 0x0, 0x0, 0x0, 0x3c003c00
.long 0x0, 0x0, 0x0, 0x3c000000, 0x0, 0x0, 0x0, 0x0
.long 0x0, 0x0, 0x0, 0x0, 0x0, 0x0, 0x0, 0x0
.long 0x0, 0x0, 0x0, 0x0, 0x0, 0x0, 0x0, 0x0
.long 0x0, 0x0, 0x0, 0x0, 0x0, 0x0, 0x0, 0x0
.long 0x0, 0x0, 0x0, 0x0, 0x0, 0x0, 0x0, 0x0
.long 0x0, 0x0, 0x0, 0x0, 0x0, 0x0, 0x0, 0x0
.long 0x0, 0x0, 0x0, 0x0, 0x0, 0x0, 0x0, 0x0
.long 0x0, 0x0, 0x0, 0x0, 0x3c00, 0x0, 0x0, 0x0
.long 0x3c003c00, 0x0, 0x0, 0x0, 0x3c003c00, 0x3c00, 0x0, 0x0
.long 0x3c000000, 0x3c003c00, 0x0, 0x0, 0x0, 0x3c003c00, 0x3c00, 0x0
.long 0x0, 0x0, 0x0, 0x3c003c00, 0x0, 0x0, 0x0, 0x3c000000
.long 0x0, 0x0, 0x0, 0x0, 0x0, 0x0, 0x0, 0x0
.long 0x0, 0x0, 0x0, 0x0, 0x0, 0x0, 0x0, 0x0
.long 0x0, 0x0, 0x0, 0x0, 0x0, 0x0, 0x0, 0x0
.long 0x0, 0x0, 0x0, 0x0, 0x0, 0x0, 0x0, 0x0
.long 0x0, 0x0, 0x0, 0x0, 0x0, 0x0, 0x0, 0x0
.long 0x0, 0x0, 0x0, 0x0, 0x0, 0x0, 0x0, 0x0
.long 0x0, 0x0, 0x0, 0x0, 0x0, 0x0, 0x0, 0x0
.long 0x3c003c00, 0x3c00, 0x0, 0x0, 0x3c003c00, 0x3c003c00, 0x0, 0x0
.long 0x3c003c00, 0x3c003c00, 0x3c00, 0x0, 0x3c000000, 0x3c003c00, 0x3c003c00, 0x0
.long 0x0, 0x3c003c00, 0x3c003c00, 0x3c00, 0x0, 0x3c000000, 0x3c003c00, 0x3c003c00
.long 0x0, 0x0, 0x3c003c00, 0x3c003c00, 0x0, 0x0, 0x3c000000, 0x3c003c00
.long 0x0, 0x0, 0x0, 0x3c003c00, 0x0, 0x0, 0x0, 0x3c000000
.long 0x0, 0x0, 0x0, 0x0, 0x0, 0x0, 0x0, 0x0
.long 0x0, 0x0, 0x0, 0x0, 0x0, 0x0, 0x0, 0x0
.long 0x0, 0x0, 0x0, 0x0, 0x0, 0x0, 0x0, 0x0
.long 0x0, 0x0, 0x0, 0x0, 0x0, 0x0, 0x0, 0x0
.long 0x0, 0x0, 0x0, 0x0, 0x0, 0x0, 0x0, 0x0
.long 0x0, 0x0, 0x0, 0x0, 0x0, 0x0, 0x0, 0x0
.long 0x3c00, 0x0, 0x0, 0x0, 0x3c003c00, 0x0, 0x0, 0x0
.long 0x3c003c00, 0x3c00, 0x0, 0x0, 0x3c003c00, 0x3c003c00, 0x0, 0x0
.long 0x3c003c00, 0x3c003c00, 0x3c00, 0x0, 0x3c000000, 0x3c003c00, 0x3c003c00, 0x0
.long 0x0, 0x3c003c00, 0x3c003c00, 0x3c00, 0x0, 0x3c000000, 0x3c003c00, 0x3c003c00
.long 0x0, 0x0, 0x3c003c00, 0x3c003c00, 0x0, 0x0, 0x3c000000, 0x3c003c00
.long 0x0, 0x0, 0x0, 0x0, 0x0, 0x0, 0x0, 0x0
.long 0x0, 0x0, 0x0, 0x0, 0x0, 0x0, 0x0, 0x0
.long 0x0, 0x0, 0x0, 0x0, 0x0, 0x0, 0x0, 0x0
.long 0x0, 0x0, 0x0, 0x0, 0x0, 0x0, 0x0, 0x0
.long 0x0, 0x0, 0x0, 0x0, 0x0, 0x0, 0x0, 0x0
.long 0x0, 0x0, 0x0, 0x0, 0x0, 0x0, 0x0, 0x0
.long 0x0, 0x0, 0x0, 0x0, 0x0, 0x0, 0x0, 0x0
.long 0x3c00, 0x0, 0x0, 0x0, 0x3c003c00, 0x0, 0x0, 0x0
.long 0x0, 0x3c000000, 0x3c003c00, 0x0, 0x0, 0x0, 0x3c003c00, 0x3c00
.long 0x0, 0x0, 0x3c000000, 0x3c003c00, 0x0, 0x0, 0x0, 0x3c003c00
.long 0x0, 0x0, 0x0, 0x3c000000, 0x0, 0x0, 0x0, 0x0
.long 0x0, 0x0, 0x0, 0x0, 0x0, 0x0, 0x0, 0x0
.long 0x0, 0x0, 0x0, 0x0, 0x0, 0x0, 0x0, 0x0
.long 0x0, 0x0, 0x0, 0x0, 0x0, 0x0, 0x0, 0x0
.long 0x0, 0x0, 0x0, 0x0, 0x0, 0x0, 0x0, 0x0
.long 0x0, 0x0, 0x0, 0x0, 0x0, 0x0, 0x0, 0x0
.long 0x0, 0x0, 0x0, 0x0, 0x0, 0x0, 0x0, 0x0
.long 0x0, 0x0, 0x0, 0x0, 0x3c00, 0x0, 0x0, 0x0
.long 0x3c003c00, 0x0, 0x0, 0x0, 0x3c003c00, 0x3c00, 0x0, 0x0
.long 0x3c000000, 0x3c003c00, 0x0, 0x0, 0x0, 0x3c003c00, 0x3c00, 0x0
.long 0x0, 0x3c000000, 0x3c003c00, 0x0, 0x0, 0x0, 0x3c003c00, 0x3c00
.long 0x0, 0x0, 0x3c000000, 0x3c003c00, 0x0, 0x0, 0x0, 0x3c003c00
.long 0x0, 0x0, 0x0, 0x3c000000, 0x0, 0x0, 0x0, 0x0
.long 0x0, 0x0, 0x0, 0x0, 0x0, 0x0, 0x0, 0x0
.long 0x0, 0x0, 0x0, 0x0, 0x0, 0x0, 0x0, 0x0
.long 0x0, 0x0, 0x0, 0x0, 0x0, 0x0, 0x0, 0x0
.long 0x0, 0x0, 0x0, 0x0, 0x0, 0x0, 0x0, 0x0
.long 0x0, 0x0, 0x0, 0x0, 0x0, 0x0, 0x0, 0x0
.long 0x0, 0x0, 0x0, 0x0, 0x0, 0x0, 0x0, 0x0
.long 0x0, 0x0, 0x0, 0x0, 0x3c00, 0x0, 0x0, 0x0
.long 0x3c003c00, 0x0, 0x0, 0x0, 0x3c003c00, 0x3c00, 0x0, 0x0
.long 0x3c000000, 0x3c003c00, 0x0, 0x0, 0x0, 0x3c003c00, 0x3c00, 0x0
.long 0x0, 0x0, 0x0, 0x0, 0x0, 0x0, 0x0, 0x0
.long 0x0, 0x0, 0x0, 0x0, 0x0, 0x0, 0x0, 0x0
.long 0x0, 0x0, 0x0, 0x0, 0x0, 0x0, 0x0, 0x0
.long 0x0, 0x0, 0x0, 0x0, 0x0, 0x0, 0x0, 0x0
.long 0x0, 0x0, 0x0, 0x0, 0x0, 0x0, 0x0, 0x0
.long 0x0, 0x0, 0x0, 0x0, 0x0, 0x0, 0x0, 0x0
.long 0x0, 0x0, 0x0, 0x0, 0x0, 0x0, 0x0, 0x0
.long 0x0, 0x0, 0x0, 0x0, 0x0, 0x0, 0x0, 0x0
.long 0x0, 0x0, 0x0, 0x3c003c00, 0x0, 0x0, 0x0, 0x3c000000
.long 0x0, 0x0, 0x0, 0x0, 0x0, 0x0, 0x0, 0x0
.long 0x0, 0x0, 0x0, 0x0, 0x0, 0x0, 0x0, 0x0
.long 0x0, 0x0, 0x0, 0x0, 0x0, 0x0, 0x0, 0x0
.long 0x0, 0x0, 0x0, 0x0, 0x0, 0x0, 0x0, 0x0
.long 0x0, 0x0, 0x0, 0x0, 0x0, 0x0, 0x0, 0x0
.long 0x0, 0x0, 0x0, 0x0, 0x0, 0x0, 0x0, 0x0
.long 0x0, 0x0, 0x0, 0x0, 0x0, 0x0, 0x0, 0x0
.long 0x3c003c00, 0x3c00, 0x0, 0x0, 0x3c003c00, 0x3c003c00, 0x0, 0x0
.long 0x3c003c00, 0x3c003c00, 0x3c00, 0x0, 0x3c000000, 0x3c003c00, 0x3c003c00, 0x0
.long 0x0, 0x3c003c00, 0x3c003c00, 0x3c00, 0x0, 0x3c000000, 0x3c003c00, 0x3c003c00
.long 0x0, 0x0, 0x3c003c00, 0x3c003c00, 0x0, 0x0, 0x3c000000, 0x3c003c00
.long 0x0, 0x0, 0x0, 0x3c003c00, 0x0, 0x0, 0x0, 0x3c000000
.long 0x0, 0x0, 0x0, 0x0, 0x0, 0x0, 0x0, 0x0
.long 0x0, 0x0, 0x0, 0x0, 0x0, 0x0, 0x0, 0x0
.long 0x0, 0x0, 0x0, 0x0, 0x0, 0x0, 0x0, 0x0
.long 0x0, 0x0, 0x0, 0x0, 0x0, 0x0, 0x0, 0x0
.long 0x0, 0x0, 0x0, 0x0, 0x0, 0x0, 0x0, 0x0
.long 0x0, 0x0, 0x0, 0x0, 0x0, 0x0, 0x0, 0x0
.long 0x3c00, 0x0, 0x0, 0x0, 0x3c003c00, 0x0, 0x0, 0x0
.long 0x3c003c00, 0x3c00, 0x0, 0x0, 0x3c003c00, 0x3c003c00, 0x0, 0x0
.long 0x3c003c00, 0x3c003c00, 0x3c00, 0x0, 0x3c000000, 0x3c003c00, 0x3c003c00, 0x0
.long 0x0, 0x3c003c00, 0x3c003c00, 0x3c00, 0x0, 0x3c000000, 0x3c003c00, 0x3c003c00
.long 0x0, 0x0, 0x3c003c00, 0x3c003c00, 0x0, 0x0, 0x3c000000, 0x3c003c00
.long 0x0, 0x0, 0x0, 0x0, 0x0, 0x0, 0x0, 0x0
.long 0x0, 0x0, 0x0, 0x0, 0x0, 0x0, 0x0, 0x0
.long 0x0, 0x0, 0x0, 0x0, 0x0, 0x0, 0x0, 0x0
.long 0x0, 0x0, 0x0, 0x0, 0x0, 0x0, 0x0, 0x0
.long 0x0, 0x0, 0x0, 0x0, 0x0, 0x0, 0x0, 0x0
.long 0x0, 0x0, 0x0, 0x0, 0x0, 0x0, 0x0, 0x0
.long 0x0, 0x0, 0x0, 0x0, 0x0, 0x0, 0x0, 0x0
.long 0x3c00, 0x0, 0x0, 0x0, 0x3c003c00, 0x0, 0x0, 0x0
.long 0x0, 0x0, 0x3c000000, 0x3c003c00, 0x0, 0x0, 0x0, 0x3c003c00
.long 0x0, 0x0, 0x0, 0x3c000000, 0x0, 0x0, 0x0, 0x0
.long 0x0, 0x0, 0x0, 0x0, 0x0, 0x0, 0x0, 0x0
.long 0x0, 0x0, 0x0, 0x0, 0x0, 0x0, 0x0, 0x0
.long 0x0, 0x0, 0x0, 0x0, 0x0, 0x0, 0x0, 0x0
.long 0x0, 0x0, 0x0, 0x0, 0x0, 0x0, 0x0, 0x0
.long 0x0, 0x0, 0x0, 0x0, 0x0, 0x0, 0x0, 0x0
.long 0x0, 0x0, 0x0, 0x0, 0x0, 0x0, 0x0, 0x0
.long 0x3c003c00, 0x3c003c00, 0x0, 0x0, 0x3c003c00, 0x3c003c00, 0x3c00, 0x0
.long 0x3c003c00, 0x3c003c00, 0x3c003c00, 0x0, 0x3c003c00, 0x3c003c00, 0x3c003c00, 0x3c00
.long 0x3c000000, 0x3c003c00, 0x3c003c00, 0x3c003c00, 0x0, 0x3c003c00, 0x3c003c00, 0x3c003c00
.long 0x0, 0x3c000000, 0x3c003c00, 0x3c003c00, 0x0, 0x0, 0x3c003c00, 0x3c003c00
.long 0x0, 0x0, 0x3c000000, 0x3c003c00, 0x0, 0x0, 0x0, 0x3c003c00
.long 0x0, 0x0, 0x0, 0x3c000000, 0x0, 0x0, 0x0, 0x0
.long 0x0, 0x0, 0x0, 0x0, 0x0, 0x0, 0x0, 0x0
.long 0x0, 0x0, 0x0, 0x0, 0x0, 0x0, 0x0, 0x0
.long 0x0, 0x0, 0x0, 0x0, 0x0, 0x0, 0x0, 0x0
.long 0x0, 0x0, 0x0, 0x0, 0x0, 0x0, 0x0, 0x0
.long 0x0, 0x0, 0x0, 0x0, 0x3c00, 0x0, 0x0, 0x0
.long 0x3c003c00, 0x0, 0x0, 0x0, 0x3c003c00, 0x3c00, 0x0, 0x0
.long 0x3c003c00, 0x3c003c00, 0x0, 0x0, 0x3c003c00, 0x3c003c00, 0x3c00, 0x0
.long 0x3c003c00, 0x3c003c00, 0x3c003c00, 0x0, 0x3c003c00, 0x3c003c00, 0x3c003c00, 0x3c00
.long 0x3c000000, 0x3c003c00, 0x3c003c00, 0x3c003c00, 0x0, 0x3c003c00, 0x3c003c00, 0x3c003c00
.long 0x0, 0x3c000000, 0x3c003c00, 0x3c003c00, 0x0, 0x0, 0x3c003c00, 0x3c003c00
.long 0x0, 0x0, 0x0, 0x0, 0x0, 0x0, 0x0, 0x0
.long 0x0, 0x0, 0x0, 0x0, 0x0, 0x0, 0x0, 0x0
.long 0x0, 0x0, 0x0, 0x0, 0x0, 0x0, 0x0, 0x0
.long 0x0, 0x0, 0x0, 0x0, 0x0, 0x0, 0x0, 0x0
.long 0x0, 0x0, 0x0, 0x0, 0x0, 0x0, 0x0, 0x0
.long 0x0, 0x0, 0x0, 0x0, 0x0, 0x0, 0x0, 0x0
.long 0x0, 0x0, 0x0, 0x0, 0x3c00, 0x0, 0x0, 0x0
.long 0x3c003c00, 0x0, 0x0, 0x0, 0x3c003c00, 0x3c00, 0x0, 0x0
.long 0x0, 0x0, 0x3c003c00, 0x3c003c00, 0x0, 0x0, 0x3c000000, 0x3c003c00
.long 0x0, 0x0, 0x0, 0x3c003c00, 0x0, 0x0, 0x0, 0x3c000000
.long 0x0, 0x0, 0x0, 0x0, 0x0, 0x0, 0x0, 0x0
.long 0x0, 0x0, 0x0, 0x0, 0x0, 0x0, 0x0, 0x0
.long 0x0, 0x0, 0x0, 0x0, 0x0, 0x0, 0x0, 0x0
.long 0x0, 0x0, 0x0, 0x0, 0x0, 0x0, 0x0, 0x0
.long 0x0, 0x0, 0x0, 0x0, 0x0, 0x0, 0x0, 0x0
.long 0x0, 0x0, 0x0, 0x0, 0x0, 0x0, 0x0, 0x0
.long 0x3c003c00, 0x3c003c00, 0x3c00, 0x0, 0x3c003c00, 0x3c003c00, 0x3c003c00, 0x0
.long 0x3c003c00, 0x3c003c00, 0x3c003c00, 0x3c00, 0x3c003c00, 0x3c003c00, 0x3c003c00, 0x3c003c00
.long 0x3c003c00, 0x3c003c00, 0x3c003c00, 0x3c003c00, 0x3c000000, 0x3c003c00, 0x3c003c00, 0x3c003c00
.long 0x0, 0x3c003c00, 0x3c003c00, 0x3c003c00, 0x0, 0x3c000000, 0x3c003c00, 0x3c003c00
.long 0x0, 0x0, 0x3c003c00, 0x3c003c00, 0x0, 0x0, 0x3c000000, 0x3c003c00
.long 0x0, 0x0, 0x0, 0x3c003c00, 0x0, 0x0, 0x0, 0x3c000000
.long 0x0, 0x0, 0x0, 0x0, 0x0, 0x0, 0x0, 0x0
.long 0x0, 0x0, 0x0, 0x0, 0x0, 0x0, 0x0, 0x0
.long 0x0, 0x0, 0x0, 0x0, 0x0, 0x0, 0x0, 0x0
.long 0x0, 0x0, 0x0, 0x0, 0x0, 0x0, 0x0, 0x0
.long 0x3c00, 0x0, 0x0, 0x0, 0x3c003c00, 0x0, 0x0, 0x0
.long 0x3c003c00, 0x3c00, 0x0, 0x0, 0x3c003c00, 0x3c003c00, 0x0, 0x0
.long 0x3c003c00, 0x3c003c00, 0x3c00, 0x0, 0x3c003c00, 0x3c003c00, 0x3c003c00, 0x0
.long 0x3c003c00, 0x3c003c00, 0x3c003c00, 0x3c00, 0x3c003c00, 0x3c003c00, 0x3c003c00, 0x3c003c00
.long 0x3c003c00, 0x3c003c00, 0x3c003c00, 0x3c003c00, 0x3c000000, 0x3c003c00, 0x3c003c00, 0x3c003c00
.long 0x0, 0x3c003c00, 0x3c003c00, 0x3c003c00, 0x0, 0x3c000000, 0x3c003c00, 0x3c003c00
.long 0x0, 0x0, 0x0, 0x0, 0x0, 0x0, 0x0, 0x0
.long 0x0, 0x0, 0x0, 0x0, 0x0, 0x0, 0x0, 0x0
.long 0x0, 0x0, 0x0, 0x0, 0x0, 0x0, 0x0, 0x0
.long 0x0, 0x0, 0x0, 0x0, 0x0, 0x0, 0x0, 0x0
.long 0x0, 0x0, 0x0, 0x0, 0x0, 0x0, 0x0, 0x0
.long 0x0, 0x0, 0x0, 0x0, 0x0, 0x0, 0x0, 0x0
.long 0x3c00, 0x0, 0x0, 0x0, 0x3c003c00, 0x0, 0x0, 0x0
.long 0x3c003c00, 0x3c00, 0x0, 0x0, 0x3c003c00, 0x3c003c00, 0x0, 0x0
.long 0x0, 0x0, 0x0, 0x0, 0x0, 0x0, 0x0, 0x0
.long 0x0, 0x0, 0x0, 0x0, 0x0, 0x0, 0x0, 0x0
.long 0x0, 0x0, 0x0, 0x0, 0x0, 0x0, 0x0, 0x0
.long 0x0, 0x0, 0x0, 0x0, 0x0, 0x0, 0x0, 0x0
.long 0x0, 0x0, 0x0, 0x0, 0x0, 0x0, 0x0, 0x0
.long 0x0, 0x0, 0x0, 0x0, 0x0, 0x0, 0x0, 0x0
.long 0x0, 0x0, 0x0, 0x0, 0x0, 0x0, 0x0, 0x0
.long 0x0, 0x0, 0x0, 0x0, 0x0, 0x0, 0x0, 0x0
.long 0x0, 0x0, 0xffffffff, 0x0, 0x0, 0x0, 0xffff0000, 0xffff
.long 0x0, 0x0, 0x0, 0xffffffff, 0x0, 0x0, 0x0, 0xffff0000
.long 0x0, 0x0, 0x0, 0x0, 0x0, 0x0, 0x0, 0x0
.long 0x0, 0x0, 0x0, 0x0, 0x0, 0x0, 0x0, 0x0
.long 0x0, 0x0, 0x0, 0x0, 0x0, 0x0, 0x0, 0x0
.long 0x0, 0x0, 0x0, 0x0, 0x0, 0x0, 0x0, 0x0
.long 0x0, 0x0, 0x0, 0x0, 0x0, 0x0, 0x0, 0x0
.long 0x0, 0x0, 0x0, 0x0, 0x0, 0x0, 0x0, 0x0
.long 0x0, 0x0, 0x0, 0x0, 0x0, 0x0, 0x0, 0x0
.long 0x0, 0x0, 0x0, 0x0, 0xffff, 0x0, 0x0, 0x0
.long 0xffffffff, 0x0, 0x0, 0x0, 0xffff0000, 0xffff, 0x0, 0x0
.long 0x0, 0xffffffff, 0x0, 0x0, 0x0, 0xffff0000, 0xffff, 0x0
.long 0x0, 0x0, 0xffffffff, 0x0, 0x0, 0x0, 0xffff0000, 0xffff
.long 0x0, 0x0, 0x0, 0xffffffff, 0x0, 0x0, 0x0, 0xffff0000
.long 0x0, 0x0, 0x0, 0x0, 0x0, 0x0, 0x0, 0x0
.long 0x0, 0x0, 0x0, 0x0, 0x0, 0x0, 0x0, 0x0
.long 0x0, 0x0, 0x0, 0x0, 0x0, 0x0, 0x0, 0x0
.long 0x0, 0x0, 0x0, 0x0, 0x0, 0x0, 0x0, 0x0
.long 0x0, 0x0, 0x0, 0x0, 0x0, 0x0, 0x0, 0x0
.long 0x0, 0x0, 0x0, 0x0, 0x0, 0x0, 0x0, 0x0
.long 0x0, 0x0, 0x0, 0x0, 0x0, 0x0, 0x0, 0x0
.long 0x0, 0x0, 0x0, 0x0, 0xffff, 0x0, 0x0, 0x0
.long 0xffffffff, 0x0, 0x0, 0x0, 0xffff0000, 0xffff, 0x0, 0x0
.long 0x0, 0xffffffff, 0x0, 0x0, 0x0, 0xffff0000, 0xffff, 0x0
.long 0x878, 0x438, 0x230, 0x238, 0x858, 0x418, 0x210, 0x218
.long 0x838, 0x3f8, 0x1f0, 0x1f8, 0x818, 0x3d8, 0x1d0, 0x1d8
.long 0x7f8, 0x3b8, 0x1b0, 0x1b8, 0x7d8, 0x398, 0x190, 0x198
.long 0x7b8, 0x378, 0x170, 0x178, 0x798, 0x358, 0x150, 0x158
.long 0x778, 0x338, 0x130, 0x138, 0x758, 0x318, 0x110, 0x118
.long 0x738, 0x2f8, 0xf0, 0xf8, 0x718, 0x2d8, 0xd0, 0xd8
.long 0x6f8, 0x2b8, 0xb0, 0xb8, 0x6d8, 0x298, 0x90, 0x98
.long 0x6b8, 0x278, 0x70, 0x78, 0x698, 0x258, 0x50, 0x58
.long 0x868, 0x428, 0x220, 0x228, 0x848, 0x408, 0x200, 0x208
.long 0x828, 0x3e8, 0x1e0, 0x1e8, 0x808, 0x3c8, 0x1c0, 0x1c8
.long 0x7e8, 0x3a8, 0x1a0, 0x1a8, 0x7c8, 0x388, 0x180, 0x188
.long 0x7a8, 0x368, 0x160, 0x168, 0x788, 0x348, 0x140, 0x148
.long 0x768, 0x328, 0x120, 0x128, 0x748, 0x308, 0x100, 0x108
.long 0x728, 0x2e8, 0xe0, 0xe8, 0x708, 0x2c8, 0xc0, 0xc8
.long 0x6e8, 0x2a8, 0xa0, 0xa8, 0x6c8, 0x288, 0x80, 0x88
.long 0x6a8, 0x268, 0x60, 0x68, 0x688, 0x248, 0x40, 0x48
.long 0x870, 0x430, 0x90c, 0x94c, 0x850, 0x410, 0x908, 0x948
.long 0x830, 0x3f0, 0x904, 0x944, 0x810, 0x3d0, 0x900, 0x940
.long 0x7f0, 0x3b0, 0x8fc, 0x93c, 0x7d0, 0x390, 0x8f8, 0x938
.long 0x7b0, 0x370, 0x8f4, 0x934, 0x790, 0x350, 0x8f0, 0x930
.long 0x770, 0x330, 0x8ec, 0x92c, 0x750, 0x310, 0x8e8, 0x928
.long 0x730, 0x2f0, 0x8e4, 0x924, 0x710, 0x2d0, 0x8e0, 0x920
.long 0x6f0, 0x2b0, 0x8dc, 0x91c, 0x6d0, 0x290, 0x8d8, 0x918
.long 0x6b0, 0x270, 0x8d4, 0x914, 0x690, 0x250, 0x8d0, 0x910
.long 0x860, 0x420, 0x9cc, 0xa0c, 0x840, 0x400, 0x9c8, 0xa08
.long 0x820, 0x3e0, 0x9c4, 0xa04, 0x800, 0x3c0, 0x9c0, 0xa00
.long 0x7e0, 0x3a0, 0x9bc, 0x9fc, 0x7c0, 0x380, 0x9b8, 0x9f8
.long 0x7a0, 0x360, 0x9b4, 0x9f4, 0x780, 0x340, 0x9b0, 0x9f0
.long 0x760, 0x320, 0x9ac, 0x9ec, 0x740, 0x300, 0x9a8, 0x9e8
.long 0x720, 0x2e0, 0x9a4, 0x9e4, 0x700, 0x2c0, 0x9a0, 0x9e0
.long 0x6e0, 0x2a0, 0x99c, 0x9dc, 0x6c0, 0x280, 0x998, 0x9d8
.long 0x6a0, 0x260, 0x994, 0x9d4, 0x680, 0x240, 0x990, 0x9d0
.long 0x22c, 0x670, 0xb90, 0x23e, 0x20c, 0x650, 0xb90, 0xb90
.long 0x1ec, 0x630, 0xb90, 0xb90, 0x1cc, 0x610, 0xb90, 0xb90
.long 0x1ac, 0x5f0, 0xb90, 0xb90, 0x18c, 0x5d0, 0xb90, 0xb90
.long 0x16c, 0x5b0, 0xb90, 0xb90, 0x14c, 0x590, 0xb90, 0xb90
.long 0x12c, 0x570, 0xb90, 0xb90, 0x10c, 0x550, 0xb90, 0xb90
.long 0xec, 0x530, 0xb90, 0xb90, 0xcc, 0x510, 0xb90, 0xb90
.long 0xac, 0x4f0, 0xb90, 0xb90, 0x8c, 0x4d0, 0xb90, 0xb90
.long 0x6c, 0x4b0, 0xb90, 0xb90, 0x4c, 0x490, 0xb90, 0xb90
.long 0x21c, 0x660, 0xb90, 0xb90, 0x1fc, 0x640, 0xb90, 0xb90
.long 0x1dc, 0x620, 0xb90, 0xb90, 0x1bc, 0x600, 0xb90, 0xb90
.long 0x19c, 0x5e0, 0xb90, 0xb90, 0x17c, 0x5c0, 0xb90, 0xb90
.long 0x15c, 0x5a0, 0xb90, 0xb90, 0x13c, 0x580, 0xb90, 0xb90
.long 0x11c, 0x560, 0xb90, 0xb90, 0xfc, 0x540, 0xb90, 0xb90
.long 0xdc, 0x520, 0xb90, 0xb90, 0xbc, 0x500, 0xb90, 0xb90
.long 0x9c, 0x4e0, 0xb90, 0xb90, 0x7c, 0x4c0, 0xb90, 0xb90
.long 0x5c, 0x4a0, 0xb90, 0xb90, 0x3c, 0x480, 0x47c, 0xb90
.long 0xb90, 0xb90, 0xb90, 0xb4c, 0xb90, 0xb90, 0xb90, 0xb48
.long 0xb90, 0xb90, 0xb90, 0xb44, 0xb90, 0xb90, 0xb90, 0xb40
.long 0xb90, 0xb90, 0xb90, 0xb3c, 0xb90, 0xb90, 0xb90, 0xb38
.long 0xb90, 0xb90, 0xb90, 0xb34, 0xb90, 0xb90, 0xb90, 0xb30
.long 0xb90, 0xb90, 0xb90, 0xb2c, 0xb90, 0xb90, 0xb90, 0xb28
.long 0xb90, 0xb90, 0xb90, 0xb24, 0xb90, 0xb90, 0xb90, 0xb20
.long 0xb90, 0xb90, 0xb90, 0xb1c, 0xb90, 0xb90, 0xb90, 0xb18
.long 0xb90, 0xb90, 0xb90, 0xb14, 0xb90, 0xb90, 0xb90, 0xb10
.long 0xb90, 0xb90, 0xb90, 0xb4e, 0xb90, 0xb90, 0xb90, 0xb4a
.long 0xb90, 0xb90, 0xb90, 0xb46, 0xb90, 0xb90, 0xb90, 0xb42
.long 0xb90, 0xb90, 0xb90, 0xb3e, 0xb90, 0xb90, 0xb90, 0xb3a
.long 0xb90, 0xb90, 0xb90, 0xb36, 0xb90, 0xb90, 0xb90, 0xb32
.long 0xb90, 0xb90, 0xb90, 0xb2e, 0xb90, 0xb90, 0xb90, 0xb2a
.long 0xb90, 0xb90, 0xb90, 0xb26, 0xb90, 0xb90, 0xb90, 0xb22
.long 0xb90, 0xb90, 0xb90, 0xb1e, 0xb90, 0xb90, 0xb90, 0xb1a
.long 0xb90, 0xb90, 0xb90, 0xb16, 0xb90, 0xb90, 0xb90, 0xb12
.long 0x23c, 0x880, 0xb90, 0x4200, 0xb90, 0xb90, 0xb90, 0x4c50
.long 0xb90, 0xb90, 0xb90, 0x4410, 0xb90, 0xb90, 0xb90, 0x5070
.long 0xb90, 0xb90, 0xb90, 0x5280, 0xb90, 0xb90, 0xb90, 0x4620
.long 0xb90, 0xb90, 0xb90, 0x5490, 0xb90, 0xb90, 0xb90, 0x4830
.long 0xb90, 0xb90, 0xb90, 0x6510, 0xb90, 0xb90, 0xb90, 0x6d50
.long 0xb90, 0xb90, 0xb90, 0x56a0, 0xb90, 0xb90, 0xb90, 0x4a40
.long 0xb90, 0xb90, 0xb90, 0x6720, 0xb90, 0xb90, 0xb90, 0x6b40
.long 0xb90, 0xb90, 0xb90, 0x6930, 0xb90, 0xb90, 0xb90, 0x58b0
.long 0xb90, 0xb90, 0xb90, 0x6300, 0xb90, 0xb90, 0xb90, 0x6300
.long 0xb90, 0xb90, 0xb90, 0x4e60, 0xb90, 0xb90, 0xb90, 0x4a40
.long 0xb90, 0xb90, 0xb90, 0x5ac0, 0xb90, 0xb90, 0xb90, 0x5cd0
.long 0xb90, 0xb90, 0xb90, 0x5ee0, 0xb90, 0xb90, 0xb90, 0x60f0
.long 0xb90, 0xb90, 0xb90, 0x4e60, 0xb90, 0xb90, 0xb90, 0x4200
.long 0xb90, 0xb90, 0xb90, 0x4c50, 0xb90, 0xb90, 0xb90, 0x4410
.long 0xb90, 0xb90, 0xb90, 0x5070, 0xb90, 0xb90, 0xb90, 0x5280
.long 0xb90, 0xb90, 0xb90, 0x4620, 0xb90, 0xb90, 0x3a, 0x5490
.long 0xb0c, 0xacc, 0xa8c, 0x4210, 0xb08, 0xac8, 0xa88, 0x4c60
.long 0xb04, 0xac4, 0xa84, 0x4420, 0xb00, 0xac0, 0xa80, 0x5080
.long 0xafc, 0xabc, 0xa7c, 0x5290, 0xaf8, 0xab8, 0xa78, 0x4630
.long 0xaf4, 0xab4, 0xa74, 0x54a0, 0xaf0, 0xab0, 0xa70, 0x4840
.long 0xaec, 0xaac, 0xa6c, 0x6520, 0xae8, 0xaa8, 0xa68, 0x6d60
.long 0xae4, 0xaa4, 0xa64, 0x56b0, 0xae0, 0xaa0, 0xa60, 0x4a50
.long 0xadc, 0xa9c, 0xa5c, 0x6730, 0xad8, 0xa98, 0xa58, 0x6b50
.long 0xad4, 0xa94, 0xa54, 0x6940, 0xad0, 0xa90, 0xa50, 0x58c0
.long 0xb0e, 0xace, 0xa8e, 0x6310, 0xb0a, 0xaca, 0xa8a, 0x6310
.long 0xb06, 0xac6, 0xa86, 0x4e70, 0xb02, 0xac2, 0xa82, 0x4a50
.long 0xafe, 0xabe, 0xa7e, 0x5ad0, 0xafa, 0xaba, 0xa7a, 0x5ce0
.long 0xaf6, 0xab6, 0xa76, 0x5ef0, 0xaf2, 0xab2, 0xa72, 0x6100
.long 0xaee, 0xaae, 0xa6e, 0x4e70, 0xaea, 0xaaa, 0xa6a, 0x4210
.long 0xae6, 0xaa6, 0xa66, 0x4c60, 0xae2, 0xaa2, 0xa62, 0x4420
.long 0xade, 0xa9e, 0xa5e, 0x5080, 0xada, 0xa9a, 0xa5a, 0x5290
.long 0xad6, 0xa96, 0xa56, 0x4630, 0xad2, 0xa92, 0xa52, 0x54a0
TBLEND:
.size TBL, .-TBL
.section .rodata,"a"
.p2align 6
.amdhsa_kernel sequential_preLN__ssm_conv_s4d__moe_arch_mod__prompt_kernel
  .amdhsa_next_free_vgpr 256
  .amdhsa_next_free_sgpr 102
  .amdhsa_accum_offset 256
  .amdhsa_group_segment_fixed_size 0
  .amdhsa_kernarg_size 120
  .amdhsa_user_sgpr_count 2
  .amdhsa_user_sgpr_kernarg_segment_ptr 1
  .amdhsa_system_sgpr_workgroup_id_x 1
.end_amdhsa_kernel
```

```asm
; @launch grid=(248,1,1) block=(512,1,1) lds=163840
.amdgcn_target "amdgcn-amd-amdhsa--gfx950"
.text
.globl sequential_preLN__ssm_conv_s4d__moe_arch_mod__prompt_kernel
.p2align 8
.type sequential_preLN__ssm_conv_s4d__moe_arch_mod__prompt_kernel,@function
sequential_preLN__ssm_conv_s4d__moe_arch_mod__prompt_kernel:
    s_cmp_ge_u32 s2, 248
    s_cbranch_scc1 END
    s_load_dwordx16 s[4:19], s[0:1], 0
    s_load_dwordx8 s[20:27], s[0:1], 64
    s_load_dwordx2 s[28:29], s[0:1], 96
    s_load_dwordx2 s[30:31], s[0:1], 112
    s_getpc_b64 s[42:43]
PC0:
    v_and_b32 v1, 63, v0
    v_lshrrev_b32 v14, 6, v0
    v_lshlrev_b32 v15, 7, v0
    v_readfirstlane_b32 s3, v14
    s_add_u32 s44, s42, TBL-PC0
    s_addc_u32 s45, s43, 0
    v_lshlrev_b32 v2, 4, v1
    v_lshlrev_b32 v3, 4, v0
    s_sub_u32 s50, s2, 192
    s_cmp_lt_u32 s50, 24
    s_cbranch_scc1 FROLE
    s_and_b32 s51, s3, 3
    s_lshr_b32 s46, s3, 2
    s_sub_u32 s49, s2, 120
    s_cmp_lt_u32 s2, 216
    s_cselect_b32 s49, 255, s49
    s_cmp_lt_u32 s2, 96
    s_cselect_b32 s49, s2, s49
    s_sub_u32 s38, s2, 96
    s_cmp_lt_u32 s49, 128
    s_cselect_b32 s38, s49, s38
    s_cselect_b32 s39, s46, 1
    s_lshl_b32 s48, s38, 1
    s_add_u32 s48, s48, s39
    s_lshl_b32 s48, s48, 3
    s_add_u32 s48, s48, s51
    s_mul_i32 s50, s48, 1152
    v_and_b32 v13, 31, v1
    v_lshrrev_b32 v15, 5, v1
    v_mul_u32_u24 v14, 4608, v15
    v_add_u32 v14, s50, v14
    v_lshlrev_b32 v12, 4, v13
    v_lshlrev_b32 v13, 2, v13
    v_add_u32 v4, v12, v14
    v_add_u32 v5, v13, v14
    s_cmp_ge_u32 s2, 216
    s_cselect_b32 s61, 0, s46
    s_lshl_b32 s52, s2, 2
    s_add_u32 s52, s52, s51
    s_lshl_b32 s53, s52, 8
    s_lshl_b32 s54, s46, 7
    s_add_u32 s53, s53, s54
    v_lshl_add_u32 v34, v1, 1, s53
    v_xor_b32 v35, 128, v34
    v_mov_b32 v28, 0
    v_mov_b32 v29, 0
    v_mov_b32 v30, 0
    v_mov_b32 v31, 0
    v_mov_b32 v32, 0
    v_mov_b32 v33, 0
    s_lshl_b32 s54, s2, 3
    s_cmp_lg_u32 s61, 0
    s_waitcnt lgkmcnt(0)
    s_cbranch_scc1 C_NOX
    global_load_dwordx4 v[16:19], v4, s[4:5] nt
    global_load_dwordx4 v[20:23], v4, s[4:5] offset:512 nt
    global_load_dword v24, v5, s[4:5] offset:1024 nt
C_NOX:
    s_load_dword s40, s[30:31], 0
    s_cmp_ge_u32 s2, 144
    s_cbranch_scc1 C_NOP
    s_load_dwordx2 s[56:57], s[14:15], s54
    global_load_short_d16_hi v28, v34, s[6:7] nt
    global_load_short_d16_hi v29, v34, s[8:9] nt
    global_load_short_d16_hi v30, v34, s[10:11] nt
    global_load_short_d16_hi v31, v34, s[12:13] nt
    global_load_short_d16_hi v32, v35, s[10:11] nt
    global_load_short_d16_hi v33, v35, s[12:13] nt
C_NOP:
    s_mov_b32 s32, s30
    s_and_b32 s33, s31, 0xffff
    s_mov_b32 s34, 0x10000000
    s_mov_b32 s35, 0x00020000
    v_mov_b32 v6, 0x3f80
    v_mov_b32 v7, 1.0
    v_mov_b32 v8, 0x3f803f80
    v_mov_b32 v9, 0xfff8fff8
    v_mov_b32 v11, 0x40004
    v_mul_u32_u24 v15, 4736, v15
    s_and_b32 s46, s3, 4
    s_add_u32 s46, s46, s3
    s_mul_i32 s46, s46, 1184
    s_add_u32 s46, s46, 132608
    v_add_u32 v15, s46, v15
    v_add_u32 v25, v12, v15
    v_add_u32 v26, v13, v15
    s_lshr_b32 s46, s3, 2
    s_lshl_b32 s46, s46, 8
    s_mul_i32 s60, s51, 28512
    s_add_u32 s46, s60, s46
    v_lshl_add_u32 v40, v1, 2, s46
    v_add_u32 v41, 528, v40
    v_add_u32 v42, 1056, v40
    v_add_u32 v43, 1584, v40
    v_add_u32 v44, 2112, v40
    v_add_u32 v45, 2640, v40
    v_add_u32 v46, 3168, v40
    v_add_u32 v47, 3696, v40
    v_add_u32 v48, 4224, v40
    v_add_u32 v49, 4752, v40
    v_add_u32 v50, 5280, v40
    v_add_u32 v51, 5808, v40
    v_add_u32 v52, 6336, v40
    v_add_u32 v53, 6864, v40
    v_add_u32 v54, 7392, v40
    v_add_u32 v55, 7920, v40
    s_mul_i32 s62, s51, 2976
    s_add_u32 s62, s62, 151552
    s_cmp_ge_u32 s2, 144
    s_cbranch_scc1 C_O1
    s_cmp_lg_u32 s61, 0
    s_cbranch_scc1 C_O1
    v_and_b32 v14, 31, v1
    v_mul_u32_u24 v14, 528, v14
    v_lshrrev_b32 v15, 5, v1
    v_lshl_add_u32 v14, v15, 4, v14
    v_add_u32 v253, s60, v14
    v_add_u32 v27, 7168, v2
    v_mov_b32 v37, 0
    global_load_dwordx4 v[184:187], v27, s[44:45] offset:0
    global_load_dwordx4 v[188:191], v27, s[44:45] offset:1024
    global_load_dwordx4 v[192:195], v27, s[44:45] offset:2048
    global_load_dwordx4 v[208:211], v12, s[16:17]
    global_load_dwordx4 v[212:215], v12, s[16:17] offset:512
    global_load_dword v216, v13, s[16:17] offset:1024
    global_load_dwordx4 v[218:221], v12, s[20:21]
    global_load_dwordx4 v[222:225], v12, s[20:21] offset:512
    global_load_dword v226, v13, s[20:21] offset:1024
    s_waitcnt vmcnt(15)
    s_branch C_LN1
C_O1:
    v_bfe_u32 v15, v1, 2, 2
    v_mul_u32_u24 v14, 1184, v15
    v_lshrrev_b32 v15, 4, v1
    v_lshl_add_u32 v14, v15, 5, v14
    v_and_b32 v15, 3, v1
    v_lshl_add_u32 v14, v15, 3, v14
    s_cmp_ge_u32 s2, 216
    s_cselect_b32 s46, s39, 0
    s_mul_i32 s53, s46, 9472
    s_lshl_b32 s55, s51, 7
    s_add_u32 s53, s53, s55
    s_add_u32 s53, s53, 132608
    v_add_u32 v36, s53, v14
    v_lshrrev_b32 v14, 2, v1
    v_lshlrev_b32 v15, 4, v15
    v_lshl_add_u32 v37, v14, 14, v15
    s_cmp_lt_u32 s2, 96
    s_cselect_b32 s46, 0, s39
    s_lshl_b32 s46, s46, 6
    s_lshl_b32 s55, s38, 7
    s_add_u32 s55, s55, s46
    s_lshl_b32 s46, s51, 18
    s_add_u32 s55, s55, s46
    s_add_u32 s55, s55, 1048576
    s_add_u32 s36, s55, 1048576
    s_add_u32 s37, s55, 2097152
    v_mov_b32 v120, 0
    v_mov_b32 v121, 0
    v_mov_b32 v122, 0
    v_mov_b32 v123, 0
    s_lshl_b32 s46, s51, 10
    s_add_u32 s46, s46, 151296
    v_add_u32 v14, s46, v2
    v_max_u32 v15, 151552, v14
    ds_write_b128 v15, v[120:123]
    ds_write_b128 v14, v[120:123] offset:4096
    ds_write_b128 v14, v[120:123] offset:8192
    s_mul_i32 s46, s51, 4640
    s_add_u32 s46, s46, 114048
    v_add_u32 v14, s46, v12
    ds_write_b128 v14, v[120:123]
    s_waitcnt lgkmcnt(0)
    s_add_u32 s40, s40, 1
    s_and_b32 s41, s40, 7
    s_bfe_u32 s46, s40, 0x30003
    s_lshl_b32 s46, s46, 16
    s_or_b32 s41, s41, s46
    v_mov_b32 v10, s41
    s_cmp_eq_u32 s61, 0
    s_cbranch_scc1 C_O2
    s_cmp_ge_u32 s2, 144
    s_cbranch_scc1 C_BA
    s_waitcnt vmcnt(0)
    s_bitcmp1_b32 s51, 1
    s_cselect_b32 s56, s57, s56
    s_lshl_b32 s57, s56, 16
    s_and_b32 s56, s56, 0xffff0000
    s_bitcmp1_b32 s51, 0
    s_cselect_b32 s56, s56, s57
    v_mov_b32 v60, 0x3fb8aa3b
    v_mul_f32 v62, 0x3fb8aa3b, v28
    v_mul_f32 v60, s56, v60
    v_exp_f32 v62, v62
    v_exp_f32 v60, v60
    v_add_f32 v64, |v30|, |v31|
    v_add_f32 v65, |v32|, |v33|
    v_cvt_pk_bf16_f32 v62, 0, v62
    v_cvt_pk_bf16_f32 v60, 0, v60
    v_add_f32 v64, v64, v65
    v_mul_f32 v62, v62, v60
    v_mul_f32 v63, v29, v60
    v_mul_f32 v62, 0xbfb8aa3b, v62
    v_mul_f32 v63, 0.15915494, v63
    v_mul_f32 v104, 0x41000000, v62
    v_add_f32_dpp v64, v64, v64 row_ror:8 row_mask:0xf bank_mask:0xf
    v_mul_f32 v105, 0x41000000, v63
    v_exp_f32 v104, v104
    v_fract_f32 v105, v105
    v_add_f32_dpp v64, v64, v64 row_ror:4 row_mask:0xf bank_mask:0xf
    v_cos_f32 v72, v105
    v_sin_f32 v73, v105
    v_add_f32_dpp v64, v64, v64 row_ror:2 row_mask:0xf bank_mask:0xf
    v_pk_mul_f32 v[72:73], v[72:73], v[104:105] op_sel_hi:[1,0] neg_hi:[1,0]
    v_exp_f32 v106, v62
    v_add_f32_dpp v64, v64, v64 row_ror:1 row_mask:0xf bank_mask:0xf
    v_fract_f32 v107, v63
    v_cos_f32 v66, v107
    v_sin_f32 v67, v107
    v_mov_b32 v65, v64
    v_pk_mul_f32 v[66:67], v[66:67], v[106:107] op_sel_hi:[1,0]
    v_mul_f32 v108, 0x43800000, v62
    v_permlane16_swap_b32 v64, v65
    v_mul_f32 v109, 0x43800000, v63
    v_exp_f32 v108, v108
    v_add_f32 v64, v64, v65
    v_fract_f32 v109, v109
    v_cos_f32 v68, v109
    v_sin_f32 v69, v109
    v_mov_b32 v65, v64
    v_pk_mul_f32 v[68:69], v[68:69], v[108:109] op_sel_hi:[1,0]
    v_mov_b32 v162, 0x3c00
    v_pk_mul_f32 v[74:75], v[72:73], v[72:73] op_sel_hi:[1,0]
    v_permlane32_swap_b32 v64, v65
    v_pk_fma_f32 v[74:75], v[72:73], v[72:73], v[74:75] op_sel:[1,1,0] op_sel_hi:[0,1,1] neg_lo:[1,0,0]
    s_setprio 2
    s_branch C_BA
C_O2:
    global_load_dwordx4 v[208:211], v12, s[16:17]
    global_load_dwordx4 v[212:215], v12, s[16:17] offset:512
    global_load_dword v216, v13, s[16:17] offset:1024
    global_load_dwordx4 v[218:221], v12, s[20:21]
    global_load_dwordx4 v[222:225], v12, s[20:21] offset:512
    global_load_dword v226, v13, s[20:21] offset:1024
    s_waitcnt vmcnt(6)
C_LN1:
    v_dot2_f32_bf16 v120, v16, v8, 0
    v_dot2_f32_bf16 v121, v16, v16, 0
    v_dot2_f32_bf16 v120, v17, v8, v120
    v_dot2_f32_bf16 v121, v17, v17, v121
    v_dot2_f32_bf16 v120, v18, v8, v120
    v_dot2_f32_bf16 v121, v18, v18, v121
    v_dot2_f32_bf16 v120, v19, v8, v120
    v_dot2_f32_bf16 v121, v19, v19, v121
    v_dot2_f32_bf16 v120, v20, v8, v120
    v_dot2_f32_bf16 v121, v20, v20, v121
    v_dot2_f32_bf16 v120, v21, v8, v120
    v_dot2_f32_bf16 v121, v21, v21, v121
    v_dot2_f32_bf16 v120, v22, v8, v120
    v_dot2_f32_bf16 v121, v22, v22, v121
    v_dot2_f32_bf16 v120, v23, v8, v120
    v_dot2_f32_bf16 v121, v23, v23, v121
    v_dot2_f32_bf16 v120, v24, v8, v120
    v_dot2_f32_bf16 v121, v24, v24, v121
    s_nop 2
    v_permlane16_swap_b32 v120, v121
    v_add_f32 v120, v120, v121
    s_nop 1
    v_add_f32_dpp v120, v120, v120 row_ror:8 row_mask:0xf bank_mask:0xf
    s_nop 1
    v_add_f32_dpp v120, v120, v120 row_ror:4 row_mask:0xf bank_mask:0xf
    s_nop 1
    v_add_f32_dpp v120, v120, v120 row_ror:2 row_mask:0xf bank_mask:0xf
    s_nop 1
    v_add_f32_dpp v120, v120, v120 row_ror:1 row_mask:0xf bank_mask:0xf
    v_mov_b32 v121, v120
    s_nop 1
    v_permlane16_swap_b32 v120, v121
    v_mul_f32 v120, 0x3ae38e39, v120
    v_mul_f32 v121, 0x3ae38e39, v121
    v_fma_f32 v121, -v120, v120, v121
    v_cvt_pk_bf16_f32 v122, 0, v120
    v_dot2_f32_bf16 v126, v16, v6, v122 neg_lo:[0,0,1]
    v_max_f32 v121, 0, v121
    v_dot2_f32_bf16 v127, v16, v7, v122 neg_lo:[0,0,1]
    v_dot2_f32_bf16 v128, v17, v6, v122 neg_lo:[0,0,1]
    v_dot2_f32_bf16 v129, v17, v7, v122 neg_lo:[0,0,1]
    v_cvt_pk_bf16_f32 v121, 0, v121
    v_dot2_f32_bf16 v130, v18, v6, v122 neg_lo:[0,0,1]
    v_dot2_f32_bf16 v131, v18, v7, v122 neg_lo:[0,0,1]
    v_add_f32 v121, 0x3727c5ac, v121
    v_dot2_f32_bf16 v132, v19, v6, v122 neg_lo:[0,0,1]
    v_dot2_f32_bf16 v133, v19, v7, v122 neg_lo:[0,0,1]
    v_dot2_f32_bf16 v134, v20, v6, v122 neg_lo:[0,0,1]
    v_cvt_pk_bf16_f32 v121, 0, v121
    v_dot2_f32_bf16 v135, v20, v7, v122 neg_lo:[0,0,1]
    v_dot2_f32_bf16 v136, v21, v6, v122 neg_lo:[0,0,1]
    v_dot2_f32_bf16 v137, v21, v7, v122 neg_lo:[0,0,1]
    v_sqrt_f32 v121, v121
    v_dot2_f32_bf16 v138, v22, v6, v122 neg_lo:[0,0,1]
    v_dot2_f32_bf16 v139, v22, v7, v122 neg_lo:[0,0,1]
    v_cvt_pk_bf16_f32 v121, 0, v121
    v_dot2_f32_bf16 v140, v23, v6, v122 neg_lo:[0,0,1]
    v_dot2_f32_bf16 v141, v23, v7, v122 neg_lo:[0,0,1]
    v_dot2_f32_bf16 v142, v24, v6, v122 neg_lo:[0,0,1]
    v_rcp_f32 v124, v121
    v_dot2_f32_bf16 v143, v24, v7, v122 neg_lo:[0,0,1]
    v_cvt_pk_bf16_f32 v126, 0, v126
    v_cvt_pk_bf16_f32 v127, 0, v127
    v_cvt_pk_bf16_f32 v128, 0, v128
    v_cvt_pk_bf16_f32 v129, 0, v129
    v_cvt_pk_bf16_f32 v130, 0, v130
    v_cvt_pk_bf16_f32 v131, 0, v131
    v_cvt_pk_bf16_f32 v132, 0, v132
    v_cvt_pk_bf16_f32 v133, 0, v133
    v_cvt_pk_bf16_f32 v134, 0, v134
    v_cvt_pk_bf16_f32 v135, 0, v135
    v_cvt_pk_bf16_f32 v136, 0, v136
    v_cvt_pk_bf16_f32 v137, 0, v137
    v_cvt_pk_bf16_f32 v138, 0, v138
    v_cvt_pk_bf16_f32 v139, 0, v139
    v_cvt_pk_bf16_f32 v140, 0, v140
    v_cvt_pk_bf16_f32 v141, 0, v141
    v_cvt_pk_bf16_f32 v142, 0, v142
    v_cvt_pk_bf16_f32 v143, 0, v143
    v_pk_mul_f32 v[126:127], v[126:127], v[124:125] op_sel_hi:[1,0]
    v_pk_mul_f32 v[128:129], v[128:129], v[124:125] op_sel_hi:[1,0]
    v_pk_mul_f32 v[130:131], v[130:131], v[124:125] op_sel_hi:[1,0]
    v_pk_mul_f32 v[132:133], v[132:133], v[124:125] op_sel_hi:[1,0]
    v_pk_mul_f32 v[134:135], v[134:135], v[124:125] op_sel_hi:[1,0]
    v_pk_mul_f32 v[136:137], v[136:137], v[124:125] op_sel_hi:[1,0]
    v_pk_mul_f32 v[138:139], v[138:139], v[124:125] op_sel_hi:[1,0]
    v_pk_mul_f32 v[140:141], v[140:141], v[124:125] op_sel_hi:[1,0]
    v_pk_mul_f32 v[142:143], v[142:143], v[124:125] op_sel_hi:[1,0]
    v_cvt_pkrtz_f16_f32 v144, v126, v127
    v_cvt_pkrtz_f16_f32 v145, v128, v129
    v_cvt_pkrtz_f16_f32 v146, v130, v131
    v_cvt_pkrtz_f16_f32 v147, v132, v133
    v_cvt_pkrtz_f16_f32 v148, v134, v135
    ds_write_b128 v25, v[144:147]
    v_cvt_pkrtz_f16_f32 v149, v136, v137
    v_cvt_pkrtz_f16_f32 v150, v138, v139
    v_cvt_pkrtz_f16_f32 v151, v140, v141
    v_cvt_pkrtz_f16_f32 v152, v142, v143
    ds_write_b128 v25, v[148:151] offset:512
    ds_write_b32 v26, v152 offset:1024
    s_waitcnt lgkmcnt(0)
C_BA:
    s_barrier
    s_cmp_ge_u32 s3, 4
    s_cbranch_scc1 C_US
    s_cmp_lt_u32 s2, 144
    s_cbranch_scc1 C_K1
    s_cmp_ge_u32 s49, 128
    s_cbranch_scc1 FROLE
C_US:
    ds_read_b64_tr_b16 v[228:229], v36 offset:0
    ds_read_b64_tr_b16 v[230:231], v36 offset:4736
    ds_read_b64_tr_b16 v[232:233], v36 offset:512
    ds_read_b64_tr_b16 v[234:235], v36 offset:5248
    ds_read_b64_tr_b16 v[236:237], v36 offset:1024
    ds_read_b64_tr_b16 v[238:239], v36 offset:5760
    s_waitcnt lgkmcnt(4)
    v_add_u32 v228, v11, v228
    v_add_u32 v229, v11, v229
    v_add_u32 v230, v11, v230
    v_add_u32 v231, v11, v231
    v_and_or_b32 v228, v228, v9, v10
    v_and_or_b32 v229, v229, v9, v10
    v_and_or_b32 v230, v230, v9, v10
    v_and_or_b32 v231, v231, v9, v10
    buffer_store_dwordx4 v[228:231], v37, s[32:35], s55 offen sc1
    s_waitcnt lgkmcnt(2)
    v_add_u32 v232, v11, v232
    v_add_u32 v233, v11, v233
    v_add_u32 v234, v11, v234
    v_add_u32 v235, v11, v235
    v_and_or_b32 v232, v232, v9, v10
    v_and_or_b32 v233, v233, v9, v10
    v_and_or_b32 v234, v234, v9, v10
    v_and_or_b32 v235, v235, v9, v10
    buffer_store_dwordx4 v[232:235], v37, s[32:35], s36 offen sc1
    s_cmp_lg_u32 s51, 0
    s_cbranch_scc1 US1
    s_waitcnt lgkmcnt(0)
    v_add_u32 v236, v11, v236
    v_add_u32 v237, v11, v237
    v_add_u32 v238, v11, v238
    v_add_u32 v239, v11, v239
    v_and_or_b32 v236, v236, v9, v10
    v_and_or_b32 v237, v237, v9, v10
    v_and_or_b32 v238, v238, v9, v10
    v_and_or_b32 v239, v239, v9, v10
    buffer_store_dwordx4 v[236:239], v37, s[32:35], s37 offen sc1
US1:
    s_cmp_ge_u32 s2, 144
    s_cbranch_scc1 C_O3
    s_branch C_K2
C_O3:
    s_cmp_lt_u32 s49, 128
    s_cbranch_scc1 C_RL2
    v_subrev_u32 v14, 9472, v25
    v_subrev_u32 v15, 9472, v26
    ds_read_b128 v[140:143], v14
    ds_read_b128 v[144:147], v14 offset:512
    ds_read_b32 v148, v15 offset:1024
    s_mov_b32 s46, 10485760
    s_waitcnt lgkmcnt(0)
    v_add_u32 v140, v11, v140
    v_add_u32 v141, v11, v141
    v_add_u32 v142, v11, v142
    v_add_u32 v143, v11, v143
    v_add_u32 v144, v11, v144
    v_add_u32 v145, v11, v145
    v_add_u32 v146, v11, v146
    v_add_u32 v147, v11, v147
    v_add_u32 v148, v11, v148
    v_and_or_b32 v140, v140, v9, v10
    v_and_or_b32 v141, v141, v9, v10
    v_and_or_b32 v142, v142, v9, v10
    v_and_or_b32 v143, v143, v9, v10
    v_and_or_b32 v144, v144, v9, v10
    v_and_or_b32 v145, v145, v9, v10
    v_and_or_b32 v146, v146, v9, v10
    v_and_or_b32 v147, v147, v9, v10
    v_and_or_b32 v148, v148, v9, v10
    buffer_store_dwordx4 v[140:143], v4, s[32:35], s46 offen sc1
    buffer_store_dwordx4 v[144:147], v4, s[32:35], s46 offen offset:512 sc1
    buffer_store_dword v148, v5, s[32:35], s46 offen offset:1024 sc1
    s_branch FROLE
C_RL2:
    s_waitcnt vmcnt(0)
    s_branch RPREP
C_K1:
    s_add_u32 s40, s40, 1
    s_and_b32 s41, s40, 7
    s_bfe_u32 s46, s40, 0x30003
    s_lshl_b32 s46, s46, 16
    s_or_b32 s41, s41, s46
    v_mov_b32 v10, s41
    s_waitcnt vmcnt(9)
    s_bitcmp1_b32 s51, 1
    s_cselect_b32 s56, s57, s56
    s_lshl_b32 s57, s56, 16
    s_and_b32 s56, s56, 0xffff0000
    s_bitcmp1_b32 s51, 0
    s_cselect_b32 s56, s56, s57
    v_mov_b32 v60, 0x3fb8aa3b
    v_mul_f32 v62, 0x3fb8aa3b, v28
    v_mul_f32 v60, s56, v60
    v_exp_f32 v62, v62
    v_exp_f32 v60, v60
    v_add_f32 v64, |v30|, |v31|
    v_add_f32 v65, |v32|, |v33|
    v_cvt_pk_bf16_f32 v62, 0, v62
    v_cvt_pk_bf16_f32 v60, 0, v60
    v_add_f32 v64, v64, v65
    v_mul_f32 v62, v62, v60
    v_mul_f32 v63, v29, v60
    v_mul_f32 v62, 0xbfb8aa3b, v62
    v_mul_f32 v63, 0.15915494, v63
    v_mul_f32 v104, 0x41000000, v62
    v_add_f32_dpp v64, v64, v64 row_ror:8 row_mask:0xf bank_mask:0xf
    v_mul_f32 v105, 0x41000000, v63
    v_exp_f32 v104, v104
    v_fract_f32 v105, v105
    v_add_f32_dpp v64, v64, v64 row_ror:4 row_mask:0xf bank_mask:0xf
    v_cos_f32 v72, v105
    v_sin_f32 v73, v105
    v_add_f32_dpp v64, v64, v64 row_ror:2 row_mask:0xf bank_mask:0xf
    v_pk_mul_f32 v[72:73], v[72:73], v[104:105] op_sel_hi:[1,0] neg_hi:[1,0]
    v_exp_f32 v106, v62
    v_add_f32_dpp v64, v64, v64 row_ror:1 row_mask:0xf bank_mask:0xf
    v_fract_f32 v107, v63
    v_cos_f32 v66, v107
    v_sin_f32 v67, v107
    v_mov_b32 v65, v64
    v_pk_mul_f32 v[66:67], v[66:67], v[106:107] op_sel_hi:[1,0]
    v_mul_f32 v108, 0x43800000, v62
    v_permlane16_swap_b32 v64, v65
    v_mul_f32 v109, 0x43800000, v63
    v_exp_f32 v108, v108
    v_add_f32 v64, v64, v65
    v_fract_f32 v109, v109
    v_cos_f32 v68, v109
    v_sin_f32 v69, v109
    v_mov_b32 v65, v64
    v_pk_mul_f32 v[68:69], v[68:69], v[108:109] op_sel_hi:[1,0]
    v_mov_b32 v162, 0x3c00
    v_pk_mul_f32 v[74:75], v[72:73], v[72:73] op_sel_hi:[1,0]
    v_permlane32_swap_b32 v64, v65
    v_pk_fma_f32 v[74:75], v[72:73], v[72:73], v[74:75] op_sel:[1,1,0] op_sel_hi:[0,1,1] neg_lo:[1,0,0]
C_K2:
    v_pk_mul_f32 v[76:77], v[74:75], v[72:73] op_sel_hi:[1,0]
    v_pk_mul_f32 v[78:79], v[74:75], v[74:75] op_sel_hi:[1,0]
    v_cvt_pk_f16_f32 v163, v72, v73
    v_cvt_pk_f16_f32 v164, v74, v75
    v_add_f32 v64, v64, v65
    v_pk_fma_f32 v[76:77], v[74:75], v[72:73], v[76:77] op_sel:[1,1,0] op_sel_hi:[0,1,1] neg_lo:[1,0,0]
    v_pk_fma_f32 v[78:79], v[74:75], v[74:75], v[78:79] op_sel:[1,1,0] op_sel_hi:[0,1,1] neg_lo:[1,0,0]
    ds_write2st64_b32 v40, v163, v162 offset0:33 offset1:0
    v_pk_mul_f32 v[80:81], v[78:79], v[72:73] op_sel_hi:[1,0]
    v_pk_mul_f32 v[82:83], v[78:79], v[74:75] op_sel_hi:[1,0]
    v_cvt_pk_f16_f32 v165, v76, v77
    v_cvt_pk_f16_f32 v166, v78, v79
    v_mul_f32 v64, v64, v60
    v_pk_fma_f32 v[80:81], v[78:79], v[72:73], v[80:81] op_sel:[1,1,0] op_sel_hi:[0,1,1] neg_lo:[1,0,0]
    v_pk_fma_f32 v[82:83], v[78:79], v[74:75], v[82:83] op_sel:[1,1,0] op_sel_hi:[0,1,1] neg_lo:[1,0,0]
    ds_write2st64_b32 v41, v165, v164 offset0:33 offset1:0
    v_pk_mul_f32 v[84:85], v[78:79], v[76:77] op_sel_hi:[1,0]
    v_pk_mul_f32 v[86:87], v[78:79], v[78:79] op_sel_hi:[1,0]
    v_cvt_pk_f16_f32 v167, v80, v81
    v_cvt_pk_f16_f32 v56, v82, v83
    v_frexp_exp_i32_f32 v64, v64
    v_pk_fma_f32 v[84:85], v[78:79], v[76:77], v[84:85] op_sel:[1,1,0] op_sel_hi:[0,1,1] neg_lo:[1,0,0]
    v_pk_fma_f32 v[86:87], v[78:79], v[78:79], v[86:87] op_sel:[1,1,0] op_sel_hi:[0,1,1] neg_lo:[1,0,0]
    ds_write2st64_b32 v42, v167, v166 offset0:33 offset1:0
    v_pk_mul_f32 v[88:89], v[86:87], v[72:73] op_sel_hi:[1,0]
    v_pk_mul_f32 v[90:91], v[86:87], v[74:75] op_sel_hi:[1,0]
    v_cvt_pk_f16_f32 v57, v84, v85
    v_cvt_pk_f16_f32 v163, v86, v87
    v_max_i32 v64, -100, v64
    v_pk_fma_f32 v[88:89], v[86:87], v[72:73], v[88:89] op_sel:[1,1,0] op_sel_hi:[0,1,1] neg_lo:[1,0,0]
    v_pk_fma_f32 v[90:91], v[86:87], v[74:75], v[90:91] op_sel:[1,1,0] op_sel_hi:[0,1,1] neg_lo:[1,0,0]
    ds_write2st64_b32 v43, v57, v56 offset0:33 offset1:0
    v_pk_mul_f32 v[92:93], v[86:87], v[76:77] op_sel_hi:[1,0]
    v_pk_mul_f32 v[94:95], v[86:87], v[78:79] op_sel_hi:[1,0]
    v_cvt_pk_f16_f32 v162, v88, v89
    v_cvt_pk_f16_f32 v165, v90, v91
    v_min_i32 v64, 100, v64
    v_pk_fma_f32 v[92:93], v[86:87], v[76:77], v[92:93] op_sel:[1,1,0] op_sel_hi:[0,1,1] neg_lo:[1,0,0]
    v_pk_fma_f32 v[94:95], v[86:87], v[78:79], v[94:95] op_sel:[1,1,0] op_sel_hi:[0,1,1] neg_lo:[1,0,0]
    ds_write2st64_b32 v44, v162, v163 offset0:33 offset1:0
    v_pk_mul_f32 v[96:97], v[86:87], v[80:81] op_sel_hi:[1,0]
    v_pk_mul_f32 v[98:99], v[86:87], v[82:83] op_sel_hi:[1,0]
    v_cvt_pk_f16_f32 v164, v92, v93
    v_cvt_pk_f16_f32 v167, v94, v95
    v_sub_u32 v65, 0, v64
    v_pk_fma_f32 v[96:97], v[86:87], v[80:81], v[96:97] op_sel:[1,1,0] op_sel_hi:[0,1,1] neg_lo:[1,0,0]
    v_pk_fma_f32 v[98:99], v[86:87], v[82:83], v[98:99] op_sel:[1,1,0] op_sel_hi:[0,1,1] neg_lo:[1,0,0]
    ds_write2st64_b32 v45, v164, v165 offset0:33 offset1:0
    v_pk_mul_f32 v[100:101], v[86:87], v[84:85] op_sel_hi:[1,0]
    v_pk_mul_f32 v[102:103], v[86:87], v[86:87] op_sel_hi:[1,0]
    v_cvt_pk_f16_f32 v166, v96, v97
    v_cvt_pk_f16_f32 v57, v98, v99
    v_ldexp_f32 v60, v60, v65
    v_pk_fma_f32 v[100:101], v[86:87], v[84:85], v[100:101] op_sel:[1,1,0] op_sel_hi:[0,1,1] neg_lo:[1,0,0]
    v_pk_fma_f32 v[102:103], v[86:87], v[86:87], v[102:103] op_sel:[1,1,0] op_sel_hi:[0,1,1] neg_lo:[1,0,0]
    ds_write2st64_b32 v46, v166, v167 offset0:33 offset1:0
    v_pk_mul_f32 v[112:113], v[102:103], v[72:73] op_sel_hi:[1,0]
    v_pk_mul_f32 v[114:115], v[102:103], v[74:75] op_sel_hi:[1,0]
    v_cvt_pk_f16_f32 v56, v100, v101
    v_cvt_pk_f16_f32 v162, v102, v103
    v_pk_mul_f32 v[30:31], v[30:31], v[60:61] op_sel_hi:[1,0]
    v_pk_fma_f32 v[112:113], v[102:103], v[72:73], v[112:113] op_sel:[1,1,0] op_sel_hi:[0,1,1] neg_lo:[1,0,0]
    v_pk_fma_f32 v[114:115], v[102:103], v[74:75], v[114:115] op_sel:[1,1,0] op_sel_hi:[0,1,1] neg_lo:[1,0,0]
    ds_write2st64_b32 v47, v56, v57 offset0:33 offset1:0
    v_pk_mul_f32 v[116:117], v[102:103], v[76:77] op_sel_hi:[1,0]
    v_pk_mul_f32 v[110:111], v[102:103], v[78:79] op_sel_hi:[1,0]
    v_cvt_pk_f16_f32 v163, v112, v113
    v_cvt_pk_f16_f32 v164, v114, v115
    v_pk_fma_f32 v[116:117], v[102:103], v[76:77], v[116:117] op_sel:[1,1,0] op_sel_hi:[0,1,1] neg_lo:[1,0,0]
    v_pk_fma_f32 v[110:111], v[102:103], v[78:79], v[110:111] op_sel:[1,1,0] op_sel_hi:[0,1,1] neg_lo:[1,0,0]
    ds_write2st64_b32 v48, v163, v162 offset0:33 offset1:0
    v_pk_mul_f32 v[112:113], v[102:103], v[80:81] op_sel_hi:[1,0]
    v_pk_mul_f32 v[114:115], v[102:103], v[82:83] op_sel_hi:[1,0]
    v_cvt_pk_f16_f32 v165, v116, v117
    v_cvt_pk_f16_f32 v166, v110, v111
    v_pk_fma_f32 v[112:113], v[102:103], v[80:81], v[112:113] op_sel:[1,1,0] op_sel_hi:[0,1,1] neg_lo:[1,0,0]
    v_pk_fma_f32 v[114:115], v[102:103], v[82:83], v[114:115] op_sel:[1,1,0] op_sel_hi:[0,1,1] neg_lo:[1,0,0]
    ds_write2st64_b32 v49, v165, v164 offset0:33 offset1:0
    s_setprio 0
    v_pk_mul_f32 v[120:121], v[30:31], v[66:67] op_sel_hi:[1,0]
    v_cvt_pk_f16_f32 v167, v112, v113
    v_cvt_pk_f16_f32 v56, v114, v115
    v_pk_fma_f32 v[120:121], v[30:31], v[66:67], v[120:121] op_sel:[1,1,0] op_sel_hi:[0,1,1] neg_lo:[1,0,0]
    ds_write2st64_b32 v50, v167, v166 offset0:33 offset1:0
    s_cmp_ge_u32 s3, 4
    s_cbranch_scc1 C_K3
    v_add_u32 v64, 1, v64
    s_and_b32 s46, s40, 0x7fffff
    v_ldexp_f32 v64, 1.0, v64
    s_lshl_b32 s53, s2, 7
    v_or_b32 v64, s46, v64
    s_lshl_b32 s46, s51, 2
    s_add_u32 s46, s46, s53
    s_add_u32 s46, s46, 32768
    s_mov_b64 exec, 1
    buffer_store_dword v64, v2, s[32:35], s46 offen sc1
    s_mov_b64 exec, -1
    s_branch C_K4
C_K3:
    v_add_u32 v27, 4096, v2
    global_load_dwordx4 v[168:171], v27, s[44:45] offset:-4096
    global_load_dwordx4 v[172:175], v27, s[44:45] offset:-3072
    global_load_dwordx4 v[176:179], v27, s[44:45] offset:-2048
    global_load_dwordx4 v[180:183], v27, s[44:45] offset:-1024
    global_load_dwordx4 v[184:187], v27, s[44:45] offset:0
    global_load_dwordx4 v[188:191], v27, s[44:45] offset:1024
    global_load_dwordx4 v[192:195], v27, s[44:45] offset:2048
    s_lshl_b32 s48, s2, 14
    s_add_u32 s48, s48, 1048576
    s_lshl_b32 s46, s51, 10
    s_add_u32 s59, s48, s46
    s_add_u32 s59, s59, 12288
    s_mul_i32 s46, s51, 3072
    s_add_u32 s48, s48, s46
C_K4:
    v_pk_mul_f32 v[136:137], v[30:31], v[68:69] op_sel_hi:[1,0]
    v_pk_mul_f32 v[122:123], v[120:121], v[66:67] op_sel_hi:[1,0]
    v_cvt_pk_f16_f32 v57, v30, v31
    v_cvt_pk_f16_f32 v163, v120, v121
    v_pk_fma_f32 v[136:137], v[30:31], v[68:69], v[136:137] op_sel:[1,1,0] op_sel_hi:[0,1,1] neg_lo:[1,0,0]
    v_pk_fma_f32 v[122:123], v[120:121], v[66:67], v[122:123] op_sel:[1,1,0] op_sel_hi:[0,1,1] neg_lo:[1,0,0]
    ds_write_b32 v46, v57 offset:16896
    v_pk_mul_f32 v[124:125], v[122:123], v[66:67] op_sel_hi:[1,0]
    v_pk_mul_f32 v[138:139], v[122:123], v[68:69] op_sel_hi:[1,0]
    v_cvt_pk_f16_f32 v162, v136, v137
    v_cvt_pk_f16_f32 v165, v122, v123
    v_pk_fma_f32 v[124:125], v[122:123], v[66:67], v[124:125] op_sel:[1,1,0] op_sel_hi:[0,1,1] neg_lo:[1,0,0]
    v_pk_fma_f32 v[138:139], v[122:123], v[68:69], v[138:139] op_sel:[1,1,0] op_sel_hi:[0,1,1] neg_lo:[1,0,0]
    ds_write2st64_b32 v40, v162, v163 offset0:99 offset1:66
    v_pk_mul_f32 v[126:127], v[124:125], v[66:67] op_sel_hi:[1,0]
    v_cvt_pk_f16_f32 v164, v124, v125
    v_cvt_pk_f16_f32 v167, v138, v139
    v_pk_fma_f32 v[126:127], v[124:125], v[66:67], v[126:127] op_sel:[1,1,0] op_sel_hi:[0,1,1] neg_lo:[1,0,0]
    ds_write2st64_b32 v41, v167, v164 offset0:99 offset1:66
    v_pk_mul_f32 v[128:129], v[126:127], v[66:67] op_sel_hi:[1,0]
    v_pk_mul_f32 v[140:141], v[126:127], v[68:69] op_sel_hi:[1,0]
    v_cvt_pk_f16_f32 v166, v126, v127
    v_pk_fma_f32 v[128:129], v[126:127], v[66:67], v[128:129] op_sel:[1,1,0] op_sel_hi:[0,1,1] neg_lo:[1,0,0]
    v_pk_fma_f32 v[140:141], v[126:127], v[68:69], v[140:141] op_sel:[1,1,0] op_sel_hi:[0,1,1] neg_lo:[1,0,0]
    ds_write_b32 v47, v166 offset:16896
    v_pk_mul_f32 v[130:131], v[128:129], v[66:67] op_sel_hi:[1,0]
    v_pk_mul_f32 v[146:147], v[140:141], v[68:69] op_sel_hi:[1,0]
    v_cvt_pk_f16_f32 v57, v128, v129
    v_cvt_pk_f16_f32 v162, v140, v141
    v_pk_fma_f32 v[130:131], v[128:129], v[66:67], v[130:131] op_sel:[1,1,0] op_sel_hi:[0,1,1] neg_lo:[1,0,0]
    v_pk_fma_f32 v[146:147], v[140:141], v[68:69], v[146:147] op_sel:[1,1,0] op_sel_hi:[0,1,1] neg_lo:[1,0,0]
    ds_write_b32 v48, v57 offset:16896
    v_pk_mul_f32 v[132:133], v[130:131], v[66:67] op_sel_hi:[1,0]
    v_pk_mul_f32 v[142:143], v[130:131], v[68:69] op_sel_hi:[1,0]
    v_cvt_pk_f16_f32 v163, v130, v131
    v_cvt_pk_f16_f32 v167, v146, v147
    v_pk_fma_f32 v[132:133], v[130:131], v[66:67], v[132:133] op_sel:[1,1,0] op_sel_hi:[0,1,1] neg_lo:[1,0,0]
    v_pk_fma_f32 v[142:143], v[130:131], v[68:69], v[142:143] op_sel:[1,1,0] op_sel_hi:[0,1,1] neg_lo:[1,0,0]
    ds_write2st64_b32 v45, v162, v165 offset0:99 offset1:66
    v_pk_mul_f32 v[134:135], v[132:133], v[66:67] op_sel_hi:[1,0]
    v_pk_mul_f32 v[150:151], v[146:147], v[68:69] op_sel_hi:[1,0]
    v_cvt_pk_f16_f32 v164, v132, v133
    v_cvt_pk_f16_f32 v166, v142, v143
    v_pk_fma_f32 v[134:135], v[132:133], v[66:67], v[134:135] op_sel:[1,1,0] op_sel_hi:[0,1,1] neg_lo:[1,0,0]
    v_pk_fma_f32 v[150:151], v[146:147], v[68:69], v[150:151] op_sel:[1,1,0] op_sel_hi:[0,1,1] neg_lo:[1,0,0]
    ds_write2st64_b32 v42, v167, v163 offset0:99 offset1:66
    v_pk_mul_f32 v[144:145], v[134:135], v[68:69] op_sel_hi:[1,0]
    v_pk_mul_f32 v[116:117], v[102:103], v[84:85] op_sel_hi:[1,0]
    ds_write_b32 v49, v164 offset:16896
    v_cvt_pk_f16_f32 v57, v134, v135
    v_cvt_pk_f16_f32 v162, v150, v151
    v_pk_fma_f32 v[144:145], v[134:135], v[68:69], v[144:145] op_sel:[1,1,0] op_sel_hi:[0,1,1] neg_lo:[1,0,0]
    v_pk_fma_f32 v[116:117], v[102:103], v[84:85], v[116:117] op_sel:[1,1,0] op_sel_hi:[0,1,1] neg_lo:[1,0,0]
    ds_write_b32 v50, v166 offset:16896
    v_pk_mul_f32 v[148:149], v[144:145], v[68:69] op_sel_hi:[1,0]
    v_pk_mul_f32 v[110:111], v[102:103], v[86:87] op_sel_hi:[1,0]
    v_cvt_pk_f16_f32 v165, v144, v145
    v_cvt_pk_f16_f32 v167, v116, v117
    v_pk_fma_f32 v[148:149], v[144:145], v[68:69], v[148:149] op_sel:[1,1,0] op_sel_hi:[0,1,1] neg_lo:[1,0,0]
    v_pk_fma_f32 v[110:111], v[102:103], v[86:87], v[110:111] op_sel:[1,1,0] op_sel_hi:[0,1,1] neg_lo:[1,0,0]
    ds_write2st64_b32 v43, v162, v57 offset0:99 offset1:66
    v_pk_mul_f32 v[152:153], v[148:149], v[68:69] op_sel_hi:[1,0]
    v_pk_mul_f32 v[112:113], v[102:103], v[88:89] op_sel_hi:[1,0]
    v_cvt_pk_f16_f32 v163, v148, v149
    v_cvt_pk_f16_f32 v164, v110, v111
    v_pk_fma_f32 v[152:153], v[148:149], v[68:69], v[152:153] op_sel:[1,1,0] op_sel_hi:[0,1,1] neg_lo:[1,0,0]
    v_pk_fma_f32 v[112:113], v[102:103], v[88:89], v[112:113] op_sel:[1,1,0] op_sel_hi:[0,1,1] neg_lo:[1,0,0]
    ds_write2st64_b32 v51, v167, v56 offset0:33 offset1:0
    v_pk_mul_f32 v[114:115], v[102:103], v[90:91] op_sel_hi:[1,0]
    v_pk_mul_f32 v[154:155], v[152:153], v[68:69] op_sel_hi:[1,0]
    v_cvt_pk_f16_f32 v166, v152, v153
    v_cvt_pk_f16_f32 v162, v112, v113
    v_pk_fma_f32 v[114:115], v[102:103], v[90:91], v[114:115] op_sel:[1,1,0] op_sel_hi:[0,1,1] neg_lo:[1,0,0]
    v_pk_fma_f32 v[154:155], v[152:153], v[68:69], v[154:155] op_sel:[1,1,0] op_sel_hi:[0,1,1] neg_lo:[1,0,0]
    ds_write2st64_b32 v44, v163, v165 offset0:99 offset1:66
    v_pk_mul_f32 v[116:117], v[102:103], v[92:93] op_sel_hi:[1,0]
    v_pk_mul_f32 v[156:157], v[154:155], v[68:69] op_sel_hi:[1,0]
    ds_write_b32 v51, v166 offset:16896
    v_cvt_pk_f16_f32 v57, v114, v115
    v_cvt_pk_f16_f32 v167, v154, v155
    v_pk_fma_f32 v[116:117], v[102:103], v[92:93], v[116:117] op_sel:[1,1,0] op_sel_hi:[0,1,1] neg_lo:[1,0,0]
    v_pk_fma_f32 v[156:157], v[154:155], v[68:69], v[156:157] op_sel:[1,1,0] op_sel_hi:[0,1,1] neg_lo:[1,0,0]
    ds_write2st64_b32 v52, v162, v164 offset0:33 offset1:0
    s_cmp_lt_u32 s3, 4
    s_cbranch_scc1 C_K6
    buffer_load_dwordx4 v[200:203], v2, s[32:35], s48 offen offset:0 sc1
    buffer_load_dwordx4 v[204:207], v2, s[32:35], s48 offen offset:1024 sc1
    buffer_load_dwordx4 v[208:211], v2, s[32:35], s48 offen offset:2048 sc1
C_K6:
    v_pk_mul_f32 v[110:111], v[102:103], v[94:95] op_sel_hi:[1,0]
    v_pk_mul_f32 v[112:113], v[102:103], v[96:97] op_sel_hi:[1,0]
    v_cvt_pk_f16_f32 v56, v116, v117
    v_cvt_pk_f16_f32 v163, v156, v157
    v_pk_fma_f32 v[110:111], v[102:103], v[94:95], v[110:111] op_sel:[1,1,0] op_sel_hi:[0,1,1] neg_lo:[1,0,0]
    v_pk_fma_f32 v[112:113], v[102:103], v[96:97], v[112:113] op_sel:[1,1,0] op_sel_hi:[0,1,1] neg_lo:[1,0,0]
    ds_write_b32 v52, v167 offset:16896
    v_pk_mul_f32 v[158:159], v[156:157], v[68:69] op_sel_hi:[1,0]
    v_pk_mul_f32 v[114:115], v[102:103], v[98:99] op_sel_hi:[1,0]
    ds_write2st64_b32 v53, v56, v57 offset0:33 offset1:0
    v_cvt_pk_f16_f32 v165, v110, v111
    v_cvt_pk_f16_f32 v166, v112, v113
    v_pk_fma_f32 v[158:159], v[156:157], v[68:69], v[158:159] op_sel:[1,1,0] op_sel_hi:[0,1,1] neg_lo:[1,0,0]
    v_pk_fma_f32 v[114:115], v[102:103], v[98:99], v[114:115] op_sel:[1,1,0] op_sel_hi:[0,1,1] neg_lo:[1,0,0]
    ds_write_b32 v53, v163 offset:16896
    v_pk_mul_f32 v[160:161], v[158:159], v[68:69] op_sel_hi:[1,0]
    v_pk_mul_f32 v[116:117], v[102:103], v[100:101] op_sel_hi:[1,0]
    v_cvt_pk_f16_f32 v162, v158, v159
    v_cvt_pk_f16_f32 v164, v114, v115
    v_pk_fma_f32 v[160:161], v[158:159], v[68:69], v[160:161] op_sel:[1,1,0] op_sel_hi:[0,1,1] neg_lo:[1,0,0]
    v_pk_fma_f32 v[116:117], v[102:103], v[100:101], v[116:117] op_sel:[1,1,0] op_sel_hi:[0,1,1] neg_lo:[1,0,0]
    ds_write2st64_b32 v54, v166, v165 offset0:33 offset1:0
    v_cvt_pk_f16_f32 v167, v160, v161
    v_cvt_pk_f16_f32 v56, v116, v117
    ds_write_b32 v54, v162 offset:16896
    ds_write_b32 v55, v167 offset:16896
    ds_write2st64_b32 v55, v56, v164 offset0:33 offset1:0
    s_cmp_ge_u32 s3, 4
    s_cbranch_scc1 H_PATH
    s_waitcnt vmcnt(7)
    v_add_u32 v195, s60, v195
    ds_read_b128 v[92:95], v195 offset:0
    ds_read_b128 v[96:99], v253 offset:0
    ds_read_b128 v[100:103], v195 offset:32
    ds_read_b128 v[104:107], v253 offset:32
    s_barrier
    ds_read_b128 v[108:111], v195 offset:64
    ds_read_b128 v[112:115], v253 offset:64
    ds_read_b128 v[116:119], v195 offset:96
    ds_read_b128 v[120:123], v253 offset:96
    ds_read_b128 v[124:127], v195 offset:128
    ds_read_b128 v[128:131], v253 offset:128
    ds_read_b128 v[132:135], v195 offset:160
    ds_read_b128 v[136:139], v253 offset:160
    ds_read_b128 v[140:143], v195 offset:192
    ds_read_b128 v[144:147], v253 offset:192
    s_waitcnt lgkmcnt(12)
    v_mfma_f32_32x32x16_f16 v[168:183], v[92:95], v[96:99], 0
    ds_read_b128 v[148:151], v195 offset:224
    ds_read_b128 v[152:155], v253 offset:224
    v_add_u32 v184, s62, v184
    v_add_u32 v185, s62, v185
    s_waitcnt lgkmcnt(12)
    v_mfma_f32_32x32x16_f16 v[168:183], v[100:103], v[104:107], v[168:183]
    ds_read_b128 v[92:95], v195 offset:256
    ds_read_b128 v[96:99], v253 offset:256
    v_add_u32 v186, s62, v186
    v_add_u32 v187, s62, v187
    s_waitcnt lgkmcnt(12)
    v_mfma_f32_32x32x16_f16 v[168:183], v[108:111], v[112:115], v[168:183]
    ds_read_b128 v[100:103], v195 offset:288
    ds_read_b128 v[104:107], v253 offset:288
    v_add_u32 v188, s62, v188
    v_add_u32 v189, s62, v189
    s_waitcnt lgkmcnt(12)
    v_mfma_f32_32x32x16_f16 v[168:183], v[116:119], v[120:123], v[168:183]
    ds_read_b128 v[108:111], v195 offset:320
    ds_read_b128 v[112:115], v253 offset:320
    v_add_u32 v190, s62, v190
    v_add_u32 v191, s62, v191
    s_waitcnt lgkmcnt(12)
    v_mfma_f32_32x32x16_f16 v[168:183], v[124:127], v[128:131], v[168:183]
    ds_read_b128 v[116:119], v195 offset:352
    ds_read_b128 v[120:123], v253 offset:352
    v_add_u32 v192, s62, v192
    v_add_u32 v193, s62, v193
    s_waitcnt lgkmcnt(12)
    v_mfma_f32_32x32x16_f16 v[168:183], v[132:135], v[136:139], v[168:183]
    ds_read_b128 v[124:127], v195 offset:384
    ds_read_b128 v[128:131], v253 offset:384
    v_add_u32 v194, s62, v194
    v_and_b32 v14, 15, v1
    s_waitcnt lgkmcnt(12)
    v_mfma_f32_32x32x16_f16 v[168:183], v[140:143], v[144:147], v[168:183]
    ds_read_b128 v[132:135], v195 offset:416
    ds_read_b128 v[136:139], v253 offset:416
    v_lshrrev_b32 v15, 4, v1
    s_mul_i32 s46, s51, 4640
    s_waitcnt lgkmcnt(12)
    v_mfma_f32_32x32x16_f16 v[168:183], v[148:151], v[152:155], v[168:183]
    ds_read_b128 v[140:143], v195 offset:448
    ds_read_b128 v[144:147], v253 offset:448
    s_add_u32 s46, s46, 114048
    v_lshlrev_b32 v248, 5, v14
    s_waitcnt lgkmcnt(12)
    v_mfma_f32_32x32x16_f16 v[168:183], v[92:95], v[96:99], v[168:183]
    ds_read_b128 v[148:151], v195 offset:480
    ds_read_b128 v[152:155], v253 offset:480
    v_lshl_add_u32 v248, v15, 4, v248
    v_add_u32 v248, s46, v248
    s_waitcnt lgkmcnt(12)
    v_mfma_f32_32x32x16_f16 v[168:183], v[100:103], v[104:107], v[168:183]
    s_mul_i32 s46, s51, 6144
    s_add_u32 s46, s46, 20480
    v_add_u32 v249, s46, v2
    v_lshlrev_b32 v250, 3, v15
    v_sub_u32 v250, v250, v14
    s_waitcnt lgkmcnt(10)
    v_mfma_f32_32x32x16_f16 v[168:183], v[108:111], v[112:115], v[168:183]
    v_add_u32 v250, 15, v250
    v_and_b32 v34, 1, v250
    v_mul_u32_u24 v34, 1090, v34
    v_lshl_add_u32 v250, v250, 1, v34
    v_add_u32 v250, s62, v250
    s_waitcnt lgkmcnt(8)
    v_mfma_f32_32x32x16_f16 v[168:183], v[116:119], v[120:123], v[168:183]
    v_lshlrev_b32 v251, 3, v14
    v_and_b32 v34, 1, v15
    v_lshl_add_u32 v251, v34, 8, v251
    v_lshrrev_b32 v34, 1, v15
    v_lshl_add_u32 v251, v34, 7, v251
    s_waitcnt lgkmcnt(6)
    v_mfma_f32_32x32x16_f16 v[168:183], v[124:127], v[128:131], v[168:183]
    s_mul_i32 s46, s51, 4128
    v_add_u32 v251, s46, v251
    v_add_u32 v252, 576, v250
    v_add_u32 v250, 64, v250
    s_and_b32 s46, s2, 7
    s_waitcnt lgkmcnt(4)
    v_mfma_f32_32x32x16_f16 v[168:183], v[132:135], v[136:139], v[168:183]
    s_mul_i32 s46, s46, 72
    s_lshr_b32 s53, s2, 3
    s_lshl_b32 s53, s53, 2
    s_add_u32 s46, s46, s53
    s_add_u32 s46, s46, s51
    s_waitcnt lgkmcnt(2)
    v_mfma_f32_32x32x16_f16 v[168:183], v[140:143], v[144:147], v[168:183]
    s_mul_i32 s46, s46, 9216
    s_add_u32 s46, s46, 4096
    v_add_u32 v27, s46, v2
    s_waitcnt lgkmcnt(0)
    v_mfma_f32_32x32x16_f16 v[168:183], v[148:151], v[152:155], v[168:183]
    s_nop 11
    v_cvt_pk_f16_f32 v196, v171, v170
    v_cvt_pk_f16_f32 v197, v169, v168
    v_cvt_pk_f16_f32 v198, v183, v182
    ds_write2_b32 v184, v196, v197 offset0:0 offset1:1
    v_cvt_pk_f16_f32 v199, v181, v180
    v_cvt_pk_f16_f32 v200, v175, v175
    ds_write2_b32 v185, v198, v199 offset0:0 offset1:1
    v_cvt_pk_f16_f32 v201, v174, v173
    v_cvt_pk_f16_f32 v202, v173, v173
    ds_write2_b32 v189, v200, v201 offset0:0 offset1:1
    ds_write_b32 v190, v200
    v_cvt_pk_f16_f32 v203, v172, v176
    ds_write2_b32 v188, v200, v202 offset0:0 offset1:2
    v_cvt_pk_f16_f32 v204, v175, v174
    ds_write2_b32 v189, v202, v203 offset0:2 offset1:3
    v_cvt_pk_f16_f32 v205, v173, v172
    ds_write_b32 v186, v204
    v_cvt_pk_f16_f32 v206, v176, v177
    ds_write_b32 v187, v205
    v_cvt_pk_f16_f32 v207, v178, v179
    ds_write_b16 v191, v206
    ds_write_b16_d16_hi v192, v206
    ds_write_b16 v193, v207
    ds_write_b16_d16_hi v194, v207
    ds_read2_b32 v[44:45], v252 offset0:48 offset1:49
    ds_read2_b32 v[46:47], v252 offset0:50 offset1:51
    ds_read2_b32 v[48:49], v252 offset0:32 offset1:33
    ds_read2_b32 v[50:51], v252 offset0:34 offset1:35
    ds_read2_b32 v[52:53], v252 offset0:16 offset1:17
    ds_read2_b32 v[54:55], v252 offset0:18 offset1:19
    ds_read2_b32 v[56:57], v252 offset0:0 offset1:1
    ds_read2_b32 v[58:59], v252 offset0:2 offset1:3
    ds_read2_b32 v[28:29], v252 offset0:112 offset1:113
    ds_read2_b32 v[30:31], v252 offset0:114 offset1:115
    ds_read2_b32 v[32:33], v252 offset0:96 offset1:97
    ds_read2_b32 v[34:35], v252 offset0:98 offset1:99
    ds_read2_b32 v[36:37], v252 offset0:80 offset1:81
    ds_read2_b32 v[38:39], v252 offset0:82 offset1:83
    ds_read2_b32 v[40:41], v252 offset0:64 offset1:65
    ds_read2_b32 v[42:43], v252 offset0:66 offset1:67
    s_waitcnt lgkmcnt(15)
    s_barrier
    ds_read_b128 v[92:95], v248 offset:480
    ds_read_b128 v[96:99], v248 offset:416
    ds_read_b128 v[100:103], v248 offset:352
    ds_read_b128 v[104:107], v248 offset:288
    ds_read_b128 v[108:111], v248 offset:992
    ds_read_b128 v[112:115], v248 offset:928
    ds_read_b128 v[116:119], v248 offset:864
    ds_read_b128 v[120:123], v248 offset:800
    s_waitcnt lgkmcnt(15)
    s_waitcnt lgkmcnt(7)
    v_mfma_f32_16x16x32_f16 v[188:191], v[44:47], v[92:95], 0
    ds_read2_b32 v[76:77], v250 offset0:48 offset1:49
    ds_read2_b32 v[78:79], v250 offset0:50 offset1:51
    s_waitcnt lgkmcnt(8)
    v_mfma_f32_16x16x32_f16 v[188:191], v[48:51], v[96:99], v[188:191]
    ds_read2_b32 v[80:81], v250 offset0:32 offset1:33
    ds_read2_b32 v[82:83], v250 offset0:34 offset1:35
    s_waitcnt lgkmcnt(9)
    v_mfma_f32_16x16x32_f16 v[188:191], v[52:55], v[100:103], v[188:191]
    ds_read2_b32 v[84:85], v250 offset0:16 offset1:17
    ds_read2_b32 v[86:87], v250 offset0:18 offset1:19
    s_waitcnt lgkmcnt(10)
    v_mfma_f32_16x16x32_f16 v[188:191], v[56:59], v[104:107], v[188:191]
    ds_read2_b32 v[88:89], v250 offset0:0 offset1:1
    ds_read2_b32 v[90:91], v250 offset0:2 offset1:3
    v_mfma_f32_16x16x32_f16 v[156:159], v[28:31], v[92:95], 0
    ds_read2_b32 v[60:61], v250 offset0:112 offset1:113
    ds_read2_b32 v[62:63], v250 offset0:114 offset1:115
    v_mfma_f32_16x16x32_f16 v[156:159], v[32:35], v[96:99], v[156:159]
    ds_read2_b32 v[64:65], v250 offset0:96 offset1:97
    ds_read2_b32 v[66:67], v250 offset0:98 offset1:99
    v_mfma_f32_16x16x32_f16 v[156:159], v[36:39], v[100:103], v[156:159]
    ds_read2_b32 v[68:69], v250 offset0:80 offset1:81
    ds_read2_b32 v[70:71], v250 offset0:82 offset1:83
    v_mfma_f32_16x16x32_f16 v[156:159], v[40:43], v[104:107], v[156:159]
    ds_read2_b32 v[72:73], v250 offset0:64 offset1:65
    ds_read2_b32 v[74:75], v250 offset0:66 offset1:67
    s_waitcnt lgkmcnt(15)
    v_mfma_f32_16x16x32_f16 v[192:195], v[44:47], v[108:111], 0
    ds_read_b128 v[124:127], v248 offset:1504
    v_mfma_f32_16x16x32_f16 v[192:195], v[48:51], v[112:115], v[192:195]
    ds_read_b128 v[128:131], v248 offset:1440
    s_waitcnt lgkmcnt(15)
    v_mfma_f32_16x16x32_f16 v[192:195], v[52:55], v[116:119], v[192:195]
    ds_read_b128 v[132:135], v248 offset:1376
    v_mfma_f32_16x16x32_f16 v[192:195], v[56:59], v[120:123], v[192:195]
    ds_read_b128 v[136:139], v248 offset:1312
    s_waitcnt lgkmcnt(15)
    v_mfma_f32_16x16x32_f16 v[192:195], v[76:79], v[92:95], v[192:195]
    v_add_f32_dpp v156, v188, v156 row_ror:8 row_mask:0xf bank_mask:0xc
    v_add_f32_dpp v157, v189, v157 row_ror:8 row_mask:0xf bank_mask:0xc
    s_waitcnt lgkmcnt(15)
    v_mfma_f32_16x16x32_f16 v[192:195], v[80:83], v[96:99], v[192:195]
    v_add_f32_dpp v158, v190, v158 row_ror:8 row_mask:0xf bank_mask:0xc
    v_add_f32_dpp v159, v191, v159 row_ror:8 row_mask:0xf bank_mask:0xc
    s_waitcnt lgkmcnt(14)
    v_mfma_f32_16x16x32_f16 v[192:195], v[84:87], v[100:103], v[192:195]
    v_cvt_pkrtz_f16_f32 v156, v156, v157
    v_cvt_pkrtz_f16_f32 v157, v158, v159
    s_waitcnt lgkmcnt(12)
    v_mfma_f32_16x16x32_f16 v[192:195], v[88:91], v[104:107], v[192:195]
    v_mfma_f32_16x16x32_f16 v[160:163], v[28:31], v[108:111], 0
    ds_write_b64 v251, v[156:157] offset:0
    v_mfma_f32_16x16x32_f16 v[160:163], v[32:35], v[112:115], v[160:163]
    v_mfma_f32_16x16x32_f16 v[160:163], v[36:39], v[116:119], v[160:163]
    v_mfma_f32_16x16x32_f16 v[160:163], v[40:43], v[120:123], v[160:163]
    s_waitcnt lgkmcnt(11)
    v_mfma_f32_16x16x32_f16 v[160:163], v[60:63], v[92:95], v[160:163]
    s_waitcnt lgkmcnt(9)
    v_mfma_f32_16x16x32_f16 v[160:163], v[64:67], v[96:99], v[160:163]
    v_mov_b32_dpp v188, v192 quad_perm:[0,1,2,3] row_mask:0xf bank_mask:0x3
    v_mov_b32_dpp v189, v193 quad_perm:[0,1,2,3] row_mask:0xf bank_mask:0x3
    s_waitcnt lgkmcnt(7)
    v_mfma_f32_16x16x32_f16 v[160:163], v[68:71], v[100:103], v[160:163]
    v_mov_b32_dpp v190, v194 quad_perm:[0,1,2,3] row_mask:0xf bank_mask:0x3
    v_mov_b32_dpp v191, v195 quad_perm:[0,1,2,3] row_mask:0xf bank_mask:0x3
    s_waitcnt lgkmcnt(5)
    v_mfma_f32_16x16x32_f16 v[160:163], v[72:75], v[104:107], v[160:163]
    s_waitcnt lgkmcnt(3)
    v_mfma_f32_16x16x32_f16 v[196:199], v[44:47], v[124:127], 0
    ds_read_b128 v[92:95], v248 offset:2016
    v_mfma_f32_16x16x32_f16 v[196:199], v[48:51], v[128:131], v[196:199]
    ds_read_b128 v[96:99], v248 offset:1952
    s_waitcnt lgkmcnt(3)
    v_mfma_f32_16x16x32_f16 v[196:199], v[52:55], v[132:135], v[196:199]
    ds_read_b128 v[100:103], v248 offset:1888
    v_mfma_f32_16x16x32_f16 v[196:199], v[56:59], v[136:139], v[196:199]
    ds_read_b128 v[104:107], v248 offset:1824
    v_mfma_f32_16x16x32_f16 v[196:199], v[76:79], v[108:111], v[196:199]
    v_add_f32_dpp v160, v188, v160 row_ror:8 row_mask:0xf bank_mask:0xf
    v_add_f32_dpp v161, v189, v161 row_ror:8 row_mask:0xf bank_mask:0xf
    v_mfma_f32_16x16x32_f16 v[196:199], v[80:83], v[112:115], v[196:199]
    v_add_f32_dpp v162, v190, v162 row_ror:8 row_mask:0xf bank_mask:0xf
    v_add_f32_dpp v163, v191, v163 row_ror:8 row_mask:0xf bank_mask:0xf
    v_mfma_f32_16x16x32_f16 v[196:199], v[84:87], v[116:119], v[196:199]
    v_cvt_pkrtz_f16_f32 v160, v160, v161
    v_cvt_pkrtz_f16_f32 v161, v162, v163
    v_mfma_f32_16x16x32_f16 v[196:199], v[88:91], v[120:123], v[196:199]
    v_mfma_f32_16x16x32_f16 v[164:167], v[28:31], v[124:127], 0
    ds_write_b64 v251, v[160:161] offset:512
    v_mfma_f32_16x16x32_f16 v[164:167], v[32:35], v[128:131], v[164:167]
    v_mfma_f32_16x16x32_f16 v[164:167], v[36:39], v[132:135], v[164:167]
    v_mfma_f32_16x16x32_f16 v[164:167], v[40:43], v[136:139], v[164:167]
    v_mfma_f32_16x16x32_f16 v[164:167], v[60:63], v[108:111], v[164:167]
    v_mfma_f32_16x16x32_f16 v[164:167], v[64:67], v[112:115], v[164:167]
    s_nop 0
    v_mov_b32_dpp v192, v196 quad_perm:[0,1,2,3] row_mask:0xf bank_mask:0x3
    v_mov_b32_dpp v193, v197 quad_perm:[0,1,2,3] row_mask:0xf bank_mask:0x3
    s_waitcnt lgkmcnt(0)
    s_barrier
    ds_read_b128 v[148:151], v249 offset:0
    ds_read_b128 v[152:155], v249 offset:1024
    v_mfma_f32_16x16x32_f16 v[164:167], v[68:71], v[116:119], v[164:167]
    v_mov_b32_dpp v194, v198 quad_perm:[0,1,2,3] row_mask:0xf bank_mask:0x3
    v_mov_b32_dpp v195, v199 quad_perm:[0,1,2,3] row_mask:0xf bank_mask:0x3
    v_mfma_f32_16x16x32_f16 v[164:167], v[72:75], v[120:123], v[164:167]
    v_mfma_f32_16x16x32_f16 v[188:191], v[44:47], v[92:95], 0
    ds_read_b128 v[108:111], v248 offset:2528
    v_mfma_f32_16x16x32_f16 v[188:191], v[48:51], v[96:99], v[188:191]
    ds_read_b128 v[112:115], v248 offset:2464
    v_mfma_f32_16x16x32_f16 v[188:191], v[52:55], v[100:103], v[188:191]
    ds_read_b128 v[116:119], v248 offset:2400
    v_mfma_f32_16x16x32_f16 v[188:191], v[56:59], v[104:107], v[188:191]
    ds_read_b128 v[120:123], v248 offset:2336
    v_mfma_f32_16x16x32_f16 v[188:191], v[76:79], v[124:127], v[188:191]
    v_add_f32_dpp v164, v192, v164 row_ror:8 row_mask:0xf bank_mask:0xf
    v_add_f32_dpp v165, v193, v165 row_ror:8 row_mask:0xf bank_mask:0xf
    v_mfma_f32_16x16x32_f16 v[188:191], v[80:83], v[128:131], v[188:191]
    v_add_f32_dpp v166, v194, v166 row_ror:8 row_mask:0xf bank_mask:0xf
    v_add_f32_dpp v167, v195, v167 row_ror:8 row_mask:0xf bank_mask:0xf
    v_mfma_f32_16x16x32_f16 v[188:191], v[84:87], v[132:135], v[188:191]
    s_waitcnt lgkmcnt(5)
    v_add_f32 v164, v164, v148
    v_add_f32 v165, v165, v149
    v_mfma_f32_16x16x32_f16 v[188:191], v[88:91], v[136:139], v[188:191]
    v_add_f32 v166, v166, v150
    v_add_f32 v167, v167, v151
    s_waitcnt lgkmcnt(4)
    v_mfma_f32_16x16x32_f16 v[152:155], v[28:31], v[92:95], v[152:155]
    v_cvt_pkrtz_f16_f32 v164, v164, v165
    v_cvt_pkrtz_f16_f32 v165, v166, v167
    v_mfma_f32_16x16x32_f16 v[152:155], v[32:35], v[96:99], v[152:155]
    v_mfma_f32_16x16x32_f16 v[152:155], v[36:39], v[100:103], v[152:155]
    ds_write_b64 v251, v[164:165] offset:1024
    v_mfma_f32_16x16x32_f16 v[152:155], v[40:43], v[104:107], v[152:155]
    v_mfma_f32_16x16x32_f16 v[152:155], v[60:63], v[124:127], v[152:155]
    v_mfma_f32_16x16x32_f16 v[152:155], v[64:67], v[128:131], v[152:155]
    v_mov_b32_dpp v196, v188 quad_perm:[0,1,2,3] row_mask:0xf bank_mask:0x3
    v_mov_b32_dpp v197, v189 quad_perm:[0,1,2,3] row_mask:0xf bank_mask:0x3
    v_mfma_f32_16x16x32_f16 v[152:155], v[68:71], v[132:135], v[152:155]
    v_mov_b32_dpp v198, v190 quad_perm:[0,1,2,3] row_mask:0xf bank_mask:0x3
    v_mov_b32_dpp v199, v191 quad_perm:[0,1,2,3] row_mask:0xf bank_mask:0x3
    v_mfma_f32_16x16x32_f16 v[152:155], v[72:75], v[136:139], v[152:155]
    s_waitcnt lgkmcnt(3)
    v_mfma_f32_16x16x32_f16 v[192:195], v[44:47], v[108:111], 0
    ds_read_b128 v[124:127], v248 offset:3040
    v_mfma_f32_16x16x32_f16 v[192:195], v[48:51], v[112:115], v[192:195]
    ds_read_b128 v[128:131], v248 offset:2976
    s_waitcnt lgkmcnt(3)
    v_mfma_f32_16x16x32_f16 v[192:195], v[52:55], v[116:119], v[192:195]
    ds_read_b128 v[132:135], v248 offset:2912
    v_mfma_f32_16x16x32_f16 v[192:195], v[56:59], v[120:123], v[192:195]
    ds_read_b128 v[136:139], v248 offset:2848
    v_mfma_f32_16x16x32_f16 v[192:195], v[76:79], v[92:95], v[192:195]
    v_add_f32_dpp v152, v196, v152 row_ror:8 row_mask:0xf bank_mask:0xf
    v_add_f32_dpp v153, v197, v153 row_ror:8 row_mask:0xf bank_mask:0xf
    v_mfma_f32_16x16x32_f16 v[192:195], v[80:83], v[96:99], v[192:195]
    v_add_f32_dpp v154, v198, v154 row_ror:8 row_mask:0xf bank_mask:0xf
    v_add_f32_dpp v155, v199, v155 row_ror:8 row_mask:0xf bank_mask:0xf
    v_mfma_f32_16x16x32_f16 v[192:195], v[84:87], v[100:103], v[192:195]
    v_cvt_pkrtz_f16_f32 v152, v152, v153
    v_cvt_pkrtz_f16_f32 v153, v154, v155
    v_mfma_f32_16x16x32_f16 v[192:195], v[88:91], v[104:107], v[192:195]
    v_mfma_f32_16x16x32_f16 v[172:175], v[28:31], v[108:111], 0
    ds_write_b64 v251, v[152:153] offset:1536
    v_mfma_f32_16x16x32_f16 v[172:175], v[32:35], v[112:115], v[172:175]
    v_mfma_f32_16x16x32_f16 v[172:175], v[36:39], v[116:119], v[172:175]
    v_mfma_f32_16x16x32_f16 v[172:175], v[40:43], v[120:123], v[172:175]
    v_mfma_f32_16x16x32_f16 v[172:175], v[60:63], v[92:95], v[172:175]
    v_mfma_f32_16x16x32_f16 v[172:175], v[64:67], v[96:99], v[172:175]
    s_nop 0
    v_mov_b32_dpp v188, v192 quad_perm:[0,1,2,3] row_mask:0xf bank_mask:0x3
    v_mov_b32_dpp v189, v193 quad_perm:[0,1,2,3] row_mask:0xf bank_mask:0x3
    s_waitcnt lgkmcnt(0)
    s_barrier
    ds_read_b128 v[140:143], v249 offset:2048
    ds_read_b128 v[144:147], v249 offset:3072
    v_mfma_f32_16x16x32_f16 v[172:175], v[68:71], v[100:103], v[172:175]
    v_mov_b32_dpp v190, v194 quad_perm:[0,1,2,3] row_mask:0xf bank_mask:0x3
    v_mov_b32_dpp v191, v195 quad_perm:[0,1,2,3] row_mask:0xf bank_mask:0x3
    v_mfma_f32_16x16x32_f16 v[172:175], v[72:75], v[104:107], v[172:175]
    v_mfma_f32_16x16x32_f16 v[196:199], v[44:47], v[124:127], 0
    ds_read_b128 v[92:95], v248 offset:3552
    v_mfma_f32_16x16x32_f16 v[196:199], v[48:51], v[128:131], v[196:199]
    ds_read_b128 v[96:99], v248 offset:3488
    v_mfma_f32_16x16x32_f16 v[196:199], v[52:55], v[132:135], v[196:199]
    ds_read_b128 v[100:103], v248 offset:3424
    v_mfma_f32_16x16x32_f16 v[196:199], v[56:59], v[136:139], v[196:199]
    ds_read_b128 v[104:107], v248 offset:3360
    v_mfma_f32_16x16x32_f16 v[196:199], v[76:79], v[108:111], v[196:199]
    v_add_f32_dpp v172, v188, v172 row_ror:8 row_mask:0xf bank_mask:0xf
    v_add_f32_dpp v173, v189, v173 row_ror:8 row_mask:0xf bank_mask:0xf
    v_mfma_f32_16x16x32_f16 v[196:199], v[80:83], v[112:115], v[196:199]
    v_add_f32_dpp v174, v190, v174 row_ror:8 row_mask:0xf bank_mask:0xf
    v_add_f32_dpp v175, v191, v175 row_ror:8 row_mask:0xf bank_mask:0xf
    v_mfma_f32_16x16x32_f16 v[196:199], v[84:87], v[116:119], v[196:199]
    s_waitcnt lgkmcnt(5)
    v_add_f32 v172, v172, v140
    v_add_f32 v173, v173, v141
    v_mfma_f32_16x16x32_f16 v[196:199], v[88:91], v[120:123], v[196:199]
    v_add_f32 v174, v174, v142
    v_add_f32 v175, v175, v143
    s_waitcnt lgkmcnt(4)
    v_mfma_f32_16x16x32_f16 v[144:147], v[28:31], v[124:127], v[144:147]
    v_cvt_pkrtz_f16_f32 v172, v172, v173
    v_cvt_pkrtz_f16_f32 v173, v174, v175
    v_mfma_f32_16x16x32_f16 v[144:147], v[32:35], v[128:131], v[144:147]
    v_mfma_f32_16x16x32_f16 v[144:147], v[36:39], v[132:135], v[144:147]
    ds_write_b64 v251, v[172:173] offset:2048
    v_mfma_f32_16x16x32_f16 v[144:147], v[40:43], v[136:139], v[144:147]
    v_mfma_f32_16x16x32_f16 v[144:147], v[60:63], v[108:111], v[144:147]
    v_mfma_f32_16x16x32_f16 v[144:147], v[64:67], v[112:115], v[144:147]
    v_mov_b32_dpp v192, v196 quad_perm:[0,1,2,3] row_mask:0xf bank_mask:0x3
    v_mov_b32_dpp v193, v197 quad_perm:[0,1,2,3] row_mask:0xf bank_mask:0x3
    v_mfma_f32_16x16x32_f16 v[144:147], v[68:71], v[116:119], v[144:147]
    v_mov_b32_dpp v194, v198 quad_perm:[0,1,2,3] row_mask:0xf bank_mask:0x3
    v_mov_b32_dpp v195, v199 quad_perm:[0,1,2,3] row_mask:0xf bank_mask:0x3
    v_mfma_f32_16x16x32_f16 v[144:147], v[72:75], v[120:123], v[144:147]
    s_waitcnt lgkmcnt(3)
    v_mfma_f32_16x16x32_f16 v[188:191], v[44:47], v[92:95], 0
    ds_read_b128 v[108:111], v248 offset:4064
    v_mfma_f32_16x16x32_f16 v[188:191], v[48:51], v[96:99], v[188:191]
    ds_read_b128 v[112:115], v248 offset:4000
    s_waitcnt lgkmcnt(3)
    v_mfma_f32_16x16x32_f16 v[188:191], v[52:55], v[100:103], v[188:191]
    ds_read_b128 v[116:119], v248 offset:3936
    v_mfma_f32_16x16x32_f16 v[188:191], v[56:59], v[104:107], v[188:191]
    ds_read_b128 v[120:123], v248 offset:3872
    v_mfma_f32_16x16x32_f16 v[188:191], v[76:79], v[124:127], v[188:191]
    v_add_f32_dpp v144, v192, v144 row_ror:8 row_mask:0xf bank_mask:0xf
    v_add_f32_dpp v145, v193, v145 row_ror:8 row_mask:0xf bank_mask:0xf
    v_mfma_f32_16x16x32_f16 v[188:191], v[80:83], v[128:131], v[188:191]
    v_add_f32_dpp v146, v194, v146 row_ror:8 row_mask:0xf bank_mask:0xf
    v_add_f32_dpp v147, v195, v147 row_ror:8 row_mask:0xf bank_mask:0xf
    v_mfma_f32_16x16x32_f16 v[188:191], v[84:87], v[132:135], v[188:191]
    v_cvt_pkrtz_f16_f32 v144, v144, v145
    v_cvt_pkrtz_f16_f32 v145, v146, v147
    v_mfma_f32_16x16x32_f16 v[188:191], v[88:91], v[136:139], v[188:191]
    v_mfma_f32_16x16x32_f16 v[180:183], v[28:31], v[92:95], 0
    ds_write_b64 v251, v[144:145] offset:2560
    v_mfma_f32_16x16x32_f16 v[180:183], v[32:35], v[96:99], v[180:183]
    v_mfma_f32_16x16x32_f16 v[180:183], v[36:39], v[100:103], v[180:183]
    v_mfma_f32_16x16x32_f16 v[180:183], v[40:43], v[104:107], v[180:183]
    v_mfma_f32_16x16x32_f16 v[180:183], v[60:63], v[124:127], v[180:183]
    s_waitcnt lgkmcnt(0)
    s_barrier
    ds_read_b128 v[148:151], v249 offset:4096
    ds_read_b128 v[152:155], v249 offset:5120
    v_mfma_f32_16x16x32_f16 v[180:183], v[64:67], v[128:131], v[180:183]
    v_mov_b32_dpp v196, v188 quad_perm:[0,1,2,3] row_mask:0xf bank_mask:0x3
    v_mov_b32_dpp v197, v189 quad_perm:[0,1,2,3] row_mask:0xf bank_mask:0x3
    v_mfma_f32_16x16x32_f16 v[180:183], v[68:71], v[132:135], v[180:183]
    v_mov_b32_dpp v198, v190 quad_perm:[0,1,2,3] row_mask:0xf bank_mask:0x3
    v_mov_b32_dpp v199, v191 quad_perm:[0,1,2,3] row_mask:0xf bank_mask:0x3
    v_mfma_f32_16x16x32_f16 v[180:183], v[72:75], v[136:139], v[180:183]
    v_mfma_f32_16x16x32_f16 v[192:195], v[44:47], v[108:111], 0
    v_mfma_f32_16x16x32_f16 v[192:195], v[48:51], v[112:115], v[192:195]
    v_mfma_f32_16x16x32_f16 v[192:195], v[52:55], v[116:119], v[192:195]
    v_mfma_f32_16x16x32_f16 v[192:195], v[56:59], v[120:123], v[192:195]
    v_mfma_f32_16x16x32_f16 v[192:195], v[76:79], v[92:95], v[192:195]
    v_mfma_f32_16x16x32_f16 v[192:195], v[80:83], v[96:99], v[192:195]
    s_nop 1
    v_add_f32_dpp v180, v196, v180 row_ror:8 row_mask:0xf bank_mask:0xf
    v_add_f32_dpp v181, v197, v181 row_ror:8 row_mask:0xf bank_mask:0xf
    v_mfma_f32_16x16x32_f16 v[192:195], v[84:87], v[100:103], v[192:195]
    v_add_f32_dpp v182, v198, v182 row_ror:8 row_mask:0xf bank_mask:0xf
    v_add_f32_dpp v183, v199, v183 row_ror:8 row_mask:0xf bank_mask:0xf
    v_mfma_f32_16x16x32_f16 v[192:195], v[88:91], v[104:107], v[192:195]
    s_waitcnt lgkmcnt(1)
    v_add_f32 v180, v180, v148
    v_add_f32 v181, v181, v149
    s_waitcnt lgkmcnt(0)
    v_mfma_f32_16x16x32_f16 v[152:155], v[28:31], v[108:111], v[152:155]
    v_add_f32 v182, v182, v150
    v_add_f32 v183, v183, v151
    v_mfma_f32_16x16x32_f16 v[152:155], v[32:35], v[112:115], v[152:155]
    v_cvt_pkrtz_f16_f32 v180, v180, v181
    v_cvt_pkrtz_f16_f32 v181, v182, v183
    v_mfma_f32_16x16x32_f16 v[152:155], v[36:39], v[116:119], v[152:155]
    v_mfma_f32_16x16x32_f16 v[152:155], v[40:43], v[120:123], v[152:155]
    ds_write_b64 v251, v[180:181] offset:3072
    s_waitcnt lgkmcnt(0)
    s_barrier
    v_mfma_f32_16x16x32_f16 v[152:155], v[60:63], v[92:95], v[152:155]
    v_mfma_f32_16x16x32_f16 v[152:155], v[64:67], v[96:99], v[152:155]
    v_mov_b32_dpp v188, v192 quad_perm:[0,1,2,3] row_mask:0xf bank_mask:0x3
    v_mov_b32_dpp v189, v193 quad_perm:[0,1,2,3] row_mask:0xf bank_mask:0x3
    v_mfma_f32_16x16x32_f16 v[152:155], v[68:71], v[100:103], v[152:155]
    v_mov_b32_dpp v190, v194 quad_perm:[0,1,2,3] row_mask:0xf bank_mask:0x3
    v_mov_b32_dpp v191, v195 quad_perm:[0,1,2,3] row_mask:0xf bank_mask:0x3
    v_mfma_f32_16x16x32_f16 v[152:155], v[72:75], v[104:107], v[152:155]
    s_nop 7
    v_add_f32_dpp v152, v188, v152 row_ror:8 row_mask:0xf bank_mask:0xf
    v_add_f32_dpp v153, v189, v153 row_ror:8 row_mask:0xf bank_mask:0xf
    v_add_f32_dpp v154, v190, v154 row_ror:8 row_mask:0xf bank_mask:0xf
    v_add_f32_dpp v155, v191, v155 row_ror:8 row_mask:0xf bank_mask:0xf
    v_cvt_pkrtz_f16_f32 v152, v152, v153
    v_cvt_pkrtz_f16_f32 v153, v154, v155
    ds_write_b64 v251, v[152:153] offset:3584
    s_waitcnt lgkmcnt(0)
    s_barrier
    s_waitcnt vmcnt(0)
    s_branch RPREP
H_PATH:
    s_waitcnt lgkmcnt(0)
    s_barrier
    v_and_b32 v14, 15, v1
    v_lshrrev_b32 v15, 4, v1
    s_mul_i32 s46, s51, 4640
    s_add_u32 s46, s46, 114048
    v_lshlrev_b32 v248, 5, v14
    v_lshl_add_u32 v248, v15, 4, v248
    v_add_u32 v248, s46, v248
    s_mul_i32 s46, s51, 6144
    s_add_u32 s46, s46, 20480
    v_add_u32 v249, s46, v2
    v_lshlrev_b32 v250, 3, v15
    v_sub_u32 v250, v250, v14
    v_add_u32 v250, 15, v250
    v_and_b32 v34, 1, v250
    v_mul_u32_u24 v34, 1090, v34
    v_lshl_add_u32 v250, v250, 1, v34
    v_add_u32 v250, s62, v250
    v_lshlrev_b32 v251, 2, v15
    v_sub_u32 v251, v251, v14
    v_lshlrev_b32 v251, 2, v251
    s_add_u32 s46, s62, 2252
    v_add_u32 v251, s46, v251
    v_bfe_u32 v34, v1, 2, 2
    v_mul_u32_u24 v34, 4128, v34
    v_and_b32 v35, 1, v1
    v_lshl_add_u32 v34, v35, 7, v34
    v_lshl_add_u32 v34, v15, 4, v34
    v_and_b32 v35, 2, v1
    v_lshl_add_u32 v34, v35, 2, v34
    s_and_b32 s46, s3, 1
    s_lshl_b32 s46, s46, 6
    v_add_u32 v252, s46, v34
    v_lshrrev_b32 v34, 3, v1
    v_mul_u32_u24 v34, 18432, v34
    v_and_b32 v35, 7, v1
    v_lshl_add_u32 v253, v35, 4, v34
    s_and_b32 s46, s3, 1
    s_mul_i32 s46, s46, 147456
    s_lshl_b32 s63, s2, 7
    s_add_u32 s63, s63, s46
    s_add_u32 s63, s63, 4194304
    v_and_b32 v34, 3, v1
    v_mul_u32_u24 v34, 4640, v34
    v_lshrrev_b32 v35, 2, v1
    v_lshl_add_u32 v34, v35, 4, v34
    s_mul_i32 s46, s51, 768
    s_add_u32 s46, s46, 114560
    v_add_u32 v254, s46, v34
    s_cmp_lt_u32 s49, 128
    s_cbranch_scc1 H_UI
    v_subrev_u32 v14, 9472, v25
    v_subrev_u32 v15, 9472, v26
    ds_read_b128 v[120:123], v14
    ds_read_b128 v[124:127], v14 offset:512
    ds_read_b32 v128, v15 offset:1024
    s_mov_b32 s46, 10485760
    s_waitcnt lgkmcnt(0)
    v_add_u32 v120, v11, v120
    v_add_u32 v121, v11, v121
    v_add_u32 v122, v11, v122
    v_add_u32 v123, v11, v123
    v_add_u32 v124, v11, v124
    v_add_u32 v125, v11, v125
    v_add_u32 v126, v11, v126
    v_add_u32 v127, v11, v127
    v_add_u32 v128, v11, v128
    v_and_or_b32 v120, v120, v9, v10
    v_and_or_b32 v121, v121, v9, v10
    v_and_or_b32 v122, v122, v9, v10
    v_and_or_b32 v123, v123, v9, v10
    v_and_or_b32 v124, v124, v9, v10
    v_and_or_b32 v125, v125, v9, v10
    v_and_or_b32 v126, v126, v9, v10
    v_and_or_b32 v127, v127, v9, v10
    v_and_or_b32 v128, v128, v9, v10
    buffer_store_dwordx4 v[120:123], v4, s[32:35], s46 offen sc1
    buffer_store_dwordx4 v[124:127], v4, s[32:35], s46 offen offset:512 sc1
    buffer_store_dword v128, v5, s[32:35], s46 offen offset:1024 sc1
H_UI:
    s_mov_b32 s47, 0
PL2:
    s_waitcnt vmcnt(0)
    v_xor_b32 v200, v10, v200
    v_xor_b32 v201, v10, v201
    v_xor_b32 v202, v10, v202
    v_xor_b32 v203, v10, v203
    v_xor_b32 v204, v10, v204
    v_xor_b32 v205, v10, v205
    v_xor_b32 v206, v10, v206
    v_xor_b32 v207, v10, v207
    v_xor_b32 v208, v10, v208
    v_xor_b32 v209, v10, v209
    v_xor_b32 v210, v10, v210
    v_xor_b32 v211, v10, v211
    v_or3_b32 v14, v200, v201, v202
    v_or3_b32 v14, v14, v203, v204
    v_or3_b32 v14, v14, v205, v206
    v_or3_b32 v14, v14, v207, v208
    v_or3_b32 v14, v14, v209, v210
    v_or_b32 v14, v14, v211
    v_and_b32 v14, 0x70007, v14
    v_cmp_ne_u32 vcc, 0, v14
    s_cbranch_vccz PD3
    s_add_u32 s47, s47, 1
    s_cmp_ge_u32 s47, 262144
    s_cbranch_scc1 PD3
    s_sleep 2
    buffer_load_dwordx4 v[200:203], v2, s[32:35], s48 offen offset:0 sc1
    buffer_load_dwordx4 v[204:207], v2, s[32:35], s48 offen offset:1024 sc1
    buffer_load_dwordx4 v[208:211], v2, s[32:35], s48 offen offset:2048 sc1
    s_branch PL2
PD3:
    ds_write_b128 v254, v[200:203] offset:0
    ds_write_b128 v254, v[204:207] offset:256
    ds_write_b128 v254, v[208:211] offset:512
    buffer_load_dwordx4 v[244:247], v2, s[32:35], s59 offen sc1
    s_lshl_b32 s46, s51, 9
    v_subrev_u32 v254, s46, v254
    v_mov_b32 v15, s62
    s_setprio 1
    s_waitcnt lgkmcnt(0)
    s_barrier
    ds_read_b128 v[28:31], v248 offset:480
    ds_read_b128 v[32:35], v248 offset:464
    ds_read_b128 v[36:39], v248 offset:992
    ds_read_b128 v[40:43], v248 offset:976
    s_waitcnt lgkmcnt(3)
    v_mfma_f32_16x16x32_f16 v[76:79], v[28:31], v[172:175], 0
    v_mfma_f32_16x16x32_f16 v[80:83], v[28:31], v[168:171], 0
    v_mfma_f32_16x16x32_f16 v[88:91], v[28:31], v[176:179], 0
    s_waitcnt lgkmcnt(2)
    v_mfma_f32_16x16x32_f16 v[84:87], v[32:35], v[180:183], 0
    ds_read_b128 v[44:47], v248 offset:1504
    ds_read_b128 v[48:51], v248 offset:1488
    v_mfma_f32_16x16x32_f16 v[92:95], v[28:31], v[184:187], 0
    s_nop 1
    v_cvt_pk_f16_f32 v100, v76, v80
    v_cvt_pk_f16_f32 v101, v77, v81
    v_mfma_f32_16x16x32_f16 v[96:99], v[32:35], v[188:191], 0
    v_cvt_pk_f16_f32 v102, v78, v82
    v_cvt_pk_f16_f32 v103, v79, v83
    s_waitcnt lgkmcnt(3)
    v_mfma_f32_16x16x32_f16 v[76:79], v[36:39], v[172:175], 0
    v_cvt_pk_f16_f32 v104, v84, v88
    v_cvt_pk_f16_f32 v105, v85, v89
    v_mfma_f32_16x16x32_f16 v[80:83], v[36:39], v[168:171], 0
    v_cvt_pk_f16_f32 v106, v86, v90
    v_cvt_pk_f16_f32 v107, v87, v91
    v_mfma_f32_16x16x32_f16 v[88:91], v[36:39], v[176:179], 0
    v_cvt_pk_f16_f32 v148, v92, v96
    v_cvt_pk_f16_f32 v149, v93, v97
    s_waitcnt lgkmcnt(2)
    v_mfma_f32_16x16x32_f16 v[84:87], v[40:43], v[180:183], 0
    v_cvt_pk_f16_f32 v150, v94, v98
    v_cvt_pk_f16_f32 v151, v95, v99
    ds_read_b128 v[52:55], v248 offset:2016
    ds_read_b128 v[56:59], v248 offset:2000
    v_mfma_f32_16x16x32_f16 v[92:95], v[36:39], v[184:187], 0
    v_cvt_pk_f16_f32 v108, v76, v80
    v_cvt_pk_f16_f32 v109, v77, v81
    v_mfma_f32_16x16x32_f16 v[96:99], v[40:43], v[188:191], 0
    v_cvt_pk_f16_f32 v110, v78, v82
    v_cvt_pk_f16_f32 v111, v79, v83
    s_waitcnt lgkmcnt(3)
    v_mfma_f32_16x16x32_f16 v[76:79], v[44:47], v[172:175], 0
    v_cvt_pk_f16_f32 v112, v84, v88
    v_cvt_pk_f16_f32 v113, v85, v89
    v_mfma_f32_16x16x32_f16 v[80:83], v[44:47], v[168:171], 0
    v_cvt_pk_f16_f32 v114, v86, v90
    v_cvt_pk_f16_f32 v115, v87, v91
    ds_read_b128 v[60:63], v248 offset:2528
    ds_read_b128 v[64:67], v248 offset:2512
    v_mfma_f32_16x16x32_f16 v[88:91], v[44:47], v[176:179], 0
    v_cvt_pk_f16_f32 v152, v92, v96
    v_cvt_pk_f16_f32 v153, v93, v97
    s_waitcnt lgkmcnt(4)
    v_mfma_f32_16x16x32_f16 v[84:87], v[48:51], v[180:183], 0
    v_cvt_pk_f16_f32 v154, v94, v98
    v_cvt_pk_f16_f32 v155, v95, v99
    v_mfma_f32_16x16x32_f16 v[92:95], v[44:47], v[184:187], 0
    v_cvt_pk_f16_f32 v116, v76, v80
    v_cvt_pk_f16_f32 v117, v77, v81
    v_mfma_f32_16x16x32_f16 v[96:99], v[48:51], v[188:191], 0
    v_cvt_pk_f16_f32 v118, v78, v82
    v_cvt_pk_f16_f32 v119, v79, v83
    ds_read_b128 v[68:71], v248 offset:3040
    ds_read_b128 v[72:75], v248 offset:3024
    s_waitcnt lgkmcnt(5)
    v_mfma_f32_16x16x32_f16 v[76:79], v[52:55], v[172:175], 0
    v_cvt_pk_f16_f32 v120, v84, v88
    v_cvt_pk_f16_f32 v121, v85, v89
    v_mfma_f32_16x16x32_f16 v[80:83], v[52:55], v[168:171], 0
    v_cvt_pk_f16_f32 v122, v86, v90
    v_cvt_pk_f16_f32 v123, v87, v91
    v_mfma_f32_16x16x32_f16 v[88:91], v[52:55], v[176:179], 0
    v_cvt_pk_f16_f32 v156, v92, v96
    v_cvt_pk_f16_f32 v157, v93, v97
    s_waitcnt lgkmcnt(4)
    v_mfma_f32_16x16x32_f16 v[84:87], v[56:59], v[180:183], 0
    v_cvt_pk_f16_f32 v158, v94, v98
    v_cvt_pk_f16_f32 v159, v95, v99
    ds_read2_b32 v[196:197], v250 offset0:0 offset1:1
    ds_read2_b32 v[198:199], v250 offset0:2 offset1:3
    v_mfma_f32_16x16x32_f16 v[92:95], v[52:55], v[184:187], 0
    v_cvt_pk_f16_f32 v124, v76, v80
    v_cvt_pk_f16_f32 v125, v77, v81
    v_mfma_f32_16x16x32_f16 v[96:99], v[56:59], v[188:191], 0
    v_cvt_pk_f16_f32 v126, v78, v82
    v_cvt_pk_f16_f32 v127, v79, v83
    ds_read2_b32 v[200:201], v251 offset0:32 offset1:33
    ds_read2_b32 v[202:203], v251 offset0:34 offset1:35
    s_waitcnt lgkmcnt(7)
    v_mfma_f32_16x16x32_f16 v[76:79], v[60:63], v[172:175], 0
    v_cvt_pk_f16_f32 v128, v84, v88
    v_cvt_pk_f16_f32 v129, v85, v89
    v_mfma_f32_16x16x32_f16 v[80:83], v[60:63], v[168:171], 0
    v_cvt_pk_f16_f32 v130, v86, v90
    v_cvt_pk_f16_f32 v131, v87, v91
    ds_read2_b32 v[204:205], v251 offset0:80 offset1:81
    ds_read2_b32 v[206:207], v251 offset0:82 offset1:83
    v_mfma_f32_16x16x32_f16 v[88:91], v[60:63], v[176:179], 0
    v_cvt_pk_f16_f32 v160, v92, v96
    v_cvt_pk_f16_f32 v161, v93, v97
    s_waitcnt lgkmcnt(8)
    v_mfma_f32_16x16x32_f16 v[84:87], v[64:67], v[180:183], 0
    v_cvt_pk_f16_f32 v162, v94, v98
    v_cvt_pk_f16_f32 v163, v95, v99
    ds_read2_b32 v[208:209], v251 offset0:16 offset1:17
    ds_read2_b32 v[210:211], v251 offset0:18 offset1:19
    s_waitcnt lgkmcnt(9)
    v_mfma_f32_16x16x32_f16 v[92:95], v[68:71], v[172:175], 0
    v_cvt_pk_f16_f32 v132, v76, v80
    v_cvt_pk_f16_f32 v133, v77, v81
    v_mfma_f32_16x16x32_f16 v[96:99], v[68:71], v[168:171], 0
    v_cvt_pk_f16_f32 v134, v78, v82
    v_cvt_pk_f16_f32 v135, v79, v83
    ds_read2_b32 v[212:213], v251 offset0:64 offset1:65
    ds_read2_b32 v[214:215], v251 offset0:66 offset1:67
    v_mfma_f32_16x16x32_f16 v[80:83], v[68:71], v[176:179], 0
    v_cvt_pk_f16_f32 v136, v84, v88
    v_cvt_pk_f16_f32 v137, v85, v89
    s_waitcnt lgkmcnt(10)
    v_mfma_f32_16x16x32_f16 v[76:79], v[72:75], v[180:183], 0
    v_cvt_pk_f16_f32 v138, v86, v90
    v_cvt_pk_f16_f32 v139, v87, v91
    ds_read_u16 v15, v15 offset:2448
    s_waitcnt lgkmcnt(9)
    v_mfma_f32_16x16x32_f16 v[164:167], v[196:199], v[28:31], 0
    v_cvt_pk_f16_f32 v140, v92, v96
    v_cvt_pk_f16_f32 v141, v93, v97
    s_waitcnt lgkmcnt(7)
    v_mfma_f32_16x16x32_f16 v[164:167], v[100:103], v[200:203], v[164:167]
    v_cvt_pk_f16_f32 v142, v94, v98
    v_cvt_pk_f16_f32 v143, v95, v99
    s_waitcnt lgkmcnt(5)
    v_mfma_f32_16x16x32_f16 v[164:167], v[104:107], v[204:207], v[164:167]
    v_cvt_pk_f16_f32 v144, v76, v80
    v_cvt_pk_f16_f32 v145, v77, v81
    v_mfma_f32_16x16x32_f16 v[240:243], v[196:199], v[36:39], 0
    v_cvt_pk_f16_f32 v146, v78, v82
    v_cvt_pk_f16_f32 v147, v79, v83
    v_mfma_f32_16x16x32_f16 v[240:243], v[108:111], v[200:203], v[240:243]
    s_waitcnt lgkmcnt(0)
    v_lshl_or_b32 v15, v15, 16, v15
    v_and_b32 v192, v15, v192
    v_and_b32 v193, v15, v193
    v_and_b32 v194, v15, v194
    v_and_b32 v195, v15, v195
    v_mfma_f32_16x16x32_f16 v[240:243], v[112:115], v[204:207], v[240:243]
    ds_read2_b32 v[216:217], v251 offset0:0 offset1:1
    ds_read2_b32 v[218:219], v251 offset0:2 offset1:3
    v_mfma_f32_16x16x32_f16 v[240:243], v[100:103], v[208:211], v[240:243]
    ds_read2_b32 v[220:221], v251 offset0:48 offset1:49
    ds_read2_b32 v[222:223], v251 offset0:50 offset1:51
    v_mfma_f32_16x16x32_f16 v[240:243], v[104:107], v[212:215], v[240:243]
    ds_write_b128 v249, v[164:167] offset:0
    ds_read2_b32 v[224:225], v251 offset0:160 offset1:161
    ds_read2_b32 v[226:227], v251 offset0:162 offset1:163
    s_mov_b32 s47, 0
PL4:
    s_waitcnt vmcnt(0)
    v_xor_b32 v244, v10, v244
    v_xor_b32 v245, v10, v245
    v_xor_b32 v246, v10, v246
    v_xor_b32 v247, v10, v247
    v_or3_b32 v14, v244, v245, v246
    v_or_b32 v14, v14, v247
    v_and_b32 v14, 0x70007, v14
    v_cmp_ne_u32 vcc, 0, v14
    s_cbranch_vccz PD5
    s_add_u32 s47, s47, 1
    s_cmp_ge_u32 s47, 262144
    s_cbranch_scc1 PD5
    s_sleep 2
    buffer_load_dwordx4 v[244:247], v2, s[32:35], s59 offen sc1
    s_branch PL4
PD5:
    ds_write_b128 v254, v[244:247] offset:3072
    s_bitcmp1_b32 s3, 1
    s_cselect_b32 s46, 1, 0
    s_lshl_b32 s50, s46, 9
    v_add_u32 v15, s50, v252
    s_mul_i32 s46, s46, 294912
    s_add_u32 s46, s46, s63
    ds_write_b128 v249, v[240:243] offset:1024
    s_waitcnt lgkmcnt(0)
    s_barrier
    ds_read_b64_tr_b16 v[244:245], v15 offset:0
    ds_read_b64_tr_b16 v[246:247], v15 offset:256
    v_mfma_f32_16x16x32_f16 v[164:167], v[196:199], v[44:47], 0
    ds_read2_b32 v[228:229], v251 offset0:144 offset1:145
    ds_read2_b32 v[230:231], v251 offset0:146 offset1:147
    v_mfma_f32_16x16x32_f16 v[164:167], v[116:119], v[200:203], v[164:167]
    ds_read2_b32 v[232:233], v251 offset0:128 offset1:129
    ds_read2_b32 v[234:235], v251 offset0:130 offset1:131
    v_mfma_f32_16x16x32_f16 v[164:167], v[120:123], v[204:207], v[164:167]
    s_mov_b32 s57, 10485760
    buffer_load_dwordx4 v[72:75], v4, s[32:35], s57 offen sc1
    buffer_load_dwordx4 v[76:79], v4, s[32:35], s57 offen offset:512 sc1
    buffer_load_dword v80, v5, s[32:35], s57 offen offset:1024 sc1
    global_load_dwordx4 v[16:19], v4, s[4:5]
    global_load_dwordx4 v[20:23], v4, s[4:5] offset:512
    global_load_dword v24, v5, s[4:5] offset:1024
    v_mfma_f32_16x16x32_f16 v[164:167], v[108:111], v[208:211], v[164:167]
    ds_read2_b32 v[236:237], v251 offset0:112 offset1:113
    ds_read2_b32 v[238:239], v251 offset0:114 offset1:115
    v_mfma_f32_16x16x32_f16 v[164:167], v[112:115], v[212:215], v[164:167]
    s_lshl_b32 s57, s51, 6
    v_add_u32 v14, s57, v1
    v_min_u32 v14, 143, v14
    v_lshlrev_b32 v27, 7, v14
    v_lshlrev_b32 v14, 4, v14
    s_mov_b32 s53, 32768
    buffer_load_dwordx4 v[32:35], v27, s[32:35], s53 offen sc1
    v_mfma_f32_16x16x32_f16 v[164:167], v[100:103], v[216:219], v[164:167]
    v_mfma_f32_16x16x32_f16 v[164:167], v[104:107], v[220:223], v[164:167]
    s_waitcnt lgkmcnt(6)
    v_add_u32 v244, v11, v244
    v_add_u32 v245, v11, v245
    v_add_u32 v246, v11, v246
    v_add_u32 v247, v11, v247
    v_and_or_b32 v244, v244, v9, v10
    v_and_or_b32 v245, v245, v9, v10
    v_and_or_b32 v246, v246, v9, v10
    v_and_or_b32 v247, v247, v9, v10
    buffer_store_dwordx4 v[244:247], v253, s[32:35], s46 offen sc1
    v_mfma_f32_16x16x32_f16 v[164:167], v[192:195], v[28:31], v[164:167]
    v_mfma_f32_16x16x32_f16 v[164:167], v[148:151], v[224:227], v[164:167]
    v_mfma_f32_16x16x32_f16 v[240:243], v[196:199], v[52:55], 0
    v_mfma_f32_16x16x32_f16 v[240:243], v[124:127], v[200:203], v[240:243]
    v_mfma_f32_16x16x32_f16 v[240:243], v[128:131], v[204:207], v[240:243]
    v_mfma_f32_16x16x32_f16 v[240:243], v[116:119], v[208:211], v[240:243]
    v_mfma_f32_16x16x32_f16 v[240:243], v[120:123], v[212:215], v[240:243]
    v_mfma_f32_16x16x32_f16 v[240:243], v[108:111], v[216:219], v[240:243]
    v_mfma_f32_16x16x32_f16 v[240:243], v[112:115], v[220:223], v[240:243]
    v_mfma_f32_16x16x32_f16 v[240:243], v[192:195], v[36:39], v[240:243]
    ds_write_b128 v249, v[164:167] offset:2048
    v_mfma_f32_16x16x32_f16 v[240:243], v[152:155], v[224:227], v[240:243]
    s_waitcnt lgkmcnt(5)
    v_mfma_f32_16x16x32_f16 v[240:243], v[148:151], v[228:231], v[240:243]
    v_mfma_f32_16x16x32_f16 v[164:167], v[196:199], v[60:63], 0
    v_mfma_f32_16x16x32_f16 v[164:167], v[132:135], v[200:203], v[164:167]
    v_mfma_f32_16x16x32_f16 v[164:167], v[136:139], v[204:207], v[164:167]
    v_mfma_f32_16x16x32_f16 v[164:167], v[124:127], v[208:211], v[164:167]
    v_mfma_f32_16x16x32_f16 v[164:167], v[128:131], v[212:215], v[164:167]
    v_mfma_f32_16x16x32_f16 v[164:167], v[116:119], v[216:219], v[164:167]
    v_mfma_f32_16x16x32_f16 v[164:167], v[120:123], v[220:223], v[164:167]
    v_mfma_f32_16x16x32_f16 v[164:167], v[192:195], v[44:47], v[164:167]
    ds_write_b128 v249, v[240:243] offset:3072
    v_mfma_f32_16x16x32_f16 v[164:167], v[156:159], v[224:227], v[164:167]
    v_mfma_f32_16x16x32_f16 v[164:167], v[152:155], v[228:231], v[164:167]
    s_waitcnt lgkmcnt(4)
    v_mfma_f32_16x16x32_f16 v[164:167], v[148:151], v[232:235], v[164:167]
    v_mfma_f32_16x16x32_f16 v[240:243], v[196:199], v[68:71], 0
    v_mfma_f32_16x16x32_f16 v[240:243], v[140:143], v[200:203], v[240:243]
    v_mfma_f32_16x16x32_f16 v[240:243], v[144:147], v[204:207], v[240:243]
    v_mfma_f32_16x16x32_f16 v[240:243], v[132:135], v[208:211], v[240:243]
    v_mfma_f32_16x16x32_f16 v[240:243], v[136:139], v[212:215], v[240:243]
    v_mfma_f32_16x16x32_f16 v[240:243], v[124:127], v[216:219], v[240:243]
    v_mfma_f32_16x16x32_f16 v[240:243], v[128:131], v[220:223], v[240:243]
    v_mfma_f32_16x16x32_f16 v[240:243], v[192:195], v[52:55], v[240:243]
    ds_write_b128 v249, v[164:167] offset:4096
    v_mfma_f32_16x16x32_f16 v[240:243], v[160:163], v[224:227], v[240:243]
    v_mfma_f32_16x16x32_f16 v[240:243], v[156:159], v[228:231], v[240:243]
    v_mfma_f32_16x16x32_f16 v[240:243], v[152:155], v[232:235], v[240:243]
    s_waitcnt lgkmcnt(3)
    v_mfma_f32_16x16x32_f16 v[240:243], v[148:151], v[236:239], v[240:243]
    s_bitcmp1_b32 s3, 1
    s_cselect_b32 s46, 3, 2
    s_lshl_b32 s50, s46, 9
    v_add_u32 v15, s50, v252
    s_mul_i32 s46, s46, 294912
    s_add_u32 s46, s46, s63
    s_nop 1
    ds_write_b128 v249, v[240:243] offset:5120
    s_waitcnt lgkmcnt(0)
    s_barrier
    ds_read_b64_tr_b16 v[244:245], v15 offset:0
    ds_read_b64_tr_b16 v[246:247], v15 offset:256
    s_waitcnt lgkmcnt(0)
    v_add_u32 v244, v11, v244
    v_add_u32 v245, v11, v245
    v_add_u32 v246, v11, v246
    v_add_u32 v247, v11, v247
    v_and_or_b32 v244, v244, v9, v10
    v_and_or_b32 v245, v245, v9, v10
    v_and_or_b32 v246, v246, v9, v10
    v_and_or_b32 v247, v247, v9, v10
    buffer_store_dwordx4 v[244:247], v253, s[32:35], s46 offen sc1
    s_setprio 0
    s_and_b32 s56, s40, 0x7fffff
    s_mov_b32 s47, 0
    s_waitcnt vmcnt(2)
SCP6:
    v_xor_b32 v32, s56, v32
    v_xor_b32 v33, s56, v33
    v_xor_b32 v34, s56, v34
    v_xor_b32 v35, s56, v35
    v_or3_b32 v255, v32, v33, v34
    v_or_b32 v255, v255, v35
    v_and_b32 v255, 0x7fffff, v255
    v_cmp_ne_u32 vcc, 0, v255
    s_cbranch_vccz SCD7
    s_add_u32 s47, s47, 1
    s_cmp_ge_u32 s47, 262144
    s_cbranch_scc1 SCD7
    s_sleep 8
    buffer_load_dwordx4 v[32:35], v27, s[32:35], s53 offen sc1
    s_waitcnt vmcnt(0)
    s_branch SCP6
SCD7:
    ds_write_b128 v14, v[32:35] offset:46080
    s_cmp_ge_u32 s49, 128
    s_cbranch_scc1 H_NOR
    global_load_dwordx4 v[208:211], v12, s[16:17]
    global_load_dwordx4 v[212:215], v12, s[16:17] offset:512
    global_load_dword v216, v13, s[16:17] offset:1024
    global_load_dwordx4 v[218:221], v12, s[20:21]
    global_load_dwordx4 v[222:225], v12, s[20:21] offset:512
    global_load_dword v226, v13, s[20:21] offset:1024
H_NOR:
    s_bitcmp1_b32 s3, 1
    s_cselect_b32 s46, 5, 4
    s_lshl_b32 s50, s46, 9
    v_add_u32 v15, s50, v252
    s_mul_i32 s46, s46, 294912
    s_add_u32 s46, s46, s63
    s_waitcnt lgkmcnt(0)
    s_barrier
    ds_read_b64_tr_b16 v[244:245], v15 offset:0
    ds_read_b64_tr_b16 v[246:247], v15 offset:256
    s_waitcnt lgkmcnt(0)
    v_add_u32 v244, v11, v244
    v_add_u32 v245, v11, v245
    v_add_u32 v246, v11, v246
    v_add_u32 v247, v11, v247
    v_and_or_b32 v244, v244, v9, v10
    v_and_or_b32 v245, v245, v9, v10
    v_and_or_b32 v246, v246, v9, v10
    v_and_or_b32 v247, v247, v9, v10
    buffer_store_dwordx4 v[244:247], v253, s[32:35], s46 offen sc1
    s_add_u32 s46, s63, 1769472
    s_bitcmp1_b32 s3, 1
    s_waitcnt lgkmcnt(0)
    s_barrier
    s_cbranch_scc1 YS8
    ds_read_b64_tr_b16 v[244:245], v252 offset:3072
    ds_read_b64_tr_b16 v[246:247], v252 offset:3328
    s_waitcnt lgkmcnt(0)
    v_add_u32 v244, v11, v244
    v_add_u32 v245, v11, v245
    v_add_u32 v246, v11, v246
    v_add_u32 v247, v11, v247
    v_and_or_b32 v244, v244, v9, v10
    v_and_or_b32 v245, v245, v9, v10
    v_and_or_b32 v246, v246, v9, v10
    v_and_or_b32 v247, v247, v9, v10
    buffer_store_dwordx4 v[244:247], v253, s[32:35], s46 offen sc1
YS8:
    s_add_u32 s46, s63, 2064384
    s_bitcmp1_b32 s3, 1
    s_waitcnt lgkmcnt(0)
    s_barrier
    s_cbranch_scc0 YS9
    ds_read_b64_tr_b16 v[244:245], v252 offset:3584
    ds_read_b64_tr_b16 v[246:247], v252 offset:3840
    s_waitcnt lgkmcnt(0)
    v_add_u32 v244, v11, v244
    v_add_u32 v245, v11, v245
    v_add_u32 v246, v11, v246
    v_add_u32 v247, v11, v247
    v_and_or_b32 v244, v244, v9, v10
    v_and_or_b32 v245, v245, v9, v10
    v_and_or_b32 v246, v246, v9, v10
    v_and_or_b32 v247, v247, v9, v10
    buffer_store_dwordx4 v[244:247], v253, s[32:35], s46 offen sc1
YS9:
RPREP:
    s_cmp_ge_u32 s49, 128
    s_cbranch_scc1 ZROLE
    s_cmp_lg_u32 s61, 0
    s_cselect_b32 s39, 1, 0
    s_cbranch_scc1 RP_U0
    ds_read_b128 v[72:75], v25
    ds_read_b128 v[76:79], v25 offset:512
    ds_read_b32 v80, v26 offset:1024
RP_U0:
    v_lshlrev_b32 v38, 1, v12
    v_lshlrev_b32 v39, 1, v13
    s_mul_i32 s60, s49, 18432
    s_add_u32 s60, s60, 4194304
    s_add_u32 s61, s60, 8192
    s_add_u32 s62, s60, 16384
    v_mov_b32 v204, 0
    s_waitcnt vmcnt(2)
    s_cmp_ge_u32 s49, 64
    s_cbranch_scc1 RP_0
    buffer_load_dwordx4 v[140:143], v3, s[32:35], s60 offen sc1
    buffer_load_dwordx4 v[144:147], v3, s[32:35], s61 offen sc1
    s_cmp_ge_u32 s3, 2
    s_cbranch_scc1 YL10
    buffer_load_dwordx4 v[148:151], v3, s[32:35], s62 offen sc1
YL10:
RP_0:
    v_lshlrev_b32 v84, 16, v208
    v_and_b32 v85, 0xffff0000, v208
    v_lshlrev_b32 v120, 16, v218
    v_and_b32 v121, 0xffff0000, v218
    v_dot2c_f32_bf16 v204, v218, v8
    v_lshlrev_b32 v86, 16, v209
    v_and_b32 v87, 0xffff0000, v209
    v_lshlrev_b32 v122, 16, v219
    v_and_b32 v123, 0xffff0000, v219
    v_dot2c_f32_bf16 v204, v219, v8
    v_lshlrev_b32 v88, 16, v210
    v_and_b32 v89, 0xffff0000, v210
    v_lshlrev_b32 v124, 16, v220
    v_and_b32 v125, 0xffff0000, v220
    v_dot2c_f32_bf16 v204, v220, v8
    v_lshlrev_b32 v90, 16, v211
    v_and_b32 v91, 0xffff0000, v211
    v_lshlrev_b32 v126, 16, v221
    v_and_b32 v127, 0xffff0000, v221
    v_dot2c_f32_bf16 v204, v221, v8
    v_lshlrev_b32 v92, 16, v212
    v_and_b32 v93, 0xffff0000, v212
    v_lshlrev_b32 v128, 16, v222
    v_and_b32 v129, 0xffff0000, v222
    v_dot2c_f32_bf16 v204, v222, v8
    v_lshlrev_b32 v94, 16, v213
    v_and_b32 v95, 0xffff0000, v213
    v_lshlrev_b32 v130, 16, v223
    v_and_b32 v131, 0xffff0000, v223
    v_dot2c_f32_bf16 v204, v223, v8
    v_lshlrev_b32 v96, 16, v214
    v_and_b32 v97, 0xffff0000, v214
    v_lshlrev_b32 v132, 16, v224
    v_and_b32 v133, 0xffff0000, v224
    v_dot2c_f32_bf16 v204, v224, v8
    v_lshlrev_b32 v98, 16, v215
    v_and_b32 v99, 0xffff0000, v215
    v_lshlrev_b32 v134, 16, v225
    v_and_b32 v135, 0xffff0000, v225
    v_dot2c_f32_bf16 v204, v225, v8
    v_lshlrev_b32 v100, 16, v216
    v_and_b32 v101, 0xffff0000, v216
    v_lshlrev_b32 v136, 16, v226
    v_and_b32 v137, 0xffff0000, v226
    v_dot2c_f32_bf16 v204, v226, v8
    s_waitcnt lgkmcnt(0)
    s_cmp_lg_u32 s39, 0
    s_cbranch_scc1 RP_U1
    v_add_u32 v72, v11, v72
    v_add_u32 v73, v11, v73
    v_add_u32 v74, v11, v74
    v_add_u32 v75, v11, v75
    v_add_u32 v76, v11, v76
    v_add_u32 v77, v11, v77
    v_add_u32 v78, v11, v78
    v_add_u32 v79, v11, v79
    v_add_u32 v80, v11, v80
    v_and_b32 v72, v9, v72
    v_and_b32 v73, v9, v73
    v_and_b32 v74, v9, v74
    v_and_b32 v75, v9, v75
    v_and_b32 v76, v9, v76
    v_and_b32 v77, v9, v77
    v_and_b32 v78, v9, v78
    v_and_b32 v79, v9, v79
    v_and_b32 v80, v9, v80
    s_branch RP_U2
RP_U1:
    s_mov_b32 s47, 0
RP_U3:
    v_xor_b32 v72, v10, v72
    v_xor_b32 v73, v10, v73
    v_xor_b32 v74, v10, v74
    v_xor_b32 v75, v10, v75
    v_xor_b32 v76, v10, v76
    v_xor_b32 v77, v10, v77
    v_xor_b32 v78, v10, v78
    v_xor_b32 v79, v10, v79
    v_xor_b32 v80, v10, v80
    v_or3_b32 v37, v72, v73, v74
    v_or3_b32 v37, v37, v75, v76
    v_or3_b32 v37, v37, v77, v78
    v_or3_b32 v37, v37, v79, v80
    v_and_b32 v37, 0x70007, v37
    v_cmp_ne_u32 vcc, 0, v37
    s_cbranch_vccz RP_U2
    s_add_u32 s47, s47, 1
    s_cmp_ge_u32 s47, 262144
    s_cbranch_scc1 RP_U2
    s_sleep 4
    s_mov_b32 s57, 10485760
    buffer_load_dwordx4 v[72:75], v4, s[32:35], s57 offen sc1
    buffer_load_dwordx4 v[76:79], v4, s[32:35], s57 offen offset:512 sc1
    buffer_load_dword v80, v5, s[32:35], s57 offen offset:1024 sc1
    s_waitcnt vmcnt(0)
    s_branch RP_U3
RP_U2:
    v_fma_mix_f32 v84, v72, v84, 0 op_sel:[0,0,0] op_sel_hi:[1,0,0]
    v_fma_mix_f32 v85, v72, v85, 0 op_sel:[1,0,0] op_sel_hi:[1,0,0]
    v_fma_mix_f32 v86, v73, v86, 0 op_sel:[0,0,0] op_sel_hi:[1,0,0]
    v_add_f32_dpp v204, v204, v204 row_ror:8 row_mask:0xf bank_mask:0xf
    v_fma_mix_f32 v87, v73, v87, 0 op_sel:[1,0,0] op_sel_hi:[1,0,0]
    v_fma_mix_f32 v88, v74, v88, 0 op_sel:[0,0,0] op_sel_hi:[1,0,0]
    v_fma_mix_f32 v89, v74, v89, 0 op_sel:[1,0,0] op_sel_hi:[1,0,0]
    v_fma_mix_f32 v90, v75, v90, 0 op_sel:[0,0,0] op_sel_hi:[1,0,0]
    v_fma_mix_f32 v91, v75, v91, 0 op_sel:[1,0,0] op_sel_hi:[1,0,0]
    v_add_f32_dpp v204, v204, v204 row_ror:4 row_mask:0xf bank_mask:0xf
    v_fma_mix_f32 v92, v76, v92, 0 op_sel:[0,0,0] op_sel_hi:[1,0,0]
    v_fma_mix_f32 v93, v76, v93, 0 op_sel:[1,0,0] op_sel_hi:[1,0,0]
    v_fma_mix_f32 v94, v77, v94, 0 op_sel:[0,0,0] op_sel_hi:[1,0,0]
    v_fma_mix_f32 v95, v77, v95, 0 op_sel:[1,0,0] op_sel_hi:[1,0,0]
    v_fma_mix_f32 v96, v78, v96, 0 op_sel:[0,0,0] op_sel_hi:[1,0,0]
    v_add_f32_dpp v204, v204, v204 row_ror:2 row_mask:0xf bank_mask:0xf
    v_fma_mix_f32 v97, v78, v97, 0 op_sel:[1,0,0] op_sel_hi:[1,0,0]
    v_fma_mix_f32 v98, v79, v98, 0 op_sel:[0,0,0] op_sel_hi:[1,0,0]
    v_fma_mix_f32 v99, v79, v99, 0 op_sel:[1,0,0] op_sel_hi:[1,0,0]
    v_fma_mix_f32 v100, v80, v100, 0 op_sel:[0,0,0] op_sel_hi:[1,0,0]
    v_fma_mix_f32 v101, v80, v101, 0 op_sel:[1,0,0] op_sel_hi:[1,0,0]
    v_add_f32_dpp v204, v204, v204 row_ror:1 row_mask:0xf bank_mask:0xf
    v_cvt_pk_bf16_f32 v84, 0, v84
    v_cvt_pk_bf16_f32 v85, 0, v85
    v_cvt_pk_bf16_f32 v86, 0, v86
    v_cvt_pk_bf16_f32 v87, 0, v87
    v_cvt_pk_bf16_f32 v88, 0, v88
    v_mov_b32 v37, v204
    v_cvt_pk_bf16_f32 v89, 0, v89
    v_cvt_pk_bf16_f32 v90, 0, v90
    v_cvt_pk_bf16_f32 v91, 0, v91
    v_cvt_pk_bf16_f32 v92, 0, v92
    v_cvt_pk_bf16_f32 v93, 0, v93
    v_permlane16_swap_b32 v204, v37
    v_cvt_pk_bf16_f32 v94, 0, v94
    v_cvt_pk_bf16_f32 v95, 0, v95
    v_cvt_pk_bf16_f32 v96, 0, v96
    v_cvt_pk_bf16_f32 v97, 0, v97
    v_cvt_pk_bf16_f32 v98, 0, v98
    v_add_f32 v204, v204, v37
    v_cvt_pk_bf16_f32 v99, 0, v99
    v_cvt_pk_bf16_f32 v100, 0, v100
    v_cvt_pk_bf16_f32 v101, 0, v101
    v_dot2_f32_bf16 v102, v16, v6, v84
    v_dot2_f32_bf16 v103, v16, v7, v85
    v_dot2_f32_bf16 v104, v17, v6, v86
    v_dot2_f32_bf16 v105, v17, v7, v87
    v_dot2_f32_bf16 v106, v18, v6, v88
    v_dot2_f32_bf16 v107, v18, v7, v89
    v_dot2_f32_bf16 v108, v19, v6, v90
    v_dot2_f32_bf16 v109, v19, v7, v91
    v_dot2_f32_bf16 v110, v20, v6, v92
    v_dot2_f32_bf16 v111, v20, v7, v93
    v_dot2_f32_bf16 v112, v21, v6, v94
    v_dot2_f32_bf16 v113, v21, v7, v95
    v_dot2_f32_bf16 v114, v22, v6, v96
    v_dot2_f32_bf16 v115, v22, v7, v97
    v_dot2_f32_bf16 v116, v23, v6, v98
    v_dot2_f32_bf16 v117, v23, v7, v99
    v_dot2_f32_bf16 v118, v24, v6, v100
    v_dot2_f32_bf16 v119, v24, v7, v101
    s_cmp_lt_u32 s2, 144
    s_cbranch_scc1 RP_1
    s_and_b32 s46, s2, 7
    s_sub_u32 s48, s2, 216
    s_lshr_b32 s48, s48, 3
    v_lshrrev_b32 v37, 3, v0
    v_mul_u32_u24 v37, 9216, v37
    v_and_b32 v36, 7, v0
    v_lshl_add_u32 v37, v36, 4, v37
    s_cmp_ge_u32 s46, 4
    s_cselect_b32 s50, 1, 0
    s_add_u32 s50, s50, s46
    s_lshl_b32 s50, s50, 10
    s_add_u32 s50, s50, 384
    s_lshr_b32 s53, s48, 1
    s_sub_u32 s53, 8, s53
    s_mul_i32 s53, s53, 589824
    s_add_u32 s50, s50, s53
    v_add_u32 v36, s50, v37
    s_bitcmp1_b32 s48, 0
    s_cselect_b32 s56, s24, s22
    s_cselect_b32 s57, s25, s23
    global_load_dwordx4 v[140:143], v36, s[56:57] nt
    s_cmp_lg_u32 s46, 3
    s_cbranch_scc1 PF_0
    global_load_dwordx4 v[144:147], v36, s[56:57] offset:1024 nt
PF_0:
    v_subrev_u32 v36, 1179648, v36
    global_load_dwordx4 v[140:143], v36, s[56:57] nt
    s_cmp_lg_u32 s46, 3
    s_cbranch_scc1 PF_1
    global_load_dwordx4 v[144:147], v36, s[56:57] offset:1024 nt
PF_1:
    v_subrev_u32 v36, 1179648, v36
    global_load_dwordx4 v[140:143], v36, s[56:57] nt
    s_cmp_lg_u32 s46, 3
    s_cbranch_scc1 PF_2
    global_load_dwordx4 v[144:147], v36, s[56:57] offset:1024 nt
PF_2:
    v_subrev_u32 v36, 1179648, v36
    s_waitcnt vmcnt(0)
    s_cmp_ge_u32 s3, 4
    s_cbranch_scc1 RP_S
    s_lshl_b32 s57, s51, 6
    v_add_u32 v14, s57, v1
    v_min_u32 v14, 143, v14
    v_lshlrev_b32 v27, 7, v14
    v_lshlrev_b32 v14, 4, v14
    s_mov_b32 s53, 32768
    buffer_load_dwordx4 v[32:35], v27, s[32:35], s53 offen sc1
    s_and_b32 s56, s40, 0x7fffff
    s_mov_b32 s47, 0
    s_waitcnt vmcnt(0)
SCP11:
    v_xor_b32 v32, s56, v32
    v_xor_b32 v33, s56, v33
    v_xor_b32 v34, s56, v34
    v_xor_b32 v35, s56, v35
    v_or3_b32 v255, v32, v33, v34
    v_or_b32 v255, v255, v35
    v_and_b32 v255, 0x7fffff, v255
    v_cmp_ne_u32 vcc, 0, v255
    s_cbranch_vccz SCD12
    s_add_u32 s47, s47, 1
    s_cmp_ge_u32 s47, 262144
    s_cbranch_scc1 SCD12
    s_sleep 8
    buffer_load_dwordx4 v[32:35], v27, s[32:35], s53 offen sc1
    s_waitcnt vmcnt(0)
    s_branch SCP11
SCD12:
    ds_write_b128 v14, v[32:35] offset:46080
RP_S:
    s_waitcnt lgkmcnt(0)
    s_barrier
RP_1:
    s_cmp_lt_u32 s49, 64
    s_cbranch_scc1 RP_2
    buffer_load_dwordx4 v[140:143], v3, s[32:35], s60 offen sc1
    buffer_load_dwordx4 v[144:147], v3, s[32:35], s61 offen sc1
    s_cmp_ge_u32 s3, 2
    s_cbranch_scc1 YL13
    buffer_load_dwordx4 v[148:151], v3, s[32:35], s62 offen sc1
YL13:
RP_2:
    ds_read_b128 v[52:55], v38 offset:46080
    ds_read_b128 v[56:59], v38 offset:46096
    ds_read_b128 v[60:63], v38 offset:47104
    ds_read_b128 v[64:67], v38 offset:47120
    ds_read_b64 v[68:69], v39 offset:48128
    v_and_b32 v36, 7, v0
    v_mul_u32_u24 v36, 2320, v36
    v_lshrrev_b32 v37, 3, v0
    v_lshl_add_u32 v36, v37, 4, v36
    v_lshrrev_b32 v37, 5, v1
    s_mul_i32 s46, s3, 2320
    s_add_u32 s46, s46, 49152
    v_lshl_add_u32 v37, v37, 3, s46
    v_lshl_add_u32 v38, v12, 1, v37
    v_bfe_u32 v39, v1, 1, 4
    v_lshl_add_u32 v39, v39, 4, v37
    v_and_b32 v37, 1, v1
    v_lshl_add_u32 v39, v37, 2, v39
    v_lshrrev_b32 v35, 5, v1
    v_lshlrev_b32 v35, 4, v35
    s_and_b32 s52, s3, 4
    s_add_u32 s52, s52, s3
    s_lshl_b32 s46, s52, 2
    s_add_u32 s46, s46, 163456
    v_add_u32 v35, s46, v35
    v_and_b32 v40, 15, v1
    v_lshlrev_b32 v34, 2, v40
    v_add_u32 v34, 163456, v34
    v_and_b32 v42, 48, v2
    v_add_u32 v41, 163456, v42
    v_lshrrev_b32 v43, 2, v1
    v_lshl_add_u32 v42, v43, 14, v42
    s_and_b32 s63, s40, 0xffff
    s_or_b32 s53, s63, 0x80000000
    s_lshl_b32 s54, s49, 6
    s_add_u32 s54, s54, 9437184
    s_mov_b32 s58, 1
    s_mov_b32 s59, 1
    s_lshl_b32 s46, s49, 4
    s_sub_u32 s46, 0xffff, s46
    v_sub_u32 v44, s46, v40
    v_mov_b32 v45, 0xffff0000
    v_lshrrev_b32 v46, 5, v1
    v_mul_u32_u24 v46, 6144, v46
    s_mul_i32 s46, s52, 1536
    v_add3_u32 v46, v46, v12, s46
    v_lshrrev_b32 v47, 2, v0
    v_and_b32 v48, 3, v0
    v_lshlrev_b32 v48, 4, v48
    v_lshl_add_u32 v47, v47, 6, v48
    v_mov_b32 v183, s40
    v_mov_b32 v187, s40
    v_mov_b32 v191, s40
    v_lshlrev_b32 v49, 2, v0
    v_sub_u32 v232, 0xffff, v49
    v_subrev_u32 v233, 1, v232
    v_subrev_u32 v234, 2, v232
    v_subrev_u32 v235, 3, v232
    v_mov_b32 v48, s63
    v_mov_b32 v49, 163520
    v_mov_b32 v50, -1
    s_lshl_b32 s46, s49, 4
    s_add_u32 s46, s46, s52
    s_sub_u32 s46, 0xffff, s46
    v_lshrrev_b32 v51, 5, v1
    v_lshlrev_b32 v51, 2, v51
    v_sub_u32 v51, s46, v51
    s_cmp_ge_u32 s3, 2
    s_cbranch_scc1 RP_3
    s_mov_b32 s47, 0
PL14:
    s_waitcnt vmcnt(0)
    v_xor_b32 v140, v10, v140
    v_xor_b32 v141, v10, v141
    v_xor_b32 v142, v10, v142
    v_xor_b32 v143, v10, v143
    v_xor_b32 v144, v10, v144
    v_xor_b32 v145, v10, v145
    v_xor_b32 v146, v10, v146
    v_xor_b32 v147, v10, v147
    v_xor_b32 v148, v10, v148
    v_xor_b32 v149, v10, v149
    v_xor_b32 v150, v10, v150
    v_xor_b32 v151, v10, v151
    v_or3_b32 v37, v140, v141, v142
    v_or3_b32 v37, v37, v143, v144
    v_or3_b32 v37, v37, v145, v146
    v_or3_b32 v37, v37, v147, v148
    v_or3_b32 v37, v37, v149, v150
    v_or_b32 v37, v37, v151
    v_and_b32 v37, 0x70007, v37
    v_cmp_ne_u32 vcc, 0, v37
    s_cbranch_vccz PD15
    s_add_u32 s47, s47, 1
    s_cmp_ge_u32 s47, 262144
    s_cbranch_scc1 PD15
    s_sleep 1
    buffer_load_dwordx4 v[140:143], v3, s[32:35], s60 offen sc1
    buffer_load_dwordx4 v[144:147], v3, s[32:35], s61 offen sc1
    buffer_load_dwordx4 v[148:151], v3, s[32:35], s62 offen sc1
    s_branch PL14
PD15:
    ds_write_b128 v36, v[148:151] offset:51200
    s_branch RP_4
RP_3:
    s_mov_b32 s47, 0
PL16:
    s_waitcnt vmcnt(0)
    v_xor_b32 v140, v10, v140
    v_xor_b32 v141, v10, v141
    v_xor_b32 v142, v10, v142
    v_xor_b32 v143, v10, v143
    v_xor_b32 v144, v10, v144
    v_xor_b32 v145, v10, v145
    v_xor_b32 v146, v10, v146
    v_xor_b32 v147, v10, v147
    v_or3_b32 v37, v140, v141, v142
    v_or3_b32 v37, v37, v143, v144
    v_or3_b32 v37, v37, v145, v146
    v_or_b32 v37, v37, v147
    v_and_b32 v37, 0x70007, v37
    v_cmp_ne_u32 vcc, 0, v37
    s_cbranch_vccz PD17
    s_add_u32 s47, s47, 1
    s_cmp_ge_u32 s47, 262144
    s_cbranch_scc1 PD17
    s_sleep 1
    buffer_load_dwordx4 v[140:143], v3, s[32:35], s60 offen sc1
    buffer_load_dwordx4 v[144:147], v3, s[32:35], s61 offen sc1
    s_branch PL16
PD17:
RP_4:
    ds_write_b128 v36, v[140:143] offset:49152
    ds_write_b128 v36, v[144:147] offset:50176
    s_waitcnt lgkmcnt(0)
    s_barrier
    ds_read2_b64 v[152:155], v38 offset0:0 offset1:2
    ds_read2_b64 v[156:159], v38 offset0:128 offset1:130
    ds_read_b32 v160, v39 offset:2048
    s_getreg_b32 s60, hwreg(HW_REG_XCC_ID, 0, 3)
    s_mul_i32 s60, s60, 16384
    s_add_u32 s60, s60, 9437184
    s_mul_i32 s61, s49, 24576
    s_add_u32 s61, s61, 13631488
    s_waitcnt lgkmcnt(2)
    v_fma_mix_f32 v162, v152, v52, v102 op_sel:[0,0,0] op_sel_hi:[1,0,0]
    v_fma_mix_f32 v163, v152, v53, v103 op_sel:[1,0,0] op_sel_hi:[1,0,0]
    v_fma_mix_f32 v164, v153, v54, v104 op_sel:[0,0,0] op_sel_hi:[1,0,0]
    v_fma_mix_f32 v165, v153, v55, v105 op_sel:[1,0,0] op_sel_hi:[1,0,0]
    v_pk_mul_f32 v[30:31], v[162:163], v[162:163]
    v_pk_mul_f32 v[32:33], v[162:163], v[120:121]
    v_fma_mix_f32 v166, v154, v56, v106 op_sel:[0,0,0] op_sel_hi:[1,0,0]
    v_fma_mix_f32 v167, v154, v57, v107 op_sel:[1,0,0] op_sel_hi:[1,0,0]
    v_pk_add_f32 v[28:29], v[162:163], v[164:165]
    v_pk_fma_f32 v[30:31], v[164:165], v[164:165], v[30:31]
    v_pk_fma_f32 v[32:33], v[164:165], v[122:123], v[32:33]
    v_fma_mix_f32 v168, v155, v58, v108 op_sel:[0,0,0] op_sel_hi:[1,0,0]
    v_fma_mix_f32 v169, v155, v59, v109 op_sel:[1,0,0] op_sel_hi:[1,0,0]
    v_pk_add_f32 v[28:29], v[28:29], v[166:167]
    v_pk_fma_f32 v[30:31], v[166:167], v[166:167], v[30:31]
    v_pk_fma_f32 v[32:33], v[166:167], v[124:125], v[32:33]
    s_waitcnt lgkmcnt(1)
    v_fma_mix_f32 v170, v156, v60, v110 op_sel:[0,0,0] op_sel_hi:[1,0,0]
    v_fma_mix_f32 v171, v156, v61, v111 op_sel:[1,0,0] op_sel_hi:[1,0,0]
    v_pk_add_f32 v[28:29], v[28:29], v[168:169]
    v_pk_fma_f32 v[30:31], v[168:169], v[168:169], v[30:31]
    v_pk_fma_f32 v[32:33], v[168:169], v[126:127], v[32:33]
    v_fma_mix_f32 v172, v157, v62, v112 op_sel:[0,0,0] op_sel_hi:[1,0,0]
    v_fma_mix_f32 v173, v157, v63, v113 op_sel:[1,0,0] op_sel_hi:[1,0,0]
    v_pk_add_f32 v[28:29], v[28:29], v[170:171]
    v_pk_fma_f32 v[30:31], v[170:171], v[170:171], v[30:31]
    v_pk_fma_f32 v[32:33], v[170:171], v[128:129], v[32:33]
    v_fma_mix_f32 v174, v158, v64, v114 op_sel:[0,0,0] op_sel_hi:[1,0,0]
    v_fma_mix_f32 v175, v158, v65, v115 op_sel:[1,0,0] op_sel_hi:[1,0,0]
    v_pk_add_f32 v[28:29], v[28:29], v[172:173]
    v_pk_fma_f32 v[30:31], v[172:173], v[172:173], v[30:31]
    v_pk_fma_f32 v[32:33], v[172:173], v[130:131], v[32:33]
    v_fma_mix_f32 v176, v159, v66, v116 op_sel:[0,0,0] op_sel_hi:[1,0,0]
    v_fma_mix_f32 v177, v159, v67, v117 op_sel:[1,0,0] op_sel_hi:[1,0,0]
    v_pk_add_f32 v[28:29], v[28:29], v[174:175]
    v_pk_fma_f32 v[30:31], v[174:175], v[174:175], v[30:31]
    v_pk_fma_f32 v[32:33], v[174:175], v[132:133], v[32:33]
    s_waitcnt lgkmcnt(0)
    v_fma_mix_f32 v178, v160, v68, v118 op_sel:[0,0,0] op_sel_hi:[1,0,0]
    v_fma_mix_f32 v179, v160, v69, v119 op_sel:[1,0,0] op_sel_hi:[1,0,0]
    v_pk_add_f32 v[28:29], v[28:29], v[176:177]
    v_pk_fma_f32 v[30:31], v[176:177], v[176:177], v[30:31]
    v_pk_fma_f32 v[32:33], v[176:177], v[134:135], v[32:33]
    v_pk_add_f32 v[28:29], v[28:29], v[178:179]
    v_pk_fma_f32 v[30:31], v[178:179], v[178:179], v[30:31]
    v_pk_fma_f32 v[32:33], v[178:179], v[136:137], v[32:33]
    v_add_f32 v28, v28, v29
    v_add_f32 v30, v30, v31
    v_add_f32 v32, v32, v33
    s_nop 0
    v_permlane16_swap_b32 v28, v30
    v_add_f32 v28, v28, v30
    v_add_f32_dpp v32, v32, v32 row_ror:8 row_mask:0xf bank_mask:0xf
    s_nop 0
    v_add_f32_dpp v28, v28, v28 row_ror:8 row_mask:0xf bank_mask:0xf
    v_add_f32_dpp v32, v32, v32 row_ror:4 row_mask:0xf bank_mask:0xf
    s_nop 0
    v_add_f32_dpp v28, v28, v28 row_ror:4 row_mask:0xf bank_mask:0xf
    v_add_f32_dpp v32, v32, v32 row_ror:2 row_mask:0xf bank_mask:0xf
    s_nop 0
    v_add_f32_dpp v28, v28, v28 row_ror:2 row_mask:0xf bank_mask:0xf
    v_add_f32_dpp v32, v32, v32 row_ror:1 row_mask:0xf bank_mask:0xf
    s_nop 0
    v_add_f32_dpp v28, v28, v28 row_ror:1 row_mask:0xf bank_mask:0xf
    v_mov_b32 v33, v32
    v_mov_b32 v30, v28
    s_nop 1
    v_permlane16_swap_b32 v28, v30
    v_permlane16_swap_b32 v32, v33
    v_add_f32 v32, v32, v33
    v_mul_f32 v28, 0x3ae38e39, v28
    v_mul_f32 v30, 0x3ae38e39, v30
    v_fma_f32 v30, -v28, v28, v30
    v_cvt_pk_bf16_f32 v200, 0, v28
    v_max_f32 v30, 0, v30
    v_cvt_pk_bf16_f32 v30, 0, v30
    v_add_f32 v30, 0x3727c5ac, v30
    v_cvt_pk_bf16_f32 v30, 0, v30
    v_sqrt_f32 v30, v30
    s_nop 0
    v_cvt_pk_bf16_f32 v30, 0, v30
    v_rcp_f32 v202, v30
    v_fma_f32 v32, -v200, v204, v32
    v_mul_f32 v32, v32, v202
    v_cvt_pk_bf16_f32 v236, 0, v32
    v_ashrrev_i32 v28, 31, v236
    v_and_b32 v28, 0x7fff0000, v28
    v_xor_b32 v28, v28, v236
    v_xor_b32 v43, s53, v28
    s_mov_b64 exec, s[58:59]
    ds_write_b32 v35, v43
    s_mov_b64 exec, -1
    s_waitcnt lgkmcnt(0)
    s_barrier
    s_cmp_lg_u32 s3, 0
    s_cbranch_scc1 L2_NOKEY
    s_mov_b32 exec_hi, 0
    ds_read_b128 v[28:31], v41
    s_waitcnt lgkmcnt(0)
    buffer_store_dwordx4 v[28:31], v42, s[32:35], s54 offen sc1
    s_mov_b64 exec, -1
L2_NOKEY:
    ds_read_b32 v205, v34
    v_fma_mix_f32 v162, v152, v52, v84 op_sel:[0,0,0] op_sel_hi:[1,0,0]
    v_fma_mix_f32 v163, v152, v53, v85 op_sel:[1,0,0] op_sel_hi:[1,0,0]
    v_fma_mix_f32 v164, v153, v54, v86 op_sel:[0,0,0] op_sel_hi:[1,0,0]
    v_fma_mix_f32 v165, v153, v55, v87 op_sel:[1,0,0] op_sel_hi:[1,0,0]
    v_fma_mix_f32 v166, v154, v56, v88 op_sel:[0,0,0] op_sel_hi:[1,0,0]
    v_fma_mix_f32 v167, v154, v57, v89 op_sel:[1,0,0] op_sel_hi:[1,0,0]
    v_fma_mix_f32 v168, v155, v58, v90 op_sel:[0,0,0] op_sel_hi:[1,0,0]
    v_fma_mix_f32 v169, v155, v59, v91 op_sel:[1,0,0] op_sel_hi:[1,0,0]
    v_fma_mix_f32 v170, v156, v60, v92 op_sel:[0,0,0] op_sel_hi:[1,0,0]
    v_fma_mix_f32 v171, v156, v61, v93 op_sel:[1,0,0] op_sel_hi:[1,0,0]
    v_and_or_b32 v43, v43, v45, v51
    s_waitcnt lgkmcnt(0)
    v_and_or_b32 v205, v205, v45, v44
    v_cmp_gt_u32 vcc, v205, v43
    s_and_b32 s46, vcc_lo, 0xffff
    s_and_b32 s48, vcc_hi, 0xffff
    s_bcnt1_i32_b32 s46, s46
    s_bcnt1_i32_b32 s48, s48
    s_cmp_lt_u32 s46, 2
    s_cselect_b32 s36, -1, 0
    s_cmp_lt_u32 s48, 2
    s_cselect_b32 s37, -1, 0
    s_cmp_eq_u64 s[36:37], 0
    s_cbranch_scc1 L2_NP
    s_setprio 1
L2_NP:
    v_fma_mix_f32 v172, v157, v62, v94 op_sel:[0,0,0] op_sel_hi:[1,0,0]
    v_fma_mix_f32 v173, v157, v63, v95 op_sel:[1,0,0] op_sel_hi:[1,0,0]
    v_fma_mix_f32 v174, v158, v64, v96 op_sel:[0,0,0] op_sel_hi:[1,0,0]
    v_fma_mix_f32 v175, v158, v65, v97 op_sel:[1,0,0] op_sel_hi:[1,0,0]
    v_fma_mix_f32 v176, v159, v66, v98 op_sel:[0,0,0] op_sel_hi:[1,0,0]
    v_fma_mix_f32 v177, v159, v67, v99 op_sel:[1,0,0] op_sel_hi:[1,0,0]
    v_fma_mix_f32 v178, v160, v68, v100 op_sel:[0,0,0] op_sel_hi:[1,0,0]
    v_fma_mix_f32 v179, v160, v69, v101 op_sel:[1,0,0] op_sel_hi:[1,0,0]
    v_cvt_pk_bf16_f32 v162, 0, v162
    v_cvt_pk_bf16_f32 v163, 0, v163
    v_cvt_pk_bf16_f32 v164, 0, v164
    v_cvt_pk_bf16_f32 v165, 0, v165
    v_cvt_pk_bf16_f32 v166, 0, v166
    v_cvt_pk_bf16_f32 v167, 0, v167
    v_cvt_pk_bf16_f32 v168, 0, v168
    v_cvt_pk_bf16_f32 v169, 0, v169
    v_cvt_pk_bf16_f32 v170, 0, v170
    v_cvt_pk_bf16_f32 v171, 0, v171
    v_cvt_pk_bf16_f32 v172, 0, v172
    v_cvt_pk_bf16_f32 v173, 0, v173
    v_cvt_pk_bf16_f32 v174, 0, v174
    v_cvt_pk_bf16_f32 v175, 0, v175
    v_cvt_pk_bf16_f32 v176, 0, v176
    v_cvt_pk_bf16_f32 v177, 0, v177
    v_cvt_pk_bf16_f32 v178, 0, v178
    v_cvt_pk_bf16_f32 v179, 0, v179
    v_dot2_f32_bf16 v162, v16, v6, v162
    v_dot2_f32_bf16 v163, v16, v7, v163
    v_dot2_f32_bf16 v164, v17, v6, v164
    v_dot2_f32_bf16 v165, v17, v7, v165
    v_dot2_f32_bf16 v166, v18, v6, v166
    v_dot2_f32_bf16 v167, v18, v7, v167
    v_dot2_f32_bf16 v168, v19, v6, v168
    v_dot2_f32_bf16 v169, v19, v7, v169
    v_dot2_f32_bf16 v170, v20, v6, v170
    v_dot2_f32_bf16 v171, v20, v7, v171
    v_dot2_f32_bf16 v172, v21, v6, v172
    v_dot2_f32_bf16 v173, v21, v7, v173
    v_dot2_f32_bf16 v174, v22, v6, v174
    v_dot2_f32_bf16 v175, v22, v7, v175
    v_dot2_f32_bf16 v176, v23, v6, v176
    v_dot2_f32_bf16 v177, v23, v7, v177
    v_dot2_f32_bf16 v178, v24, v6, v178
    v_dot2_f32_bf16 v179, v24, v7, v179
    v_cvt_pk_bf16_f32 v162, 0, v162
    v_cvt_pk_bf16_f32 v163, 0, v163
    v_cvt_pk_bf16_f32 v164, 0, v164
    v_cvt_pk_bf16_f32 v165, 0, v165
    v_cvt_pk_bf16_f32 v166, 0, v166
    v_cvt_pk_bf16_f32 v167, 0, v167
    v_cvt_pk_bf16_f32 v168, 0, v168
    v_cvt_pk_bf16_f32 v169, 0, v169
    v_cvt_pk_bf16_f32 v170, 0, v170
    v_cvt_pk_bf16_f32 v171, 0, v171
    v_cvt_pk_bf16_f32 v172, 0, v172
    v_cvt_pk_bf16_f32 v173, 0, v173
    v_cvt_pk_bf16_f32 v174, 0, v174
    v_cvt_pk_bf16_f32 v175, 0, v175
    v_cvt_pk_bf16_f32 v176, 0, v176
    v_cvt_pk_bf16_f32 v177, 0, v177
    v_cvt_pk_bf16_f32 v178, 0, v178
    v_cvt_pk_bf16_f32 v179, 0, v179
    v_pk_add_f32 v[102:103], v[162:163], v[200:201] op_sel_hi:[1,0] neg_lo:[0,1] neg_hi:[0,1]
    v_pk_add_f32 v[104:105], v[164:165], v[200:201] op_sel_hi:[1,0] neg_lo:[0,1] neg_hi:[0,1]
    v_pk_add_f32 v[106:107], v[166:167], v[200:201] op_sel_hi:[1,0] neg_lo:[0,1] neg_hi:[0,1]
    v_pk_add_f32 v[108:109], v[168:169], v[200:201] op_sel_hi:[1,0] neg_lo:[0,1] neg_hi:[0,1]
    v_pk_add_f32 v[110:111], v[170:171], v[200:201] op_sel_hi:[1,0] neg_lo:[0,1] neg_hi:[0,1]
    v_pk_add_f32 v[112:113], v[172:173], v[200:201] op_sel_hi:[1,0] neg_lo:[0,1] neg_hi:[0,1]
    v_pk_add_f32 v[114:115], v[174:175], v[200:201] op_sel_hi:[1,0] neg_lo:[0,1] neg_hi:[0,1]
    v_pk_add_f32 v[116:117], v[176:177], v[200:201] op_sel_hi:[1,0] neg_lo:[0,1] neg_hi:[0,1]
    v_pk_add_f32 v[118:119], v[178:179], v[200:201] op_sel_hi:[1,0] neg_lo:[0,1] neg_hi:[0,1]
    v_cvt_pk_bf16_f32 v102, 0, v102
    v_cvt_pk_bf16_f32 v103, 0, v103
    v_cvt_pk_bf16_f32 v104, 0, v104
    v_cvt_pk_bf16_f32 v105, 0, v105
    v_cvt_pk_bf16_f32 v106, 0, v106
    v_cvt_pk_bf16_f32 v107, 0, v107
    v_cvt_pk_bf16_f32 v108, 0, v108
    v_cvt_pk_bf16_f32 v109, 0, v109
    v_cvt_pk_bf16_f32 v110, 0, v110
    v_cvt_pk_bf16_f32 v111, 0, v111
    v_cvt_pk_bf16_f32 v112, 0, v112
    v_cvt_pk_bf16_f32 v113, 0, v113
    v_cvt_pk_bf16_f32 v114, 0, v114
    v_cvt_pk_bf16_f32 v115, 0, v115
    v_cvt_pk_bf16_f32 v116, 0, v116
    v_cvt_pk_bf16_f32 v117, 0, v117
    v_cvt_pk_bf16_f32 v118, 0, v118
    v_cvt_pk_bf16_f32 v119, 0, v119
    v_pk_mul_f32 v[102:103], v[102:103], v[202:203] op_sel_hi:[1,0]
    v_pk_mul_f32 v[104:105], v[104:105], v[202:203] op_sel_hi:[1,0]
    v_pk_mul_f32 v[106:107], v[106:107], v[202:203] op_sel_hi:[1,0]
    v_pk_mul_f32 v[108:109], v[108:109], v[202:203] op_sel_hi:[1,0]
    v_pk_mul_f32 v[110:111], v[110:111], v[202:203] op_sel_hi:[1,0]
    v_pk_mul_f32 v[112:113], v[112:113], v[202:203] op_sel_hi:[1,0]
    v_pk_mul_f32 v[114:115], v[114:115], v[202:203] op_sel_hi:[1,0]
    v_pk_mul_f32 v[116:117], v[116:117], v[202:203] op_sel_hi:[1,0]
    v_pk_mul_f32 v[118:119], v[118:119], v[202:203] op_sel_hi:[1,0]
    v_cvt_pk_bf16_f32 v180, v102, v103
    v_cvt_pk_bf16_f32 v181, v104, v105
    v_cvt_pk_bf16_f32 v182, v106, v107
    v_cvt_pk_bf16_f32 v184, v108, v109
    v_cvt_pk_bf16_f32 v185, v110, v111
    v_cvt_pk_bf16_f32 v186, v112, v113
    v_cvt_pk_bf16_f32 v188, v114, v115
    v_cvt_pk_bf16_f32 v189, v116, v117
    v_cvt_pk_bf16_f32 v190, v118, v119
    s_and_b64 exec, s[36:37], -1
    s_cbranch_execz L2_NS
    buffer_store_dwordx4 v[180:183], v46, s[32:35], s61 offen offset:0 sc1
    buffer_store_dwordx4 v[184:187], v46, s[32:35], s61 offen offset:512 sc1
    buffer_store_dwordx4 v[188:191], v46, s[32:35], s61 offen offset:1024 sc1
L2_NS:
    s_mov_b64 exec, -1
    s_setprio 0
    v_dot2_f32_bf16 v102, v180, v6, v162
    v_dot2_f32_bf16 v103, v180, v7, v163
    v_dot2_f32_bf16 v104, v181, v6, v164
    v_dot2_f32_bf16 v105, v181, v7, v165
    v_dot2_f32_bf16 v106, v182, v6, v166
    v_dot2_f32_bf16 v107, v182, v7, v167
    v_dot2_f32_bf16 v108, v184, v6, v168
    v_dot2_f32_bf16 v109, v184, v7, v169
    v_dot2_f32_bf16 v110, v185, v6, v170
    v_dot2_f32_bf16 v111, v185, v7, v171
    v_dot2_f32_bf16 v112, v186, v6, v172
    v_dot2_f32_bf16 v113, v186, v7, v173
    v_dot2_f32_bf16 v114, v188, v6, v174
    v_dot2_f32_bf16 v115, v188, v7, v175
    v_dot2_f32_bf16 v116, v189, v6, v176
    v_dot2_f32_bf16 v117, v189, v7, v177
    v_dot2_f32_bf16 v118, v190, v6, v178
    v_dot2_f32_bf16 v119, v190, v7, v179
    v_cvt_pk_bf16_f32 v16, v102, v103
    v_cvt_pk_bf16_f32 v17, v104, v105
    v_cvt_pk_bf16_f32 v18, v106, v107
    v_cvt_pk_bf16_f32 v19, v108, v109
    v_cvt_pk_bf16_f32 v20, v110, v111
    v_cvt_pk_bf16_f32 v21, v112, v113
    v_cvt_pk_bf16_f32 v22, v114, v115
    v_cvt_pk_bf16_f32 v23, v116, v117
    v_cvt_pk_bf16_f32 v24, v118, v119
    buffer_load_dwordx4 v[228:231], v47, s[32:35], s60 offen sc1
    v_mov_b32 v206, v205
    s_nop 1
    v_max_u32_dpp v206, v206, v206 row_ror:8 row_mask:0xf bank_mask:0xf
    s_nop 1
    v_max_u32_dpp v206, v206, v206 row_ror:4 row_mask:0xf bank_mask:0xf
    s_nop 1
    v_max_u32_dpp v206, v206, v206 row_ror:2 row_mask:0xf bank_mask:0xf
    s_nop 1
    v_max_u32_dpp v206, v206, v206 row_ror:1 row_mask:0xf bank_mask:0xf
    s_nop 0
    v_readfirstlane_b32 s56, v206
    v_cmp_ne_u32 vcc, v206, v205
    s_nop 1
    v_cndmask_b32 v205, 0, v205, vcc
    v_mov_b32 v206, v205
    s_nop 1
    v_max_u32_dpp v206, v206, v206 row_ror:8 row_mask:0xf bank_mask:0xf
    s_nop 1
    v_max_u32_dpp v206, v206, v206 row_ror:4 row_mask:0xf bank_mask:0xf
    s_nop 1
    v_max_u32_dpp v206, v206, v206 row_ror:2 row_mask:0xf bank_mask:0xf
    s_nop 1
    v_max_u32_dpp v206, v206, v206 row_ror:1 row_mask:0xf bank_mask:0xf
    s_nop 0
    v_readfirstlane_b32 s57, v206
    v_cmp_ne_u32 vcc, v206, v205
    s_nop 1
    v_cndmask_b32 v205, 0, v205, vcc
    s_mov_b32 s47, 0
PL18:
    s_waitcnt vmcnt(0)
    v_xor_b32 v228, v48, v228
    v_xor_b32 v229, v48, v229
    v_xor_b32 v230, v48, v230
    v_xor_b32 v231, v48, v231
    v_or3_b32 v37, v228, v229, v230
    v_or_b32 v37, v37, v231
    v_and_b32 v37, 0xffff, v37
    v_cmp_ne_u32 vcc, 0, v37
    s_cbranch_vccz PD19
    s_add_u32 s47, s47, 1
    s_cmp_ge_u32 s47, 262144
    s_cbranch_scc1 PD19
    s_sleep 1
    buffer_load_dwordx4 v[228:231], v47, s[32:35], s60 offen sc1
    s_branch PL18
PD19:
    v_or_b32 v228, v228, v232
    v_or_b32 v229, v229, v233
    v_or_b32 v230, v230, v234
    v_or_b32 v231, v231, v235
RK_LOOP:
    v_cmp_lt_u32 s[4:5], s56, v228
    v_cmp_lt_u32 s[6:7], s56, v229
    v_cmp_lt_u32 s[8:9], s56, v230
    v_cmp_lt_u32 s[10:11], s56, v231
    v_cmp_lt_u32 s[12:13], s57, v228
    v_cmp_lt_u32 s[14:15], s57, v229
    v_cmp_lt_u32 s[16:17], s57, v230
    v_cmp_lt_u32 s[18:19], s57, v231
    s_bcnt1_i32_b64 s4, s[4:5]
    s_bcnt1_i32_b64 s6, s[6:7]
    s_bcnt1_i32_b64 s8, s[8:9]
    s_bcnt1_i32_b64 s10, s[10:11]
    s_add_u32 s4, s4, s6
    s_add_u32 s8, s8, s10
    s_add_u32 s46, s4, s8
    s_bcnt1_i32_b64 s12, s[12:13]
    s_bcnt1_i32_b64 s14, s[14:15]
    s_bcnt1_i32_b64 s16, s[16:17]
    s_bcnt1_i32_b64 s18, s[18:19]
    s_add_u32 s12, s12, s14
    s_add_u32 s16, s16, s18
    s_add_u32 s48, s12, s16
    s_pack_ll_b32_b16 s46, s46, s48
    v_mov_b32 v37, s46
    s_mov_b64 exec, 1
    ds_add_u32 v49, v37
    s_mov_b64 exec, -1
    s_waitcnt lgkmcnt(0)
    s_barrier
    ds_read_b32 v37, v49
    v_add_u32 v49, 4, v49
    s_waitcnt lgkmcnt(0)
    v_readfirstlane_b32 s53, v37
    s_and_b32 s54, s53, 0xffff
    s_cmp_ge_u32 s54, 8
    s_cbranch_scc1 RK_DONE
    s_andn2_b32 s46, 0xffff, s56
    s_and_b32 s48, s46, 11
    s_cmp_lg_u32 s48, s52
    s_cbranch_scc1 RK_N20
    s_bitcmp1_b32 s46, 2
    s_cselect_b32 exec_lo, 0, -1
    s_cselect_b32 exec_hi, -1, 0
    v_mov_b32 v50, s54
    s_mov_b64 exec, -1
RK_N20:
    s_lshr_b32 s54, s53, 16
    s_cmp_ge_u32 s54, 8
    s_cbranch_scc1 RK_DONE
    s_andn2_b32 s46, 0xffff, s57
    s_and_b32 s48, s46, 11
    s_cmp_lg_u32 s48, s52
    s_cbranch_scc1 RK_N21
    s_bitcmp1_b32 s46, 2
    s_cselect_b32 exec_lo, 0, -1
    s_cselect_b32 exec_hi, -1, 0
    v_mov_b32 v50, s54
    s_mov_b64 exec, -1
RK_N21:
    v_mov_b32 v206, v205
    s_nop 1
    v_max_u32_dpp v206, v206, v206 row_ror:8 row_mask:0xf bank_mask:0xf
    s_nop 1
    v_max_u32_dpp v206, v206, v206 row_ror:4 row_mask:0xf bank_mask:0xf
    s_nop 1
    v_max_u32_dpp v206, v206, v206 row_ror:2 row_mask:0xf bank_mask:0xf
    s_nop 1
    v_max_u32_dpp v206, v206, v206 row_ror:1 row_mask:0xf bank_mask:0xf
    s_nop 0
    v_readfirstlane_b32 s56, v206
    v_cmp_ne_u32 vcc, v206, v205
    s_nop 1
    v_cndmask_b32 v205, 0, v205, vcc
    v_mov_b32 v206, v205
    s_nop 1
    v_max_u32_dpp v206, v206, v206 row_ror:8 row_mask:0xf bank_mask:0xf
    s_nop 1
    v_max_u32_dpp v206, v206, v206 row_ror:4 row_mask:0xf bank_mask:0xf
    s_nop 1
    v_max_u32_dpp v206, v206, v206 row_ror:2 row_mask:0xf bank_mask:0xf
    s_nop 1
    v_max_u32_dpp v206, v206, v206 row_ror:1 row_mask:0xf bank_mask:0xf
    s_nop 0
    v_readfirstlane_b32 s57, v206
    v_cmp_ne_u32 vcc, v206, v205
    s_nop 1
    v_cndmask_b32 v205, 0, v205, vcc
    s_branch RK_LOOP
RK_DONE:
    v_cmp_gt_u32 vcc, 8, v50
    s_andn2_b64 s[58:59], -1, vcc
    s_andn2_b64 exec, vcc, s[36:37]
    s_cbranch_execz RK_NOLATE
    buffer_store_dwordx4 v[180:183], v46, s[32:35], s61 offen offset:0 sc1
    buffer_store_dwordx4 v[184:187], v46, s[32:35], s61 offen offset:512 sc1
    buffer_store_dwordx4 v[188:191], v46, s[32:35], s61 offen offset:1024 sc1
RK_NOLATE:
    s_and_b64 exec, vcc, -1
    s_cbranch_execz RK_NOSEL
    v_sub_u32 v51, 0xffff, v51
    v_mul_f32 v30, 0xbfb8aa3b, v236
    v_exp_f32 v30, v30
    v_mov_b32 v31, s40
    v_add_f32 v30, 1.0, v30
    v_rcp_f32 v30, v30
    v_mov_b32 v35, s40
    v_cvt_pk_bf16_f32 v30, 0, v30
    v_or_b32 v30, v51, v30
    v_mov_b32 v34, v30
    v_mul_u32_u24 v50, 4608, v50
    v_add_u32 v50, v50, v12
    s_mov_b32 s48, 131072
    s_mov_b32 s55, 131584
    v_or_b32_sdwa v28, v162, v180 dst_sel:DWORD dst_unused:UNUSED_PAD src0_sel:DWORD src1_sel:WORD_0
    v_or_b32_sdwa v29, v163, v180 dst_sel:DWORD dst_unused:UNUSED_PAD src0_sel:DWORD src1_sel:WORD_1
    buffer_store_dwordx4 v[28:31], v50, s[32:35], s48 offen offset:0 sc1
    v_or_b32_sdwa v32, v164, v181 dst_sel:DWORD dst_unused:UNUSED_PAD src0_sel:DWORD src1_sel:WORD_0
    v_or_b32_sdwa v33, v165, v181 dst_sel:DWORD dst_unused:UNUSED_PAD src0_sel:DWORD src1_sel:WORD_1
    buffer_store_dwordx4 v[32:35], v50, s[32:35], s55 offen offset:0 sc1
    v_or_b32_sdwa v28, v166, v182 dst_sel:DWORD dst_unused:UNUSED_PAD src0_sel:DWORD src1_sel:WORD_0
    v_or_b32_sdwa v29, v167, v182 dst_sel:DWORD dst_unused:UNUSED_PAD src0_sel:DWORD src1_sel:WORD_1
    buffer_store_dwordx4 v[28:31], v50, s[32:35], s55 offen offset:512 sc1
    v_or_b32_sdwa v32, v168, v184 dst_sel:DWORD dst_unused:UNUSED_PAD src0_sel:DWORD src1_sel:WORD_0
    v_or_b32_sdwa v33, v169, v184 dst_sel:DWORD dst_unused:UNUSED_PAD src0_sel:DWORD src1_sel:WORD_1
    buffer_store_dwordx4 v[32:35], v50, s[32:35], s55 offen offset:1024 sc1
    v_or_b32_sdwa v28, v170, v185 dst_sel:DWORD dst_unused:UNUSED_PAD src0_sel:DWORD src1_sel:WORD_0
    v_or_b32_sdwa v29, v171, v185 dst_sel:DWORD dst_unused:UNUSED_PAD src0_sel:DWORD src1_sel:WORD_1
    buffer_store_dwordx4 v[28:31], v50, s[32:35], s55 offen offset:1536 sc1
    v_or_b32_sdwa v32, v172, v186 dst_sel:DWORD dst_unused:UNUSED_PAD src0_sel:DWORD src1_sel:WORD_0
    v_or_b32_sdwa v33, v173, v186 dst_sel:DWORD dst_unused:UNUSED_PAD src0_sel:DWORD src1_sel:WORD_1
    buffer_store_dwordx4 v[32:35], v50, s[32:35], s55 offen offset:2048 sc1
    v_or_b32_sdwa v28, v174, v188 dst_sel:DWORD dst_unused:UNUSED_PAD src0_sel:DWORD src1_sel:WORD_0
    v_or_b32_sdwa v29, v175, v188 dst_sel:DWORD dst_unused:UNUSED_PAD src0_sel:DWORD src1_sel:WORD_1
    buffer_store_dwordx4 v[28:31], v50, s[32:35], s55 offen offset:2560 sc1
    v_or_b32_sdwa v32, v176, v189 dst_sel:DWORD dst_unused:UNUSED_PAD src0_sel:DWORD src1_sel:WORD_0
    v_or_b32_sdwa v33, v177, v189 dst_sel:DWORD dst_unused:UNUSED_PAD src0_sel:DWORD src1_sel:WORD_1
    buffer_store_dwordx4 v[32:35], v50, s[32:35], s55 offen offset:3072 sc1
    v_or_b32_sdwa v28, v178, v190 dst_sel:DWORD dst_unused:UNUSED_PAD src0_sel:DWORD src1_sel:WORD_0
    v_or_b32_sdwa v29, v179, v190 dst_sel:DWORD dst_unused:UNUSED_PAD src0_sel:DWORD src1_sel:WORD_1
    buffer_store_dwordx4 v[28:31], v50, s[32:35], s55 offen offset:3584 sc1
RK_NOSEL:
    s_mov_b64 exec, -1
    s_mov_b64 exec, s[58:59]
    s_cbranch_execz RK_NOOUT
    global_store_dwordx4 v4, v[16:19], s[28:29] sc1
    global_store_dwordx4 v4, v[20:23], s[28:29] offset:512 sc1
    global_store_dword v5, v24, s[28:29] offset:1024 sc1
RK_NOOUT:
    s_mov_b64 exec, -1
    s_cmp_ge_u32 s2, 144
    s_cbranch_scc1 DUMP
ZROLE:
    s_and_b32 s50, s2, 7
    s_mul_i32 s50, s50, 18
    s_lshr_b32 s46, s2, 3
    s_add_u32 s50, s50, s46
    s_mul_i32 s60, s50, 9216
    s_add_u32 s60, s60, 7340032
    s_and_b32 s46, s40, 63
    v_mov_b32 v36, s46
    v_lshlrev_b32 v82, 2, v0
    s_cmp_lg_u32 s3, 0
    s_cbranch_scc1 Z_W
    v_and_b32 v12, 7, v1
    v_mul_u32_u24 v12, 4608, v12
    v_bfe_u32 v13, v1, 4, 1
    v_lshrrev_b32 v14, 5, v1
    v_lshl_add_u32 v13, v13, 1, v14
    s_lshl_b32 s46, s50, 2
    v_add_u32 v13, s46, v13
    v_bfe_u32 v14, v13, 3, 5
    v_and_b32 v15, 7, v13
    v_lshrrev_b32 v36, 8, v13
    v_lshl_add_u32 v15, v36, 3, v15
    s_cmp_lt_u32 s50, 128
    s_cbranch_scc1 Z_A
    v_bfe_u32 v14, v13, 1, 5
    v_and_b32 v15, 1, v13
    v_add_u32 v15, 16, v15
Z_A:
    v_lshrrev_b32 v36, 1, v15
    v_and_b32 v15, 1, v15
    v_lshl_add_u32 v14, v14, 4, v12
    v_lshl_add_u32 v14, v36, 9, v14
    v_cmp_eq_u32 s[52:53], 1, v15
    s_mul_i32 s60, s50, 9216
    s_add_u32 s60, s60, 7340032
    s_add_u32 s61, s60, 4096
    s_add_u32 s62, s60, 8192
    s_mov_b32 s63, 131072
    s_and_b32 s46, s40, 63
    v_mov_b32 v36, s46
    s_getreg_b32 s48, hwreg(HW_REG_XCC_ID, 0, 3)
    s_lshl_b32 s48, s48, 14
    s_add_u32 s48, s48, 9699328
    s_add_u32 s59, s48, 8192
    v_lshlrev_b32 v80, 7, v1
    v_and_b32 v81, 7, v1
    v_lshlrev_b32 v81, 7, v81
    buffer_load_dword v38, v80, s[32:35], s48 offen sc1
    buffer_load_dword v39, v81, s[32:35], s59 offen sc1
    s_mov_b32 s47, 0
PL22:
    s_waitcnt vmcnt(0)
    v_cmp_ne_u32 vcc, s40, v38
    v_cmp_ne_u32 s[56:57], s40, v39
    s_or_b64 vcc, vcc, s[56:57]
    s_cbranch_vccz PD23
    s_add_u32 s47, s47, 1
    s_cmp_ge_u32 s47, 262144
    s_cbranch_scc1 PD23
    s_sleep 1
    buffer_load_dword v38, v80, s[32:35], s48 offen sc1
    buffer_load_dword v39, v81, s[32:35], s59 offen sc1
    s_branch PL22
PD23:
    s_barrier
    buffer_load_dwordx4 v[40:43], v3, s[32:35], s60 offen sc1
    buffer_load_dwordx4 v[44:47], v3, s[32:35], s62 offen sc1
    buffer_load_dwordx4 v[32:35], v14, s[32:35], s63 offen sc1
    s_mov_b32 s47, 0
PL24:
    s_waitcnt vmcnt(0)
    v_xor_b32 v40, v36, v40
    v_xor_b32 v41, v36, v41
    v_xor_b32 v42, v36, v42
    v_xor_b32 v43, v36, v43
    v_xor_b32 v44, v36, v44
    v_xor_b32 v45, v36, v45
    v_xor_b32 v46, v36, v46
    v_xor_b32 v47, v36, v47
    v_or3_b32 v37, v40, v41, v42
    v_or3_b32 v37, v37, v44, v45
    v_or3_b32 v37, v37, v46, v47
    v_or_b32 v37, v37, v43
    v_and_b32 v37, 63, v37
    v_cmp_ne_u32 vcc, 0, v37
    s_cbranch_vccz PD25
    s_add_u32 s47, s47, 1
    s_cmp_ge_u32 s47, 262144
    s_cbranch_scc1 PD25
    buffer_load_dwordx4 v[40:43], v3, s[32:35], s60 offen sc1
    buffer_load_dwordx4 v[44:47], v3, s[32:35], s62 offen sc1
    s_branch PL24
PD25:
    s_mov_b32 s47, 0
PL26:
    s_waitcnt vmcnt(0)
    v_cmp_ne_u32 vcc, s40, v35
    s_cbranch_vccz PD27
    s_add_u32 s47, s47, 1
    s_cmp_ge_u32 s47, 262144
    s_cbranch_scc1 PD27
    s_sleep 2
    buffer_load_dwordx4 v[32:35], v14, s[32:35], s63 offen sc1
    s_branch PL26
PD27:
    v_cndmask_b32 v32, v32, v33, s[52:53]
    v_and_b32 v33, 0xffff0000, v34
    v_and_b32 v28, 2047, v34
    v_mul_u32_u24 v28, 1152, v28
    v_lshl_add_u32 v28, v13, 1, v28
    v_lshlrev_b32 v34, 16, v32
    v_and_b32 v35, 0xffff0000, v32
    v_pk_add_f32 v[40:41], v[40:41], v[44:45]
    v_pk_add_f32 v[42:43], v[42:43], v[46:47]
    s_nop 0
    v_permlane32_swap_b32 v40, v41
    v_permlane32_swap_b32 v42, v43
    v_add_f32 v40, v40, v41
    v_add_f32 v42, v42, v43
    s_nop 1
    v_permlane16_swap_b32 v40, v42
    v_add_f32 v40, v40, v42
    s_barrier
    ds_read2st64_b32 v[44:45], v82 offset0:1 offset1:2
    ds_read2st64_b32 v[46:47], v82 offset0:3 offset1:4
    ds_read2st64_b32 v[48:49], v82 offset0:5 offset1:6
    ds_read_b32 v50, v82 offset:1792
    s_waitcnt lgkmcnt(2)
    v_add_f32 v44, v44, v45
    v_add_f32 v46, v46, v47
    v_add_f32 v40, v40, v44
    s_waitcnt lgkmcnt(0)
    v_add_f32 v48, v48, v49
    v_add_f32 v46, v46, v50
    v_add_f32 v40, v40, v48
    v_add_f32 v40, v40, v46
    s_nop 1
    v_add_f32_dpp v40, v40, v40 row_ror:8 row_mask:0xf bank_mask:0xf
    v_cvt_pk_bf16_f32 v40, 0, v40
    v_mul_f32 v40, v40, v33
    v_cvt_pk_bf16_f32 v40, 0, v40
    v_add_f32 v40, v40, v34
    v_cvt_pk_bf16_f32 v40, 0, v40
    v_add_f32 v40, v40, v35
    v_cvt_pk_bf16_f32 v40, v40, v40
    s_mov_b32 exec_lo, 0x00ff00ff
    s_mov_b32 exec_hi, 0x00ff00ff
    global_store_short v28, v40, s[28:29]
    s_cmp_lg_u32 s50, 0
    s_cbranch_scc1 DUMP
    s_mov_b64 exec, 1
    v_mov_b32 v36, s40
    buffer_store_dword v36, v2, s[32:35], 0 offen sc1
    s_branch DUMP
Z_W:
    s_barrier
    buffer_load_dwordx4 v[40:43], v3, s[32:35], s60 offen sc1
    s_mov_b32 s47, 0
PL28:
    s_waitcnt vmcnt(0)
    v_xor_b32 v40, v36, v40
    v_xor_b32 v41, v36, v41
    v_xor_b32 v42, v36, v42
    v_xor_b32 v43, v36, v43
    v_or3_b32 v37, v40, v41, v42
    v_or_b32 v37, v37, v43
    v_and_b32 v37, 63, v37
    v_cmp_ne_u32 vcc, 0, v37
    s_cbranch_vccz PD29
    s_add_u32 s47, s47, 1
    s_cmp_ge_u32 s47, 262144
    s_cbranch_scc1 PD29
    buffer_load_dwordx4 v[40:43], v3, s[32:35], s60 offen sc1
    s_branch PL28
PD29:
    v_permlane32_swap_b32 v40, v41
    v_permlane32_swap_b32 v42, v43
    v_add_f32 v40, v40, v41
    v_add_f32 v42, v42, v43
    s_nop 1
    v_permlane16_swap_b32 v40, v42
    v_add_f32 v40, v40, v42
    ds_write_b32 v82, v40
    s_waitcnt lgkmcnt(0)
    s_barrier
    s_branch DUMP
FROLE:
    s_sub_u32 s50, s2, 144
    s_cmp_lt_u32 s50, 48
    s_cbranch_scc1 F_NT
    v_cmp_gt_u32 vcc, TBLEND-PC0, v15
    s_and_saveexec_b64 s[58:59], vcc
    s_cbranch_execz F_NT
    global_load_dword v255, v15, s[42:43]
F_NT:
    s_mov_b64 exec, -1
    s_and_b32 s46, s50, 7
    s_sub_u32 s48, 3, s46
    s_and_b32 s48, s48, 7
    s_lshr_b32 s50, s50, 3
    s_add_u32 s50, s50, s48
    s_add_u32 s50, s50, 2
    s_cmp_ge_u32 s50, 9
    s_cselect_b32 s48, 9, 0
    s_sub_u32 s50, s50, s48
    s_mul_i32 s46, s46, 9
    s_add_u32 s50, s50, s46
    v_lshrrev_b32 v12, 3, v0
    v_and_b32 v13, 7, v0
    v_lshlrev_b32 v13, 4, v13
    v_mul_u32_u24 v4, 9216, v12
    v_add_u32 v4, v4, v13
    v_mul_u32_u24 v5, 1152, v12
    v_add_u32 v5, v5, v13
    s_lshl_b32 s46, s50, 7
    s_mul_i32 s48, s50, 73728
    s_mov_b32 s38, 5308416
    s_mov_b32 s39, 0x00020000
    s_mov_b32 s54, 5308416
    s_mov_b32 s55, 0x00020000
    s_mov_b32 s58, 5308416
    s_mov_b32 s59, 0x00020000
    s_waitcnt lgkmcnt(0)
    s_mov_b32 s36, s22
    s_and_b32 s37, s23, 0xffff
    s_mov_b32 s52, s24
    s_and_b32 s53, s25, 0xffff
    s_mov_b32 s56, s26
    s_and_b32 s57, s27, 0xffff
    s_load_dword s40, s[30:31], 0
    s_cmp_ge_u32 s2, 192
    s_cbranch_scc1 F_L1
    s_barrier
    s_lshl_b32 s49, s50, 7
    buffer_load_dwordx4 v[16:19], v4, s[36:39], s49 offen nt
    buffer_load_dwordx4 v[20:23], v4, s[52:55], s49 offen nt
    s_add_u32 s49, s49, 589824
    buffer_load_dwordx4 v[24:27], v4, s[36:39], s49 offen nt
    buffer_load_dwordx4 v[28:31], v4, s[52:55], s49 offen nt
    s_add_u32 s49, s49, 589824
    buffer_load_dwordx4 v[32:35], v4, s[36:39], s49 offen nt
    buffer_load_dwordx4 v[36:39], v4, s[52:55], s49 offen nt
    s_add_u32 s49, s49, 589824
F_L1:
    s_mov_b32 s32, s30
    s_and_b32 s33, s31, 0xffff
    s_mov_b32 s34, 0x10000000
    s_mov_b32 s35, 0x00020000
    v_mul_u32_u24 v6, 272, v12
    v_add_u32 v6, v6, v13
    v_lshrrev_b32 v14, 4, v1
    v_bfe_u32 v15, v1, 2, 2
    v_lshl_add_u32 v7, v14, 3, v15
    v_mul_u32_u24 v7, 272, v7
    v_and_b32 v8, 2, v1
    v_lshl_add_u32 v7, v8, 6, v7
    v_and_b32 v8, 1, v1
    v_lshl_add_u32 v7, v8, 3, v7
    s_lshl_b32 s46, s3, 4
    v_add_u32 v7, s46, v7
    v_bfe_u32 v8, v1, 3, 3
    v_mul_u32_u24 v8, 1184, v8
    v_add_u32 v8, v8, v13
    s_mul_i32 s46, s3, 9600
    v_add_u32 v8, s46, v8
    v_mul_u32_u24 v9, 9600, v14
    v_mul_u32_u24 v15, 1184, v15
    v_add_u32 v9, v9, v15
    v_and_b32 v15, 3, v1
    v_lshl_add_u32 v9, v15, 3, v9
    s_lshl_b32 s46, s3, 5
    v_add_u32 v9, s46, v9
    s_mul_i32 s46, s3, 1216
    s_add_u32 s46, s46, 81920
    v_mov_b32 v243, s46
    v_and_b32 v244, 31, v1
    v_lshrrev_b32 v242, 5, v1
    v_lshl_add_u32 v245, v244, 4, v243
    v_lshl_add_u32 v246, v244, 2, v243
    v_add_u32 v246, 1024, v246
    v_cmp_eq_u32 s[60:61], 1, v242
    v_cmp_eq_u32 s[62:63], 2, v242
    v_mov_b32 v247, 0
    v_mov_b32 v248, 12
    v_cndmask_b32 v247, v247, v248, s[60:61]
    v_mov_b32 v248, 520
    v_cndmask_b32 v247, v247, v248, s[62:63]
    v_add_u32 v236, v247, v245
    v_mov_b32 v247, 4
    v_mov_b32 v248, 512
    v_cndmask_b32 v247, v247, v248, s[60:61]
    v_mov_b32 v248, 524
    v_cndmask_b32 v247, v247, v248, s[62:63]
    v_add_u32 v237, v247, v245
    v_mov_b32 v247, 8
    v_mov_b32 v248, 516
    v_cndmask_b32 v247, v247, v248, s[60:61]
    v_add_u32 v247, v247, v245
    v_cndmask_b32 v238, v247, v246, s[62:63]
    s_mul_i32 s46, s3, 1216
    s_add_u32 s46, s46, 81920
    v_mov_b32 v243, s46
    v_and_b32 v244, 31, v1
    v_mov_b32 v242, 2
    v_lshl_add_u32 v245, v244, 4, v243
    v_lshl_add_u32 v246, v244, 2, v243
    v_add_u32 v246, 1024, v246
    v_cmp_eq_u32 s[60:61], 1, v242
    v_cmp_eq_u32 s[62:63], 2, v242
    v_mov_b32 v247, 0
    v_mov_b32 v248, 12
    v_cndmask_b32 v247, v247, v248, s[60:61]
    v_mov_b32 v248, 520
    v_cndmask_b32 v247, v247, v248, s[62:63]
    v_add_u32 v239, v247, v245
    v_mov_b32 v247, 4
    v_mov_b32 v248, 512
    v_cndmask_b32 v247, v247, v248, s[60:61]
    v_mov_b32 v248, 524
    v_cndmask_b32 v247, v247, v248, s[62:63]
    v_add_u32 v240, v247, v245
    v_mov_b32 v247, 8
    v_mov_b32 v248, 516
    v_cndmask_b32 v247, v247, v248, s[60:61]
    v_add_u32 v247, v247, v245
    v_cndmask_b32 v241, v247, v246, s[62:63]
    v_bfe_u32 v247, v236, 2, 1
    v_bfe_u32 v248, v236, 3, 2
    v_and_b32 v236, 0xffffffe3, v236
    v_lshl_add_u32 v236, v247, 4, v236
    v_lshl_add_u32 v236, v248, 2, v236
    v_bfe_u32 v247, v237, 2, 1
    v_bfe_u32 v248, v237, 3, 2
    v_and_b32 v237, 0xffffffe3, v237
    v_lshl_add_u32 v237, v247, 4, v237
    v_lshl_add_u32 v237, v248, 2, v237
    v_bfe_u32 v247, v238, 2, 1
    v_bfe_u32 v248, v238, 3, 2
    v_and_b32 v238, 0xffffffe3, v238
    v_lshl_add_u32 v238, v247, 4, v238
    v_lshl_add_u32 v238, v248, 2, v238
    v_bfe_u32 v247, v239, 2, 1
    v_bfe_u32 v248, v239, 3, 2
    v_and_b32 v239, 0xffffffe3, v239
    v_lshl_add_u32 v239, v247, 4, v239
    v_lshl_add_u32 v239, v248, 2, v239
    v_bfe_u32 v247, v240, 2, 1
    v_bfe_u32 v248, v240, 3, 2
    v_and_b32 v240, 0xffffffe3, v240
    v_lshl_add_u32 v240, v247, 4, v240
    v_lshl_add_u32 v240, v248, 2, v240
    v_bfe_u32 v247, v241, 2, 1
    v_bfe_u32 v248, v241, 3, 2
    v_and_b32 v241, 0xffffffe3, v241
    v_lshl_add_u32 v241, v247, 4, v241
    v_lshl_add_u32 v241, v248, 2, v241
    v_and_b32 v15, 7, v1
    v_mul_u32_u24 v10, 1216, v15
    v_lshl_add_u32 v10, v14, 5, v10
    v_and_b32 v247, 8, v1
    v_lshl_add_u32 v10, v247, 1, v10
    v_add_u32 v10, 81920, v10
    v_mul_u32_u24 v11, 144, v15
    v_add_u32 v11, 98304, v11
    v_lshl_add_u32 v242, v14, 4, v11
    v_bfe_u32 v243, v1, 3, 2
    v_lshrrev_b32 v244, 5, v1
    v_lshl_add_u32 v243, v243, 1, v244
    v_mul_u32_u24 v11, 144, v243
    v_lshl_add_u32 v11, v15, 1, v11
    s_lshl_b32 s46, s3, 4
    s_add_u32 s46, s46, 98304
    v_add_u32 v11, s46, v11
    v_bfe_u32 v243, v1, 3, 1
    v_lshl_add_u32 v243, v243, 5, v14
    v_mul_u32_u24 v243, 9216, v243
    v_lshl_add_u32 v243, v15, 4, v243
    s_mul_i32 s62, s3, 36864
    s_lshl_b32 s46, s50, 7
    s_add_u32 s62, s62, s46
    s_add_u32 s62, s62, 7340032
    v_and_b32 v244, 8, v1
    v_cmp_eq_u32 s[60:61], 0, v244
    v_mov_b32 v251, 0xeeee
    v_mov_b32 v252, 0x4444
    v_cndmask_b32 v251, v251, v252, s[60:61]
    s_waitcnt lgkmcnt(0)
    s_add_u32 s40, s40, 1
    s_and_b32 s46, s40, 63
    v_mov_b32 v245, s46
    v_mov_b32 v246, 0xffffffc0
    v_mov_b32 v249, s40
    v_lshlrev_b32 v250, 14, v1
    s_lshl_b32 s63, s50, 7
    s_add_u32 s63, s63, 9699328
    s_cmp_lt_u32 s2, 192
    s_cbranch_scc1 F_L2
    s_lshl_b32 s49, s50, 7
    buffer_load_dwordx4 v[16:19], v4, s[36:39], s49 offen nt
    buffer_load_dwordx4 v[20:23], v4, s[52:55], s49 offen nt
    s_add_u32 s49, s49, 589824
    buffer_load_dwordx4 v[24:27], v4, s[36:39], s49 offen nt
    buffer_load_dwordx4 v[28:31], v4, s[52:55], s49 offen nt
    s_add_u32 s49, s49, 589824
    buffer_load_dwordx4 v[32:35], v4, s[36:39], s49 offen nt
    buffer_load_dwordx4 v[36:39], v4, s[52:55], s49 offen nt
    s_add_u32 s49, s49, 589824
F_L2:
    buffer_load_dwordx4 v[40:43], v4, s[36:39], s49 offen nt
    buffer_load_dwordx4 v[44:47], v4, s[52:55], s49 offen nt
    s_add_u32 s49, s49, 589824
    s_waitcnt vmcnt(6)
    ds_write_b128 v6, v[16:19] offset:0
    ds_write_b128 v6, v[20:23] offset:128
    s_waitcnt lgkmcnt(0)
    s_barrier
    ds_read_b64_tr_b16 v[124:125], v7 offset:0
    ds_read_b64_tr_b16 v[126:127], v7 offset:1088
    ds_read_b64_tr_b16 v[128:129], v7 offset:8704
    ds_read_b64_tr_b16 v[130:131], v7 offset:9792
    buffer_load_dwordx4 v[48:51], v4, s[36:39], s49 offen nt
    buffer_load_dwordx4 v[52:55], v4, s[52:55], s49 offen nt
    s_add_u32 s49, s49, 589824
    s_waitcnt vmcnt(6)
    ds_write_b128 v6, v[24:27] offset:17408
    ds_write_b128 v6, v[28:31] offset:17536
    s_waitcnt lgkmcnt(0)
    s_barrier
    ds_read_b64_tr_b16 v[132:133], v7 offset:17408
    ds_read_b64_tr_b16 v[134:135], v7 offset:18496
    ds_read_b64_tr_b16 v[136:137], v7 offset:26112
    ds_read_b64_tr_b16 v[138:139], v7 offset:27200
    buffer_load_dwordx4 v[56:59], v4, s[36:39], s49 offen nt
    buffer_load_dwordx4 v[60:63], v4, s[52:55], s49 offen nt
    s_add_u32 s49, s49, 589824
    s_waitcnt vmcnt(6)
    ds_write_b128 v6, v[32:35] offset:34816
    ds_write_b128 v6, v[36:39] offset:34944
    s_waitcnt lgkmcnt(0)
    s_barrier
    ds_read_b64_tr_b16 v[140:141], v7 offset:34816
    ds_read_b64_tr_b16 v[142:143], v7 offset:35904
    ds_read_b64_tr_b16 v[144:145], v7 offset:43520
    ds_read_b64_tr_b16 v[146:147], v7 offset:44608
    buffer_load_dwordx4 v[64:67], v4, s[36:39], s49 offen nt
    buffer_load_dwordx4 v[68:71], v4, s[52:55], s49 offen nt
    s_add_u32 s49, s49, 589824
    s_waitcnt vmcnt(6)
    v_add_u32 v6, 52224, v6
    v_add_u32 v7, 52224, v7
    ds_write_b128 v6, v[40:43] offset:0
    ds_write_b128 v6, v[44:47] offset:128
    s_waitcnt lgkmcnt(0)
    s_barrier
    ds_read_b64_tr_b16 v[148:149], v7 offset:0
    ds_read_b64_tr_b16 v[150:151], v7 offset:1088
    ds_read_b64_tr_b16 v[152:153], v7 offset:8704
    ds_read_b64_tr_b16 v[154:155], v7 offset:9792
    buffer_load_dwordx4 v[72:75], v4, s[36:39], s49 offen nt
    buffer_load_dwordx4 v[76:79], v4, s[52:55], s49 offen nt
    s_add_u32 s49, s49, 589824
    s_waitcnt vmcnt(6)
    ds_write_b128 v6, v[48:51] offset:17408
    ds_write_b128 v6, v[52:55] offset:17536
    s_waitcnt lgkmcnt(0)
    s_barrier
    ds_read_b64_tr_b16 v[156:157], v7 offset:17408
    ds_read_b64_tr_b16 v[158:159], v7 offset:18496
    ds_read_b64_tr_b16 v[160:161], v7 offset:26112
    ds_read_b64_tr_b16 v[162:163], v7 offset:27200
    buffer_load_dwordx4 v[80:83], v4, s[36:39], s49 offen nt
    buffer_load_dwordx4 v[84:87], v4, s[52:55], s49 offen nt
    s_add_u32 s49, s49, 589824
    s_waitcnt vmcnt(6)
    ds_write_b128 v6, v[56:59] offset:34816
    ds_write_b128 v6, v[60:63] offset:34944
    s_waitcnt lgkmcnt(0)
    s_barrier
    ds_read_b64_tr_b16 v[164:165], v7 offset:34816
    ds_read_b64_tr_b16 v[166:167], v7 offset:35904
    ds_read_b64_tr_b16 v[168:169], v7 offset:43520
    ds_read_b64_tr_b16 v[170:171], v7 offset:44608
    buffer_load_dwordx4 v[88:91], v5, s[56:59], s48 offen offset:0 nt
    buffer_load_dwordx4 v[92:95], v5, s[56:59], s48 offen offset:128 nt
    s_waitcnt vmcnt(6)
    v_add_u32 v6, 52224, v6
    v_add_u32 v7, 52224, v7
    ds_write_b128 v6, v[64:67] offset:0
    ds_write_b128 v6, v[68:71] offset:128
    s_waitcnt lgkmcnt(0)
    s_barrier
    ds_read_b64_tr_b16 v[172:173], v7 offset:0
    ds_read_b64_tr_b16 v[174:175], v7 offset:1088
    ds_read_b64_tr_b16 v[176:177], v7 offset:8704
    ds_read_b64_tr_b16 v[178:179], v7 offset:9792
    buffer_load_dwordx4 v[96:99], v5, s[56:59], s48 offen offset:256 nt
    buffer_load_dwordx4 v[100:103], v5, s[56:59], s48 offen offset:384 nt
    s_waitcnt vmcnt(6)
    ds_write_b128 v6, v[72:75] offset:17408
    ds_write_b128 v6, v[76:79] offset:17536
    s_waitcnt lgkmcnt(0)
    s_barrier
    ds_read_b64_tr_b16 v[180:181], v7 offset:17408
    ds_read_b64_tr_b16 v[182:183], v7 offset:18496
    ds_read_b64_tr_b16 v[184:185], v7 offset:26112
    ds_read_b64_tr_b16 v[186:187], v7 offset:27200
    buffer_load_dwordx4 v[104:107], v5, s[56:59], s48 offen offset:512 nt
    buffer_load_dwordx4 v[108:111], v5, s[56:59], s48 offen offset:640 nt
    s_waitcnt vmcnt(6)
    ds_write_b128 v6, v[80:83] offset:34816
    ds_write_b128 v6, v[84:87] offset:34944
    s_waitcnt lgkmcnt(0)
    s_barrier
    ds_read_b64_tr_b16 v[188:189], v7 offset:34816
    ds_read_b64_tr_b16 v[190:191], v7 offset:35904
    ds_read_b64_tr_b16 v[192:193], v7 offset:43520
    ds_read_b64_tr_b16 v[194:195], v7 offset:44608
    buffer_load_dwordx4 v[112:115], v5, s[56:59], s48 offen offset:768 nt
    buffer_load_dwordx4 v[116:119], v5, s[56:59], s48 offen offset:896 nt
    s_waitcnt vmcnt(6)
    ds_write_b128 v8, v[88:91] offset:0
    ds_write_b128 v8, v[92:95] offset:128
    s_waitcnt lgkmcnt(0)
    s_barrier
    ds_read_b64_tr_b16 v[196:197], v9 offset:0
    ds_read_b64_tr_b16 v[198:199], v9 offset:4736
    ds_read_b64_tr_b16 v[200:201], v9 offset:38400
    ds_read_b64_tr_b16 v[202:203], v9 offset:43136
    buffer_load_dwordx4 v[120:123], v5, s[56:59], s48 offen offset:1024 nt
    s_waitcnt vmcnt(5)
    ds_write_b128 v8, v[96:99] offset:256
    ds_write_b128 v8, v[100:103] offset:384
    s_waitcnt lgkmcnt(0)
    s_barrier
    ds_read_b64_tr_b16 v[204:205], v9 offset:256
    ds_read_b64_tr_b16 v[206:207], v9 offset:4992
    ds_read_b64_tr_b16 v[208:209], v9 offset:38656
    ds_read_b64_tr_b16 v[210:211], v9 offset:43392
    s_waitcnt vmcnt(3)
    ds_write_b128 v8, v[104:107] offset:512
    ds_write_b128 v8, v[108:111] offset:640
    s_waitcnt lgkmcnt(0)
    s_barrier
    ds_read_b64_tr_b16 v[212:213], v9 offset:512
    ds_read_b64_tr_b16 v[214:215], v9 offset:5248
    ds_read_b64_tr_b16 v[216:217], v9 offset:38912
    ds_read_b64_tr_b16 v[218:219], v9 offset:43648
    s_waitcnt vmcnt(1)
    ds_write_b128 v8, v[112:115] offset:768
    ds_write_b128 v8, v[116:119] offset:896
    v_mov_b32 v16, 0
    v_lshlrev_b32 v17, 2, v1
    v_add_u32 v17, 100352, v17
    ds_write2st64_b32 v17, v16, v16 offset0:0 offset1:1
    s_waitcnt lgkmcnt(0)
    s_barrier
    ds_read_b64_tr_b16 v[220:221], v9 offset:768
    ds_read_b64_tr_b16 v[222:223], v9 offset:5504
    ds_read_b64_tr_b16 v[224:225], v9 offset:39168
    ds_read_b64_tr_b16 v[226:227], v9 offset:43904
    s_waitcnt vmcnt(0)
    ds_write_b128 v8, v[120:123] offset:1024
    s_waitcnt lgkmcnt(0)
    s_barrier
    ds_read_b64_tr_b16 v[228:229], v9 offset:1024
    ds_read_b64_tr_b16 v[230:231], v9 offset:5760
    ds_read_b64_tr_b16 v[232:233], v9 offset:39424
    ds_read_b64_tr_b16 v[234:235], v9 offset:44160
    s_getreg_b32 s48, hwreg(HW_REG_XCC_ID, 0, 3)
    s_mul_i32 s48, s48, 16384
    s_add_u32 s48, s48, 9437184
    s_waitcnt lgkmcnt(0)
    v_mov_b32 v68, 0
    v_mov_b32 v69, 0
    v_mov_b32 v70, 0
    v_mov_b32 v71, 0
    s_add_u32 s54, s62, 589824
    s_add_u32 s55, s62, 1179648
    v_lshrrev_b32 v100, 2, v0
    v_and_b32 v98, 3, v0
    v_lshlrev_b32 v98, 4, v98
    v_lshl_add_u32 v100, v100, 6, v98
    buffer_load_dwordx4 v[72:75], v100, s[32:35], s48 offen sc1
    s_and_b32 s46, s40, 0xffff
    v_mov_b32 v101, s46
    v_lshlrev_b32 v98, 2, v0
    v_sub_u32 v104, 0xffff, v98
    v_subrev_u32 v105, 1, v104
    v_subrev_u32 v106, 2, v104
    v_subrev_u32 v107, 3, v104
    v_lshrrev_b32 v102, 4, v0
    v_lshlrev_b32 v102, 3, v102
    v_add_u32 v102, 100352, v102
    v_and_b32 v110, 31, v1
    v_lshlrev_b32 v110, 4, v110
    v_lshrrev_b32 v103, 3, v0
    v_lshlrev_b32 v103, 2, v103
    v_add_u32 v103, 100352, v103
    v_and_b32 v108, 7, v1
    v_lshlrev_b32 v108, 5, v108
    v_add_u32 v108, 100352, v108
    v_mov_b32 v109, 100608
    s_lshl_b32 s46, s3, 2
    v_add_u32 v111, s46, v109
    s_mov_b32 s56, 0x10001
    s_mov_b32 s57, 0x10001
    s_mov_b32 s58, 0x01010101
    s_mov_b32 s59, 0x01010101
    s_mov_b32 s47, 0
PL30:
    s_waitcnt vmcnt(0)
    v_xor_b32 v72, v101, v72
    v_xor_b32 v73, v101, v73
    v_xor_b32 v74, v101, v74
    v_xor_b32 v75, v101, v75
    v_or3_b32 v98, v72, v73, v74
    v_or_b32 v98, v98, v75
    v_and_b32 v98, 0xffff, v98
    v_cmp_ne_u32 vcc, 0, v98
    s_cbranch_vccz PD31
    s_add_u32 s47, s47, 1
    s_cmp_ge_u32 s47, 262144
    s_cbranch_scc1 PD31
    s_sleep 1
    buffer_load_dwordx4 v[72:75], v100, s[32:35], s48 offen sc1
    s_branch PL30
PD31:
    v_or_b32 v72, v72, v104
    v_or_b32 v73, v73, v105
    v_or_b32 v74, v74, v106
    v_or_b32 v75, v75, v107
    v_max_u32 v98, v72, v73
    v_max_u32 v99, v74, v75
    v_max_u32 v76, v98, v99
    v_min_u32 v72, v72, v73
    v_min_u32 v74, v74, v75
    v_max_u32_dpp v112, v76, v76 row_ror:8 row_mask:0xf bank_mask:0xf
    v_min_u32 v98, v98, v99
    v_max_u32 v99, v72, v74
    v_max_u32_dpp v112, v112, v112 row_ror:4 row_mask:0xf bank_mask:0xf
    v_max_u32 v77, v98, v99
    v_min_u32 v78, v98, v99
    v_max_u32_dpp v112, v112, v112 row_ror:2 row_mask:0xf bank_mask:0xf
    v_min_u32 v79, v72, v74
    v_mov_b32 v97, 0
    v_max_u32_dpp v112, v112, v112 row_ror:1 row_mask:0xf bank_mask:0xf
    v_cmp_eq_u32 vcc, v112, v76
    s_nop 1
    v_cndmask_b32 v115, v76, v77, vcc
    v_cndmask_b32 v116, v77, v78, vcc
    s_nop 0
    v_max_u32_dpp v113, v115, v115 row_ror:8 row_mask:0xf bank_mask:0xf
    s_nop 1
    v_max_u32_dpp v113, v113, v113 row_ror:4 row_mask:0xf bank_mask:0xf
    s_nop 1
    v_max_u32_dpp v113, v113, v113 row_ror:2 row_mask:0xf bank_mask:0xf
    s_nop 1
    v_max_u32_dpp v113, v113, v113 row_ror:1 row_mask:0xf bank_mask:0xf
    s_mov_b64 exec, s[56:57]
    ds_write_b64 v102, v[112:113]
    s_mov_b64 exec, -1
    v_cmp_eq_u32 vcc, v113, v115
    s_nop 1
    v_cndmask_b32 v115, v115, v116, vcc
    s_waitcnt lgkmcnt(0)
    s_barrier
    ds_read_b32 v96, v103
    ds_read_b128 v[80:83], v108
    ds_read_b128 v[84:87], v108 offset:16
    s_waitcnt lgkmcnt(1)
    v_cmp_gt_u32 s[4:5], v80, v96
    v_cmp_gt_u32 s[6:7], v81, v96
    v_cmp_gt_u32 s[8:9], v82, v96
    v_cmp_gt_u32 s[10:11], v83, v96
    v_addc_co_u32 v97, vcc, 0, v97, s[4:5]
    v_addc_co_u32 v97, vcc, 0, v97, s[6:7]
    v_addc_co_u32 v97, vcc, 0, v97, s[8:9]
    v_addc_co_u32 v97, vcc, 0, v97, s[10:11]
    s_waitcnt lgkmcnt(0)
    v_cmp_gt_u32 s[4:5], v84, v96
    v_cmp_gt_u32 s[6:7], v85, v96
    v_cmp_gt_u32 s[8:9], v86, v96
    v_cmp_gt_u32 s[10:11], v87, v96
    v_addc_co_u32 v97, vcc, 0, v97, s[4:5]
    v_addc_co_u32 v97, vcc, 0, v97, s[6:7]
    v_addc_co_u32 v97, vcc, 0, v97, s[8:9]
    v_addc_co_u32 v97, vcc, 0, v97, s[10:11]
    s_nop 1
    v_add_u32_dpp v97, v97, v97 quad_perm:[1,0,3,2] row_mask:0xf bank_mask:0xf
    s_nop 1
    v_add_u32_dpp v97, v97, v97 quad_perm:[2,3,0,1] row_mask:0xf bank_mask:0xf
    s_nop 1
    v_add_u32_dpp v97, v97, v97 row_half_mirror row_mask:0xf bank_mask:0xf
    v_cmp_gt_u32 vcc, 8, v97
    v_lshl_add_u32 v98, v97, 2, v109
    s_and_b64 exec, vcc, s[58:59]
    ds_write_b32 v98, v96
    s_mov_b64 exec, -1
    s_waitcnt lgkmcnt(0)
    s_barrier
    ds_read_b32 v98, v111
    ds_read_b32 v99, v109 offset:28
    s_waitcnt lgkmcnt(1)
    v_readfirstlane_b32 s49, v98
F_SEL:
    s_andn2_b32 s49, 0x7ff, s49
    s_mul_i32 s49, s49, 1536
    s_add_u32 s49, s49, 13631488
    s_nop 1
    buffer_load_dwordx4 v[16:19], v2, s[32:35], s49 offen sc1
    buffer_load_dwordx4 v[20:23], v110, s[32:35], s49 offen offset:1024 sc1
    s_waitcnt lgkmcnt(0)
    v_cmp_gt_u32 vcc, v115, v99
    s_cbranch_vccz F_NOV
    ds_write_b32 v109, v109 offset:32
F_NOV:
    s_mov_b32 s47, 0
PL32:
    s_waitcnt vmcnt(0)
    v_cmp_ne_u32 vcc, s40, v19
    v_cmp_ne_u32 s[52:53], s40, v23
    s_or_b64 vcc, vcc, s[52:53]
    s_cbranch_vccz PD33
    s_add_u32 s47, s47, 1
    s_cmp_ge_u32 s47, 262144
    s_cbranch_scc1 PD33
    s_sleep 1
    buffer_load_dwordx4 v[16:19], v2, s[32:35], s49 offen sc1
    buffer_load_dwordx4 v[20:23], v110, s[32:35], s49 offen offset:1024 sc1
    s_branch PL32
PD33:
    ds_write_b32 v236, v16
    ds_write_b32 v237, v17
    ds_write_b32 v238, v18
    s_mov_b32 exec_hi, 0
    ds_write_b32 v239, v20
    ds_write_b32 v240, v21
    ds_write_b32 v241, v22
    s_mov_b64 exec, -1
    s_waitcnt lgkmcnt(0)
    s_barrier
    s_cmp_lg_u32 s3, 7
    s_cbranch_scc1 FH34
    s_mov_b64 exec, 0xff
    buffer_store_dword v249, v250, s[32:35], s63 offen sc1
    s_mov_b64 exec, -1
FH34:
    ds_read_b32 v98, v109 offset:32
    ds_read_b128 v[32:35], v10 offset:0
    ds_read_b128 v[36:39], v10 offset:128
    ds_read_b128 v[40:43], v10 offset:256
    ds_read_b128 v[44:47], v10 offset:384
    ds_read_b128 v[48:51], v10 offset:512
    ds_read_b128 v[52:55], v10 offset:640
    ds_read_b128 v[56:59], v10 offset:768
    ds_read_b128 v[60:63], v10 offset:896
    ds_read_b128 v[64:67], v10 offset:1024
    s_waitcnt lgkmcnt(9)
    v_cmp_ne_u32 vcc, 0, v98
    s_cbranch_vccnz F_SLOW
    s_waitcnt lgkmcnt(8)
    v_smfmac_f32_16x16x64_bf16 v[68:71], v[32:35], v[124:131], v251
    s_waitcnt lgkmcnt(7)
    v_smfmac_f32_16x16x64_bf16 v[68:71], v[36:39], v[132:139], v251
    s_waitcnt lgkmcnt(6)
    v_smfmac_f32_16x16x64_bf16 v[68:71], v[40:43], v[140:147], v251
    s_waitcnt lgkmcnt(5)
    v_smfmac_f32_16x16x64_bf16 v[68:71], v[44:47], v[148:155], v251
    s_waitcnt lgkmcnt(4)
    v_smfmac_f32_16x16x64_bf16 v[68:71], v[48:51], v[156:163], v251
    s_waitcnt lgkmcnt(3)
    v_smfmac_f32_16x16x64_bf16 v[68:71], v[52:55], v[164:171], v251
    s_waitcnt lgkmcnt(2)
    v_smfmac_f32_16x16x64_bf16 v[68:71], v[56:59], v[172:179], v251
    s_waitcnt lgkmcnt(1)
    v_smfmac_f32_16x16x64_bf16 v[68:71], v[60:63], v[180:187], v251
    s_waitcnt lgkmcnt(0)
    v_smfmac_f32_16x16x64_bf16 v[68:71], v[64:67], v[188:195], v251
    s_nop 7
    v_permlane32_swap_b32 v68, v69
    v_permlane32_swap_b32 v70, v71
    v_add_f32 v28, v68, v69
    v_add_f32 v29, v70, v71
    v_cvt_pk_bf16_f32 v30, 0, v28
    v_cvt_pk_bf16_f32 v29, 0, v29
    v_cvt_pk_bf16_f32 v28, 0, v28
    s_nop 0
    v_mov_b32_dpp v28, v29 row_ror:8 row_mask:0xf bank_mask:0xc
    v_mov_b32_dpp v29, v30 row_ror:8 row_mask:0xf bank_mask:0x3
    v_mul_f32 v30, 0xbfb8aa3b, v28
    v_exp_f32 v30, v30
    s_nop 0
    v_add_f32 v30, 1.0, v30
    v_rcp_f32 v30, v30
    s_nop 0
    v_mul_f32 v28, v28, v30
    v_cvt_pk_bf16_f32 v28, 0, v28
    v_mul_f32 v28, v28, v29
    v_cvt_pk_bf16_f32 v28, v28, v28
    ds_write_b16 v11, v28
    s_waitcnt lgkmcnt(0)
    s_barrier
    ds_read_b128 v[16:19], v242
    ds_read_b128 v[20:23], v242 offset:64
    s_waitcnt lgkmcnt(1)
    v_mfma_f32_16x16x32_bf16 v[32:35], v[196:199], v[16:19], 0
    v_mfma_f32_16x16x32_bf16 v[36:39], v[204:207], v[16:19], 0
    s_waitcnt lgkmcnt(0)
    v_mfma_f32_16x16x32_bf16 v[32:35], v[200:203], v[20:23], v[32:35]
    v_mfma_f32_16x16x32_bf16 v[36:39], v[208:211], v[20:23], v[36:39]
    v_mfma_f32_16x16x32_bf16 v[40:43], v[212:215], v[16:19], 0
    v_mfma_f32_16x16x32_bf16 v[44:47], v[220:223], v[16:19], 0
    v_mfma_f32_16x16x32_bf16 v[40:43], v[216:219], v[20:23], v[40:43]
    v_mfma_f32_16x16x32_bf16 v[44:47], v[224:227], v[20:23], v[44:47]
    s_cmp_ge_u32 s3, 4
    s_cbranch_scc1 F_T4
    v_mfma_f32_16x16x32_bf16 v[48:51], v[228:231], v[16:19], 0
    v_mfma_f32_16x16x32_bf16 v[48:51], v[232:235], v[20:23], v[48:51]
    v_cndmask_b32 v32, v36, v32, s[60:61]
    v_cndmask_b32 v33, v37, v33, s[60:61]
    v_cndmask_b32 v34, v38, v34, s[60:61]
    v_cndmask_b32 v35, v39, v35, s[60:61]
    v_and_or_b32 v32, v32, v246, v245
    v_and_or_b32 v33, v33, v246, v245
    v_and_or_b32 v34, v34, v246, v245
    v_and_or_b32 v35, v35, v246, v245
    buffer_store_dwordx4 v[32:35], v243, s[32:35], s62 offen sc1
    v_cndmask_b32 v40, v44, v40, s[60:61]
    v_cndmask_b32 v41, v45, v41, s[60:61]
    v_cndmask_b32 v42, v46, v42, s[60:61]
    v_cndmask_b32 v43, v47, v43, s[60:61]
    v_and_or_b32 v40, v40, v246, v245
    v_and_or_b32 v41, v41, v246, v245
    v_and_or_b32 v42, v42, v246, v245
    v_and_or_b32 v43, v43, v246, v245
    buffer_store_dwordx4 v[40:43], v243, s[32:35], s54 offen sc1
    v_and_or_b32 v48, v48, v246, v245
    v_and_or_b32 v49, v49, v246, v245
    v_and_or_b32 v50, v50, v246, v245
    v_and_or_b32 v51, v51, v246, v245
    s_mov_b64 exec, s[60:61]
    buffer_store_dwordx4 v[48:51], v243, s[32:35], s55 offen sc1
    s_branch DUMP
F_SLOW:
    s_lshl_b32 s46, s3, 5
    s_add_u32 s46, s46, 100864
    v_mov_b32 v97, s46
    s_mov_b32 s47, 0
F_SL1:
    v_mov_b32 v98, v76
    s_nop 1
    v_max_u32_dpp v98, v98, v98 row_ror:8 row_mask:0xf bank_mask:0xf
    s_nop 1
    v_max_u32_dpp v98, v98, v98 row_ror:4 row_mask:0xf bank_mask:0xf
    s_nop 1
    v_max_u32_dpp v98, v98, v98 row_ror:2 row_mask:0xf bank_mask:0xf
    s_nop 1
    v_max_u32_dpp v98, v98, v98 row_ror:1 row_mask:0xf bank_mask:0xf
    v_mov_b32 v99, v98
    s_nop 1
    v_permlane16_swap_b32 v98, v99
    v_max_u32 v98, v98, v99
    v_mov_b32 v99, v98
    s_nop 1
    v_permlane32_swap_b32 v98, v99
    v_max_u32 v98, v98, v99
    ds_write_b32 v97, v98
    v_cmp_eq_u32 vcc, v98, v76
    v_add_u32 v97, 4, v97
    s_nop 0
    v_cndmask_b32 v76, v76, v77, vcc
    v_cndmask_b32 v77, v77, v78, vcc
    v_cndmask_b32 v78, v78, v79, vcc
    v_cndmask_b32 v79, v79, v68, vcc
    s_add_u32 s47, s47, 1
    s_cmp_lt_u32 s47, 8
    s_cbranch_scc1 F_SL1
    v_lshlrev_b32 v98, 2, v1
    v_add_u32 v98, 100864, v98
    s_waitcnt lgkmcnt(0)
    s_barrier
    ds_read_b32 v96, v98
    ds_write_b32 v109, v68 offset:32
    v_mov_b32 v115, 0
    s_mov_b64 s[4:5], -1
    s_waitcnt lgkmcnt(0)
F_SL2:
    s_ff1_i32_b64 s46, s[4:5]
    s_and_b32 s46, s46, 63
    v_readlane_b32 s49, v96, s46
    s_nop 1
    v_cmp_lt_u32 vcc, s49, v96
    s_bitset0_b64 s[4:5], s46
    s_bcnt1_i32_b64 s47, vcc
    s_cmp_eq_u32 s47, s3
    s_cbranch_scc1 F_SEL
    s_and_b64 s[6:7], s[4:5], vcc
    s_andn2_b64 s[4:5], s[4:5], vcc
    s_cmp_gt_u32 s47, s3
    s_cselect_b64 s[4:5], s[6:7], s[4:5]
    s_cmp_lg_u64 s[4:5], 0
    s_cbranch_scc1 F_SL2
    s_branch F_SEL
F_T4:
    s_nop 1
    v_cndmask_b32 v32, v36, v32, s[60:61]
    v_cndmask_b32 v33, v37, v33, s[60:61]
    v_cndmask_b32 v34, v38, v34, s[60:61]
    v_cndmask_b32 v35, v39, v35, s[60:61]
    v_and_or_b32 v32, v32, v246, v245
    v_and_or_b32 v33, v33, v246, v245
    v_and_or_b32 v34, v34, v246, v245
    v_and_or_b32 v35, v35, v246, v245
    buffer_store_dwordx4 v[32:35], v243, s[32:35], s62 offen sc1
    v_cndmask_b32 v40, v44, v40, s[60:61]
    v_cndmask_b32 v41, v45, v41, s[60:61]
    v_cndmask_b32 v42, v46, v42, s[60:61]
    v_cndmask_b32 v43, v47, v43, s[60:61]
    v_and_or_b32 v40, v40, v246, v245
    v_and_or_b32 v41, v41, v246, v245
    v_and_or_b32 v42, v42, v246, v245
    v_and_or_b32 v43, v43, v246, v245
    buffer_store_dwordx4 v[40:43], v243, s[32:35], s54 offen sc1
DUMP:
END:
    s_endpgm
.p2align 7
.type TBL,@object
TBL:
.long 0x0, 0x0, 0x0, 0x0, 0x0, 0x0, 0x0, 0x0
.long 0x0, 0x0, 0x0, 0x0, 0x0, 0x0, 0x0, 0x0
.long 0x0, 0x0, 0x0, 0x0, 0x0, 0x0, 0x0, 0x0
.long 0x0, 0x0, 0x0, 0x0, 0x0, 0x0, 0x0, 0x0
.long 0x0, 0x0, 0x0, 0x0, 0x0, 0x0, 0x0, 0x0
.long 0x0, 0x0, 0x0, 0x0, 0x0, 0x0, 0x0, 0x0
.long 0x0, 0x0, 0x0, 0x0, 0x0, 0x0, 0x0, 0x0
.long 0x0, 0x0, 0x0, 0x0, 0x0, 0x0, 0x0, 0x0
.long 0x0, 0x3c000000, 0x3c003c00, 0x0, 0x0, 0x0, 0x3c003c00, 0x3c00
.long 0x0, 0x0, 0x3c000000, 0x3c003c00, 0x0, 0x0, 0x0, 0x3c003c00
.long 0x0, 0x0, 0x0, 0x3c000000, 0x0, 0x0, 0x0, 0x0
.long 0x0, 0x0, 0x0, 0x0, 0x0, 0x0, 0x0, 0x0
.long 0x0, 0x0, 0x0, 0x0, 0x0, 0x0, 0x0, 0x0
.long 0x0, 0x0, 0x0, 0x0, 0x0, 0x0, 0x0, 0x0
.long 0x0, 0x0, 0x0, 0x0, 0x0, 0x0, 0x0, 0x0
.long 0x0, 0x0, 0x0, 0x0, 0x0, 0x0, 0x0, 0x0
.long 0x0, 0x0, 0x0, 0x0, 0x0, 0x0, 0x0, 0x0
.long 0x0, 0x0, 0x0, 0x0, 0x3c00, 0x0, 0x0, 0x0
.long 0x3c003c00, 0x0, 0x0, 0x0, 0x3c003c00, 0x3c00, 0x0, 0x0
.long 0x3c000000, 0x3c003c00, 0x0, 0x0, 0x0, 0x3c003c00, 0x3c00, 0x0
.long 0x0, 0x3c000000, 0x3c003c00, 0x0, 0x0, 0x0, 0x3c003c00, 0x3c00
.long 0x0, 0x0, 0x3c000000, 0x3c003c00, 0x0, 0x0, 0x0, 0x3c003c00
.long 0x0, 0x0, 0x0, 0x3c000000, 0x0, 0x0, 0x0, 0x0
.long 0x0, 0x0, 0x0, 0x0, 0x0, 0x0, 0x0, 0x0
.long 0x0, 0x0, 0x0, 0x0, 0x0, 0x0, 0x0, 0x0
.long 0x0, 0x0, 0x0, 0x0, 0x0, 0x0, 0x0, 0x0
.long 0x0, 0x0, 0x0, 0x0, 0x0, 0x0, 0x0, 0x0
.long 0x0, 0x0, 0x0, 0x0, 0x0, 0x0, 0x0, 0x0
.long 0x0, 0x0, 0x0, 0x0, 0x0, 0x0, 0x0, 0x0
.long 0x0, 0x0, 0x0, 0x0, 0x3c00, 0x0, 0x0, 0x0
.long 0x3c003c00, 0x0, 0x0, 0x0, 0x3c003c00, 0x3c00, 0x0, 0x0
.long 0x3c000000, 0x3c003c00, 0x0, 0x0, 0x0, 0x3c003c00, 0x3c00, 0x0
.long 0x0, 0x0, 0x0, 0x3c003c00, 0x0, 0x0, 0x0, 0x3c000000
.long 0x0, 0x0, 0x0, 0x0, 0x0, 0x0, 0x0, 0x0
.long 0x0, 0x0, 0x0, 0x0, 0x0, 0x0, 0x0, 0x0
.long 0x0, 0x0, 0x0, 0x0, 0x0, 0x0, 0x0, 0x0
.long 0x0, 0x0, 0x0, 0x0, 0x0, 0x0, 0x0, 0x0
.long 0x0, 0x0, 0x0, 0x0, 0x0, 0x0, 0x0, 0x0
.long 0x0, 0x0, 0x0, 0x0, 0x0, 0x0, 0x0, 0x0
.long 0x0, 0x0, 0x0, 0x0, 0x0, 0x0, 0x0, 0x0
.long 0x3c003c00, 0x3c00, 0x0, 0x0, 0x3c003c00, 0x3c003c00, 0x0, 0x0
.long 0x3c003c00, 0x3c003c00, 0x3c00, 0x0, 0x3c000000, 0x3c003c00, 0x3c003c00, 0x0
.long 0x0, 0x3c003c00, 0x3c003c00, 0x3c00, 0x0, 0x3c000000, 0x3c003c00, 0x3c003c00
.long 0x0, 0x0, 0x3c003c00, 0x3c003c00, 0x0, 0x0, 0x3c000000, 0x3c003c00
.long 0x0, 0x0, 0x0, 0x3c003c00, 0x0, 0x0, 0x0, 0x3c000000
.long 0x0, 0x0, 0x0, 0x0, 0x0, 0x0, 0x0, 0x0
.long 0x0, 0x0, 0x0, 0x0, 0x0, 0x0, 0x0, 0x0
.long 0x0, 0x0, 0x0, 0x0, 0x0, 0x0, 0x0, 0x0
.long 0x0, 0x0, 0x0, 0x0, 0x0, 0x0, 0x0, 0x0
.long 0x0, 0x0, 0x0, 0x0, 0x0, 0x0, 0x0, 0x0
.long 0x0, 0x0, 0x0, 0x0, 0x0, 0x0, 0x0, 0x0
.long 0x3c00, 0x0, 0x0, 0x0, 0x3c003c00, 0x0, 0x0, 0x0
.long 0x3c003c00, 0x3c00, 0x0, 0x0, 0x3c003c00, 0x3c003c00, 0x0, 0x0
.long 0x3c003c00, 0x3c003c00, 0x3c00, 0x0, 0x3c000000, 0x3c003c00, 0x3c003c00, 0x0
.long 0x0, 0x3c003c00, 0x3c003c00, 0x3c00, 0x0, 0x3c000000, 0x3c003c00, 0x3c003c00
.long 0x0, 0x0, 0x3c003c00, 0x3c003c00, 0x0, 0x0, 0x3c000000, 0x3c003c00
.long 0x0, 0x0, 0x0, 0x0, 0x0, 0x0, 0x0, 0x0
.long 0x0, 0x0, 0x0, 0x0, 0x0, 0x0, 0x0, 0x0
.long 0x0, 0x0, 0x0, 0x0, 0x0, 0x0, 0x0, 0x0
.long 0x0, 0x0, 0x0, 0x0, 0x0, 0x0, 0x0, 0x0
.long 0x0, 0x0, 0x0, 0x0, 0x0, 0x0, 0x0, 0x0
.long 0x0, 0x0, 0x0, 0x0, 0x0, 0x0, 0x0, 0x0
.long 0x0, 0x0, 0x0, 0x0, 0x0, 0x0, 0x0, 0x0
.long 0x3c00, 0x0, 0x0, 0x0, 0x3c003c00, 0x0, 0x0, 0x0
.long 0x0, 0x3c000000, 0x3c003c00, 0x0, 0x0, 0x0, 0x3c003c00, 0x3c00
.long 0x0, 0x0, 0x3c000000, 0x3c003c00, 0x0, 0x0, 0x0, 0x3c003c00
.long 0x0, 0x0, 0x0, 0x3c000000, 0x0, 0x0, 0x0, 0x0
.long 0x0, 0x0, 0x0, 0x0, 0x0, 0x0, 0x0, 0x0
.long 0x0, 0x0, 0x0, 0x0, 0x0, 0x0, 0x0, 0x0
.long 0x0, 0x0, 0x0, 0x0, 0x0, 0x0, 0x0, 0x0
.long 0x0, 0x0, 0x0, 0x0, 0x0, 0x0, 0x0, 0x0
.long 0x0, 0x0, 0x0, 0x0, 0x0, 0x0, 0x0, 0x0
.long 0x0, 0x0, 0x0, 0x0, 0x0, 0x0, 0x0, 0x0
.long 0x0, 0x0, 0x0, 0x0, 0x3c00, 0x0, 0x0, 0x0
.long 0x3c003c00, 0x0, 0x0, 0x0, 0x3c003c00, 0x3c00, 0x0, 0x0
.long 0x3c000000, 0x3c003c00, 0x0, 0x0, 0x0, 0x3c003c00, 0x3c00, 0x0
.long 0x0, 0x3c000000, 0x3c003c00, 0x0, 0x0, 0x0, 0x3c003c00, 0x3c00
.long 0x0, 0x0, 0x3c000000, 0x3c003c00, 0x0, 0x0, 0x0, 0x3c003c00
.long 0x0, 0x0, 0x0, 0x3c000000, 0x0, 0x0, 0x0, 0x0
.long 0x0, 0x0, 0x0, 0x0, 0x0, 0x0, 0x0, 0x0
.long 0x0, 0x0, 0x0, 0x0, 0x0, 0x0, 0x0, 0x0
.long 0x0, 0x0, 0x0, 0x0, 0x0, 0x0, 0x0, 0x0
.long 0x0, 0x0, 0x0, 0x0, 0x0, 0x0, 0x0, 0x0
.long 0x0, 0x0, 0x0, 0x0, 0x0, 0x0, 0x0, 0x0
.long 0x0, 0x0, 0x0, 0x0, 0x0, 0x0, 0x0, 0x0
.long 0x0, 0x0, 0x0, 0x0, 0x3c00, 0x0, 0x0, 0x0
.long 0x3c003c00, 0x0, 0x0, 0x0, 0x3c003c00, 0x3c00, 0x0, 0x0
.long 0x3c000000, 0x3c003c00, 0x0, 0x0, 0x0, 0x3c003c00, 0x3c00, 0x0
.long 0x0, 0x0, 0x0, 0x0, 0x0, 0x0, 0x0, 0x0
.long 0x0, 0x0, 0x0, 0x0, 0x0, 0x0, 0x0, 0x0
.long 0x0, 0x0, 0x0, 0x0, 0x0, 0x0, 0x0, 0x0
.long 0x0, 0x0, 0x0, 0x0, 0x0, 0x0, 0x0, 0x0
.long 0x0, 0x0, 0x0, 0x0, 0x0, 0x0, 0x0, 0x0
.long 0x0, 0x0, 0x0, 0x0, 0x0, 0x0, 0x0, 0x0
.long 0x0, 0x0, 0x0, 0x0, 0x0, 0x0, 0x0, 0x0
.long 0x0, 0x0, 0x0, 0x0, 0x0, 0x0, 0x0, 0x0
.long 0x0, 0x0, 0x0, 0x3c003c00, 0x0, 0x0, 0x0, 0x3c000000
.long 0x0, 0x0, 0x0, 0x0, 0x0, 0x0, 0x0, 0x0
.long 0x0, 0x0, 0x0, 0x0, 0x0, 0x0, 0x0, 0x0
.long 0x0, 0x0, 0x0, 0x0, 0x0, 0x0, 0x0, 0x0
.long 0x0, 0x0, 0x0, 0x0, 0x0, 0x0, 0x0, 0x0
.long 0x0, 0x0, 0x0, 0x0, 0x0, 0x0, 0x0, 0x0
.long 0x0, 0x0, 0x0, 0x0, 0x0, 0x0, 0x0, 0x0
.long 0x0, 0x0, 0x0, 0x0, 0x0, 0x0, 0x0, 0x0
.long 0x3c003c00, 0x3c00, 0x0, 0x0, 0x3c003c00, 0x3c003c00, 0x0, 0x0
.long 0x3c003c00, 0x3c003c00, 0x3c00, 0x0, 0x3c000000, 0x3c003c00, 0x3c003c00, 0x0
.long 0x0, 0x3c003c00, 0x3c003c00, 0x3c00, 0x0, 0x3c000000, 0x3c003c00, 0x3c003c00
.long 0x0, 0x0, 0x3c003c00, 0x3c003c00, 0x0, 0x0, 0x3c000000, 0x3c003c00
.long 0x0, 0x0, 0x0, 0x3c003c00, 0x0, 0x0, 0x0, 0x3c000000
.long 0x0, 0x0, 0x0, 0x0, 0x0, 0x0, 0x0, 0x0
.long 0x0, 0x0, 0x0, 0x0, 0x0, 0x0, 0x0, 0x0
.long 0x0, 0x0, 0x0, 0x0, 0x0, 0x0, 0x0, 0x0
.long 0x0, 0x0, 0x0, 0x0, 0x0, 0x0, 0x0, 0x0
.long 0x0, 0x0, 0x0, 0x0, 0x0, 0x0, 0x0, 0x0
.long 0x0, 0x0, 0x0, 0x0, 0x0, 0x0, 0x0, 0x0
.long 0x3c00, 0x0, 0x0, 0x0, 0x3c003c00, 0x0, 0x0, 0x0
.long 0x3c003c00, 0x3c00, 0x0, 0x0, 0x3c003c00, 0x3c003c00, 0x0, 0x0
.long 0x3c003c00, 0x3c003c00, 0x3c00, 0x0, 0x3c000000, 0x3c003c00, 0x3c003c00, 0x0
.long 0x0, 0x3c003c00, 0x3c003c00, 0x3c00, 0x0, 0x3c000000, 0x3c003c00, 0x3c003c00
.long 0x0, 0x0, 0x3c003c00, 0x3c003c00, 0x0, 0x0, 0x3c000000, 0x3c003c00
.long 0x0, 0x0, 0x0, 0x0, 0x0, 0x0, 0x0, 0x0
.long 0x0, 0x0, 0x0, 0x0, 0x0, 0x0, 0x0, 0x0
.long 0x0, 0x0, 0x0, 0x0, 0x0, 0x0, 0x0, 0x0
.long 0x0, 0x0, 0x0, 0x0, 0x0, 0x0, 0x0, 0x0
.long 0x0, 0x0, 0x0, 0x0, 0x0, 0x0, 0x0, 0x0
.long 0x0, 0x0, 0x0, 0x0, 0x0, 0x0, 0x0, 0x0
.long 0x0, 0x0, 0x0, 0x0, 0x0, 0x0, 0x0, 0x0
.long 0x3c00, 0x0, 0x0, 0x0, 0x3c003c00, 0x0, 0x0, 0x0
.long 0x0, 0x0, 0x3c000000, 0x3c003c00, 0x0, 0x0, 0x0, 0x3c003c00
.long 0x0, 0x0, 0x0, 0x3c000000, 0x0, 0x0, 0x0, 0x0
.long 0x0, 0x0, 0x0, 0x0, 0x0, 0x0, 0x0, 0x0
.long 0x0, 0x0, 0x0, 0x0, 0x0, 0x0, 0x0, 0x0
.long 0x0, 0x0, 0x0, 0x0, 0x0, 0x0, 0x0, 0x0
.long 0x0, 0x0, 0x0, 0x0, 0x0, 0x0, 0x0, 0x0
.long 0x0, 0x0, 0x0, 0x0, 0x0, 0x0, 0x0, 0x0
.long 0x0, 0x0, 0x0, 0x0, 0x0, 0x0, 0x0, 0x0
.long 0x3c003c00, 0x3c003c00, 0x0, 0x0, 0x3c003c00, 0x3c003c00, 0x3c00, 0x0
.long 0x3c003c00, 0x3c003c00, 0x3c003c00, 0x0, 0x3c003c00, 0x3c003c00, 0x3c003c00, 0x3c00
.long 0x3c000000, 0x3c003c00, 0x3c003c00, 0x3c003c00, 0x0, 0x3c003c00, 0x3c003c00, 0x3c003c00
.long 0x0, 0x3c000000, 0x3c003c00, 0x3c003c00, 0x0, 0x0, 0x3c003c00, 0x3c003c00
.long 0x0, 0x0, 0x3c000000, 0x3c003c00, 0x0, 0x0, 0x0, 0x3c003c00
.long 0x0, 0x0, 0x0, 0x3c000000, 0x0, 0x0, 0x0, 0x0
.long 0x0, 0x0, 0x0, 0x0, 0x0, 0x0, 0x0, 0x0
.long 0x0, 0x0, 0x0, 0x0, 0x0, 0x0, 0x0, 0x0
.long 0x0, 0x0, 0x0, 0x0, 0x0, 0x0, 0x0, 0x0
.long 0x0, 0x0, 0x0, 0x0, 0x0, 0x0, 0x0, 0x0
.long 0x0, 0x0, 0x0, 0x0, 0x3c00, 0x0, 0x0, 0x0
.long 0x3c003c00, 0x0, 0x0, 0x0, 0x3c003c00, 0x3c00, 0x0, 0x0
.long 0x3c003c00, 0x3c003c00, 0x0, 0x0, 0x3c003c00, 0x3c003c00, 0x3c00, 0x0
.long 0x3c003c00, 0x3c003c00, 0x3c003c00, 0x0, 0x3c003c00, 0x3c003c00, 0x3c003c00, 0x3c00
.long 0x3c000000, 0x3c003c00, 0x3c003c00, 0x3c003c00, 0x0, 0x3c003c00, 0x3c003c00, 0x3c003c00
.long 0x0, 0x3c000000, 0x3c003c00, 0x3c003c00, 0x0, 0x0, 0x3c003c00, 0x3c003c00
.long 0x0, 0x0, 0x0, 0x0, 0x0, 0x0, 0x0, 0x0
.long 0x0, 0x0, 0x0, 0x0, 0x0, 0x0, 0x0, 0x0
.long 0x0, 0x0, 0x0, 0x0, 0x0, 0x0, 0x0, 0x0
.long 0x0, 0x0, 0x0, 0x0, 0x0, 0x0, 0x0, 0x0
.long 0x0, 0x0, 0x0, 0x0, 0x0, 0x0, 0x0, 0x0
.long 0x0, 0x0, 0x0, 0x0, 0x0, 0x0, 0x0, 0x0
.long 0x0, 0x0, 0x0, 0x0, 0x3c00, 0x0, 0x0, 0x0
.long 0x3c003c00, 0x0, 0x0, 0x0, 0x3c003c00, 0x3c00, 0x0, 0x0
.long 0x0, 0x0, 0x3c003c00, 0x3c003c00, 0x0, 0x0, 0x3c000000, 0x3c003c00
.long 0x0, 0x0, 0x0, 0x3c003c00, 0x0, 0x0, 0x0, 0x3c000000
.long 0x0, 0x0, 0x0, 0x0, 0x0, 0x0, 0x0, 0x0
.long 0x0, 0x0, 0x0, 0x0, 0x0, 0x0, 0x0, 0x0
.long 0x0, 0x0, 0x0, 0x0, 0x0, 0x0, 0x0, 0x0
.long 0x0, 0x0, 0x0, 0x0, 0x0, 0x0, 0x0, 0x0
.long 0x0, 0x0, 0x0, 0x0, 0x0, 0x0, 0x0, 0x0
.long 0x0, 0x0, 0x0, 0x0, 0x0, 0x0, 0x0, 0x0
.long 0x3c003c00, 0x3c003c00, 0x3c00, 0x0, 0x3c003c00, 0x3c003c00, 0x3c003c00, 0x0
.long 0x3c003c00, 0x3c003c00, 0x3c003c00, 0x3c00, 0x3c003c00, 0x3c003c00, 0x3c003c00, 0x3c003c00
.long 0x3c003c00, 0x3c003c00, 0x3c003c00, 0x3c003c00, 0x3c000000, 0x3c003c00, 0x3c003c00, 0x3c003c00
.long 0x0, 0x3c003c00, 0x3c003c00, 0x3c003c00, 0x0, 0x3c000000, 0x3c003c00, 0x3c003c00
.long 0x0, 0x0, 0x3c003c00, 0x3c003c00, 0x0, 0x0, 0x3c000000, 0x3c003c00
.long 0x0, 0x0, 0x0, 0x3c003c00, 0x0, 0x0, 0x0, 0x3c000000
.long 0x0, 0x0, 0x0, 0x0, 0x0, 0x0, 0x0, 0x0
.long 0x0, 0x0, 0x0, 0x0, 0x0, 0x0, 0x0, 0x0
.long 0x0, 0x0, 0x0, 0x0, 0x0, 0x0, 0x0, 0x0
.long 0x0, 0x0, 0x0, 0x0, 0x0, 0x0, 0x0, 0x0
.long 0x3c00, 0x0, 0x0, 0x0, 0x3c003c00, 0x0, 0x0, 0x0
.long 0x3c003c00, 0x3c00, 0x0, 0x0, 0x3c003c00, 0x3c003c00, 0x0, 0x0
.long 0x3c003c00, 0x3c003c00, 0x3c00, 0x0, 0x3c003c00, 0x3c003c00, 0x3c003c00, 0x0
.long 0x3c003c00, 0x3c003c00, 0x3c003c00, 0x3c00, 0x3c003c00, 0x3c003c00, 0x3c003c00, 0x3c003c00
.long 0x3c003c00, 0x3c003c00, 0x3c003c00, 0x3c003c00, 0x3c000000, 0x3c003c00, 0x3c003c00, 0x3c003c00
.long 0x0, 0x3c003c00, 0x3c003c00, 0x3c003c00, 0x0, 0x3c000000, 0x3c003c00, 0x3c003c00
.long 0x0, 0x0, 0x0, 0x0, 0x0, 0x0, 0x0, 0x0
.long 0x0, 0x0, 0x0, 0x0, 0x0, 0x0, 0x0, 0x0
.long 0x0, 0x0, 0x0, 0x0, 0x0, 0x0, 0x0, 0x0
.long 0x0, 0x0, 0x0, 0x0, 0x0, 0x0, 0x0, 0x0
.long 0x0, 0x0, 0x0, 0x0, 0x0, 0x0, 0x0, 0x0
.long 0x0, 0x0, 0x0, 0x0, 0x0, 0x0, 0x0, 0x0
.long 0x3c00, 0x0, 0x0, 0x0, 0x3c003c00, 0x0, 0x0, 0x0
.long 0x3c003c00, 0x3c00, 0x0, 0x0, 0x3c003c00, 0x3c003c00, 0x0, 0x0
.long 0x0, 0x0, 0x0, 0x0, 0x0, 0x0, 0x0, 0x0
.long 0x0, 0x0, 0x0, 0x0, 0x0, 0x0, 0x0, 0x0
.long 0x0, 0x0, 0x0, 0x0, 0x0, 0x0, 0x0, 0x0
.long 0x0, 0x0, 0x0, 0x0, 0x0, 0x0, 0x0, 0x0
.long 0x0, 0x0, 0x0, 0x0, 0x0, 0x0, 0x0, 0x0
.long 0x0, 0x0, 0x0, 0x0, 0x0, 0x0, 0x0, 0x0
.long 0x0, 0x0, 0x0, 0x0, 0x0, 0x0, 0x0, 0x0
.long 0x0, 0x0, 0x0, 0x0, 0x0, 0x0, 0x0, 0x0
.long 0x0, 0x0, 0xffffffff, 0x0, 0x0, 0x0, 0xffff0000, 0xffff
.long 0x0, 0x0, 0x0, 0xffffffff, 0x0, 0x0, 0x0, 0xffff0000
.long 0x0, 0x0, 0x0, 0x0, 0x0, 0x0, 0x0, 0x0
.long 0x0, 0x0, 0x0, 0x0, 0x0, 0x0, 0x0, 0x0
.long 0x0, 0x0, 0x0, 0x0, 0x0, 0x0, 0x0, 0x0
.long 0x0, 0x0, 0x0, 0x0, 0x0, 0x0, 0x0, 0x0
.long 0x0, 0x0, 0x0, 0x0, 0x0, 0x0, 0x0, 0x0
.long 0x0, 0x0, 0x0, 0x0, 0x0, 0x0, 0x0, 0x0
.long 0x0, 0x0, 0x0, 0x0, 0x0, 0x0, 0x0, 0x0
.long 0x0, 0x0, 0x0, 0x0, 0xffff, 0x0, 0x0, 0x0
.long 0xffffffff, 0x0, 0x0, 0x0, 0xffff0000, 0xffff, 0x0, 0x0
.long 0x0, 0xffffffff, 0x0, 0x0, 0x0, 0xffff0000, 0xffff, 0x0
.long 0x0, 0x0, 0xffffffff, 0x0, 0x0, 0x0, 0xffff0000, 0xffff
.long 0x0, 0x0, 0x0, 0xffffffff, 0x0, 0x0, 0x0, 0xffff0000
.long 0x0, 0x0, 0x0, 0x0, 0x0, 0x0, 0x0, 0x0
.long 0x0, 0x0, 0x0, 0x0, 0x0, 0x0, 0x0, 0x0
.long 0x0, 0x0, 0x0, 0x0, 0x0, 0x0, 0x0, 0x0
.long 0x0, 0x0, 0x0, 0x0, 0x0, 0x0, 0x0, 0x0
.long 0x0, 0x0, 0x0, 0x0, 0x0, 0x0, 0x0, 0x0
.long 0x0, 0x0, 0x0, 0x0, 0x0, 0x0, 0x0, 0x0
.long 0x0, 0x0, 0x0, 0x0, 0x0, 0x0, 0x0, 0x0
.long 0x0, 0x0, 0x0, 0x0, 0xffff, 0x0, 0x0, 0x0
.long 0xffffffff, 0x0, 0x0, 0x0, 0xffff0000, 0xffff, 0x0, 0x0
.long 0x0, 0xffffffff, 0x0, 0x0, 0x0, 0xffff0000, 0xffff, 0x0
.long 0x878, 0x438, 0x230, 0x238, 0x858, 0x418, 0x210, 0x218
.long 0x838, 0x3f8, 0x1f0, 0x1f8, 0x818, 0x3d8, 0x1d0, 0x1d8
.long 0x7f8, 0x3b8, 0x1b0, 0x1b8, 0x7d8, 0x398, 0x190, 0x198
.long 0x7b8, 0x378, 0x170, 0x178, 0x798, 0x358, 0x150, 0x158
.long 0x778, 0x338, 0x130, 0x138, 0x758, 0x318, 0x110, 0x118
.long 0x738, 0x2f8, 0xf0, 0xf8, 0x718, 0x2d8, 0xd0, 0xd8
.long 0x6f8, 0x2b8, 0xb0, 0xb8, 0x6d8, 0x298, 0x90, 0x98
.long 0x6b8, 0x278, 0x70, 0x78, 0x698, 0x258, 0x50, 0x58
.long 0x868, 0x428, 0x220, 0x228, 0x848, 0x408, 0x200, 0x208
.long 0x828, 0x3e8, 0x1e0, 0x1e8, 0x808, 0x3c8, 0x1c0, 0x1c8
.long 0x7e8, 0x3a8, 0x1a0, 0x1a8, 0x7c8, 0x388, 0x180, 0x188
.long 0x7a8, 0x368, 0x160, 0x168, 0x788, 0x348, 0x140, 0x148
.long 0x768, 0x328, 0x120, 0x128, 0x748, 0x308, 0x100, 0x108
.long 0x728, 0x2e8, 0xe0, 0xe8, 0x708, 0x2c8, 0xc0, 0xc8
.long 0x6e8, 0x2a8, 0xa0, 0xa8, 0x6c8, 0x288, 0x80, 0x88
.long 0x6a8, 0x268, 0x60, 0x68, 0x688, 0x248, 0x40, 0x48
.long 0x870, 0x430, 0x90c, 0x94c, 0x850, 0x410, 0x908, 0x948
.long 0x830, 0x3f0, 0x904, 0x944, 0x810, 0x3d0, 0x900, 0x940
.long 0x7f0, 0x3b0, 0x8fc, 0x93c, 0x7d0, 0x390, 0x8f8, 0x938
.long 0x7b0, 0x370, 0x8f4, 0x934, 0x790, 0x350, 0x8f0, 0x930
.long 0x770, 0x330, 0x8ec, 0x92c, 0x750, 0x310, 0x8e8, 0x928
.long 0x730, 0x2f0, 0x8e4, 0x924, 0x710, 0x2d0, 0x8e0, 0x920
.long 0x6f0, 0x2b0, 0x8dc, 0x91c, 0x6d0, 0x290, 0x8d8, 0x918
.long 0x6b0, 0x270, 0x8d4, 0x914, 0x690, 0x250, 0x8d0, 0x910
.long 0x860, 0x420, 0x9cc, 0xa0c, 0x840, 0x400, 0x9c8, 0xa08
.long 0x820, 0x3e0, 0x9c4, 0xa04, 0x800, 0x3c0, 0x9c0, 0xa00
.long 0x7e0, 0x3a0, 0x9bc, 0x9fc, 0x7c0, 0x380, 0x9b8, 0x9f8
.long 0x7a0, 0x360, 0x9b4, 0x9f4, 0x780, 0x340, 0x9b0, 0x9f0
.long 0x760, 0x320, 0x9ac, 0x9ec, 0x740, 0x300, 0x9a8, 0x9e8
.long 0x720, 0x2e0, 0x9a4, 0x9e4, 0x700, 0x2c0, 0x9a0, 0x9e0
.long 0x6e0, 0x2a0, 0x99c, 0x9dc, 0x6c0, 0x280, 0x998, 0x9d8
.long 0x6a0, 0x260, 0x994, 0x9d4, 0x680, 0x240, 0x990, 0x9d0
.long 0x22c, 0x670, 0xb90, 0x23e, 0x20c, 0x650, 0xb90, 0xb90
.long 0x1ec, 0x630, 0xb90, 0xb90, 0x1cc, 0x610, 0xb90, 0xb90
.long 0x1ac, 0x5f0, 0xb90, 0xb90, 0x18c, 0x5d0, 0xb90, 0xb90
.long 0x16c, 0x5b0, 0xb90, 0xb90, 0x14c, 0x590, 0xb90, 0xb90
.long 0x12c, 0x570, 0xb90, 0xb90, 0x10c, 0x550, 0xb90, 0xb90
.long 0xec, 0x530, 0xb90, 0xb90, 0xcc, 0x510, 0xb90, 0xb90
.long 0xac, 0x4f0, 0xb90, 0xb90, 0x8c, 0x4d0, 0xb90, 0xb90
.long 0x6c, 0x4b0, 0xb90, 0xb90, 0x4c, 0x490, 0xb90, 0xb90
.long 0x21c, 0x660, 0xb90, 0xb90, 0x1fc, 0x640, 0xb90, 0xb90
.long 0x1dc, 0x620, 0xb90, 0xb90, 0x1bc, 0x600, 0xb90, 0xb90
.long 0x19c, 0x5e0, 0xb90, 0xb90, 0x17c, 0x5c0, 0xb90, 0xb90
.long 0x15c, 0x5a0, 0xb90, 0xb90, 0x13c, 0x580, 0xb90, 0xb90
.long 0x11c, 0x560, 0xb90, 0xb90, 0xfc, 0x540, 0xb90, 0xb90
.long 0xdc, 0x520, 0xb90, 0xb90, 0xbc, 0x500, 0xb90, 0xb90
.long 0x9c, 0x4e0, 0xb90, 0xb90, 0x7c, 0x4c0, 0xb90, 0xb90
.long 0x5c, 0x4a0, 0xb90, 0xb90, 0x3c, 0x480, 0x47c, 0xb90
.long 0xb90, 0xb90, 0xb90, 0xb4c, 0xb90, 0xb90, 0xb90, 0xb48
.long 0xb90, 0xb90, 0xb90, 0xb44, 0xb90, 0xb90, 0xb90, 0xb40
.long 0xb90, 0xb90, 0xb90, 0xb3c, 0xb90, 0xb90, 0xb90, 0xb38
.long 0xb90, 0xb90, 0xb90, 0xb34, 0xb90, 0xb90, 0xb90, 0xb30
.long 0xb90, 0xb90, 0xb90, 0xb2c, 0xb90, 0xb90, 0xb90, 0xb28
.long 0xb90, 0xb90, 0xb90, 0xb24, 0xb90, 0xb90, 0xb90, 0xb20
.long 0xb90, 0xb90, 0xb90, 0xb1c, 0xb90, 0xb90, 0xb90, 0xb18
.long 0xb90, 0xb90, 0xb90, 0xb14, 0xb90, 0xb90, 0xb90, 0xb10
.long 0xb90, 0xb90, 0xb90, 0xb4e, 0xb90, 0xb90, 0xb90, 0xb4a
.long 0xb90, 0xb90, 0xb90, 0xb46, 0xb90, 0xb90, 0xb90, 0xb42
.long 0xb90, 0xb90, 0xb90, 0xb3e, 0xb90, 0xb90, 0xb90, 0xb3a
.long 0xb90, 0xb90, 0xb90, 0xb36, 0xb90, 0xb90, 0xb90, 0xb32
.long 0xb90, 0xb90, 0xb90, 0xb2e, 0xb90, 0xb90, 0xb90, 0xb2a
.long 0xb90, 0xb90, 0xb90, 0xb26, 0xb90, 0xb90, 0xb90, 0xb22
.long 0xb90, 0xb90, 0xb90, 0xb1e, 0xb90, 0xb90, 0xb90, 0xb1a
.long 0xb90, 0xb90, 0xb90, 0xb16, 0xb90, 0xb90, 0xb90, 0xb12
.long 0x23c, 0x880, 0xb90, 0x4200, 0xb90, 0xb90, 0xb90, 0x4c50
.long 0xb90, 0xb90, 0xb90, 0x4410, 0xb90, 0xb90, 0xb90, 0x5070
.long 0xb90, 0xb90, 0xb90, 0x5280, 0xb90, 0xb90, 0xb90, 0x4620
.long 0xb90, 0xb90, 0xb90, 0x5490, 0xb90, 0xb90, 0xb90, 0x4830
.long 0xb90, 0xb90, 0xb90, 0x6510, 0xb90, 0xb90, 0xb90, 0x6d50
.long 0xb90, 0xb90, 0xb90, 0x56a0, 0xb90, 0xb90, 0xb90, 0x4a40
.long 0xb90, 0xb90, 0xb90, 0x6720, 0xb90, 0xb90, 0xb90, 0x6b40
.long 0xb90, 0xb90, 0xb90, 0x6930, 0xb90, 0xb90, 0xb90, 0x58b0
.long 0xb90, 0xb90, 0xb90, 0x6300, 0xb90, 0xb90, 0xb90, 0x6300
.long 0xb90, 0xb90, 0xb90, 0x4e60, 0xb90, 0xb90, 0xb90, 0x4a40
.long 0xb90, 0xb90, 0xb90, 0x5ac0, 0xb90, 0xb90, 0xb90, 0x5cd0
.long 0xb90, 0xb90, 0xb90, 0x5ee0, 0xb90, 0xb90, 0xb90, 0x60f0
.long 0xb90, 0xb90, 0xb90, 0x4e60, 0xb90, 0xb90, 0xb90, 0x4200
.long 0xb90, 0xb90, 0xb90, 0x4c50, 0xb90, 0xb90, 0xb90, 0x4410
.long 0xb90, 0xb90, 0xb90, 0x5070, 0xb90, 0xb90, 0xb90, 0x5280
.long 0xb90, 0xb90, 0xb90, 0x4620, 0xb90, 0xb90, 0x3a, 0x5490
.long 0xb0c, 0xacc, 0xa8c, 0x4210, 0xb08, 0xac8, 0xa88, 0x4c60
.long 0xb04, 0xac4, 0xa84, 0x4420, 0xb00, 0xac0, 0xa80, 0x5080
.long 0xafc, 0xabc, 0xa7c, 0x5290, 0xaf8, 0xab8, 0xa78, 0x4630
.long 0xaf4, 0xab4, 0xa74, 0x54a0, 0xaf0, 0xab0, 0xa70, 0x4840
.long 0xaec, 0xaac, 0xa6c, 0x6520, 0xae8, 0xaa8, 0xa68, 0x6d60
.long 0xae4, 0xaa4, 0xa64, 0x56b0, 0xae0, 0xaa0, 0xa60, 0x4a50
.long 0xadc, 0xa9c, 0xa5c, 0x6730, 0xad8, 0xa98, 0xa58, 0x6b50
.long 0xad4, 0xa94, 0xa54, 0x6940, 0xad0, 0xa90, 0xa50, 0x58c0
.long 0xb0e, 0xace, 0xa8e, 0x6310, 0xb0a, 0xaca, 0xa8a, 0x6310
.long 0xb06, 0xac6, 0xa86, 0x4e70, 0xb02, 0xac2, 0xa82, 0x4a50
.long 0xafe, 0xabe, 0xa7e, 0x5ad0, 0xafa, 0xaba, 0xa7a, 0x5ce0
.long 0xaf6, 0xab6, 0xa76, 0x5ef0, 0xaf2, 0xab2, 0xa72, 0x6100
.long 0xaee, 0xaae, 0xa6e, 0x4e70, 0xaea, 0xaaa, 0xa6a, 0x4210
.long 0xae6, 0xaa6, 0xa66, 0x4c60, 0xae2, 0xaa2, 0xa62, 0x4420
.long 0xade, 0xa9e, 0xa5e, 0x5080, 0xada, 0xa9a, 0xa5a, 0x5290
.long 0xad6, 0xa96, 0xa56, 0x4630, 0xad2, 0xa92, 0xa52, 0x54a0
TBLEND:
.size TBL, .-TBL
.section .rodata,"a"
.p2align 6
.amdhsa_kernel sequential_preLN__ssm_conv_s4d__moe_arch_mod__prompt_kernel
  .amdhsa_next_free_vgpr 256
  .amdhsa_next_free_sgpr 102
  .amdhsa_accum_offset 256
  .amdhsa_group_segment_fixed_size 0
  .amdhsa_kernarg_size 120
  .amdhsa_user_sgpr_count 2
  .amdhsa_user_sgpr_kernarg_segment_ptr 1
  .amdhsa_system_sgpr_workgroup_id_x 1
.end_amdhsa_kernel
```

```asm
; @launch grid=(248,1,1) block=(512,1,1) lds=163840
.amdgcn_target "amdgcn-amd-amdhsa--gfx950"
.text
.globl sequential_preLN__ssm_conv_s4d__moe_arch_mod__prompt_kernel
.p2align 8
.type sequential_preLN__ssm_conv_s4d__moe_arch_mod__prompt_kernel,@function
sequential_preLN__ssm_conv_s4d__moe_arch_mod__prompt_kernel:
    s_cmp_ge_u32 s2, 248
    s_cbranch_scc1 END
    s_load_dwordx16 s[4:19], s[0:1], 0
    s_load_dwordx8 s[20:27], s[0:1], 64
    s_load_dwordx2 s[28:29], s[0:1], 96
    s_load_dwordx2 s[30:31], s[0:1], 112
    s_getpc_b64 s[42:43]
PC0:
    v_and_b32 v1, 63, v0
    v_lshrrev_b32 v14, 6, v0
    v_lshlrev_b32 v15, 7, v0
    v_readfirstlane_b32 s3, v14
    s_add_u32 s44, s42, TBL-PC0
    s_addc_u32 s45, s43, 0
    v_lshlrev_b32 v2, 4, v1
    v_lshlrev_b32 v3, 4, v0
    s_sub_u32 s50, s2, 192
    s_cmp_lt_u32 s50, 24
    s_cbranch_scc1 FROLE
    s_and_b32 s51, s3, 3
    s_lshr_b32 s46, s3, 2
    s_sub_u32 s49, s2, 120
    s_cmp_lt_u32 s2, 216
    s_cselect_b32 s49, 255, s49
    s_cmp_lt_u32 s2, 96
    s_cselect_b32 s49, s2, s49
    s_sub_u32 s38, s2, 96
    s_cmp_lt_u32 s49, 128
    s_cselect_b32 s38, s49, s38
    s_cselect_b32 s39, s46, 1
    s_lshl_b32 s48, s38, 1
    s_add_u32 s48, s48, s39
    s_lshl_b32 s48, s48, 3
    s_add_u32 s48, s48, s51
    s_mul_i32 s50, s48, 1152
    v_and_b32 v13, 31, v1
    v_lshrrev_b32 v15, 5, v1
    v_mul_u32_u24 v14, 4608, v15
    v_add_u32 v14, s50, v14
    v_lshlrev_b32 v12, 4, v13
    v_lshlrev_b32 v13, 2, v13
    v_add_u32 v4, v12, v14
    v_add_u32 v5, v13, v14
    s_cmp_ge_u32 s2, 216
    s_cselect_b32 s61, 0, s46
    s_lshl_b32 s52, s2, 2
    s_add_u32 s52, s52, s51
    s_lshl_b32 s53, s52, 8
    s_lshl_b32 s54, s46, 7
    s_add_u32 s53, s53, s54
    v_lshl_add_u32 v34, v1, 1, s53
    v_xor_b32 v35, 128, v34
    v_mov_b32 v28, 0
    v_mov_b32 v29, 0
    v_mov_b32 v30, 0
    v_mov_b32 v31, 0
    v_mov_b32 v32, 0
    v_mov_b32 v33, 0
    s_lshl_b32 s54, s2, 3
    s_cmp_lg_u32 s61, 0
    s_waitcnt lgkmcnt(0)
    s_cmp_lg_u32 s61, 0
    s_cbranch_scc1 C_NOX
    global_load_dwordx4 v[16:19], v4, s[4:5] nt
    global_load_dwordx4 v[20:23], v4, s[4:5] offset:512 nt
    global_load_dword v24, v5, s[4:5] offset:1024 nt
C_NOX:
    s_cmp_ge_u32 s2, 144
    s_cbranch_scc1 C_NOP
    s_load_dwordx2 s[56:57], s[14:15], s54
    global_load_short_d16_hi v28, v34, s[6:7] nt
    global_load_short_d16_hi v29, v34, s[8:9] nt
    global_load_short_d16_hi v30, v34, s[10:11] nt
    global_load_short_d16_hi v31, v34, s[12:13] nt
    global_load_short_d16_hi v32, v35, s[10:11] nt
    global_load_short_d16_hi v33, v35, s[12:13] nt
C_NOP:
    s_load_dword s40, s[30:31], 0
    s_mov_b32 s32, s30
    s_and_b32 s33, s31, 0xffff
    s_mov_b32 s34, 0x10000000
    s_mov_b32 s35, 0x00020000
    v_mov_b32 v6, 0x3f80
    v_mov_b32 v7, 1.0
    v_mov_b32 v8, 0x3f803f80
    v_mov_b32 v9, 0xfff8fff8
    v_mov_b32 v11, 0x40004
    v_mul_u32_u24 v15, 4736, v15
    s_and_b32 s46, s3, 4
    s_add_u32 s46, s46, s3
    s_mul_i32 s46, s46, 1184
    s_add_u32 s46, s46, 132608
    v_add_u32 v15, s46, v15
    v_add_u32 v25, v12, v15
    v_add_u32 v26, v13, v15
    s_lshr_b32 s46, s3, 2
    s_lshl_b32 s46, s46, 8
    s_mul_i32 s60, s51, 28512
    s_add_u32 s46, s60, s46
    v_lshl_add_u32 v40, v1, 2, s46
    v_add_u32 v41, 528, v40
    v_add_u32 v42, 1056, v40
    v_add_u32 v43, 1584, v40
    v_add_u32 v44, 2112, v40
    v_add_u32 v45, 2640, v40
    v_add_u32 v46, 3168, v40
    v_add_u32 v47, 3696, v40
    v_add_u32 v48, 4224, v40
    v_add_u32 v49, 4752, v40
    v_add_u32 v50, 5280, v40
    v_add_u32 v51, 5808, v40
    v_add_u32 v52, 6336, v40
    v_add_u32 v53, 6864, v40
    v_add_u32 v54, 7392, v40
    v_add_u32 v55, 7920, v40
    s_mul_i32 s62, s51, 2976
    s_add_u32 s62, s62, 151552
    s_cmp_ge_u32 s2, 144
    s_cbranch_scc1 C_O1
    s_cmp_lg_u32 s61, 0
    s_cbranch_scc1 C_O1
    v_and_b32 v14, 31, v1
    v_mul_u32_u24 v14, 528, v14
    v_lshrrev_b32 v15, 5, v1
    v_lshl_add_u32 v14, v15, 4, v14
    v_add_u32 v253, s60, v14
    v_add_u32 v27, 7168, v2
    v_mov_b32 v37, 0
    global_load_dwordx4 v[184:187], v27, s[44:45] offset:0
    global_load_dwordx4 v[188:191], v27, s[44:45] offset:1024
    global_load_dwordx4 v[192:195], v27, s[44:45] offset:2048
    global_load_dwordx4 v[208:211], v12, s[16:17]
    global_load_dwordx4 v[212:215], v12, s[16:17] offset:512
    global_load_dword v216, v13, s[16:17] offset:1024
    global_load_dwordx4 v[218:221], v12, s[20:21]
    global_load_dwordx4 v[222:225], v12, s[20:21] offset:512
    global_load_dword v226, v13, s[20:21] offset:1024
    s_waitcnt vmcnt(15)
    s_branch C_LN1
C_O1:
    v_bfe_u32 v15, v1, 2, 2
    v_mul_u32_u24 v14, 1184, v15
    v_lshrrev_b32 v15, 4, v1
    v_lshl_add_u32 v14, v15, 5, v14
    v_and_b32 v15, 3, v1
    v_lshl_add_u32 v14, v15, 3, v14
    s_cmp_ge_u32 s2, 216
    s_cselect_b32 s46, s39, 0
    s_mul_i32 s53, s46, 9472
    s_lshl_b32 s55, s51, 7
    s_add_u32 s53, s53, s55
    s_add_u32 s53, s53, 132608
    v_add_u32 v36, s53, v14
    v_lshrrev_b32 v14, 2, v1
    v_lshlrev_b32 v15, 4, v15
    v_lshl_add_u32 v37, v14, 14, v15
    s_cmp_lt_u32 s2, 96
    s_cselect_b32 s46, 0, s39
    s_lshl_b32 s46, s46, 6
    s_lshl_b32 s55, s38, 7
    s_add_u32 s55, s55, s46
    s_lshl_b32 s46, s51, 18
    s_add_u32 s55, s55, s46
    s_add_u32 s55, s55, 1048576
    s_add_u32 s36, s55, 1048576
    s_add_u32 s37, s55, 2097152
    v_mov_b32 v120, 0
    v_mov_b32 v121, 0
    v_mov_b32 v122, 0
    v_mov_b32 v123, 0
    s_lshl_b32 s46, s51, 10
    s_add_u32 s46, s46, 151296
    v_add_u32 v14, s46, v2
    v_max_u32 v15, 151552, v14
    ds_write_b128 v15, v[120:123]
    ds_write_b128 v14, v[120:123] offset:4096
    ds_write_b128 v14, v[120:123] offset:8192
    s_mul_i32 s46, s51, 4640
    s_add_u32 s46, s46, 114048
    v_add_u32 v14, s46, v12
    ds_write_b128 v14, v[120:123]
    s_waitcnt lgkmcnt(0)
    s_add_u32 s40, s40, 1
    s_and_b32 s41, s40, 7
    s_bfe_u32 s46, s40, 0x30003
    s_lshl_b32 s46, s46, 16
    s_or_b32 s41, s41, s46
    v_mov_b32 v10, s41
    s_cmp_eq_u32 s61, 0
    s_cbranch_scc1 C_O2
    s_cmp_ge_u32 s2, 144
    s_cbranch_scc1 C_BA
    s_waitcnt vmcnt(0)
    s_bitcmp1_b32 s51, 1
    s_cselect_b32 s56, s57, s56
    s_lshl_b32 s57, s56, 16
    s_and_b32 s56, s56, 0xffff0000
    s_bitcmp1_b32 s51, 0
    s_cselect_b32 s56, s56, s57
    v_mov_b32 v60, 0x3fb8aa3b
    v_mul_f32 v62, 0x3fb8aa3b, v28
    v_mul_f32 v60, s56, v60
    v_exp_f32 v62, v62
    v_exp_f32 v60, v60
    v_add_f32 v64, |v30|, |v31|
    v_add_f32 v65, |v32|, |v33|
    v_cvt_pk_bf16_f32 v62, 0, v62
    v_cvt_pk_bf16_f32 v60, 0, v60
    v_add_f32 v64, v64, v65
    v_mul_f32 v62, v62, v60
    v_mul_f32 v63, v29, v60
    v_mul_f32 v62, 0xbfb8aa3b, v62
    v_mul_f32 v63, 0.15915494, v63
    v_mul_f32 v104, 0x41000000, v62
    v_add_f32_dpp v64, v64, v64 row_ror:8 row_mask:0xf bank_mask:0xf
    v_mul_f32 v105, 0x41000000, v63
    v_exp_f32 v104, v104
    v_fract_f32 v105, v105
    v_add_f32_dpp v64, v64, v64 row_ror:4 row_mask:0xf bank_mask:0xf
    v_cos_f32 v72, v105
    v_sin_f32 v73, v105
    v_add_f32_dpp v64, v64, v64 row_ror:2 row_mask:0xf bank_mask:0xf
    v_pk_mul_f32 v[72:73], v[72:73], v[104:105] op_sel_hi:[1,0] neg_hi:[1,0]
    v_exp_f32 v106, v62
    v_add_f32_dpp v64, v64, v64 row_ror:1 row_mask:0xf bank_mask:0xf
    v_fract_f32 v107, v63
    v_cos_f32 v66, v107
    v_sin_f32 v67, v107
    v_mov_b32 v65, v64
    v_pk_mul_f32 v[66:67], v[66:67], v[106:107] op_sel_hi:[1,0]
    v_mul_f32 v108, 0x43800000, v62
    v_permlane16_swap_b32 v64, v65
    v_mul_f32 v109, 0x43800000, v63
    v_exp_f32 v108, v108
    v_add_f32 v64, v64, v65
    v_fract_f32 v109, v109
    v_cos_f32 v68, v109
    v_sin_f32 v69, v109
    v_mov_b32 v65, v64
    v_pk_mul_f32 v[68:69], v[68:69], v[108:109] op_sel_hi:[1,0]
    v_mov_b32 v162, 0x3c00
    v_pk_mul_f32 v[74:75], v[72:73], v[72:73] op_sel_hi:[1,0]
    v_permlane32_swap_b32 v64, v65
    v_pk_fma_f32 v[74:75], v[72:73], v[72:73], v[74:75] op_sel:[1,1,0] op_sel_hi:[0,1,1] neg_lo:[1,0,0]
    s_setprio 2
    s_branch C_BA
C_O2:
    global_load_dwordx4 v[208:211], v12, s[16:17]
    global_load_dwordx4 v[212:215], v12, s[16:17] offset:512
    global_load_dword v216, v13, s[16:17] offset:1024
    global_load_dwordx4 v[218:221], v12, s[20:21]
    global_load_dwordx4 v[222:225], v12, s[20:21] offset:512
    global_load_dword v226, v13, s[20:21] offset:1024
    s_waitcnt vmcnt(6)
C_LN1:
    v_dot2_f32_bf16 v120, v16, v8, 0
    v_dot2_f32_bf16 v121, v16, v16, 0
    v_dot2_f32_bf16 v120, v17, v8, v120
    v_dot2_f32_bf16 v121, v17, v17, v121
    v_dot2_f32_bf16 v120, v18, v8, v120
    v_dot2_f32_bf16 v121, v18, v18, v121
    v_dot2_f32_bf16 v120, v19, v8, v120
    v_dot2_f32_bf16 v121, v19, v19, v121
    v_dot2_f32_bf16 v120, v20, v8, v120
    v_dot2_f32_bf16 v121, v20, v20, v121
    v_dot2_f32_bf16 v120, v21, v8, v120
    v_dot2_f32_bf16 v121, v21, v21, v121
    v_dot2_f32_bf16 v120, v22, v8, v120
    v_dot2_f32_bf16 v121, v22, v22, v121
    v_dot2_f32_bf16 v120, v23, v8, v120
    v_dot2_f32_bf16 v121, v23, v23, v121
    v_dot2_f32_bf16 v120, v24, v8, v120
    v_dot2_f32_bf16 v121, v24, v24, v121
    s_nop 2
    v_permlane16_swap_b32 v120, v121
    v_add_f32 v120, v120, v121
    s_nop 1
    v_add_f32_dpp v120, v120, v120 row_ror:8 row_mask:0xf bank_mask:0xf
    s_nop 1
    v_add_f32_dpp v120, v120, v120 row_ror:4 row_mask:0xf bank_mask:0xf
    s_nop 1
    v_add_f32_dpp v120, v120, v120 row_ror:2 row_mask:0xf bank_mask:0xf
    s_nop 1
    v_add_f32_dpp v120, v120, v120 row_ror:1 row_mask:0xf bank_mask:0xf
    v_mov_b32 v121, v120
    s_nop 1
    v_permlane16_swap_b32 v120, v121
    v_mul_f32 v120, 0x3ae38e39, v120
    v_mul_f32 v121, 0x3ae38e39, v121
    v_fma_f32 v121, -v120, v120, v121
    v_cvt_pk_bf16_f32 v122, 0, v120
    v_dot2_f32_bf16 v126, v16, v6, v122 neg_lo:[0,0,1]
    v_max_f32 v121, 0, v121
    v_dot2_f32_bf16 v127, v16, v7, v122 neg_lo:[0,0,1]
    v_dot2_f32_bf16 v128, v17, v6, v122 neg_lo:[0,0,1]
    v_dot2_f32_bf16 v129, v17, v7, v122 neg_lo:[0,0,1]
    v_cvt_pk_bf16_f32 v121, 0, v121
    v_dot2_f32_bf16 v130, v18, v6, v122 neg_lo:[0,0,1]
    v_dot2_f32_bf16 v131, v18, v7, v122 neg_lo:[0,0,1]
    v_add_f32 v121, 0x3727c5ac, v121
    v_dot2_f32_bf16 v132, v19, v6, v122 neg_lo:[0,0,1]
    v_dot2_f32_bf16 v133, v19, v7, v122 neg_lo:[0,0,1]
    v_dot2_f32_bf16 v134, v20, v6, v122 neg_lo:[0,0,1]
    v_cvt_pk_bf16_f32 v121, 0, v121
    v_dot2_f32_bf16 v135, v20, v7, v122 neg_lo:[0,0,1]
    v_dot2_f32_bf16 v136, v21, v6, v122 neg_lo:[0,0,1]
    v_dot2_f32_bf16 v137, v21, v7, v122 neg_lo:[0,0,1]
    v_sqrt_f32 v121, v121
    v_dot2_f32_bf16 v138, v22, v6, v122 neg_lo:[0,0,1]
    v_dot2_f32_bf16 v139, v22, v7, v122 neg_lo:[0,0,1]
    v_cvt_pk_bf16_f32 v121, 0, v121
    v_dot2_f32_bf16 v140, v23, v6, v122 neg_lo:[0,0,1]
    v_dot2_f32_bf16 v141, v23, v7, v122 neg_lo:[0,0,1]
    v_dot2_f32_bf16 v142, v24, v6, v122 neg_lo:[0,0,1]
    v_rcp_f32 v124, v121
    v_dot2_f32_bf16 v143, v24, v7, v122 neg_lo:[0,0,1]
    v_cvt_pk_bf16_f32 v126, 0, v126
    v_cvt_pk_bf16_f32 v127, 0, v127
    v_cvt_pk_bf16_f32 v128, 0, v128
    v_cvt_pk_bf16_f32 v129, 0, v129
    v_cvt_pk_bf16_f32 v130, 0, v130
    v_cvt_pk_bf16_f32 v131, 0, v131
    v_cvt_pk_bf16_f32 v132, 0, v132
    v_cvt_pk_bf16_f32 v133, 0, v133
    v_cvt_pk_bf16_f32 v134, 0, v134
    v_cvt_pk_bf16_f32 v135, 0, v135
    v_cvt_pk_bf16_f32 v136, 0, v136
    v_cvt_pk_bf16_f32 v137, 0, v137
    v_cvt_pk_bf16_f32 v138, 0, v138
    v_cvt_pk_bf16_f32 v139, 0, v139
    v_cvt_pk_bf16_f32 v140, 0, v140
    v_cvt_pk_bf16_f32 v141, 0, v141
    v_cvt_pk_bf16_f32 v142, 0, v142
    v_cvt_pk_bf16_f32 v143, 0, v143
    v_pk_mul_f32 v[126:127], v[126:127], v[124:125] op_sel_hi:[1,0]
    v_pk_mul_f32 v[128:129], v[128:129], v[124:125] op_sel_hi:[1,0]
    v_pk_mul_f32 v[130:131], v[130:131], v[124:125] op_sel_hi:[1,0]
    v_pk_mul_f32 v[132:133], v[132:133], v[124:125] op_sel_hi:[1,0]
    v_pk_mul_f32 v[134:135], v[134:135], v[124:125] op_sel_hi:[1,0]
    v_pk_mul_f32 v[136:137], v[136:137], v[124:125] op_sel_hi:[1,0]
    v_pk_mul_f32 v[138:139], v[138:139], v[124:125] op_sel_hi:[1,0]
    v_pk_mul_f32 v[140:141], v[140:141], v[124:125] op_sel_hi:[1,0]
    v_pk_mul_f32 v[142:143], v[142:143], v[124:125] op_sel_hi:[1,0]
    v_cvt_pkrtz_f16_f32 v144, v126, v127
    v_cvt_pkrtz_f16_f32 v145, v128, v129
    v_cvt_pkrtz_f16_f32 v146, v130, v131
    v_cvt_pkrtz_f16_f32 v147, v132, v133
    v_cvt_pkrtz_f16_f32 v148, v134, v135
    ds_write_b128 v25, v[144:147]
    v_cvt_pkrtz_f16_f32 v149, v136, v137
    v_cvt_pkrtz_f16_f32 v150, v138, v139
    v_cvt_pkrtz_f16_f32 v151, v140, v141
    v_cvt_pkrtz_f16_f32 v152, v142, v143
    ds_write_b128 v25, v[148:151] offset:512
    ds_write_b32 v26, v152 offset:1024
    s_waitcnt lgkmcnt(0)
C_BA:
    s_barrier
    s_cmp_ge_u32 s3, 4
    s_cbranch_scc1 C_US
    s_cmp_lt_u32 s2, 144
    s_cbranch_scc1 C_K1
    s_cmp_ge_u32 s49, 128
    s_cbranch_scc1 FROLE
C_US:
    ds_read_b64_tr_b16 v[228:229], v36 offset:0
    ds_read_b64_tr_b16 v[230:231], v36 offset:4736
    ds_read_b64_tr_b16 v[232:233], v36 offset:512
    ds_read_b64_tr_b16 v[234:235], v36 offset:5248
    ds_read_b64_tr_b16 v[236:237], v36 offset:1024
    ds_read_b64_tr_b16 v[238:239], v36 offset:5760
    s_waitcnt lgkmcnt(4)
    v_add_u32 v228, v11, v228
    v_add_u32 v229, v11, v229
    v_add_u32 v230, v11, v230
    v_add_u32 v231, v11, v231
    v_and_or_b32 v228, v228, v9, v10
    v_and_or_b32 v229, v229, v9, v10
    v_and_or_b32 v230, v230, v9, v10
    v_and_or_b32 v231, v231, v9, v10
    buffer_store_dwordx4 v[228:231], v37, s[32:35], s55 offen sc1
    s_waitcnt lgkmcnt(2)
    v_add_u32 v232, v11, v232
    v_add_u32 v233, v11, v233
    v_add_u32 v234, v11, v234
    v_add_u32 v235, v11, v235
    v_and_or_b32 v232, v232, v9, v10
    v_and_or_b32 v233, v233, v9, v10
    v_and_or_b32 v234, v234, v9, v10
    v_and_or_b32 v235, v235, v9, v10
    buffer_store_dwordx4 v[232:235], v37, s[32:35], s36 offen sc1
    s_cmp_lg_u32 s51, 0
    s_cbranch_scc1 US1
    s_waitcnt lgkmcnt(0)
    v_add_u32 v236, v11, v236
    v_add_u32 v237, v11, v237
    v_add_u32 v238, v11, v238
    v_add_u32 v239, v11, v239
    v_and_or_b32 v236, v236, v9, v10
    v_and_or_b32 v237, v237, v9, v10
    v_and_or_b32 v238, v238, v9, v10
    v_and_or_b32 v239, v239, v9, v10
    buffer_store_dwordx4 v[236:239], v37, s[32:35], s37 offen sc1
US1:
    s_cmp_ge_u32 s2, 144
    s_cbranch_scc1 C_O3
    s_branch C_K2
C_O3:
    s_cmp_lt_u32 s49, 128
    s_cbranch_scc1 C_RL2
    v_subrev_u32 v14, 9472, v25
    v_subrev_u32 v15, 9472, v26
    ds_read_b128 v[140:143], v14
    ds_read_b128 v[144:147], v14 offset:512
    ds_read_b32 v148, v15 offset:1024
    s_mov_b32 s46, 10485760
    s_waitcnt lgkmcnt(0)
    v_add_u32 v140, v11, v140
    v_add_u32 v141, v11, v141
    v_add_u32 v142, v11, v142
    v_add_u32 v143, v11, v143
    v_add_u32 v144, v11, v144
    v_add_u32 v145, v11, v145
    v_add_u32 v146, v11, v146
    v_add_u32 v147, v11, v147
    v_add_u32 v148, v11, v148
    v_and_or_b32 v140, v140, v9, v10
    v_and_or_b32 v141, v141, v9, v10
    v_and_or_b32 v142, v142, v9, v10
    v_and_or_b32 v143, v143, v9, v10
    v_and_or_b32 v144, v144, v9, v10
    v_and_or_b32 v145, v145, v9, v10
    v_and_or_b32 v146, v146, v9, v10
    v_and_or_b32 v147, v147, v9, v10
    v_and_or_b32 v148, v148, v9, v10
    buffer_store_dwordx4 v[140:143], v4, s[32:35], s46 offen sc1
    buffer_store_dwordx4 v[144:147], v4, s[32:35], s46 offen offset:512 sc1
    buffer_store_dword v148, v5, s[32:35], s46 offen offset:1024 sc1
    s_branch FROLE
C_RL2:
    s_waitcnt vmcnt(0)
    s_branch RPREP
C_K1:
    s_add_u32 s40, s40, 1
    s_and_b32 s41, s40, 7
    s_bfe_u32 s46, s40, 0x30003
    s_lshl_b32 s46, s46, 16
    s_or_b32 s41, s41, s46
    v_mov_b32 v10, s41
    s_waitcnt vmcnt(9)
    s_bitcmp1_b32 s51, 1
    s_cselect_b32 s56, s57, s56
    s_lshl_b32 s57, s56, 16
    s_and_b32 s56, s56, 0xffff0000
    s_bitcmp1_b32 s51, 0
    s_cselect_b32 s56, s56, s57
    v_mov_b32 v60, 0x3fb8aa3b
    v_mul_f32 v62, 0x3fb8aa3b, v28
    v_mul_f32 v60, s56, v60
    v_exp_f32 v62, v62
    v_exp_f32 v60, v60
    v_add_f32 v64, |v30|, |v31|
    v_add_f32 v65, |v32|, |v33|
    v_cvt_pk_bf16_f32 v62, 0, v62
    v_cvt_pk_bf16_f32 v60, 0, v60
    v_add_f32 v64, v64, v65
    v_mul_f32 v62, v62, v60
    v_mul_f32 v63, v29, v60
    v_mul_f32 v62, 0xbfb8aa3b, v62
    v_mul_f32 v63, 0.15915494, v63
    v_mul_f32 v104, 0x41000000, v62
    v_add_f32_dpp v64, v64, v64 row_ror:8 row_mask:0xf bank_mask:0xf
    v_mul_f32 v105, 0x41000000, v63
    v_exp_f32 v104, v104
    v_fract_f32 v105, v105
    v_add_f32_dpp v64, v64, v64 row_ror:4 row_mask:0xf bank_mask:0xf
    v_cos_f32 v72, v105
    v_sin_f32 v73, v105
    v_add_f32_dpp v64, v64, v64 row_ror:2 row_mask:0xf bank_mask:0xf
    v_pk_mul_f32 v[72:73], v[72:73], v[104:105] op_sel_hi:[1,0] neg_hi:[1,0]
    v_exp_f32 v106, v62
    v_add_f32_dpp v64, v64, v64 row_ror:1 row_mask:0xf bank_mask:0xf
    v_fract_f32 v107, v63
    v_cos_f32 v66, v107
    v_sin_f32 v67, v107
    v_mov_b32 v65, v64
    v_pk_mul_f32 v[66:67], v[66:67], v[106:107] op_sel_hi:[1,0]
    v_mul_f32 v108, 0x43800000, v62
    v_permlane16_swap_b32 v64, v65
    v_mul_f32 v109, 0x43800000, v63
    v_exp_f32 v108, v108
    v_add_f32 v64, v64, v65
    v_fract_f32 v109, v109
    v_cos_f32 v68, v109
    v_sin_f32 v69, v109
    v_mov_b32 v65, v64
    v_pk_mul_f32 v[68:69], v[68:69], v[108:109] op_sel_hi:[1,0]
    v_mov_b32 v162, 0x3c00
    v_pk_mul_f32 v[74:75], v[72:73], v[72:73] op_sel_hi:[1,0]
    v_permlane32_swap_b32 v64, v65
    v_pk_fma_f32 v[74:75], v[72:73], v[72:73], v[74:75] op_sel:[1,1,0] op_sel_hi:[0,1,1] neg_lo:[1,0,0]
C_K2:
    v_pk_mul_f32 v[76:77], v[74:75], v[72:73] op_sel_hi:[1,0]
    v_pk_mul_f32 v[78:79], v[74:75], v[74:75] op_sel_hi:[1,0]
    v_cvt_pk_f16_f32 v163, v72, v73
    v_cvt_pk_f16_f32 v164, v74, v75
    v_add_f32 v64, v64, v65
    v_pk_fma_f32 v[76:77], v[74:75], v[72:73], v[76:77] op_sel:[1,1,0] op_sel_hi:[0,1,1] neg_lo:[1,0,0]
    v_pk_fma_f32 v[78:79], v[74:75], v[74:75], v[78:79] op_sel:[1,1,0] op_sel_hi:[0,1,1] neg_lo:[1,0,0]
    ds_write2st64_b32 v40, v163, v162 offset0:33 offset1:0
    v_pk_mul_f32 v[80:81], v[78:79], v[72:73] op_sel_hi:[1,0]
    v_pk_mul_f32 v[82:83], v[78:79], v[74:75] op_sel_hi:[1,0]
    v_cvt_pk_f16_f32 v165, v76, v77
    v_cvt_pk_f16_f32 v166, v78, v79
    v_mul_f32 v64, v64, v60
    v_pk_fma_f32 v[80:81], v[78:79], v[72:73], v[80:81] op_sel:[1,1,0] op_sel_hi:[0,1,1] neg_lo:[1,0,0]
    v_pk_fma_f32 v[82:83], v[78:79], v[74:75], v[82:83] op_sel:[1,1,0] op_sel_hi:[0,1,1] neg_lo:[1,0,0]
    ds_write2st64_b32 v41, v165, v164 offset0:33 offset1:0
    v_pk_mul_f32 v[84:85], v[78:79], v[76:77] op_sel_hi:[1,0]
    v_pk_mul_f32 v[86:87], v[78:79], v[78:79] op_sel_hi:[1,0]
    v_cvt_pk_f16_f32 v167, v80, v81
    v_cvt_pk_f16_f32 v56, v82, v83
    v_frexp_exp_i32_f32 v64, v64
    v_pk_fma_f32 v[84:85], v[78:79], v[76:77], v[84:85] op_sel:[1,1,0] op_sel_hi:[0,1,1] neg_lo:[1,0,0]
    v_pk_fma_f32 v[86:87], v[78:79], v[78:79], v[86:87] op_sel:[1,1,0] op_sel_hi:[0,1,1] neg_lo:[1,0,0]
    ds_write2st64_b32 v42, v167, v166 offset0:33 offset1:0
    v_pk_mul_f32 v[88:89], v[86:87], v[72:73] op_sel_hi:[1,0]
    v_pk_mul_f32 v[90:91], v[86:87], v[74:75] op_sel_hi:[1,0]
    v_cvt_pk_f16_f32 v57, v84, v85
    v_cvt_pk_f16_f32 v163, v86, v87
    v_max_i32 v64, -100, v64
    v_pk_fma_f32 v[88:89], v[86:87], v[72:73], v[88:89] op_sel:[1,1,0] op_sel_hi:[0,1,1] neg_lo:[1,0,0]
    v_pk_fma_f32 v[90:91], v[86:87], v[74:75], v[90:91] op_sel:[1,1,0] op_sel_hi:[0,1,1] neg_lo:[1,0,0]
    ds_write2st64_b32 v43, v57, v56 offset0:33 offset1:0
    v_pk_mul_f32 v[92:93], v[86:87], v[76:77] op_sel_hi:[1,0]
    v_pk_mul_f32 v[94:95], v[86:87], v[78:79] op_sel_hi:[1,0]
    v_cvt_pk_f16_f32 v162, v88, v89
    v_cvt_pk_f16_f32 v165, v90, v91
    v_min_i32 v64, 100, v64
    v_pk_fma_f32 v[92:93], v[86:87], v[76:77], v[92:93] op_sel:[1,1,0] op_sel_hi:[0,1,1] neg_lo:[1,0,0]
    v_pk_fma_f32 v[94:95], v[86:87], v[78:79], v[94:95] op_sel:[1,1,0] op_sel_hi:[0,1,1] neg_lo:[1,0,0]
    ds_write2st64_b32 v44, v162, v163 offset0:33 offset1:0
    v_pk_mul_f32 v[96:97], v[86:87], v[80:81] op_sel_hi:[1,0]
    v_pk_mul_f32 v[98:99], v[86:87], v[82:83] op_sel_hi:[1,0]
    v_cvt_pk_f16_f32 v164, v92, v93
    v_cvt_pk_f16_f32 v167, v94, v95
    v_sub_u32 v65, 0, v64
    v_pk_fma_f32 v[96:97], v[86:87], v[80:81], v[96:97] op_sel:[1,1,0] op_sel_hi:[0,1,1] neg_lo:[1,0,0]
    v_pk_fma_f32 v[98:99], v[86:87], v[82:83], v[98:99] op_sel:[1,1,0] op_sel_hi:[0,1,1] neg_lo:[1,0,0]
    ds_write2st64_b32 v45, v164, v165 offset0:33 offset1:0
    v_pk_mul_f32 v[100:101], v[86:87], v[84:85] op_sel_hi:[1,0]
    v_pk_mul_f32 v[102:103], v[86:87], v[86:87] op_sel_hi:[1,0]
    v_cvt_pk_f16_f32 v166, v96, v97
    v_cvt_pk_f16_f32 v57, v98, v99
    v_ldexp_f32 v60, v60, v65
    v_pk_fma_f32 v[100:101], v[86:87], v[84:85], v[100:101] op_sel:[1,1,0] op_sel_hi:[0,1,1] neg_lo:[1,0,0]
    v_pk_fma_f32 v[102:103], v[86:87], v[86:87], v[102:103] op_sel:[1,1,0] op_sel_hi:[0,1,1] neg_lo:[1,0,0]
    ds_write2st64_b32 v46, v166, v167 offset0:33 offset1:0
    v_pk_mul_f32 v[112:113], v[102:103], v[72:73] op_sel_hi:[1,0]
    v_pk_mul_f32 v[114:115], v[102:103], v[74:75] op_sel_hi:[1,0]
    v_cvt_pk_f16_f32 v56, v100, v101
    v_cvt_pk_f16_f32 v162, v102, v103
    v_pk_mul_f32 v[30:31], v[30:31], v[60:61] op_sel_hi:[1,0]
    v_pk_fma_f32 v[112:113], v[102:103], v[72:73], v[112:113] op_sel:[1,1,0] op_sel_hi:[0,1,1] neg_lo:[1,0,0]
    v_pk_fma_f32 v[114:115], v[102:103], v[74:75], v[114:115] op_sel:[1,1,0] op_sel_hi:[0,1,1] neg_lo:[1,0,0]
    ds_write2st64_b32 v47, v56, v57 offset0:33 offset1:0
    v_pk_mul_f32 v[116:117], v[102:103], v[76:77] op_sel_hi:[1,0]
    v_pk_mul_f32 v[110:111], v[102:103], v[78:79] op_sel_hi:[1,0]
    v_cvt_pk_f16_f32 v163, v112, v113
    v_cvt_pk_f16_f32 v164, v114, v115
    v_pk_fma_f32 v[116:117], v[102:103], v[76:77], v[116:117] op_sel:[1,1,0] op_sel_hi:[0,1,1] neg_lo:[1,0,0]
    v_pk_fma_f32 v[110:111], v[102:103], v[78:79], v[110:111] op_sel:[1,1,0] op_sel_hi:[0,1,1] neg_lo:[1,0,0]
    ds_write2st64_b32 v48, v163, v162 offset0:33 offset1:0
    v_pk_mul_f32 v[112:113], v[102:103], v[80:81] op_sel_hi:[1,0]
    v_pk_mul_f32 v[114:115], v[102:103], v[82:83] op_sel_hi:[1,0]
    v_cvt_pk_f16_f32 v165, v116, v117
    v_cvt_pk_f16_f32 v166, v110, v111
    v_pk_fma_f32 v[112:113], v[102:103], v[80:81], v[112:113] op_sel:[1,1,0] op_sel_hi:[0,1,1] neg_lo:[1,0,0]
    v_pk_fma_f32 v[114:115], v[102:103], v[82:83], v[114:115] op_sel:[1,1,0] op_sel_hi:[0,1,1] neg_lo:[1,0,0]
    ds_write2st64_b32 v49, v165, v164 offset0:33 offset1:0
    s_setprio 0
    v_pk_mul_f32 v[120:121], v[30:31], v[66:67] op_sel_hi:[1,0]
    v_cvt_pk_f16_f32 v167, v112, v113
    v_cvt_pk_f16_f32 v56, v114, v115
    v_pk_fma_f32 v[120:121], v[30:31], v[66:67], v[120:121] op_sel:[1,1,0] op_sel_hi:[0,1,1] neg_lo:[1,0,0]
    ds_write2st64_b32 v50, v167, v166 offset0:33 offset1:0
    s_cmp_ge_u32 s3, 4
    s_cbranch_scc1 C_K3
    v_add_u32 v64, 1, v64
    s_and_b32 s46, s40, 0x7fffff
    v_ldexp_f32 v64, 1.0, v64
    s_lshl_b32 s53, s2, 7
    v_or_b32 v64, s46, v64
    s_lshl_b32 s46, s51, 2
    s_add_u32 s46, s46, s53
    s_add_u32 s46, s46, 32768
    s_mov_b64 exec, 1
    buffer_store_dword v64, v2, s[32:35], s46 offen sc1
    s_mov_b64 exec, -1
    s_branch C_K4
C_K3:
    v_add_u32 v27, 4096, v2
    global_load_dwordx4 v[168:171], v27, s[44:45] offset:-4096
    global_load_dwordx4 v[172:175], v27, s[44:45] offset:-3072
    global_load_dwordx4 v[176:179], v27, s[44:45] offset:-2048
    global_load_dwordx4 v[180:183], v27, s[44:45] offset:-1024
    global_load_dwordx4 v[184:187], v27, s[44:45] offset:0
    global_load_dwordx4 v[188:191], v27, s[44:45] offset:1024
    global_load_dwordx4 v[192:195], v27, s[44:45] offset:2048
    s_lshl_b32 s48, s2, 14
    s_add_u32 s48, s48, 1048576
    s_lshl_b32 s46, s51, 10
    s_add_u32 s59, s48, s46
    s_add_u32 s59, s59, 12288
    s_mul_i32 s46, s51, 3072
    s_add_u32 s48, s48, s46
C_K4:
    v_pk_mul_f32 v[136:137], v[30:31], v[68:69] op_sel_hi:[1,0]
    v_pk_mul_f32 v[122:123], v[120:121], v[66:67] op_sel_hi:[1,0]
    v_cvt_pk_f16_f32 v57, v30, v31
    v_cvt_pk_f16_f32 v163, v120, v121
    v_pk_fma_f32 v[136:137], v[30:31], v[68:69], v[136:137] op_sel:[1,1,0] op_sel_hi:[0,1,1] neg_lo:[1,0,0]
    v_pk_fma_f32 v[122:123], v[120:121], v[66:67], v[122:123] op_sel:[1,1,0] op_sel_hi:[0,1,1] neg_lo:[1,0,0]
    ds_write_b32 v46, v57 offset:16896
    v_pk_mul_f32 v[124:125], v[122:123], v[66:67] op_sel_hi:[1,0]
    v_pk_mul_f32 v[138:139], v[122:123], v[68:69] op_sel_hi:[1,0]
    v_cvt_pk_f16_f32 v162, v136, v137
    v_cvt_pk_f16_f32 v165, v122, v123
    v_pk_fma_f32 v[124:125], v[122:123], v[66:67], v[124:125] op_sel:[1,1,0] op_sel_hi:[0,1,1] neg_lo:[1,0,0]
    v_pk_fma_f32 v[138:139], v[122:123], v[68:69], v[138:139] op_sel:[1,1,0] op_sel_hi:[0,1,1] neg_lo:[1,0,0]
    ds_write2st64_b32 v40, v162, v163 offset0:99 offset1:66
    v_pk_mul_f32 v[126:127], v[124:125], v[66:67] op_sel_hi:[1,0]
    v_cvt_pk_f16_f32 v164, v124, v125
    v_cvt_pk_f16_f32 v167, v138, v139
    v_pk_fma_f32 v[126:127], v[124:125], v[66:67], v[126:127] op_sel:[1,1,0] op_sel_hi:[0,1,1] neg_lo:[1,0,0]
    ds_write2st64_b32 v41, v167, v164 offset0:99 offset1:66
    v_pk_mul_f32 v[128:129], v[126:127], v[66:67] op_sel_hi:[1,0]
    v_pk_mul_f32 v[140:141], v[126:127], v[68:69] op_sel_hi:[1,0]
    v_cvt_pk_f16_f32 v166, v126, v127
    v_pk_fma_f32 v[128:129], v[126:127], v[66:67], v[128:129] op_sel:[1,1,0] op_sel_hi:[0,1,1] neg_lo:[1,0,0]
    v_pk_fma_f32 v[140:141], v[126:127], v[68:69], v[140:141] op_sel:[1,1,0] op_sel_hi:[0,1,1] neg_lo:[1,0,0]
    ds_write_b32 v47, v166 offset:16896
    v_pk_mul_f32 v[130:131], v[128:129], v[66:67] op_sel_hi:[1,0]
    v_pk_mul_f32 v[146:147], v[140:141], v[68:69] op_sel_hi:[1,0]
    v_cvt_pk_f16_f32 v57, v128, v129
    v_cvt_pk_f16_f32 v162, v140, v141
    v_pk_fma_f32 v[130:131], v[128:129], v[66:67], v[130:131] op_sel:[1,1,0] op_sel_hi:[0,1,1] neg_lo:[1,0,0]
    v_pk_fma_f32 v[146:147], v[140:141], v[68:69], v[146:147] op_sel:[1,1,0] op_sel_hi:[0,1,1] neg_lo:[1,0,0]
    ds_write_b32 v48, v57 offset:16896
    v_pk_mul_f32 v[132:133], v[130:131], v[66:67] op_sel_hi:[1,0]
    v_pk_mul_f32 v[142:143], v[130:131], v[68:69] op_sel_hi:[1,0]
    v_cvt_pk_f16_f32 v163, v130, v131
    v_cvt_pk_f16_f32 v167, v146, v147
    v_pk_fma_f32 v[132:133], v[130:131], v[66:67], v[132:133] op_sel:[1,1,0] op_sel_hi:[0,1,1] neg_lo:[1,0,0]
    v_pk_fma_f32 v[142:143], v[130:131], v[68:69], v[142:143] op_sel:[1,1,0] op_sel_hi:[0,1,1] neg_lo:[1,0,0]
    ds_write2st64_b32 v45, v162, v165 offset0:99 offset1:66
    v_pk_mul_f32 v[134:135], v[132:133], v[66:67] op_sel_hi:[1,0]
    v_pk_mul_f32 v[150:151], v[146:147], v[68:69] op_sel_hi:[1,0]
    v_cvt_pk_f16_f32 v164, v132, v133
    v_cvt_pk_f16_f32 v166, v142, v143
    v_pk_fma_f32 v[134:135], v[132:133], v[66:67], v[134:135] op_sel:[1,1,0] op_sel_hi:[0,1,1] neg_lo:[1,0,0]
    v_pk_fma_f32 v[150:151], v[146:147], v[68:69], v[150:151] op_sel:[1,1,0] op_sel_hi:[0,1,1] neg_lo:[1,0,0]
    ds_write2st64_b32 v42, v167, v163 offset0:99 offset1:66
    v_pk_mul_f32 v[144:145], v[134:135], v[68:69] op_sel_hi:[1,0]
    v_pk_mul_f32 v[116:117], v[102:103], v[84:85] op_sel_hi:[1,0]
    ds_write_b32 v49, v164 offset:16896
    v_cvt_pk_f16_f32 v57, v134, v135
    v_cvt_pk_f16_f32 v162, v150, v151
    v_pk_fma_f32 v[144:145], v[134:135], v[68:69], v[144:145] op_sel:[1,1,0] op_sel_hi:[0,1,1] neg_lo:[1,0,0]
    v_pk_fma_f32 v[116:117], v[102:103], v[84:85], v[116:117] op_sel:[1,1,0] op_sel_hi:[0,1,1] neg_lo:[1,0,0]
    ds_write_b32 v50, v166 offset:16896
    v_pk_mul_f32 v[148:149], v[144:145], v[68:69] op_sel_hi:[1,0]
    v_pk_mul_f32 v[110:111], v[102:103], v[86:87] op_sel_hi:[1,0]
    v_cvt_pk_f16_f32 v165, v144, v145
    v_cvt_pk_f16_f32 v167, v116, v117
    v_pk_fma_f32 v[148:149], v[144:145], v[68:69], v[148:149] op_sel:[1,1,0] op_sel_hi:[0,1,1] neg_lo:[1,0,0]
    v_pk_fma_f32 v[110:111], v[102:103], v[86:87], v[110:111] op_sel:[1,1,0] op_sel_hi:[0,1,1] neg_lo:[1,0,0]
    ds_write2st64_b32 v43, v162, v57 offset0:99 offset1:66
    v_pk_mul_f32 v[152:153], v[148:149], v[68:69] op_sel_hi:[1,0]
    v_pk_mul_f32 v[112:113], v[102:103], v[88:89] op_sel_hi:[1,0]
    v_cvt_pk_f16_f32 v163, v148, v149
    v_cvt_pk_f16_f32 v164, v110, v111
    v_pk_fma_f32 v[152:153], v[148:149], v[68:69], v[152:153] op_sel:[1,1,0] op_sel_hi:[0,1,1] neg_lo:[1,0,0]
    v_pk_fma_f32 v[112:113], v[102:103], v[88:89], v[112:113] op_sel:[1,1,0] op_sel_hi:[0,1,1] neg_lo:[1,0,0]
    ds_write2st64_b32 v51, v167, v56 offset0:33 offset1:0
    v_pk_mul_f32 v[114:115], v[102:103], v[90:91] op_sel_hi:[1,0]
    v_pk_mul_f32 v[154:155], v[152:153], v[68:69] op_sel_hi:[1,0]
    v_cvt_pk_f16_f32 v166, v152, v153
    v_cvt_pk_f16_f32 v162, v112, v113
    v_pk_fma_f32 v[114:115], v[102:103], v[90:91], v[114:115] op_sel:[1,1,0] op_sel_hi:[0,1,1] neg_lo:[1,0,0]
    v_pk_fma_f32 v[154:155], v[152:153], v[68:69], v[154:155] op_sel:[1,1,0] op_sel_hi:[0,1,1] neg_lo:[1,0,0]
    ds_write2st64_b32 v44, v163, v165 offset0:99 offset1:66
    v_pk_mul_f32 v[116:117], v[102:103], v[92:93] op_sel_hi:[1,0]
    v_pk_mul_f32 v[156:157], v[154:155], v[68:69] op_sel_hi:[1,0]
    ds_write_b32 v51, v166 offset:16896
    v_cvt_pk_f16_f32 v57, v114, v115
    v_cvt_pk_f16_f32 v167, v154, v155
    v_pk_fma_f32 v[116:117], v[102:103], v[92:93], v[116:117] op_sel:[1,1,0] op_sel_hi:[0,1,1] neg_lo:[1,0,0]
    v_pk_fma_f32 v[156:157], v[154:155], v[68:69], v[156:157] op_sel:[1,1,0] op_sel_hi:[0,1,1] neg_lo:[1,0,0]
    ds_write2st64_b32 v52, v162, v164 offset0:33 offset1:0
    s_cmp_lt_u32 s3, 4
    s_cbranch_scc1 C_K6
    buffer_load_dwordx4 v[200:203], v2, s[32:35], s48 offen offset:0 sc1
    buffer_load_dwordx4 v[204:207], v2, s[32:35], s48 offen offset:1024 sc1
    buffer_load_dwordx4 v[208:211], v2, s[32:35], s48 offen offset:2048 sc1
C_K6:
    v_pk_mul_f32 v[110:111], v[102:103], v[94:95] op_sel_hi:[1,0]
    v_pk_mul_f32 v[112:113], v[102:103], v[96:97] op_sel_hi:[1,0]
    v_cvt_pk_f16_f32 v56, v116, v117
    v_cvt_pk_f16_f32 v163, v156, v157
    v_pk_fma_f32 v[110:111], v[102:103], v[94:95], v[110:111] op_sel:[1,1,0] op_sel_hi:[0,1,1] neg_lo:[1,0,0]
    v_pk_fma_f32 v[112:113], v[102:103], v[96:97], v[112:113] op_sel:[1,1,0] op_sel_hi:[0,1,1] neg_lo:[1,0,0]
    ds_write_b32 v52, v167 offset:16896
    v_pk_mul_f32 v[158:159], v[156:157], v[68:69] op_sel_hi:[1,0]
    v_pk_mul_f32 v[114:115], v[102:103], v[98:99] op_sel_hi:[1,0]
    ds_write2st64_b32 v53, v56, v57 offset0:33 offset1:0
    v_cvt_pk_f16_f32 v165, v110, v111
    v_cvt_pk_f16_f32 v166, v112, v113
    v_pk_fma_f32 v[158:159], v[156:157], v[68:69], v[158:159] op_sel:[1,1,0] op_sel_hi:[0,1,1] neg_lo:[1,0,0]
    v_pk_fma_f32 v[114:115], v[102:103], v[98:99], v[114:115] op_sel:[1,1,0] op_sel_hi:[0,1,1] neg_lo:[1,0,0]
    ds_write_b32 v53, v163 offset:16896
    v_pk_mul_f32 v[160:161], v[158:159], v[68:69] op_sel_hi:[1,0]
    v_pk_mul_f32 v[116:117], v[102:103], v[100:101] op_sel_hi:[1,0]
    v_cvt_pk_f16_f32 v162, v158, v159
    v_cvt_pk_f16_f32 v164, v114, v115
    v_pk_fma_f32 v[160:161], v[158:159], v[68:69], v[160:161] op_sel:[1,1,0] op_sel_hi:[0,1,1] neg_lo:[1,0,0]
    v_pk_fma_f32 v[116:117], v[102:103], v[100:101], v[116:117] op_sel:[1,1,0] op_sel_hi:[0,1,1] neg_lo:[1,0,0]
    ds_write2st64_b32 v54, v166, v165 offset0:33 offset1:0
    v_cvt_pk_f16_f32 v167, v160, v161
    v_cvt_pk_f16_f32 v56, v116, v117
    ds_write_b32 v54, v162 offset:16896
    ds_write_b32 v55, v167 offset:16896
    ds_write2st64_b32 v55, v56, v164 offset0:33 offset1:0
    s_cmp_ge_u32 s3, 4
    s_cbranch_scc1 H_PATH
    s_waitcnt vmcnt(7)
    v_add_u32 v195, s60, v195
    ds_read_b128 v[92:95], v195 offset:0
    ds_read_b128 v[96:99], v253 offset:0
    ds_read_b128 v[100:103], v195 offset:32
    ds_read_b128 v[104:107], v253 offset:32
    s_barrier
    ds_read_b128 v[108:111], v195 offset:64
    ds_read_b128 v[112:115], v253 offset:64
    ds_read_b128 v[116:119], v195 offset:96
    ds_read_b128 v[120:123], v253 offset:96
    ds_read_b128 v[124:127], v195 offset:128
    ds_read_b128 v[128:131], v253 offset:128
    ds_read_b128 v[132:135], v195 offset:160
    ds_read_b128 v[136:139], v253 offset:160
    ds_read_b128 v[140:143], v195 offset:192
    ds_read_b128 v[144:147], v253 offset:192
    s_waitcnt lgkmcnt(12)
    v_mfma_f32_32x32x16_f16 v[168:183], v[92:95], v[96:99], 0
    ds_read_b128 v[148:151], v195 offset:224
    ds_read_b128 v[152:155], v253 offset:224
    v_add_u32 v184, s62, v184
    v_add_u32 v185, s62, v185
    s_waitcnt lgkmcnt(12)
    v_mfma_f32_32x32x16_f16 v[168:183], v[100:103], v[104:107], v[168:183]
    ds_read_b128 v[92:95], v195 offset:256
    ds_read_b128 v[96:99], v253 offset:256
    v_add_u32 v186, s62, v186
    v_add_u32 v187, s62, v187
    s_waitcnt lgkmcnt(12)
    v_mfma_f32_32x32x16_f16 v[168:183], v[108:111], v[112:115], v[168:183]
    ds_read_b128 v[100:103], v195 offset:288
    ds_read_b128 v[104:107], v253 offset:288
    v_add_u32 v188, s62, v188
    v_add_u32 v189, s62, v189
    s_waitcnt lgkmcnt(12)
    v_mfma_f32_32x32x16_f16 v[168:183], v[116:119], v[120:123], v[168:183]
    ds_read_b128 v[108:111], v195 offset:320
    ds_read_b128 v[112:115], v253 offset:320
    v_add_u32 v190, s62, v190
    v_add_u32 v191, s62, v191
    s_waitcnt lgkmcnt(12)
    v_mfma_f32_32x32x16_f16 v[168:183], v[124:127], v[128:131], v[168:183]
    ds_read_b128 v[116:119], v195 offset:352
    ds_read_b128 v[120:123], v253 offset:352
    v_add_u32 v192, s62, v192
    v_add_u32 v193, s62, v193
    s_waitcnt lgkmcnt(12)
    v_mfma_f32_32x32x16_f16 v[168:183], v[132:135], v[136:139], v[168:183]
    ds_read_b128 v[124:127], v195 offset:384
    ds_read_b128 v[128:131], v253 offset:384
    v_add_u32 v194, s62, v194
    v_and_b32 v14, 15, v1
    s_waitcnt lgkmcnt(12)
    v_mfma_f32_32x32x16_f16 v[168:183], v[140:143], v[144:147], v[168:183]
    ds_read_b128 v[132:135], v195 offset:416
    ds_read_b128 v[136:139], v253 offset:416
    v_lshrrev_b32 v15, 4, v1
    s_mul_i32 s46, s51, 4640
    s_waitcnt lgkmcnt(12)
    v_mfma_f32_32x32x16_f16 v[168:183], v[148:151], v[152:155], v[168:183]
    ds_read_b128 v[140:143], v195 offset:448
    ds_read_b128 v[144:147], v253 offset:448
    s_add_u32 s46, s46, 114048
    v_lshlrev_b32 v248, 5, v14
    s_waitcnt lgkmcnt(12)
    v_mfma_f32_32x32x16_f16 v[168:183], v[92:95], v[96:99], v[168:183]
    ds_read_b128 v[148:151], v195 offset:480
    ds_read_b128 v[152:155], v253 offset:480
    v_lshl_add_u32 v248, v15, 4, v248
    v_add_u32 v248, s46, v248
    s_waitcnt lgkmcnt(12)
    v_mfma_f32_32x32x16_f16 v[168:183], v[100:103], v[104:107], v[168:183]
    s_mul_i32 s46, s51, 6144
    s_add_u32 s46, s46, 20480
    v_add_u32 v249, s46, v2
    v_lshlrev_b32 v250, 3, v15
    v_sub_u32 v250, v250, v14
    s_waitcnt lgkmcnt(10)
    v_mfma_f32_32x32x16_f16 v[168:183], v[108:111], v[112:115], v[168:183]
    v_add_u32 v250, 15, v250
    v_and_b32 v34, 1, v250
    v_mul_u32_u24 v34, 1090, v34
    v_lshl_add_u32 v250, v250, 1, v34
    v_add_u32 v250, s62, v250
    s_waitcnt lgkmcnt(8)
    v_mfma_f32_32x32x16_f16 v[168:183], v[116:119], v[120:123], v[168:183]
    v_lshlrev_b32 v251, 3, v14
    v_and_b32 v34, 1, v15
    v_lshl_add_u32 v251, v34, 8, v251
    v_lshrrev_b32 v34, 1, v15
    v_lshl_add_u32 v251, v34, 7, v251
    s_waitcnt lgkmcnt(6)
    v_mfma_f32_32x32x16_f16 v[168:183], v[124:127], v[128:131], v[168:183]
    s_mul_i32 s46, s51, 4128
    v_add_u32 v251, s46, v251
    v_add_u32 v252, 576, v250
    v_add_u32 v250, 64, v250
    s_and_b32 s46, s2, 7
    s_waitcnt lgkmcnt(4)
    v_mfma_f32_32x32x16_f16 v[168:183], v[132:135], v[136:139], v[168:183]
    s_mul_i32 s46, s46, 72
    s_lshr_b32 s53, s2, 3
    s_lshl_b32 s53, s53, 2
    s_add_u32 s46, s46, s53
    s_add_u32 s46, s46, s51
    s_waitcnt lgkmcnt(2)
    v_mfma_f32_32x32x16_f16 v[168:183], v[140:143], v[144:147], v[168:183]
    s_mul_i32 s46, s46, 9216
    s_add_u32 s46, s46, 4096
    v_add_u32 v27, s46, v2
    s_waitcnt lgkmcnt(0)
    v_mfma_f32_32x32x16_f16 v[168:183], v[148:151], v[152:155], v[168:183]
    s_nop 11
    v_cvt_pk_f16_f32 v196, v171, v170
    v_cvt_pk_f16_f32 v197, v169, v168
    v_cvt_pk_f16_f32 v198, v183, v182
    ds_write2_b32 v184, v196, v197 offset0:0 offset1:1
    v_cvt_pk_f16_f32 v199, v181, v180
    v_cvt_pk_f16_f32 v200, v175, v175
    ds_write2_b32 v185, v198, v199 offset0:0 offset1:1
    v_cvt_pk_f16_f32 v201, v174, v173
    v_cvt_pk_f16_f32 v202, v173, v173
    ds_write2_b32 v189, v200, v201 offset0:0 offset1:1
    ds_write_b32 v190, v200
    v_cvt_pk_f16_f32 v203, v172, v176
    ds_write2_b32 v188, v200, v202 offset0:0 offset1:2
    v_cvt_pk_f16_f32 v204, v175, v174
    ds_write2_b32 v189, v202, v203 offset0:2 offset1:3
    v_cvt_pk_f16_f32 v205, v173, v172
    ds_write_b32 v186, v204
    v_cvt_pk_f16_f32 v206, v176, v177
    ds_write_b32 v187, v205
    v_cvt_pk_f16_f32 v207, v178, v179
    ds_write_b16 v191, v206
    ds_write_b16_d16_hi v192, v206
    ds_write_b16 v193, v207
    ds_write_b16_d16_hi v194, v207
    ds_read2_b32 v[44:45], v252 offset0:48 offset1:49
    ds_read2_b32 v[46:47], v252 offset0:50 offset1:51
    ds_read2_b32 v[48:49], v252 offset0:32 offset1:33
    ds_read2_b32 v[50:51], v252 offset0:34 offset1:35
    ds_read2_b32 v[52:53], v252 offset0:16 offset1:17
    ds_read2_b32 v[54:55], v252 offset0:18 offset1:19
    ds_read2_b32 v[56:57], v252 offset0:0 offset1:1
    ds_read2_b32 v[58:59], v252 offset0:2 offset1:3
    ds_read2_b32 v[28:29], v252 offset0:112 offset1:113
    ds_read2_b32 v[30:31], v252 offset0:114 offset1:115
    ds_read2_b32 v[32:33], v252 offset0:96 offset1:97
    ds_read2_b32 v[34:35], v252 offset0:98 offset1:99
    ds_read2_b32 v[36:37], v252 offset0:80 offset1:81
    ds_read2_b32 v[38:39], v252 offset0:82 offset1:83
    ds_read2_b32 v[40:41], v252 offset0:64 offset1:65
    ds_read2_b32 v[42:43], v252 offset0:66 offset1:67
    s_waitcnt lgkmcnt(15)
    s_barrier
    ds_read_b128 v[92:95], v248 offset:480
    ds_read_b128 v[96:99], v248 offset:416
    ds_read_b128 v[100:103], v248 offset:352
    ds_read_b128 v[104:107], v248 offset:288
    ds_read_b128 v[108:111], v248 offset:992
    ds_read_b128 v[112:115], v248 offset:928
    ds_read_b128 v[116:119], v248 offset:864
    ds_read_b128 v[120:123], v248 offset:800
    s_waitcnt lgkmcnt(15)
    s_waitcnt lgkmcnt(7)
    v_mfma_f32_16x16x32_f16 v[188:191], v[44:47], v[92:95], 0
    ds_read2_b32 v[76:77], v250 offset0:48 offset1:49
    ds_read2_b32 v[78:79], v250 offset0:50 offset1:51
    s_waitcnt lgkmcnt(8)
    v_mfma_f32_16x16x32_f16 v[188:191], v[48:51], v[96:99], v[188:191]
    ds_read2_b32 v[80:81], v250 offset0:32 offset1:33
    ds_read2_b32 v[82:83], v250 offset0:34 offset1:35
    s_waitcnt lgkmcnt(9)
    v_mfma_f32_16x16x32_f16 v[188:191], v[52:55], v[100:103], v[188:191]
    ds_read2_b32 v[84:85], v250 offset0:16 offset1:17
    ds_read2_b32 v[86:87], v250 offset0:18 offset1:19
    s_waitcnt lgkmcnt(10)
    v_mfma_f32_16x16x32_f16 v[188:191], v[56:59], v[104:107], v[188:191]
    ds_read2_b32 v[88:89], v250 offset0:0 offset1:1
    ds_read2_b32 v[90:91], v250 offset0:2 offset1:3
    v_mfma_f32_16x16x32_f16 v[156:159], v[28:31], v[92:95], 0
    ds_read2_b32 v[60:61], v250 offset0:112 offset1:113
    ds_read2_b32 v[62:63], v250 offset0:114 offset1:115
    v_mfma_f32_16x16x32_f16 v[156:159], v[32:35], v[96:99], v[156:159]
    ds_read2_b32 v[64:65], v250 offset0:96 offset1:97
    ds_read2_b32 v[66:67], v250 offset0:98 offset1:99
    v_mfma_f32_16x16x32_f16 v[156:159], v[36:39], v[100:103], v[156:159]
    ds_read2_b32 v[68:69], v250 offset0:80 offset1:81
    ds_read2_b32 v[70:71], v250 offset0:82 offset1:83
    v_mfma_f32_16x16x32_f16 v[156:159], v[40:43], v[104:107], v[156:159]
    ds_read2_b32 v[72:73], v250 offset0:64 offset1:65
    ds_read2_b32 v[74:75], v250 offset0:66 offset1:67
    s_waitcnt lgkmcnt(15)
    v_mfma_f32_16x16x32_f16 v[192:195], v[44:47], v[108:111], 0
    ds_read_b128 v[124:127], v248 offset:1504
    v_mfma_f32_16x16x32_f16 v[192:195], v[48:51], v[112:115], v[192:195]
    ds_read_b128 v[128:131], v248 offset:1440
    s_waitcnt lgkmcnt(15)
    v_mfma_f32_16x16x32_f16 v[192:195], v[52:55], v[116:119], v[192:195]
    ds_read_b128 v[132:135], v248 offset:1376
    v_mfma_f32_16x16x32_f16 v[192:195], v[56:59], v[120:123], v[192:195]
    ds_read_b128 v[136:139], v248 offset:1312
    s_waitcnt lgkmcnt(15)
    v_mfma_f32_16x16x32_f16 v[192:195], v[76:79], v[92:95], v[192:195]
    v_add_f32_dpp v156, v188, v156 row_ror:8 row_mask:0xf bank_mask:0xc
    v_add_f32_dpp v157, v189, v157 row_ror:8 row_mask:0xf bank_mask:0xc
    s_waitcnt lgkmcnt(15)
    v_mfma_f32_16x16x32_f16 v[192:195], v[80:83], v[96:99], v[192:195]
    v_add_f32_dpp v158, v190, v158 row_ror:8 row_mask:0xf bank_mask:0xc
    v_add_f32_dpp v159, v191, v159 row_ror:8 row_mask:0xf bank_mask:0xc
    s_waitcnt lgkmcnt(14)
    v_mfma_f32_16x16x32_f16 v[192:195], v[84:87], v[100:103], v[192:195]
    v_cvt_pkrtz_f16_f32 v156, v156, v157
    v_cvt_pkrtz_f16_f32 v157, v158, v159
    s_waitcnt lgkmcnt(12)
    v_mfma_f32_16x16x32_f16 v[192:195], v[88:91], v[104:107], v[192:195]
    v_mfma_f32_16x16x32_f16 v[160:163], v[28:31], v[108:111], 0
    ds_write_b64 v251, v[156:157] offset:0
    v_mfma_f32_16x16x32_f16 v[160:163], v[32:35], v[112:115], v[160:163]
    v_mfma_f32_16x16x32_f16 v[160:163], v[36:39], v[116:119], v[160:163]
    v_mfma_f32_16x16x32_f16 v[160:163], v[40:43], v[120:123], v[160:163]
    s_waitcnt lgkmcnt(11)
    v_mfma_f32_16x16x32_f16 v[160:163], v[60:63], v[92:95], v[160:163]
    s_waitcnt lgkmcnt(9)
    v_mfma_f32_16x16x32_f16 v[160:163], v[64:67], v[96:99], v[160:163]
    v_mov_b32_dpp v188, v192 quad_perm:[0,1,2,3] row_mask:0xf bank_mask:0x3
    v_mov_b32_dpp v189, v193 quad_perm:[0,1,2,3] row_mask:0xf bank_mask:0x3
    s_waitcnt lgkmcnt(7)
    v_mfma_f32_16x16x32_f16 v[160:163], v[68:71], v[100:103], v[160:163]
    v_mov_b32_dpp v190, v194 quad_perm:[0,1,2,3] row_mask:0xf bank_mask:0x3
    v_mov_b32_dpp v191, v195 quad_perm:[0,1,2,3] row_mask:0xf bank_mask:0x3
    s_waitcnt lgkmcnt(5)
    v_mfma_f32_16x16x32_f16 v[160:163], v[72:75], v[104:107], v[160:163]
    s_waitcnt lgkmcnt(3)
    v_mfma_f32_16x16x32_f16 v[196:199], v[44:47], v[124:127], 0
    ds_read_b128 v[92:95], v248 offset:2016
    v_mfma_f32_16x16x32_f16 v[196:199], v[48:51], v[128:131], v[196:199]
    ds_read_b128 v[96:99], v248 offset:1952
    s_waitcnt lgkmcnt(3)
    v_mfma_f32_16x16x32_f16 v[196:199], v[52:55], v[132:135], v[196:199]
    ds_read_b128 v[100:103], v248 offset:1888
    v_mfma_f32_16x16x32_f16 v[196:199], v[56:59], v[136:139], v[196:199]
    ds_read_b128 v[104:107], v248 offset:1824
    v_mfma_f32_16x16x32_f16 v[196:199], v[76:79], v[108:111], v[196:199]
    v_add_f32_dpp v160, v188, v160 row_ror:8 row_mask:0xf bank_mask:0xf
    v_add_f32_dpp v161, v189, v161 row_ror:8 row_mask:0xf bank_mask:0xf
    v_mfma_f32_16x16x32_f16 v[196:199], v[80:83], v[112:115], v[196:199]
    v_add_f32_dpp v162, v190, v162 row_ror:8 row_mask:0xf bank_mask:0xf
    v_add_f32_dpp v163, v191, v163 row_ror:8 row_mask:0xf bank_mask:0xf
    v_mfma_f32_16x16x32_f16 v[196:199], v[84:87], v[116:119], v[196:199]
    v_cvt_pkrtz_f16_f32 v160, v160, v161
    v_cvt_pkrtz_f16_f32 v161, v162, v163
    v_mfma_f32_16x16x32_f16 v[196:199], v[88:91], v[120:123], v[196:199]
    v_mfma_f32_16x16x32_f16 v[164:167], v[28:31], v[124:127], 0
    ds_write_b64 v251, v[160:161] offset:512
    v_mfma_f32_16x16x32_f16 v[164:167], v[32:35], v[128:131], v[164:167]
    v_mfma_f32_16x16x32_f16 v[164:167], v[36:39], v[132:135], v[164:167]
    v_mfma_f32_16x16x32_f16 v[164:167], v[40:43], v[136:139], v[164:167]
    v_mfma_f32_16x16x32_f16 v[164:167], v[60:63], v[108:111], v[164:167]
    v_mfma_f32_16x16x32_f16 v[164:167], v[64:67], v[112:115], v[164:167]
    s_nop 0
    v_mov_b32_dpp v192, v196 quad_perm:[0,1,2,3] row_mask:0xf bank_mask:0x3
    v_mov_b32_dpp v193, v197 quad_perm:[0,1,2,3] row_mask:0xf bank_mask:0x3
    s_waitcnt lgkmcnt(0)
    s_barrier
    ds_read_b128 v[148:151], v249 offset:0
    ds_read_b128 v[152:155], v249 offset:1024
    v_mfma_f32_16x16x32_f16 v[164:167], v[68:71], v[116:119], v[164:167]
    v_mov_b32_dpp v194, v198 quad_perm:[0,1,2,3] row_mask:0xf bank_mask:0x3
    v_mov_b32_dpp v195, v199 quad_perm:[0,1,2,3] row_mask:0xf bank_mask:0x3
    v_mfma_f32_16x16x32_f16 v[164:167], v[72:75], v[120:123], v[164:167]
    v_mfma_f32_16x16x32_f16 v[188:191], v[44:47], v[92:95], 0
    ds_read_b128 v[108:111], v248 offset:2528
    v_mfma_f32_16x16x32_f16 v[188:191], v[48:51], v[96:99], v[188:191]
    ds_read_b128 v[112:115], v248 offset:2464
    v_mfma_f32_16x16x32_f16 v[188:191], v[52:55], v[100:103], v[188:191]
    ds_read_b128 v[116:119], v248 offset:2400
    v_mfma_f32_16x16x32_f16 v[188:191], v[56:59], v[104:107], v[188:191]
    ds_read_b128 v[120:123], v248 offset:2336
    v_mfma_f32_16x16x32_f16 v[188:191], v[76:79], v[124:127], v[188:191]
    v_add_f32_dpp v164, v192, v164 row_ror:8 row_mask:0xf bank_mask:0xf
    v_add_f32_dpp v165, v193, v165 row_ror:8 row_mask:0xf bank_mask:0xf
    v_mfma_f32_16x16x32_f16 v[188:191], v[80:83], v[128:131], v[188:191]
    v_add_f32_dpp v166, v194, v166 row_ror:8 row_mask:0xf bank_mask:0xf
    v_add_f32_dpp v167, v195, v167 row_ror:8 row_mask:0xf bank_mask:0xf
    v_mfma_f32_16x16x32_f16 v[188:191], v[84:87], v[132:135], v[188:191]
    s_waitcnt lgkmcnt(5)
    v_add_f32 v164, v164, v148
    v_add_f32 v165, v165, v149
    v_mfma_f32_16x16x32_f16 v[188:191], v[88:91], v[136:139], v[188:191]
    v_add_f32 v166, v166, v150
    v_add_f32 v167, v167, v151
    s_waitcnt lgkmcnt(4)
    v_mfma_f32_16x16x32_f16 v[152:155], v[28:31], v[92:95], v[152:155]
    v_cvt_pkrtz_f16_f32 v164, v164, v165
    v_cvt_pkrtz_f16_f32 v165, v166, v167
    v_mfma_f32_16x16x32_f16 v[152:155], v[32:35], v[96:99], v[152:155]
    v_mfma_f32_16x16x32_f16 v[152:155], v[36:39], v[100:103], v[152:155]
    ds_write_b64 v251, v[164:165] offset:1024
    v_mfma_f32_16x16x32_f16 v[152:155], v[40:43], v[104:107], v[152:155]
    v_mfma_f32_16x16x32_f16 v[152:155], v[60:63], v[124:127], v[152:155]
    v_mfma_f32_16x16x32_f16 v[152:155], v[64:67], v[128:131], v[152:155]
    v_mov_b32_dpp v196, v188 quad_perm:[0,1,2,3] row_mask:0xf bank_mask:0x3
    v_mov_b32_dpp v197, v189 quad_perm:[0,1,2,3] row_mask:0xf bank_mask:0x3
    v_mfma_f32_16x16x32_f16 v[152:155], v[68:71], v[132:135], v[152:155]
    v_mov_b32_dpp v198, v190 quad_perm:[0,1,2,3] row_mask:0xf bank_mask:0x3
    v_mov_b32_dpp v199, v191 quad_perm:[0,1,2,3] row_mask:0xf bank_mask:0x3
    v_mfma_f32_16x16x32_f16 v[152:155], v[72:75], v[136:139], v[152:155]
    s_waitcnt lgkmcnt(3)
    v_mfma_f32_16x16x32_f16 v[192:195], v[44:47], v[108:111], 0
    ds_read_b128 v[124:127], v248 offset:3040
    v_mfma_f32_16x16x32_f16 v[192:195], v[48:51], v[112:115], v[192:195]
    ds_read_b128 v[128:131], v248 offset:2976
    s_waitcnt lgkmcnt(3)
    v_mfma_f32_16x16x32_f16 v[192:195], v[52:55], v[116:119], v[192:195]
    ds_read_b128 v[132:135], v248 offset:2912
    v_mfma_f32_16x16x32_f16 v[192:195], v[56:59], v[120:123], v[192:195]
    ds_read_b128 v[136:139], v248 offset:2848
    v_mfma_f32_16x16x32_f16 v[192:195], v[76:79], v[92:95], v[192:195]
    v_add_f32_dpp v152, v196, v152 row_ror:8 row_mask:0xf bank_mask:0xf
    v_add_f32_dpp v153, v197, v153 row_ror:8 row_mask:0xf bank_mask:0xf
    v_mfma_f32_16x16x32_f16 v[192:195], v[80:83], v[96:99], v[192:195]
    v_add_f32_dpp v154, v198, v154 row_ror:8 row_mask:0xf bank_mask:0xf
    v_add_f32_dpp v155, v199, v155 row_ror:8 row_mask:0xf bank_mask:0xf
    v_mfma_f32_16x16x32_f16 v[192:195], v[84:87], v[100:103], v[192:195]
    v_cvt_pkrtz_f16_f32 v152, v152, v153
    v_cvt_pkrtz_f16_f32 v153, v154, v155
    v_mfma_f32_16x16x32_f16 v[192:195], v[88:91], v[104:107], v[192:195]
    v_mfma_f32_16x16x32_f16 v[172:175], v[28:31], v[108:111], 0
    ds_write_b64 v251, v[152:153] offset:1536
    v_mfma_f32_16x16x32_f16 v[172:175], v[32:35], v[112:115], v[172:175]
    v_mfma_f32_16x16x32_f16 v[172:175], v[36:39], v[116:119], v[172:175]
    v_mfma_f32_16x16x32_f16 v[172:175], v[40:43], v[120:123], v[172:175]
    v_mfma_f32_16x16x32_f16 v[172:175], v[60:63], v[92:95], v[172:175]
    v_mfma_f32_16x16x32_f16 v[172:175], v[64:67], v[96:99], v[172:175]
    s_nop 0
    v_mov_b32_dpp v188, v192 quad_perm:[0,1,2,3] row_mask:0xf bank_mask:0x3
    v_mov_b32_dpp v189, v193 quad_perm:[0,1,2,3] row_mask:0xf bank_mask:0x3
    s_waitcnt lgkmcnt(0)
    s_barrier
    ds_read_b128 v[140:143], v249 offset:2048
    ds_read_b128 v[144:147], v249 offset:3072
    v_mfma_f32_16x16x32_f16 v[172:175], v[68:71], v[100:103], v[172:175]
    v_mov_b32_dpp v190, v194 quad_perm:[0,1,2,3] row_mask:0xf bank_mask:0x3
    v_mov_b32_dpp v191, v195 quad_perm:[0,1,2,3] row_mask:0xf bank_mask:0x3
    v_mfma_f32_16x16x32_f16 v[172:175], v[72:75], v[104:107], v[172:175]
    v_mfma_f32_16x16x32_f16 v[196:199], v[44:47], v[124:127], 0
    ds_read_b128 v[92:95], v248 offset:3552
    v_mfma_f32_16x16x32_f16 v[196:199], v[48:51], v[128:131], v[196:199]
    ds_read_b128 v[96:99], v248 offset:3488
    v_mfma_f32_16x16x32_f16 v[196:199], v[52:55], v[132:135], v[196:199]
    ds_read_b128 v[100:103], v248 offset:3424
    v_mfma_f32_16x16x32_f16 v[196:199], v[56:59], v[136:139], v[196:199]
    ds_read_b128 v[104:107], v248 offset:3360
    v_mfma_f32_16x16x32_f16 v[196:199], v[76:79], v[108:111], v[196:199]
    v_add_f32_dpp v172, v188, v172 row_ror:8 row_mask:0xf bank_mask:0xf
    v_add_f32_dpp v173, v189, v173 row_ror:8 row_mask:0xf bank_mask:0xf
    v_mfma_f32_16x16x32_f16 v[196:199], v[80:83], v[112:115], v[196:199]
    v_add_f32_dpp v174, v190, v174 row_ror:8 row_mask:0xf bank_mask:0xf
    v_add_f32_dpp v175, v191, v175 row_ror:8 row_mask:0xf bank_mask:0xf
    v_mfma_f32_16x16x32_f16 v[196:199], v[84:87], v[116:119], v[196:199]
    s_waitcnt lgkmcnt(5)
    v_add_f32 v172, v172, v140
    v_add_f32 v173, v173, v141
    v_mfma_f32_16x16x32_f16 v[196:199], v[88:91], v[120:123], v[196:199]
    v_add_f32 v174, v174, v142
    v_add_f32 v175, v175, v143
    s_waitcnt lgkmcnt(4)
    v_mfma_f32_16x16x32_f16 v[144:147], v[28:31], v[124:127], v[144:147]
    v_cvt_pkrtz_f16_f32 v172, v172, v173
    v_cvt_pkrtz_f16_f32 v173, v174, v175
    v_mfma_f32_16x16x32_f16 v[144:147], v[32:35], v[128:131], v[144:147]
    v_mfma_f32_16x16x32_f16 v[144:147], v[36:39], v[132:135], v[144:147]
    ds_write_b64 v251, v[172:173] offset:2048
    v_mfma_f32_16x16x32_f16 v[144:147], v[40:43], v[136:139], v[144:147]
    v_mfma_f32_16x16x32_f16 v[144:147], v[60:63], v[108:111], v[144:147]
    v_mfma_f32_16x16x32_f16 v[144:147], v[64:67], v[112:115], v[144:147]
    v_mov_b32_dpp v192, v196 quad_perm:[0,1,2,3] row_mask:0xf bank_mask:0x3
    v_mov_b32_dpp v193, v197 quad_perm:[0,1,2,3] row_mask:0xf bank_mask:0x3
    v_mfma_f32_16x16x32_f16 v[144:147], v[68:71], v[116:119], v[144:147]
    v_mov_b32_dpp v194, v198 quad_perm:[0,1,2,3] row_mask:0xf bank_mask:0x3
    v_mov_b32_dpp v195, v199 quad_perm:[0,1,2,3] row_mask:0xf bank_mask:0x3
    v_mfma_f32_16x16x32_f16 v[144:147], v[72:75], v[120:123], v[144:147]
    s_waitcnt lgkmcnt(3)
    v_mfma_f32_16x16x32_f16 v[188:191], v[44:47], v[92:95], 0
    ds_read_b128 v[108:111], v248 offset:4064
    v_mfma_f32_16x16x32_f16 v[188:191], v[48:51], v[96:99], v[188:191]
    ds_read_b128 v[112:115], v248 offset:4000
    s_waitcnt lgkmcnt(3)
    v_mfma_f32_16x16x32_f16 v[188:191], v[52:55], v[100:103], v[188:191]
    ds_read_b128 v[116:119], v248 offset:3936
    v_mfma_f32_16x16x32_f16 v[188:191], v[56:59], v[104:107], v[188:191]
    ds_read_b128 v[120:123], v248 offset:3872
    v_mfma_f32_16x16x32_f16 v[188:191], v[76:79], v[124:127], v[188:191]
    v_add_f32_dpp v144, v192, v144 row_ror:8 row_mask:0xf bank_mask:0xf
    v_add_f32_dpp v145, v193, v145 row_ror:8 row_mask:0xf bank_mask:0xf
    v_mfma_f32_16x16x32_f16 v[188:191], v[80:83], v[128:131], v[188:191]
    v_add_f32_dpp v146, v194, v146 row_ror:8 row_mask:0xf bank_mask:0xf
    v_add_f32_dpp v147, v195, v147 row_ror:8 row_mask:0xf bank_mask:0xf
    v_mfma_f32_16x16x32_f16 v[188:191], v[84:87], v[132:135], v[188:191]
    v_cvt_pkrtz_f16_f32 v144, v144, v145
    v_cvt_pkrtz_f16_f32 v145, v146, v147
    v_mfma_f32_16x16x32_f16 v[188:191], v[88:91], v[136:139], v[188:191]
    v_mfma_f32_16x16x32_f16 v[180:183], v[28:31], v[92:95], 0
    ds_write_b64 v251, v[144:145] offset:2560
    v_mfma_f32_16x16x32_f16 v[180:183], v[32:35], v[96:99], v[180:183]
    v_mfma_f32_16x16x32_f16 v[180:183], v[36:39], v[100:103], v[180:183]
    v_mfma_f32_16x16x32_f16 v[180:183], v[40:43], v[104:107], v[180:183]
    v_mfma_f32_16x16x32_f16 v[180:183], v[60:63], v[124:127], v[180:183]
    s_waitcnt lgkmcnt(0)
    s_barrier
    ds_read_b128 v[148:151], v249 offset:4096
    ds_read_b128 v[152:155], v249 offset:5120
    v_mfma_f32_16x16x32_f16 v[180:183], v[64:67], v[128:131], v[180:183]
    v_mov_b32_dpp v196, v188 quad_perm:[0,1,2,3] row_mask:0xf bank_mask:0x3
    v_mov_b32_dpp v197, v189 quad_perm:[0,1,2,3] row_mask:0xf bank_mask:0x3
    v_mfma_f32_16x16x32_f16 v[180:183], v[68:71], v[132:135], v[180:183]
    v_mov_b32_dpp v198, v190 quad_perm:[0,1,2,3] row_mask:0xf bank_mask:0x3
    v_mov_b32_dpp v199, v191 quad_perm:[0,1,2,3] row_mask:0xf bank_mask:0x3
    v_mfma_f32_16x16x32_f16 v[180:183], v[72:75], v[136:139], v[180:183]
    v_mfma_f32_16x16x32_f16 v[192:195], v[44:47], v[108:111], 0
    v_mfma_f32_16x16x32_f16 v[192:195], v[48:51], v[112:115], v[192:195]
    v_mfma_f32_16x16x32_f16 v[192:195], v[52:55], v[116:119], v[192:195]
    v_mfma_f32_16x16x32_f16 v[192:195], v[56:59], v[120:123], v[192:195]
    v_mfma_f32_16x16x32_f16 v[192:195], v[76:79], v[92:95], v[192:195]
    v_mfma_f32_16x16x32_f16 v[192:195], v[80:83], v[96:99], v[192:195]
    s_nop 1
    v_add_f32_dpp v180, v196, v180 row_ror:8 row_mask:0xf bank_mask:0xf
    v_add_f32_dpp v181, v197, v181 row_ror:8 row_mask:0xf bank_mask:0xf
    v_mfma_f32_16x16x32_f16 v[192:195], v[84:87], v[100:103], v[192:195]
    v_add_f32_dpp v182, v198, v182 row_ror:8 row_mask:0xf bank_mask:0xf
    v_add_f32_dpp v183, v199, v183 row_ror:8 row_mask:0xf bank_mask:0xf
    v_mfma_f32_16x16x32_f16 v[192:195], v[88:91], v[104:107], v[192:195]
    s_waitcnt lgkmcnt(1)
    v_add_f32 v180, v180, v148
    v_add_f32 v181, v181, v149
    s_waitcnt lgkmcnt(0)
    v_mfma_f32_16x16x32_f16 v[152:155], v[28:31], v[108:111], v[152:155]
    v_add_f32 v182, v182, v150
    v_add_f32 v183, v183, v151
    v_mfma_f32_16x16x32_f16 v[152:155], v[32:35], v[112:115], v[152:155]
    v_cvt_pkrtz_f16_f32 v180, v180, v181
    v_cvt_pkrtz_f16_f32 v181, v182, v183
    v_mfma_f32_16x16x32_f16 v[152:155], v[36:39], v[116:119], v[152:155]
    v_mfma_f32_16x16x32_f16 v[152:155], v[40:43], v[120:123], v[152:155]
    ds_write_b64 v251, v[180:181] offset:3072
    s_waitcnt lgkmcnt(0)
    s_barrier
    v_mfma_f32_16x16x32_f16 v[152:155], v[60:63], v[92:95], v[152:155]
    v_mfma_f32_16x16x32_f16 v[152:155], v[64:67], v[96:99], v[152:155]
    v_mov_b32_dpp v188, v192 quad_perm:[0,1,2,3] row_mask:0xf bank_mask:0x3
    v_mov_b32_dpp v189, v193 quad_perm:[0,1,2,3] row_mask:0xf bank_mask:0x3
    v_mfma_f32_16x16x32_f16 v[152:155], v[68:71], v[100:103], v[152:155]
    v_mov_b32_dpp v190, v194 quad_perm:[0,1,2,3] row_mask:0xf bank_mask:0x3
    v_mov_b32_dpp v191, v195 quad_perm:[0,1,2,3] row_mask:0xf bank_mask:0x3
    v_mfma_f32_16x16x32_f16 v[152:155], v[72:75], v[104:107], v[152:155]
    s_nop 7
    v_add_f32_dpp v152, v188, v152 row_ror:8 row_mask:0xf bank_mask:0xf
    v_add_f32_dpp v153, v189, v153 row_ror:8 row_mask:0xf bank_mask:0xf
    v_add_f32_dpp v154, v190, v154 row_ror:8 row_mask:0xf bank_mask:0xf
    v_add_f32_dpp v155, v191, v155 row_ror:8 row_mask:0xf bank_mask:0xf
    v_cvt_pkrtz_f16_f32 v152, v152, v153
    v_cvt_pkrtz_f16_f32 v153, v154, v155
    ds_write_b64 v251, v[152:153] offset:3584
    s_waitcnt lgkmcnt(0)
    s_barrier
    s_waitcnt vmcnt(0)
    s_branch RPREP
H_PATH:
    s_waitcnt lgkmcnt(0)
    s_barrier
    v_and_b32 v34, 3, v1
    v_mul_u32_u24 v34, 4640, v34
    v_lshrrev_b32 v35, 2, v1
    v_lshl_add_u32 v34, v35, 4, v34
    s_mul_i32 s46, s51, 768
    s_add_u32 s46, s46, 114560
    v_add_u32 v254, s46, v34
    v_and_b32 v14, 15, v1
    v_lshrrev_b32 v15, 4, v1
    s_mul_i32 s46, s51, 4640
    s_add_u32 s46, s46, 114048
    v_lshlrev_b32 v248, 5, v14
    v_lshl_add_u32 v248, v15, 4, v248
    v_add_u32 v248, s46, v248
    s_cmp_lt_u32 s49, 128
    s_cbranch_scc1 H_UI
    v_subrev_u32 v14, 9472, v25
    v_subrev_u32 v15, 9472, v26
    ds_read_b128 v[224:227], v14
    ds_read_b128 v[228:231], v14 offset:512
    ds_read_b32 v232, v15 offset:1024
    s_mov_b32 s46, 10485760
    s_waitcnt lgkmcnt(0)
    v_add_u32 v224, v11, v224
    v_add_u32 v225, v11, v225
    v_add_u32 v226, v11, v226
    v_add_u32 v227, v11, v227
    v_add_u32 v228, v11, v228
    v_add_u32 v229, v11, v229
    v_add_u32 v230, v11, v230
    v_add_u32 v231, v11, v231
    v_add_u32 v232, v11, v232
    v_and_or_b32 v224, v224, v9, v10
    v_and_or_b32 v225, v225, v9, v10
    v_and_or_b32 v226, v226, v9, v10
    v_and_or_b32 v227, v227, v9, v10
    v_and_or_b32 v228, v228, v9, v10
    v_and_or_b32 v229, v229, v9, v10
    v_and_or_b32 v230, v230, v9, v10
    v_and_or_b32 v231, v231, v9, v10
    v_and_or_b32 v232, v232, v9, v10
    buffer_store_dwordx4 v[224:227], v4, s[32:35], s46 offen sc1
    buffer_store_dwordx4 v[228:231], v4, s[32:35], s46 offen offset:512 sc1
    buffer_store_dword v232, v5, s[32:35], s46 offen offset:1024 sc1
    s_mov_b32 s47, 0
    s_waitcnt vmcnt(3)
    s_branch H_UE
H_UI:
    s_mov_b32 s47, 0
PL2:
    s_waitcnt vmcnt(0)
H_UE:
    v_xor_b32 v200, v10, v200
    v_xor_b32 v201, v10, v201
    v_xor_b32 v202, v10, v202
    v_xor_b32 v203, v10, v203
    v_xor_b32 v204, v10, v204
    v_xor_b32 v205, v10, v205
    v_xor_b32 v206, v10, v206
    v_xor_b32 v207, v10, v207
    v_xor_b32 v208, v10, v208
    v_xor_b32 v209, v10, v209
    v_xor_b32 v210, v10, v210
    v_xor_b32 v211, v10, v211
    v_or3_b32 v14, v200, v201, v202
    v_or3_b32 v14, v14, v203, v204
    v_or3_b32 v14, v14, v205, v206
    v_or3_b32 v14, v14, v207, v208
    v_or3_b32 v14, v14, v209, v210
    v_or_b32 v14, v14, v211
    v_and_b32 v14, 0x70007, v14
    v_cmp_ne_u32 vcc, 0, v14
    s_cbranch_vccz PD3
    s_add_u32 s47, s47, 1
    s_cmp_ge_u32 s47, 262144
    s_cbranch_scc1 PD3
    s_sleep 2
    buffer_load_dwordx4 v[200:203], v2, s[32:35], s48 offen offset:0 sc1
    buffer_load_dwordx4 v[204:207], v2, s[32:35], s48 offen offset:1024 sc1
    buffer_load_dwordx4 v[208:211], v2, s[32:35], s48 offen offset:2048 sc1
    s_branch PL2
PD3:
    ds_write_b128 v254, v[200:203] offset:0
    ds_write_b128 v254, v[204:207] offset:256
    ds_write_b128 v254, v[208:211] offset:512
    buffer_load_dwordx4 v[244:247], v2, s[32:35], s59 offen sc1
    s_lshl_b32 s46, s51, 9
    v_subrev_u32 v254, s46, v254
    v_and_b32 v14, 15, v1
    v_lshrrev_b32 v15, 4, v1
    s_mul_i32 s46, s51, 6144
    s_add_u32 s46, s46, 20480
    v_add_u32 v249, s46, v2
    v_lshlrev_b32 v250, 3, v15
    v_sub_u32 v250, v250, v14
    v_add_u32 v250, 15, v250
    v_and_b32 v34, 1, v250
    v_mul_u32_u24 v34, 1090, v34
    v_lshl_add_u32 v250, v250, 1, v34
    v_add_u32 v250, s62, v250
    v_lshlrev_b32 v251, 2, v15
    v_sub_u32 v251, v251, v14
    v_lshlrev_b32 v251, 2, v251
    s_add_u32 s46, s62, 2252
    v_add_u32 v251, s46, v251
    v_bfe_u32 v34, v1, 2, 2
    v_mul_u32_u24 v34, 4128, v34
    v_and_b32 v35, 1, v1
    v_lshl_add_u32 v34, v35, 7, v34
    v_lshl_add_u32 v34, v15, 4, v34
    v_and_b32 v35, 2, v1
    v_lshl_add_u32 v34, v35, 2, v34
    s_and_b32 s46, s3, 1
    s_lshl_b32 s46, s46, 6
    v_add_u32 v252, s46, v34
    v_lshrrev_b32 v34, 3, v1
    v_mul_u32_u24 v34, 18432, v34
    v_and_b32 v35, 7, v1
    v_lshl_add_u32 v253, v35, 4, v34
    s_and_b32 s46, s3, 1
    s_mul_i32 s46, s46, 147456
    s_lshl_b32 s63, s2, 7
    s_add_u32 s63, s63, s46
    s_add_u32 s63, s63, 4194304
    v_mov_b32 v15, s62
    s_setprio 1
    s_waitcnt lgkmcnt(0)
    s_barrier
    ds_read_b128 v[28:31], v248 offset:480
    ds_read_b128 v[32:35], v248 offset:464
    ds_read_b128 v[36:39], v248 offset:992
    ds_read_b128 v[40:43], v248 offset:976
    s_waitcnt lgkmcnt(3)
    v_mfma_f32_16x16x32_f16 v[76:79], v[28:31], v[172:175], 0
    v_mfma_f32_16x16x32_f16 v[80:83], v[28:31], v[168:171], 0
    v_mfma_f32_16x16x32_f16 v[88:91], v[28:31], v[176:179], 0
    s_waitcnt lgkmcnt(2)
    v_mfma_f32_16x16x32_f16 v[84:87], v[32:35], v[180:183], 0
    ds_read_b128 v[44:47], v248 offset:1504
    ds_read_b128 v[48:51], v248 offset:1488
    v_mfma_f32_16x16x32_f16 v[92:95], v[28:31], v[184:187], 0
    s_nop 1
    v_cvt_pk_f16_f32 v100, v76, v80
    v_cvt_pk_f16_f32 v101, v77, v81
    v_mfma_f32_16x16x32_f16 v[96:99], v[32:35], v[188:191], 0
    v_cvt_pk_f16_f32 v102, v78, v82
    v_cvt_pk_f16_f32 v103, v79, v83
    s_waitcnt lgkmcnt(3)
    v_mfma_f32_16x16x32_f16 v[76:79], v[36:39], v[172:175], 0
    v_cvt_pk_f16_f32 v104, v84, v88
    v_cvt_pk_f16_f32 v105, v85, v89
    v_mfma_f32_16x16x32_f16 v[80:83], v[36:39], v[168:171], 0
    v_cvt_pk_f16_f32 v106, v86, v90
    v_cvt_pk_f16_f32 v107, v87, v91
    v_mfma_f32_16x16x32_f16 v[88:91], v[36:39], v[176:179], 0
    v_cvt_pk_f16_f32 v148, v92, v96
    v_cvt_pk_f16_f32 v149, v93, v97
    s_waitcnt lgkmcnt(2)
    v_mfma_f32_16x16x32_f16 v[84:87], v[40:43], v[180:183], 0
    v_cvt_pk_f16_f32 v150, v94, v98
    v_cvt_pk_f16_f32 v151, v95, v99
    ds_read_b128 v[52:55], v248 offset:2016
    ds_read_b128 v[56:59], v248 offset:2000
    v_mfma_f32_16x16x32_f16 v[92:95], v[36:39], v[184:187], 0
    v_cvt_pk_f16_f32 v108, v76, v80
    v_cvt_pk_f16_f32 v109, v77, v81
    v_mfma_f32_16x16x32_f16 v[96:99], v[40:43], v[188:191], 0
    v_cvt_pk_f16_f32 v110, v78, v82
    v_cvt_pk_f16_f32 v111, v79, v83
    s_waitcnt lgkmcnt(3)
    v_mfma_f32_16x16x32_f16 v[76:79], v[44:47], v[172:175], 0
    v_cvt_pk_f16_f32 v112, v84, v88
    v_cvt_pk_f16_f32 v113, v85, v89
    v_mfma_f32_16x16x32_f16 v[80:83], v[44:47], v[168:171], 0
    v_cvt_pk_f16_f32 v114, v86, v90
    v_cvt_pk_f16_f32 v115, v87, v91
    ds_read_b128 v[60:63], v248 offset:2528
    ds_read_b128 v[64:67], v248 offset:2512
    v_mfma_f32_16x16x32_f16 v[88:91], v[44:47], v[176:179], 0
    v_cvt_pk_f16_f32 v152, v92, v96
    v_cvt_pk_f16_f32 v153, v93, v97
    s_waitcnt lgkmcnt(4)
    v_mfma_f32_16x16x32_f16 v[84:87], v[48:51], v[180:183], 0
    v_cvt_pk_f16_f32 v154, v94, v98
    v_cvt_pk_f16_f32 v155, v95, v99
    v_mfma_f32_16x16x32_f16 v[92:95], v[44:47], v[184:187], 0
    v_cvt_pk_f16_f32 v116, v76, v80
    v_cvt_pk_f16_f32 v117, v77, v81
    v_mfma_f32_16x16x32_f16 v[96:99], v[48:51], v[188:191], 0
    v_cvt_pk_f16_f32 v118, v78, v82
    v_cvt_pk_f16_f32 v119, v79, v83
    ds_read_b128 v[68:71], v248 offset:3040
    ds_read_b128 v[72:75], v248 offset:3024
    s_waitcnt lgkmcnt(5)
    v_mfma_f32_16x16x32_f16 v[76:79], v[52:55], v[172:175], 0
    v_cvt_pk_f16_f32 v120, v84, v88
    v_cvt_pk_f16_f32 v121, v85, v89
    v_mfma_f32_16x16x32_f16 v[80:83], v[52:55], v[168:171], 0
    v_cvt_pk_f16_f32 v122, v86, v90
    v_cvt_pk_f16_f32 v123, v87, v91
    v_mfma_f32_16x16x32_f16 v[88:91], v[52:55], v[176:179], 0
    v_cvt_pk_f16_f32 v156, v92, v96
    v_cvt_pk_f16_f32 v157, v93, v97
    s_waitcnt lgkmcnt(4)
    v_mfma_f32_16x16x32_f16 v[84:87], v[56:59], v[180:183], 0
    v_cvt_pk_f16_f32 v158, v94, v98
    v_cvt_pk_f16_f32 v159, v95, v99
    ds_read2_b32 v[196:197], v250 offset0:0 offset1:1
    ds_read2_b32 v[198:199], v250 offset0:2 offset1:3
    v_mfma_f32_16x16x32_f16 v[92:95], v[52:55], v[184:187], 0
    v_cvt_pk_f16_f32 v124, v76, v80
    v_cvt_pk_f16_f32 v125, v77, v81
    v_mfma_f32_16x16x32_f16 v[96:99], v[56:59], v[188:191], 0
    v_cvt_pk_f16_f32 v126, v78, v82
    v_cvt_pk_f16_f32 v127, v79, v83
    ds_read2_b32 v[200:201], v251 offset0:32 offset1:33
    ds_read2_b32 v[202:203], v251 offset0:34 offset1:35
    s_waitcnt lgkmcnt(7)
    v_mfma_f32_16x16x32_f16 v[76:79], v[60:63], v[172:175], 0
    v_cvt_pk_f16_f32 v128, v84, v88
    v_cvt_pk_f16_f32 v129, v85, v89
    v_mfma_f32_16x16x32_f16 v[80:83], v[60:63], v[168:171], 0
    v_cvt_pk_f16_f32 v130, v86, v90
    v_cvt_pk_f16_f32 v131, v87, v91
    ds_read2_b32 v[204:205], v251 offset0:80 offset1:81
    ds_read2_b32 v[206:207], v251 offset0:82 offset1:83
    v_mfma_f32_16x16x32_f16 v[88:91], v[60:63], v[176:179], 0
    v_cvt_pk_f16_f32 v160, v92, v96
    v_cvt_pk_f16_f32 v161, v93, v97
    s_waitcnt lgkmcnt(8)
    v_mfma_f32_16x16x32_f16 v[84:87], v[64:67], v[180:183], 0
    v_cvt_pk_f16_f32 v162, v94, v98
    v_cvt_pk_f16_f32 v163, v95, v99
    ds_read2_b32 v[208:209], v251 offset0:16 offset1:17
    ds_read2_b32 v[210:211], v251 offset0:18 offset1:19
    s_waitcnt lgkmcnt(9)
    v_mfma_f32_16x16x32_f16 v[92:95], v[68:71], v[172:175], 0
    v_cvt_pk_f16_f32 v132, v76, v80
    v_cvt_pk_f16_f32 v133, v77, v81
    v_mfma_f32_16x16x32_f16 v[96:99], v[68:71], v[168:171], 0
    v_cvt_pk_f16_f32 v134, v78, v82
    v_cvt_pk_f16_f32 v135, v79, v83
    ds_read2_b32 v[212:213], v251 offset0:64 offset1:65
    ds_read2_b32 v[214:215], v251 offset0:66 offset1:67
    v_mfma_f32_16x16x32_f16 v[80:83], v[68:71], v[176:179], 0
    v_cvt_pk_f16_f32 v136, v84, v88
    v_cvt_pk_f16_f32 v137, v85, v89
    s_waitcnt lgkmcnt(10)
    v_mfma_f32_16x16x32_f16 v[76:79], v[72:75], v[180:183], 0
    v_cvt_pk_f16_f32 v138, v86, v90
    v_cvt_pk_f16_f32 v139, v87, v91
    ds_read_u16 v15, v15 offset:2448
    s_waitcnt lgkmcnt(9)
    v_mfma_f32_16x16x32_f16 v[164:167], v[196:199], v[28:31], 0
    v_cvt_pk_f16_f32 v140, v92, v96
    v_cvt_pk_f16_f32 v141, v93, v97
    s_waitcnt lgkmcnt(7)
    v_mfma_f32_16x16x32_f16 v[164:167], v[100:103], v[200:203], v[164:167]
    v_cvt_pk_f16_f32 v142, v94, v98
    v_cvt_pk_f16_f32 v143, v95, v99
    s_waitcnt lgkmcnt(5)
    v_mfma_f32_16x16x32_f16 v[164:167], v[104:107], v[204:207], v[164:167]
    v_cvt_pk_f16_f32 v144, v76, v80
    v_cvt_pk_f16_f32 v145, v77, v81
    v_mfma_f32_16x16x32_f16 v[240:243], v[196:199], v[36:39], 0
    v_cvt_pk_f16_f32 v146, v78, v82
    v_cvt_pk_f16_f32 v147, v79, v83
    v_mfma_f32_16x16x32_f16 v[240:243], v[108:111], v[200:203], v[240:243]
    s_waitcnt lgkmcnt(0)
    v_lshl_or_b32 v15, v15, 16, v15
    v_and_b32 v192, v15, v192
    v_and_b32 v193, v15, v193
    v_and_b32 v194, v15, v194
    v_and_b32 v195, v15, v195
    v_mfma_f32_16x16x32_f16 v[240:243], v[112:115], v[204:207], v[240:243]
    ds_read2_b32 v[216:217], v251 offset0:0 offset1:1
    ds_read2_b32 v[218:219], v251 offset0:2 offset1:3
    v_mfma_f32_16x16x32_f16 v[240:243], v[100:103], v[208:211], v[240:243]
    ds_read2_b32 v[220:221], v251 offset0:48 offset1:49
    ds_read2_b32 v[222:223], v251 offset0:50 offset1:51
    v_mfma_f32_16x16x32_f16 v[240:243], v[104:107], v[212:215], v[240:243]
    ds_write_b128 v249, v[164:167] offset:0
    ds_read2_b32 v[224:225], v251 offset0:160 offset1:161
    ds_read2_b32 v[226:227], v251 offset0:162 offset1:163
    s_mov_b32 s47, 0
PL4:
    s_waitcnt vmcnt(0)
    v_xor_b32 v244, v10, v244
    v_xor_b32 v245, v10, v245
    v_xor_b32 v246, v10, v246
    v_xor_b32 v247, v10, v247
    v_or3_b32 v14, v244, v245, v246
    v_or_b32 v14, v14, v247
    v_and_b32 v14, 0x70007, v14
    v_cmp_ne_u32 vcc, 0, v14
    s_cbranch_vccz PD5
    s_add_u32 s47, s47, 1
    s_cmp_ge_u32 s47, 262144
    s_cbranch_scc1 PD5
    s_sleep 2
    buffer_load_dwordx4 v[244:247], v2, s[32:35], s59 offen sc1
    s_branch PL4
PD5:
    ds_write_b128 v254, v[244:247] offset:3072
    s_bitcmp1_b32 s3, 1
    s_cselect_b32 s46, 1, 0
    s_lshl_b32 s50, s46, 9
    v_add_u32 v15, s50, v252
    s_mul_i32 s46, s46, 294912
    s_add_u32 s46, s46, s63
    ds_write_b128 v249, v[240:243] offset:1024
    s_waitcnt lgkmcnt(0)
    s_barrier
    ds_read_b64_tr_b16 v[244:245], v15 offset:0
    ds_read_b64_tr_b16 v[246:247], v15 offset:256
    v_mfma_f32_16x16x32_f16 v[164:167], v[196:199], v[44:47], 0
    ds_read2_b32 v[228:229], v251 offset0:144 offset1:145
    ds_read2_b32 v[230:231], v251 offset0:146 offset1:147
    v_mfma_f32_16x16x32_f16 v[164:167], v[116:119], v[200:203], v[164:167]
    ds_read2_b32 v[232:233], v251 offset0:128 offset1:129
    ds_read2_b32 v[234:235], v251 offset0:130 offset1:131
    v_mfma_f32_16x16x32_f16 v[164:167], v[120:123], v[204:207], v[164:167]
    s_mov_b32 s57, 10485760
    buffer_load_dwordx4 v[72:75], v4, s[32:35], s57 offen sc1
    buffer_load_dwordx4 v[76:79], v4, s[32:35], s57 offen offset:512 sc1
    buffer_load_dword v80, v5, s[32:35], s57 offen offset:1024 sc1
    global_load_dwordx4 v[16:19], v4, s[4:5]
    global_load_dwordx4 v[20:23], v4, s[4:5] offset:512
    global_load_dword v24, v5, s[4:5] offset:1024
    v_mfma_f32_16x16x32_f16 v[164:167], v[108:111], v[208:211], v[164:167]
    ds_read2_b32 v[236:237], v251 offset0:112 offset1:113
    ds_read2_b32 v[238:239], v251 offset0:114 offset1:115
    v_mfma_f32_16x16x32_f16 v[164:167], v[112:115], v[212:215], v[164:167]
    s_lshl_b32 s57, s51, 6
    v_add_u32 v14, s57, v1
    v_min_u32 v14, 143, v14
    v_lshlrev_b32 v27, 7, v14
    v_lshlrev_b32 v14, 4, v14
    s_mov_b32 s53, 32768
    buffer_load_dwordx4 v[32:35], v27, s[32:35], s53 offen sc1
    v_mfma_f32_16x16x32_f16 v[164:167], v[100:103], v[216:219], v[164:167]
    v_mfma_f32_16x16x32_f16 v[164:167], v[104:107], v[220:223], v[164:167]
    s_waitcnt lgkmcnt(6)
    v_add_u32 v244, v11, v244
    v_add_u32 v245, v11, v245
    v_add_u32 v246, v11, v246
    v_add_u32 v247, v11, v247
    v_and_or_b32 v244, v244, v9, v10
    v_and_or_b32 v245, v245, v9, v10
    v_and_or_b32 v246, v246, v9, v10
    v_and_or_b32 v247, v247, v9, v10
    buffer_store_dwordx4 v[244:247], v253, s[32:35], s46 offen sc1
    v_mfma_f32_16x16x32_f16 v[164:167], v[192:195], v[28:31], v[164:167]
    v_mfma_f32_16x16x32_f16 v[164:167], v[148:151], v[224:227], v[164:167]
    v_mfma_f32_16x16x32_f16 v[240:243], v[196:199], v[52:55], 0
    v_mfma_f32_16x16x32_f16 v[240:243], v[124:127], v[200:203], v[240:243]
    v_mfma_f32_16x16x32_f16 v[240:243], v[128:131], v[204:207], v[240:243]
    v_mfma_f32_16x16x32_f16 v[240:243], v[116:119], v[208:211], v[240:243]
    v_mfma_f32_16x16x32_f16 v[240:243], v[120:123], v[212:215], v[240:243]
    v_mfma_f32_16x16x32_f16 v[240:243], v[108:111], v[216:219], v[240:243]
    v_mfma_f32_16x16x32_f16 v[240:243], v[112:115], v[220:223], v[240:243]
    v_mfma_f32_16x16x32_f16 v[240:243], v[192:195], v[36:39], v[240:243]
    ds_write_b128 v249, v[164:167] offset:2048
    v_mfma_f32_16x16x32_f16 v[240:243], v[152:155], v[224:227], v[240:243]
    s_waitcnt lgkmcnt(5)
    v_mfma_f32_16x16x32_f16 v[240:243], v[148:151], v[228:231], v[240:243]
    v_mfma_f32_16x16x32_f16 v[164:167], v[196:199], v[60:63], 0
    v_mfma_f32_16x16x32_f16 v[164:167], v[132:135], v[200:203], v[164:167]
    v_mfma_f32_16x16x32_f16 v[164:167], v[136:139], v[204:207], v[164:167]
    v_mfma_f32_16x16x32_f16 v[164:167], v[124:127], v[208:211], v[164:167]
    v_mfma_f32_16x16x32_f16 v[164:167], v[128:131], v[212:215], v[164:167]
    v_mfma_f32_16x16x32_f16 v[164:167], v[116:119], v[216:219], v[164:167]
    v_mfma_f32_16x16x32_f16 v[164:167], v[120:123], v[220:223], v[164:167]
    v_mfma_f32_16x16x32_f16 v[164:167], v[192:195], v[44:47], v[164:167]
    ds_write_b128 v249, v[240:243] offset:3072
    v_mfma_f32_16x16x32_f16 v[164:167], v[156:159], v[224:227], v[164:167]
    v_mfma_f32_16x16x32_f16 v[164:167], v[152:155], v[228:231], v[164:167]
    s_waitcnt lgkmcnt(4)
    v_mfma_f32_16x16x32_f16 v[164:167], v[148:151], v[232:235], v[164:167]
    v_mfma_f32_16x16x32_f16 v[240:243], v[196:199], v[68:71], 0
    v_mfma_f32_16x16x32_f16 v[240:243], v[140:143], v[200:203], v[240:243]
    v_mfma_f32_16x16x32_f16 v[240:243], v[144:147], v[204:207], v[240:243]
    v_mfma_f32_16x16x32_f16 v[240:243], v[132:135], v[208:211], v[240:243]
    v_mfma_f32_16x16x32_f16 v[240:243], v[136:139], v[212:215], v[240:243]
    v_mfma_f32_16x16x32_f16 v[240:243], v[124:127], v[216:219], v[240:243]
    v_mfma_f32_16x16x32_f16 v[240:243], v[128:131], v[220:223], v[240:243]
    v_mfma_f32_16x16x32_f16 v[240:243], v[192:195], v[52:55], v[240:243]
    ds_write_b128 v249, v[164:167] offset:4096
    v_mfma_f32_16x16x32_f16 v[240:243], v[160:163], v[224:227], v[240:243]
    v_mfma_f32_16x16x32_f16 v[240:243], v[156:159], v[228:231], v[240:243]
    v_mfma_f32_16x16x32_f16 v[240:243], v[152:155], v[232:235], v[240:243]
    s_waitcnt lgkmcnt(3)
    v_mfma_f32_16x16x32_f16 v[240:243], v[148:151], v[236:239], v[240:243]
    s_bitcmp1_b32 s3, 1
    s_cselect_b32 s46, 3, 2
    s_lshl_b32 s50, s46, 9
    v_add_u32 v15, s50, v252
    s_mul_i32 s46, s46, 294912
    s_add_u32 s46, s46, s63
    s_nop 1
    ds_write_b128 v249, v[240:243] offset:5120
    s_waitcnt lgkmcnt(0)
    s_barrier
    ds_read_b64_tr_b16 v[244:245], v15 offset:0
    ds_read_b64_tr_b16 v[246:247], v15 offset:256
    s_waitcnt lgkmcnt(0)
    v_add_u32 v244, v11, v244
    v_add_u32 v245, v11, v245
    v_add_u32 v246, v11, v246
    v_add_u32 v247, v11, v247
    v_and_or_b32 v244, v244, v9, v10
    v_and_or_b32 v245, v245, v9, v10
    v_and_or_b32 v246, v246, v9, v10
    v_and_or_b32 v247, v247, v9, v10
    buffer_store_dwordx4 v[244:247], v253, s[32:35], s46 offen sc1
    s_setprio 0
    s_and_b32 s56, s40, 0x7fffff
    s_mov_b32 s47, 0
    s_waitcnt vmcnt(2)
SCP6:
    v_xor_b32 v32, s56, v32
    v_xor_b32 v33, s56, v33
    v_xor_b32 v34, s56, v34
    v_xor_b32 v35, s56, v35
    v_or3_b32 v255, v32, v33, v34
    v_or_b32 v255, v255, v35
    v_and_b32 v255, 0x7fffff, v255
    v_cmp_ne_u32 vcc, 0, v255
    s_cbranch_vccz SCD7
    s_add_u32 s47, s47, 1
    s_cmp_ge_u32 s47, 262144
    s_cbranch_scc1 SCD7
    s_sleep 8
    buffer_load_dwordx4 v[32:35], v27, s[32:35], s53 offen sc1
    s_waitcnt vmcnt(0)
    s_branch SCP6
SCD7:
    ds_write_b128 v14, v[32:35] offset:46080
    s_cmp_ge_u32 s49, 128
    s_cbranch_scc1 H_NOR
    global_load_dwordx4 v[208:211], v12, s[16:17]
    global_load_dwordx4 v[212:215], v12, s[16:17] offset:512
    global_load_dword v216, v13, s[16:17] offset:1024
    global_load_dwordx4 v[218:221], v12, s[20:21]
    global_load_dwordx4 v[222:225], v12, s[20:21] offset:512
    global_load_dword v226, v13, s[20:21] offset:1024
H_NOR:
    s_bitcmp1_b32 s3, 1
    s_cselect_b32 s46, 5, 4
    s_lshl_b32 s50, s46, 9
    v_add_u32 v15, s50, v252
    s_mul_i32 s46, s46, 294912
    s_add_u32 s46, s46, s63
    s_waitcnt lgkmcnt(0)
    s_barrier
    ds_read_b64_tr_b16 v[244:245], v15 offset:0
    ds_read_b64_tr_b16 v[246:247], v15 offset:256
    s_waitcnt lgkmcnt(0)
    v_add_u32 v244, v11, v244
    v_add_u32 v245, v11, v245
    v_add_u32 v246, v11, v246
    v_add_u32 v247, v11, v247
    v_and_or_b32 v244, v244, v9, v10
    v_and_or_b32 v245, v245, v9, v10
    v_and_or_b32 v246, v246, v9, v10
    v_and_or_b32 v247, v247, v9, v10
    buffer_store_dwordx4 v[244:247], v253, s[32:35], s46 offen sc1
    s_add_u32 s46, s63, 1769472
    s_bitcmp1_b32 s3, 1
    s_waitcnt lgkmcnt(0)
    s_barrier
    s_cbranch_scc1 YS8
    ds_read_b64_tr_b16 v[244:245], v252 offset:3072
    ds_read_b64_tr_b16 v[246:247], v252 offset:3328
    s_waitcnt lgkmcnt(0)
    v_add_u32 v244, v11, v244
    v_add_u32 v245, v11, v245
    v_add_u32 v246, v11, v246
    v_add_u32 v247, v11, v247
    v_and_or_b32 v244, v244, v9, v10
    v_and_or_b32 v245, v245, v9, v10
    v_and_or_b32 v246, v246, v9, v10
    v_and_or_b32 v247, v247, v9, v10
    buffer_store_dwordx4 v[244:247], v253, s[32:35], s46 offen sc1
YS8:
    s_add_u32 s46, s63, 2064384
    s_bitcmp1_b32 s3, 1
    s_waitcnt lgkmcnt(0)
    s_barrier
    s_cbranch_scc0 YS9
    ds_read_b64_tr_b16 v[244:245], v252 offset:3584
    ds_read_b64_tr_b16 v[246:247], v252 offset:3840
    s_waitcnt lgkmcnt(0)
    v_add_u32 v244, v11, v244
    v_add_u32 v245, v11, v245
    v_add_u32 v246, v11, v246
    v_add_u32 v247, v11, v247
    v_and_or_b32 v244, v244, v9, v10
    v_and_or_b32 v245, v245, v9, v10
    v_and_or_b32 v246, v246, v9, v10
    v_and_or_b32 v247, v247, v9, v10
    buffer_store_dwordx4 v[244:247], v253, s[32:35], s46 offen sc1
YS9:
RPREP:
    s_cmp_ge_u32 s49, 128
    s_cbranch_scc1 ZROLE
    s_cmp_lg_u32 s61, 0
    s_cselect_b32 s39, 1, 0
    s_cbranch_scc1 RP_U0
    ds_read_b128 v[72:75], v25
    ds_read_b128 v[76:79], v25 offset:512
    ds_read_b32 v80, v26 offset:1024
RP_U0:
    v_lshlrev_b32 v38, 1, v12
    v_lshlrev_b32 v39, 1, v13
    s_mul_i32 s60, s49, 18432
    s_add_u32 s60, s60, 4194304
    s_add_u32 s61, s60, 8192
    s_add_u32 s62, s60, 16384
    v_mov_b32 v204, 0
    s_waitcnt vmcnt(2)
    s_cmp_ge_u32 s49, 64
    s_cbranch_scc1 RP_0
    buffer_load_dwordx4 v[140:143], v3, s[32:35], s60 offen sc1
    buffer_load_dwordx4 v[144:147], v3, s[32:35], s61 offen sc1
    s_cmp_ge_u32 s3, 2
    s_cbranch_scc1 YL10
    buffer_load_dwordx4 v[148:151], v3, s[32:35], s62 offen sc1
YL10:
RP_0:
    v_lshlrev_b32 v84, 16, v208
    v_and_b32 v85, 0xffff0000, v208
    v_lshlrev_b32 v120, 16, v218
    v_and_b32 v121, 0xffff0000, v218
    v_dot2c_f32_bf16 v204, v218, v8
    v_lshlrev_b32 v86, 16, v209
    v_and_b32 v87, 0xffff0000, v209
    v_lshlrev_b32 v122, 16, v219
    v_and_b32 v123, 0xffff0000, v219
    v_dot2c_f32_bf16 v204, v219, v8
    v_lshlrev_b32 v88, 16, v210
    v_and_b32 v89, 0xffff0000, v210
    v_lshlrev_b32 v124, 16, v220
    v_and_b32 v125, 0xffff0000, v220
    v_dot2c_f32_bf16 v204, v220, v8
    v_lshlrev_b32 v90, 16, v211
    v_and_b32 v91, 0xffff0000, v211
    v_lshlrev_b32 v126, 16, v221
    v_and_b32 v127, 0xffff0000, v221
    v_dot2c_f32_bf16 v204, v221, v8
    v_lshlrev_b32 v92, 16, v212
    v_and_b32 v93, 0xffff0000, v212
    v_lshlrev_b32 v128, 16, v222
    v_and_b32 v129, 0xffff0000, v222
    v_dot2c_f32_bf16 v204, v222, v8
    v_lshlrev_b32 v94, 16, v213
    v_and_b32 v95, 0xffff0000, v213
    v_lshlrev_b32 v130, 16, v223
    v_and_b32 v131, 0xffff0000, v223
    v_dot2c_f32_bf16 v204, v223, v8
    v_lshlrev_b32 v96, 16, v214
    v_and_b32 v97, 0xffff0000, v214
    v_lshlrev_b32 v132, 16, v224
    v_and_b32 v133, 0xffff0000, v224
    v_dot2c_f32_bf16 v204, v224, v8
    v_lshlrev_b32 v98, 16, v215
    v_and_b32 v99, 0xffff0000, v215
    v_lshlrev_b32 v134, 16, v225
    v_and_b32 v135, 0xffff0000, v225
    v_dot2c_f32_bf16 v204, v225, v8
    v_lshlrev_b32 v100, 16, v216
    v_and_b32 v101, 0xffff0000, v216
    v_lshlrev_b32 v136, 16, v226
    v_and_b32 v137, 0xffff0000, v226
    v_dot2c_f32_bf16 v204, v226, v8
    s_waitcnt lgkmcnt(0)
    s_cmp_lg_u32 s39, 0
    s_cbranch_scc1 RP_U1
    v_add_u32 v72, v11, v72
    v_add_u32 v73, v11, v73
    v_add_u32 v74, v11, v74
    v_add_u32 v75, v11, v75
    v_add_u32 v76, v11, v76
    v_add_u32 v77, v11, v77
    v_add_u32 v78, v11, v78
    v_add_u32 v79, v11, v79
    v_add_u32 v80, v11, v80
    v_and_b32 v72, v9, v72
    v_and_b32 v73, v9, v73
    v_and_b32 v74, v9, v74
    v_and_b32 v75, v9, v75
    v_and_b32 v76, v9, v76
    v_and_b32 v77, v9, v77
    v_and_b32 v78, v9, v78
    v_and_b32 v79, v9, v79
    v_and_b32 v80, v9, v80
    s_branch RP_U2
RP_U1:
    s_mov_b32 s47, 0
RP_U3:
    v_xor_b32 v72, v10, v72
    v_xor_b32 v73, v10, v73
    v_xor_b32 v74, v10, v74
    v_xor_b32 v75, v10, v75
    v_xor_b32 v76, v10, v76
    v_xor_b32 v77, v10, v77
    v_xor_b32 v78, v10, v78
    v_xor_b32 v79, v10, v79
    v_xor_b32 v80, v10, v80
    v_or3_b32 v37, v72, v73, v74
    v_or3_b32 v37, v37, v75, v76
    v_or3_b32 v37, v37, v77, v78
    v_or3_b32 v37, v37, v79, v80
    v_and_b32 v37, 0x70007, v37
    v_cmp_ne_u32 vcc, 0, v37
    s_cbranch_vccz RP_U2
    s_add_u32 s47, s47, 1
    s_cmp_ge_u32 s47, 262144
    s_cbranch_scc1 RP_U2
    s_sleep 4
    s_mov_b32 s57, 10485760
    buffer_load_dwordx4 v[72:75], v4, s[32:35], s57 offen sc1
    buffer_load_dwordx4 v[76:79], v4, s[32:35], s57 offen offset:512 sc1
    buffer_load_dword v80, v5, s[32:35], s57 offen offset:1024 sc1
    s_waitcnt vmcnt(0)
    s_branch RP_U3
RP_U2:
    v_fma_mix_f32 v84, v72, v84, 0 op_sel:[0,0,0] op_sel_hi:[1,0,0]
    v_fma_mix_f32 v85, v72, v85, 0 op_sel:[1,0,0] op_sel_hi:[1,0,0]
    v_fma_mix_f32 v86, v73, v86, 0 op_sel:[0,0,0] op_sel_hi:[1,0,0]
    v_add_f32_dpp v204, v204, v204 row_ror:8 row_mask:0xf bank_mask:0xf
    v_fma_mix_f32 v87, v73, v87, 0 op_sel:[1,0,0] op_sel_hi:[1,0,0]
    v_fma_mix_f32 v88, v74, v88, 0 op_sel:[0,0,0] op_sel_hi:[1,0,0]
    v_fma_mix_f32 v89, v74, v89, 0 op_sel:[1,0,0] op_sel_hi:[1,0,0]
    v_fma_mix_f32 v90, v75, v90, 0 op_sel:[0,0,0] op_sel_hi:[1,0,0]
    v_fma_mix_f32 v91, v75, v91, 0 op_sel:[1,0,0] op_sel_hi:[1,0,0]
    v_add_f32_dpp v204, v204, v204 row_ror:4 row_mask:0xf bank_mask:0xf
    v_fma_mix_f32 v92, v76, v92, 0 op_sel:[0,0,0] op_sel_hi:[1,0,0]
    v_fma_mix_f32 v93, v76, v93, 0 op_sel:[1,0,0] op_sel_hi:[1,0,0]
    v_fma_mix_f32 v94, v77, v94, 0 op_sel:[0,0,0] op_sel_hi:[1,0,0]
    v_fma_mix_f32 v95, v77, v95, 0 op_sel:[1,0,0] op_sel_hi:[1,0,0]
    v_fma_mix_f32 v96, v78, v96, 0 op_sel:[0,0,0] op_sel_hi:[1,0,0]
    v_add_f32_dpp v204, v204, v204 row_ror:2 row_mask:0xf bank_mask:0xf
    v_fma_mix_f32 v97, v78, v97, 0 op_sel:[1,0,0] op_sel_hi:[1,0,0]
    v_fma_mix_f32 v98, v79, v98, 0 op_sel:[0,0,0] op_sel_hi:[1,0,0]
    v_fma_mix_f32 v99, v79, v99, 0 op_sel:[1,0,0] op_sel_hi:[1,0,0]
    v_fma_mix_f32 v100, v80, v100, 0 op_sel:[0,0,0] op_sel_hi:[1,0,0]
    v_fma_mix_f32 v101, v80, v101, 0 op_sel:[1,0,0] op_sel_hi:[1,0,0]
    v_add_f32_dpp v204, v204, v204 row_ror:1 row_mask:0xf bank_mask:0xf
    v_cvt_pk_bf16_f32 v84, 0, v84
    v_cvt_pk_bf16_f32 v85, 0, v85
    v_cvt_pk_bf16_f32 v86, 0, v86
    v_cvt_pk_bf16_f32 v87, 0, v87
    v_cvt_pk_bf16_f32 v88, 0, v88
    v_mov_b32 v37, v204
    v_cvt_pk_bf16_f32 v89, 0, v89
    v_cvt_pk_bf16_f32 v90, 0, v90
    v_cvt_pk_bf16_f32 v91, 0, v91
    v_cvt_pk_bf16_f32 v92, 0, v92
    v_cvt_pk_bf16_f32 v93, 0, v93
    v_permlane16_swap_b32 v204, v37
    v_cvt_pk_bf16_f32 v94, 0, v94
    v_cvt_pk_bf16_f32 v95, 0, v95
    v_cvt_pk_bf16_f32 v96, 0, v96
    v_cvt_pk_bf16_f32 v97, 0, v97
    v_cvt_pk_bf16_f32 v98, 0, v98
    v_add_f32 v204, v204, v37
    v_cvt_pk_bf16_f32 v99, 0, v99
    v_cvt_pk_bf16_f32 v100, 0, v100
    v_cvt_pk_bf16_f32 v101, 0, v101
    v_dot2_f32_bf16 v102, v16, v6, v84
    v_dot2_f32_bf16 v103, v16, v7, v85
    v_dot2_f32_bf16 v104, v17, v6, v86
    v_dot2_f32_bf16 v105, v17, v7, v87
    v_dot2_f32_bf16 v106, v18, v6, v88
    v_dot2_f32_bf16 v107, v18, v7, v89
    v_dot2_f32_bf16 v108, v19, v6, v90
    v_dot2_f32_bf16 v109, v19, v7, v91
    v_dot2_f32_bf16 v110, v20, v6, v92
    v_dot2_f32_bf16 v111, v20, v7, v93
    v_dot2_f32_bf16 v112, v21, v6, v94
    v_dot2_f32_bf16 v113, v21, v7, v95
    v_dot2_f32_bf16 v114, v22, v6, v96
    v_dot2_f32_bf16 v115, v22, v7, v97
    v_dot2_f32_bf16 v116, v23, v6, v98
    v_dot2_f32_bf16 v117, v23, v7, v99
    v_dot2_f32_bf16 v118, v24, v6, v100
    v_dot2_f32_bf16 v119, v24, v7, v101
    s_cmp_lt_u32 s2, 144
    s_cbranch_scc1 RP_1
    s_and_b32 s46, s2, 7
    s_sub_u32 s48, s2, 216
    s_lshr_b32 s48, s48, 3
    v_lshrrev_b32 v37, 3, v0
    v_mul_u32_u24 v37, 9216, v37
    v_and_b32 v36, 7, v0
    v_lshl_add_u32 v37, v36, 4, v37
    s_cmp_ge_u32 s46, 4
    s_cselect_b32 s50, 1, 0
    s_add_u32 s50, s50, s46
    s_lshl_b32 s50, s50, 10
    s_add_u32 s50, s50, 384
    s_lshr_b32 s53, s48, 1
    s_sub_u32 s53, 8, s53
    s_mul_i32 s53, s53, 589824
    s_add_u32 s50, s50, s53
    v_add_u32 v36, s50, v37
    s_bitcmp1_b32 s48, 0
    s_cselect_b32 s56, s24, s22
    s_cselect_b32 s57, s25, s23
    global_load_dwordx4 v[140:143], v36, s[56:57] nt
    s_cmp_lg_u32 s46, 3
    s_cbranch_scc1 PF_0
    global_load_dwordx4 v[144:147], v36, s[56:57] offset:1024 nt
PF_0:
    v_subrev_u32 v36, 1179648, v36
    global_load_dwordx4 v[140:143], v36, s[56:57] nt
    s_cmp_lg_u32 s46, 3
    s_cbranch_scc1 PF_1
    global_load_dwordx4 v[144:147], v36, s[56:57] offset:1024 nt
PF_1:
    v_subrev_u32 v36, 1179648, v36
    global_load_dwordx4 v[140:143], v36, s[56:57] nt
    s_cmp_lg_u32 s46, 3
    s_cbranch_scc1 PF_2
    global_load_dwordx4 v[144:147], v36, s[56:57] offset:1024 nt
PF_2:
    v_subrev_u32 v36, 1179648, v36
    s_waitcnt vmcnt(0)
    s_cmp_ge_u32 s3, 4
    s_cbranch_scc1 RP_S
    s_lshl_b32 s57, s51, 6
    v_add_u32 v14, s57, v1
    v_min_u32 v14, 143, v14
    v_lshlrev_b32 v27, 7, v14
    v_lshlrev_b32 v14, 4, v14
    s_mov_b32 s53, 32768
    buffer_load_dwordx4 v[32:35], v27, s[32:35], s53 offen sc1
    s_and_b32 s56, s40, 0x7fffff
    s_mov_b32 s47, 0
    s_waitcnt vmcnt(0)
SCP11:
    v_xor_b32 v32, s56, v32
    v_xor_b32 v33, s56, v33
    v_xor_b32 v34, s56, v34
    v_xor_b32 v35, s56, v35
    v_or3_b32 v255, v32, v33, v34
    v_or_b32 v255, v255, v35
    v_and_b32 v255, 0x7fffff, v255
    v_cmp_ne_u32 vcc, 0, v255
    s_cbranch_vccz SCD12
    s_add_u32 s47, s47, 1
    s_cmp_ge_u32 s47, 262144
    s_cbranch_scc1 SCD12
    s_sleep 8
    buffer_load_dwordx4 v[32:35], v27, s[32:35], s53 offen sc1
    s_waitcnt vmcnt(0)
    s_branch SCP11
SCD12:
    ds_write_b128 v14, v[32:35] offset:46080
RP_S:
    s_waitcnt lgkmcnt(0)
    s_barrier
RP_1:
    s_cmp_lt_u32 s49, 64
    s_cbranch_scc1 RP_2
    buffer_load_dwordx4 v[140:143], v3, s[32:35], s60 offen sc1
    buffer_load_dwordx4 v[144:147], v3, s[32:35], s61 offen sc1
    s_cmp_ge_u32 s3, 2
    s_cbranch_scc1 YL13
    buffer_load_dwordx4 v[148:151], v3, s[32:35], s62 offen sc1
YL13:
RP_2:
    ds_read_b128 v[52:55], v38 offset:46080
    ds_read_b128 v[56:59], v38 offset:46096
    ds_read_b128 v[60:63], v38 offset:47104
    ds_read_b128 v[64:67], v38 offset:47120
    ds_read_b64 v[68:69], v39 offset:48128
    v_and_b32 v36, 7, v0
    v_mul_u32_u24 v36, 2320, v36
    v_lshrrev_b32 v37, 3, v0
    v_lshl_add_u32 v36, v37, 4, v36
    v_lshrrev_b32 v37, 5, v1
    s_mul_i32 s46, s3, 2320
    s_add_u32 s46, s46, 49152
    v_lshl_add_u32 v37, v37, 3, s46
    v_lshl_add_u32 v38, v12, 1, v37
    v_bfe_u32 v39, v1, 1, 4
    v_lshl_add_u32 v39, v39, 4, v37
    v_and_b32 v37, 1, v1
    v_lshl_add_u32 v39, v37, 2, v39
    v_lshrrev_b32 v35, 5, v1
    v_lshlrev_b32 v35, 4, v35
    s_and_b32 s52, s3, 4
    s_add_u32 s52, s52, s3
    s_lshl_b32 s46, s52, 2
    s_add_u32 s46, s46, 163456
    v_add_u32 v35, s46, v35
    v_and_b32 v40, 15, v1
    v_lshlrev_b32 v34, 2, v40
    v_add_u32 v34, 163456, v34
    v_and_b32 v42, 48, v2
    v_add_u32 v41, 163456, v42
    v_lshrrev_b32 v43, 2, v1
    v_lshl_add_u32 v42, v43, 14, v42
    s_and_b32 s63, s40, 0xffff
    s_or_b32 s53, s63, 0x80000000
    s_lshl_b32 s54, s49, 6
    s_add_u32 s54, s54, 9437184
    s_mov_b32 s58, 1
    s_mov_b32 s59, 1
    s_lshl_b32 s46, s49, 4
    s_sub_u32 s46, 0xffff, s46
    v_sub_u32 v44, s46, v40
    v_mov_b32 v45, 0xffff0000
    v_lshrrev_b32 v46, 5, v1
    v_mul_u32_u24 v46, 6144, v46
    s_mul_i32 s46, s52, 1536
    v_add3_u32 v46, v46, v12, s46
    v_lshrrev_b32 v47, 2, v0
    v_and_b32 v48, 3, v0
    v_lshlrev_b32 v48, 4, v48
    v_lshl_add_u32 v47, v47, 6, v48
    v_mov_b32 v183, s40
    v_mov_b32 v187, s40
    v_mov_b32 v191, s40
    v_lshlrev_b32 v49, 2, v0
    v_sub_u32 v232, 0xffff, v49
    v_subrev_u32 v233, 1, v232
    v_subrev_u32 v234, 2, v232
    v_subrev_u32 v235, 3, v232
    v_mov_b32 v48, s63
    v_mov_b32 v49, 163520
    v_mov_b32 v50, -1
    s_lshl_b32 s46, s49, 4
    s_add_u32 s46, s46, s52
    s_sub_u32 s46, 0xffff, s46
    v_lshrrev_b32 v51, 5, v1
    v_lshlrev_b32 v51, 2, v51
    v_sub_u32 v51, s46, v51
    s_cmp_ge_u32 s3, 2
    s_cbranch_scc1 RP_3
    s_mov_b32 s47, 0
PL14:
    s_waitcnt vmcnt(0)
    v_xor_b32 v140, v10, v140
    v_xor_b32 v141, v10, v141
    v_xor_b32 v142, v10, v142
    v_xor_b32 v143, v10, v143
    v_xor_b32 v144, v10, v144
    v_xor_b32 v145, v10, v145
    v_xor_b32 v146, v10, v146
    v_xor_b32 v147, v10, v147
    v_xor_b32 v148, v10, v148
    v_xor_b32 v149, v10, v149
    v_xor_b32 v150, v10, v150
    v_xor_b32 v151, v10, v151
    v_or3_b32 v37, v140, v141, v142
    v_or3_b32 v37, v37, v143, v144
    v_or3_b32 v37, v37, v145, v146
    v_or3_b32 v37, v37, v147, v148
    v_or3_b32 v37, v37, v149, v150
    v_or_b32 v37, v37, v151
    v_and_b32 v37, 0x70007, v37
    v_cmp_ne_u32 vcc, 0, v37
    s_cbranch_vccz PD15
    s_add_u32 s47, s47, 1
    s_cmp_ge_u32 s47, 262144
    s_cbranch_scc1 PD15
    s_sleep 1
    buffer_load_dwordx4 v[140:143], v3, s[32:35], s60 offen sc1
    buffer_load_dwordx4 v[144:147], v3, s[32:35], s61 offen sc1
    buffer_load_dwordx4 v[148:151], v3, s[32:35], s62 offen sc1
    s_branch PL14
PD15:
    ds_write_b128 v36, v[148:151] offset:51200
    s_branch RP_4
RP_3:
    s_mov_b32 s47, 0
PL16:
    s_waitcnt vmcnt(0)
    v_xor_b32 v140, v10, v140
    v_xor_b32 v141, v10, v141
    v_xor_b32 v142, v10, v142
    v_xor_b32 v143, v10, v143
    v_xor_b32 v144, v10, v144
    v_xor_b32 v145, v10, v145
    v_xor_b32 v146, v10, v146
    v_xor_b32 v147, v10, v147
    v_or3_b32 v37, v140, v141, v142
    v_or3_b32 v37, v37, v143, v144
    v_or3_b32 v37, v37, v145, v146
    v_or_b32 v37, v37, v147
    v_and_b32 v37, 0x70007, v37
    v_cmp_ne_u32 vcc, 0, v37
    s_cbranch_vccz PD17
    s_add_u32 s47, s47, 1
    s_cmp_ge_u32 s47, 262144
    s_cbranch_scc1 PD17
    s_sleep 1
    buffer_load_dwordx4 v[140:143], v3, s[32:35], s60 offen sc1
    buffer_load_dwordx4 v[144:147], v3, s[32:35], s61 offen sc1
    s_branch PL16
PD17:
RP_4:
    ds_write_b128 v36, v[140:143] offset:49152
    ds_write_b128 v36, v[144:147] offset:50176
RP_5:
    s_waitcnt lgkmcnt(0)
    s_barrier
    ds_read2_b64 v[152:155], v38 offset0:0 offset1:2
    ds_read2_b64 v[156:159], v38 offset0:128 offset1:130
    ds_read_b32 v160, v39 offset:2048
    s_getreg_b32 s60, hwreg(HW_REG_XCC_ID, 0, 3)
    s_mul_i32 s60, s60, 16384
    s_add_u32 s60, s60, 9437184
    s_mul_i32 s61, s49, 24576
    s_add_u32 s61, s61, 13631488
    s_waitcnt lgkmcnt(2)
    v_fma_mix_f32 v162, v152, v52, v102 op_sel:[0,0,0] op_sel_hi:[1,0,0]
    v_fma_mix_f32 v163, v152, v53, v103 op_sel:[1,0,0] op_sel_hi:[1,0,0]
    v_fma_mix_f32 v164, v153, v54, v104 op_sel:[0,0,0] op_sel_hi:[1,0,0]
    v_fma_mix_f32 v165, v153, v55, v105 op_sel:[1,0,0] op_sel_hi:[1,0,0]
    v_pk_mul_f32 v[30:31], v[162:163], v[162:163]
    v_pk_mul_f32 v[32:33], v[162:163], v[120:121]
    v_fma_mix_f32 v166, v154, v56, v106 op_sel:[0,0,0] op_sel_hi:[1,0,0]
    v_fma_mix_f32 v167, v154, v57, v107 op_sel:[1,0,0] op_sel_hi:[1,0,0]
    v_pk_add_f32 v[28:29], v[162:163], v[164:165]
    v_pk_fma_f32 v[30:31], v[164:165], v[164:165], v[30:31]
    v_pk_fma_f32 v[32:33], v[164:165], v[122:123], v[32:33]
    v_fma_mix_f32 v168, v155, v58, v108 op_sel:[0,0,0] op_sel_hi:[1,0,0]
    v_fma_mix_f32 v169, v155, v59, v109 op_sel:[1,0,0] op_sel_hi:[1,0,0]
    v_pk_add_f32 v[28:29], v[28:29], v[166:167]
    v_pk_fma_f32 v[30:31], v[166:167], v[166:167], v[30:31]
    v_pk_fma_f32 v[32:33], v[166:167], v[124:125], v[32:33]
    s_waitcnt lgkmcnt(1)
    v_fma_mix_f32 v170, v156, v60, v110 op_sel:[0,0,0] op_sel_hi:[1,0,0]
    v_fma_mix_f32 v171, v156, v61, v111 op_sel:[1,0,0] op_sel_hi:[1,0,0]
    v_pk_add_f32 v[28:29], v[28:29], v[168:169]
    v_pk_fma_f32 v[30:31], v[168:169], v[168:169], v[30:31]
    v_pk_fma_f32 v[32:33], v[168:169], v[126:127], v[32:33]
    v_fma_mix_f32 v172, v157, v62, v112 op_sel:[0,0,0] op_sel_hi:[1,0,0]
    v_fma_mix_f32 v173, v157, v63, v113 op_sel:[1,0,0] op_sel_hi:[1,0,0]
    v_pk_add_f32 v[28:29], v[28:29], v[170:171]
    v_pk_fma_f32 v[30:31], v[170:171], v[170:171], v[30:31]
    v_pk_fma_f32 v[32:33], v[170:171], v[128:129], v[32:33]
    v_fma_mix_f32 v174, v158, v64, v114 op_sel:[0,0,0] op_sel_hi:[1,0,0]
    v_fma_mix_f32 v175, v158, v65, v115 op_sel:[1,0,0] op_sel_hi:[1,0,0]
    v_pk_add_f32 v[28:29], v[28:29], v[172:173]
    v_pk_fma_f32 v[30:31], v[172:173], v[172:173], v[30:31]
    v_pk_fma_f32 v[32:33], v[172:173], v[130:131], v[32:33]
    v_fma_mix_f32 v176, v159, v66, v116 op_sel:[0,0,0] op_sel_hi:[1,0,0]
    v_fma_mix_f32 v177, v159, v67, v117 op_sel:[1,0,0] op_sel_hi:[1,0,0]
    v_pk_add_f32 v[28:29], v[28:29], v[174:175]
    v_pk_fma_f32 v[30:31], v[174:175], v[174:175], v[30:31]
    v_pk_fma_f32 v[32:33], v[174:175], v[132:133], v[32:33]
    s_waitcnt lgkmcnt(0)
    v_fma_mix_f32 v178, v160, v68, v118 op_sel:[0,0,0] op_sel_hi:[1,0,0]
    v_fma_mix_f32 v179, v160, v69, v119 op_sel:[1,0,0] op_sel_hi:[1,0,0]
    v_pk_add_f32 v[28:29], v[28:29], v[176:177]
    v_pk_fma_f32 v[30:31], v[176:177], v[176:177], v[30:31]
    v_pk_fma_f32 v[32:33], v[176:177], v[134:135], v[32:33]
    v_pk_add_f32 v[28:29], v[28:29], v[178:179]
    v_pk_fma_f32 v[30:31], v[178:179], v[178:179], v[30:31]
    v_pk_fma_f32 v[32:33], v[178:179], v[136:137], v[32:33]
    v_add_f32 v28, v28, v29
    v_add_f32 v30, v30, v31
    v_add_f32 v32, v32, v33
    s_nop 0
    v_permlane16_swap_b32 v28, v30
    v_add_f32 v28, v28, v30
    v_add_f32_dpp v32, v32, v32 row_ror:8 row_mask:0xf bank_mask:0xf
    s_nop 0
    v_add_f32_dpp v28, v28, v28 row_ror:8 row_mask:0xf bank_mask:0xf
    v_add_f32_dpp v32, v32, v32 row_ror:4 row_mask:0xf bank_mask:0xf
    s_nop 0
    v_add_f32_dpp v28, v28, v28 row_ror:4 row_mask:0xf bank_mask:0xf
    v_add_f32_dpp v32, v32, v32 row_ror:2 row_mask:0xf bank_mask:0xf
    s_nop 0
    v_add_f32_dpp v28, v28, v28 row_ror:2 row_mask:0xf bank_mask:0xf
    v_add_f32_dpp v32, v32, v32 row_ror:1 row_mask:0xf bank_mask:0xf
    s_nop 0
    v_add_f32_dpp v28, v28, v28 row_ror:1 row_mask:0xf bank_mask:0xf
    v_mov_b32 v33, v32
    v_mov_b32 v30, v28
    s_nop 1
    v_permlane16_swap_b32 v28, v30
    v_permlane16_swap_b32 v32, v33
    v_add_f32 v32, v32, v33
    v_mul_f32 v28, 0x3ae38e39, v28
    v_mul_f32 v30, 0x3ae38e39, v30
    v_fma_f32 v30, -v28, v28, v30
    v_cvt_pk_bf16_f32 v200, 0, v28
    v_max_f32 v30, 0, v30
    v_cvt_pk_bf16_f32 v30, 0, v30
    v_add_f32 v30, 0x3727c5ac, v30
    v_cvt_pk_bf16_f32 v30, 0, v30
    v_sqrt_f32 v30, v30
    s_nop 0
    v_cvt_pk_bf16_f32 v30, 0, v30
    v_rcp_f32 v202, v30
    v_fma_f32 v32, -v200, v204, v32
    v_mul_f32 v32, v32, v202
    v_cvt_pk_bf16_f32 v236, 0, v32
    v_ashrrev_i32 v28, 31, v236
    v_and_b32 v28, 0x7fff0000, v28
    v_xor_b32 v28, v28, v236
    v_xor_b32 v43, s53, v28
    s_mov_b64 exec, s[58:59]
    ds_write_b32 v35, v43
    s_mov_b64 exec, -1
    s_waitcnt lgkmcnt(0)
    s_barrier
    s_cmp_lg_u32 s3, 0
    s_cbranch_scc1 L2_NOKEY
    s_mov_b32 exec_hi, 0
    ds_read_b128 v[28:31], v41
    s_waitcnt lgkmcnt(0)
    buffer_store_dwordx4 v[28:31], v42, s[32:35], s54 offen sc1
    s_mov_b64 exec, -1
L2_NOKEY:
    ds_read_b32 v205, v34
    v_fma_mix_f32 v162, v152, v52, v84 op_sel:[0,0,0] op_sel_hi:[1,0,0]
    v_fma_mix_f32 v163, v152, v53, v85 op_sel:[1,0,0] op_sel_hi:[1,0,0]
    v_fma_mix_f32 v164, v153, v54, v86 op_sel:[0,0,0] op_sel_hi:[1,0,0]
    v_fma_mix_f32 v165, v153, v55, v87 op_sel:[1,0,0] op_sel_hi:[1,0,0]
    v_fma_mix_f32 v166, v154, v56, v88 op_sel:[0,0,0] op_sel_hi:[1,0,0]
    v_fma_mix_f32 v167, v154, v57, v89 op_sel:[1,0,0] op_sel_hi:[1,0,0]
    v_fma_mix_f32 v168, v155, v58, v90 op_sel:[0,0,0] op_sel_hi:[1,0,0]
    v_fma_mix_f32 v169, v155, v59, v91 op_sel:[1,0,0] op_sel_hi:[1,0,0]
    v_fma_mix_f32 v170, v156, v60, v92 op_sel:[0,0,0] op_sel_hi:[1,0,0]
    v_fma_mix_f32 v171, v156, v61, v93 op_sel:[1,0,0] op_sel_hi:[1,0,0]
    v_and_or_b32 v43, v43, v45, v51
    s_waitcnt lgkmcnt(0)
    v_and_or_b32 v205, v205, v45, v44
    v_cmp_gt_u32 vcc, v205, v43
    s_and_b32 s46, vcc_lo, 0xffff
    s_and_b32 s48, vcc_hi, 0xffff
    s_bcnt1_i32_b32 s46, s46
    s_bcnt1_i32_b32 s48, s48
    s_cmp_lt_u32 s46, 2
    s_cselect_b32 s36, -1, 0
    s_cmp_lt_u32 s48, 2
    s_cselect_b32 s37, -1, 0
    s_cmp_eq_u64 s[36:37], 0
    s_cbranch_scc1 L2_NP
    s_setprio 1
L2_NP:
    v_fma_mix_f32 v172, v157, v62, v94 op_sel:[0,0,0] op_sel_hi:[1,0,0]
    v_fma_mix_f32 v173, v157, v63, v95 op_sel:[1,0,0] op_sel_hi:[1,0,0]
    v_fma_mix_f32 v174, v158, v64, v96 op_sel:[0,0,0] op_sel_hi:[1,0,0]
    v_fma_mix_f32 v175, v158, v65, v97 op_sel:[1,0,0] op_sel_hi:[1,0,0]
    v_fma_mix_f32 v176, v159, v66, v98 op_sel:[0,0,0] op_sel_hi:[1,0,0]
    v_fma_mix_f32 v177, v159, v67, v99 op_sel:[1,0,0] op_sel_hi:[1,0,0]
    v_fma_mix_f32 v178, v160, v68, v100 op_sel:[0,0,0] op_sel_hi:[1,0,0]
    v_fma_mix_f32 v179, v160, v69, v101 op_sel:[1,0,0] op_sel_hi:[1,0,0]
    v_cvt_pk_bf16_f32 v162, 0, v162
    v_cvt_pk_bf16_f32 v163, 0, v163
    v_cvt_pk_bf16_f32 v164, 0, v164
    v_cvt_pk_bf16_f32 v165, 0, v165
    v_cvt_pk_bf16_f32 v166, 0, v166
    v_cvt_pk_bf16_f32 v167, 0, v167
    v_cvt_pk_bf16_f32 v168, 0, v168
    v_cvt_pk_bf16_f32 v169, 0, v169
    v_cvt_pk_bf16_f32 v170, 0, v170
    v_cvt_pk_bf16_f32 v171, 0, v171
    v_cvt_pk_bf16_f32 v172, 0, v172
    v_cvt_pk_bf16_f32 v173, 0, v173
    v_cvt_pk_bf16_f32 v174, 0, v174
    v_cvt_pk_bf16_f32 v175, 0, v175
    v_cvt_pk_bf16_f32 v176, 0, v176
    v_cvt_pk_bf16_f32 v177, 0, v177
    v_cvt_pk_bf16_f32 v178, 0, v178
    v_cvt_pk_bf16_f32 v179, 0, v179
    v_dot2_f32_bf16 v162, v16, v6, v162
    v_dot2_f32_bf16 v163, v16, v7, v163
    v_dot2_f32_bf16 v164, v17, v6, v164
    v_dot2_f32_bf16 v165, v17, v7, v165
    v_dot2_f32_bf16 v166, v18, v6, v166
    v_dot2_f32_bf16 v167, v18, v7, v167
    v_dot2_f32_bf16 v168, v19, v6, v168
    v_dot2_f32_bf16 v169, v19, v7, v169
    v_dot2_f32_bf16 v170, v20, v6, v170
    v_dot2_f32_bf16 v171, v20, v7, v171
    v_dot2_f32_bf16 v172, v21, v6, v172
    v_dot2_f32_bf16 v173, v21, v7, v173
    v_dot2_f32_bf16 v174, v22, v6, v174
    v_dot2_f32_bf16 v175, v22, v7, v175
    v_dot2_f32_bf16 v176, v23, v6, v176
    v_dot2_f32_bf16 v177, v23, v7, v177
    v_dot2_f32_bf16 v178, v24, v6, v178
    v_dot2_f32_bf16 v179, v24, v7, v179
    v_cvt_pk_bf16_f32 v162, 0, v162
    v_cvt_pk_bf16_f32 v163, 0, v163
    v_cvt_pk_bf16_f32 v164, 0, v164
    v_cvt_pk_bf16_f32 v165, 0, v165
    v_cvt_pk_bf16_f32 v166, 0, v166
    v_cvt_pk_bf16_f32 v167, 0, v167
    v_cvt_pk_bf16_f32 v168, 0, v168
    v_cvt_pk_bf16_f32 v169, 0, v169
    v_cvt_pk_bf16_f32 v170, 0, v170
    v_cvt_pk_bf16_f32 v171, 0, v171
    v_cvt_pk_bf16_f32 v172, 0, v172
    v_cvt_pk_bf16_f32 v173, 0, v173
    v_cvt_pk_bf16_f32 v174, 0, v174
    v_cvt_pk_bf16_f32 v175, 0, v175
    v_cvt_pk_bf16_f32 v176, 0, v176
    v_cvt_pk_bf16_f32 v177, 0, v177
    v_cvt_pk_bf16_f32 v178, 0, v178
    v_cvt_pk_bf16_f32 v179, 0, v179
    v_pk_add_f32 v[102:103], v[162:163], v[200:201] op_sel_hi:[1,0] neg_lo:[0,1] neg_hi:[0,1]
    v_pk_add_f32 v[104:105], v[164:165], v[200:201] op_sel_hi:[1,0] neg_lo:[0,1] neg_hi:[0,1]
    v_pk_add_f32 v[106:107], v[166:167], v[200:201] op_sel_hi:[1,0] neg_lo:[0,1] neg_hi:[0,1]
    v_pk_add_f32 v[108:109], v[168:169], v[200:201] op_sel_hi:[1,0] neg_lo:[0,1] neg_hi:[0,1]
    v_pk_add_f32 v[110:111], v[170:171], v[200:201] op_sel_hi:[1,0] neg_lo:[0,1] neg_hi:[0,1]
    v_pk_add_f32 v[112:113], v[172:173], v[200:201] op_sel_hi:[1,0] neg_lo:[0,1] neg_hi:[0,1]
    v_pk_add_f32 v[114:115], v[174:175], v[200:201] op_sel_hi:[1,0] neg_lo:[0,1] neg_hi:[0,1]
    v_pk_add_f32 v[116:117], v[176:177], v[200:201] op_sel_hi:[1,0] neg_lo:[0,1] neg_hi:[0,1]
    v_pk_add_f32 v[118:119], v[178:179], v[200:201] op_sel_hi:[1,0] neg_lo:[0,1] neg_hi:[0,1]
    v_cvt_pk_bf16_f32 v102, 0, v102
    v_cvt_pk_bf16_f32 v103, 0, v103
    v_cvt_pk_bf16_f32 v104, 0, v104
    v_cvt_pk_bf16_f32 v105, 0, v105
    v_cvt_pk_bf16_f32 v106, 0, v106
    v_cvt_pk_bf16_f32 v107, 0, v107
    v_cvt_pk_bf16_f32 v108, 0, v108
    v_cvt_pk_bf16_f32 v109, 0, v109
    v_cvt_pk_bf16_f32 v110, 0, v110
    v_cvt_pk_bf16_f32 v111, 0, v111
    v_cvt_pk_bf16_f32 v112, 0, v112
    v_cvt_pk_bf16_f32 v113, 0, v113
    v_cvt_pk_bf16_f32 v114, 0, v114
    v_cvt_pk_bf16_f32 v115, 0, v115
    v_cvt_pk_bf16_f32 v116, 0, v116
    v_cvt_pk_bf16_f32 v117, 0, v117
    v_cvt_pk_bf16_f32 v118, 0, v118
    v_cvt_pk_bf16_f32 v119, 0, v119
    v_pk_mul_f32 v[102:103], v[102:103], v[202:203] op_sel_hi:[1,0]
    v_pk_mul_f32 v[104:105], v[104:105], v[202:203] op_sel_hi:[1,0]
    v_pk_mul_f32 v[106:107], v[106:107], v[202:203] op_sel_hi:[1,0]
    v_pk_mul_f32 v[108:109], v[108:109], v[202:203] op_sel_hi:[1,0]
    v_pk_mul_f32 v[110:111], v[110:111], v[202:203] op_sel_hi:[1,0]
    v_pk_mul_f32 v[112:113], v[112:113], v[202:203] op_sel_hi:[1,0]
    v_pk_mul_f32 v[114:115], v[114:115], v[202:203] op_sel_hi:[1,0]
    v_pk_mul_f32 v[116:117], v[116:117], v[202:203] op_sel_hi:[1,0]
    v_pk_mul_f32 v[118:119], v[118:119], v[202:203] op_sel_hi:[1,0]
    v_cvt_pk_bf16_f32 v180, v102, v103
    v_cvt_pk_bf16_f32 v181, v104, v105
    v_cvt_pk_bf16_f32 v182, v106, v107
    v_cvt_pk_bf16_f32 v184, v108, v109
    v_cvt_pk_bf16_f32 v185, v110, v111
    v_cvt_pk_bf16_f32 v186, v112, v113
    v_cvt_pk_bf16_f32 v188, v114, v115
    v_cvt_pk_bf16_f32 v189, v116, v117
    v_cvt_pk_bf16_f32 v190, v118, v119
    s_and_b64 exec, s[36:37], -1
    s_cbranch_execz L2_NS
    buffer_store_dwordx4 v[180:183], v46, s[32:35], s61 offen offset:0 sc1
    buffer_store_dwordx4 v[184:187], v46, s[32:35], s61 offen offset:512 sc1
    buffer_store_dwordx4 v[188:191], v46, s[32:35], s61 offen offset:1024 sc1
L2_NS:
    s_mov_b64 exec, -1
    s_setprio 0
    v_dot2_f32_bf16 v102, v180, v6, v162
    v_dot2_f32_bf16 v103, v180, v7, v163
    v_dot2_f32_bf16 v104, v181, v6, v164
    v_dot2_f32_bf16 v105, v181, v7, v165
    v_dot2_f32_bf16 v106, v182, v6, v166
    v_dot2_f32_bf16 v107, v182, v7, v167
    v_dot2_f32_bf16 v108, v184, v6, v168
    v_dot2_f32_bf16 v109, v184, v7, v169
    v_dot2_f32_bf16 v110, v185, v6, v170
    v_dot2_f32_bf16 v111, v185, v7, v171
    v_dot2_f32_bf16 v112, v186, v6, v172
    v_dot2_f32_bf16 v113, v186, v7, v173
    v_dot2_f32_bf16 v114, v188, v6, v174
    v_dot2_f32_bf16 v115, v188, v7, v175
    v_dot2_f32_bf16 v116, v189, v6, v176
    v_dot2_f32_bf16 v117, v189, v7, v177
    v_dot2_f32_bf16 v118, v190, v6, v178
    v_dot2_f32_bf16 v119, v190, v7, v179
    v_cvt_pk_bf16_f32 v16, v102, v103
    v_cvt_pk_bf16_f32 v17, v104, v105
    v_cvt_pk_bf16_f32 v18, v106, v107
    v_cvt_pk_bf16_f32 v19, v108, v109
    v_cvt_pk_bf16_f32 v20, v110, v111
    v_cvt_pk_bf16_f32 v21, v112, v113
    v_cvt_pk_bf16_f32 v22, v114, v115
    v_cvt_pk_bf16_f32 v23, v116, v117
    v_cvt_pk_bf16_f32 v24, v118, v119
    buffer_load_dwordx4 v[228:231], v47, s[32:35], s60 offen sc1
    v_mov_b32 v206, v205
    s_nop 1
    v_max_u32_dpp v206, v206, v206 row_ror:8 row_mask:0xf bank_mask:0xf
    s_nop 1
    v_max_u32_dpp v206, v206, v206 row_ror:4 row_mask:0xf bank_mask:0xf
    s_nop 1
    v_max_u32_dpp v206, v206, v206 row_ror:2 row_mask:0xf bank_mask:0xf
    s_nop 1
    v_max_u32_dpp v206, v206, v206 row_ror:1 row_mask:0xf bank_mask:0xf
    s_nop 0
    v_readfirstlane_b32 s56, v206
    v_cmp_ne_u32 vcc, v206, v205
    s_nop 1
    v_cndmask_b32 v205, 0, v205, vcc
    v_mov_b32 v206, v205
    s_nop 1
    v_max_u32_dpp v206, v206, v206 row_ror:8 row_mask:0xf bank_mask:0xf
    s_nop 1
    v_max_u32_dpp v206, v206, v206 row_ror:4 row_mask:0xf bank_mask:0xf
    s_nop 1
    v_max_u32_dpp v206, v206, v206 row_ror:2 row_mask:0xf bank_mask:0xf
    s_nop 1
    v_max_u32_dpp v206, v206, v206 row_ror:1 row_mask:0xf bank_mask:0xf
    s_nop 0
    v_readfirstlane_b32 s57, v206
    v_cmp_ne_u32 vcc, v206, v205
    s_nop 1
    v_cndmask_b32 v205, 0, v205, vcc
    s_mov_b32 s47, 0
PL18:
    s_waitcnt vmcnt(0)
    v_xor_b32 v228, v48, v228
    v_xor_b32 v229, v48, v229
    v_xor_b32 v230, v48, v230
    v_xor_b32 v231, v48, v231
    v_or3_b32 v37, v228, v229, v230
    v_or_b32 v37, v37, v231
    v_and_b32 v37, 0xffff, v37
    v_cmp_ne_u32 vcc, 0, v37
    s_cbranch_vccz PD19
    s_add_u32 s47, s47, 1
    s_cmp_ge_u32 s47, 262144
    s_cbranch_scc1 PD19
    s_sleep 1
    buffer_load_dwordx4 v[228:231], v47, s[32:35], s60 offen sc1
    s_branch PL18
PD19:
    v_or_b32 v228, v228, v232
    v_or_b32 v229, v229, v233
    v_or_b32 v230, v230, v234
    v_or_b32 v231, v231, v235
RK_LOOP:
    v_cmp_lt_u32 s[4:5], s56, v228
    v_cmp_lt_u32 s[6:7], s56, v229
    v_cmp_lt_u32 s[8:9], s56, v230
    v_cmp_lt_u32 s[10:11], s56, v231
    v_cmp_lt_u32 s[12:13], s57, v228
    v_cmp_lt_u32 s[14:15], s57, v229
    v_cmp_lt_u32 s[16:17], s57, v230
    v_cmp_lt_u32 s[18:19], s57, v231
    s_bcnt1_i32_b64 s4, s[4:5]
    s_bcnt1_i32_b64 s6, s[6:7]
    s_bcnt1_i32_b64 s8, s[8:9]
    s_bcnt1_i32_b64 s10, s[10:11]
    s_add_u32 s4, s4, s6
    s_add_u32 s8, s8, s10
    s_add_u32 s46, s4, s8
    s_bcnt1_i32_b64 s12, s[12:13]
    s_bcnt1_i32_b64 s14, s[14:15]
    s_bcnt1_i32_b64 s16, s[16:17]
    s_bcnt1_i32_b64 s18, s[18:19]
    s_add_u32 s12, s12, s14
    s_add_u32 s16, s16, s18
    s_add_u32 s48, s12, s16
    s_pack_ll_b32_b16 s46, s46, s48
    v_mov_b32 v37, s46
    s_mov_b64 exec, 1
    ds_add_u32 v49, v37
    s_mov_b64 exec, -1
    s_waitcnt lgkmcnt(0)
    s_barrier
    ds_read_b32 v37, v49
    v_add_u32 v49, 4, v49
    s_waitcnt lgkmcnt(0)
    v_readfirstlane_b32 s53, v37
    s_and_b32 s54, s53, 0xffff
    s_cmp_ge_u32 s54, 8
    s_cbranch_scc1 RK_DONE
    s_andn2_b32 s46, 0xffff, s56
    s_and_b32 s48, s46, 11
    s_cmp_lg_u32 s48, s52
    s_cbranch_scc1 RK_N20
    s_bitcmp1_b32 s46, 2
    s_cselect_b32 exec_lo, 0, -1
    s_cselect_b32 exec_hi, -1, 0
    v_mov_b32 v50, s54
    s_mov_b64 exec, -1
RK_N20:
    s_lshr_b32 s54, s53, 16
    s_cmp_ge_u32 s54, 8
    s_cbranch_scc1 RK_DONE
    s_andn2_b32 s46, 0xffff, s57
    s_and_b32 s48, s46, 11
    s_cmp_lg_u32 s48, s52
    s_cbranch_scc1 RK_N21
    s_bitcmp1_b32 s46, 2
    s_cselect_b32 exec_lo, 0, -1
    s_cselect_b32 exec_hi, -1, 0
    v_mov_b32 v50, s54
    s_mov_b64 exec, -1
RK_N21:
    v_mov_b32 v206, v205
    s_nop 1
    v_max_u32_dpp v206, v206, v206 row_ror:8 row_mask:0xf bank_mask:0xf
    s_nop 1
    v_max_u32_dpp v206, v206, v206 row_ror:4 row_mask:0xf bank_mask:0xf
    s_nop 1
    v_max_u32_dpp v206, v206, v206 row_ror:2 row_mask:0xf bank_mask:0xf
    s_nop 1
    v_max_u32_dpp v206, v206, v206 row_ror:1 row_mask:0xf bank_mask:0xf
    s_nop 0
    v_readfirstlane_b32 s56, v206
    v_cmp_ne_u32 vcc, v206, v205
    s_nop 1
    v_cndmask_b32 v205, 0, v205, vcc
    v_mov_b32 v206, v205
    s_nop 1
    v_max_u32_dpp v206, v206, v206 row_ror:8 row_mask:0xf bank_mask:0xf
    s_nop 1
    v_max_u32_dpp v206, v206, v206 row_ror:4 row_mask:0xf bank_mask:0xf
    s_nop 1
    v_max_u32_dpp v206, v206, v206 row_ror:2 row_mask:0xf bank_mask:0xf
    s_nop 1
    v_max_u32_dpp v206, v206, v206 row_ror:1 row_mask:0xf bank_mask:0xf
    s_nop 0
    v_readfirstlane_b32 s57, v206
    v_cmp_ne_u32 vcc, v206, v205
    s_nop 1
    v_cndmask_b32 v205, 0, v205, vcc
    s_branch RK_LOOP
RK_DONE:
    v_cmp_gt_u32 vcc, 8, v50
    s_andn2_b64 s[58:59], -1, vcc
    s_andn2_b64 exec, vcc, s[36:37]
    s_cbranch_execz RK_NOLATE
    buffer_store_dwordx4 v[180:183], v46, s[32:35], s61 offen offset:0 sc1
    buffer_store_dwordx4 v[184:187], v46, s[32:35], s61 offen offset:512 sc1
    buffer_store_dwordx4 v[188:191], v46, s[32:35], s61 offen offset:1024 sc1
RK_NOLATE:
    s_and_b64 exec, vcc, -1
    s_cbranch_execz RK_NOSEL
    v_sub_u32 v51, 0xffff, v51
    v_mul_f32 v30, 0xbfb8aa3b, v236
    v_exp_f32 v30, v30
    v_mov_b32 v31, s40
    v_add_f32 v30, 1.0, v30
    v_rcp_f32 v30, v30
    v_mov_b32 v35, s40
    v_cvt_pk_bf16_f32 v30, 0, v30
    v_or_b32 v30, v51, v30
    v_mov_b32 v34, v30
    v_mul_u32_u24 v50, 4608, v50
    v_add_u32 v50, v50, v12
    s_mov_b32 s48, 131072
    s_mov_b32 s55, 131584
    v_or_b32_sdwa v28, v162, v180 dst_sel:DWORD dst_unused:UNUSED_PAD src0_sel:DWORD src1_sel:WORD_0
    v_or_b32_sdwa v29, v163, v180 dst_sel:DWORD dst_unused:UNUSED_PAD src0_sel:DWORD src1_sel:WORD_1
    buffer_store_dwordx4 v[28:31], v50, s[32:35], s48 offen offset:0 sc1
    v_or_b32_sdwa v32, v164, v181 dst_sel:DWORD dst_unused:UNUSED_PAD src0_sel:DWORD src1_sel:WORD_0
    v_or_b32_sdwa v33, v165, v181 dst_sel:DWORD dst_unused:UNUSED_PAD src0_sel:DWORD src1_sel:WORD_1
    buffer_store_dwordx4 v[32:35], v50, s[32:35], s55 offen offset:0 sc1
    v_or_b32_sdwa v28, v166, v182 dst_sel:DWORD dst_unused:UNUSED_PAD src0_sel:DWORD src1_sel:WORD_0
    v_or_b32_sdwa v29, v167, v182 dst_sel:DWORD dst_unused:UNUSED_PAD src0_sel:DWORD src1_sel:WORD_1
    buffer_store_dwordx4 v[28:31], v50, s[32:35], s55 offen offset:512 sc1
    v_or_b32_sdwa v32, v168, v184 dst_sel:DWORD dst_unused:UNUSED_PAD src0_sel:DWORD src1_sel:WORD_0
    v_or_b32_sdwa v33, v169, v184 dst_sel:DWORD dst_unused:UNUSED_PAD src0_sel:DWORD src1_sel:WORD_1
    buffer_store_dwordx4 v[32:35], v50, s[32:35], s55 offen offset:1024 sc1
    v_or_b32_sdwa v28, v170, v185 dst_sel:DWORD dst_unused:UNUSED_PAD src0_sel:DWORD src1_sel:WORD_0
    v_or_b32_sdwa v29, v171, v185 dst_sel:DWORD dst_unused:UNUSED_PAD src0_sel:DWORD src1_sel:WORD_1
    buffer_store_dwordx4 v[28:31], v50, s[32:35], s55 offen offset:1536 sc1
    v_or_b32_sdwa v32, v172, v186 dst_sel:DWORD dst_unused:UNUSED_PAD src0_sel:DWORD src1_sel:WORD_0
    v_or_b32_sdwa v33, v173, v186 dst_sel:DWORD dst_unused:UNUSED_PAD src0_sel:DWORD src1_sel:WORD_1
    buffer_store_dwordx4 v[32:35], v50, s[32:35], s55 offen offset:2048 sc1
    v_or_b32_sdwa v28, v174, v188 dst_sel:DWORD dst_unused:UNUSED_PAD src0_sel:DWORD src1_sel:WORD_0
    v_or_b32_sdwa v29, v175, v188 dst_sel:DWORD dst_unused:UNUSED_PAD src0_sel:DWORD src1_sel:WORD_1
    buffer_store_dwordx4 v[28:31], v50, s[32:35], s55 offen offset:2560 sc1
    v_or_b32_sdwa v32, v176, v189 dst_sel:DWORD dst_unused:UNUSED_PAD src0_sel:DWORD src1_sel:WORD_0
    v_or_b32_sdwa v33, v177, v189 dst_sel:DWORD dst_unused:UNUSED_PAD src0_sel:DWORD src1_sel:WORD_1
    buffer_store_dwordx4 v[32:35], v50, s[32:35], s55 offen offset:3072 sc1
    v_or_b32_sdwa v28, v178, v190 dst_sel:DWORD dst_unused:UNUSED_PAD src0_sel:DWORD src1_sel:WORD_0
    v_or_b32_sdwa v29, v179, v190 dst_sel:DWORD dst_unused:UNUSED_PAD src0_sel:DWORD src1_sel:WORD_1
    buffer_store_dwordx4 v[28:31], v50, s[32:35], s55 offen offset:3584 sc1
RK_NOSEL:
    s_mov_b64 exec, -1
    s_mov_b64 exec, s[58:59]
    s_cbranch_execz RK_NOOUT
    global_store_dwordx4 v4, v[16:19], s[28:29] sc1
    global_store_dwordx4 v4, v[20:23], s[28:29] offset:512 sc1
    global_store_dword v5, v24, s[28:29] offset:1024 sc1
RK_NOOUT:
    s_mov_b64 exec, -1
    s_cmp_ge_u32 s2, 144
    s_cbranch_scc1 DUMP
ZROLE:
    s_and_b32 s50, s2, 7
    s_mul_i32 s50, s50, 18
    s_lshr_b32 s46, s2, 3
    s_add_u32 s50, s50, s46
    s_mul_i32 s60, s50, 9216
    s_add_u32 s60, s60, 7340032
    s_and_b32 s46, s40, 63
    v_mov_b32 v36, s46
    v_lshlrev_b32 v82, 2, v0
    s_cmp_lg_u32 s3, 0
    s_cbranch_scc1 Z_W
    v_and_b32 v12, 7, v1
    v_mul_u32_u24 v12, 4608, v12
    v_bfe_u32 v13, v1, 4, 1
    v_lshrrev_b32 v14, 5, v1
    v_lshl_add_u32 v13, v13, 1, v14
    s_lshl_b32 s46, s50, 2
    v_add_u32 v13, s46, v13
    v_bfe_u32 v14, v13, 3, 5
    v_and_b32 v15, 7, v13
    v_lshrrev_b32 v36, 8, v13
    v_lshl_add_u32 v15, v36, 3, v15
    s_cmp_lt_u32 s50, 128
    s_cbranch_scc1 Z_A
    v_bfe_u32 v14, v13, 1, 5
    v_and_b32 v15, 1, v13
    v_add_u32 v15, 16, v15
Z_A:
    v_lshrrev_b32 v36, 1, v15
    v_and_b32 v15, 1, v15
    v_lshl_add_u32 v14, v14, 4, v12
    v_lshl_add_u32 v14, v36, 9, v14
    v_cmp_eq_u32 s[52:53], 1, v15
    s_mul_i32 s60, s50, 9216
    s_add_u32 s60, s60, 7340032
    s_add_u32 s61, s60, 4096
    s_add_u32 s62, s60, 8192
    s_mov_b32 s63, 131072
    s_and_b32 s46, s40, 63
    v_mov_b32 v36, s46
    s_getreg_b32 s48, hwreg(HW_REG_XCC_ID, 0, 3)
    s_lshl_b32 s48, s48, 14
    s_add_u32 s48, s48, 9699328
    s_add_u32 s59, s48, 8192
    v_lshlrev_b32 v80, 7, v1
    v_and_b32 v81, 7, v1
    v_lshlrev_b32 v81, 7, v81
    buffer_load_dword v38, v80, s[32:35], s48 offen sc1
    buffer_load_dword v39, v81, s[32:35], s59 offen sc1
    s_mov_b32 s47, 0
PL22:
    s_waitcnt vmcnt(0)
    v_cmp_ne_u32 vcc, s40, v38
    v_cmp_ne_u32 s[56:57], s40, v39
    s_or_b64 vcc, vcc, s[56:57]
    s_cbranch_vccz PD23
    s_add_u32 s47, s47, 1
    s_cmp_ge_u32 s47, 262144
    s_cbranch_scc1 PD23
    s_sleep 1
    buffer_load_dword v38, v80, s[32:35], s48 offen sc1
    buffer_load_dword v39, v81, s[32:35], s59 offen sc1
    s_branch PL22
PD23:
    s_barrier
    buffer_load_dwordx4 v[40:43], v3, s[32:35], s60 offen sc1
    buffer_load_dwordx4 v[44:47], v3, s[32:35], s62 offen sc1
    buffer_load_dwordx4 v[32:35], v14, s[32:35], s63 offen sc1
    s_mov_b32 s47, 0
PL24:
    s_waitcnt vmcnt(0)
    v_xor_b32 v40, v36, v40
    v_xor_b32 v41, v36, v41
    v_xor_b32 v42, v36, v42
    v_xor_b32 v43, v36, v43
    v_xor_b32 v44, v36, v44
    v_xor_b32 v45, v36, v45
    v_xor_b32 v46, v36, v46
    v_xor_b32 v47, v36, v47
    v_or3_b32 v37, v40, v41, v42
    v_or3_b32 v37, v37, v44, v45
    v_or3_b32 v37, v37, v46, v47
    v_or_b32 v37, v37, v43
    v_and_b32 v37, 63, v37
    v_cmp_ne_u32 vcc, 0, v37
    s_cbranch_vccz PD25
    s_add_u32 s47, s47, 1
    s_cmp_ge_u32 s47, 262144
    s_cbranch_scc1 PD25
    buffer_load_dwordx4 v[40:43], v3, s[32:35], s60 offen sc1
    buffer_load_dwordx4 v[44:47], v3, s[32:35], s62 offen sc1
    s_branch PL24
PD25:
    s_mov_b32 s47, 0
PL26:
    s_waitcnt vmcnt(0)
    v_cmp_ne_u32 vcc, s40, v35
    s_cbranch_vccz PD27
    s_add_u32 s47, s47, 1
    s_cmp_ge_u32 s47, 262144
    s_cbranch_scc1 PD27
    s_sleep 2
    buffer_load_dwordx4 v[32:35], v14, s[32:35], s63 offen sc1
    s_branch PL26
PD27:
    v_cndmask_b32 v32, v32, v33, s[52:53]
    v_and_b32 v33, 0xffff0000, v34
    v_and_b32 v28, 2047, v34
    v_mul_u32_u24 v28, 1152, v28
    v_lshl_add_u32 v28, v13, 1, v28
    v_lshlrev_b32 v34, 16, v32
    v_and_b32 v35, 0xffff0000, v32
    v_pk_add_f32 v[40:41], v[40:41], v[44:45]
    v_pk_add_f32 v[42:43], v[42:43], v[46:47]
    s_nop 0
    v_permlane32_swap_b32 v40, v41
    v_permlane32_swap_b32 v42, v43
    v_add_f32 v40, v40, v41
    v_add_f32 v42, v42, v43
    s_nop 1
    v_permlane16_swap_b32 v40, v42
    v_add_f32 v40, v40, v42
    s_barrier
    ds_read2st64_b32 v[44:45], v82 offset0:1 offset1:2
    ds_read2st64_b32 v[46:47], v82 offset0:3 offset1:4
    ds_read2st64_b32 v[48:49], v82 offset0:5 offset1:6
    ds_read_b32 v50, v82 offset:1792
    s_waitcnt lgkmcnt(2)
    v_add_f32 v44, v44, v45
    v_add_f32 v46, v46, v47
    v_add_f32 v40, v40, v44
    s_waitcnt lgkmcnt(0)
    v_add_f32 v48, v48, v49
    v_add_f32 v46, v46, v50
    v_add_f32 v40, v40, v48
    v_add_f32 v40, v40, v46
    s_nop 1
    v_add_f32_dpp v40, v40, v40 row_ror:8 row_mask:0xf bank_mask:0xf
    v_cvt_pk_bf16_f32 v40, 0, v40
    v_mul_f32 v40, v40, v33
    v_cvt_pk_bf16_f32 v40, 0, v40
    v_add_f32 v40, v40, v34
    v_cvt_pk_bf16_f32 v40, 0, v40
    v_add_f32 v40, v40, v35
    v_cvt_pk_bf16_f32 v40, v40, v40
    s_mov_b32 exec_lo, 0x00ff00ff
    s_mov_b32 exec_hi, 0x00ff00ff
    global_store_short v28, v40, s[28:29]
    s_cmp_lg_u32 s50, 0
    s_cbranch_scc1 DUMP
    s_mov_b64 exec, 1
    v_mov_b32 v36, s40
    buffer_store_dword v36, v2, s[32:35], 0 offen sc1
    s_branch DUMP
Z_W:
    s_barrier
    buffer_load_dwordx4 v[40:43], v3, s[32:35], s60 offen sc1
    s_mov_b32 s47, 0
PL28:
    s_waitcnt vmcnt(0)
    v_xor_b32 v40, v36, v40
    v_xor_b32 v41, v36, v41
    v_xor_b32 v42, v36, v42
    v_xor_b32 v43, v36, v43
    v_or3_b32 v37, v40, v41, v42
    v_or_b32 v37, v37, v43
    v_and_b32 v37, 63, v37
    v_cmp_ne_u32 vcc, 0, v37
    s_cbranch_vccz PD29
    s_add_u32 s47, s47, 1
    s_cmp_ge_u32 s47, 262144
    s_cbranch_scc1 PD29
    buffer_load_dwordx4 v[40:43], v3, s[32:35], s60 offen sc1
    s_branch PL28
PD29:
    v_permlane32_swap_b32 v40, v41
    v_permlane32_swap_b32 v42, v43
    v_add_f32 v40, v40, v41
    v_add_f32 v42, v42, v43
    s_nop 1
    v_permlane16_swap_b32 v40, v42
    v_add_f32 v40, v40, v42
    ds_write_b32 v82, v40
    s_waitcnt lgkmcnt(0)
    s_barrier
    s_branch DUMP
FROLE:
    s_sub_u32 s50, s2, 144
    s_cmp_lt_u32 s50, 48
    s_cbranch_scc1 F_NT
    v_cmp_gt_u32 vcc, TBLEND-PC0, v15
    s_and_saveexec_b64 s[58:59], vcc
    s_cbranch_execz F_NT
    global_load_dword v255, v15, s[42:43]
F_NT:
    s_mov_b64 exec, -1
    s_and_b32 s46, s50, 7
    s_sub_u32 s48, 3, s46
    s_and_b32 s48, s48, 7
    s_lshr_b32 s50, s50, 3
    s_add_u32 s50, s50, s48
    s_add_u32 s50, s50, 2
    s_cmp_ge_u32 s50, 9
    s_cselect_b32 s48, 9, 0
    s_sub_u32 s50, s50, s48
    s_mul_i32 s46, s46, 9
    s_add_u32 s50, s50, s46
    v_lshrrev_b32 v12, 3, v0
    v_and_b32 v13, 7, v0
    v_lshlrev_b32 v13, 4, v13
    v_mul_u32_u24 v4, 9216, v12
    v_add_u32 v4, v4, v13
    v_mul_u32_u24 v5, 1152, v12
    v_add_u32 v5, v5, v13
    s_lshl_b32 s46, s50, 7
    s_mul_i32 s48, s50, 73728
    s_mov_b32 s38, 5308416
    s_mov_b32 s39, 0x00020000
    s_mov_b32 s54, 5308416
    s_mov_b32 s55, 0x00020000
    s_mov_b32 s58, 5308416
    s_mov_b32 s59, 0x00020000
    s_waitcnt lgkmcnt(0)
    s_mov_b32 s36, s22
    s_and_b32 s37, s23, 0xffff
    s_mov_b32 s52, s24
    s_and_b32 s53, s25, 0xffff
    s_mov_b32 s56, s26
    s_and_b32 s57, s27, 0xffff
    s_load_dword s40, s[30:31], 0
    s_cmp_ge_u32 s2, 192
    s_cbranch_scc1 F_L1
    s_barrier
    s_lshl_b32 s49, s50, 7
    buffer_load_dwordx4 v[16:19], v4, s[36:39], s49 offen nt
    buffer_load_dwordx4 v[20:23], v4, s[52:55], s49 offen nt
    s_add_u32 s49, s49, 589824
    buffer_load_dwordx4 v[24:27], v4, s[36:39], s49 offen nt
    buffer_load_dwordx4 v[28:31], v4, s[52:55], s49 offen nt
    s_add_u32 s49, s49, 589824
F_L1:
    s_mov_b32 s32, s30
    s_and_b32 s33, s31, 0xffff
    s_mov_b32 s34, 0x10000000
    s_mov_b32 s35, 0x00020000
    v_mul_u32_u24 v6, 272, v12
    v_add_u32 v6, v6, v13
    v_lshrrev_b32 v14, 4, v1
    v_bfe_u32 v15, v1, 2, 2
    v_lshl_add_u32 v7, v14, 3, v15
    v_mul_u32_u24 v7, 272, v7
    v_and_b32 v8, 2, v1
    v_lshl_add_u32 v7, v8, 6, v7
    v_and_b32 v8, 1, v1
    v_lshl_add_u32 v7, v8, 3, v7
    s_lshl_b32 s46, s3, 4
    v_add_u32 v7, s46, v7
    v_bfe_u32 v8, v1, 3, 3
    v_mul_u32_u24 v8, 1184, v8
    v_add_u32 v8, v8, v13
    s_mul_i32 s46, s3, 9600
    v_add_u32 v8, s46, v8
    v_mul_u32_u24 v9, 9600, v14
    v_mul_u32_u24 v15, 1184, v15
    v_add_u32 v9, v9, v15
    v_and_b32 v15, 3, v1
    v_lshl_add_u32 v9, v15, 3, v9
    s_lshl_b32 s46, s3, 5
    v_add_u32 v9, s46, v9
    s_mul_i32 s46, s3, 1216
    s_add_u32 s46, s46, 81920
    v_mov_b32 v243, s46
    v_and_b32 v244, 31, v1
    v_lshrrev_b32 v242, 5, v1
    v_lshl_add_u32 v245, v244, 4, v243
    v_lshl_add_u32 v246, v244, 2, v243
    v_add_u32 v246, 1024, v246
    v_cmp_eq_u32 s[60:61], 1, v242
    v_cmp_eq_u32 s[62:63], 2, v242
    v_mov_b32 v247, 0
    v_mov_b32 v248, 12
    v_cndmask_b32 v247, v247, v248, s[60:61]
    v_mov_b32 v248, 520
    v_cndmask_b32 v247, v247, v248, s[62:63]
    v_add_u32 v236, v247, v245
    v_mov_b32 v247, 4
    v_mov_b32 v248, 512
    v_cndmask_b32 v247, v247, v248, s[60:61]
    v_mov_b32 v248, 524
    v_cndmask_b32 v247, v247, v248, s[62:63]
    v_add_u32 v237, v247, v245
    v_mov_b32 v247, 8
    v_mov_b32 v248, 516
    v_cndmask_b32 v247, v247, v248, s[60:61]
    v_add_u32 v247, v247, v245
    v_cndmask_b32 v238, v247, v246, s[62:63]
    s_mul_i32 s46, s3, 1216
    s_add_u32 s46, s46, 81920
    v_mov_b32 v243, s46
    v_and_b32 v244, 31, v1
    v_mov_b32 v242, 2
    v_lshl_add_u32 v245, v244, 4, v243
    v_lshl_add_u32 v246, v244, 2, v243
    v_add_u32 v246, 1024, v246
    v_cmp_eq_u32 s[60:61], 1, v242
    v_cmp_eq_u32 s[62:63], 2, v242
    v_mov_b32 v247, 0
    v_mov_b32 v248, 12
    v_cndmask_b32 v247, v247, v248, s[60:61]
    v_mov_b32 v248, 520
    v_cndmask_b32 v247, v247, v248, s[62:63]
    v_add_u32 v239, v247, v245
    v_mov_b32 v247, 4
    v_mov_b32 v248, 512
    v_cndmask_b32 v247, v247, v248, s[60:61]
    v_mov_b32 v248, 524
    v_cndmask_b32 v247, v247, v248, s[62:63]
    v_add_u32 v240, v247, v245
    v_mov_b32 v247, 8
    v_mov_b32 v248, 516
    v_cndmask_b32 v247, v247, v248, s[60:61]
    v_add_u32 v247, v247, v245
    v_cndmask_b32 v241, v247, v246, s[62:63]
    v_bfe_u32 v247, v236, 2, 1
    v_bfe_u32 v248, v236, 3, 2
    v_and_b32 v236, 0xffffffe3, v236
    v_lshl_add_u32 v236, v247, 4, v236
    v_lshl_add_u32 v236, v248, 2, v236
    v_bfe_u32 v247, v237, 2, 1
    v_bfe_u32 v248, v237, 3, 2
    v_and_b32 v237, 0xffffffe3, v237
    v_lshl_add_u32 v237, v247, 4, v237
    v_lshl_add_u32 v237, v248, 2, v237
    v_bfe_u32 v247, v238, 2, 1
    v_bfe_u32 v248, v238, 3, 2
    v_and_b32 v238, 0xffffffe3, v238
    v_lshl_add_u32 v238, v247, 4, v238
    v_lshl_add_u32 v238, v248, 2, v238
    v_bfe_u32 v247, v239, 2, 1
    v_bfe_u32 v248, v239, 3, 2
    v_and_b32 v239, 0xffffffe3, v239
    v_lshl_add_u32 v239, v247, 4, v239
    v_lshl_add_u32 v239, v248, 2, v239
    v_bfe_u32 v247, v240, 2, 1
    v_bfe_u32 v248, v240, 3, 2
    v_and_b32 v240, 0xffffffe3, v240
    v_lshl_add_u32 v240, v247, 4, v240
    v_lshl_add_u32 v240, v248, 2, v240
    v_bfe_u32 v247, v241, 2, 1
    v_bfe_u32 v248, v241, 3, 2
    v_and_b32 v241, 0xffffffe3, v241
    v_lshl_add_u32 v241, v247, 4, v241
    v_lshl_add_u32 v241, v248, 2, v241
    v_and_b32 v15, 7, v1
    v_mul_u32_u24 v10, 1216, v15
    v_lshl_add_u32 v10, v14, 5, v10
    v_and_b32 v247, 8, v1
    v_lshl_add_u32 v10, v247, 1, v10
    v_add_u32 v10, 81920, v10
    v_mul_u32_u24 v11, 144, v15
    v_add_u32 v11, 98304, v11
    v_lshl_add_u32 v242, v14, 4, v11
    v_bfe_u32 v243, v1, 3, 2
    v_lshrrev_b32 v244, 5, v1
    v_lshl_add_u32 v243, v243, 1, v244
    v_mul_u32_u24 v11, 144, v243
    v_lshl_add_u32 v11, v15, 1, v11
    s_lshl_b32 s46, s3, 4
    s_add_u32 s46, s46, 98304
    v_add_u32 v11, s46, v11
    v_bfe_u32 v243, v1, 3, 1
    v_lshl_add_u32 v243, v243, 5, v14
    v_mul_u32_u24 v243, 9216, v243
    v_lshl_add_u32 v243, v15, 4, v243
    s_mul_i32 s62, s3, 36864
    s_lshl_b32 s46, s50, 7
    s_add_u32 s62, s62, s46
    s_add_u32 s62, s62, 7340032
    v_and_b32 v244, 8, v1
    v_cmp_eq_u32 s[60:61], 0, v244
    v_mov_b32 v251, 0xeeee
    v_mov_b32 v252, 0x4444
    v_cndmask_b32 v251, v251, v252, s[60:61]
    s_waitcnt lgkmcnt(0)
    s_add_u32 s40, s40, 1
    s_and_b32 s46, s40, 63
    v_mov_b32 v245, s46
    v_mov_b32 v246, 0xffffffc0
    v_mov_b32 v249, s40
    v_lshlrev_b32 v250, 14, v1
    s_lshl_b32 s63, s50, 7
    s_add_u32 s63, s63, 9699328
    s_cmp_lt_u32 s2, 192
    s_cbranch_scc1 F_L2
    s_lshl_b32 s49, s50, 7
    buffer_load_dwordx4 v[16:19], v4, s[36:39], s49 offen nt
    buffer_load_dwordx4 v[20:23], v4, s[52:55], s49 offen nt
    s_add_u32 s49, s49, 589824
    buffer_load_dwordx4 v[24:27], v4, s[36:39], s49 offen nt
    buffer_load_dwordx4 v[28:31], v4, s[52:55], s49 offen nt
    s_add_u32 s49, s49, 589824
F_L2:
    buffer_load_dwordx4 v[32:35], v4, s[36:39], s49 offen nt
    buffer_load_dwordx4 v[36:39], v4, s[52:55], s49 offen nt
    s_add_u32 s49, s49, 589824
    s_waitcnt vmcnt(4)
    ds_write_b128 v6, v[16:19] offset:0
    ds_write_b128 v6, v[20:23] offset:128
    s_waitcnt lgkmcnt(0)
    s_barrier
    ds_read_b64_tr_b16 v[124:125], v7 offset:0
    ds_read_b64_tr_b16 v[126:127], v7 offset:1088
    ds_read_b64_tr_b16 v[128:129], v7 offset:8704
    ds_read_b64_tr_b16 v[130:131], v7 offset:9792
    buffer_load_dwordx4 v[40:43], v4, s[36:39], s49 offen nt
    buffer_load_dwordx4 v[44:47], v4, s[52:55], s49 offen nt
    s_add_u32 s49, s49, 589824
    s_waitcnt vmcnt(4)
    ds_write_b128 v6, v[24:27] offset:17408
    ds_write_b128 v6, v[28:31] offset:17536
    s_waitcnt lgkmcnt(0)
    s_barrier
    ds_read_b64_tr_b16 v[132:133], v7 offset:17408
    ds_read_b64_tr_b16 v[134:135], v7 offset:18496
    ds_read_b64_tr_b16 v[136:137], v7 offset:26112
    ds_read_b64_tr_b16 v[138:139], v7 offset:27200
    buffer_load_dwordx4 v[48:51], v4, s[36:39], s49 offen nt
    buffer_load_dwordx4 v[52:55], v4, s[52:55], s49 offen nt
    s_add_u32 s49, s49, 589824
    s_waitcnt vmcnt(4)
    ds_write_b128 v6, v[32:35] offset:34816
    ds_write_b128 v6, v[36:39] offset:34944
    s_waitcnt lgkmcnt(0)
    s_barrier
    ds_read_b64_tr_b16 v[140:141], v7 offset:34816
    ds_read_b64_tr_b16 v[142:143], v7 offset:35904
    ds_read_b64_tr_b16 v[144:145], v7 offset:43520
    ds_read_b64_tr_b16 v[146:147], v7 offset:44608
    buffer_load_dwordx4 v[56:59], v4, s[36:39], s49 offen nt
    buffer_load_dwordx4 v[60:63], v4, s[52:55], s49 offen nt
    s_add_u32 s49, s49, 589824
    s_waitcnt vmcnt(4)
    v_add_u32 v6, 52224, v6
    v_add_u32 v7, 52224, v7
    ds_write_b128 v6, v[40:43] offset:0
    ds_write_b128 v6, v[44:47] offset:128
    s_waitcnt lgkmcnt(0)
    s_barrier
    ds_read_b64_tr_b16 v[148:149], v7 offset:0
    ds_read_b64_tr_b16 v[150:151], v7 offset:1088
    ds_read_b64_tr_b16 v[152:153], v7 offset:8704
    ds_read_b64_tr_b16 v[154:155], v7 offset:9792
    buffer_load_dwordx4 v[64:67], v4, s[36:39], s49 offen nt
    buffer_load_dwordx4 v[68:71], v4, s[52:55], s49 offen nt
    s_add_u32 s49, s49, 589824
    s_waitcnt vmcnt(4)
    ds_write_b128 v6, v[48:51] offset:17408
    ds_write_b128 v6, v[52:55] offset:17536
    s_waitcnt lgkmcnt(0)
    s_barrier
    ds_read_b64_tr_b16 v[156:157], v7 offset:17408
    ds_read_b64_tr_b16 v[158:159], v7 offset:18496
    ds_read_b64_tr_b16 v[160:161], v7 offset:26112
    ds_read_b64_tr_b16 v[162:163], v7 offset:27200
    buffer_load_dwordx4 v[72:75], v4, s[36:39], s49 offen nt
    buffer_load_dwordx4 v[76:79], v4, s[52:55], s49 offen nt
    s_add_u32 s49, s49, 589824
    s_waitcnt vmcnt(4)
    ds_write_b128 v6, v[56:59] offset:34816
    ds_write_b128 v6, v[60:63] offset:34944
    s_waitcnt lgkmcnt(0)
    s_barrier
    ds_read_b64_tr_b16 v[164:165], v7 offset:34816
    ds_read_b64_tr_b16 v[166:167], v7 offset:35904
    ds_read_b64_tr_b16 v[168:169], v7 offset:43520
    ds_read_b64_tr_b16 v[170:171], v7 offset:44608
    buffer_load_dwordx4 v[80:83], v4, s[36:39], s49 offen nt
    buffer_load_dwordx4 v[84:87], v4, s[52:55], s49 offen nt
    s_add_u32 s49, s49, 589824
    s_waitcnt vmcnt(4)
    v_add_u32 v6, 52224, v6
    v_add_u32 v7, 52224, v7
    ds_write_b128 v6, v[64:67] offset:0
    ds_write_b128 v6, v[68:71] offset:128
    s_waitcnt lgkmcnt(0)
    s_barrier
    ds_read_b64_tr_b16 v[172:173], v7 offset:0
    ds_read_b64_tr_b16 v[174:175], v7 offset:1088
    ds_read_b64_tr_b16 v[176:177], v7 offset:8704
    ds_read_b64_tr_b16 v[178:179], v7 offset:9792
    buffer_load_dwordx4 v[88:91], v5, s[56:59], s48 offen offset:0 nt
    buffer_load_dwordx4 v[92:95], v5, s[56:59], s48 offen offset:128 nt
    s_waitcnt vmcnt(4)
    ds_write_b128 v6, v[72:75] offset:17408
    ds_write_b128 v6, v[76:79] offset:17536
    s_waitcnt lgkmcnt(0)
    s_barrier
    ds_read_b64_tr_b16 v[180:181], v7 offset:17408
    ds_read_b64_tr_b16 v[182:183], v7 offset:18496
    ds_read_b64_tr_b16 v[184:185], v7 offset:26112
    ds_read_b64_tr_b16 v[186:187], v7 offset:27200
    buffer_load_dwordx4 v[96:99], v5, s[56:59], s48 offen offset:256 nt
    buffer_load_dwordx4 v[100:103], v5, s[56:59], s48 offen offset:384 nt
    s_waitcnt vmcnt(4)
    ds_write_b128 v6, v[80:83] offset:34816
    ds_write_b128 v6, v[84:87] offset:34944
    s_waitcnt lgkmcnt(0)
    s_barrier
    ds_read_b64_tr_b16 v[188:189], v7 offset:34816
    ds_read_b64_tr_b16 v[190:191], v7 offset:35904
    ds_read_b64_tr_b16 v[192:193], v7 offset:43520
    ds_read_b64_tr_b16 v[194:195], v7 offset:44608
    buffer_load_dwordx4 v[104:107], v5, s[56:59], s48 offen offset:512 nt
    buffer_load_dwordx4 v[108:111], v5, s[56:59], s48 offen offset:640 nt
    s_waitcnt vmcnt(4)
    ds_write_b128 v8, v[88:91] offset:0
    ds_write_b128 v8, v[92:95] offset:128
    s_waitcnt lgkmcnt(0)
    s_barrier
    ds_read_b64_tr_b16 v[196:197], v9 offset:0
    ds_read_b64_tr_b16 v[198:199], v9 offset:4736
    ds_read_b64_tr_b16 v[200:201], v9 offset:38400
    ds_read_b64_tr_b16 v[202:203], v9 offset:43136
    buffer_load_dwordx4 v[112:115], v5, s[56:59], s48 offen offset:768 nt
    buffer_load_dwordx4 v[116:119], v5, s[56:59], s48 offen offset:896 nt
    s_waitcnt vmcnt(4)
    ds_write_b128 v8, v[96:99] offset:256
    ds_write_b128 v8, v[100:103] offset:384
    s_waitcnt lgkmcnt(0)
    s_barrier
    ds_read_b64_tr_b16 v[204:205], v9 offset:256
    ds_read_b64_tr_b16 v[206:207], v9 offset:4992
    ds_read_b64_tr_b16 v[208:209], v9 offset:38656
    ds_read_b64_tr_b16 v[210:211], v9 offset:43392
    buffer_load_dwordx4 v[120:123], v5, s[56:59], s48 offen offset:1024 nt
    s_waitcnt vmcnt(3)
    ds_write_b128 v8, v[104:107] offset:512
    ds_write_b128 v8, v[108:111] offset:640
    s_waitcnt lgkmcnt(0)
    s_barrier
    ds_read_b64_tr_b16 v[212:213], v9 offset:512
    ds_read_b64_tr_b16 v[214:215], v9 offset:5248
    ds_read_b64_tr_b16 v[216:217], v9 offset:38912
    ds_read_b64_tr_b16 v[218:219], v9 offset:43648
    s_waitcnt vmcnt(1)
    ds_write_b128 v8, v[112:115] offset:768
    ds_write_b128 v8, v[116:119] offset:896
    v_mov_b32 v16, 0
    v_lshlrev_b32 v17, 2, v1
    v_add_u32 v17, 100352, v17
    ds_write2st64_b32 v17, v16, v16 offset0:0 offset1:1
    s_waitcnt lgkmcnt(0)
    s_barrier
    ds_read_b64_tr_b16 v[220:221], v9 offset:768
    ds_read_b64_tr_b16 v[222:223], v9 offset:5504
    ds_read_b64_tr_b16 v[224:225], v9 offset:39168
    ds_read_b64_tr_b16 v[226:227], v9 offset:43904
    s_waitcnt vmcnt(0)
    ds_write_b128 v8, v[120:123] offset:1024
    s_waitcnt lgkmcnt(0)
    s_barrier
    ds_read_b64_tr_b16 v[228:229], v9 offset:1024
    ds_read_b64_tr_b16 v[230:231], v9 offset:5760
    ds_read_b64_tr_b16 v[232:233], v9 offset:39424
    ds_read_b64_tr_b16 v[234:235], v9 offset:44160
    s_getreg_b32 s48, hwreg(HW_REG_XCC_ID, 0, 3)
    s_mul_i32 s48, s48, 16384
    s_add_u32 s48, s48, 9437184
    s_waitcnt lgkmcnt(0)
    v_mov_b32 v68, 0
    v_mov_b32 v69, 0
    v_mov_b32 v70, 0
    v_mov_b32 v71, 0
    s_add_u32 s54, s62, 589824
    s_add_u32 s55, s62, 1179648
    v_lshrrev_b32 v100, 2, v0
    v_and_b32 v98, 3, v0
    v_lshlrev_b32 v98, 4, v98
    v_lshl_add_u32 v100, v100, 6, v98
    buffer_load_dwordx4 v[72:75], v100, s[32:35], s48 offen sc1
    s_and_b32 s46, s40, 0xffff
    v_mov_b32 v101, s46
    v_lshlrev_b32 v98, 2, v0
    v_sub_u32 v104, 0xffff, v98
    v_subrev_u32 v105, 1, v104
    v_subrev_u32 v106, 2, v104
    v_subrev_u32 v107, 3, v104
    v_lshrrev_b32 v102, 4, v0
    v_lshlrev_b32 v102, 3, v102
    v_add_u32 v102, 100352, v102
    v_and_b32 v110, 31, v1
    v_lshlrev_b32 v110, 4, v110
    v_lshrrev_b32 v103, 3, v0
    v_lshlrev_b32 v103, 2, v103
    v_add_u32 v103, 100352, v103
    v_and_b32 v108, 7, v1
    v_lshlrev_b32 v108, 5, v108
    v_add_u32 v108, 100352, v108
    v_mov_b32 v109, 100608
    s_lshl_b32 s46, s3, 2
    v_add_u32 v111, s46, v109
    s_mov_b32 s56, 0x10001
    s_mov_b32 s57, 0x10001
    s_mov_b32 s58, 0x01010101
    s_mov_b32 s59, 0x01010101
    s_mov_b32 s47, 0
PL30:
    s_waitcnt vmcnt(0)
    v_xor_b32 v72, v101, v72
    v_xor_b32 v73, v101, v73
    v_xor_b32 v74, v101, v74
    v_xor_b32 v75, v101, v75
    v_or3_b32 v98, v72, v73, v74
    v_or_b32 v98, v98, v75
    v_and_b32 v98, 0xffff, v98
    v_cmp_ne_u32 vcc, 0, v98
    s_cbranch_vccz PD31
    s_add_u32 s47, s47, 1
    s_cmp_ge_u32 s47, 262144
    s_cbranch_scc1 PD31
    s_sleep 1
    buffer_load_dwordx4 v[72:75], v100, s[32:35], s48 offen sc1
    s_branch PL30
PD31:
    v_or_b32 v72, v72, v104
    v_or_b32 v73, v73, v105
    v_or_b32 v74, v74, v106
    v_or_b32 v75, v75, v107
    v_max_u32 v98, v72, v73
    v_max_u32 v99, v74, v75
    v_max_u32 v76, v98, v99
    v_min_u32 v72, v72, v73
    v_min_u32 v74, v74, v75
    v_max_u32_dpp v112, v76, v76 row_ror:8 row_mask:0xf bank_mask:0xf
    v_min_u32 v98, v98, v99
    v_max_u32 v99, v72, v74
    v_max_u32_dpp v112, v112, v112 row_ror:4 row_mask:0xf bank_mask:0xf
    v_max_u32 v77, v98, v99
    v_min_u32 v78, v98, v99
    v_max_u32_dpp v112, v112, v112 row_ror:2 row_mask:0xf bank_mask:0xf
    v_min_u32 v79, v72, v74
    v_mov_b32 v97, 0
    v_max_u32_dpp v112, v112, v112 row_ror:1 row_mask:0xf bank_mask:0xf
    v_cmp_eq_u32 vcc, v112, v76
    s_nop 1
    v_cndmask_b32 v115, v76, v77, vcc
    v_cndmask_b32 v116, v77, v78, vcc
    s_nop 0
    v_max_u32_dpp v113, v115, v115 row_ror:8 row_mask:0xf bank_mask:0xf
    s_nop 1
    v_max_u32_dpp v113, v113, v113 row_ror:4 row_mask:0xf bank_mask:0xf
    s_nop 1
    v_max_u32_dpp v113, v113, v113 row_ror:2 row_mask:0xf bank_mask:0xf
    s_nop 1
    v_max_u32_dpp v113, v113, v113 row_ror:1 row_mask:0xf bank_mask:0xf
    s_mov_b64 exec, s[56:57]
    ds_write_b64 v102, v[112:113]
    s_mov_b64 exec, -1
    v_cmp_eq_u32 vcc, v113, v115
    s_nop 1
    v_cndmask_b32 v115, v115, v116, vcc
    s_waitcnt lgkmcnt(0)
    s_barrier
    ds_read_b32 v96, v103
    ds_read_b128 v[80:83], v108
    ds_read_b128 v[84:87], v108 offset:16
    s_waitcnt lgkmcnt(1)
    v_cmp_gt_u32 s[4:5], v80, v96
    v_cmp_gt_u32 s[6:7], v81, v96
    v_cmp_gt_u32 s[8:9], v82, v96
    v_cmp_gt_u32 s[10:11], v83, v96
    v_addc_co_u32 v97, vcc, 0, v97, s[4:5]
    v_addc_co_u32 v97, vcc, 0, v97, s[6:7]
    v_addc_co_u32 v97, vcc, 0, v97, s[8:9]
    v_addc_co_u32 v97, vcc, 0, v97, s[10:11]
    s_waitcnt lgkmcnt(0)
    v_cmp_gt_u32 s[4:5], v84, v96
    v_cmp_gt_u32 s[6:7], v85, v96
    v_cmp_gt_u32 s[8:9], v86, v96
    v_cmp_gt_u32 s[10:11], v87, v96
    v_addc_co_u32 v97, vcc, 0, v97, s[4:5]
    v_addc_co_u32 v97, vcc, 0, v97, s[6:7]
    v_addc_co_u32 v97, vcc, 0, v97, s[8:9]
    v_addc_co_u32 v97, vcc, 0, v97, s[10:11]
    s_nop 1
    v_add_u32_dpp v97, v97, v97 quad_perm:[1,0,3,2] row_mask:0xf bank_mask:0xf
    s_nop 1
    v_add_u32_dpp v97, v97, v97 quad_perm:[2,3,0,1] row_mask:0xf bank_mask:0xf
    s_nop 1
    v_add_u32_dpp v97, v97, v97 row_half_mirror row_mask:0xf bank_mask:0xf
    v_cmp_gt_u32 vcc, 8, v97
    v_lshl_add_u32 v98, v97, 2, v109
    s_and_b64 exec, vcc, s[58:59]
    ds_write_b32 v98, v96
    s_mov_b64 exec, -1
    s_waitcnt lgkmcnt(0)
    s_barrier
    ds_read_b32 v98, v111
    ds_read_b32 v99, v109 offset:28
    s_waitcnt lgkmcnt(1)
    v_readfirstlane_b32 s49, v98
F_SEL:
    s_andn2_b32 s49, 0x7ff, s49
    s_mul_i32 s49, s49, 1536
    s_add_u32 s49, s49, 13631488
    s_nop 1
    buffer_load_dwordx4 v[16:19], v2, s[32:35], s49 offen sc1
    buffer_load_dwordx4 v[20:23], v110, s[32:35], s49 offen offset:1024 sc1
    s_waitcnt lgkmcnt(0)
    v_cmp_gt_u32 vcc, v115, v99
    s_cbranch_vccz F_NOV
    ds_write_b32 v109, v109 offset:32
F_NOV:
    s_mov_b32 s47, 0
PL32:
    s_waitcnt vmcnt(0)
    v_cmp_ne_u32 vcc, s40, v19
    v_cmp_ne_u32 s[52:53], s40, v23
    s_or_b64 vcc, vcc, s[52:53]
    s_cbranch_vccz PD33
    s_add_u32 s47, s47, 1
    s_cmp_ge_u32 s47, 262144
    s_cbranch_scc1 PD33
    s_sleep 1
    buffer_load_dwordx4 v[16:19], v2, s[32:35], s49 offen sc1
    buffer_load_dwordx4 v[20:23], v110, s[32:35], s49 offen offset:1024 sc1
    s_branch PL32
PD33:
    ds_write_b32 v236, v16
    ds_write_b32 v237, v17
    ds_write_b32 v238, v18
    s_mov_b32 exec_hi, 0
    ds_write_b32 v239, v20
    ds_write_b32 v240, v21
    ds_write_b32 v241, v22
    s_mov_b64 exec, -1
    s_waitcnt lgkmcnt(0)
    s_barrier
    s_cmp_lg_u32 s3, 7
    s_cbranch_scc1 FH34
    s_mov_b64 exec, 0xff
    buffer_store_dword v249, v250, s[32:35], s63 offen sc1
    s_mov_b64 exec, -1
FH34:
    ds_read_b32 v98, v109 offset:32
    ds_read_b128 v[32:35], v10 offset:0
    ds_read_b128 v[36:39], v10 offset:128
    ds_read_b128 v[40:43], v10 offset:256
    ds_read_b128 v[44:47], v10 offset:384
    ds_read_b128 v[48:51], v10 offset:512
    ds_read_b128 v[52:55], v10 offset:640
    ds_read_b128 v[56:59], v10 offset:768
    ds_read_b128 v[60:63], v10 offset:896
    ds_read_b128 v[64:67], v10 offset:1024
    s_waitcnt lgkmcnt(9)
    v_cmp_ne_u32 vcc, 0, v98
    s_cbranch_vccnz F_SLOW
    s_waitcnt lgkmcnt(8)
    v_smfmac_f32_16x16x64_bf16 v[68:71], v[32:35], v[124:131], v251
    s_waitcnt lgkmcnt(7)
    v_smfmac_f32_16x16x64_bf16 v[68:71], v[36:39], v[132:139], v251
    s_waitcnt lgkmcnt(6)
    v_smfmac_f32_16x16x64_bf16 v[68:71], v[40:43], v[140:147], v251
    s_waitcnt lgkmcnt(5)
    v_smfmac_f32_16x16x64_bf16 v[68:71], v[44:47], v[148:155], v251
    s_waitcnt lgkmcnt(4)
    v_smfmac_f32_16x16x64_bf16 v[68:71], v[48:51], v[156:163], v251
    s_waitcnt lgkmcnt(3)
    v_smfmac_f32_16x16x64_bf16 v[68:71], v[52:55], v[164:171], v251
    s_waitcnt lgkmcnt(2)
    v_smfmac_f32_16x16x64_bf16 v[68:71], v[56:59], v[172:179], v251
    s_waitcnt lgkmcnt(1)
    v_smfmac_f32_16x16x64_bf16 v[68:71], v[60:63], v[180:187], v251
    s_waitcnt lgkmcnt(0)
    v_smfmac_f32_16x16x64_bf16 v[68:71], v[64:67], v[188:195], v251
    s_nop 7
    v_permlane32_swap_b32 v68, v69
    v_permlane32_swap_b32 v70, v71
    v_add_f32 v28, v68, v69
    v_add_f32 v29, v70, v71
    v_cvt_pk_bf16_f32 v30, 0, v28
    v_cvt_pk_bf16_f32 v29, 0, v29
    v_cvt_pk_bf16_f32 v28, 0, v28
    s_nop 0
    v_mov_b32_dpp v28, v29 row_ror:8 row_mask:0xf bank_mask:0xc
    v_mov_b32_dpp v29, v30 row_ror:8 row_mask:0xf bank_mask:0x3
    v_mul_f32 v30, 0xbfb8aa3b, v28
    v_exp_f32 v30, v30
    s_nop 0
    v_add_f32 v30, 1.0, v30
    v_rcp_f32 v30, v30
    s_nop 0
    v_mul_f32 v28, v28, v30
    v_cvt_pk_bf16_f32 v28, 0, v28
    v_mul_f32 v28, v28, v29
    v_cvt_pk_bf16_f32 v28, v28, v28
    ds_write_b16 v11, v28
    s_waitcnt lgkmcnt(0)
    s_barrier
    ds_read_b128 v[16:19], v242
    ds_read_b128 v[20:23], v242 offset:64
    s_waitcnt lgkmcnt(1)
    v_mfma_f32_16x16x32_bf16 v[32:35], v[196:199], v[16:19], 0
    v_mfma_f32_16x16x32_bf16 v[36:39], v[204:207], v[16:19], 0
    s_waitcnt lgkmcnt(0)
    v_mfma_f32_16x16x32_bf16 v[32:35], v[200:203], v[20:23], v[32:35]
    v_mfma_f32_16x16x32_bf16 v[36:39], v[208:211], v[20:23], v[36:39]
    v_mfma_f32_16x16x32_bf16 v[40:43], v[212:215], v[16:19], 0
    v_mfma_f32_16x16x32_bf16 v[44:47], v[220:223], v[16:19], 0
    v_mfma_f32_16x16x32_bf16 v[40:43], v[216:219], v[20:23], v[40:43]
    v_mfma_f32_16x16x32_bf16 v[44:47], v[224:227], v[20:23], v[44:47]
    s_cmp_ge_u32 s3, 4
    s_cbranch_scc1 F_T4
    v_mfma_f32_16x16x32_bf16 v[48:51], v[228:231], v[16:19], 0
    v_mfma_f32_16x16x32_bf16 v[48:51], v[232:235], v[20:23], v[48:51]
    v_cndmask_b32 v32, v36, v32, s[60:61]
    v_cndmask_b32 v33, v37, v33, s[60:61]
    v_cndmask_b32 v34, v38, v34, s[60:61]
    v_cndmask_b32 v35, v39, v35, s[60:61]
    v_and_or_b32 v32, v32, v246, v245
    v_and_or_b32 v33, v33, v246, v245
    v_and_or_b32 v34, v34, v246, v245
    v_and_or_b32 v35, v35, v246, v245
    buffer_store_dwordx4 v[32:35], v243, s[32:35], s62 offen sc1
    v_cndmask_b32 v40, v44, v40, s[60:61]
    v_cndmask_b32 v41, v45, v41, s[60:61]
    v_cndmask_b32 v42, v46, v42, s[60:61]
    v_cndmask_b32 v43, v47, v43, s[60:61]
    v_and_or_b32 v40, v40, v246, v245
    v_and_or_b32 v41, v41, v246, v245
    v_and_or_b32 v42, v42, v246, v245
    v_and_or_b32 v43, v43, v246, v245
    buffer_store_dwordx4 v[40:43], v243, s[32:35], s54 offen sc1
    v_and_or_b32 v48, v48, v246, v245
    v_and_or_b32 v49, v49, v246, v245
    v_and_or_b32 v50, v50, v246, v245
    v_and_or_b32 v51, v51, v246, v245
    s_mov_b64 exec, s[60:61]
    buffer_store_dwordx4 v[48:51], v243, s[32:35], s55 offen sc1
    s_branch DUMP
F_SLOW:
    s_lshl_b32 s46, s3, 5
    s_add_u32 s46, s46, 100864
    v_mov_b32 v97, s46
    s_mov_b32 s47, 0
F_SL1:
    v_mov_b32 v98, v76
    s_nop 1
    v_max_u32_dpp v98, v98, v98 row_ror:8 row_mask:0xf bank_mask:0xf
    s_nop 1
    v_max_u32_dpp v98, v98, v98 row_ror:4 row_mask:0xf bank_mask:0xf
    s_nop 1
    v_max_u32_dpp v98, v98, v98 row_ror:2 row_mask:0xf bank_mask:0xf
    s_nop 1
    v_max_u32_dpp v98, v98, v98 row_ror:1 row_mask:0xf bank_mask:0xf
    v_mov_b32 v99, v98
    s_nop 1
    v_permlane16_swap_b32 v98, v99
    v_max_u32 v98, v98, v99
    v_mov_b32 v99, v98
    s_nop 1
    v_permlane32_swap_b32 v98, v99
    v_max_u32 v98, v98, v99
    ds_write_b32 v97, v98
    v_cmp_eq_u32 vcc, v98, v76
    v_add_u32 v97, 4, v97
    s_nop 0
    v_cndmask_b32 v76, v76, v77, vcc
    v_cndmask_b32 v77, v77, v78, vcc
    v_cndmask_b32 v78, v78, v79, vcc
    v_cndmask_b32 v79, v79, v68, vcc
    s_add_u32 s47, s47, 1
    s_cmp_lt_u32 s47, 8
    s_cbranch_scc1 F_SL1
    v_lshlrev_b32 v98, 2, v1
    v_add_u32 v98, 100864, v98
    s_waitcnt lgkmcnt(0)
    s_barrier
    ds_read_b32 v96, v98
    ds_write_b32 v109, v68 offset:32
    v_mov_b32 v115, 0
    s_mov_b64 s[4:5], -1
    s_waitcnt lgkmcnt(0)
F_SL2:
    s_ff1_i32_b64 s46, s[4:5]
    s_and_b32 s46, s46, 63
    v_readlane_b32 s49, v96, s46
    s_nop 1
    v_cmp_lt_u32 vcc, s49, v96
    s_bitset0_b64 s[4:5], s46
    s_bcnt1_i32_b64 s47, vcc
    s_cmp_eq_u32 s47, s3
    s_cbranch_scc1 F_SEL
    s_and_b64 s[6:7], s[4:5], vcc
    s_andn2_b64 s[4:5], s[4:5], vcc
    s_cmp_gt_u32 s47, s3
    s_cselect_b64 s[4:5], s[6:7], s[4:5]
    s_cmp_lg_u64 s[4:5], 0
    s_cbranch_scc1 F_SL2
    s_branch F_SEL
F_T4:
    s_nop 1
    v_cndmask_b32 v32, v36, v32, s[60:61]
    v_cndmask_b32 v33, v37, v33, s[60:61]
    v_cndmask_b32 v34, v38, v34, s[60:61]
    v_cndmask_b32 v35, v39, v35, s[60:61]
    v_and_or_b32 v32, v32, v246, v245
    v_and_or_b32 v33, v33, v246, v245
    v_and_or_b32 v34, v34, v246, v245
    v_and_or_b32 v35, v35, v246, v245
    buffer_store_dwordx4 v[32:35], v243, s[32:35], s62 offen sc1
    v_cndmask_b32 v40, v44, v40, s[60:61]
    v_cndmask_b32 v41, v45, v41, s[60:61]
    v_cndmask_b32 v42, v46, v42, s[60:61]
    v_cndmask_b32 v43, v47, v43, s[60:61]
    v_and_or_b32 v40, v40, v246, v245
    v_and_or_b32 v41, v41, v246, v245
    v_and_or_b32 v42, v42, v246, v245
    v_and_or_b32 v43, v43, v246, v245
    buffer_store_dwordx4 v[40:43], v243, s[32:35], s54 offen sc1
DUMP:
END:
    s_endpgm
.p2align 7
.type TBL,@object
TBL:
.long 0x0, 0x0, 0x0, 0x0, 0x0, 0x0, 0x0, 0x0
.long 0x0, 0x0, 0x0, 0x0, 0x0, 0x0, 0x0, 0x0
.long 0x0, 0x0, 0x0, 0x0, 0x0, 0x0, 0x0, 0x0
.long 0x0, 0x0, 0x0, 0x0, 0x0, 0x0, 0x0, 0x0
.long 0x0, 0x0, 0x0, 0x0, 0x0, 0x0, 0x0, 0x0
.long 0x0, 0x0, 0x0, 0x0, 0x0, 0x0, 0x0, 0x0
.long 0x0, 0x0, 0x0, 0x0, 0x0, 0x0, 0x0, 0x0
.long 0x0, 0x0, 0x0, 0x0, 0x0, 0x0, 0x0, 0x0
.long 0x0, 0x3c000000, 0x3c003c00, 0x0, 0x0, 0x0, 0x3c003c00, 0x3c00
.long 0x0, 0x0, 0x3c000000, 0x3c003c00, 0x0, 0x0, 0x0, 0x3c003c00
.long 0x0, 0x0, 0x0, 0x3c000000, 0x0, 0x0, 0x0, 0x0
.long 0x0, 0x0, 0x0, 0x0, 0x0, 0x0, 0x0, 0x0
.long 0x0, 0x0, 0x0, 0x0, 0x0, 0x0, 0x0, 0x0
.long 0x0, 0x0, 0x0, 0x0, 0x0, 0x0, 0x0, 0x0
.long 0x0, 0x0, 0x0, 0x0, 0x0, 0x0, 0x0, 0x0
.long 0x0, 0x0, 0x0, 0x0, 0x0, 0x0, 0x0, 0x0
.long 0x0, 0x0, 0x0, 0x0, 0x0, 0x0, 0x0, 0x0
.long 0x0, 0x0, 0x0, 0x0, 0x3c00, 0x0, 0x0, 0x0
.long 0x3c003c00, 0x0, 0x0, 0x0, 0x3c003c00, 0x3c00, 0x0, 0x0
.long 0x3c000000, 0x3c003c00, 0x0, 0x0, 0x0, 0x3c003c00, 0x3c00, 0x0
.long 0x0, 0x3c000000, 0x3c003c00, 0x0, 0x0, 0x0, 0x3c003c00, 0x3c00
.long 0x0, 0x0, 0x3c000000, 0x3c003c00, 0x0, 0x0, 0x0, 0x3c003c00
.long 0x0, 0x0, 0x0, 0x3c000000, 0x0, 0x0, 0x0, 0x0
.long 0x0, 0x0, 0x0, 0x0, 0x0, 0x0, 0x0, 0x0
.long 0x0, 0x0, 0x0, 0x0, 0x0, 0x0, 0x0, 0x0
.long 0x0, 0x0, 0x0, 0x0, 0x0, 0x0, 0x0, 0x0
.long 0x0, 0x0, 0x0, 0x0, 0x0, 0x0, 0x0, 0x0
.long 0x0, 0x0, 0x0, 0x0, 0x0, 0x0, 0x0, 0x0
.long 0x0, 0x0, 0x0, 0x0, 0x0, 0x0, 0x0, 0x0
.long 0x0, 0x0, 0x0, 0x0, 0x3c00, 0x0, 0x0, 0x0
.long 0x3c003c00, 0x0, 0x0, 0x0, 0x3c003c00, 0x3c00, 0x0, 0x0
.long 0x3c000000, 0x3c003c00, 0x0, 0x0, 0x0, 0x3c003c00, 0x3c00, 0x0
.long 0x0, 0x0, 0x0, 0x3c003c00, 0x0, 0x0, 0x0, 0x3c000000
.long 0x0, 0x0, 0x0, 0x0, 0x0, 0x0, 0x0, 0x0
.long 0x0, 0x0, 0x0, 0x0, 0x0, 0x0, 0x0, 0x0
.long 0x0, 0x0, 0x0, 0x0, 0x0, 0x0, 0x0, 0x0
.long 0x0, 0x0, 0x0, 0x0, 0x0, 0x0, 0x0, 0x0
.long 0x0, 0x0, 0x0, 0x0, 0x0, 0x0, 0x0, 0x0
.long 0x0, 0x0, 0x0, 0x0, 0x0, 0x0, 0x0, 0x0
.long 0x0, 0x0, 0x0, 0x0, 0x0, 0x0, 0x0, 0x0
.long 0x3c003c00, 0x3c00, 0x0, 0x0, 0x3c003c00, 0x3c003c00, 0x0, 0x0
.long 0x3c003c00, 0x3c003c00, 0x3c00, 0x0, 0x3c000000, 0x3c003c00, 0x3c003c00, 0x0
.long 0x0, 0x3c003c00, 0x3c003c00, 0x3c00, 0x0, 0x3c000000, 0x3c003c00, 0x3c003c00
.long 0x0, 0x0, 0x3c003c00, 0x3c003c00, 0x0, 0x0, 0x3c000000, 0x3c003c00
.long 0x0, 0x0, 0x0, 0x3c003c00, 0x0, 0x0, 0x0, 0x3c000000
.long 0x0, 0x0, 0x0, 0x0, 0x0, 0x0, 0x0, 0x0
.long 0x0, 0x0, 0x0, 0x0, 0x0, 0x0, 0x0, 0x0
.long 0x0, 0x0, 0x0, 0x0, 0x0, 0x0, 0x0, 0x0
.long 0x0, 0x0, 0x0, 0x0, 0x0, 0x0, 0x0, 0x0
.long 0x0, 0x0, 0x0, 0x0, 0x0, 0x0, 0x0, 0x0
.long 0x0, 0x0, 0x0, 0x0, 0x0, 0x0, 0x0, 0x0
.long 0x3c00, 0x0, 0x0, 0x0, 0x3c003c00, 0x0, 0x0, 0x0
.long 0x3c003c00, 0x3c00, 0x0, 0x0, 0x3c003c00, 0x3c003c00, 0x0, 0x0
.long 0x3c003c00, 0x3c003c00, 0x3c00, 0x0, 0x3c000000, 0x3c003c00, 0x3c003c00, 0x0
.long 0x0, 0x3c003c00, 0x3c003c00, 0x3c00, 0x0, 0x3c000000, 0x3c003c00, 0x3c003c00
.long 0x0, 0x0, 0x3c003c00, 0x3c003c00, 0x0, 0x0, 0x3c000000, 0x3c003c00
.long 0x0, 0x0, 0x0, 0x0, 0x0, 0x0, 0x0, 0x0
.long 0x0, 0x0, 0x0, 0x0, 0x0, 0x0, 0x0, 0x0
.long 0x0, 0x0, 0x0, 0x0, 0x0, 0x0, 0x0, 0x0
.long 0x0, 0x0, 0x0, 0x0, 0x0, 0x0, 0x0, 0x0
.long 0x0, 0x0, 0x0, 0x0, 0x0, 0x0, 0x0, 0x0
.long 0x0, 0x0, 0x0, 0x0, 0x0, 0x0, 0x0, 0x0
.long 0x0, 0x0, 0x0, 0x0, 0x0, 0x0, 0x0, 0x0
.long 0x3c00, 0x0, 0x0, 0x0, 0x3c003c00, 0x0, 0x0, 0x0
.long 0x0, 0x3c000000, 0x3c003c00, 0x0, 0x0, 0x0, 0x3c003c00, 0x3c00
.long 0x0, 0x0, 0x3c000000, 0x3c003c00, 0x0, 0x0, 0x0, 0x3c003c00
.long 0x0, 0x0, 0x0, 0x3c000000, 0x0, 0x0, 0x0, 0x0
.long 0x0, 0x0, 0x0, 0x0, 0x0, 0x0, 0x0, 0x0
.long 0x0, 0x0, 0x0, 0x0, 0x0, 0x0, 0x0, 0x0
.long 0x0, 0x0, 0x0, 0x0, 0x0, 0x0, 0x0, 0x0
.long 0x0, 0x0, 0x0, 0x0, 0x0, 0x0, 0x0, 0x0
.long 0x0, 0x0, 0x0, 0x0, 0x0, 0x0, 0x0, 0x0
.long 0x0, 0x0, 0x0, 0x0, 0x0, 0x0, 0x0, 0x0
.long 0x0, 0x0, 0x0, 0x0, 0x3c00, 0x0, 0x0, 0x0
.long 0x3c003c00, 0x0, 0x0, 0x0, 0x3c003c00, 0x3c00, 0x0, 0x0
.long 0x3c000000, 0x3c003c00, 0x0, 0x0, 0x0, 0x3c003c00, 0x3c00, 0x0
.long 0x0, 0x3c000000, 0x3c003c00, 0x0, 0x0, 0x0, 0x3c003c00, 0x3c00
.long 0x0, 0x0, 0x3c000000, 0x3c003c00, 0x0, 0x0, 0x0, 0x3c003c00
.long 0x0, 0x0, 0x0, 0x3c000000, 0x0, 0x0, 0x0, 0x0
.long 0x0, 0x0, 0x0, 0x0, 0x0, 0x0, 0x0, 0x0
.long 0x0, 0x0, 0x0, 0x0, 0x0, 0x0, 0x0, 0x0
.long 0x0, 0x0, 0x0, 0x0, 0x0, 0x0, 0x0, 0x0
.long 0x0, 0x0, 0x0, 0x0, 0x0, 0x0, 0x0, 0x0
.long 0x0, 0x0, 0x0, 0x0, 0x0, 0x0, 0x0, 0x0
.long 0x0, 0x0, 0x0, 0x0, 0x0, 0x0, 0x0, 0x0
.long 0x0, 0x0, 0x0, 0x0, 0x3c00, 0x0, 0x0, 0x0
.long 0x3c003c00, 0x0, 0x0, 0x0, 0x3c003c00, 0x3c00, 0x0, 0x0
.long 0x3c000000, 0x3c003c00, 0x0, 0x0, 0x0, 0x3c003c00, 0x3c00, 0x0
.long 0x0, 0x0, 0x0, 0x0, 0x0, 0x0, 0x0, 0x0
.long 0x0, 0x0, 0x0, 0x0, 0x0, 0x0, 0x0, 0x0
.long 0x0, 0x0, 0x0, 0x0, 0x0, 0x0, 0x0, 0x0
.long 0x0, 0x0, 0x0, 0x0, 0x0, 0x0, 0x0, 0x0
.long 0x0, 0x0, 0x0, 0x0, 0x0, 0x0, 0x0, 0x0
.long 0x0, 0x0, 0x0, 0x0, 0x0, 0x0, 0x0, 0x0
.long 0x0, 0x0, 0x0, 0x0, 0x0, 0x0, 0x0, 0x0
.long 0x0, 0x0, 0x0, 0x0, 0x0, 0x0, 0x0, 0x0
.long 0x0, 0x0, 0x0, 0x3c003c00, 0x0, 0x0, 0x0, 0x3c000000
.long 0x0, 0x0, 0x0, 0x0, 0x0, 0x0, 0x0, 0x0
.long 0x0, 0x0, 0x0, 0x0, 0x0, 0x0, 0x0, 0x0
.long 0x0, 0x0, 0x0, 0x0, 0x0, 0x0, 0x0, 0x0
.long 0x0, 0x0, 0x0, 0x0, 0x0, 0x0, 0x0, 0x0
.long 0x0, 0x0, 0x0, 0x0, 0x0, 0x0, 0x0, 0x0
.long 0x0, 0x0, 0x0, 0x0, 0x0, 0x0, 0x0, 0x0
.long 0x0, 0x0, 0x0, 0x0, 0x0, 0x0, 0x0, 0x0
.long 0x3c003c00, 0x3c00, 0x0, 0x0, 0x3c003c00, 0x3c003c00, 0x0, 0x0
.long 0x3c003c00, 0x3c003c00, 0x3c00, 0x0, 0x3c000000, 0x3c003c00, 0x3c003c00, 0x0
.long 0x0, 0x3c003c00, 0x3c003c00, 0x3c00, 0x0, 0x3c000000, 0x3c003c00, 0x3c003c00
.long 0x0, 0x0, 0x3c003c00, 0x3c003c00, 0x0, 0x0, 0x3c000000, 0x3c003c00
.long 0x0, 0x0, 0x0, 0x3c003c00, 0x0, 0x0, 0x0, 0x3c000000
.long 0x0, 0x0, 0x0, 0x0, 0x0, 0x0, 0x0, 0x0
.long 0x0, 0x0, 0x0, 0x0, 0x0, 0x0, 0x0, 0x0
.long 0x0, 0x0, 0x0, 0x0, 0x0, 0x0, 0x0, 0x0
.long 0x0, 0x0, 0x0, 0x0, 0x0, 0x0, 0x0, 0x0
.long 0x0, 0x0, 0x0, 0x0, 0x0, 0x0, 0x0, 0x0
.long 0x0, 0x0, 0x0, 0x0, 0x0, 0x0, 0x0, 0x0
.long 0x3c00, 0x0, 0x0, 0x0, 0x3c003c00, 0x0, 0x0, 0x0
.long 0x3c003c00, 0x3c00, 0x0, 0x0, 0x3c003c00, 0x3c003c00, 0x0, 0x0
.long 0x3c003c00, 0x3c003c00, 0x3c00, 0x0, 0x3c000000, 0x3c003c00, 0x3c003c00, 0x0
.long 0x0, 0x3c003c00, 0x3c003c00, 0x3c00, 0x0, 0x3c000000, 0x3c003c00, 0x3c003c00
.long 0x0, 0x0, 0x3c003c00, 0x3c003c00, 0x0, 0x0, 0x3c000000, 0x3c003c00
.long 0x0, 0x0, 0x0, 0x0, 0x0, 0x0, 0x0, 0x0
.long 0x0, 0x0, 0x0, 0x0, 0x0, 0x0, 0x0, 0x0
.long 0x0, 0x0, 0x0, 0x0, 0x0, 0x0, 0x0, 0x0
.long 0x0, 0x0, 0x0, 0x0, 0x0, 0x0, 0x0, 0x0
.long 0x0, 0x0, 0x0, 0x0, 0x0, 0x0, 0x0, 0x0
.long 0x0, 0x0, 0x0, 0x0, 0x0, 0x0, 0x0, 0x0
.long 0x0, 0x0, 0x0, 0x0, 0x0, 0x0, 0x0, 0x0
.long 0x3c00, 0x0, 0x0, 0x0, 0x3c003c00, 0x0, 0x0, 0x0
.long 0x0, 0x0, 0x3c000000, 0x3c003c00, 0x0, 0x0, 0x0, 0x3c003c00
.long 0x0, 0x0, 0x0, 0x3c000000, 0x0, 0x0, 0x0, 0x0
.long 0x0, 0x0, 0x0, 0x0, 0x0, 0x0, 0x0, 0x0
.long 0x0, 0x0, 0x0, 0x0, 0x0, 0x0, 0x0, 0x0
.long 0x0, 0x0, 0x0, 0x0, 0x0, 0x0, 0x0, 0x0
.long 0x0, 0x0, 0x0, 0x0, 0x0, 0x0, 0x0, 0x0
.long 0x0, 0x0, 0x0, 0x0, 0x0, 0x0, 0x0, 0x0
.long 0x0, 0x0, 0x0, 0x0, 0x0, 0x0, 0x0, 0x0
.long 0x3c003c00, 0x3c003c00, 0x0, 0x0, 0x3c003c00, 0x3c003c00, 0x3c00, 0x0
.long 0x3c003c00, 0x3c003c00, 0x3c003c00, 0x0, 0x3c003c00, 0x3c003c00, 0x3c003c00, 0x3c00
.long 0x3c000000, 0x3c003c00, 0x3c003c00, 0x3c003c00, 0x0, 0x3c003c00, 0x3c003c00, 0x3c003c00
.long 0x0, 0x3c000000, 0x3c003c00, 0x3c003c00, 0x0, 0x0, 0x3c003c00, 0x3c003c00
.long 0x0, 0x0, 0x3c000000, 0x3c003c00, 0x0, 0x0, 0x0, 0x3c003c00
.long 0x0, 0x0, 0x0, 0x3c000000, 0x0, 0x0, 0x0, 0x0
.long 0x0, 0x0, 0x0, 0x0, 0x0, 0x0, 0x0, 0x0
.long 0x0, 0x0, 0x0, 0x0, 0x0, 0x0, 0x0, 0x0
.long 0x0, 0x0, 0x0, 0x0, 0x0, 0x0, 0x0, 0x0
.long 0x0, 0x0, 0x0, 0x0, 0x0, 0x0, 0x0, 0x0
.long 0x0, 0x0, 0x0, 0x0, 0x3c00, 0x0, 0x0, 0x0
.long 0x3c003c00, 0x0, 0x0, 0x0, 0x3c003c00, 0x3c00, 0x0, 0x0
.long 0x3c003c00, 0x3c003c00, 0x0, 0x0, 0x3c003c00, 0x3c003c00, 0x3c00, 0x0
.long 0x3c003c00, 0x3c003c00, 0x3c003c00, 0x0, 0x3c003c00, 0x3c003c00, 0x3c003c00, 0x3c00
.long 0x3c000000, 0x3c003c00, 0x3c003c00, 0x3c003c00, 0x0, 0x3c003c00, 0x3c003c00, 0x3c003c00
.long 0x0, 0x3c000000, 0x3c003c00, 0x3c003c00, 0x0, 0x0, 0x3c003c00, 0x3c003c00
.long 0x0, 0x0, 0x0, 0x0, 0x0, 0x0, 0x0, 0x0
.long 0x0, 0x0, 0x0, 0x0, 0x0, 0x0, 0x0, 0x0
.long 0x0, 0x0, 0x0, 0x0, 0x0, 0x0, 0x0, 0x0
.long 0x0, 0x0, 0x0, 0x0, 0x0, 0x0, 0x0, 0x0
.long 0x0, 0x0, 0x0, 0x0, 0x0, 0x0, 0x0, 0x0
.long 0x0, 0x0, 0x0, 0x0, 0x0, 0x0, 0x0, 0x0
.long 0x0, 0x0, 0x0, 0x0, 0x3c00, 0x0, 0x0, 0x0
.long 0x3c003c00, 0x0, 0x0, 0x0, 0x3c003c00, 0x3c00, 0x0, 0x0
.long 0x0, 0x0, 0x3c003c00, 0x3c003c00, 0x0, 0x0, 0x3c000000, 0x3c003c00
.long 0x0, 0x0, 0x0, 0x3c003c00, 0x0, 0x0, 0x0, 0x3c000000
.long 0x0, 0x0, 0x0, 0x0, 0x0, 0x0, 0x0, 0x0
.long 0x0, 0x0, 0x0, 0x0, 0x0, 0x0, 0x0, 0x0
.long 0x0, 0x0, 0x0, 0x0, 0x0, 0x0, 0x0, 0x0
.long 0x0, 0x0, 0x0, 0x0, 0x0, 0x0, 0x0, 0x0
.long 0x0, 0x0, 0x0, 0x0, 0x0, 0x0, 0x0, 0x0
.long 0x0, 0x0, 0x0, 0x0, 0x0, 0x0, 0x0, 0x0
.long 0x3c003c00, 0x3c003c00, 0x3c00, 0x0, 0x3c003c00, 0x3c003c00, 0x3c003c00, 0x0
.long 0x3c003c00, 0x3c003c00, 0x3c003c00, 0x3c00, 0x3c003c00, 0x3c003c00, 0x3c003c00, 0x3c003c00
.long 0x3c003c00, 0x3c003c00, 0x3c003c00, 0x3c003c00, 0x3c000000, 0x3c003c00, 0x3c003c00, 0x3c003c00
.long 0x0, 0x3c003c00, 0x3c003c00, 0x3c003c00, 0x0, 0x3c000000, 0x3c003c00, 0x3c003c00
.long 0x0, 0x0, 0x3c003c00, 0x3c003c00, 0x0, 0x0, 0x3c000000, 0x3c003c00
.long 0x0, 0x0, 0x0, 0x3c003c00, 0x0, 0x0, 0x0, 0x3c000000
.long 0x0, 0x0, 0x0, 0x0, 0x0, 0x0, 0x0, 0x0
.long 0x0, 0x0, 0x0, 0x0, 0x0, 0x0, 0x0, 0x0
.long 0x0, 0x0, 0x0, 0x0, 0x0, 0x0, 0x0, 0x0
.long 0x0, 0x0, 0x0, 0x0, 0x0, 0x0, 0x0, 0x0
.long 0x3c00, 0x0, 0x0, 0x0, 0x3c003c00, 0x0, 0x0, 0x0
.long 0x3c003c00, 0x3c00, 0x0, 0x0, 0x3c003c00, 0x3c003c00, 0x0, 0x0
.long 0x3c003c00, 0x3c003c00, 0x3c00, 0x0, 0x3c003c00, 0x3c003c00, 0x3c003c00, 0x0
.long 0x3c003c00, 0x3c003c00, 0x3c003c00, 0x3c00, 0x3c003c00, 0x3c003c00, 0x3c003c00, 0x3c003c00
.long 0x3c003c00, 0x3c003c00, 0x3c003c00, 0x3c003c00, 0x3c000000, 0x3c003c00, 0x3c003c00, 0x3c003c00
.long 0x0, 0x3c003c00, 0x3c003c00, 0x3c003c00, 0x0, 0x3c000000, 0x3c003c00, 0x3c003c00
.long 0x0, 0x0, 0x0, 0x0, 0x0, 0x0, 0x0, 0x0
.long 0x0, 0x0, 0x0, 0x0, 0x0, 0x0, 0x0, 0x0
.long 0x0, 0x0, 0x0, 0x0, 0x0, 0x0, 0x0, 0x0
.long 0x0, 0x0, 0x0, 0x0, 0x0, 0x0, 0x0, 0x0
.long 0x0, 0x0, 0x0, 0x0, 0x0, 0x0, 0x0, 0x0
.long 0x0, 0x0, 0x0, 0x0, 0x0, 0x0, 0x0, 0x0
.long 0x3c00, 0x0, 0x0, 0x0, 0x3c003c00, 0x0, 0x0, 0x0
.long 0x3c003c00, 0x3c00, 0x0, 0x0, 0x3c003c00, 0x3c003c00, 0x0, 0x0
.long 0x0, 0x0, 0x0, 0x0, 0x0, 0x0, 0x0, 0x0
.long 0x0, 0x0, 0x0, 0x0, 0x0, 0x0, 0x0, 0x0
.long 0x0, 0x0, 0x0, 0x0, 0x0, 0x0, 0x0, 0x0
.long 0x0, 0x0, 0x0, 0x0, 0x0, 0x0, 0x0, 0x0
.long 0x0, 0x0, 0x0, 0x0, 0x0, 0x0, 0x0, 0x0
.long 0x0, 0x0, 0x0, 0x0, 0x0, 0x0, 0x0, 0x0
.long 0x0, 0x0, 0x0, 0x0, 0x0, 0x0, 0x0, 0x0
.long 0x0, 0x0, 0x0, 0x0, 0x0, 0x0, 0x0, 0x0
.long 0x0, 0x0, 0xffffffff, 0x0, 0x0, 0x0, 0xffff0000, 0xffff
.long 0x0, 0x0, 0x0, 0xffffffff, 0x0, 0x0, 0x0, 0xffff0000
.long 0x0, 0x0, 0x0, 0x0, 0x0, 0x0, 0x0, 0x0
.long 0x0, 0x0, 0x0, 0x0, 0x0, 0x0, 0x0, 0x0
.long 0x0, 0x0, 0x0, 0x0, 0x0, 0x0, 0x0, 0x0
.long 0x0, 0x0, 0x0, 0x0, 0x0, 0x0, 0x0, 0x0
.long 0x0, 0x0, 0x0, 0x0, 0x0, 0x0, 0x0, 0x0
.long 0x0, 0x0, 0x0, 0x0, 0x0, 0x0, 0x0, 0x0
.long 0x0, 0x0, 0x0, 0x0, 0x0, 0x0, 0x0, 0x0
.long 0x0, 0x0, 0x0, 0x0, 0xffff, 0x0, 0x0, 0x0
.long 0xffffffff, 0x0, 0x0, 0x0, 0xffff0000, 0xffff, 0x0, 0x0
.long 0x0, 0xffffffff, 0x0, 0x0, 0x0, 0xffff0000, 0xffff, 0x0
.long 0x0, 0x0, 0xffffffff, 0x0, 0x0, 0x0, 0xffff0000, 0xffff
.long 0x0, 0x0, 0x0, 0xffffffff, 0x0, 0x0, 0x0, 0xffff0000
.long 0x0, 0x0, 0x0, 0x0, 0x0, 0x0, 0x0, 0x0
.long 0x0, 0x0, 0x0, 0x0, 0x0, 0x0, 0x0, 0x0
.long 0x0, 0x0, 0x0, 0x0, 0x0, 0x0, 0x0, 0x0
.long 0x0, 0x0, 0x0, 0x0, 0x0, 0x0, 0x0, 0x0
.long 0x0, 0x0, 0x0, 0x0, 0x0, 0x0, 0x0, 0x0
.long 0x0, 0x0, 0x0, 0x0, 0x0, 0x0, 0x0, 0x0
.long 0x0, 0x0, 0x0, 0x0, 0x0, 0x0, 0x0, 0x0
.long 0x0, 0x0, 0x0, 0x0, 0xffff, 0x0, 0x0, 0x0
.long 0xffffffff, 0x0, 0x0, 0x0, 0xffff0000, 0xffff, 0x0, 0x0
.long 0x0, 0xffffffff, 0x0, 0x0, 0x0, 0xffff0000, 0xffff, 0x0
.long 0x878, 0x438, 0x230, 0x238, 0x858, 0x418, 0x210, 0x218
.long 0x838, 0x3f8, 0x1f0, 0x1f8, 0x818, 0x3d8, 0x1d0, 0x1d8
.long 0x7f8, 0x3b8, 0x1b0, 0x1b8, 0x7d8, 0x398, 0x190, 0x198
.long 0x7b8, 0x378, 0x170, 0x178, 0x798, 0x358, 0x150, 0x158
.long 0x778, 0x338, 0x130, 0x138, 0x758, 0x318, 0x110, 0x118
.long 0x738, 0x2f8, 0xf0, 0xf8, 0x718, 0x2d8, 0xd0, 0xd8
.long 0x6f8, 0x2b8, 0xb0, 0xb8, 0x6d8, 0x298, 0x90, 0x98
.long 0x6b8, 0x278, 0x70, 0x78, 0x698, 0x258, 0x50, 0x58
.long 0x868, 0x428, 0x220, 0x228, 0x848, 0x408, 0x200, 0x208
.long 0x828, 0x3e8, 0x1e0, 0x1e8, 0x808, 0x3c8, 0x1c0, 0x1c8
.long 0x7e8, 0x3a8, 0x1a0, 0x1a8, 0x7c8, 0x388, 0x180, 0x188
.long 0x7a8, 0x368, 0x160, 0x168, 0x788, 0x348, 0x140, 0x148
.long 0x768, 0x328, 0x120, 0x128, 0x748, 0x308, 0x100, 0x108
.long 0x728, 0x2e8, 0xe0, 0xe8, 0x708, 0x2c8, 0xc0, 0xc8
.long 0x6e8, 0x2a8, 0xa0, 0xa8, 0x6c8, 0x288, 0x80, 0x88
.long 0x6a8, 0x268, 0x60, 0x68, 0x688, 0x248, 0x40, 0x48
.long 0x870, 0x430, 0x90c, 0x94c, 0x850, 0x410, 0x908, 0x948
.long 0x830, 0x3f0, 0x904, 0x944, 0x810, 0x3d0, 0x900, 0x940
.long 0x7f0, 0x3b0, 0x8fc, 0x93c, 0x7d0, 0x390, 0x8f8, 0x938
.long 0x7b0, 0x370, 0x8f4, 0x934, 0x790, 0x350, 0x8f0, 0x930
.long 0x770, 0x330, 0x8ec, 0x92c, 0x750, 0x310, 0x8e8, 0x928
.long 0x730, 0x2f0, 0x8e4, 0x924, 0x710, 0x2d0, 0x8e0, 0x920
.long 0x6f0, 0x2b0, 0x8dc, 0x91c, 0x6d0, 0x290, 0x8d8, 0x918
.long 0x6b0, 0x270, 0x8d4, 0x914, 0x690, 0x250, 0x8d0, 0x910
.long 0x860, 0x420, 0x9cc, 0xa0c, 0x840, 0x400, 0x9c8, 0xa08
.long 0x820, 0x3e0, 0x9c4, 0xa04, 0x800, 0x3c0, 0x9c0, 0xa00
.long 0x7e0, 0x3a0, 0x9bc, 0x9fc, 0x7c0, 0x380, 0x9b8, 0x9f8
.long 0x7a0, 0x360, 0x9b4, 0x9f4, 0x780, 0x340, 0x9b0, 0x9f0
.long 0x760, 0x320, 0x9ac, 0x9ec, 0x740, 0x300, 0x9a8, 0x9e8
.long 0x720, 0x2e0, 0x9a4, 0x9e4, 0x700, 0x2c0, 0x9a0, 0x9e0
.long 0x6e0, 0x2a0, 0x99c, 0x9dc, 0x6c0, 0x280, 0x998, 0x9d8
.long 0x6a0, 0x260, 0x994, 0x9d4, 0x680, 0x240, 0x990, 0x9d0
.long 0x22c, 0x670, 0xb90, 0x23e, 0x20c, 0x650, 0xb90, 0xb90
.long 0x1ec, 0x630, 0xb90, 0xb90, 0x1cc, 0x610, 0xb90, 0xb90
.long 0x1ac, 0x5f0, 0xb90, 0xb90, 0x18c, 0x5d0, 0xb90, 0xb90
.long 0x16c, 0x5b0, 0xb90, 0xb90, 0x14c, 0x590, 0xb90, 0xb90
.long 0x12c, 0x570, 0xb90, 0xb90, 0x10c, 0x550, 0xb90, 0xb90
.long 0xec, 0x530, 0xb90, 0xb90, 0xcc, 0x510, 0xb90, 0xb90
.long 0xac, 0x4f0, 0xb90, 0xb90, 0x8c, 0x4d0, 0xb90, 0xb90
.long 0x6c, 0x4b0, 0xb90, 0xb90, 0x4c, 0x490, 0xb90, 0xb90
.long 0x21c, 0x660, 0xb90, 0xb90, 0x1fc, 0x640, 0xb90, 0xb90
.long 0x1dc, 0x620, 0xb90, 0xb90, 0x1bc, 0x600, 0xb90, 0xb90
.long 0x19c, 0x5e0, 0xb90, 0xb90, 0x17c, 0x5c0, 0xb90, 0xb90
.long 0x15c, 0x5a0, 0xb90, 0xb90, 0x13c, 0x580, 0xb90, 0xb90
.long 0x11c, 0x560, 0xb90, 0xb90, 0xfc, 0x540, 0xb90, 0xb90
.long 0xdc, 0x520, 0xb90, 0xb90, 0xbc, 0x500, 0xb90, 0xb90
.long 0x9c, 0x4e0, 0xb90, 0xb90, 0x7c, 0x4c0, 0xb90, 0xb90
.long 0x5c, 0x4a0, 0xb90, 0xb90, 0x3c, 0x480, 0x47c, 0xb90
.long 0xb90, 0xb90, 0xb90, 0xb4c, 0xb90, 0xb90, 0xb90, 0xb48
.long 0xb90, 0xb90, 0xb90, 0xb44, 0xb90, 0xb90, 0xb90, 0xb40
.long 0xb90, 0xb90, 0xb90, 0xb3c, 0xb90, 0xb90, 0xb90, 0xb38
.long 0xb90, 0xb90, 0xb90, 0xb34, 0xb90, 0xb90, 0xb90, 0xb30
.long 0xb90, 0xb90, 0xb90, 0xb2c, 0xb90, 0xb90, 0xb90, 0xb28
.long 0xb90, 0xb90, 0xb90, 0xb24, 0xb90, 0xb90, 0xb90, 0xb20
.long 0xb90, 0xb90, 0xb90, 0xb1c, 0xb90, 0xb90, 0xb90, 0xb18
.long 0xb90, 0xb90, 0xb90, 0xb14, 0xb90, 0xb90, 0xb90, 0xb10
.long 0xb90, 0xb90, 0xb90, 0xb4e, 0xb90, 0xb90, 0xb90, 0xb4a
.long 0xb90, 0xb90, 0xb90, 0xb46, 0xb90, 0xb90, 0xb90, 0xb42
.long 0xb90, 0xb90, 0xb90, 0xb3e, 0xb90, 0xb90, 0xb90, 0xb3a
.long 0xb90, 0xb90, 0xb90, 0xb36, 0xb90, 0xb90, 0xb90, 0xb32
.long 0xb90, 0xb90, 0xb90, 0xb2e, 0xb90, 0xb90, 0xb90, 0xb2a
.long 0xb90, 0xb90, 0xb90, 0xb26, 0xb90, 0xb90, 0xb90, 0xb22
.long 0xb90, 0xb90, 0xb90, 0xb1e, 0xb90, 0xb90, 0xb90, 0xb1a
.long 0xb90, 0xb90, 0xb90, 0xb16, 0xb90, 0xb90, 0xb90, 0xb12
.long 0x23c, 0x880, 0xb90, 0x4200, 0xb90, 0xb90, 0xb90, 0x4c50
.long 0xb90, 0xb90, 0xb90, 0x4410, 0xb90, 0xb90, 0xb90, 0x5070
.long 0xb90, 0xb90, 0xb90, 0x5280, 0xb90, 0xb90, 0xb90, 0x4620
.long 0xb90, 0xb90, 0xb90, 0x5490, 0xb90, 0xb90, 0xb90, 0x4830
.long 0xb90, 0xb90, 0xb90, 0x6510, 0xb90, 0xb90, 0xb90, 0x6d50
.long 0xb90, 0xb90, 0xb90, 0x56a0, 0xb90, 0xb90, 0xb90, 0x4a40
.long 0xb90, 0xb90, 0xb90, 0x6720, 0xb90, 0xb90, 0xb90, 0x6b40
.long 0xb90, 0xb90, 0xb90, 0x6930, 0xb90, 0xb90, 0xb90, 0x58b0
.long 0xb90, 0xb90, 0xb90, 0x6300, 0xb90, 0xb90, 0xb90, 0x6300
.long 0xb90, 0xb90, 0xb90, 0x4e60, 0xb90, 0xb90, 0xb90, 0x4a40
.long 0xb90, 0xb90, 0xb90, 0x5ac0, 0xb90, 0xb90, 0xb90, 0x5cd0
.long 0xb90, 0xb90, 0xb90, 0x5ee0, 0xb90, 0xb90, 0xb90, 0x60f0
.long 0xb90, 0xb90, 0xb90, 0x4e60, 0xb90, 0xb90, 0xb90, 0x4200
.long 0xb90, 0xb90, 0xb90, 0x4c50, 0xb90, 0xb90, 0xb90, 0x4410
.long 0xb90, 0xb90, 0xb90, 0x5070, 0xb90, 0xb90, 0xb90, 0x5280
.long 0xb90, 0xb90, 0xb90, 0x4620, 0xb90, 0xb90, 0x3a, 0x5490
.long 0xb0c, 0xacc, 0xa8c, 0x4210, 0xb08, 0xac8, 0xa88, 0x4c60
.long 0xb04, 0xac4, 0xa84, 0x4420, 0xb00, 0xac0, 0xa80, 0x5080
.long 0xafc, 0xabc, 0xa7c, 0x5290, 0xaf8, 0xab8, 0xa78, 0x4630
.long 0xaf4, 0xab4, 0xa74, 0x54a0, 0xaf0, 0xab0, 0xa70, 0x4840
.long 0xaec, 0xaac, 0xa6c, 0x6520, 0xae8, 0xaa8, 0xa68, 0x6d60
.long 0xae4, 0xaa4, 0xa64, 0x56b0, 0xae0, 0xaa0, 0xa60, 0x4a50
.long 0xadc, 0xa9c, 0xa5c, 0x6730, 0xad8, 0xa98, 0xa58, 0x6b50
.long 0xad4, 0xa94, 0xa54, 0x6940, 0xad0, 0xa90, 0xa50, 0x58c0
.long 0xb0e, 0xace, 0xa8e, 0x6310, 0xb0a, 0xaca, 0xa8a, 0x6310
.long 0xb06, 0xac6, 0xa86, 0x4e70, 0xb02, 0xac2, 0xa82, 0x4a50
.long 0xafe, 0xabe, 0xa7e, 0x5ad0, 0xafa, 0xaba, 0xa7a, 0x5ce0
.long 0xaf6, 0xab6, 0xa76, 0x5ef0, 0xaf2, 0xab2, 0xa72, 0x6100
.long 0xaee, 0xaae, 0xa6e, 0x4e70, 0xaea, 0xaaa, 0xa6a, 0x4210
.long 0xae6, 0xaa6, 0xa66, 0x4c60, 0xae2, 0xaa2, 0xa62, 0x4420
.long 0xade, 0xa9e, 0xa5e, 0x5080, 0xada, 0xa9a, 0xa5a, 0x5290
.long 0xad6, 0xa96, 0xa56, 0x4630, 0xad2, 0xa92, 0xa52, 0x54a0
TBLEND:
.size TBL, .-TBL
.section .rodata,"a"
.p2align 6
.amdhsa_kernel sequential_preLN__ssm_conv_s4d__moe_arch_mod__prompt_kernel
  .amdhsa_next_free_vgpr 256
  .amdhsa_next_free_sgpr 102
  .amdhsa_accum_offset 256
  .amdhsa_group_segment_fixed_size 0
  .amdhsa_kernarg_size 120
  .amdhsa_user_sgpr_count 2
  .amdhsa_user_sgpr_kernarg_segment_ptr 1
  .amdhsa_system_sgpr_workgroup_id_x 1
.end_amdhsa_kernel
```
